```python
import torch

def _softmax(x, axis=-1):
    return torch.softmax(x, dim=axis)
def _gelu(x):
    return torch.nn.functional.gelu(x, approximate="tanh")
def _silu(x):
    return torch.nn.functional.silu(x)
def _sigmoid(x):
    return torch.sigmoid(x)
def _layernorm(x, axis=-1, eps=1e-5):
    m = x.mean(dim=axis, keepdim=True)
    v = x.var(dim=axis, keepdim=True, unbiased=False)
    return (x - m) / torch.sqrt(v + eps)
def _scatter_add(tgt, idx, src, axis=0):
    return tgt.clone().index_add_(axis, idx, src)
def _segment_sum(src, seg, n):
    out = torch.zeros((n,) + src.shape[1:], dtype=src.dtype)
    return out.index_add_(0, seg, src)
def _pad(x, pw):
    flat = tuple(v for pair in reversed(pw) for v in pair)
    return torch.nn.functional.pad(x, flat)

kernel_name = 'sequential_preLN__spectral_gfnet__geglu_ffn__prompt'

def setup_inputs():

    _w = (lambda a: (lambda t: t.to(torch.bfloat16) if t.is_floating_point() else t)(torch.as_tensor(a)))
    def _A_setup():
        B, S, D = 1, 2048, 640
        Df = D // 2 + 1
        return {
            "x": _w((lambda *s: torch.randn(*s, dtype=torch.bfloat16) * 0.05)(B, S, D)),
            "w_r": _w((lambda *s: torch.randn(*s, dtype=torch.bfloat16) * 0.4)(S, Df) * 0.02),
            "w_i": _w((lambda *s: torch.randn(*s, dtype=torch.bfloat16) * 0.4)(S, Df) * 0.02),
        }
    _A_in = _A_setup()

    def _B_setup():
        B, S, D, F = 1, 2048, 640, 1536
        return {
            "x": _w((lambda *s: torch.randn(*s, dtype=torch.bfloat16) * 0.05)(B, S, D)),
            "w_gate": _w((lambda *s: torch.randn(*s, dtype=torch.bfloat16) * 0.05)(D, F)),
            "w_up": _w((lambda *s: torch.randn(*s, dtype=torch.bfloat16) * 0.05)(D, F)),
            "w_down": _w((lambda *s: torch.randn(*s, dtype=torch.bfloat16) * 0.05)(F, D)),
        }
    _B_in = _B_setup()

    return {
        "A_x": _A_in["x"],
        "A_w_r": _A_in["w_r"],
        "A_w_i": _A_in["w_i"],
        "B_x": _B_in["x"],
        "B_w_gate": _B_in["w_gate"],
        "B_w_up": _B_in["w_up"],
        "B_w_down": _B_in["w_down"],
    }

def reference(A_x, A_w_r, A_w_i, B_x, B_w_gate, B_w_up, B_w_down):
    def _A_ref(x, w_r, w_i):
        B, S, D = x.shape
        X = (lambda x, axes=(-2,-1): torch.fft.rfft2(x.float(), dim=axes))(x, axes=(-2, -1))
        W = w_r + 1j * w_i
        X = X * W
        y = (lambda x, s, axes=(-2,-1): torch.fft.irfft2(x, s=s, dim=axes).to(torch.bfloat16))(X, (S, D), axes=(-2, -1))
        return y

    def _B_ref(x, w_gate, w_up, w_down):
        return (_gelu(x @ w_gate) * (x @ w_up)) @ w_down

    x = A_x
    h = x + _A_ref(_layernorm(x, axis=-1), A_w_r, A_w_i)
    h2 = h + _B_ref(_layernorm(h, axis=-1), B_w_gate, B_w_up, B_w_down)
    return h2
```

```asm
; @launch kernel=k1_kernel grid=(204,1,1) block=(512,1,1) lds=65536
; @launch kernel=k2_kernel grid=(252,1,1) block=(256,1,1) lds=57344
; @launch kernel=k3_kernel grid=(256,1,1) block=(512,1,1) lds=84224
; @launch kernel=k4_kernel grid=(256,1,1) block=(512,1,1) lds=122880
; @launch kernel=k5_kernel grid=(256,1,1) block=(256,1,1) lds=61440
.amdgcn_target "amdgcn-amd-amdhsa--gfx950"
.text
    .globl k1_kernel
    .p2align 8
    .type k1_kernel,@function
k1_kernel:
    s_cmp_ge_u32 s2, 204
    s_cbranch_scc1 k1_kernel_END
    s_cmp_ge_u32 s2, 128
    s_cbranch_scc1 k1_kernel_RP
    s_load_dwordx2 s[4:5], s[0:1], 0
    s_load_dwordx2 s[8:9], s[0:1], 72
    s_getpc_b64 s[90:91]
    s_add_u32 s20, s90, rowtab@rel32@lo+4
    s_addc_u32 s21, s91, rowtab@rel32@hi+12
    s_mov_b32 s22, 236544
    s_mov_b32 s23, 0x00020000
    v_lshrrev_b32 v1, 6, v0
    v_and_b32 v2, 63, v0
    s_and_b32 s30, s2, 63
    s_lshr_b32 s31, s2, 6
    v_readfirstlane_b32 s33, v1
    v_and_b32 v4, 15, v2
    v_lshrrev_b32 v5, 4, v2
    s_mul_i32 s34, s31, 6
    s_add_u32 s34, s34, s33
    s_cmp_lt_u32 s33, 6
    s_cselect_b32 s35, 1, 0
    s_cmp_lt_u32 s34, 11
    s_cselect_b32 s35, s35, 0
    s_lshl_b32 s36, s33, 8
    s_add_u32 s36, s36, s30
    v_lshl_add_u32 v6, v5, 6, s36
    v_mul_u32_u24 v6, 1280, v6
    v_lshlrev_b32 v7, 3, v4
    v_sub_u32 v8, v6, v7
    v_add_u32 v8, 760, v8
    v_add_u32 v6, v6, v7
    s_waitcnt lgkmcnt(0)
    s_mov_b32 s12, s4
    s_mov_b32 s13, s5
    s_mov_b32 s14, 2621440
    s_mov_b32 s15, 0x00020000
    buffer_load_dwordx2 v[96:97], v6, s[12:15], 0 offen offset:0
    buffer_load_dwordx2 v[106:107], v8, s[12:15], 0 offen offset:512
    buffer_load_dwordx2 v[98:99], v6, s[12:15], 0 offen offset:128
    buffer_load_dwordx2 v[108:109], v8, s[12:15], 0 offen offset:384
    buffer_load_dwordx2 v[100:101], v6, s[12:15], 0 offen offset:256
    buffer_load_dwordx2 v[110:111], v8, s[12:15], 0 offen offset:256
    buffer_load_dwordx2 v[102:103], v6, s[12:15], 0 offen offset:384
    buffer_load_dwordx2 v[112:113], v8, s[12:15], 0 offen offset:128
    buffer_load_dwordx2 v[104:105], v6, s[12:15], 0 offen offset:512
    buffer_load_dwordx2 v[114:115], v8, s[12:15], 0 offen offset:0
    s_mov_b32 s16, s8
    s_mov_b32 s17, s9
    s_mov_b32 s18, 2883584
    s_mov_b32 s19, 0x00020000
    s_cmp_lg_u32 s33, 7
    s_cbranch_scc1 k1_kernel_nopf
    s_lshr_b32 s36, s2, 3
    s_mul_i32 s36, s36, 14848
    v_lshlrev_b32 v3, 7, v2
    buffer_load_dword v120, v3, s[20:23], s36 offen
    s_add_u32 s36, s36, 8192
    buffer_load_dword v121, v3, s[20:23], s36 offen
k1_kernel_nopf:
    v_lshlrev_b32 v3, 4, v2
    s_mul_i32 s36, s34, 21504
    s_cmp_eq_u32 s35, 0
    s_cselect_b32 s36, 0x80000000, s36
    s_cbranch_scc1 k1_kernel_ln
    s_mov_b32 s80, 0x3a000000
    s_mov_b32 s81, 0x3e3504f3
    v_add_u32 v16, 0, v4
    v_lshl_add_u32 v17, v5, 2, 0
    v_lshl_add_u32 v17, v17, 6, s30
    v_mul_u32_u24 v16, v16, v17
    v_and_b32 v16, 2047, v16
    v_cvt_f32_u32 v16, v16
    v_mul_f32 v16, s80, v16
    v_cos_f32 v17, v16
    v_sin_f32 v18, v16
    v_add_u32 v20, 0, v4
    v_lshl_add_u32 v21, v5, 2, 1
    v_lshl_add_u32 v21, v21, 6, s30
    v_mul_u32_u24 v20, v20, v21
    v_and_b32 v20, 2047, v20
    v_cvt_f32_u32 v20, v20
    v_mul_f32 v20, s80, v20
    v_cos_f32 v21, v20
    v_sin_f32 v22, v20
    v_add_u32 v24, 0, v4
    v_lshl_add_u32 v25, v5, 2, 2
    v_lshl_add_u32 v25, v25, 6, s30
    v_mul_u32_u24 v24, v24, v25
    v_and_b32 v24, 2047, v24
    v_cvt_f32_u32 v24, v24
    v_mul_f32 v24, s80, v24
    v_cos_f32 v25, v24
    v_sin_f32 v26, v24
    v_add_u32 v28, 0, v4
    v_lshl_add_u32 v29, v5, 2, 3
    v_lshl_add_u32 v29, v29, 6, s30
    v_mul_u32_u24 v28, v28, v29
    v_and_b32 v28, 2047, v28
    v_cvt_f32_u32 v28, v28
    v_mul_f32 v28, s80, v28
    v_cos_f32 v29, v28
    v_sin_f32 v30, v28
    v_mul_f32 v17, s81, v17
    v_mul_f32 v18, s81, v18
    v_mul_f32 v21, s81, v21
    v_mul_f32 v22, s81, v22
    v_mul_f32 v25, s81, v25
    v_mul_f32 v26, s81, v26
    v_mul_f32 v29, s81, v29
    v_mul_f32 v30, s81, v30
    v_cvt_pk_f16_f32 v64, v17, v18
    v_cvt_pk_f16_f32 v72, -v18, v17
    v_cvt_pk_f16_f32 v65, v21, v22
    v_cvt_pk_f16_f32 v73, -v22, v21
    v_cvt_pk_f16_f32 v66, v25, v26
    v_cvt_pk_f16_f32 v74, -v26, v25
    v_cvt_pk_f16_f32 v67, v29, v30
    v_cvt_pk_f16_f32 v75, -v30, v29
    v_add_u32 v16, 0, v4
    v_lshl_add_u32 v17, v5, 2, 16
    v_lshl_add_u32 v17, v17, 6, s30
    v_mul_u32_u24 v16, v16, v17
    v_and_b32 v16, 2047, v16
    v_cvt_f32_u32 v16, v16
    v_mul_f32 v16, s80, v16
    v_cos_f32 v17, v16
    v_sin_f32 v18, v16
    v_add_u32 v20, 0, v4
    v_lshl_add_u32 v21, v5, 2, 17
    v_lshl_add_u32 v21, v21, 6, s30
    v_mul_u32_u24 v20, v20, v21
    v_and_b32 v20, 2047, v20
    v_cvt_f32_u32 v20, v20
    v_mul_f32 v20, s80, v20
    v_cos_f32 v21, v20
    v_sin_f32 v22, v20
    v_add_u32 v24, 0, v4
    v_lshl_add_u32 v25, v5, 2, 18
    v_lshl_add_u32 v25, v25, 6, s30
    v_mul_u32_u24 v24, v24, v25
    v_and_b32 v24, 2047, v24
    v_cvt_f32_u32 v24, v24
    v_mul_f32 v24, s80, v24
    v_cos_f32 v25, v24
    v_sin_f32 v26, v24
    v_add_u32 v28, 0, v4
    v_lshl_add_u32 v29, v5, 2, 19
    v_lshl_add_u32 v29, v29, 6, s30
    v_mul_u32_u24 v28, v28, v29
    v_and_b32 v28, 2047, v28
    v_cvt_f32_u32 v28, v28
    v_mul_f32 v28, s80, v28
    v_cos_f32 v29, v28
    v_sin_f32 v30, v28
    v_mul_f32 v17, s81, v17
    v_mul_f32 v18, s81, v18
    v_mul_f32 v21, s81, v21
    v_mul_f32 v22, s81, v22
    v_mul_f32 v25, s81, v25
    v_mul_f32 v26, s81, v26
    v_mul_f32 v29, s81, v29
    v_mul_f32 v30, s81, v30
    v_cvt_pk_f16_f32 v68, v17, v18
    v_cvt_pk_f16_f32 v76, -v18, v17
    v_cvt_pk_f16_f32 v69, v21, v22
    v_cvt_pk_f16_f32 v77, -v22, v21
    v_cvt_pk_f16_f32 v70, v25, v26
    v_cvt_pk_f16_f32 v78, -v26, v25
    v_cvt_pk_f16_f32 v71, v29, v30
    v_cvt_pk_f16_f32 v79, -v30, v29
    v_add_u32 v16, 16, v4
    v_lshl_add_u32 v17, v5, 2, 0
    v_lshl_add_u32 v17, v17, 6, s30
    v_mul_u32_u24 v16, v16, v17
    v_and_b32 v16, 2047, v16
    v_cvt_f32_u32 v16, v16
    v_mul_f32 v16, s80, v16
    v_cos_f32 v17, v16
    v_sin_f32 v18, v16
    v_add_u32 v20, 16, v4
    v_lshl_add_u32 v21, v5, 2, 1
    v_lshl_add_u32 v21, v21, 6, s30
    v_mul_u32_u24 v20, v20, v21
    v_and_b32 v20, 2047, v20
    v_cvt_f32_u32 v20, v20
    v_mul_f32 v20, s80, v20
    v_cos_f32 v21, v20
    v_sin_f32 v22, v20
    v_add_u32 v24, 16, v4
    v_lshl_add_u32 v25, v5, 2, 2
    v_lshl_add_u32 v25, v25, 6, s30
    v_mul_u32_u24 v24, v24, v25
    v_and_b32 v24, 2047, v24
    v_cvt_f32_u32 v24, v24
    v_mul_f32 v24, s80, v24
    v_cos_f32 v25, v24
    v_sin_f32 v26, v24
    v_add_u32 v28, 16, v4
    v_lshl_add_u32 v29, v5, 2, 3
    v_lshl_add_u32 v29, v29, 6, s30
    v_mul_u32_u24 v28, v28, v29
    v_and_b32 v28, 2047, v28
    v_cvt_f32_u32 v28, v28
    v_mul_f32 v28, s80, v28
    v_cos_f32 v29, v28
    v_sin_f32 v30, v28
    v_mul_f32 v17, s81, v17
    v_mul_f32 v18, s81, v18
    v_mul_f32 v21, s81, v21
    v_mul_f32 v22, s81, v22
    v_mul_f32 v25, s81, v25
    v_mul_f32 v26, s81, v26
    v_mul_f32 v29, s81, v29
    v_mul_f32 v30, s81, v30
    v_cvt_pk_f16_f32 v80, v17, v18
    v_cvt_pk_f16_f32 v88, -v18, v17
    v_cvt_pk_f16_f32 v81, v21, v22
    v_cvt_pk_f16_f32 v89, -v22, v21
    v_cvt_pk_f16_f32 v82, v25, v26
    v_cvt_pk_f16_f32 v90, -v26, v25
    v_cvt_pk_f16_f32 v83, v29, v30
    v_cvt_pk_f16_f32 v91, -v30, v29
    v_add_u32 v16, 16, v4
    v_lshl_add_u32 v17, v5, 2, 16
    v_lshl_add_u32 v17, v17, 6, s30
    v_mul_u32_u24 v16, v16, v17
    v_and_b32 v16, 2047, v16
    v_cvt_f32_u32 v16, v16
    v_mul_f32 v16, s80, v16
    v_cos_f32 v17, v16
    v_sin_f32 v18, v16
    v_add_u32 v20, 16, v4
    v_lshl_add_u32 v21, v5, 2, 17
    v_lshl_add_u32 v21, v21, 6, s30
    v_mul_u32_u24 v20, v20, v21
    v_and_b32 v20, 2047, v20
    v_cvt_f32_u32 v20, v20
    v_mul_f32 v20, s80, v20
    v_cos_f32 v21, v20
    v_sin_f32 v22, v20
    v_add_u32 v24, 16, v4
    v_lshl_add_u32 v25, v5, 2, 18
    v_lshl_add_u32 v25, v25, 6, s30
    v_mul_u32_u24 v24, v24, v25
    v_and_b32 v24, 2047, v24
    v_cvt_f32_u32 v24, v24
    v_mul_f32 v24, s80, v24
    v_cos_f32 v25, v24
    v_sin_f32 v26, v24
    v_add_u32 v28, 16, v4
    v_lshl_add_u32 v29, v5, 2, 19
    v_lshl_add_u32 v29, v29, 6, s30
    v_mul_u32_u24 v28, v28, v29
    v_and_b32 v28, 2047, v28
    v_cvt_f32_u32 v28, v28
    v_mul_f32 v28, s80, v28
    v_cos_f32 v29, v28
    v_sin_f32 v30, v28
    v_mul_f32 v17, s81, v17
    v_mul_f32 v18, s81, v18
    v_mul_f32 v21, s81, v21
    v_mul_f32 v22, s81, v22
    v_mul_f32 v25, s81, v25
    v_mul_f32 v26, s81, v26
    v_mul_f32 v29, s81, v29
    v_mul_f32 v30, s81, v30
    v_cvt_pk_f16_f32 v84, v17, v18
    v_cvt_pk_f16_f32 v92, -v18, v17
    v_cvt_pk_f16_f32 v85, v21, v22
    v_cvt_pk_f16_f32 v93, -v22, v21
    v_cvt_pk_f16_f32 v86, v25, v26
    v_cvt_pk_f16_f32 v94, -v26, v25
    v_cvt_pk_f16_f32 v87, v29, v30
    v_cvt_pk_f16_f32 v95, -v30, v29
k1_kernel_ln:
    s_add_u32 s51, s36, 4096
    s_add_u32 s52, s36, 8192
    s_add_u32 s53, s36, 12288
    s_add_u32 s54, s36, 16384
    s_add_u32 s55, s36, 20480
    s_mov_b32 s50, s36
    v_mov_b32 v9, 0xffff0000
    s_waitcnt vmcnt(0)
    v_lshlrev_b32 v16, 16, v96
    v_and_b32 v17, v9, v96
    v_lshlrev_b32 v18, 16, v97
    v_and_b32 v19, v9, v97
    v_lshlrev_b32 v20, 16, v98
    v_and_b32 v21, v9, v98
    v_lshlrev_b32 v22, 16, v99
    v_and_b32 v23, v9, v99
    v_lshlrev_b32 v24, 16, v100
    v_and_b32 v25, v9, v100
    v_lshlrev_b32 v26, 16, v101
    v_and_b32 v27, v9, v101
    v_lshlrev_b32 v28, 16, v102
    v_and_b32 v29, v9, v102
    v_lshlrev_b32 v30, 16, v103
    v_and_b32 v31, v9, v103
    v_lshlrev_b32 v32, 16, v104
    v_and_b32 v33, v9, v104
    v_lshlrev_b32 v34, 16, v105
    v_and_b32 v35, v9, v105
    v_lshlrev_b32 v36, 16, v106
    v_and_b32 v37, v9, v106
    v_lshlrev_b32 v38, 16, v107
    v_and_b32 v39, v9, v107
    v_lshlrev_b32 v40, 16, v108
    v_and_b32 v41, v9, v108
    v_lshlrev_b32 v42, 16, v109
    v_and_b32 v43, v9, v109
    v_lshlrev_b32 v44, 16, v110
    v_and_b32 v45, v9, v110
    v_lshlrev_b32 v46, 16, v111
    v_and_b32 v47, v9, v111
    v_lshlrev_b32 v48, 16, v112
    v_and_b32 v49, v9, v112
    v_lshlrev_b32 v50, 16, v113
    v_and_b32 v51, v9, v113
    v_lshlrev_b32 v52, 16, v114
    v_and_b32 v53, v9, v114
    v_lshlrev_b32 v54, 16, v115
    v_and_b32 v55, v9, v115
    v_add_f32 v56, v16, v20
    v_add_f32 v57, v17, v21
    v_add_f32 v58, v18, v22
    v_add_f32 v59, v19, v23
    v_add_f32 v56, v56, v24
    v_add_f32 v57, v57, v25
    v_add_f32 v58, v58, v26
    v_add_f32 v59, v59, v27
    v_add_f32 v56, v56, v28
    v_add_f32 v57, v57, v29
    v_add_f32 v58, v58, v30
    v_add_f32 v59, v59, v31
    v_add_f32 v56, v56, v32
    v_add_f32 v57, v57, v33
    v_add_f32 v58, v58, v34
    v_add_f32 v59, v59, v35
    v_add_f32 v56, v56, v36
    v_add_f32 v57, v57, v37
    v_add_f32 v58, v58, v38
    v_add_f32 v59, v59, v39
    v_add_f32 v56, v56, v40
    v_add_f32 v57, v57, v41
    v_add_f32 v58, v58, v42
    v_add_f32 v59, v59, v43
    v_add_f32 v56, v56, v44
    v_add_f32 v57, v57, v45
    v_add_f32 v58, v58, v46
    v_add_f32 v59, v59, v47
    v_add_f32 v56, v56, v48
    v_add_f32 v57, v57, v49
    v_add_f32 v58, v58, v50
    v_add_f32 v59, v59, v51
    v_add_f32 v56, v56, v52
    v_add_f32 v57, v57, v53
    v_add_f32 v58, v58, v54
    v_add_f32 v59, v59, v55
    v_add_f32 v56, v56, v57
    v_add_f32 v58, v58, v59
    v_add_f32 v56, v56, v58
    s_nop 1
    v_add_f32_dpp v56, v56, v56 row_ror:8 row_mask:0xf bank_mask:0xf
    s_nop 1
    v_add_f32_dpp v56, v56, v56 row_ror:4 row_mask:0xf bank_mask:0xf
    s_nop 1
    v_add_f32_dpp v56, v56, v56 row_ror:2 row_mask:0xf bank_mask:0xf
    s_nop 1
    v_add_f32_dpp v56, v56, v56 row_ror:1 row_mask:0xf bank_mask:0xf
    s_mov_b32 s82, 0x3acccccd
    s_mov_b32 s83, 0x3727c5ac
    v_mul_f32 v56, s82, v56
    v_cvt_pk_bf16_f32 v60, v56, v56
    v_and_b32 v60, v9, v60
    v_sub_f32 v61, v56, v60
    v_sub_f32 v16, v16, v60
    v_sub_f32 v17, v17, v60
    v_sub_f32 v18, v18, v60
    v_sub_f32 v19, v19, v60
    v_sub_f32 v20, v20, v60
    v_sub_f32 v21, v21, v60
    v_sub_f32 v22, v22, v60
    v_sub_f32 v23, v23, v60
    v_sub_f32 v24, v24, v60
    v_sub_f32 v25, v25, v60
    v_sub_f32 v26, v26, v60
    v_sub_f32 v27, v27, v60
    v_sub_f32 v28, v28, v60
    v_sub_f32 v29, v29, v60
    v_sub_f32 v30, v30, v60
    v_sub_f32 v31, v31, v60
    v_sub_f32 v32, v32, v60
    v_sub_f32 v33, v33, v60
    v_sub_f32 v34, v34, v60
    v_sub_f32 v35, v35, v60
    v_sub_f32 v36, v36, v60
    v_sub_f32 v37, v37, v60
    v_sub_f32 v38, v38, v60
    v_sub_f32 v39, v39, v60
    v_sub_f32 v40, v40, v60
    v_sub_f32 v41, v41, v60
    v_sub_f32 v42, v42, v60
    v_sub_f32 v43, v43, v60
    v_sub_f32 v44, v44, v60
    v_sub_f32 v45, v45, v60
    v_sub_f32 v46, v46, v60
    v_sub_f32 v47, v47, v60
    v_sub_f32 v48, v48, v60
    v_sub_f32 v49, v49, v60
    v_sub_f32 v50, v50, v60
    v_sub_f32 v51, v51, v60
    v_sub_f32 v52, v52, v60
    v_sub_f32 v53, v53, v60
    v_sub_f32 v54, v54, v60
    v_sub_f32 v55, v55, v60
    v_mul_f32 v56, v16, v16
    v_mul_f32 v57, v17, v17
    v_mul_f32 v58, v18, v18
    v_mul_f32 v59, v19, v19
    v_fmac_f32 v56, v20, v20
    v_fmac_f32 v57, v21, v21
    v_fmac_f32 v58, v22, v22
    v_fmac_f32 v59, v23, v23
    v_fmac_f32 v56, v24, v24
    v_fmac_f32 v57, v25, v25
    v_fmac_f32 v58, v26, v26
    v_fmac_f32 v59, v27, v27
    v_fmac_f32 v56, v28, v28
    v_fmac_f32 v57, v29, v29
    v_fmac_f32 v58, v30, v30
    v_fmac_f32 v59, v31, v31
    v_fmac_f32 v56, v32, v32
    v_fmac_f32 v57, v33, v33
    v_fmac_f32 v58, v34, v34
    v_fmac_f32 v59, v35, v35
    v_fmac_f32 v56, v36, v36
    v_fmac_f32 v57, v37, v37
    v_fmac_f32 v58, v38, v38
    v_fmac_f32 v59, v39, v39
    v_fmac_f32 v56, v40, v40
    v_fmac_f32 v57, v41, v41
    v_fmac_f32 v58, v42, v42
    v_fmac_f32 v59, v43, v43
    v_fmac_f32 v56, v44, v44
    v_fmac_f32 v57, v45, v45
    v_fmac_f32 v58, v46, v46
    v_fmac_f32 v59, v47, v47
    v_fmac_f32 v56, v48, v48
    v_fmac_f32 v57, v49, v49
    v_fmac_f32 v58, v50, v50
    buffer_load_dwordx4 v[128:131], v3, s[20:23], s50 offen offset:0
    v_fmac_f32 v59, v51, v51
    v_fmac_f32 v56, v52, v52
    v_fmac_f32 v57, v53, v53
    v_fmac_f32 v58, v54, v54
    v_fmac_f32 v59, v55, v55
    v_add_f32 v56, v56, v57
    v_add_f32 v58, v58, v59
    v_add_f32 v56, v56, v58
    buffer_load_dwordx4 v[132:135], v3, s[20:23], s50 offen offset:1024
    s_nop 1
    v_add_f32_dpp v56, v56, v56 row_ror:8 row_mask:0xf bank_mask:0xf
    s_nop 1
    v_add_f32_dpp v56, v56, v56 row_ror:4 row_mask:0xf bank_mask:0xf
    s_nop 1
    v_add_f32_dpp v56, v56, v56 row_ror:2 row_mask:0xf bank_mask:0xf
    s_nop 1
    v_add_f32_dpp v56, v56, v56 row_ror:1 row_mask:0xf bank_mask:0xf
    buffer_load_dwordx4 v[136:139], v3, s[20:23], s50 offen offset:2048
    v_mul_f32 v56, s82, v56
    v_fma_f32 v56, -v61, v61, v56
    v_max_f32 v56, 0, v56
    v_cvt_pk_bf16_f32 v56, v56, v56
    v_and_b32 v56, v9, v56
    v_add_f32 v56, s83, v56
    v_cvt_pk_bf16_f32 v56, v56, v56
    v_and_b32 v56, v9, v56
    buffer_load_dwordx4 v[140:143], v3, s[20:23], s50 offen offset:3072
    v_sqrt_f32 v56, v56
    v_cvt_pk_bf16_f32 v16, v16, v17
    v_cvt_pk_bf16_f32 v18, v18, v19
    v_cvt_pk_bf16_f32 v20, v20, v21
    v_cvt_pk_bf16_f32 v22, v22, v23
    v_cvt_pk_bf16_f32 v24, v24, v25
    v_cvt_pk_bf16_f32 v26, v26, v27
    v_cvt_pk_bf16_f32 v28, v28, v29
    buffer_load_dwordx4 v[144:147], v3, s[20:23], s51 offen offset:0
    v_cvt_pk_bf16_f32 v30, v30, v31
    v_cvt_pk_bf16_f32 v32, v32, v33
    v_cvt_pk_bf16_f32 v34, v34, v35
    v_cvt_pk_bf16_f32 v36, v36, v37
    v_cvt_pk_bf16_f32 v38, v38, v39
    v_cvt_pk_bf16_f32 v40, v40, v41
    v_cvt_pk_bf16_f32 v42, v42, v43
    v_cvt_pk_bf16_f32 v44, v44, v45
    buffer_load_dwordx4 v[148:151], v3, s[20:23], s51 offen offset:1024
    v_cvt_pk_bf16_f32 v46, v46, v47
    v_cvt_pk_bf16_f32 v48, v48, v49
    v_cvt_pk_bf16_f32 v50, v50, v51
    v_cvt_pk_bf16_f32 v52, v52, v53
    v_cvt_pk_bf16_f32 v54, v54, v55
    v_cvt_pk_bf16_f32 v56, v56, v56
    v_and_b32 v56, v9, v56
    v_rcp_f32 v56, v56
    buffer_load_dwordx4 v[152:155], v3, s[20:23], s51 offen offset:2048
    v_and_b32 v17, v9, v16
    v_lshlrev_b32 v16, 16, v16
    v_and_b32 v19, v9, v18
    v_lshlrev_b32 v18, 16, v18
    v_and_b32 v21, v9, v20
    v_lshlrev_b32 v20, 16, v20
    v_and_b32 v23, v9, v22
    v_lshlrev_b32 v22, 16, v22
    buffer_load_dwordx4 v[156:159], v3, s[20:23], s51 offen offset:3072
    v_and_b32 v25, v9, v24
    v_lshlrev_b32 v24, 16, v24
    v_and_b32 v27, v9, v26
    v_lshlrev_b32 v26, 16, v26
    v_and_b32 v29, v9, v28
    v_lshlrev_b32 v28, 16, v28
    v_and_b32 v31, v9, v30
    v_lshlrev_b32 v30, 16, v30
    buffer_load_dwordx4 v[160:163], v3, s[20:23], s52 offen offset:0
    v_and_b32 v33, v9, v32
    v_lshlrev_b32 v32, 16, v32
    v_and_b32 v35, v9, v34
    v_lshlrev_b32 v34, 16, v34
    v_and_b32 v37, v9, v36
    v_lshlrev_b32 v36, 16, v36
    v_and_b32 v39, v9, v38
    v_lshlrev_b32 v38, 16, v38
    buffer_load_dwordx4 v[164:167], v3, s[20:23], s52 offen offset:1024
    v_and_b32 v41, v9, v40
    v_lshlrev_b32 v40, 16, v40
    v_and_b32 v43, v9, v42
    v_lshlrev_b32 v42, 16, v42
    v_and_b32 v45, v9, v44
    v_lshlrev_b32 v44, 16, v44
    v_and_b32 v47, v9, v46
    v_lshlrev_b32 v46, 16, v46
    buffer_load_dwordx4 v[168:171], v3, s[20:23], s52 offen offset:2048
    v_and_b32 v49, v9, v48
    v_lshlrev_b32 v48, 16, v48
    v_and_b32 v51, v9, v50
    v_lshlrev_b32 v50, 16, v50
    v_and_b32 v53, v9, v52
    v_lshlrev_b32 v52, 16, v52
    v_and_b32 v55, v9, v54
    v_lshlrev_b32 v54, 16, v54
    buffer_load_dwordx4 v[172:175], v3, s[20:23], s52 offen offset:3072
    v_mul_f32 v16, v16, v56
    v_mul_f32 v17, v17, v56
    v_mul_f32 v18, v18, v56
    v_mul_f32 v19, v19, v56
    v_mul_f32 v20, v20, v56
    v_mul_f32 v21, v21, v56
    v_mul_f32 v22, v22, v56
    v_mul_f32 v23, v23, v56
    buffer_load_dwordx4 v[176:179], v3, s[20:23], s53 offen offset:0
    v_mul_f32 v24, v24, v56
    v_mul_f32 v25, v25, v56
    v_mul_f32 v26, v26, v56
    v_mul_f32 v27, v27, v56
    v_mul_f32 v28, v28, v56
    v_mul_f32 v29, v29, v56
    v_mul_f32 v30, v30, v56
    v_mul_f32 v31, v31, v56
    buffer_load_dwordx4 v[180:183], v3, s[20:23], s53 offen offset:1024
    v_mul_f32 v32, v32, v56
    v_mul_f32 v33, v33, v56
    v_mul_f32 v34, v34, v56
    v_mul_f32 v35, v35, v56
    v_mul_f32 v36, v36, v56
    v_mul_f32 v37, v37, v56
    v_mul_f32 v38, v38, v56
    v_mul_f32 v39, v39, v56
    buffer_load_dwordx4 v[184:187], v3, s[20:23], s53 offen offset:2048
    v_mul_f32 v40, v40, v56
    v_mul_f32 v41, v41, v56
    v_mul_f32 v42, v42, v56
    v_mul_f32 v43, v43, v56
    v_mul_f32 v44, v44, v56
    v_mul_f32 v45, v45, v56
    v_mul_f32 v46, v46, v56
    v_mul_f32 v47, v47, v56
    buffer_load_dwordx4 v[188:191], v3, s[20:23], s53 offen offset:3072
    v_mul_f32 v48, v48, v56
    v_mul_f32 v49, v49, v56
    v_mul_f32 v50, v50, v56
    v_mul_f32 v51, v51, v56
    v_mul_f32 v52, v52, v56
    v_mul_f32 v53, v53, v56
    v_mul_f32 v54, v54, v56
    v_mul_f32 v55, v55, v56
    buffer_load_dwordx4 v[192:195], v3, s[20:23], s54 offen offset:0
    v_cvt_pk_bf16_f32 v16, v16, v17
    v_cvt_pk_bf16_f32 v18, v18, v19
    v_cvt_pk_bf16_f32 v20, v20, v21
    v_cvt_pk_bf16_f32 v22, v22, v23
    v_cvt_pk_bf16_f32 v24, v24, v25
    v_cvt_pk_bf16_f32 v26, v26, v27
    v_cvt_pk_bf16_f32 v28, v28, v29
    v_cvt_pk_bf16_f32 v30, v30, v31
    buffer_load_dwordx4 v[196:199], v3, s[20:23], s54 offen offset:1024
    v_cvt_pk_bf16_f32 v32, v32, v33
    v_cvt_pk_bf16_f32 v34, v34, v35
    v_cvt_pk_bf16_f32 v36, v36, v37
    v_cvt_pk_bf16_f32 v38, v38, v39
    v_cvt_pk_bf16_f32 v40, v40, v41
    v_cvt_pk_bf16_f32 v42, v42, v43
    v_cvt_pk_bf16_f32 v44, v44, v45
    v_cvt_pk_bf16_f32 v46, v46, v47
    buffer_load_dwordx4 v[200:203], v3, s[20:23], s54 offen offset:2048
    v_cvt_pk_bf16_f32 v48, v48, v49
    v_cvt_pk_bf16_f32 v50, v50, v51
    v_cvt_pk_bf16_f32 v52, v52, v53
    v_cvt_pk_bf16_f32 v54, v54, v55
    v_and_b32 v17, v9, v16
    v_lshlrev_b32 v16, 16, v16
    v_and_b32 v19, v9, v18
    v_lshlrev_b32 v18, 16, v18
    buffer_load_dwordx4 v[204:207], v3, s[20:23], s54 offen offset:3072
    v_and_b32 v21, v9, v20
    v_lshlrev_b32 v20, 16, v20
    v_and_b32 v23, v9, v22
    v_lshlrev_b32 v22, 16, v22
    v_and_b32 v25, v9, v24
    v_lshlrev_b32 v24, 16, v24
    v_and_b32 v27, v9, v26
    v_lshlrev_b32 v26, 16, v26
    buffer_load_dwordx4 v[208:211], v3, s[20:23], s55 offen offset:0
    v_and_b32 v29, v9, v28
    v_lshlrev_b32 v28, 16, v28
    v_and_b32 v31, v9, v30
    v_lshlrev_b32 v30, 16, v30
    v_and_b32 v33, v9, v32
    v_lshlrev_b32 v32, 16, v32
    v_and_b32 v35, v9, v34
    v_lshlrev_b32 v34, 16, v34
    v_and_b32 v37, v9, v36
    v_lshlrev_b32 v36, 16, v36
    v_and_b32 v39, v9, v38
    v_lshlrev_b32 v38, 16, v38
    v_and_b32 v41, v9, v40
    v_lshlrev_b32 v40, 16, v40
    v_and_b32 v43, v9, v42
    v_lshlrev_b32 v42, 16, v42
    v_and_b32 v45, v9, v44
    v_lshlrev_b32 v44, 16, v44
    v_and_b32 v47, v9, v46
    v_lshlrev_b32 v46, 16, v46
    v_and_b32 v49, v9, v48
    v_lshlrev_b32 v48, 16, v48
    v_and_b32 v51, v9, v50
    v_lshlrev_b32 v50, 16, v50
    v_and_b32 v53, v9, v52
    v_lshlrev_b32 v52, 16, v52
    v_and_b32 v55, v9, v54
    v_lshlrev_b32 v54, 16, v54
    v_mov_b32_dpp v96, v36 row_ror:1 row_mask:0xf bank_mask:0xf
    v_mov_b32_dpp v97, v40 row_ror:1 row_mask:0xf bank_mask:0xf
    v_mov_b32_dpp v98, v44 row_ror:1 row_mask:0xf bank_mask:0xf
    v_mov_b32_dpp v99, v48 row_ror:1 row_mask:0xf bank_mask:0xf
    v_mov_b32_dpp v100, v52 row_ror:1 row_mask:0xf bank_mask:0xf
    s_lshl_b32 s36, s33, 2
    v_add_u32 v10, s36, v5
    v_mul_u32_u24 v10, 1552, v10
    v_lshl_add_u32 v10, v4, 2, v10
    v_mov_b32 v102, 0
    v_mov_b32 v103, v16
    s_mov_b32 s42, 0x00010001
    s_mov_b32 s43, 0x00010001
    s_mov_b64 exec, s[42:43]
    v_mov_b32 v102, v100
    v_mov_b32 v100, v99
    v_mov_b32 v99, v98
    v_mov_b32 v98, v97
    v_mov_b32 v97, v96
    v_mov_b32 v96, 0
    v_mov_b32 v103, 0
    s_mov_b64 exec, -1
    v_cvt_pk_f16_f32 v102, v102, 0
    ds_write_b32 v10, v102 offset:320
    v_add_f32 v104, v16, v96
    v_sub_f32 v108, v103, v96
    v_add_f32 v105, v17, v39
    v_sub_f32 v109, v17, v39
    v_add_f32 v106, v18, v38
    v_sub_f32 v110, v18, v38
    v_add_f32 v107, v19, v37
    v_sub_f32 v111, v19, v37
    v_cvt_pk_f16_f32 v112, v104, v106
    v_cvt_pk_f16_f32 v113, v105, v107
    v_cvt_pk_f16_f32 v114, v108, v110
    v_cvt_pk_f16_f32 v115, v109, v111
    ds_write_b32 v10, v112 offset:0
    ds_write_b32 v10, v113 offset:384
    ds_write_b32 v10, v114 offset:768
    ds_write_b32 v10, v115 offset:1152
    v_add_f32 v116, v20, v97
    v_sub_f32 v120, v20, v97
    v_add_f32 v117, v21, v43
    v_sub_f32 v121, v21, v43
    v_add_f32 v118, v22, v42
    v_sub_f32 v122, v22, v42
    v_add_f32 v119, v23, v41
    v_sub_f32 v123, v23, v41
    v_cvt_pk_f16_f32 v124, v116, v118
    v_cvt_pk_f16_f32 v125, v117, v119
    v_cvt_pk_f16_f32 v126, v120, v122
    v_cvt_pk_f16_f32 v127, v121, v123
    ds_write_b32 v10, v124 offset:64
    ds_write_b32 v10, v125 offset:448
    ds_write_b32 v10, v126 offset:832
    ds_write_b32 v10, v127 offset:1216
    v_add_f32 v104, v24, v98
    v_sub_f32 v108, v24, v98
    v_add_f32 v105, v25, v47
    v_sub_f32 v109, v25, v47
    v_add_f32 v106, v26, v46
    v_sub_f32 v110, v26, v46
    v_add_f32 v107, v27, v45
    v_sub_f32 v111, v27, v45
    v_cvt_pk_f16_f32 v112, v104, v106
    v_cvt_pk_f16_f32 v113, v105, v107
    v_cvt_pk_f16_f32 v114, v108, v110
    v_cvt_pk_f16_f32 v115, v109, v111
    ds_write_b32 v10, v112 offset:128
    ds_write_b32 v10, v113 offset:512
    ds_write_b32 v10, v114 offset:896
    ds_write_b32 v10, v115 offset:1280
    v_add_f32 v116, v28, v99
    v_sub_f32 v120, v28, v99
    v_add_f32 v117, v29, v51
    v_sub_f32 v121, v29, v51
    v_add_f32 v118, v30, v50
    v_sub_f32 v122, v30, v50
    v_add_f32 v119, v31, v49
    v_sub_f32 v123, v31, v49
    v_cvt_pk_f16_f32 v124, v116, v118
    v_cvt_pk_f16_f32 v125, v117, v119
    v_cvt_pk_f16_f32 v126, v120, v122
    v_cvt_pk_f16_f32 v127, v121, v123
    ds_write_b32 v10, v124 offset:192
    ds_write_b32 v10, v125 offset:576
    ds_write_b32 v10, v126 offset:960
    ds_write_b32 v10, v127 offset:1344
    v_add_f32 v104, v32, v100
    v_sub_f32 v108, v32, v100
    v_add_f32 v105, v33, v55
    v_sub_f32 v109, v33, v55
    v_add_f32 v106, v34, v54
    v_sub_f32 v110, v34, v54
    v_add_f32 v107, v35, v53
    v_sub_f32 v111, v35, v53
    v_cvt_pk_f16_f32 v112, v104, v106
    v_cvt_pk_f16_f32 v113, v105, v107
    v_cvt_pk_f16_f32 v114, v108, v110
    v_cvt_pk_f16_f32 v115, v109, v111
    ds_write_b32 v10, v112 offset:256
    ds_write_b32 v10, v113 offset:640
    ds_write_b32 v10, v114 offset:1024
    ds_write_b32 v10, v115 offset:1408
    s_waitcnt lgkmcnt(0)
    s_barrier
    s_cmp_eq_u32 s35, 0
    s_cbranch_scc1 k1_kernel_END
    v_mul_u32_u24 v10, 1552, v4
    v_lshl_add_u32 v10, v5, 4, v10
    ds_read_b128 v[96:99], v10 offset:0
    ds_read_b128 v[100:103], v10 offset:24832
    ds_read_b128 v[104:107], v10 offset:64
    ds_read_b128 v[108:111], v10 offset:24896
    ds_read_b128 v[112:115], v10 offset:128
    ds_read_b128 v[116:119], v10 offset:24960
    ds_read_b128 v[120:123], v10 offset:192
    ds_read_b128 v[124:127], v10 offset:25024
    s_waitcnt vmcnt(0)
    s_waitcnt lgkmcnt(7)
    v_mfma_f32_16x16x32_f16 v[16:19], v[96:99], v[128:131], 0
    ds_read_b128 v[96:99], v10 offset:256
    s_waitcnt lgkmcnt(7)
    v_mfma_f32_16x16x32_f16 v[20:23], v[100:103], v[128:131], 0
    ds_read_b128 v[100:103], v10 offset:25088
    s_waitcnt lgkmcnt(7)
    v_mfma_f32_16x16x32_f16 v[16:19], v[104:107], v[132:135], v[16:19]
    ds_read_b128 v[104:107], v10 offset:320
    s_waitcnt lgkmcnt(7)
    v_mfma_f32_16x16x32_f16 v[20:23], v[108:111], v[132:135], v[20:23]
    ds_read_b128 v[108:111], v10 offset:25152
    s_waitcnt lgkmcnt(7)
    v_mfma_f32_16x16x32_f16 v[16:19], v[112:115], v[136:139], v[16:19]
    ds_read_b128 v[112:115], v10 offset:384
    s_waitcnt lgkmcnt(7)
    v_mfma_f32_16x16x32_f16 v[20:23], v[116:119], v[136:139], v[20:23]
    ds_read_b128 v[116:119], v10 offset:25216
    s_waitcnt lgkmcnt(7)
    v_mfma_f32_16x16x32_f16 v[16:19], v[120:123], v[140:143], v[16:19]
    ds_read_b128 v[120:123], v10 offset:448
    s_waitcnt lgkmcnt(7)
    v_mfma_f32_16x16x32_f16 v[20:23], v[124:127], v[140:143], v[20:23]
    ds_read_b128 v[124:127], v10 offset:25280
    s_waitcnt lgkmcnt(7)
    v_mfma_f32_16x16x32_f16 v[16:19], v[96:99], v[144:147], v[16:19]
    ds_read_b128 v[96:99], v10 offset:512
    s_waitcnt lgkmcnt(7)
    v_mfma_f32_16x16x32_f16 v[20:23], v[100:103], v[144:147], v[20:23]
    ds_read_b128 v[100:103], v10 offset:25344
    s_waitcnt lgkmcnt(7)
    v_mfma_f32_16x16x32_f16 v[16:19], v[104:107], v[148:151], v[16:19]
    ds_read_b128 v[104:107], v10 offset:576
    s_waitcnt lgkmcnt(7)
    v_mfma_f32_16x16x32_f16 v[20:23], v[108:111], v[148:151], v[20:23]
    ds_read_b128 v[108:111], v10 offset:25408
    s_waitcnt lgkmcnt(7)
    v_mfma_f32_16x16x32_f16 v[24:27], v[112:115], v[152:155], 0
    ds_read_b128 v[112:115], v10 offset:640
    s_waitcnt lgkmcnt(7)
    v_mfma_f32_16x16x32_f16 v[28:31], v[116:119], v[152:155], 0
    ds_read_b128 v[116:119], v10 offset:25472
    s_waitcnt lgkmcnt(7)
    v_mfma_f32_16x16x32_f16 v[24:27], v[120:123], v[156:159], v[24:27]
    ds_read_b128 v[120:123], v10 offset:768
    s_waitcnt lgkmcnt(7)
    v_mfma_f32_16x16x32_f16 v[28:31], v[124:127], v[156:159], v[28:31]
    ds_read_b128 v[124:127], v10 offset:25600
    s_waitcnt lgkmcnt(7)
    v_mfma_f32_16x16x32_f16 v[24:27], v[96:99], v[160:163], v[24:27]
    ds_read_b128 v[96:99], v10 offset:832
    s_waitcnt lgkmcnt(7)
    v_mfma_f32_16x16x32_f16 v[28:31], v[100:103], v[160:163], v[28:31]
    ds_read_b128 v[100:103], v10 offset:25664
    s_waitcnt lgkmcnt(7)
    v_mfma_f32_16x16x32_f16 v[24:27], v[104:107], v[164:167], v[24:27]
    ds_read_b128 v[104:107], v10 offset:896
    s_waitcnt lgkmcnt(7)
    v_mfma_f32_16x16x32_f16 v[28:31], v[108:111], v[164:167], v[28:31]
    ds_read_b128 v[108:111], v10 offset:25728
    s_waitcnt lgkmcnt(7)
    v_mfma_f32_16x16x32_f16 v[24:27], v[112:115], v[168:171], v[24:27]
    ds_read_b128 v[112:115], v10 offset:960
    s_waitcnt lgkmcnt(7)
    v_mfma_f32_16x16x32_f16 v[28:31], v[116:119], v[168:171], v[28:31]
    ds_read_b128 v[116:119], v10 offset:25792
    s_waitcnt lgkmcnt(7)
    v_mfma_f32_16x16x32_f16 v[32:35], v[120:123], v[172:175], 0
    ds_read_b128 v[120:123], v10 offset:1024
    s_waitcnt lgkmcnt(7)
    v_mfma_f32_16x16x32_f16 v[36:39], v[124:127], v[172:175], 0
    ds_read_b128 v[124:127], v10 offset:25856
    s_waitcnt lgkmcnt(7)
    v_mfma_f32_16x16x32_f16 v[32:35], v[96:99], v[176:179], v[32:35]
    ds_read_b128 v[96:99], v10 offset:1152
    s_waitcnt lgkmcnt(7)
    v_mfma_f32_16x16x32_f16 v[36:39], v[100:103], v[176:179], v[36:39]
    ds_read_b128 v[100:103], v10 offset:25984
    s_waitcnt lgkmcnt(7)
    v_mfma_f32_16x16x32_f16 v[32:35], v[104:107], v[180:183], v[32:35]
    ds_read_b128 v[104:107], v10 offset:1216
    s_waitcnt lgkmcnt(7)
    v_mfma_f32_16x16x32_f16 v[36:39], v[108:111], v[180:183], v[36:39]
    ds_read_b128 v[108:111], v10 offset:26048
    s_waitcnt lgkmcnt(7)
    v_mfma_f32_16x16x32_f16 v[32:35], v[112:115], v[184:187], v[32:35]
    ds_read_b128 v[112:115], v10 offset:1280
    s_waitcnt lgkmcnt(7)
    v_mfma_f32_16x16x32_f16 v[36:39], v[116:119], v[184:187], v[36:39]
    ds_read_b128 v[116:119], v10 offset:26112
    s_waitcnt lgkmcnt(7)
    v_mfma_f32_16x16x32_f16 v[32:35], v[120:123], v[188:191], v[32:35]
    ds_read_b128 v[120:123], v10 offset:1344
    s_waitcnt lgkmcnt(7)
    v_mfma_f32_16x16x32_f16 v[36:39], v[124:127], v[188:191], v[36:39]
    ds_read_b128 v[124:127], v10 offset:26176
    s_waitcnt lgkmcnt(7)
    v_mfma_f32_16x16x32_f16 v[40:43], v[96:99], v[192:195], 0
    ds_read_b128 v[96:99], v10 offset:1408
    s_waitcnt lgkmcnt(7)
    v_mfma_f32_16x16x32_f16 v[44:47], v[100:103], v[192:195], 0
    ds_read_b128 v[100:103], v10 offset:26240
    s_waitcnt lgkmcnt(7)
    v_mfma_f32_16x16x32_f16 v[40:43], v[104:107], v[196:199], v[40:43]
    s_waitcnt lgkmcnt(6)
    v_mfma_f32_16x16x32_f16 v[44:47], v[108:111], v[196:199], v[44:47]
    s_waitcnt lgkmcnt(5)
    v_mfma_f32_16x16x32_f16 v[40:43], v[112:115], v[200:203], v[40:43]
    s_waitcnt lgkmcnt(4)
    v_mfma_f32_16x16x32_f16 v[44:47], v[116:119], v[200:203], v[44:47]
    s_waitcnt lgkmcnt(3)
    v_mfma_f32_16x16x32_f16 v[40:43], v[120:123], v[204:207], v[40:43]
    s_waitcnt lgkmcnt(2)
    v_mfma_f32_16x16x32_f16 v[44:47], v[124:127], v[204:207], v[44:47]
    s_waitcnt lgkmcnt(1)
    v_mfma_f32_16x16x32_f16 v[40:43], v[96:99], v[208:211], v[40:43]
    s_waitcnt lgkmcnt(0)
    v_mfma_f32_16x16x32_f16 v[44:47], v[100:103], v[208:211], v[44:47]
    s_lshl_b32 s36, s34, 4
    v_add_u32 v11, s36, v4
    v_lshl_add_u32 v12, v5, 8, s30
    v_mul_u32_u24 v12, 1408, v12
    v_lshl_add_u32 v13, v11, 2, v12
    v_sub_u32 v14, 320, v11
    v_lshl_add_u32 v14, v14, 2, v12
    v_cmp_lt_u32 vcc, 160, v11
    v_mov_b32 v15, 0x80000000
    s_nop 0
    v_cndmask_b32 v13, v13, v15, vcc
    v_cndmask_b32 v14, v14, v15, vcc
    v_add_f32 v96, v16, v24
    v_sub_f32 v97, v16, v24
    v_add_f32 v98, v32, v40
    v_sub_f32 v99, v32, v40
    v_add_f32 v100, v17, v25
    v_sub_f32 v101, v17, v25
    v_add_f32 v102, v33, v41
    v_sub_f32 v103, v33, v41
    v_add_f32 v104, v18, v26
    v_sub_f32 v105, v18, v26
    v_add_f32 v106, v34, v42
    v_sub_f32 v107, v34, v42
    v_add_f32 v108, v19, v27
    v_sub_f32 v109, v19, v27
    v_add_f32 v110, v35, v43
    v_sub_f32 v111, v35, v43
    v_cvt_pk_f16_f32 v48, v96, -v98
    v_cvt_pk_f16_f32 v56, v97, v99
    v_cvt_pk_f16_f32 v49, v100, -v102
    v_cvt_pk_f16_f32 v57, v101, v103
    v_cvt_pk_f16_f32 v50, v104, -v106
    v_cvt_pk_f16_f32 v58, v105, v107
    v_cvt_pk_f16_f32 v51, v108, -v110
    v_cvt_pk_f16_f32 v59, v109, v111
    v_add_f32 v96, v20, v28
    v_sub_f32 v97, v20, v28
    v_add_f32 v98, v36, v44
    v_sub_f32 v99, v36, v44
    v_add_f32 v100, v21, v29
    v_sub_f32 v101, v21, v29
    v_add_f32 v102, v37, v45
    v_sub_f32 v103, v37, v45
    v_add_f32 v104, v22, v30
    v_sub_f32 v105, v22, v30
    v_add_f32 v106, v38, v46
    v_sub_f32 v107, v38, v46
    v_add_f32 v108, v23, v31
    v_sub_f32 v109, v23, v31
    v_add_f32 v110, v39, v47
    v_sub_f32 v111, v39, v47
    v_cvt_pk_f16_f32 v52, v96, -v98
    v_cvt_pk_f16_f32 v60, v97, v99
    v_cvt_pk_f16_f32 v53, v100, -v102
    v_cvt_pk_f16_f32 v61, v101, v103
    v_cvt_pk_f16_f32 v54, v104, -v106
    v_cvt_pk_f16_f32 v62, v105, v107
    v_cvt_pk_f16_f32 v55, v108, -v110
    v_cvt_pk_f16_f32 v63, v109, v111
    s_nop 1
    v_mfma_f32_16x16x32_f16 v[128:131], v[64:67], v[48:51], 0
    v_mfma_f32_16x16x32_f16 v[128:131], v[68:71], v[52:55], v[128:131]
    v_mfma_f32_16x16x32_f16 v[132:135], v[72:75], v[48:51], 0
    v_mfma_f32_16x16x32_f16 v[132:135], v[76:79], v[52:55], v[132:135]
    v_mfma_f32_16x16x32_f16 v[136:139], v[80:83], v[48:51], 0
    v_mfma_f32_16x16x32_f16 v[136:139], v[84:87], v[52:55], v[136:139]
    v_mfma_f32_16x16x32_f16 v[140:143], v[88:91], v[48:51], 0
    v_mfma_f32_16x16x32_f16 v[140:143], v[92:95], v[52:55], v[140:143]
    v_mfma_f32_16x16x32_f16 v[144:147], v[64:67], v[56:59], 0
    v_mfma_f32_16x16x32_f16 v[144:147], v[68:71], v[60:63], v[144:147]
    v_mfma_f32_16x16x32_f16 v[148:151], v[72:75], v[56:59], 0
    v_mfma_f32_16x16x32_f16 v[148:151], v[76:79], v[60:63], v[148:151]
    v_mfma_f32_16x16x32_f16 v[152:155], v[80:83], v[56:59], 0
    v_mfma_f32_16x16x32_f16 v[152:155], v[84:87], v[60:63], v[152:155]
    v_mfma_f32_16x16x32_f16 v[156:159], v[88:91], v[56:59], 0
    v_mfma_f32_16x16x32_f16 v[156:159], v[92:95], v[60:63], v[156:159]
    s_mov_b32 s44, 0
    s_mov_b32 s45, 90112
    s_mov_b32 s46, 180224
    s_mov_b32 s47, 270336
    s_mov_b32 s48, 1441792
    s_mov_b32 s49, 1531904
    s_mov_b32 s50, 1622016
    s_mov_b32 s51, 1712128
    v_cvt_pk_f16_f32 v128, v128, v132
    buffer_store_dword v128, v13, s[16:19], s44 offen
    v_cvt_pk_f16_f32 v129, v129, v133
    buffer_store_dword v129, v13, s[16:19], s45 offen
    v_cvt_pk_f16_f32 v130, v130, v134
    buffer_store_dword v130, v13, s[16:19], s46 offen
    v_cvt_pk_f16_f32 v131, v131, v135
    buffer_store_dword v131, v13, s[16:19], s47 offen
    v_cvt_pk_f16_f32 v136, v136, v140
    buffer_store_dword v136, v13, s[16:19], s48 offen
    v_cvt_pk_f16_f32 v137, v137, v141
    buffer_store_dword v137, v13, s[16:19], s49 offen
    v_cvt_pk_f16_f32 v138, v138, v142
    buffer_store_dword v138, v13, s[16:19], s50 offen
    v_cvt_pk_f16_f32 v139, v139, v143
    buffer_store_dword v139, v13, s[16:19], s51 offen
    s_nop 3
    v_cvt_pk_f16_f32 v144, v144, v148
    buffer_store_dword v144, v14, s[16:19], s44 offen
    v_cvt_pk_f16_f32 v145, v145, v149
    buffer_store_dword v145, v14, s[16:19], s45 offen
    v_cvt_pk_f16_f32 v146, v146, v150
    buffer_store_dword v146, v14, s[16:19], s46 offen
    v_cvt_pk_f16_f32 v147, v147, v151
    buffer_store_dword v147, v14, s[16:19], s47 offen
    v_cvt_pk_f16_f32 v152, v152, v156
    buffer_store_dword v152, v14, s[16:19], s48 offen
    v_cvt_pk_f16_f32 v153, v153, v157
    buffer_store_dword v153, v14, s[16:19], s49 offen
    v_cvt_pk_f16_f32 v154, v154, v158
    buffer_store_dword v154, v14, s[16:19], s50 offen
    v_cvt_pk_f16_f32 v155, v155, v159
    buffer_store_dword v155, v14, s[16:19], s51 offen
k1_kernel_END:
    s_endpgm
k1_kernel_RP:
    s_cmp_ge_u32 s2, 144
    s_cbranch_scc1 k1_kernel_RP2
    s_sub_u32 s3, s2, 128
k1_kernel_rpj:
    s_load_dwordx4 s[4:7], s[0:1], 8
    s_load_dwordx2 s[8:9], s[0:1], 72
    v_lshrrev_b32 v1, 6, v0
    v_and_b32 v2, 63, v0
    s_nop 0
    v_readfirstlane_b32 s33, v1
    s_lshl_b32 s37, s3, 3
    s_add_u32 s37, s37, s33
    s_and_b32 s38, s37, 63
    s_mul_i32 s38, s38, 20544
    s_cmp_lt_u32 s37, 64
    s_waitcnt lgkmcnt(0)
    s_cselect_b32 s12, s4, s6
    s_cselect_b32 s13, s5, s7
    s_add_u32 s14, s38, 20544
    s_mov_b32 s15, 0x00020000
    s_add_u32 s24, s8, 18874368
    s_addc_u32 s25, s9, 0
    s_mov_b32 s26, 4096
    s_mov_b32 s27, 0x00020000
    v_lshlrev_b32 v3, 4, v2
    buffer_load_dwordx4 v[16:19], v3, s[12:15], s38 offen offset:0
    buffer_load_dwordx4 v[20:23], v3, s[12:15], s38 offen offset:1024
    buffer_load_dwordx4 v[24:27], v3, s[12:15], s38 offen offset:2048
    buffer_load_dwordx4 v[28:31], v3, s[12:15], s38 offen offset:3072
    s_add_u32 s38, s38, 4096
    buffer_load_dwordx4 v[32:35], v3, s[12:15], s38 offen offset:0
    buffer_load_dwordx4 v[36:39], v3, s[12:15], s38 offen offset:1024
    buffer_load_dwordx4 v[40:43], v3, s[12:15], s38 offen offset:2048
    buffer_load_dwordx4 v[44:47], v3, s[12:15], s38 offen offset:3072
    s_add_u32 s38, s38, 4096
    buffer_load_dwordx4 v[48:51], v3, s[12:15], s38 offen offset:0
    buffer_load_dwordx4 v[52:55], v3, s[12:15], s38 offen offset:1024
    buffer_load_dwordx4 v[56:59], v3, s[12:15], s38 offen offset:2048
    buffer_load_dwordx4 v[60:63], v3, s[12:15], s38 offen offset:3072
    s_add_u32 s38, s38, 4096
    buffer_load_dwordx4 v[64:67], v3, s[12:15], s38 offen offset:0
    buffer_load_dwordx4 v[68:71], v3, s[12:15], s38 offen offset:1024
    buffer_load_dwordx4 v[72:75], v3, s[12:15], s38 offen offset:2048
    buffer_load_dwordx4 v[76:79], v3, s[12:15], s38 offen offset:3072
    s_add_u32 s38, s38, 4096
    buffer_load_dwordx4 v[80:83], v3, s[12:15], s38 offen offset:0
    buffer_load_dwordx4 v[84:87], v3, s[12:15], s38 offen offset:1024
    buffer_load_dwordx4 v[88:91], v3, s[12:15], s38 offen offset:2048
    buffer_load_dwordx4 v[92:95], v3, s[12:15], s38 offen offset:3072
    s_add_u32 s38, s38, 4096
    buffer_load_dwordx4 v[96:99], v3, s[12:15], s38 offen offset:0
    v_mov_b32 v11, 0x7fff7fff
    s_waitcnt vmcnt(0)
    v_and_b32 v16, v11, v16
    v_and_b32 v17, v11, v17
    v_and_b32 v18, v11, v18
    v_and_b32 v19, v11, v19
    v_and_b32 v20, v11, v20
    v_and_b32 v21, v11, v21
    v_and_b32 v22, v11, v22
    v_and_b32 v23, v11, v23
    v_and_b32 v24, v11, v24
    v_and_b32 v25, v11, v25
    v_and_b32 v26, v11, v26
    v_and_b32 v27, v11, v27
    v_and_b32 v28, v11, v28
    v_and_b32 v29, v11, v29
    v_and_b32 v30, v11, v30
    v_and_b32 v31, v11, v31
    v_and_b32 v32, v11, v32
    v_and_b32 v33, v11, v33
    v_and_b32 v34, v11, v34
    v_and_b32 v35, v11, v35
    v_and_b32 v36, v11, v36
    v_and_b32 v37, v11, v37
    v_and_b32 v38, v11, v38
    v_and_b32 v39, v11, v39
    v_and_b32 v40, v11, v40
    v_and_b32 v41, v11, v41
    v_and_b32 v42, v11, v42
    v_and_b32 v43, v11, v43
    v_and_b32 v44, v11, v44
    v_and_b32 v45, v11, v45
    v_and_b32 v46, v11, v46
    v_and_b32 v47, v11, v47
    v_and_b32 v48, v11, v48
    v_and_b32 v49, v11, v49
    v_and_b32 v50, v11, v50
    v_and_b32 v51, v11, v51
    v_and_b32 v52, v11, v52
    v_and_b32 v53, v11, v53
    v_and_b32 v54, v11, v54
    v_and_b32 v55, v11, v55
    v_and_b32 v56, v11, v56
    v_and_b32 v57, v11, v57
    v_and_b32 v58, v11, v58
    v_and_b32 v59, v11, v59
    v_and_b32 v60, v11, v60
    v_and_b32 v61, v11, v61
    v_and_b32 v62, v11, v62
    v_and_b32 v63, v11, v63
    v_and_b32 v64, v11, v64
    v_and_b32 v65, v11, v65
    v_and_b32 v66, v11, v66
    v_and_b32 v67, v11, v67
    v_and_b32 v68, v11, v68
    v_and_b32 v69, v11, v69
    v_and_b32 v70, v11, v70
    v_and_b32 v71, v11, v71
    v_and_b32 v72, v11, v72
    v_and_b32 v73, v11, v73
    v_and_b32 v74, v11, v74
    v_and_b32 v75, v11, v75
    v_and_b32 v76, v11, v76
    v_and_b32 v77, v11, v77
    v_and_b32 v78, v11, v78
    v_and_b32 v79, v11, v79
    v_and_b32 v80, v11, v80
    v_and_b32 v81, v11, v81
    v_and_b32 v82, v11, v82
    v_and_b32 v83, v11, v83
    v_and_b32 v84, v11, v84
    v_and_b32 v85, v11, v85
    v_and_b32 v86, v11, v86
    v_and_b32 v87, v11, v87
    v_and_b32 v88, v11, v88
    v_and_b32 v89, v11, v89
    v_and_b32 v90, v11, v90
    v_and_b32 v91, v11, v91
    v_and_b32 v92, v11, v92
    v_and_b32 v93, v11, v93
    v_and_b32 v94, v11, v94
    v_and_b32 v95, v11, v95
    v_and_b32 v96, v11, v96
    v_and_b32 v97, v11, v97
    v_and_b32 v98, v11, v98
    v_and_b32 v99, v11, v99
    v_pk_max_u16 v16, v16, v17
    v_pk_max_u16 v16, v16, v18
    v_pk_max_u16 v16, v16, v19
    v_pk_max_u16 v16, v16, v20
    v_pk_max_u16 v16, v16, v21
    v_pk_max_u16 v16, v16, v22
    v_pk_max_u16 v16, v16, v23
    v_pk_max_u16 v16, v16, v24
    v_pk_max_u16 v16, v16, v25
    v_pk_max_u16 v16, v16, v26
    v_pk_max_u16 v16, v16, v27
    v_pk_max_u16 v16, v16, v28
    v_pk_max_u16 v16, v16, v29
    v_pk_max_u16 v16, v16, v30
    v_pk_max_u16 v16, v16, v31
    v_pk_max_u16 v16, v16, v32
    v_pk_max_u16 v16, v16, v33
    v_pk_max_u16 v16, v16, v34
    v_pk_max_u16 v16, v16, v35
    v_pk_max_u16 v16, v16, v36
    v_pk_max_u16 v16, v16, v37
    v_pk_max_u16 v16, v16, v38
    v_pk_max_u16 v16, v16, v39
    v_pk_max_u16 v16, v16, v40
    v_pk_max_u16 v16, v16, v41
    v_pk_max_u16 v16, v16, v42
    v_pk_max_u16 v16, v16, v43
    v_pk_max_u16 v16, v16, v44
    v_pk_max_u16 v16, v16, v45
    v_pk_max_u16 v16, v16, v46
    v_pk_max_u16 v16, v16, v47
    v_pk_max_u16 v16, v16, v48
    v_pk_max_u16 v16, v16, v49
    v_pk_max_u16 v16, v16, v50
    v_pk_max_u16 v16, v16, v51
    v_pk_max_u16 v16, v16, v52
    v_pk_max_u16 v16, v16, v53
    v_pk_max_u16 v16, v16, v54
    v_pk_max_u16 v16, v16, v55
    v_pk_max_u16 v16, v16, v56
    v_pk_max_u16 v16, v16, v57
    v_pk_max_u16 v16, v16, v58
    v_pk_max_u16 v16, v16, v59
    v_pk_max_u16 v16, v16, v60
    v_pk_max_u16 v16, v16, v61
    v_pk_max_u16 v16, v16, v62
    v_pk_max_u16 v16, v16, v63
    v_pk_max_u16 v16, v16, v64
    v_pk_max_u16 v16, v16, v65
    v_pk_max_u16 v16, v16, v66
    v_pk_max_u16 v16, v16, v67
    v_pk_max_u16 v16, v16, v68
    v_pk_max_u16 v16, v16, v69
    v_pk_max_u16 v16, v16, v70
    v_pk_max_u16 v16, v16, v71
    v_pk_max_u16 v16, v16, v72
    v_pk_max_u16 v16, v16, v73
    v_pk_max_u16 v16, v16, v74
    v_pk_max_u16 v16, v16, v75
    v_pk_max_u16 v16, v16, v76
    v_pk_max_u16 v16, v16, v77
    v_pk_max_u16 v16, v16, v78
    v_pk_max_u16 v16, v16, v79
    v_pk_max_u16 v16, v16, v80
    v_pk_max_u16 v16, v16, v81
    v_pk_max_u16 v16, v16, v82
    v_pk_max_u16 v16, v16, v83
    v_pk_max_u16 v16, v16, v84
    v_pk_max_u16 v16, v16, v85
    v_pk_max_u16 v16, v16, v86
    v_pk_max_u16 v16, v16, v87
    v_pk_max_u16 v16, v16, v88
    v_pk_max_u16 v16, v16, v89
    v_pk_max_u16 v16, v16, v90
    v_pk_max_u16 v16, v16, v91
    v_pk_max_u16 v16, v16, v92
    v_pk_max_u16 v16, v16, v93
    v_pk_max_u16 v16, v16, v94
    v_pk_max_u16 v16, v16, v95
    v_pk_max_u16 v16, v16, v96
    v_pk_max_u16 v16, v16, v97
    v_pk_max_u16 v16, v16, v98
    v_pk_max_u16 v16, v16, v99
    v_lshrrev_b32 v33, 16, v16
    v_and_b32 v32, 0xffff, v16
    v_max_u32 v32, v32, v33
    s_nop 1
    v_max_u32_dpp v32, v32, v32 row_ror:8 row_mask:0xf bank_mask:0xf
    s_nop 1
    v_max_u32_dpp v32, v32, v32 row_ror:4 row_mask:0xf bank_mask:0xf
    s_nop 1
    v_max_u32_dpp v32, v32, v32 row_ror:2 row_mask:0xf bank_mask:0xf
    s_nop 1
    v_max_u32_dpp v32, v32, v32 row_ror:1 row_mask:0xf bank_mask:0xf
    v_mov_b32 v33, v32
    s_nop 1
    v_permlane16_swap_b32 v33, v32
    s_nop 0
    v_max_u32 v32, v32, v33
    v_mov_b32 v33, v32
    s_nop 1
    v_permlane32_swap_b32 v33, v32
    s_nop 0
    v_max_u32 v32, v32, v33
    s_lshl_b32 s42, s37, 2
    v_mov_b32 v12, 0
    s_mov_b64 exec, 1
    buffer_store_dword v32, v12, s[24:27], s42 offen
    s_endpgm
k1_kernel_RP2:
    s_sub_u32 s3, s2, 144
k1_kernel_rpk:
    s_load_dwordx4 s[4:7], s[0:1], 32
    s_load_dwordx2 s[8:9], s[0:1], 48
    s_load_dwordx2 s[10:11], s[0:1], 72
    v_lshrrev_b32 v1, 6, v0
    v_and_b32 v2, 63, v0
    s_nop 0
    v_readfirstlane_b32 s33, v1
    s_lshl_b32 s34, s3, 3
    s_add_u32 s34, s34, s33
    s_cmp_ge_u32 s34, 480
    s_cbranch_scc1 k1_kernel_rpk_down
    s_cmp_ge_u32 s34, 240
    s_cselect_b32 s35, 1, 0
    s_mul_i32 s36, s35, 240
    s_sub_u32 s34, s34, s36
    s_mul_i32 s36, s34, 5462
    s_lshr_b32 s36, s36, 16
    s_mul_i32 s37, s36, 12
    s_sub_u32 s37, s34, s37
    s_mov_b32 s38, 3072
    s_mov_b32 s46, 1024
    s_mov_b32 s47, 3
    s_lshl_b32 s40, s37, 3
    s_add_u32 s40, s40, 0
    s_mul_i32 s41, s40, 10923
    s_lshr_b32 s41, s41, 16
    s_mul_i32 s42, s41, 6
    s_sub_u32 s42, s40, s42
    s_mul_i32 s41, s41, 10
    s_lshr_b32 s43, s36, 1
    s_add_u32 s41, s41, s43
    s_lshl_b32 s41, s41, 1
    s_add_u32 s41, s41, s35
    s_lshl_b32 s41, s41, 1
    s_and_b32 s43, s36, 1
    s_add_u32 s41, s41, s43
    s_mul_i32 s41, s41, 6
    s_add_u32 s41, s41, s42
    s_lshl_b32 s50, s41, 10
    s_lshl_b32 s40, s37, 3
    s_add_u32 s40, s40, 1
    s_mul_i32 s41, s40, 10923
    s_lshr_b32 s41, s41, 16
    s_mul_i32 s42, s41, 6
    s_sub_u32 s42, s40, s42
    s_mul_i32 s41, s41, 10
    s_lshr_b32 s43, s36, 1
    s_add_u32 s41, s41, s43
    s_lshl_b32 s41, s41, 1
    s_add_u32 s41, s41, s35
    s_lshl_b32 s41, s41, 1
    s_and_b32 s43, s36, 1
    s_add_u32 s41, s41, s43
    s_mul_i32 s41, s41, 6
    s_add_u32 s41, s41, s42
    s_lshl_b32 s51, s41, 10
    s_lshl_b32 s40, s37, 3
    s_add_u32 s40, s40, 2
    s_mul_i32 s41, s40, 10923
    s_lshr_b32 s41, s41, 16
    s_mul_i32 s42, s41, 6
    s_sub_u32 s42, s40, s42
    s_mul_i32 s41, s41, 10
    s_lshr_b32 s43, s36, 1
    s_add_u32 s41, s41, s43
    s_lshl_b32 s41, s41, 1
    s_add_u32 s41, s41, s35
    s_lshl_b32 s41, s41, 1
    s_and_b32 s43, s36, 1
    s_add_u32 s41, s41, s43
    s_mul_i32 s41, s41, 6
    s_add_u32 s41, s41, s42
    s_lshl_b32 s52, s41, 10
    s_lshl_b32 s40, s37, 3
    s_add_u32 s40, s40, 3
    s_mul_i32 s41, s40, 10923
    s_lshr_b32 s41, s41, 16
    s_mul_i32 s42, s41, 6
    s_sub_u32 s42, s40, s42
    s_mul_i32 s41, s41, 10
    s_lshr_b32 s43, s36, 1
    s_add_u32 s41, s41, s43
    s_lshl_b32 s41, s41, 1
    s_add_u32 s41, s41, s35
    s_lshl_b32 s41, s41, 1
    s_and_b32 s43, s36, 1
    s_add_u32 s41, s41, s43
    s_mul_i32 s41, s41, 6
    s_add_u32 s41, s41, s42
    s_lshl_b32 s53, s41, 10
    s_lshl_b32 s40, s37, 3
    s_add_u32 s40, s40, 4
    s_mul_i32 s41, s40, 10923
    s_lshr_b32 s41, s41, 16
    s_mul_i32 s42, s41, 6
    s_sub_u32 s42, s40, s42
    s_mul_i32 s41, s41, 10
    s_lshr_b32 s43, s36, 1
    s_add_u32 s41, s41, s43
    s_lshl_b32 s41, s41, 1
    s_add_u32 s41, s41, s35
    s_lshl_b32 s41, s41, 1
    s_and_b32 s43, s36, 1
    s_add_u32 s41, s41, s43
    s_mul_i32 s41, s41, 6
    s_add_u32 s41, s41, s42
    s_lshl_b32 s54, s41, 10
    s_lshl_b32 s40, s37, 3
    s_add_u32 s40, s40, 5
    s_mul_i32 s41, s40, 10923
    s_lshr_b32 s41, s41, 16
    s_mul_i32 s42, s41, 6
    s_sub_u32 s42, s40, s42
    s_mul_i32 s41, s41, 10
    s_lshr_b32 s43, s36, 1
    s_add_u32 s41, s41, s43
    s_lshl_b32 s41, s41, 1
    s_add_u32 s41, s41, s35
    s_lshl_b32 s41, s41, 1
    s_and_b32 s43, s36, 1
    s_add_u32 s41, s41, s43
    s_mul_i32 s41, s41, 6
    s_add_u32 s41, s41, s42
    s_lshl_b32 s55, s41, 10
    s_lshl_b32 s40, s37, 3
    s_add_u32 s40, s40, 6
    s_mul_i32 s41, s40, 10923
    s_lshr_b32 s41, s41, 16
    s_mul_i32 s42, s41, 6
    s_sub_u32 s42, s40, s42
    s_mul_i32 s41, s41, 10
    s_lshr_b32 s43, s36, 1
    s_add_u32 s41, s41, s43
    s_lshl_b32 s41, s41, 1
    s_add_u32 s41, s41, s35
    s_lshl_b32 s41, s41, 1
    s_and_b32 s43, s36, 1
    s_add_u32 s41, s41, s43
    s_mul_i32 s41, s41, 6
    s_add_u32 s41, s41, s42
    s_lshl_b32 s56, s41, 10
    s_lshl_b32 s40, s37, 3
    s_add_u32 s40, s40, 7
    s_mul_i32 s41, s40, 10923
    s_lshr_b32 s41, s41, 16
    s_mul_i32 s42, s41, 6
    s_sub_u32 s42, s40, s42
    s_mul_i32 s41, s41, 10
    s_lshr_b32 s43, s36, 1
    s_add_u32 s41, s41, s43
    s_lshl_b32 s41, s41, 1
    s_add_u32 s41, s41, s35
    s_lshl_b32 s41, s41, 1
    s_and_b32 s43, s36, 1
    s_add_u32 s41, s41, s43
    s_mul_i32 s41, s41, 6
    s_add_u32 s41, s41, s42
    s_lshl_b32 s57, s41, 10
    s_waitcnt lgkmcnt(0)
    s_cmp_eq_u32 s35, 0
    s_cselect_b32 s12, s4, s6
    s_cselect_b32 s13, s5, s7
    s_mov_b32 s14, 1966080
    s_mov_b32 s15, 0x00020000
    s_add_u32 s16, s10, 23068672
    s_addc_u32 s17, s11, 0
    s_mov_b32 s18, 3932160
    s_mov_b32 s19, 0x00020000
    s_branch k1_kernel_rpk_go
k1_kernel_rpk_down:
    s_sub_u32 s34, s34, 480
    s_mul_i32 s36, s34, 13108
    s_lshr_b32 s36, s36, 16
    s_mul_i32 s37, s36, 5
    s_sub_u32 s37, s34, s37
    s_mov_b32 s38, 1280
    s_mov_b32 s46, 4096
    s_mov_b32 s47, 2
    s_lshl_b32 s40, s37, 3
    s_add_u32 s40, s40, 0
    s_mul_i32 s41, s40, 13108
    s_lshr_b32 s41, s41, 16
    s_mul_i32 s42, s41, 5
    s_sub_u32 s42, s40, s42
    s_mul_i32 s41, s41, 48
    s_add_u32 s41, s41, s36
    s_mul_i32 s41, s41, 5
    s_add_u32 s41, s41, s42
    s_lshl_b32 s50, s41, 10
    s_lshl_b32 s40, s37, 3
    s_add_u32 s40, s40, 1
    s_mul_i32 s41, s40, 13108
    s_lshr_b32 s41, s41, 16
    s_mul_i32 s42, s41, 5
    s_sub_u32 s42, s40, s42
    s_mul_i32 s41, s41, 48
    s_add_u32 s41, s41, s36
    s_mul_i32 s41, s41, 5
    s_add_u32 s41, s41, s42
    s_lshl_b32 s51, s41, 10
    s_lshl_b32 s40, s37, 3
    s_add_u32 s40, s40, 2
    s_mul_i32 s41, s40, 13108
    s_lshr_b32 s41, s41, 16
    s_mul_i32 s42, s41, 5
    s_sub_u32 s42, s40, s42
    s_mul_i32 s41, s41, 48
    s_add_u32 s41, s41, s36
    s_mul_i32 s41, s41, 5
    s_add_u32 s41, s41, s42
    s_lshl_b32 s52, s41, 10
    s_lshl_b32 s40, s37, 3
    s_add_u32 s40, s40, 3
    s_mul_i32 s41, s40, 13108
    s_lshr_b32 s41, s41, 16
    s_mul_i32 s42, s41, 5
    s_sub_u32 s42, s40, s42
    s_mul_i32 s41, s41, 48
    s_add_u32 s41, s41, s36
    s_mul_i32 s41, s41, 5
    s_add_u32 s41, s41, s42
    s_lshl_b32 s53, s41, 10
    s_lshl_b32 s40, s37, 3
    s_add_u32 s40, s40, 4
    s_mul_i32 s41, s40, 13108
    s_lshr_b32 s41, s41, 16
    s_mul_i32 s42, s41, 5
    s_sub_u32 s42, s40, s42
    s_mul_i32 s41, s41, 48
    s_add_u32 s41, s41, s36
    s_mul_i32 s41, s41, 5
    s_add_u32 s41, s41, s42
    s_lshl_b32 s54, s41, 10
    s_lshl_b32 s40, s37, 3
    s_add_u32 s40, s40, 5
    s_mul_i32 s41, s40, 13108
    s_lshr_b32 s41, s41, 16
    s_mul_i32 s42, s41, 5
    s_sub_u32 s42, s40, s42
    s_mul_i32 s41, s41, 48
    s_add_u32 s41, s41, s36
    s_mul_i32 s41, s41, 5
    s_add_u32 s41, s41, s42
    s_lshl_b32 s55, s41, 10
    s_lshl_b32 s40, s37, 3
    s_add_u32 s40, s40, 6
    s_mul_i32 s41, s40, 13108
    s_lshr_b32 s41, s41, 16
    s_mul_i32 s42, s41, 5
    s_sub_u32 s42, s40, s42
    s_mul_i32 s41, s41, 48
    s_add_u32 s41, s41, s36
    s_mul_i32 s41, s41, 5
    s_add_u32 s41, s41, s42
    s_lshl_b32 s56, s41, 10
    s_lshl_b32 s40, s37, 3
    s_add_u32 s40, s40, 7
    s_mul_i32 s41, s40, 13108
    s_lshr_b32 s41, s41, 16
    s_mul_i32 s42, s41, 5
    s_sub_u32 s42, s40, s42
    s_mul_i32 s41, s41, 48
    s_add_u32 s41, s41, s36
    s_mul_i32 s41, s41, 5
    s_add_u32 s41, s41, s42
    s_lshl_b32 s57, s41, 10
    s_waitcnt lgkmcnt(0)
    s_mov_b32 s12, s8
    s_mov_b32 s13, s9
    s_mov_b32 s14, 1966080
    s_mov_b32 s15, 0x00020000
    s_add_u32 s16, s10, 27262976
    s_addc_u32 s17, s11, 0
    s_mov_b32 s18, 1966080
    s_mov_b32 s19, 0x00020000
k1_kernel_rpk_go:
    v_lshrrev_b32 v3, 4, v2
    v_mul_lo_u32 v3, v3, s38
    v_and_b32 v4, 15, v2
    v_lshl_add_u32 v3, v4, 4, v3
    s_lshl_b32 s40, s36, 5
    s_mul_i32 s40, s40, s38
    s_lshl_b32 s41, s37, 8
    s_add_u32 s40, s40, s41
    s_lshl_b32 s41, s38, 2
    s_lshl_b32 s42, s33, 13
    s_add_u32 m0, s42, 0
    s_nop 0
    buffer_load_dwordx4 v3, s[12:15], s40 offen lds
    s_add_u32 s40, s40, s41
    s_add_u32 m0, s42, 1024
    s_nop 0
    buffer_load_dwordx4 v3, s[12:15], s40 offen lds
    s_add_u32 s40, s40, s41
    s_add_u32 m0, s42, 2048
    s_nop 0
    buffer_load_dwordx4 v3, s[12:15], s40 offen lds
    s_add_u32 s40, s40, s41
    s_add_u32 m0, s42, 3072
    s_nop 0
    buffer_load_dwordx4 v3, s[12:15], s40 offen lds
    s_add_u32 s40, s40, s41
    s_add_u32 m0, s42, 4096
    s_nop 0
    buffer_load_dwordx4 v3, s[12:15], s40 offen lds
    s_add_u32 s40, s40, s41
    s_add_u32 m0, s42, 5120
    s_nop 0
    buffer_load_dwordx4 v3, s[12:15], s40 offen lds
    s_add_u32 s40, s40, s41
    s_add_u32 m0, s42, 6144
    s_nop 0
    buffer_load_dwordx4 v3, s[12:15], s40 offen lds
    s_add_u32 s40, s40, s41
    s_add_u32 m0, s42, 7168
    s_nop 0
    buffer_load_dwordx4 v3, s[12:15], s40 offen lds
    v_lshrrev_b32 v5, 4, v2
    v_lshlrev_b32 v5, s47, v5
    v_lshrrev_b32 v6, 2, v4
    v_add_u32 v5, v5, v6
    v_lshlrev_b32 v5, 8, v5
    v_and_b32 v6, 3, v4
    v_lshl_add_u32 v5, v6, 3, v5
    v_add_u32 v5, s42, v5
    v_add_u32 v6, s46, v5
    v_lshlrev_b32 v7, 4, v2
    s_waitcnt vmcnt(0)
    ds_read_b64_tr_b16 v[8:9], v5 offset:0
    ds_read_b64_tr_b16 v[10:11], v6 offset:0
    ds_read_b64_tr_b16 v[12:13], v5 offset:32
    ds_read_b64_tr_b16 v[14:15], v6 offset:32
    ds_read_b64_tr_b16 v[16:17], v5 offset:64
    ds_read_b64_tr_b16 v[18:19], v6 offset:64
    ds_read_b64_tr_b16 v[20:21], v5 offset:96
    ds_read_b64_tr_b16 v[22:23], v6 offset:96
    ds_read_b64_tr_b16 v[24:25], v5 offset:128
    ds_read_b64_tr_b16 v[26:27], v6 offset:128
    ds_read_b64_tr_b16 v[28:29], v5 offset:160
    ds_read_b64_tr_b16 v[30:31], v6 offset:160
    ds_read_b64_tr_b16 v[32:33], v5 offset:192
    ds_read_b64_tr_b16 v[34:35], v6 offset:192
    ds_read_b64_tr_b16 v[36:37], v5 offset:224
    ds_read_b64_tr_b16 v[38:39], v6 offset:224
    s_waitcnt lgkmcnt(14)
    buffer_store_dwordx4 v[8:11], v7, s[16:19], s50 offen
    s_waitcnt lgkmcnt(12)
    buffer_store_dwordx4 v[12:15], v7, s[16:19], s51 offen
    s_waitcnt lgkmcnt(10)
    buffer_store_dwordx4 v[16:19], v7, s[16:19], s52 offen
    s_waitcnt lgkmcnt(8)
    buffer_store_dwordx4 v[20:23], v7, s[16:19], s53 offen
    s_waitcnt lgkmcnt(6)
    buffer_store_dwordx4 v[24:27], v7, s[16:19], s54 offen
    s_waitcnt lgkmcnt(4)
    buffer_store_dwordx4 v[28:31], v7, s[16:19], s55 offen
    s_waitcnt lgkmcnt(2)
    buffer_store_dwordx4 v[32:35], v7, s[16:19], s56 offen
    s_waitcnt lgkmcnt(0)
    buffer_store_dwordx4 v[36:39], v7, s[16:19], s57 offen
    s_endpgm
    .globl k2_kernel
    .p2align 8
    .type k2_kernel,@function
k2_kernel:
    s_cmp_ge_u32 s2, 252
    s_cbranch_scc1 k2_kernel_END
    s_cmp_ge_u32 s2, 192
    s_cbranch_scc1 k2_kernel_RP
    s_load_dwordx4 s[4:7], s[0:1], 8
    s_load_dwordx2 s[8:9], s[0:1], 72
    s_getpc_b64 s[90:91]
    s_add_u32 s28, s90, g64tab@rel32@lo+4
    s_addc_u32 s29, s91, g64tab@rel32@hi+12
    s_mov_b32 s30, 24576
    s_mov_b32 s31, 0x00020000
    v_lshrrev_b32 v1, 6, v0
    v_and_b32 v2, 63, v0
    v_lshlrev_b32 v3, 4, v2
    v_readfirstlane_b32 s37, v1
    s_mul_i32 s39, s2, 10923
    s_lshr_b32 s39, s39, 16
    s_mul_i32 s40, s39, 6
    s_sub_u32 s40, s2, s40
    v_and_b32 v4, 15, v2
    v_lshrrev_b32 v5, 4, v2
    v_mul_u32_u24 v6, 1408, v5
    v_lshl_add_u32 v6, v4, 4, v6
    s_lshl_b32 s41, s39, 6
    s_lshl_b32 s42, s37, 4
    s_add_u32 s41, s41, s42
    s_mul_i32 s41, s41, 1408
    s_lshl_b32 s42, s40, 8
    s_add_u32 s41, s41, s42
    v_lshrrev_b32 v7, 3, v2
    v_mul_u32_u24 v7, 20544, v7
    v_and_b32 v8, 7, v2
    v_lshl_add_u32 v7, v8, 4, v7
    s_mul_i32 s43, s39, 642
    s_lshl_b32 s42, s40, 7
    s_add_u32 s43, s43, s42
    s_mul_i32 s42, s37, 328704
    s_add_u32 s43, s43, s42
    s_waitcnt lgkmcnt(0)
    s_mov_b32 s12, s8
    s_mov_b32 s13, s9
    s_mov_b32 s14, 2883584
    s_mov_b32 s15, 0x00020000
    s_lshl_b32 s36, s37, 12
    s_add_u32 m0, s36, 40960
    s_add_u32 s38, s41, 0
    buffer_load_dwordx4 v6, s[12:15], s38 offen lds
    s_add_u32 m0, s36, 41984
    s_add_u32 s38, s41, 5632
    buffer_load_dwordx4 v6, s[12:15], s38 offen lds
    s_add_u32 m0, s36, 43008
    s_add_u32 s38, s41, 11264
    buffer_load_dwordx4 v6, s[12:15], s38 offen lds
    s_add_u32 m0, s36, 44032
    s_add_u32 s38, s41, 16896
    buffer_load_dwordx4 v6, s[12:15], s38 offen lds
    s_mul_i32 s36, s37, 6144
    s_add_u32 m0, s36, 0
    s_add_u32 s38, s36, 0
    buffer_load_dwordx4 v3, s[28:31], s38 offen lds
    s_add_u32 m0, s36, 1024
    s_add_u32 s38, s36, 1024
    buffer_load_dwordx4 v3, s[28:31], s38 offen lds
    s_add_u32 m0, s36, 2048
    s_add_u32 s38, s36, 2048
    buffer_load_dwordx4 v3, s[28:31], s38 offen lds
    s_add_u32 m0, s36, 3072
    s_add_u32 s38, s36, 3072
    buffer_load_dwordx4 v3, s[28:31], s38 offen lds
    s_add_u32 m0, s36, 4096
    s_add_u32 s38, s36, 4096
    buffer_load_dwordx4 v3, s[28:31], s38 offen lds
    s_add_u32 m0, s36, 5120
    s_add_u32 s38, s36, 5120
    buffer_load_dwordx4 v3, s[28:31], s38 offen lds
    s_mov_b32 s20, s4
    s_mov_b32 s21, s5
    s_mov_b32 s22, 1314818
    s_mov_b32 s23, 0x00020000
    s_mov_b32 s24, s6
    s_mov_b32 s25, s7
    s_mov_b32 s26, 1314818
    s_mov_b32 s27, 0x00020000
    s_lshl_b32 s36, s37, 11
    s_add_u32 m0, s36, 24576
    s_add_u32 s38, s43, 0
    buffer_load_dwordx4 v7, s[20:23], s38 offen lds
    s_add_u32 m0, s36, 25600
    s_add_u32 s38, s43, 164352
    buffer_load_dwordx4 v7, s[20:23], s38 offen lds
    s_add_u32 m0, s36, 32768
    s_add_u32 s38, s43, 0
    buffer_load_dwordx4 v7, s[24:27], s38 offen lds
    s_add_u32 m0, s36, 33792
    s_add_u32 s38, s43, 164352
    buffer_load_dwordx4 v7, s[24:27], s38 offen lds
    s_add_u32 s32, s8, 18874368
    s_addc_u32 s33, s9, 0
    s_mov_b32 s34, 512
    s_mov_b32 s35, 0x00020000
    buffer_load_dwordx4 v[48:51], v3, s[32:35], 0 offen
    s_add_u32 s16, s8, 3145728
    s_addc_u32 s17, s9, 0
    s_mov_b32 s18, 2883584
    s_mov_b32 s19, 0x00020000
    s_lshl_b32 s42, s40, 6
    s_lshl_b32 s44, s37, 4
    s_add_u32 s42, s42, s44
    v_add_u32 v8, s42, v4
    v_mov_b32 v11, 2.0
    v_cmp_eq_u32 vcc, 0, v8
    s_nop 1
    v_cndmask_b32 v11, v11, 1.0, vcc
    v_cmp_eq_u32 vcc, 320, v8
    s_nop 1
    v_cndmask_b32 v11, v11, 1.0, vcc
    v_mov_b32 v9, 320
    v_cmp_lt_u32 s[46:47], v9, v8
    v_lshlrev_b32 v9, 10, v5
    v_lshl_add_u32 v9, v4, 2, v9
    s_lshl_b32 s44, s37, 6
    s_add_u32 s44, s44, 40960
    v_add_u32 v9, s44, v9
    v_lshrrev_b32 v10, 2, v4
    v_lshl_add_u32 v10, v5, 2, v10
    v_lshlrev_b32 v10, 7, v10
    v_and_b32 v12, 3, v4
    v_lshl_add_u32 v10, v12, 3, v10
    s_lshl_b32 s44, s37, 5
    s_add_u32 s44, s44, 24576
    v_add_u32 v10, s44, v10
    s_mov_b32 s44, 0x05040100
    s_mov_b32 s45, 0x07060302
    s_waitcnt vmcnt(5)
    s_barrier
    ds_read_b32 v16, v9 offset:0
    ds_read_b32 v17, v9 offset:256
    ds_read_b32 v18, v9 offset:512
    ds_read_b32 v19, v9 offset:768
    ds_read_b32 v20, v9 offset:4096
    ds_read_b32 v21, v9 offset:4352
    ds_read_b32 v22, v9 offset:4608
    ds_read_b32 v23, v9 offset:4864
    ds_read_b32 v24, v9 offset:8192
    ds_read_b32 v25, v9 offset:8448
    ds_read_b32 v26, v9 offset:8704
    ds_read_b32 v27, v9 offset:8960
    ds_read_b32 v28, v9 offset:12288
    ds_read_b32 v29, v9 offset:12544
    ds_read_b32 v30, v9 offset:12800
    ds_read_b32 v31, v9 offset:13056
    ds_read_b128 v[128:131], v3 offset:0
    ds_read_b128 v[132:135], v3 offset:1024
    ds_read_b128 v[136:139], v3 offset:2048
    ds_read_b128 v[140:143], v3 offset:3072
    ds_read_b128 v[144:147], v3 offset:4096
    ds_read_b128 v[148:151], v3 offset:5120
    ds_read_b128 v[152:155], v3 offset:6144
    ds_read_b128 v[156:159], v3 offset:7168
    ds_read_b128 v[160:163], v3 offset:8192
    ds_read_b128 v[164:167], v3 offset:9216
    ds_read_b128 v[168:171], v3 offset:10240
    ds_read_b128 v[172:175], v3 offset:11264
    ds_read_b128 v[176:179], v3 offset:12288
    ds_read_b128 v[180:183], v3 offset:13312
    ds_read_b128 v[184:187], v3 offset:14336
    ds_read_b128 v[188:191], v3 offset:15360
    ds_read_b128 v[192:195], v3 offset:16384
    ds_read_b128 v[196:199], v3 offset:17408
    ds_read_b128 v[200:203], v3 offset:18432
    ds_read_b128 v[204:207], v3 offset:19456
    ds_read_b128 v[208:211], v3 offset:20480
    ds_read_b128 v[212:215], v3 offset:21504
    ds_read_b128 v[216:219], v3 offset:22528
    ds_read_b128 v[220:223], v3 offset:23552
    s_waitcnt lgkmcnt(15)
    s_waitcnt lgkmcnt(15)
    s_waitcnt lgkmcnt(8)
    s_mov_b64 exec, s[46:47]
    v_mov_b32 v16, 0
    v_mov_b32 v17, 0
    v_mov_b32 v18, 0
    v_mov_b32 v19, 0
    v_mov_b32 v20, 0
    v_mov_b32 v21, 0
    v_mov_b32 v22, 0
    v_mov_b32 v23, 0
    v_mov_b32 v24, 0
    v_mov_b32 v25, 0
    v_mov_b32 v26, 0
    v_mov_b32 v27, 0
    v_mov_b32 v28, 0
    v_mov_b32 v29, 0
    v_mov_b32 v30, 0
    v_mov_b32 v31, 0
    s_mov_b64 exec, -1
    v_perm_b32 v64, v17, v16, s44
    v_perm_b32 v72, v17, v16, s45
    v_perm_b32 v65, v19, v18, s44
    v_perm_b32 v73, v19, v18, s45
    v_perm_b32 v66, v21, v20, s44
    v_perm_b32 v74, v21, v20, s45
    v_perm_b32 v67, v23, v22, s44
    v_perm_b32 v75, v23, v22, s45
    v_perm_b32 v68, v25, v24, s44
    v_perm_b32 v76, v25, v24, s45
    v_perm_b32 v69, v27, v26, s44
    v_perm_b32 v77, v27, v26, s45
    v_perm_b32 v70, v29, v28, s44
    v_perm_b32 v78, v29, v28, s45
    v_perm_b32 v71, v31, v30, s44
    v_perm_b32 v79, v31, v30, s45
    s_waitcnt vmcnt(0) lgkmcnt(0)
    s_barrier
    ds_read_b64_tr_b16 v[32:33], v10 offset:0
    ds_read_b64_tr_b16 v[34:35], v10 offset:2048
    ds_read_b64_tr_b16 v[36:37], v10 offset:4096
    ds_read_b64_tr_b16 v[38:39], v10 offset:6144
    ds_read_b64_tr_b16 v[40:41], v10 offset:8192
    ds_read_b64_tr_b16 v[42:43], v10 offset:10240
    ds_read_b64_tr_b16 v[44:45], v10 offset:12288
    ds_read_b64_tr_b16 v[46:47], v10 offset:14336
    v_mfma_f32_16x16x32_f16 v[80:83], v[128:131], v[64:67], 0
    v_mfma_f32_16x16x32_f16 v[96:99], v[160:163], v[64:67], 0
    v_mfma_f32_16x16x32_f16 v[80:83], v[192:195], v[72:75], v[80:83]
    v_mfma_f32_16x16x32_f16 v[96:99], v[128:131], v[72:75], v[96:99]
    v_mfma_f32_16x16x32_f16 v[80:83], v[132:135], v[68:71], v[80:83]
    v_mfma_f32_16x16x32_f16 v[96:99], v[164:167], v[68:71], v[96:99]
    v_mfma_f32_16x16x32_f16 v[80:83], v[196:199], v[76:79], v[80:83]
    v_mfma_f32_16x16x32_f16 v[96:99], v[132:135], v[76:79], v[96:99]
    v_mfma_f32_16x16x32_f16 v[84:87], v[136:139], v[64:67], 0
    v_mfma_f32_16x16x32_f16 v[100:103], v[168:171], v[64:67], 0
    v_mfma_f32_16x16x32_f16 v[84:87], v[200:203], v[72:75], v[84:87]
    v_mfma_f32_16x16x32_f16 v[100:103], v[136:139], v[72:75], v[100:103]
    v_mfma_f32_16x16x32_f16 v[84:87], v[140:143], v[68:71], v[84:87]
    v_mfma_f32_16x16x32_f16 v[100:103], v[172:175], v[68:71], v[100:103]
    v_mfma_f32_16x16x32_f16 v[84:87], v[204:207], v[76:79], v[84:87]
    v_mfma_f32_16x16x32_f16 v[100:103], v[140:143], v[76:79], v[100:103]
    v_mfma_f32_16x16x32_f16 v[88:91], v[144:147], v[64:67], 0
    v_mfma_f32_16x16x32_f16 v[104:107], v[176:179], v[64:67], 0
    v_mfma_f32_16x16x32_f16 v[88:91], v[208:211], v[72:75], v[88:91]
    v_mfma_f32_16x16x32_f16 v[104:107], v[144:147], v[72:75], v[104:107]
    v_mfma_f32_16x16x32_f16 v[88:91], v[148:151], v[68:71], v[88:91]
    v_mfma_f32_16x16x32_f16 v[104:107], v[180:183], v[68:71], v[104:107]
    v_mfma_f32_16x16x32_f16 v[88:91], v[212:215], v[76:79], v[88:91]
    v_mfma_f32_16x16x32_f16 v[104:107], v[148:151], v[76:79], v[104:107]
    v_mfma_f32_16x16x32_f16 v[92:95], v[152:155], v[64:67], 0
    v_mfma_f32_16x16x32_f16 v[108:111], v[184:187], v[64:67], 0
    v_mfma_f32_16x16x32_f16 v[92:95], v[216:219], v[72:75], v[92:95]
    v_mfma_f32_16x16x32_f16 v[108:111], v[152:155], v[72:75], v[108:111]
    v_mfma_f32_16x16x32_f16 v[92:95], v[156:159], v[68:71], v[92:95]
    v_mfma_f32_16x16x32_f16 v[108:111], v[188:191], v[68:71], v[108:111]
    v_mfma_f32_16x16x32_f16 v[92:95], v[220:223], v[76:79], v[92:95]
    v_mfma_f32_16x16x32_f16 v[108:111], v[156:159], v[76:79], v[108:111]
    v_max_u32 v48, v48, v49
    v_max_u32 v48, v48, v50
    v_max_u32 v48, v48, v51
    s_nop 1
    v_max_u32_dpp v48, v48, v48 row_ror:8 row_mask:0xf bank_mask:0xf
    s_nop 1
    v_max_u32_dpp v48, v48, v48 row_ror:4 row_mask:0xf bank_mask:0xf
    s_nop 1
    v_max_u32_dpp v48, v48, v48 row_ror:2 row_mask:0xf bank_mask:0xf
    s_nop 1
    v_max_u32_dpp v48, v48, v48 row_ror:1 row_mask:0xf bank_mask:0xf
    v_mov_b32 v49, v48
    s_nop 1
    v_permlane16_swap_b32 v49, v48
    s_nop 0
    v_max_u32 v48, v48, v49
    v_mov_b32 v49, v48
    s_nop 1
    v_permlane32_swap_b32 v49, v48
    s_nop 0
    v_max_u32 v48, v48, v49
    v_lshrrev_b32 v48, 7, v48
    v_max_u32 v48, 1, v48
    v_min_u32 v48, 253, v48
    v_sub_u32 v49, 254, v48
    v_lshlrev_b32 v49, 23, v49
    v_lshlrev_b32 v48, 23, v48
    v_mul_f32 v11, v11, v49
    s_or_b32 s38, s2, s37
    s_cmp_lg_u32 s38, 0
    s_cbranch_scc1 k2_kernel_nosc
    s_add_u32 s32, s8, 18878464
    s_addc_u32 s33, s9, 0
    s_mov_b32 s34, 4
    s_mov_b32 s35, 0x00020000
    v_mov_b32 v12, 0
    s_mov_b64 exec, 1
    buffer_store_dword v48, v12, s[32:35], 0 offen
    s_mov_b64 exec, -1
k2_kernel_nosc:
    v_mov_b32 v12, 0xffff0000
    s_waitcnt lgkmcnt(0)
    v_lshlrev_b32 v48, 16, v32
    v_and_b32 v49, v12, v32
    v_lshlrev_b32 v112, 16, v40
    v_and_b32 v113, v12, v40
    v_lshlrev_b32 v50, 16, v33
    v_and_b32 v51, v12, v33
    v_lshlrev_b32 v114, 16, v41
    v_and_b32 v115, v12, v41
    v_lshlrev_b32 v52, 16, v34
    v_and_b32 v53, v12, v34
    v_lshlrev_b32 v116, 16, v42
    v_and_b32 v117, v12, v42
    v_lshlrev_b32 v54, 16, v35
    v_and_b32 v55, v12, v35
    v_lshlrev_b32 v118, 16, v43
    v_and_b32 v119, v12, v43
    v_lshlrev_b32 v56, 16, v36
    v_and_b32 v57, v12, v36
    v_lshlrev_b32 v120, 16, v44
    v_and_b32 v121, v12, v44
    v_lshlrev_b32 v58, 16, v37
    v_and_b32 v59, v12, v37
    v_lshlrev_b32 v122, 16, v45
    v_and_b32 v123, v12, v45
    v_lshlrev_b32 v60, 16, v38
    v_and_b32 v61, v12, v38
    v_lshlrev_b32 v124, 16, v46
    v_and_b32 v125, v12, v46
    v_lshlrev_b32 v62, 16, v39
    v_and_b32 v63, v12, v39
    v_lshlrev_b32 v126, 16, v47
    v_and_b32 v127, v12, v47
    s_mov_b64 exec, s[46:47]
    v_mov_b32 v48, 0
    v_mov_b32 v112, 0
    v_mov_b32 v49, 0
    v_mov_b32 v113, 0
    v_mov_b32 v50, 0
    v_mov_b32 v114, 0
    v_mov_b32 v51, 0
    v_mov_b32 v115, 0
    v_mov_b32 v52, 0
    v_mov_b32 v116, 0
    v_mov_b32 v53, 0
    v_mov_b32 v117, 0
    v_mov_b32 v54, 0
    v_mov_b32 v118, 0
    v_mov_b32 v55, 0
    v_mov_b32 v119, 0
    v_mov_b32 v56, 0
    v_mov_b32 v120, 0
    v_mov_b32 v57, 0
    v_mov_b32 v121, 0
    v_mov_b32 v58, 0
    v_mov_b32 v122, 0
    v_mov_b32 v59, 0
    v_mov_b32 v123, 0
    v_mov_b32 v60, 0
    v_mov_b32 v124, 0
    v_mov_b32 v61, 0
    v_mov_b32 v125, 0
    v_mov_b32 v62, 0
    v_mov_b32 v126, 0
    v_mov_b32 v63, 0
    v_mov_b32 v127, 0
    s_mov_b64 exec, -1
    v_mul_f32 v48, v11, v48
    v_mul_f32 v112, v11, v112
    v_mul_f32 v49, v11, v49
    v_mul_f32 v113, v11, v113
    v_mul_f32 v50, v11, v50
    v_mul_f32 v114, v11, v114
    v_mul_f32 v51, v11, v51
    v_mul_f32 v115, v11, v115
    v_mul_f32 v52, v11, v52
    v_mul_f32 v116, v11, v116
    v_mul_f32 v53, v11, v53
    v_mul_f32 v117, v11, v117
    v_mul_f32 v54, v11, v54
    v_mul_f32 v118, v11, v118
    v_mul_f32 v55, v11, v55
    v_mul_f32 v119, v11, v119
    v_mul_f32 v56, v11, v56
    v_mul_f32 v120, v11, v120
    v_mul_f32 v57, v11, v57
    v_mul_f32 v121, v11, v121
    v_mul_f32 v58, v11, v58
    v_mul_f32 v122, v11, v122
    v_mul_f32 v59, v11, v59
    v_mul_f32 v123, v11, v123
    v_mul_f32 v60, v11, v60
    v_mul_f32 v124, v11, v124
    v_mul_f32 v61, v11, v61
    v_mul_f32 v125, v11, v125
    v_mul_f32 v62, v11, v62
    v_mul_f32 v126, v11, v126
    v_mul_f32 v63, v11, v63
    v_mul_f32 v127, v11, v127
    v_mul_f32 v16, v80, v48
    v_mul_f32 v32, v80, v112
    v_mul_f32 v17, v81, v49
    v_mul_f32 v33, v81, v113
    v_mul_f32 v18, v82, v50
    v_mul_f32 v34, v82, v114
    v_mul_f32 v19, v83, v51
    v_mul_f32 v35, v83, v115
    v_mul_f32 v20, v84, v52
    v_mul_f32 v36, v84, v116
    v_mul_f32 v21, v85, v53
    v_mul_f32 v37, v85, v117
    v_mul_f32 v22, v86, v54
    v_mul_f32 v38, v86, v118
    v_mul_f32 v23, v87, v55
    v_mul_f32 v39, v87, v119
    v_mul_f32 v24, v88, v56
    v_mul_f32 v40, v88, v120
    v_mul_f32 v25, v89, v57
    v_mul_f32 v41, v89, v121
    v_mul_f32 v26, v90, v58
    v_mul_f32 v42, v90, v122
    v_mul_f32 v27, v91, v59
    v_mul_f32 v43, v91, v123
    v_mul_f32 v28, v92, v60
    v_mul_f32 v44, v92, v124
    v_mul_f32 v29, v93, v61
    v_mul_f32 v45, v93, v125
    v_mul_f32 v30, v94, v62
    v_mul_f32 v46, v94, v126
    v_mul_f32 v31, v95, v63
    v_mul_f32 v47, v95, v127
    v_fma_f32 v16, -v96, v112, v16
    v_fmac_f32 v32, v96, v48
    v_fma_f32 v17, -v97, v113, v17
    v_fmac_f32 v33, v97, v49
    v_fma_f32 v18, -v98, v114, v18
    v_fmac_f32 v34, v98, v50
    v_fma_f32 v19, -v99, v115, v19
    v_fmac_f32 v35, v99, v51
    v_fma_f32 v20, -v100, v116, v20
    v_fmac_f32 v36, v100, v52
    v_fma_f32 v21, -v101, v117, v21
    v_fmac_f32 v37, v101, v53
    v_fma_f32 v22, -v102, v118, v22
    v_fmac_f32 v38, v102, v54
    v_fma_f32 v23, -v103, v119, v23
    v_fmac_f32 v39, v103, v55
    v_fma_f32 v24, -v104, v120, v24
    v_fmac_f32 v40, v104, v56
    v_fma_f32 v25, -v105, v121, v25
    v_fmac_f32 v41, v105, v57
    v_fma_f32 v26, -v106, v122, v26
    v_fmac_f32 v42, v106, v58
    v_fma_f32 v27, -v107, v123, v27
    v_fmac_f32 v43, v107, v59
    v_fma_f32 v28, -v108, v124, v28
    v_fmac_f32 v44, v108, v60
    v_fma_f32 v29, -v109, v125, v29
    v_fmac_f32 v45, v109, v61
    v_fma_f32 v30, -v110, v126, v30
    v_fmac_f32 v46, v110, v62
    v_fma_f32 v31, -v111, v127, v31
    v_fmac_f32 v47, v111, v63
    v_cvt_pk_f16_f32 v64, v16, v17
    v_cvt_pk_f16_f32 v72, v32, v33
    v_cvt_pk_f16_f32 v65, v18, v19
    v_cvt_pk_f16_f32 v73, v34, v35
    v_cvt_pk_f16_f32 v66, v20, v21
    v_cvt_pk_f16_f32 v74, v36, v37
    v_cvt_pk_f16_f32 v67, v22, v23
    v_cvt_pk_f16_f32 v75, v38, v39
    v_cvt_pk_f16_f32 v68, v24, v25
    v_cvt_pk_f16_f32 v76, v40, v41
    v_cvt_pk_f16_f32 v69, v26, v27
    v_cvt_pk_f16_f32 v77, v42, v43
    v_cvt_pk_f16_f32 v70, v28, v29
    v_cvt_pk_f16_f32 v78, v44, v45
    v_cvt_pk_f16_f32 v71, v30, v31
    v_cvt_pk_f16_f32 v79, v46, v47
    s_nop 1
    v_mfma_f32_16x16x32_f16 v[80:83], v[128:131], v[64:67], 0
    v_mfma_f32_16x16x32_f16 v[96:99], v[192:195], v[64:67], 0
    v_mfma_f32_16x16x32_f16 v[80:83], v[160:163], v[72:75], v[80:83]
    v_mfma_f32_16x16x32_f16 v[96:99], v[128:131], v[72:75], v[96:99]
    v_mfma_f32_16x16x32_f16 v[80:83], v[132:135], v[68:71], v[80:83]
    v_mfma_f32_16x16x32_f16 v[96:99], v[196:199], v[68:71], v[96:99]
    v_mfma_f32_16x16x32_f16 v[80:83], v[164:167], v[76:79], v[80:83]
    v_mfma_f32_16x16x32_f16 v[96:99], v[132:135], v[76:79], v[96:99]
    v_mfma_f32_16x16x32_f16 v[84:87], v[136:139], v[64:67], 0
    v_mfma_f32_16x16x32_f16 v[100:103], v[200:203], v[64:67], 0
    v_mfma_f32_16x16x32_f16 v[84:87], v[168:171], v[72:75], v[84:87]
    v_mfma_f32_16x16x32_f16 v[100:103], v[136:139], v[72:75], v[100:103]
    v_mfma_f32_16x16x32_f16 v[84:87], v[140:143], v[68:71], v[84:87]
    v_mfma_f32_16x16x32_f16 v[100:103], v[204:207], v[68:71], v[100:103]
    v_mfma_f32_16x16x32_f16 v[84:87], v[172:175], v[76:79], v[84:87]
    v_mfma_f32_16x16x32_f16 v[100:103], v[140:143], v[76:79], v[100:103]
    v_mfma_f32_16x16x32_f16 v[88:91], v[144:147], v[64:67], 0
    v_mfma_f32_16x16x32_f16 v[104:107], v[208:211], v[64:67], 0
    v_mfma_f32_16x16x32_f16 v[88:91], v[176:179], v[72:75], v[88:91]
    v_mfma_f32_16x16x32_f16 v[104:107], v[144:147], v[72:75], v[104:107]
    v_mfma_f32_16x16x32_f16 v[88:91], v[148:151], v[68:71], v[88:91]
    v_mfma_f32_16x16x32_f16 v[104:107], v[212:215], v[68:71], v[104:107]
    v_mfma_f32_16x16x32_f16 v[88:91], v[180:183], v[76:79], v[88:91]
    v_mfma_f32_16x16x32_f16 v[104:107], v[148:151], v[76:79], v[104:107]
    v_mfma_f32_16x16x32_f16 v[92:95], v[152:155], v[64:67], 0
    v_mfma_f32_16x16x32_f16 v[108:111], v[216:219], v[64:67], 0
    v_mfma_f32_16x16x32_f16 v[92:95], v[184:187], v[72:75], v[92:95]
    v_mfma_f32_16x16x32_f16 v[108:111], v[152:155], v[72:75], v[108:111]
    v_mfma_f32_16x16x32_f16 v[92:95], v[156:159], v[68:71], v[92:95]
    v_mfma_f32_16x16x32_f16 v[108:111], v[220:223], v[68:71], v[108:111]
    v_mfma_f32_16x16x32_f16 v[92:95], v[188:191], v[76:79], v[92:95]
    v_mfma_f32_16x16x32_f16 v[108:111], v[156:159], v[76:79], v[108:111]
    s_cmp_eq_u32 s40, 5
    s_cselect_b32 s38, 4, 16
    v_cmp_le_u32 vcc, s38, v4
    v_mov_b32 v12, 0x80000000
    s_lshl_b32 s36, s37, 12
    s_add_u32 s36, s36, 40960
    v_add_u32 v13, s36, v3
    v_cndmask_b32 v6, v6, v12, vcc
    s_nop 2
    v_cvt_pk_f16_f32 v16, v80, v96
    ds_write_b32 v9, v16 offset:0
    v_cvt_pk_f16_f32 v17, v81, v97
    ds_write_b32 v9, v17 offset:256
    v_cvt_pk_f16_f32 v18, v82, v98
    ds_write_b32 v9, v18 offset:512
    v_cvt_pk_f16_f32 v19, v83, v99
    ds_write_b32 v9, v19 offset:768
    v_cvt_pk_f16_f32 v20, v84, v100
    ds_write_b32 v9, v20 offset:4096
    v_cvt_pk_f16_f32 v21, v85, v101
    ds_write_b32 v9, v21 offset:4352
    v_cvt_pk_f16_f32 v22, v86, v102
    ds_write_b32 v9, v22 offset:4608
    v_cvt_pk_f16_f32 v23, v87, v103
    ds_write_b32 v9, v23 offset:4864
    v_cvt_pk_f16_f32 v24, v88, v104
    ds_write_b32 v9, v24 offset:8192
    v_cvt_pk_f16_f32 v25, v89, v105
    ds_write_b32 v9, v25 offset:8448
    v_cvt_pk_f16_f32 v26, v90, v106
    ds_write_b32 v9, v26 offset:8704
    v_cvt_pk_f16_f32 v27, v91, v107
    ds_write_b32 v9, v27 offset:8960
    v_cvt_pk_f16_f32 v28, v92, v108
    ds_write_b32 v9, v28 offset:12288
    v_cvt_pk_f16_f32 v29, v93, v109
    ds_write_b32 v9, v29 offset:12544
    v_cvt_pk_f16_f32 v30, v94, v110
    ds_write_b32 v9, v30 offset:12800
    v_cvt_pk_f16_f32 v31, v95, v111
    ds_write_b32 v9, v31 offset:13056
    s_waitcnt lgkmcnt(0)
    s_barrier
    ds_read_b128 v[32:35], v13 offset:0
    ds_read_b128 v[36:39], v13 offset:1024
    ds_read_b128 v[40:43], v13 offset:2048
    ds_read_b128 v[44:47], v13 offset:3072
    s_add_u32 s38, s41, 0
    s_waitcnt lgkmcnt(3)
    buffer_store_dwordx4 v[32:35], v6, s[16:19], s38 offen sc1
    s_add_u32 s38, s41, 5632
    s_waitcnt lgkmcnt(2)
    buffer_store_dwordx4 v[36:39], v6, s[16:19], s38 offen sc1
    s_add_u32 s38, s41, 11264
    s_waitcnt lgkmcnt(1)
    buffer_store_dwordx4 v[40:43], v6, s[16:19], s38 offen sc1
    s_add_u32 s38, s41, 16896
    s_waitcnt lgkmcnt(0)
    buffer_store_dwordx4 v[44:47], v6, s[16:19], s38 offen sc1
k2_kernel_END:
    s_endpgm
k2_kernel_RP:
    s_sub_u32 s3, s2, 192
k2_kernel_rpk:
    s_load_dwordx4 s[4:7], s[0:1], 32
    s_load_dwordx2 s[8:9], s[0:1], 48
    s_load_dwordx2 s[10:11], s[0:1], 72
    v_lshrrev_b32 v1, 6, v0
    v_and_b32 v2, 63, v0
    s_nop 0
    v_readfirstlane_b32 s33, v1
    s_lshl_b32 s34, s3, 2
    s_add_u32 s34, s34, s33
    s_add_u32 s34, s34, 480
    s_cmp_ge_u32 s34, 480
    s_cbranch_scc1 k2_kernel_rpk_down
    s_cmp_ge_u32 s34, 240
    s_cselect_b32 s35, 1, 0
    s_mul_i32 s36, s35, 240
    s_sub_u32 s34, s34, s36
    s_mul_i32 s36, s34, 5462
    s_lshr_b32 s36, s36, 16
    s_mul_i32 s37, s36, 12
    s_sub_u32 s37, s34, s37
    s_mov_b32 s38, 3072
    s_mov_b32 s46, 1024
    s_mov_b32 s47, 3
    s_lshl_b32 s40, s37, 3
    s_add_u32 s40, s40, 0
    s_mul_i32 s41, s40, 10923
    s_lshr_b32 s41, s41, 16
    s_mul_i32 s42, s41, 6
    s_sub_u32 s42, s40, s42
    s_mul_i32 s41, s41, 10
    s_lshr_b32 s43, s36, 1
    s_add_u32 s41, s41, s43
    s_lshl_b32 s41, s41, 1
    s_add_u32 s41, s41, s35
    s_lshl_b32 s41, s41, 1
    s_and_b32 s43, s36, 1
    s_add_u32 s41, s41, s43
    s_mul_i32 s41, s41, 6
    s_add_u32 s41, s41, s42
    s_lshl_b32 s50, s41, 10
    s_lshl_b32 s40, s37, 3
    s_add_u32 s40, s40, 1
    s_mul_i32 s41, s40, 10923
    s_lshr_b32 s41, s41, 16
    s_mul_i32 s42, s41, 6
    s_sub_u32 s42, s40, s42
    s_mul_i32 s41, s41, 10
    s_lshr_b32 s43, s36, 1
    s_add_u32 s41, s41, s43
    s_lshl_b32 s41, s41, 1
    s_add_u32 s41, s41, s35
    s_lshl_b32 s41, s41, 1
    s_and_b32 s43, s36, 1
    s_add_u32 s41, s41, s43
    s_mul_i32 s41, s41, 6
    s_add_u32 s41, s41, s42
    s_lshl_b32 s51, s41, 10
    s_lshl_b32 s40, s37, 3
    s_add_u32 s40, s40, 2
    s_mul_i32 s41, s40, 10923
    s_lshr_b32 s41, s41, 16
    s_mul_i32 s42, s41, 6
    s_sub_u32 s42, s40, s42
    s_mul_i32 s41, s41, 10
    s_lshr_b32 s43, s36, 1
    s_add_u32 s41, s41, s43
    s_lshl_b32 s41, s41, 1
    s_add_u32 s41, s41, s35
    s_lshl_b32 s41, s41, 1
    s_and_b32 s43, s36, 1
    s_add_u32 s41, s41, s43
    s_mul_i32 s41, s41, 6
    s_add_u32 s41, s41, s42
    s_lshl_b32 s52, s41, 10
    s_lshl_b32 s40, s37, 3
    s_add_u32 s40, s40, 3
    s_mul_i32 s41, s40, 10923
    s_lshr_b32 s41, s41, 16
    s_mul_i32 s42, s41, 6
    s_sub_u32 s42, s40, s42
    s_mul_i32 s41, s41, 10
    s_lshr_b32 s43, s36, 1
    s_add_u32 s41, s41, s43
    s_lshl_b32 s41, s41, 1
    s_add_u32 s41, s41, s35
    s_lshl_b32 s41, s41, 1
    s_and_b32 s43, s36, 1
    s_add_u32 s41, s41, s43
    s_mul_i32 s41, s41, 6
    s_add_u32 s41, s41, s42
    s_lshl_b32 s53, s41, 10
    s_lshl_b32 s40, s37, 3
    s_add_u32 s40, s40, 4
    s_mul_i32 s41, s40, 10923
    s_lshr_b32 s41, s41, 16
    s_mul_i32 s42, s41, 6
    s_sub_u32 s42, s40, s42
    s_mul_i32 s41, s41, 10
    s_lshr_b32 s43, s36, 1
    s_add_u32 s41, s41, s43
    s_lshl_b32 s41, s41, 1
    s_add_u32 s41, s41, s35
    s_lshl_b32 s41, s41, 1
    s_and_b32 s43, s36, 1
    s_add_u32 s41, s41, s43
    s_mul_i32 s41, s41, 6
    s_add_u32 s41, s41, s42
    s_lshl_b32 s54, s41, 10
    s_lshl_b32 s40, s37, 3
    s_add_u32 s40, s40, 5
    s_mul_i32 s41, s40, 10923
    s_lshr_b32 s41, s41, 16
    s_mul_i32 s42, s41, 6
    s_sub_u32 s42, s40, s42
    s_mul_i32 s41, s41, 10
    s_lshr_b32 s43, s36, 1
    s_add_u32 s41, s41, s43
    s_lshl_b32 s41, s41, 1
    s_add_u32 s41, s41, s35
    s_lshl_b32 s41, s41, 1
    s_and_b32 s43, s36, 1
    s_add_u32 s41, s41, s43
    s_mul_i32 s41, s41, 6
    s_add_u32 s41, s41, s42
    s_lshl_b32 s55, s41, 10
    s_lshl_b32 s40, s37, 3
    s_add_u32 s40, s40, 6
    s_mul_i32 s41, s40, 10923
    s_lshr_b32 s41, s41, 16
    s_mul_i32 s42, s41, 6
    s_sub_u32 s42, s40, s42
    s_mul_i32 s41, s41, 10
    s_lshr_b32 s43, s36, 1
    s_add_u32 s41, s41, s43
    s_lshl_b32 s41, s41, 1
    s_add_u32 s41, s41, s35
    s_lshl_b32 s41, s41, 1
    s_and_b32 s43, s36, 1
    s_add_u32 s41, s41, s43
    s_mul_i32 s41, s41, 6
    s_add_u32 s41, s41, s42
    s_lshl_b32 s56, s41, 10
    s_lshl_b32 s40, s37, 3
    s_add_u32 s40, s40, 7
    s_mul_i32 s41, s40, 10923
    s_lshr_b32 s41, s41, 16
    s_mul_i32 s42, s41, 6
    s_sub_u32 s42, s40, s42
    s_mul_i32 s41, s41, 10
    s_lshr_b32 s43, s36, 1
    s_add_u32 s41, s41, s43
    s_lshl_b32 s41, s41, 1
    s_add_u32 s41, s41, s35
    s_lshl_b32 s41, s41, 1
    s_and_b32 s43, s36, 1
    s_add_u32 s41, s41, s43
    s_mul_i32 s41, s41, 6
    s_add_u32 s41, s41, s42
    s_lshl_b32 s57, s41, 10
    s_waitcnt lgkmcnt(0)
    s_cmp_eq_u32 s35, 0
    s_cselect_b32 s12, s4, s6
    s_cselect_b32 s13, s5, s7
    s_mov_b32 s14, 1966080
    s_mov_b32 s15, 0x00020000
    s_add_u32 s16, s10, 23068672
    s_addc_u32 s17, s11, 0
    s_mov_b32 s18, 3932160
    s_mov_b32 s19, 0x00020000
    s_branch k2_kernel_rpk_go
k2_kernel_rpk_down:
    s_sub_u32 s34, s34, 480
    s_mul_i32 s36, s34, 13108
    s_lshr_b32 s36, s36, 16
    s_mul_i32 s37, s36, 5
    s_sub_u32 s37, s34, s37
    s_mov_b32 s38, 1280
    s_mov_b32 s46, 4096
    s_mov_b32 s47, 2
    s_lshl_b32 s40, s37, 3
    s_add_u32 s40, s40, 0
    s_mul_i32 s41, s40, 13108
    s_lshr_b32 s41, s41, 16
    s_mul_i32 s42, s41, 5
    s_sub_u32 s42, s40, s42
    s_mul_i32 s41, s41, 48
    s_add_u32 s41, s41, s36
    s_mul_i32 s41, s41, 5
    s_add_u32 s41, s41, s42
    s_lshl_b32 s50, s41, 10
    s_lshl_b32 s40, s37, 3
    s_add_u32 s40, s40, 1
    s_mul_i32 s41, s40, 13108
    s_lshr_b32 s41, s41, 16
    s_mul_i32 s42, s41, 5
    s_sub_u32 s42, s40, s42
    s_mul_i32 s41, s41, 48
    s_add_u32 s41, s41, s36
    s_mul_i32 s41, s41, 5
    s_add_u32 s41, s41, s42
    s_lshl_b32 s51, s41, 10
    s_lshl_b32 s40, s37, 3
    s_add_u32 s40, s40, 2
    s_mul_i32 s41, s40, 13108
    s_lshr_b32 s41, s41, 16
    s_mul_i32 s42, s41, 5
    s_sub_u32 s42, s40, s42
    s_mul_i32 s41, s41, 48
    s_add_u32 s41, s41, s36
    s_mul_i32 s41, s41, 5
    s_add_u32 s41, s41, s42
    s_lshl_b32 s52, s41, 10
    s_lshl_b32 s40, s37, 3
    s_add_u32 s40, s40, 3
    s_mul_i32 s41, s40, 13108
    s_lshr_b32 s41, s41, 16
    s_mul_i32 s42, s41, 5
    s_sub_u32 s42, s40, s42
    s_mul_i32 s41, s41, 48
    s_add_u32 s41, s41, s36
    s_mul_i32 s41, s41, 5
    s_add_u32 s41, s41, s42
    s_lshl_b32 s53, s41, 10
    s_lshl_b32 s40, s37, 3
    s_add_u32 s40, s40, 4
    s_mul_i32 s41, s40, 13108
    s_lshr_b32 s41, s41, 16
    s_mul_i32 s42, s41, 5
    s_sub_u32 s42, s40, s42
    s_mul_i32 s41, s41, 48
    s_add_u32 s41, s41, s36
    s_mul_i32 s41, s41, 5
    s_add_u32 s41, s41, s42
    s_lshl_b32 s54, s41, 10
    s_lshl_b32 s40, s37, 3
    s_add_u32 s40, s40, 5
    s_mul_i32 s41, s40, 13108
    s_lshr_b32 s41, s41, 16
    s_mul_i32 s42, s41, 5
    s_sub_u32 s42, s40, s42
    s_mul_i32 s41, s41, 48
    s_add_u32 s41, s41, s36
    s_mul_i32 s41, s41, 5
    s_add_u32 s41, s41, s42
    s_lshl_b32 s55, s41, 10
    s_lshl_b32 s40, s37, 3
    s_add_u32 s40, s40, 6
    s_mul_i32 s41, s40, 13108
    s_lshr_b32 s41, s41, 16
    s_mul_i32 s42, s41, 5
    s_sub_u32 s42, s40, s42
    s_mul_i32 s41, s41, 48
    s_add_u32 s41, s41, s36
    s_mul_i32 s41, s41, 5
    s_add_u32 s41, s41, s42
    s_lshl_b32 s56, s41, 10
    s_lshl_b32 s40, s37, 3
    s_add_u32 s40, s40, 7
    s_mul_i32 s41, s40, 13108
    s_lshr_b32 s41, s41, 16
    s_mul_i32 s42, s41, 5
    s_sub_u32 s42, s40, s42
    s_mul_i32 s41, s41, 48
    s_add_u32 s41, s41, s36
    s_mul_i32 s41, s41, 5
    s_add_u32 s41, s41, s42
    s_lshl_b32 s57, s41, 10
    s_waitcnt lgkmcnt(0)
    s_mov_b32 s12, s8
    s_mov_b32 s13, s9
    s_mov_b32 s14, 1966080
    s_mov_b32 s15, 0x00020000
    s_add_u32 s16, s10, 27262976
    s_addc_u32 s17, s11, 0
    s_mov_b32 s18, 1966080
    s_mov_b32 s19, 0x00020000
k2_kernel_rpk_go:
    v_lshrrev_b32 v3, 4, v2
    v_mul_lo_u32 v3, v3, s38
    v_and_b32 v4, 15, v2
    v_lshl_add_u32 v3, v4, 4, v3
    s_lshl_b32 s40, s36, 5
    s_mul_i32 s40, s40, s38
    s_lshl_b32 s41, s37, 8
    s_add_u32 s40, s40, s41
    s_lshl_b32 s41, s38, 2
    s_lshl_b32 s42, s33, 13
    s_add_u32 m0, s42, 0
    s_nop 0
    buffer_load_dwordx4 v3, s[12:15], s40 offen lds
    s_add_u32 s40, s40, s41
    s_add_u32 m0, s42, 1024
    s_nop 0
    buffer_load_dwordx4 v3, s[12:15], s40 offen lds
    s_add_u32 s40, s40, s41
    s_add_u32 m0, s42, 2048
    s_nop 0
    buffer_load_dwordx4 v3, s[12:15], s40 offen lds
    s_add_u32 s40, s40, s41
    s_add_u32 m0, s42, 3072
    s_nop 0
    buffer_load_dwordx4 v3, s[12:15], s40 offen lds
    s_add_u32 s40, s40, s41
    s_add_u32 m0, s42, 4096
    s_nop 0
    buffer_load_dwordx4 v3, s[12:15], s40 offen lds
    s_add_u32 s40, s40, s41
    s_add_u32 m0, s42, 5120
    s_nop 0
    buffer_load_dwordx4 v3, s[12:15], s40 offen lds
    s_add_u32 s40, s40, s41
    s_add_u32 m0, s42, 6144
    s_nop 0
    buffer_load_dwordx4 v3, s[12:15], s40 offen lds
    s_add_u32 s40, s40, s41
    s_add_u32 m0, s42, 7168
    s_nop 0
    buffer_load_dwordx4 v3, s[12:15], s40 offen lds
    v_lshrrev_b32 v5, 4, v2
    v_lshlrev_b32 v5, s47, v5
    v_lshrrev_b32 v6, 2, v4
    v_add_u32 v5, v5, v6
    v_lshlrev_b32 v5, 8, v5
    v_and_b32 v6, 3, v4
    v_lshl_add_u32 v5, v6, 3, v5
    v_add_u32 v5, s42, v5
    v_add_u32 v6, s46, v5
    v_lshlrev_b32 v7, 4, v2
    s_waitcnt vmcnt(0)
    ds_read_b64_tr_b16 v[8:9], v5 offset:0
    ds_read_b64_tr_b16 v[10:11], v6 offset:0
    ds_read_b64_tr_b16 v[12:13], v5 offset:32
    ds_read_b64_tr_b16 v[14:15], v6 offset:32
    ds_read_b64_tr_b16 v[16:17], v5 offset:64
    ds_read_b64_tr_b16 v[18:19], v6 offset:64
    ds_read_b64_tr_b16 v[20:21], v5 offset:96
    ds_read_b64_tr_b16 v[22:23], v6 offset:96
    ds_read_b64_tr_b16 v[24:25], v5 offset:128
    ds_read_b64_tr_b16 v[26:27], v6 offset:128
    ds_read_b64_tr_b16 v[28:29], v5 offset:160
    ds_read_b64_tr_b16 v[30:31], v6 offset:160
    ds_read_b64_tr_b16 v[32:33], v5 offset:192
    ds_read_b64_tr_b16 v[34:35], v6 offset:192
    ds_read_b64_tr_b16 v[36:37], v5 offset:224
    ds_read_b64_tr_b16 v[38:39], v6 offset:224
    s_waitcnt lgkmcnt(14)
    buffer_store_dwordx4 v[8:11], v7, s[16:19], s50 offen
    s_waitcnt lgkmcnt(12)
    buffer_store_dwordx4 v[12:15], v7, s[16:19], s51 offen
    s_waitcnt lgkmcnt(10)
    buffer_store_dwordx4 v[16:19], v7, s[16:19], s52 offen
    s_waitcnt lgkmcnt(8)
    buffer_store_dwordx4 v[20:23], v7, s[16:19], s53 offen
    s_waitcnt lgkmcnt(6)
    buffer_store_dwordx4 v[24:27], v7, s[16:19], s54 offen
    s_waitcnt lgkmcnt(4)
    buffer_store_dwordx4 v[28:31], v7, s[16:19], s55 offen
    s_waitcnt lgkmcnt(2)
    buffer_store_dwordx4 v[32:35], v7, s[16:19], s56 offen
    s_waitcnt lgkmcnt(0)
    buffer_store_dwordx4 v[36:39], v7, s[16:19], s57 offen
    s_endpgm
    .globl k3_kernel
    .p2align 8
    .type k3_kernel,@function
k3_kernel:
    s_cmp_ge_u32 s2, 256
    s_cbranch_scc1 k3_kernel_END
    s_load_dwordx2 s[4:5], s[0:1], 0
    s_load_dwordx2 s[8:9], s[0:1], 72
    s_getpc_b64 s[90:91]
    s_add_u32 s20, s90, k3tab@rel32@lo+4
    s_addc_u32 s21, s91, k3tab@rel32@hi+12
    s_mov_b32 s22, 16384
    s_mov_b32 s23, 0x00020000
    v_lshrrev_b32 v1, 6, v0
    v_and_b32 v2, 63, v0
    s_and_b32 s34, s2, 63
    s_lshr_b32 s35, s2, 6
    v_readfirstlane_b32 s33, v1
    v_lshlrev_b32 v3, 4, v2
    s_lshl_b32 s36, s33, 11
    s_add_u32 m0, s36, 0
    s_add_u32 s37, s36, 0
    buffer_load_dwordx4 v3, s[20:23], s37 offen lds
    s_add_u32 m0, s36, 1024
    s_add_u32 s37, s36, 1024
    buffer_load_dwordx4 v3, s[20:23], s37 offen lds
    s_lshl_b32 s36, s33, 6
    v_add_u32 v8, s36, v2
    v_mul_u32_u24 v9, 47663, v8
    v_lshrrev_b32 v9, 22, v9
    v_mul_u32_u24 v10, 88, v9
    v_sub_u32 v10, v8, v10
    v_mul_u32_u24 v9, 90112, v9
    v_lshl_add_u32 v16, v10, 4, v9
    v_add_u32 v8, s36, v2
    v_add_u32 v8, 512, v8
    v_mul_u32_u24 v9, 47663, v8
    v_lshrrev_b32 v9, 22, v9
    v_mul_u32_u24 v10, 88, v9
    v_sub_u32 v10, v8, v10
    v_mul_u32_u24 v9, 90112, v9
    v_lshl_add_u32 v17, v10, 4, v9
    v_add_u32 v8, s36, v2
    v_add_u32 v8, 1024, v8
    v_mul_u32_u24 v9, 47663, v8
    v_lshrrev_b32 v9, 22, v9
    v_mul_u32_u24 v10, 88, v9
    v_sub_u32 v10, v8, v10
    v_mul_u32_u24 v9, 90112, v9
    v_lshl_add_u32 v18, v10, 4, v9
    v_add_u32 v8, s36, v2
    v_add_u32 v8, 1536, v8
    v_mul_u32_u24 v9, 47663, v8
    v_lshrrev_b32 v9, 22, v9
    v_mul_u32_u24 v10, 88, v9
    v_sub_u32 v10, v8, v10
    v_mul_u32_u24 v9, 90112, v9
    v_lshl_add_u32 v19, v10, 4, v9
    v_add_u32 v8, s36, v2
    v_add_u32 v8, 2048, v8
    v_mul_u32_u24 v9, 47663, v8
    v_lshrrev_b32 v9, 22, v9
    v_mul_u32_u24 v10, 88, v9
    v_sub_u32 v10, v8, v10
    v_mul_u32_u24 v9, 90112, v9
    v_lshl_add_u32 v20, v10, 4, v9
    v_add_u32 v8, s36, v2
    v_add_u32 v8, 2560, v8
    v_mul_u32_u24 v9, 47663, v8
    v_lshrrev_b32 v9, 22, v9
    v_mul_u32_u24 v10, 88, v9
    v_sub_u32 v10, v8, v10
    v_mul_u32_u24 v9, 90112, v9
    v_lshl_add_u32 v21, v10, 4, v9
    s_mul_i32 s37, s34, 1408
    s_lshl_b32 s36, s33, 10
    s_waitcnt lgkmcnt(0)
    s_add_u32 s16, s8, 3145728
    s_addc_u32 s17, s9, 0
    s_mov_b32 s18, 2883584
    s_mov_b32 s19, 0x00020000
    s_add_u32 m0, s36, 16384
    s_nop 0
    buffer_load_dwordx4 v16, s[16:19], s37 offen lds
    s_add_u32 m0, s36, 24576
    s_nop 0
    buffer_load_dwordx4 v17, s[16:19], s37 offen lds
    s_add_u32 m0, s36, 32768
    s_nop 0
    buffer_load_dwordx4 v18, s[16:19], s37 offen lds
    s_add_u32 m0, s36, 40960
    s_nop 0
    buffer_load_dwordx4 v19, s[16:19], s37 offen lds
    s_add_u32 m0, s36, 49152
    s_nop 0
    buffer_load_dwordx4 v20, s[16:19], s37 offen lds
    s_cmp_ge_u32 s33, 4
    s_cbranch_scc1 k3_kernel_v5
    s_add_u32 m0, s36, 57344
    s_nop 0
    buffer_load_dwordx4 v21, s[16:19], s37 offen lds
k3_kernel_v5:
    s_add_u32 s44, s8, 18878464
    s_addc_u32 s45, s9, 0
    s_load_dword s46, s[44:45], 0
    s_mov_b32 s12, s4
    s_mov_b32 s13, s5
    s_mov_b32 s14, 2621440
    s_mov_b32 s15, 0x00020000
    s_add_u32 s24, s8, 6291456
    s_addc_u32 s25, s9, 0
    s_mov_b32 s26, 2621440
    s_mov_b32 s27, 0x00020000
    s_add_u32 s28, s8, 9437184
    s_addc_u32 s29, s9, 0
    s_mov_b32 s30, 2621440
    s_mov_b32 s31, 0x00020000
    s_lshl_b32 s38, s35, 3
    s_add_u32 s38, s38, s33
    s_lshl_b32 s38, s38, 6
    s_add_u32 s38, s38, s34
    s_mul_i32 s38, s38, 1280
    v_lshlrev_b32 v6, 2, v2
    buffer_load_dword v24, v6, s[12:15], s38 offen offset:0
    buffer_load_dword v25, v6, s[12:15], s38 offen offset:256
    buffer_load_dword v26, v6, s[12:15], s38 offen offset:512
    buffer_load_dword v27, v6, s[12:15], s38 offen offset:768
    buffer_load_dword v28, v6, s[12:15], s38 offen offset:1024
    v_and_b32 v4, 15, v2
    v_lshrrev_b32 v5, 4, v2
    s_mov_b32 s40, 0x3a000000
    s_mov_b32 s41, 0x3e3504f3
    v_and_b32 v8, 7, v4
    s_lshl_b32 s36, s35, 3
    v_add_u32 v8, s36, v8
    v_lshl_add_u32 v8, v8, 6, s34
    v_cmp_lt_u32 vcc, 7, v4
    v_lshl_add_u32 v40, v5, 2, 0
    v_mul_u32_u24 v40, v40, v8
    v_and_b32 v40, 2047, v40
    v_cvt_f32_u32 v40, v40
    v_mul_f32 v40, s40, v40
    v_cos_f32 v41, v40
    v_sin_f32 v42, v40
    v_lshl_add_u32 v43, v5, 2, 1
    v_mul_u32_u24 v43, v43, v8
    v_and_b32 v43, 2047, v43
    v_cvt_f32_u32 v43, v43
    v_mul_f32 v43, s40, v43
    v_cos_f32 v44, v43
    v_sin_f32 v45, v43
    v_lshl_add_u32 v46, v5, 2, 2
    v_mul_u32_u24 v46, v46, v8
    v_and_b32 v46, 2047, v46
    v_cvt_f32_u32 v46, v46
    v_mul_f32 v46, s40, v46
    v_cos_f32 v47, v46
    v_sin_f32 v48, v46
    v_lshl_add_u32 v49, v5, 2, 3
    v_mul_u32_u24 v49, v49, v8
    v_and_b32 v49, 2047, v49
    v_cvt_f32_u32 v49, v49
    v_mul_f32 v49, s40, v49
    v_cos_f32 v50, v49
    v_sin_f32 v51, v49
    v_lshl_add_u32 v52, v5, 2, 16
    v_mul_u32_u24 v52, v52, v8
    v_and_b32 v52, 2047, v52
    v_cvt_f32_u32 v52, v52
    v_mul_f32 v52, s40, v52
    v_cos_f32 v53, v52
    v_sin_f32 v54, v52
    v_lshl_add_u32 v55, v5, 2, 17
    v_mul_u32_u24 v55, v55, v8
    v_and_b32 v55, 2047, v55
    v_cvt_f32_u32 v55, v55
    v_mul_f32 v55, s40, v55
    v_cos_f32 v56, v55
    v_sin_f32 v57, v55
    v_lshl_add_u32 v58, v5, 2, 18
    v_mul_u32_u24 v58, v58, v8
    v_and_b32 v58, 2047, v58
    v_cvt_f32_u32 v58, v58
    v_mul_f32 v58, s40, v58
    v_cos_f32 v59, v58
    v_sin_f32 v60, v58
    v_lshl_add_u32 v61, v5, 2, 19
    v_mul_u32_u24 v61, v61, v8
    v_and_b32 v61, 2047, v61
    v_cvt_f32_u32 v61, v61
    v_mul_f32 v61, s40, v61
    v_cos_f32 v62, v61
    v_sin_f32 v63, v61
    v_mul_f32 v41, s41, v41
    v_mul_f32 v42, s41, v42
    v_mul_f32 v44, s41, v44
    v_mul_f32 v45, s41, v45
    v_mul_f32 v47, s41, v47
    v_mul_f32 v48, s41, v48
    v_mul_f32 v50, s41, v50
    v_mul_f32 v51, s41, v51
    v_mul_f32 v53, s41, v53
    v_mul_f32 v54, s41, v54
    v_mul_f32 v56, s41, v56
    v_mul_f32 v57, s41, v57
    v_mul_f32 v59, s41, v59
    v_mul_f32 v60, s41, v60
    v_mul_f32 v62, s41, v62
    v_mul_f32 v63, s41, v63
    v_cvt_pk_f16_f32 v40, v41, -v42
    v_cvt_pk_f16_f32 v41, v42, v41
    v_cvt_pk_f16_f32 v43, v44, -v45
    v_cvt_pk_f16_f32 v44, v45, v44
    v_cvt_pk_f16_f32 v46, v47, -v48
    v_cvt_pk_f16_f32 v47, v48, v47
    v_cvt_pk_f16_f32 v49, v50, -v51
    v_cvt_pk_f16_f32 v50, v51, v50
    v_cvt_pk_f16_f32 v52, v53, -v54
    v_cvt_pk_f16_f32 v53, v54, v53
    v_cvt_pk_f16_f32 v55, v56, -v57
    v_cvt_pk_f16_f32 v56, v57, v56
    v_cvt_pk_f16_f32 v58, v59, -v60
    v_cvt_pk_f16_f32 v59, v60, v59
    v_cvt_pk_f16_f32 v61, v62, -v63
    v_cvt_pk_f16_f32 v62, v63, v62
    v_cndmask_b32 v32, v40, v41, vcc
    v_cndmask_b32 v33, v43, v44, vcc
    v_cndmask_b32 v34, v46, v47, vcc
    v_cndmask_b32 v35, v49, v50, vcc
    v_cndmask_b32 v36, v52, v53, vcc
    v_cndmask_b32 v37, v55, v56, vcc
    v_cndmask_b32 v38, v58, v59, vcc
    v_cndmask_b32 v39, v61, v62, vcc
    s_cmp_eq_u32 s33, 7
    s_cbranch_scc0 k3_kernel_nz
    v_mul_u32_u24 v8, 21846, v2
    v_lshrrev_b32 v8, 16, v8
    v_mul_u32_u24 v9, 3, v8
    v_sub_u32 v9, v2, v9
    v_lshrrev_b32 v10, 1, v8
    v_mul_u32_u24 v10, 1552, v10
    v_and_b32 v8, 1, v8
    v_mul_u32_u24 v8, 768, v8
    v_add_u32 v10, v10, v8
    v_lshl_add_u32 v10, v9, 5, v10
    v_mov_b32 v12, 0
    v_mov_b32 v13, 0
    v_mov_b32 v14, 0
    v_mov_b32 v15, 0
    v_cmp_gt_u32 vcc, 48, v2
    s_and_saveexec_b64 s[42:43], vcc
    ds_write_b128 v10, v[12:15] offset:62112
    ds_write_b128 v10, v[12:15] offset:62128
    s_mov_b64 exec, s[42:43]
k3_kernel_nz:
    v_mul_u32_u24 v8, 5632, v5
    v_lshl_add_u32 v8, v4, 2, v8
    s_lshl_b32 s36, s33, 6
    s_add_u32 s36, s36, 16384
    v_add_u32 v8, s36, v8
    v_and_b32 v9, 7, v4
    v_mul_u32_u24 v9, 1552, v9
    v_lshrrev_b32 v10, 3, v4
    v_mul_u32_u24 v10, 768, v10
    v_add_u32 v9, v9, v10
    v_lshl_add_u32 v9, v5, 3, v9
    s_lshl_b32 s36, s33, 5
    s_add_u32 s36, s36, 61440
    v_add_u32 v9, s36, v9
    s_waitcnt vmcnt(5) lgkmcnt(0)
    s_barrier
    s_cmp_lt_u32 s33, 5
    s_cbranch_scc0 k3_kernel_a2
    ds_read_b32 v40, v8 offset:0
    ds_read_b32 v41, v8 offset:1408
    ds_read_b32 v42, v8 offset:2816
    ds_read_b32 v43, v8 offset:4224
    ds_read_b32 v44, v8 offset:22528
    ds_read_b32 v45, v8 offset:23936
    ds_read_b32 v46, v8 offset:25344
    ds_read_b32 v47, v8 offset:26752
    ds_read_b32 v48, v8 offset:512
    ds_read_b32 v49, v8 offset:1920
    ds_read_b32 v50, v8 offset:3328
    ds_read_b32 v51, v8 offset:4736
    ds_read_b32 v52, v8 offset:23040
    ds_read_b32 v53, v8 offset:24448
    ds_read_b32 v54, v8 offset:25856
    ds_read_b32 v55, v8 offset:27264
    ds_read_b32 v56, v8 offset:1024
    ds_read_b32 v57, v8 offset:2432
    ds_read_b32 v58, v8 offset:3840
    ds_read_b32 v59, v8 offset:5248
    ds_read_b32 v60, v8 offset:23552
    ds_read_b32 v61, v8 offset:24960
    ds_read_b32 v62, v8 offset:26368
    ds_read_b32 v63, v8 offset:27776
    s_waitcnt lgkmcnt(8)
    s_waitcnt lgkmcnt(8)
    v_mfma_f32_16x16x32_f16 v[64:67], v[40:43], v[32:35], 0
    v_mfma_f32_16x16x32_f16 v[64:67], v[44:47], v[36:39], v[64:67]
    v_mfma_f32_16x16x32_f16 v[68:71], v[48:51], v[32:35], 0
    v_mfma_f32_16x16x32_f16 v[68:71], v[52:55], v[36:39], v[68:71]
    s_waitcnt lgkmcnt(0)
    v_mfma_f32_16x16x32_f16 v[72:75], v[56:59], v[32:35], 0
    v_mfma_f32_16x16x32_f16 v[72:75], v[60:63], v[36:39], v[72:75]
    ds_read_b128 v[96:99], v3 offset:0
    ds_read_b128 v[100:103], v3 offset:1024
    ds_read_b128 v[104:107], v3 offset:2048
    ds_read_b128 v[108:111], v3 offset:3072
    ds_read_b128 v[112:115], v3 offset:4096
    ds_read_b128 v[116:119], v3 offset:5120
    ds_read_b128 v[120:123], v3 offset:6144
    ds_read_b128 v[124:127], v3 offset:7168
    v_cvt_pk_f16_f32 v64, v64, v65
    v_cvt_pk_f16_f32 v65, v66, v67
    ds_write_b64 v9, v[64:65] offset:0
    v_cvt_pk_f16_f32 v68, v68, v69
    v_cvt_pk_f16_f32 v69, v70, v71
    ds_write_b64 v9, v[68:69] offset:256
    v_cvt_pk_f16_f32 v72, v72, v73
    v_cvt_pk_f16_f32 v73, v74, v75
    ds_write_b64 v9, v[72:73] offset:512
    s_branch k3_kernel_a3
k3_kernel_a2:
    ds_read_b32 v40, v8 offset:0
    ds_read_b32 v41, v8 offset:1408
    ds_read_b32 v42, v8 offset:2816
    ds_read_b32 v43, v8 offset:4224
    ds_read_b32 v44, v8 offset:22528
    ds_read_b32 v45, v8 offset:23936
    ds_read_b32 v46, v8 offset:25344
    ds_read_b32 v47, v8 offset:26752
    ds_read_b32 v48, v8 offset:512
    ds_read_b32 v49, v8 offset:1920
    ds_read_b32 v50, v8 offset:3328
    ds_read_b32 v51, v8 offset:4736
    ds_read_b32 v52, v8 offset:23040
    ds_read_b32 v53, v8 offset:24448
    ds_read_b32 v54, v8 offset:25856
    ds_read_b32 v55, v8 offset:27264
    s_waitcnt lgkmcnt(0)
    v_mfma_f32_16x16x32_f16 v[64:67], v[40:43], v[32:35], 0
    v_mfma_f32_16x16x32_f16 v[64:67], v[44:47], v[36:39], v[64:67]
    v_mfma_f32_16x16x32_f16 v[68:71], v[48:51], v[32:35], 0
    v_mfma_f32_16x16x32_f16 v[68:71], v[52:55], v[36:39], v[68:71]
    ds_read_b128 v[96:99], v3 offset:0
    ds_read_b128 v[100:103], v3 offset:1024
    ds_read_b128 v[104:107], v3 offset:2048
    ds_read_b128 v[108:111], v3 offset:3072
    ds_read_b128 v[112:115], v3 offset:4096
    ds_read_b128 v[116:119], v3 offset:5120
    ds_read_b128 v[120:123], v3 offset:6144
    ds_read_b128 v[124:127], v3 offset:7168
    s_nop 1
    v_cvt_pk_f16_f32 v64, v64, v65
    v_cvt_pk_f16_f32 v65, v66, v67
    ds_write_b64 v9, v[64:65] offset:0
    v_cvt_pk_f16_f32 v68, v68, v69
    v_cvt_pk_f16_f32 v69, v70, v71
    ds_write_b64 v9, v[68:69] offset:256
k3_kernel_a3:
    ds_read_b128 v[128:131], v3 offset:8192
    ds_read_b128 v[132:135], v3 offset:9216
    ds_read_b128 v[136:139], v3 offset:10240
    ds_read_b128 v[140:143], v3 offset:11264
    ds_read_b128 v[144:147], v3 offset:12288
    ds_read_b128 v[148:151], v3 offset:13312
    ds_read_b128 v[152:155], v3 offset:14336
    ds_read_b128 v[156:159], v3 offset:15360
    v_min_u32 v10, 2, v5
    v_lshlrev_b32 v10, 2, v10
    v_lshrrev_b32 v11, 2, v4
    v_add_u32 v10, v10, v11
    v_lshlrev_b32 v10, 6, v10
    v_and_b32 v11, 3, v4
    v_lshl_add_u32 v10, v11, 3, v10
    s_mul_i32 s36, s33, 1552
    s_add_u32 s36, s36, 61440
    v_add_u32 v10, s36, v10
    v_mul_u32_u24 v11, 160, v5
    v_lshl_add_u32 v11, v4, 1, v11
    s_mul_i32 s36, s33, 1296
    s_add_u32 s36, s36, 73856
    v_add_u32 v11, s36, v11
    v_add_u32 v7, s36, v6
    s_waitcnt lgkmcnt(0)
    s_barrier
    ds_read_b64_tr_b16 v[40:41], v10 offset:0
    ds_read_b64_tr_b16 v[42:43], v10 offset:768
    ds_read_b64_tr_b16 v[44:45], v10 offset:32
    ds_read_b64_tr_b16 v[46:47], v10 offset:800
    s_waitcnt lgkmcnt(0)
    v_mfma_f32_16x16x32_f16 v[48:51], v[40:43], v[96:99], 0
    v_mfma_f32_16x16x32_f16 v[52:55], v[40:43], v[100:103], 0
    v_mfma_f32_16x16x32_f16 v[56:59], v[40:43], v[104:107], 0
    v_mfma_f32_16x16x32_f16 v[60:63], v[40:43], v[108:111], 0
    v_mfma_f32_16x16x32_f16 v[64:67], v[44:47], v[96:99], 0
    v_mfma_f32_16x16x32_f16 v[68:71], v[44:47], v[100:103], 0
    v_mfma_f32_16x16x32_f16 v[72:75], v[44:47], v[104:107], 0
    v_mfma_f32_16x16x32_f16 v[76:79], v[44:47], v[108:111], 0
    s_nop 4
    v_mul_f32 v160, v48, v128
    v_mul_f32 v161, v48, v129
    v_mul_f32 v162, v49, v130
    v_mul_f32 v163, v49, v131
    v_mul_f32 v164, v50, v132
    v_mul_f32 v165, v50, v133
    v_mul_f32 v166, v51, v134
    v_mul_f32 v167, v51, v135
    v_fma_f32 v160, -v52, v129, v160
    v_fmac_f32 v161, v52, v128
    v_fma_f32 v162, -v53, v131, v162
    v_fmac_f32 v163, v53, v130
    v_fma_f32 v164, -v54, v133, v164
    v_fmac_f32 v165, v54, v132
    v_fma_f32 v166, -v55, v135, v166
    v_fmac_f32 v167, v55, v134
    v_cvt_pk_f16_f32 v80, v160, v161
    v_cvt_pk_f16_f32 v81, v162, v163
    v_cvt_pk_f16_f32 v82, v164, v165
    v_cvt_pk_f16_f32 v83, v166, v167
    v_mul_f32 v160, v56, v136
    v_mul_f32 v161, v56, v137
    v_mul_f32 v162, v57, v138
    v_mul_f32 v163, v57, v139
    v_mul_f32 v164, v58, v140
    v_mul_f32 v165, v58, v141
    v_mul_f32 v166, v59, v142
    v_mul_f32 v167, v59, v143
    v_fma_f32 v160, -v60, v137, v160
    v_fmac_f32 v161, v60, v136
    v_fma_f32 v162, -v61, v139, v162
    v_fmac_f32 v163, v61, v138
    v_fma_f32 v164, -v62, v141, v164
    v_fmac_f32 v165, v62, v140
    v_fma_f32 v166, -v63, v143, v166
    v_fmac_f32 v167, v63, v142
    v_cvt_pk_f16_f32 v88, v160, v161
    v_cvt_pk_f16_f32 v89, v162, v163
    v_cvt_pk_f16_f32 v90, v164, v165
    v_cvt_pk_f16_f32 v91, v166, v167
    v_mul_f32 v160, v64, v144
    v_mul_f32 v161, v64, v145
    v_mul_f32 v162, v65, v146
    v_mul_f32 v163, v65, v147
    v_mul_f32 v164, v66, v148
    v_mul_f32 v165, v66, v149
    v_mul_f32 v166, v67, v150
    v_mul_f32 v167, v67, v151
    v_fma_f32 v160, -v68, v145, v160
    v_fmac_f32 v161, v68, v144
    v_fma_f32 v162, -v69, v147, v162
    v_fmac_f32 v163, v69, v146
    v_fma_f32 v164, -v70, v149, v164
    v_fmac_f32 v165, v70, v148
    v_fma_f32 v166, -v71, v151, v166
    v_fmac_f32 v167, v71, v150
    v_cvt_pk_f16_f32 v84, v160, v161
    v_cvt_pk_f16_f32 v85, v162, v163
    v_cvt_pk_f16_f32 v86, v164, v165
    v_cvt_pk_f16_f32 v87, v166, v167
    v_mul_f32 v160, v72, v152
    v_mul_f32 v161, v72, v153
    v_mul_f32 v162, v73, v154
    v_mul_f32 v163, v73, v155
    v_mul_f32 v164, v74, v156
    v_mul_f32 v165, v74, v157
    v_mul_f32 v166, v75, v158
    v_mul_f32 v167, v75, v159
    v_fma_f32 v160, -v76, v153, v160
    v_fmac_f32 v161, v76, v152
    v_fma_f32 v162, -v77, v155, v162
    v_fmac_f32 v163, v77, v154
    v_fma_f32 v164, -v78, v157, v164
    v_fmac_f32 v165, v78, v156
    v_fma_f32 v166, -v79, v159, v166
    v_fmac_f32 v167, v79, v158
    v_cvt_pk_f16_f32 v92, v160, v161
    v_cvt_pk_f16_f32 v93, v162, v163
    v_cvt_pk_f16_f32 v94, v164, v165
    v_cvt_pk_f16_f32 v95, v166, v167
    s_nop 1
    v_mfma_f32_16x16x32_f16 v[48:51], v[112:115], v[80:83], 0
    v_mfma_f32_16x16x32_f16 v[48:51], v[116:119], v[84:87], v[48:51]
    v_mfma_f32_16x16x32_f16 v[52:55], v[120:123], v[80:83], 0
    v_mfma_f32_16x16x32_f16 v[52:55], v[124:127], v[84:87], v[52:55]
    v_mfma_f32_16x16x32_f16 v[56:59], v[112:115], v[88:91], 0
    v_mfma_f32_16x16x32_f16 v[56:59], v[116:119], v[92:95], v[56:59]
    v_mfma_f32_16x16x32_f16 v[60:63], v[120:123], v[88:91], 0
    v_mfma_f32_16x16x32_f16 v[60:63], v[124:127], v[92:95], v[60:63]
    v_cmp_gt_u32 vcc, 4, v4
    v_mov_b32 v12, s46
    s_nop 5
    v_mul_f32 v48, v48, v12
    v_mul_f32 v49, v49, v12
    v_mul_f32 v50, v50, v12
    v_mul_f32 v51, v51, v12
    v_mul_f32 v52, v52, v12
    v_mul_f32 v53, v53, v12
    v_mul_f32 v54, v54, v12
    v_mul_f32 v55, v55, v12
    v_mul_f32 v56, v56, v12
    v_mul_f32 v57, v57, v12
    v_mul_f32 v58, v58, v12
    v_mul_f32 v59, v59, v12
    v_mul_f32 v60, v60, v12
    v_mul_f32 v61, v61, v12
    v_mul_f32 v62, v62, v12
    v_mul_f32 v63, v63, v12
    v_cvt_pk_bf16_f32 v48, v48, v49
    v_cvt_pk_bf16_f32 v50, v50, v51
    v_cvt_pk_bf16_f32 v52, v52, v53
    v_cvt_pk_bf16_f32 v54, v54, v55
    v_cvt_pk_bf16_f32 v56, v56, v57
    v_cvt_pk_bf16_f32 v58, v58, v59
    v_cvt_pk_bf16_f32 v60, v60, v61
    v_cvt_pk_bf16_f32 v62, v62, v63
    ds_write_b16 v11, v48 offset:0
    ds_write_b16_d16_hi v11, v48 offset:40
    ds_write_b16 v11, v50 offset:80
    ds_write_b16_d16_hi v11, v50 offset:120
    ds_write_b16 v11, v52 offset:640
    ds_write_b16_d16_hi v11, v52 offset:680
    ds_write_b16 v11, v54 offset:720
    ds_write_b16_d16_hi v11, v54 offset:760
    s_and_saveexec_b64 s[42:43], vcc
    ds_write_b16 v11, v56 offset:32
    ds_write_b16_d16_hi v11, v56 offset:72
    ds_write_b16 v11, v58 offset:112
    ds_write_b16_d16_hi v11, v58 offset:152
    ds_write_b16 v11, v60 offset:672
    ds_write_b16_d16_hi v11, v60 offset:712
    ds_write_b16 v11, v62 offset:752
    ds_write_b16_d16_hi v11, v62 offset:792
    s_mov_b64 exec, s[42:43]
    s_waitcnt lgkmcnt(0)
    ds_read_b32 v32, v7 offset:0
    ds_read_b32 v33, v7 offset:256
    ds_read_b32 v34, v7 offset:512
    ds_read_b32 v35, v7 offset:768
    ds_read_b32 v36, v7 offset:1024
    s_mov_b32 s49, 0xffff0000
    s_waitcnt vmcnt(0) lgkmcnt(0)
    v_lshlrev_b32 v40, 16, v24
    v_and_b32 v41, s49, v24
    v_lshlrev_b32 v24, 16, v32
    v_and_b32 v32, s49, v32
    v_lshlrev_b32 v42, 16, v25
    v_and_b32 v43, s49, v25
    v_lshlrev_b32 v25, 16, v33
    v_and_b32 v33, s49, v33
    v_lshlrev_b32 v44, 16, v26
    v_and_b32 v45, s49, v26
    v_lshlrev_b32 v26, 16, v34
    v_and_b32 v34, s49, v34
    v_lshlrev_b32 v46, 16, v27
    v_and_b32 v47, s49, v27
    v_lshlrev_b32 v27, 16, v35
    v_and_b32 v35, s49, v35
    v_lshlrev_b32 v48, 16, v28
    v_and_b32 v49, s49, v28
    v_lshlrev_b32 v28, 16, v36
    v_and_b32 v36, s49, v36
    v_add_f32 v40, v40, v24
    v_add_f32 v41, v41, v32
    v_add_f32 v42, v42, v25
    v_add_f32 v43, v43, v33
    v_add_f32 v44, v44, v26
    v_add_f32 v45, v45, v34
    v_add_f32 v46, v46, v27
    v_add_f32 v47, v47, v35
    v_add_f32 v48, v48, v28
    v_add_f32 v49, v49, v36
    v_cvt_pk_bf16_f32 v24, v40, v41
    v_cvt_pk_bf16_f32 v25, v42, v43
    v_cvt_pk_bf16_f32 v26, v44, v45
    v_cvt_pk_bf16_f32 v27, v46, v47
    v_cvt_pk_bf16_f32 v28, v48, v49
    buffer_store_dword v24, v6, s[24:27], s38 offen offset:0 sc1
    buffer_store_dword v25, v6, s[24:27], s38 offen offset:256 sc1
    buffer_store_dword v26, v6, s[24:27], s38 offen offset:512 sc1
    buffer_store_dword v27, v6, s[24:27], s38 offen offset:768 sc1
    buffer_store_dword v28, v6, s[24:27], s38 offen offset:1024 sc1
    v_lshlrev_b32 v40, 16, v24
    v_and_b32 v41, s49, v24
    v_lshlrev_b32 v42, 16, v25
    v_and_b32 v43, s49, v25
    v_lshlrev_b32 v44, 16, v26
    v_and_b32 v45, s49, v26
    v_lshlrev_b32 v46, 16, v27
    v_and_b32 v47, s49, v27
    v_lshlrev_b32 v48, 16, v28
    v_and_b32 v49, s49, v28
    v_add_f32 v56, v40, v41
    v_add_f32 v56, v56, v42
    v_add_f32 v56, v56, v43
    v_add_f32 v56, v56, v44
    v_add_f32 v56, v56, v45
    v_add_f32 v56, v56, v46
    v_add_f32 v56, v56, v47
    v_add_f32 v56, v56, v48
    v_add_f32 v56, v56, v49
    s_nop 1
    v_add_f32_dpp v56, v56, v56 row_ror:8 row_mask:0xf bank_mask:0xf
    s_nop 1
    v_add_f32_dpp v56, v56, v56 row_ror:4 row_mask:0xf bank_mask:0xf
    s_nop 1
    v_add_f32_dpp v56, v56, v56 row_ror:2 row_mask:0xf bank_mask:0xf
    s_nop 1
    v_add_f32_dpp v56, v56, v56 row_ror:1 row_mask:0xf bank_mask:0xf
    v_mov_b32 v57, v56
    s_nop 1
    v_permlane16_swap_b32 v57, v56
    s_nop 0
    v_add_f32 v56, v56, v57
    v_mov_b32 v57, v56
    s_nop 1
    v_permlane32_swap_b32 v57, v56
    s_nop 0
    v_add_f32 v56, v56, v57
    s_mov_b32 s82, 0x3acccccd
    v_mul_f32 v56, s82, v56
    v_cvt_pk_bf16_f32 v58, v56, v56
    v_and_b32 v58, s49, v58
    v_sub_f32 v60, v56, v58
    v_sub_f32 v40, v40, v58
    v_sub_f32 v41, v41, v58
    v_sub_f32 v42, v42, v58
    v_sub_f32 v43, v43, v58
    v_sub_f32 v44, v44, v58
    v_sub_f32 v45, v45, v58
    v_sub_f32 v46, v46, v58
    v_sub_f32 v47, v47, v58
    v_sub_f32 v48, v48, v58
    v_sub_f32 v49, v49, v58
    v_mul_f32 v59, v40, v40
    v_fmac_f32 v59, v41, v41
    v_fmac_f32 v59, v42, v42
    v_fmac_f32 v59, v43, v43
    v_fmac_f32 v59, v44, v44
    v_fmac_f32 v59, v45, v45
    v_fmac_f32 v59, v46, v46
    v_fmac_f32 v59, v47, v47
    v_fmac_f32 v59, v48, v48
    v_fmac_f32 v59, v49, v49
    s_nop 1
    v_add_f32_dpp v59, v59, v59 row_ror:8 row_mask:0xf bank_mask:0xf
    s_nop 1
    v_add_f32_dpp v59, v59, v59 row_ror:4 row_mask:0xf bank_mask:0xf
    s_nop 1
    v_add_f32_dpp v59, v59, v59 row_ror:2 row_mask:0xf bank_mask:0xf
    s_nop 1
    v_add_f32_dpp v59, v59, v59 row_ror:1 row_mask:0xf bank_mask:0xf
    v_mov_b32 v57, v59
    s_nop 1
    v_permlane16_swap_b32 v57, v59
    s_nop 0
    v_add_f32 v59, v59, v57
    v_mov_b32 v57, v59
    s_nop 1
    v_permlane32_swap_b32 v57, v59
    s_nop 0
    v_add_f32 v59, v59, v57
    s_mov_b32 s83, 0x3727c5ac
    v_mul_f32 v59, s82, v59
    v_fma_f32 v59, -v60, v60, v59
    v_max_f32 v59, 0, v59
    v_cvt_pk_bf16_f32 v59, v59, v59
    v_and_b32 v59, s49, v59
    v_add_f32 v59, s83, v59
    v_cvt_pk_bf16_f32 v59, v59, v59
    v_and_b32 v59, s49, v59
    v_sqrt_f32 v59, v59
    s_nop 0
    v_cvt_pk_bf16_f32 v59, v59, v59
    v_and_b32 v59, s49, v59
    v_rcp_f32 v61, v59
    s_nop 0
    v_cvt_pk_bf16_f32 v40, v40, v41
    v_cvt_pk_bf16_f32 v42, v42, v43
    v_cvt_pk_bf16_f32 v44, v44, v45
    v_cvt_pk_bf16_f32 v46, v46, v47
    v_cvt_pk_bf16_f32 v48, v48, v49
    v_and_b32 v41, s49, v40
    v_lshlrev_b32 v40, 16, v40
    v_and_b32 v43, s49, v42
    v_lshlrev_b32 v42, 16, v42
    v_and_b32 v45, s49, v44
    v_lshlrev_b32 v44, 16, v44
    v_and_b32 v47, s49, v46
    v_lshlrev_b32 v46, 16, v46
    v_and_b32 v49, s49, v48
    v_lshlrev_b32 v48, 16, v48
    v_mul_f32 v40, v40, v61
    v_mul_f32 v41, v41, v61
    v_mul_f32 v42, v42, v61
    v_mul_f32 v43, v43, v61
    v_mul_f32 v44, v44, v61
    v_mul_f32 v45, v45, v61
    v_mul_f32 v46, v46, v61
    v_mul_f32 v47, v47, v61
    v_mul_f32 v48, v48, v61
    v_mul_f32 v49, v49, v61
    v_cvt_pk_bf16_f32 v32, v40, v41
    v_cvt_pk_bf16_f32 v33, v42, v43
    v_cvt_pk_bf16_f32 v34, v44, v45
    v_cvt_pk_bf16_f32 v35, v46, v47
    v_cvt_pk_bf16_f32 v36, v48, v49
    buffer_store_dword v32, v6, s[28:31], s38 offen offset:0 sc1
    buffer_store_dword v33, v6, s[28:31], s38 offen offset:256 sc1
    buffer_store_dword v34, v6, s[28:31], s38 offen offset:512 sc1
    buffer_store_dword v35, v6, s[28:31], s38 offen offset:768 sc1
    buffer_store_dword v36, v6, s[28:31], s38 offen offset:1024 sc1
k3_kernel_END:
    s_endpgm
    .globl k4_kernel
    .p2align 8
    .type k4_kernel,@function
k4_kernel:
    s_cmp_ge_u32 s2, 256
    s_cbranch_scc1 k4_kernel_END
    s_load_dwordx2 s[8:9], s[0:1], 72
    v_lshrrev_b32 v1, 6, v0
    v_and_b32 v2, 63, v0
    s_and_b32 s28, s2, 7
    v_readfirstlane_b32 s33, v1
    s_lshr_b32 s29, s2, 3
    s_lshr_b32 s30, s28, 2
    s_lshl_b32 s30, s30, 3
    s_and_b32 s31, s29, 7
    s_add_u32 s30, s30, s31
    s_and_b32 s31, s28, 3
    s_lshl_b32 s31, s31, 2
    s_lshr_b32 s32, s29, 3
    s_add_u32 s31, s31, s32
    v_lshrrev_b32 v8, 3, v2
    v_and_b32 v9, 7, v2
    v_xor_b32 v9, v9, v8
    v_lshlrev_b32 v9, 4, v9
    s_lshl_b32 s34, s33, 4
    v_add_u32 v8, s34, v8
    v_mul_u32_u24 v8, 1280, v8
    v_add_u32 v3, v8, v9
    v_lshlrev_b32 v4, 4, v2
    s_and_b32 s38, s33, 3
    s_lshr_b32 s39, s33, 2
    s_mul_i32 s34, s30, 163840
    s_mul_i32 s35, s31, 245760
    s_mul_i32 s37, s33, 3072
    s_add_u32 s35, s35, s37
    s_lshl_b32 s36, s33, 11
    s_add_u32 s37, s37, 16384
    s_waitcnt lgkmcnt(0)
    s_add_u32 s12, s8, 9437184
    s_addc_u32 s13, s9, 0
    s_mov_b32 s14, 2621440
    s_mov_b32 s15, 0x00020000
    s_add_u32 s16, s8, 23068672
    s_addc_u32 s17, s9, 0
    s_mov_b32 s18, 3932160
    s_mov_b32 s19, 0x00020000
    s_add_u32 m0, s36, 0
    s_add_u32 s41, s34, 0
    buffer_load_dwordx4 v3, s[12:15], s41 offen lds
    s_add_u32 m0, s36, 1024
    s_add_u32 s41, s34, 10240
    buffer_load_dwordx4 v3, s[12:15], s41 offen lds
    s_add_u32 m0, s37, 0
    s_add_u32 s41, s35, 0
    buffer_load_dwordx4 v4, s[16:19], s41 offen lds
    s_add_u32 m0, s37, 1024
    s_add_u32 s41, s35, 1024
    buffer_load_dwordx4 v4, s[16:19], s41 offen lds
    s_add_u32 m0, s37, 2048
    s_add_u32 s41, s35, 2048
    buffer_load_dwordx4 v4, s[16:19], s41 offen lds
    s_add_u32 m0, s36, 40960
    s_add_u32 s41, s34, 128
    buffer_load_dwordx4 v3, s[12:15], s41 offen lds
    s_add_u32 m0, s36, 41984
    s_add_u32 s41, s34, 10368
    buffer_load_dwordx4 v3, s[12:15], s41 offen lds
    s_add_u32 m0, s37, 40960
    s_add_u32 s41, s35, 24576
    buffer_load_dwordx4 v4, s[16:19], s41 offen lds
    s_add_u32 m0, s37, 41984
    s_add_u32 s41, s35, 25600
    buffer_load_dwordx4 v4, s[16:19], s41 offen lds
    s_add_u32 m0, s37, 43008
    s_add_u32 s41, s35, 26624
    buffer_load_dwordx4 v4, s[16:19], s41 offen lds
    s_add_u32 m0, s36, 81920
    s_add_u32 s41, s34, 256
    buffer_load_dwordx4 v3, s[12:15], s41 offen lds
    s_add_u32 m0, s36, 82944
    s_add_u32 s41, s34, 10496
    buffer_load_dwordx4 v3, s[12:15], s41 offen lds
    s_add_u32 m0, s37, 81920
    s_add_u32 s41, s35, 49152
    buffer_load_dwordx4 v4, s[16:19], s41 offen lds
    s_add_u32 m0, s37, 82944
    s_add_u32 s41, s35, 50176
    buffer_load_dwordx4 v4, s[16:19], s41 offen lds
    s_add_u32 m0, s37, 83968
    s_add_u32 s41, s35, 51200
    buffer_load_dwordx4 v4, s[16:19], s41 offen lds
    s_add_u32 s24, s8, 12582912
    s_addc_u32 s25, s9, 0
    s_mov_b32 s26, 6291456
    s_mov_b32 s27, 0x00020000
    v_and_b32 v8, 15, v2
    v_lshrrev_b32 v9, 4, v2
    v_and_b32 v10, 7, v8
    v_xor_b32 v10, v10, v9
    v_lshlrev_b32 v10, 4, v10
    v_lshlrev_b32 v11, 7, v8
    v_add_u32 v10, v10, v11
    s_lshl_b32 s40, s38, 12
    v_add_u32 v12, s40, v10
    v_xor_b32 v13, 64, v12
    s_mul_i32 s40, s39, 3072
    s_add_u32 s40, s40, 16384
    v_add_u32 v14, s40, v4
    v_add_u32 v16, 0, v12
    v_add_u32 v17, 0, v13
    v_add_u32 v18, 0, v14
    v_add_u32 v20, 40960, v12
    v_add_u32 v21, 40960, v13
    v_add_u32 v22, 40960, v14
    v_add_u32 v24, 81920, v12
    v_add_u32 v25, 81920, v13
    v_add_u32 v26, 81920, v14
    s_waitcnt vmcnt(10)
    s_barrier
    ds_read_b128 v[32:35], v16 offset:0
    ds_read_b128 v[36:39], v16 offset:2048
    ds_read_b128 v[40:43], v18 offset:0
    ds_read_b128 v[44:47], v18 offset:1024
    ds_read_b128 v[48:51], v18 offset:2048
    ds_read_b128 v[52:55], v18 offset:12288
    ds_read_b128 v[56:59], v18 offset:13312
    ds_read_b128 v[60:63], v18 offset:14336
    ds_read_b128 v[64:67], v17 offset:0
    ds_read_b128 v[68:71], v17 offset:2048
    ds_read_b128 v[72:75], v18 offset:6144
    ds_read_b128 v[76:79], v18 offset:7168
    ds_read_b128 v[80:83], v18 offset:8192
    ds_read_b128 v[84:87], v18 offset:18432
    ds_read_b128 v[88:91], v18 offset:19456
    ds_read_b128 v[92:95], v18 offset:20480
    s_waitcnt vmcnt(5) lgkmcnt(0)
    s_barrier
    v_mfma_f32_16x16x32_bf16 v[176:179], v[40:43], v[32:35], 0
    ds_read_b128 v[96:99], v20 offset:0
    v_mfma_f32_16x16x32_bf16 v[180:183], v[44:47], v[32:35], 0
    ds_read_b128 v[100:103], v20 offset:2048
    v_mfma_f32_16x16x32_bf16 v[184:187], v[48:51], v[32:35], 0
    ds_read_b128 v[104:107], v22 offset:0
    v_mfma_f32_16x16x32_bf16 v[188:191], v[52:55], v[32:35], 0
    ds_read_b128 v[108:111], v22 offset:1024
    s_add_u32 m0, s36, 0
    s_add_u32 s41, s34, 384
    buffer_load_dwordx4 v3, s[12:15], s41 offen lds
    v_mfma_f32_16x16x32_bf16 v[192:195], v[56:59], v[32:35], 0
    ds_read_b128 v[112:115], v22 offset:2048
    v_mfma_f32_16x16x32_bf16 v[196:199], v[60:63], v[32:35], 0
    ds_read_b128 v[116:119], v22 offset:12288
    v_mfma_f32_16x16x32_bf16 v[200:203], v[40:43], v[36:39], 0
    ds_read_b128 v[120:123], v22 offset:13312
    v_mfma_f32_16x16x32_bf16 v[204:207], v[44:47], v[36:39], 0
    ds_read_b128 v[124:127], v22 offset:14336
    s_add_u32 m0, s36, 1024
    s_add_u32 s41, s34, 10624
    buffer_load_dwordx4 v3, s[12:15], s41 offen lds
    v_mfma_f32_16x16x32_bf16 v[208:211], v[48:51], v[36:39], 0
    ds_read_b128 v[128:131], v21 offset:0
    v_mfma_f32_16x16x32_bf16 v[212:215], v[52:55], v[36:39], 0
    ds_read_b128 v[132:135], v21 offset:2048
    v_mfma_f32_16x16x32_bf16 v[216:219], v[56:59], v[36:39], 0
    ds_read_b128 v[136:139], v22 offset:6144
    v_mfma_f32_16x16x32_bf16 v[220:223], v[60:63], v[36:39], 0
    ds_read_b128 v[140:143], v22 offset:7168
    s_add_u32 m0, s37, 0
    s_add_u32 s41, s35, 73728
    buffer_load_dwordx4 v4, s[16:19], s41 offen lds
    v_mfma_f32_16x16x32_bf16 v[176:179], v[72:75], v[64:67], v[176:179]
    ds_read_b128 v[144:147], v22 offset:8192
    v_mfma_f32_16x16x32_bf16 v[180:183], v[76:79], v[64:67], v[180:183]
    ds_read_b128 v[148:151], v22 offset:18432
    v_mfma_f32_16x16x32_bf16 v[184:187], v[80:83], v[64:67], v[184:187]
    ds_read_b128 v[152:155], v22 offset:19456
    v_mfma_f32_16x16x32_bf16 v[188:191], v[84:87], v[64:67], v[188:191]
    ds_read_b128 v[156:159], v22 offset:20480
    s_add_u32 m0, s37, 1024
    s_add_u32 s41, s35, 74752
    buffer_load_dwordx4 v4, s[16:19], s41 offen lds
    v_mfma_f32_16x16x32_bf16 v[192:195], v[88:91], v[64:67], v[192:195]
    v_mfma_f32_16x16x32_bf16 v[196:199], v[92:95], v[64:67], v[196:199]
    v_mfma_f32_16x16x32_bf16 v[200:203], v[72:75], v[68:71], v[200:203]
    v_mfma_f32_16x16x32_bf16 v[204:207], v[76:79], v[68:71], v[204:207]
    s_add_u32 m0, s37, 2048
    s_add_u32 s41, s35, 75776
    buffer_load_dwordx4 v4, s[16:19], s41 offen lds
    v_mfma_f32_16x16x32_bf16 v[208:211], v[80:83], v[68:71], v[208:211]
    v_mfma_f32_16x16x32_bf16 v[212:215], v[84:87], v[68:71], v[212:215]
    v_mfma_f32_16x16x32_bf16 v[216:219], v[88:91], v[68:71], v[216:219]
    v_mfma_f32_16x16x32_bf16 v[220:223], v[92:95], v[68:71], v[220:223]
    s_waitcnt vmcnt(5) lgkmcnt(0)
    s_barrier
    v_mfma_f32_16x16x32_bf16 v[176:179], v[104:107], v[96:99], v[176:179]
    ds_read_b128 v[32:35], v24 offset:0
    v_mfma_f32_16x16x32_bf16 v[180:183], v[108:111], v[96:99], v[180:183]
    ds_read_b128 v[36:39], v24 offset:2048
    v_mfma_f32_16x16x32_bf16 v[184:187], v[112:115], v[96:99], v[184:187]
    ds_read_b128 v[40:43], v26 offset:0
    v_mfma_f32_16x16x32_bf16 v[188:191], v[116:119], v[96:99], v[188:191]
    ds_read_b128 v[44:47], v26 offset:1024
    s_add_u32 m0, s36, 40960
    s_add_u32 s41, s34, 512
    buffer_load_dwordx4 v3, s[12:15], s41 offen lds
    v_mfma_f32_16x16x32_bf16 v[192:195], v[120:123], v[96:99], v[192:195]
    ds_read_b128 v[48:51], v26 offset:2048
    v_mfma_f32_16x16x32_bf16 v[196:199], v[124:127], v[96:99], v[196:199]
    ds_read_b128 v[52:55], v26 offset:12288
    v_mfma_f32_16x16x32_bf16 v[200:203], v[104:107], v[100:103], v[200:203]
    ds_read_b128 v[56:59], v26 offset:13312
    v_mfma_f32_16x16x32_bf16 v[204:207], v[108:111], v[100:103], v[204:207]
    ds_read_b128 v[60:63], v26 offset:14336
    s_add_u32 m0, s36, 41984
    s_add_u32 s41, s34, 10752
    buffer_load_dwordx4 v3, s[12:15], s41 offen lds
    v_mfma_f32_16x16x32_bf16 v[208:211], v[112:115], v[100:103], v[208:211]
    ds_read_b128 v[64:67], v25 offset:0
    v_mfma_f32_16x16x32_bf16 v[212:215], v[116:119], v[100:103], v[212:215]
    ds_read_b128 v[68:71], v25 offset:2048
    v_mfma_f32_16x16x32_bf16 v[216:219], v[120:123], v[100:103], v[216:219]
    ds_read_b128 v[72:75], v26 offset:6144
    v_mfma_f32_16x16x32_bf16 v[220:223], v[124:127], v[100:103], v[220:223]
    ds_read_b128 v[76:79], v26 offset:7168
    s_add_u32 m0, s37, 40960
    s_add_u32 s41, s35, 98304
    buffer_load_dwordx4 v4, s[16:19], s41 offen lds
    v_mfma_f32_16x16x32_bf16 v[176:179], v[136:139], v[128:131], v[176:179]
    ds_read_b128 v[80:83], v26 offset:8192
    v_mfma_f32_16x16x32_bf16 v[180:183], v[140:143], v[128:131], v[180:183]
    ds_read_b128 v[84:87], v26 offset:18432
    v_mfma_f32_16x16x32_bf16 v[184:187], v[144:147], v[128:131], v[184:187]
    ds_read_b128 v[88:91], v26 offset:19456
    v_mfma_f32_16x16x32_bf16 v[188:191], v[148:151], v[128:131], v[188:191]
    ds_read_b128 v[92:95], v26 offset:20480
    s_add_u32 m0, s37, 41984
    s_add_u32 s41, s35, 99328
    buffer_load_dwordx4 v4, s[16:19], s41 offen lds
    v_mfma_f32_16x16x32_bf16 v[192:195], v[152:155], v[128:131], v[192:195]
    v_mfma_f32_16x16x32_bf16 v[196:199], v[156:159], v[128:131], v[196:199]
    v_mfma_f32_16x16x32_bf16 v[200:203], v[136:139], v[132:135], v[200:203]
    v_mfma_f32_16x16x32_bf16 v[204:207], v[140:143], v[132:135], v[204:207]
    s_add_u32 m0, s37, 43008
    s_add_u32 s41, s35, 100352
    buffer_load_dwordx4 v4, s[16:19], s41 offen lds
    v_mfma_f32_16x16x32_bf16 v[208:211], v[144:147], v[132:135], v[208:211]
    v_mfma_f32_16x16x32_bf16 v[212:215], v[148:151], v[132:135], v[212:215]
    v_mfma_f32_16x16x32_bf16 v[216:219], v[152:155], v[132:135], v[216:219]
    v_mfma_f32_16x16x32_bf16 v[220:223], v[156:159], v[132:135], v[220:223]
    s_waitcnt vmcnt(5) lgkmcnt(0)
    s_barrier
    v_mfma_f32_16x16x32_bf16 v[176:179], v[40:43], v[32:35], v[176:179]
    ds_read_b128 v[96:99], v16 offset:0
    v_mfma_f32_16x16x32_bf16 v[180:183], v[44:47], v[32:35], v[180:183]
    ds_read_b128 v[100:103], v16 offset:2048
    v_mfma_f32_16x16x32_bf16 v[184:187], v[48:51], v[32:35], v[184:187]
    ds_read_b128 v[104:107], v18 offset:0
    v_mfma_f32_16x16x32_bf16 v[188:191], v[52:55], v[32:35], v[188:191]
    ds_read_b128 v[108:111], v18 offset:1024
    s_add_u32 m0, s36, 81920
    s_add_u32 s41, s34, 640
    buffer_load_dwordx4 v3, s[12:15], s41 offen lds
    v_mfma_f32_16x16x32_bf16 v[192:195], v[56:59], v[32:35], v[192:195]
    ds_read_b128 v[112:115], v18 offset:2048
    v_mfma_f32_16x16x32_bf16 v[196:199], v[60:63], v[32:35], v[196:199]
    ds_read_b128 v[116:119], v18 offset:12288
    v_mfma_f32_16x16x32_bf16 v[200:203], v[40:43], v[36:39], v[200:203]
    ds_read_b128 v[120:123], v18 offset:13312
    v_mfma_f32_16x16x32_bf16 v[204:207], v[44:47], v[36:39], v[204:207]
    ds_read_b128 v[124:127], v18 offset:14336
    s_add_u32 m0, s36, 82944
    s_add_u32 s41, s34, 10880
    buffer_load_dwordx4 v3, s[12:15], s41 offen lds
    v_mfma_f32_16x16x32_bf16 v[208:211], v[48:51], v[36:39], v[208:211]
    ds_read_b128 v[128:131], v17 offset:0
    v_mfma_f32_16x16x32_bf16 v[212:215], v[52:55], v[36:39], v[212:215]
    ds_read_b128 v[132:135], v17 offset:2048
    v_mfma_f32_16x16x32_bf16 v[216:219], v[56:59], v[36:39], v[216:219]
    ds_read_b128 v[136:139], v18 offset:6144
    v_mfma_f32_16x16x32_bf16 v[220:223], v[60:63], v[36:39], v[220:223]
    ds_read_b128 v[140:143], v18 offset:7168
    s_add_u32 m0, s37, 81920
    s_add_u32 s41, s35, 122880
    buffer_load_dwordx4 v4, s[16:19], s41 offen lds
    v_mfma_f32_16x16x32_bf16 v[176:179], v[72:75], v[64:67], v[176:179]
    ds_read_b128 v[144:147], v18 offset:8192
    v_mfma_f32_16x16x32_bf16 v[180:183], v[76:79], v[64:67], v[180:183]
    ds_read_b128 v[148:151], v18 offset:18432
    v_mfma_f32_16x16x32_bf16 v[184:187], v[80:83], v[64:67], v[184:187]
    ds_read_b128 v[152:155], v18 offset:19456
    v_mfma_f32_16x16x32_bf16 v[188:191], v[84:87], v[64:67], v[188:191]
    ds_read_b128 v[156:159], v18 offset:20480
    s_add_u32 m0, s37, 82944
    s_add_u32 s41, s35, 123904
    buffer_load_dwordx4 v4, s[16:19], s41 offen lds
    v_mfma_f32_16x16x32_bf16 v[192:195], v[88:91], v[64:67], v[192:195]
    v_mfma_f32_16x16x32_bf16 v[196:199], v[92:95], v[64:67], v[196:199]
    v_mfma_f32_16x16x32_bf16 v[200:203], v[72:75], v[68:71], v[200:203]
    v_mfma_f32_16x16x32_bf16 v[204:207], v[76:79], v[68:71], v[204:207]
    s_add_u32 m0, s37, 83968
    s_add_u32 s41, s35, 124928
    buffer_load_dwordx4 v4, s[16:19], s41 offen lds
    v_mfma_f32_16x16x32_bf16 v[208:211], v[80:83], v[68:71], v[208:211]
    v_mfma_f32_16x16x32_bf16 v[212:215], v[84:87], v[68:71], v[212:215]
    v_mfma_f32_16x16x32_bf16 v[216:219], v[88:91], v[68:71], v[216:219]
    v_mfma_f32_16x16x32_bf16 v[220:223], v[92:95], v[68:71], v[220:223]
    s_waitcnt vmcnt(5) lgkmcnt(0)
    s_barrier
    v_mfma_f32_16x16x32_bf16 v[176:179], v[104:107], v[96:99], v[176:179]
    ds_read_b128 v[32:35], v20 offset:0
    v_mfma_f32_16x16x32_bf16 v[180:183], v[108:111], v[96:99], v[180:183]
    ds_read_b128 v[36:39], v20 offset:2048
    v_mfma_f32_16x16x32_bf16 v[184:187], v[112:115], v[96:99], v[184:187]
    ds_read_b128 v[40:43], v22 offset:0
    v_mfma_f32_16x16x32_bf16 v[188:191], v[116:119], v[96:99], v[188:191]
    ds_read_b128 v[44:47], v22 offset:1024
    s_add_u32 m0, s36, 0
    s_add_u32 s41, s34, 768
    buffer_load_dwordx4 v3, s[12:15], s41 offen lds
    v_mfma_f32_16x16x32_bf16 v[192:195], v[120:123], v[96:99], v[192:195]
    ds_read_b128 v[48:51], v22 offset:2048
    v_mfma_f32_16x16x32_bf16 v[196:199], v[124:127], v[96:99], v[196:199]
    ds_read_b128 v[52:55], v22 offset:12288
    v_mfma_f32_16x16x32_bf16 v[200:203], v[104:107], v[100:103], v[200:203]
    ds_read_b128 v[56:59], v22 offset:13312
    v_mfma_f32_16x16x32_bf16 v[204:207], v[108:111], v[100:103], v[204:207]
    ds_read_b128 v[60:63], v22 offset:14336
    s_add_u32 m0, s36, 1024
    s_add_u32 s41, s34, 11008
    buffer_load_dwordx4 v3, s[12:15], s41 offen lds
    v_mfma_f32_16x16x32_bf16 v[208:211], v[112:115], v[100:103], v[208:211]
    ds_read_b128 v[64:67], v21 offset:0
    v_mfma_f32_16x16x32_bf16 v[212:215], v[116:119], v[100:103], v[212:215]
    ds_read_b128 v[68:71], v21 offset:2048
    v_mfma_f32_16x16x32_bf16 v[216:219], v[120:123], v[100:103], v[216:219]
    ds_read_b128 v[72:75], v22 offset:6144
    v_mfma_f32_16x16x32_bf16 v[220:223], v[124:127], v[100:103], v[220:223]
    ds_read_b128 v[76:79], v22 offset:7168
    s_add_u32 m0, s37, 0
    s_add_u32 s41, s35, 147456
    buffer_load_dwordx4 v4, s[16:19], s41 offen lds
    v_mfma_f32_16x16x32_bf16 v[176:179], v[136:139], v[128:131], v[176:179]
    ds_read_b128 v[80:83], v22 offset:8192
    v_mfma_f32_16x16x32_bf16 v[180:183], v[140:143], v[128:131], v[180:183]
    ds_read_b128 v[84:87], v22 offset:18432
    v_mfma_f32_16x16x32_bf16 v[184:187], v[144:147], v[128:131], v[184:187]
    ds_read_b128 v[88:91], v22 offset:19456
    v_mfma_f32_16x16x32_bf16 v[188:191], v[148:151], v[128:131], v[188:191]
    ds_read_b128 v[92:95], v22 offset:20480
    s_add_u32 m0, s37, 1024
    s_add_u32 s41, s35, 148480
    buffer_load_dwordx4 v4, s[16:19], s41 offen lds
    v_mfma_f32_16x16x32_bf16 v[192:195], v[152:155], v[128:131], v[192:195]
    v_mfma_f32_16x16x32_bf16 v[196:199], v[156:159], v[128:131], v[196:199]
    v_mfma_f32_16x16x32_bf16 v[200:203], v[136:139], v[132:135], v[200:203]
    v_mfma_f32_16x16x32_bf16 v[204:207], v[140:143], v[132:135], v[204:207]
    s_add_u32 m0, s37, 2048
    s_add_u32 s41, s35, 149504
    buffer_load_dwordx4 v4, s[16:19], s41 offen lds
    v_mfma_f32_16x16x32_bf16 v[208:211], v[144:147], v[132:135], v[208:211]
    v_mfma_f32_16x16x32_bf16 v[212:215], v[148:151], v[132:135], v[212:215]
    v_mfma_f32_16x16x32_bf16 v[216:219], v[152:155], v[132:135], v[216:219]
    v_mfma_f32_16x16x32_bf16 v[220:223], v[156:159], v[132:135], v[220:223]
    s_waitcnt vmcnt(5) lgkmcnt(0)
    s_barrier
    v_mfma_f32_16x16x32_bf16 v[176:179], v[40:43], v[32:35], v[176:179]
    ds_read_b128 v[96:99], v24 offset:0
    v_mfma_f32_16x16x32_bf16 v[180:183], v[44:47], v[32:35], v[180:183]
    ds_read_b128 v[100:103], v24 offset:2048
    v_mfma_f32_16x16x32_bf16 v[184:187], v[48:51], v[32:35], v[184:187]
    ds_read_b128 v[104:107], v26 offset:0
    v_mfma_f32_16x16x32_bf16 v[188:191], v[52:55], v[32:35], v[188:191]
    ds_read_b128 v[108:111], v26 offset:1024
    s_add_u32 m0, s36, 40960
    s_add_u32 s41, s34, 896
    buffer_load_dwordx4 v3, s[12:15], s41 offen lds
    v_mfma_f32_16x16x32_bf16 v[192:195], v[56:59], v[32:35], v[192:195]
    ds_read_b128 v[112:115], v26 offset:2048
    v_mfma_f32_16x16x32_bf16 v[196:199], v[60:63], v[32:35], v[196:199]
    ds_read_b128 v[116:119], v26 offset:12288
    v_mfma_f32_16x16x32_bf16 v[200:203], v[40:43], v[36:39], v[200:203]
    ds_read_b128 v[120:123], v26 offset:13312
    v_mfma_f32_16x16x32_bf16 v[204:207], v[44:47], v[36:39], v[204:207]
    ds_read_b128 v[124:127], v26 offset:14336
    s_add_u32 m0, s36, 41984
    s_add_u32 s41, s34, 11136
    buffer_load_dwordx4 v3, s[12:15], s41 offen lds
    v_mfma_f32_16x16x32_bf16 v[208:211], v[48:51], v[36:39], v[208:211]
    ds_read_b128 v[128:131], v25 offset:0
    v_mfma_f32_16x16x32_bf16 v[212:215], v[52:55], v[36:39], v[212:215]
    ds_read_b128 v[132:135], v25 offset:2048
    v_mfma_f32_16x16x32_bf16 v[216:219], v[56:59], v[36:39], v[216:219]
    ds_read_b128 v[136:139], v26 offset:6144
    v_mfma_f32_16x16x32_bf16 v[220:223], v[60:63], v[36:39], v[220:223]
    ds_read_b128 v[140:143], v26 offset:7168
    s_add_u32 m0, s37, 40960
    s_add_u32 s41, s35, 172032
    buffer_load_dwordx4 v4, s[16:19], s41 offen lds
    v_mfma_f32_16x16x32_bf16 v[176:179], v[72:75], v[64:67], v[176:179]
    ds_read_b128 v[144:147], v26 offset:8192
    v_mfma_f32_16x16x32_bf16 v[180:183], v[76:79], v[64:67], v[180:183]
    ds_read_b128 v[148:151], v26 offset:18432
    v_mfma_f32_16x16x32_bf16 v[184:187], v[80:83], v[64:67], v[184:187]
    ds_read_b128 v[152:155], v26 offset:19456
    v_mfma_f32_16x16x32_bf16 v[188:191], v[84:87], v[64:67], v[188:191]
    ds_read_b128 v[156:159], v26 offset:20480
    s_add_u32 m0, s37, 41984
    s_add_u32 s41, s35, 173056
    buffer_load_dwordx4 v4, s[16:19], s41 offen lds
    v_mfma_f32_16x16x32_bf16 v[192:195], v[88:91], v[64:67], v[192:195]
    v_mfma_f32_16x16x32_bf16 v[196:199], v[92:95], v[64:67], v[196:199]
    v_mfma_f32_16x16x32_bf16 v[200:203], v[72:75], v[68:71], v[200:203]
    v_mfma_f32_16x16x32_bf16 v[204:207], v[76:79], v[68:71], v[204:207]
    s_add_u32 m0, s37, 43008
    s_add_u32 s41, s35, 174080
    buffer_load_dwordx4 v4, s[16:19], s41 offen lds
    v_mfma_f32_16x16x32_bf16 v[208:211], v[80:83], v[68:71], v[208:211]
    v_mfma_f32_16x16x32_bf16 v[212:215], v[84:87], v[68:71], v[212:215]
    v_mfma_f32_16x16x32_bf16 v[216:219], v[88:91], v[68:71], v[216:219]
    v_mfma_f32_16x16x32_bf16 v[220:223], v[92:95], v[68:71], v[220:223]
    s_waitcnt vmcnt(5) lgkmcnt(0)
    s_barrier
    v_mfma_f32_16x16x32_bf16 v[176:179], v[104:107], v[96:99], v[176:179]
    ds_read_b128 v[32:35], v16 offset:0
    v_mfma_f32_16x16x32_bf16 v[180:183], v[108:111], v[96:99], v[180:183]
    ds_read_b128 v[36:39], v16 offset:2048
    v_mfma_f32_16x16x32_bf16 v[184:187], v[112:115], v[96:99], v[184:187]
    ds_read_b128 v[40:43], v18 offset:0
    v_mfma_f32_16x16x32_bf16 v[188:191], v[116:119], v[96:99], v[188:191]
    ds_read_b128 v[44:47], v18 offset:1024
    s_add_u32 m0, s36, 81920
    s_add_u32 s41, s34, 1024
    buffer_load_dwordx4 v3, s[12:15], s41 offen lds
    v_mfma_f32_16x16x32_bf16 v[192:195], v[120:123], v[96:99], v[192:195]
    ds_read_b128 v[48:51], v18 offset:2048
    v_mfma_f32_16x16x32_bf16 v[196:199], v[124:127], v[96:99], v[196:199]
    ds_read_b128 v[52:55], v18 offset:12288
    v_mfma_f32_16x16x32_bf16 v[200:203], v[104:107], v[100:103], v[200:203]
    ds_read_b128 v[56:59], v18 offset:13312
    v_mfma_f32_16x16x32_bf16 v[204:207], v[108:111], v[100:103], v[204:207]
    ds_read_b128 v[60:63], v18 offset:14336
    s_add_u32 m0, s36, 82944
    s_add_u32 s41, s34, 11264
    buffer_load_dwordx4 v3, s[12:15], s41 offen lds
    v_mfma_f32_16x16x32_bf16 v[208:211], v[112:115], v[100:103], v[208:211]
    ds_read_b128 v[64:67], v17 offset:0
    v_mfma_f32_16x16x32_bf16 v[212:215], v[116:119], v[100:103], v[212:215]
    ds_read_b128 v[68:71], v17 offset:2048
    v_mfma_f32_16x16x32_bf16 v[216:219], v[120:123], v[100:103], v[216:219]
    ds_read_b128 v[72:75], v18 offset:6144
    v_mfma_f32_16x16x32_bf16 v[220:223], v[124:127], v[100:103], v[220:223]
    ds_read_b128 v[76:79], v18 offset:7168
    s_add_u32 m0, s37, 81920
    s_add_u32 s41, s35, 196608
    buffer_load_dwordx4 v4, s[16:19], s41 offen lds
    v_mfma_f32_16x16x32_bf16 v[176:179], v[136:139], v[128:131], v[176:179]
    ds_read_b128 v[80:83], v18 offset:8192
    v_mfma_f32_16x16x32_bf16 v[180:183], v[140:143], v[128:131], v[180:183]
    ds_read_b128 v[84:87], v18 offset:18432
    v_mfma_f32_16x16x32_bf16 v[184:187], v[144:147], v[128:131], v[184:187]
    ds_read_b128 v[88:91], v18 offset:19456
    v_mfma_f32_16x16x32_bf16 v[188:191], v[148:151], v[128:131], v[188:191]
    ds_read_b128 v[92:95], v18 offset:20480
    s_add_u32 m0, s37, 82944
    s_add_u32 s41, s35, 197632
    buffer_load_dwordx4 v4, s[16:19], s41 offen lds
    v_mfma_f32_16x16x32_bf16 v[192:195], v[152:155], v[128:131], v[192:195]
    v_mfma_f32_16x16x32_bf16 v[196:199], v[156:159], v[128:131], v[196:199]
    v_mfma_f32_16x16x32_bf16 v[200:203], v[136:139], v[132:135], v[200:203]
    v_mfma_f32_16x16x32_bf16 v[204:207], v[140:143], v[132:135], v[204:207]
    s_add_u32 m0, s37, 83968
    s_add_u32 s41, s35, 198656
    buffer_load_dwordx4 v4, s[16:19], s41 offen lds
    v_mfma_f32_16x16x32_bf16 v[208:211], v[144:147], v[132:135], v[208:211]
    v_mfma_f32_16x16x32_bf16 v[212:215], v[148:151], v[132:135], v[212:215]
    v_mfma_f32_16x16x32_bf16 v[216:219], v[152:155], v[132:135], v[216:219]
    v_mfma_f32_16x16x32_bf16 v[220:223], v[156:159], v[132:135], v[220:223]
    s_waitcnt vmcnt(5) lgkmcnt(0)
    s_barrier
    v_mfma_f32_16x16x32_bf16 v[176:179], v[40:43], v[32:35], v[176:179]
    ds_read_b128 v[96:99], v20 offset:0
    v_mfma_f32_16x16x32_bf16 v[180:183], v[44:47], v[32:35], v[180:183]
    ds_read_b128 v[100:103], v20 offset:2048
    v_mfma_f32_16x16x32_bf16 v[184:187], v[48:51], v[32:35], v[184:187]
    ds_read_b128 v[104:107], v22 offset:0
    v_mfma_f32_16x16x32_bf16 v[188:191], v[52:55], v[32:35], v[188:191]
    ds_read_b128 v[108:111], v22 offset:1024
    s_add_u32 m0, s36, 0
    s_add_u32 s41, s34, 1152
    buffer_load_dwordx4 v3, s[12:15], s41 offen lds
    v_mfma_f32_16x16x32_bf16 v[192:195], v[56:59], v[32:35], v[192:195]
    ds_read_b128 v[112:115], v22 offset:2048
    v_mfma_f32_16x16x32_bf16 v[196:199], v[60:63], v[32:35], v[196:199]
    ds_read_b128 v[116:119], v22 offset:12288
    v_mfma_f32_16x16x32_bf16 v[200:203], v[40:43], v[36:39], v[200:203]
    ds_read_b128 v[120:123], v22 offset:13312
    v_mfma_f32_16x16x32_bf16 v[204:207], v[44:47], v[36:39], v[204:207]
    ds_read_b128 v[124:127], v22 offset:14336
    s_add_u32 m0, s36, 1024
    s_add_u32 s41, s34, 11392
    buffer_load_dwordx4 v3, s[12:15], s41 offen lds
    v_mfma_f32_16x16x32_bf16 v[208:211], v[48:51], v[36:39], v[208:211]
    ds_read_b128 v[128:131], v21 offset:0
    v_mfma_f32_16x16x32_bf16 v[212:215], v[52:55], v[36:39], v[212:215]
    ds_read_b128 v[132:135], v21 offset:2048
    v_mfma_f32_16x16x32_bf16 v[216:219], v[56:59], v[36:39], v[216:219]
    ds_read_b128 v[136:139], v22 offset:6144
    v_mfma_f32_16x16x32_bf16 v[220:223], v[60:63], v[36:39], v[220:223]
    ds_read_b128 v[140:143], v22 offset:7168
    s_add_u32 m0, s37, 0
    s_add_u32 s41, s35, 221184
    buffer_load_dwordx4 v4, s[16:19], s41 offen lds
    v_mfma_f32_16x16x32_bf16 v[176:179], v[72:75], v[64:67], v[176:179]
    ds_read_b128 v[144:147], v22 offset:8192
    v_mfma_f32_16x16x32_bf16 v[180:183], v[76:79], v[64:67], v[180:183]
    ds_read_b128 v[148:151], v22 offset:18432
    v_mfma_f32_16x16x32_bf16 v[184:187], v[80:83], v[64:67], v[184:187]
    ds_read_b128 v[152:155], v22 offset:19456
    v_mfma_f32_16x16x32_bf16 v[188:191], v[84:87], v[64:67], v[188:191]
    ds_read_b128 v[156:159], v22 offset:20480
    s_add_u32 m0, s37, 1024
    s_add_u32 s41, s35, 222208
    buffer_load_dwordx4 v4, s[16:19], s41 offen lds
    v_mfma_f32_16x16x32_bf16 v[192:195], v[88:91], v[64:67], v[192:195]
    v_mfma_f32_16x16x32_bf16 v[196:199], v[92:95], v[64:67], v[196:199]
    v_mfma_f32_16x16x32_bf16 v[200:203], v[72:75], v[68:71], v[200:203]
    v_mfma_f32_16x16x32_bf16 v[204:207], v[76:79], v[68:71], v[204:207]
    s_add_u32 m0, s37, 2048
    s_add_u32 s41, s35, 223232
    buffer_load_dwordx4 v4, s[16:19], s41 offen lds
    v_mfma_f32_16x16x32_bf16 v[208:211], v[80:83], v[68:71], v[208:211]
    v_mfma_f32_16x16x32_bf16 v[212:215], v[84:87], v[68:71], v[212:215]
    v_mfma_f32_16x16x32_bf16 v[216:219], v[88:91], v[68:71], v[216:219]
    v_mfma_f32_16x16x32_bf16 v[220:223], v[92:95], v[68:71], v[220:223]
    s_waitcnt vmcnt(5) lgkmcnt(0)
    s_barrier
    v_mfma_f32_16x16x32_bf16 v[176:179], v[104:107], v[96:99], v[176:179]
    ds_read_b128 v[32:35], v24 offset:0
    v_mfma_f32_16x16x32_bf16 v[180:183], v[108:111], v[96:99], v[180:183]
    ds_read_b128 v[36:39], v24 offset:2048
    v_mfma_f32_16x16x32_bf16 v[184:187], v[112:115], v[96:99], v[184:187]
    ds_read_b128 v[40:43], v26 offset:0
    v_mfma_f32_16x16x32_bf16 v[188:191], v[116:119], v[96:99], v[188:191]
    ds_read_b128 v[44:47], v26 offset:1024
    v_mfma_f32_16x16x32_bf16 v[192:195], v[120:123], v[96:99], v[192:195]
    ds_read_b128 v[48:51], v26 offset:2048
    v_mfma_f32_16x16x32_bf16 v[196:199], v[124:127], v[96:99], v[196:199]
    ds_read_b128 v[52:55], v26 offset:12288
    v_mfma_f32_16x16x32_bf16 v[200:203], v[104:107], v[100:103], v[200:203]
    ds_read_b128 v[56:59], v26 offset:13312
    v_mfma_f32_16x16x32_bf16 v[204:207], v[108:111], v[100:103], v[204:207]
    ds_read_b128 v[60:63], v26 offset:14336
    v_mfma_f32_16x16x32_bf16 v[208:211], v[112:115], v[100:103], v[208:211]
    ds_read_b128 v[64:67], v25 offset:0
    v_mfma_f32_16x16x32_bf16 v[212:215], v[116:119], v[100:103], v[212:215]
    ds_read_b128 v[68:71], v25 offset:2048
    v_mfma_f32_16x16x32_bf16 v[216:219], v[120:123], v[100:103], v[216:219]
    ds_read_b128 v[72:75], v26 offset:6144
    v_mfma_f32_16x16x32_bf16 v[220:223], v[124:127], v[100:103], v[220:223]
    ds_read_b128 v[76:79], v26 offset:7168
    v_mfma_f32_16x16x32_bf16 v[176:179], v[136:139], v[128:131], v[176:179]
    ds_read_b128 v[80:83], v26 offset:8192
    v_mfma_f32_16x16x32_bf16 v[180:183], v[140:143], v[128:131], v[180:183]
    ds_read_b128 v[84:87], v26 offset:18432
    v_mfma_f32_16x16x32_bf16 v[184:187], v[144:147], v[128:131], v[184:187]
    ds_read_b128 v[88:91], v26 offset:19456
    v_mfma_f32_16x16x32_bf16 v[188:191], v[148:151], v[128:131], v[188:191]
    ds_read_b128 v[92:95], v26 offset:20480
    v_mfma_f32_16x16x32_bf16 v[192:195], v[152:155], v[128:131], v[192:195]
    v_mfma_f32_16x16x32_bf16 v[196:199], v[156:159], v[128:131], v[196:199]
    v_mfma_f32_16x16x32_bf16 v[200:203], v[136:139], v[132:135], v[200:203]
    v_mfma_f32_16x16x32_bf16 v[204:207], v[140:143], v[132:135], v[204:207]
    v_mfma_f32_16x16x32_bf16 v[208:211], v[144:147], v[132:135], v[208:211]
    v_mfma_f32_16x16x32_bf16 v[212:215], v[148:151], v[132:135], v[212:215]
    v_mfma_f32_16x16x32_bf16 v[216:219], v[152:155], v[132:135], v[216:219]
    v_mfma_f32_16x16x32_bf16 v[220:223], v[156:159], v[132:135], v[220:223]
    s_waitcnt vmcnt(0) lgkmcnt(0)
    s_barrier
    v_mfma_f32_16x16x32_bf16 v[176:179], v[40:43], v[32:35], v[176:179]
    ds_read_b128 v[96:99], v16 offset:0
    v_mfma_f32_16x16x32_bf16 v[180:183], v[44:47], v[32:35], v[180:183]
    ds_read_b128 v[100:103], v16 offset:2048
    v_mfma_f32_16x16x32_bf16 v[184:187], v[48:51], v[32:35], v[184:187]
    ds_read_b128 v[104:107], v18 offset:0
    v_mfma_f32_16x16x32_bf16 v[188:191], v[52:55], v[32:35], v[188:191]
    ds_read_b128 v[108:111], v18 offset:1024
    v_mfma_f32_16x16x32_bf16 v[192:195], v[56:59], v[32:35], v[192:195]
    ds_read_b128 v[112:115], v18 offset:2048
    v_mfma_f32_16x16x32_bf16 v[196:199], v[60:63], v[32:35], v[196:199]
    ds_read_b128 v[116:119], v18 offset:12288
    v_mfma_f32_16x16x32_bf16 v[200:203], v[40:43], v[36:39], v[200:203]
    ds_read_b128 v[120:123], v18 offset:13312
    v_mfma_f32_16x16x32_bf16 v[204:207], v[44:47], v[36:39], v[204:207]
    ds_read_b128 v[124:127], v18 offset:14336
    v_mfma_f32_16x16x32_bf16 v[208:211], v[48:51], v[36:39], v[208:211]
    ds_read_b128 v[128:131], v17 offset:0
    v_mfma_f32_16x16x32_bf16 v[212:215], v[52:55], v[36:39], v[212:215]
    ds_read_b128 v[132:135], v17 offset:2048
    v_mfma_f32_16x16x32_bf16 v[216:219], v[56:59], v[36:39], v[216:219]
    ds_read_b128 v[136:139], v18 offset:6144
    v_mfma_f32_16x16x32_bf16 v[220:223], v[60:63], v[36:39], v[220:223]
    ds_read_b128 v[140:143], v18 offset:7168
    v_mfma_f32_16x16x32_bf16 v[176:179], v[72:75], v[64:67], v[176:179]
    ds_read_b128 v[144:147], v18 offset:8192
    v_mfma_f32_16x16x32_bf16 v[180:183], v[76:79], v[64:67], v[180:183]
    ds_read_b128 v[148:151], v18 offset:18432
    v_mfma_f32_16x16x32_bf16 v[184:187], v[80:83], v[64:67], v[184:187]
    ds_read_b128 v[152:155], v18 offset:19456
    v_mfma_f32_16x16x32_bf16 v[188:191], v[84:87], v[64:67], v[188:191]
    ds_read_b128 v[156:159], v18 offset:20480
    v_mfma_f32_16x16x32_bf16 v[192:195], v[88:91], v[64:67], v[192:195]
    v_mfma_f32_16x16x32_bf16 v[196:199], v[92:95], v[64:67], v[196:199]
    v_mfma_f32_16x16x32_bf16 v[200:203], v[72:75], v[68:71], v[200:203]
    v_mfma_f32_16x16x32_bf16 v[204:207], v[76:79], v[68:71], v[204:207]
    v_mfma_f32_16x16x32_bf16 v[208:211], v[80:83], v[68:71], v[208:211]
    v_mfma_f32_16x16x32_bf16 v[212:215], v[84:87], v[68:71], v[212:215]
    v_mfma_f32_16x16x32_bf16 v[216:219], v[88:91], v[68:71], v[216:219]
    v_mfma_f32_16x16x32_bf16 v[220:223], v[92:95], v[68:71], v[220:223]
    s_waitcnt lgkmcnt(0)
    v_mfma_f32_16x16x32_bf16 v[176:179], v[104:107], v[96:99], v[176:179]
    v_mfma_f32_16x16x32_bf16 v[180:183], v[108:111], v[96:99], v[180:183]
    v_mfma_f32_16x16x32_bf16 v[184:187], v[112:115], v[96:99], v[184:187]
    v_mfma_f32_16x16x32_bf16 v[188:191], v[116:119], v[96:99], v[188:191]
    v_mfma_f32_16x16x32_bf16 v[192:195], v[120:123], v[96:99], v[192:195]
    v_mfma_f32_16x16x32_bf16 v[196:199], v[124:127], v[96:99], v[196:199]
    v_mfma_f32_16x16x32_bf16 v[200:203], v[104:107], v[100:103], v[200:203]
    v_mfma_f32_16x16x32_bf16 v[204:207], v[108:111], v[100:103], v[204:207]
    v_mfma_f32_16x16x32_bf16 v[208:211], v[112:115], v[100:103], v[208:211]
    v_mfma_f32_16x16x32_bf16 v[212:215], v[116:119], v[100:103], v[212:215]
    v_mfma_f32_16x16x32_bf16 v[216:219], v[120:123], v[100:103], v[216:219]
    v_mfma_f32_16x16x32_bf16 v[220:223], v[124:127], v[100:103], v[220:223]
    v_mfma_f32_16x16x32_bf16 v[176:179], v[136:139], v[128:131], v[176:179]
    v_mfma_f32_16x16x32_bf16 v[180:183], v[140:143], v[128:131], v[180:183]
    v_mfma_f32_16x16x32_bf16 v[184:187], v[144:147], v[128:131], v[184:187]
    v_mfma_f32_16x16x32_bf16 v[188:191], v[148:151], v[128:131], v[188:191]
    v_mfma_f32_16x16x32_bf16 v[192:195], v[152:155], v[128:131], v[192:195]
    v_mfma_f32_16x16x32_bf16 v[196:199], v[156:159], v[128:131], v[196:199]
    v_mfma_f32_16x16x32_bf16 v[200:203], v[136:139], v[132:135], v[200:203]
    v_mfma_f32_16x16x32_bf16 v[204:207], v[140:143], v[132:135], v[204:207]
    v_mfma_f32_16x16x32_bf16 v[208:211], v[144:147], v[132:135], v[208:211]
    v_mfma_f32_16x16x32_bf16 v[212:215], v[148:151], v[132:135], v[212:215]
    v_mfma_f32_16x16x32_bf16 v[216:219], v[152:155], v[132:135], v[216:219]
    v_mfma_f32_16x16x32_bf16 v[220:223], v[156:159], v[132:135], v[220:223]
    s_lshl_b32 s40, s30, 3
    s_lshl_b32 s41, s38, 1
    s_add_u32 s40, s40, s41
    s_mul_i32 s40, s40, 49152
    s_mul_i32 s41, s31, 6
    s_mul_i32 s42, s39, 3
    s_add_u32 s41, s41, s42
    s_add_u32 s42, s41, 0
    s_lshr_b32 s43, s42, 1
    s_lshl_b32 s43, s43, 10
    s_and_b32 s42, s42, 1
    s_lshl_b32 s42, s42, 3
    s_add_u32 s43, s43, s42
    s_add_u32 s46, s40, s43
    s_add_u32 s49, s46, 49152
    s_add_u32 s42, s41, 1
    s_lshr_b32 s43, s42, 1
    s_lshl_b32 s43, s43, 10
    s_and_b32 s42, s42, 1
    s_lshl_b32 s42, s42, 3
    s_add_u32 s43, s43, s42
    s_add_u32 s47, s40, s43
    s_add_u32 s50, s47, 49152
    s_add_u32 s42, s41, 2
    s_lshr_b32 s43, s42, 1
    s_lshl_b32 s43, s43, 10
    s_and_b32 s42, s42, 1
    s_lshl_b32 s42, s42, 3
    s_add_u32 s43, s43, s42
    s_add_u32 s48, s40, s43
    s_add_u32 s51, s48, 49152
    v_mov_b32 v10, 0xbdd2d3e8
    v_mov_b32 v9, 0xffff0000
    v_mov_b32 v11, 0xc0135761
    v_mov_b32 v8, 1.0
    v_cvt_pk_bf16_f32 v32, v176, v177
    v_cvt_pk_bf16_f32 v44, v188, v189
    v_cvt_pk_bf16_f32 v34, v178, v179
    v_cvt_pk_bf16_f32 v46, v190, v191
    v_cvt_pk_bf16_f32 v36, v180, v181
    v_cvt_pk_bf16_f32 v48, v192, v193
    v_cvt_pk_bf16_f32 v38, v182, v183
    v_cvt_pk_bf16_f32 v50, v194, v195
    v_cvt_pk_bf16_f32 v40, v184, v185
    v_cvt_pk_bf16_f32 v52, v196, v197
    v_cvt_pk_bf16_f32 v42, v186, v187
    v_cvt_pk_bf16_f32 v54, v198, v199
    v_and_b32 v33, v9, v32
    v_lshlrev_b32 v32, 16, v32
    v_and_b32 v35, v9, v34
    v_lshlrev_b32 v34, 16, v34
    v_and_b32 v37, v9, v36
    v_lshlrev_b32 v36, 16, v36
    v_and_b32 v39, v9, v38
    v_lshlrev_b32 v38, 16, v38
    v_and_b32 v41, v9, v40
    v_lshlrev_b32 v40, 16, v40
    v_and_b32 v43, v9, v42
    v_lshlrev_b32 v42, 16, v42
    v_mul_f32 v56, v32, v32
    v_mul_f32 v57, v33, v33
    v_mul_f32 v58, v34, v34
    v_mul_f32 v59, v35, v35
    v_mul_f32 v60, v36, v36
    v_mul_f32 v61, v37, v37
    v_mul_f32 v62, v38, v38
    v_mul_f32 v63, v39, v39
    v_mul_f32 v64, v40, v40
    v_mul_f32 v65, v41, v41
    v_mul_f32 v66, v42, v42
    v_mul_f32 v67, v43, v43
    v_fma_f32 v56, v56, v10, v11
    v_fma_f32 v57, v57, v10, v11
    v_fma_f32 v58, v58, v10, v11
    v_fma_f32 v59, v59, v10, v11
    v_fma_f32 v60, v60, v10, v11
    v_fma_f32 v61, v61, v10, v11
    v_fma_f32 v62, v62, v10, v11
    v_fma_f32 v63, v63, v10, v11
    v_fma_f32 v64, v64, v10, v11
    v_fma_f32 v65, v65, v10, v11
    v_fma_f32 v66, v66, v10, v11
    v_fma_f32 v67, v67, v10, v11
    v_mul_f32 v56, v32, v56
    v_mul_f32 v57, v33, v57
    v_mul_f32 v58, v34, v58
    v_mul_f32 v59, v35, v59
    v_mul_f32 v60, v36, v60
    v_mul_f32 v61, v37, v61
    v_mul_f32 v62, v38, v62
    v_mul_f32 v63, v39, v63
    v_mul_f32 v64, v40, v64
    v_mul_f32 v65, v41, v65
    v_mul_f32 v66, v42, v66
    v_mul_f32 v67, v43, v67
    v_exp_f32 v56, v56
    v_exp_f32 v57, v57
    v_exp_f32 v58, v58
    v_exp_f32 v59, v59
    v_exp_f32 v60, v60
    v_exp_f32 v61, v61
    v_exp_f32 v62, v62
    v_exp_f32 v63, v63
    v_exp_f32 v64, v64
    v_exp_f32 v65, v65
    v_exp_f32 v66, v66
    v_exp_f32 v67, v67
    v_and_b32 v45, v9, v44
    v_lshlrev_b32 v44, 16, v44
    v_and_b32 v47, v9, v46
    v_lshlrev_b32 v46, 16, v46
    v_and_b32 v49, v9, v48
    v_lshlrev_b32 v48, 16, v48
    v_and_b32 v51, v9, v50
    v_lshlrev_b32 v50, 16, v50
    v_and_b32 v53, v9, v52
    v_lshlrev_b32 v52, 16, v52
    v_and_b32 v55, v9, v54
    v_lshlrev_b32 v54, 16, v54
    v_add_f32 v56, v8, v56
    v_add_f32 v57, v8, v57
    v_add_f32 v58, v8, v58
    v_add_f32 v59, v8, v59
    v_add_f32 v60, v8, v60
    v_add_f32 v61, v8, v61
    v_add_f32 v62, v8, v62
    v_add_f32 v63, v8, v63
    v_add_f32 v64, v8, v64
    v_add_f32 v65, v8, v65
    v_add_f32 v66, v8, v66
    v_add_f32 v67, v8, v67
    v_rcp_f32 v56, v56
    v_rcp_f32 v57, v57
    v_rcp_f32 v58, v58
    v_rcp_f32 v59, v59
    v_rcp_f32 v60, v60
    v_rcp_f32 v61, v61
    v_rcp_f32 v62, v62
    v_rcp_f32 v63, v63
    v_rcp_f32 v64, v64
    v_rcp_f32 v65, v65
    v_rcp_f32 v66, v66
    v_rcp_f32 v67, v67
    s_nop 0
    v_mul_f32 v56, v32, v56
    v_mul_f32 v57, v33, v57
    v_mul_f32 v58, v34, v58
    v_mul_f32 v59, v35, v59
    v_mul_f32 v60, v36, v60
    v_mul_f32 v61, v37, v61
    v_mul_f32 v62, v38, v62
    v_mul_f32 v63, v39, v63
    v_mul_f32 v64, v40, v64
    v_mul_f32 v65, v41, v65
    v_mul_f32 v66, v42, v66
    v_mul_f32 v67, v43, v67
    v_cvt_pk_bf16_f32 v56, v56, v57
    v_cvt_pk_bf16_f32 v58, v58, v59
    v_cvt_pk_bf16_f32 v60, v60, v61
    v_cvt_pk_bf16_f32 v62, v62, v63
    v_cvt_pk_bf16_f32 v64, v64, v65
    v_cvt_pk_bf16_f32 v66, v66, v67
    v_and_b32 v57, v9, v56
    v_lshlrev_b32 v56, 16, v56
    v_and_b32 v59, v9, v58
    v_lshlrev_b32 v58, 16, v58
    v_and_b32 v61, v9, v60
    v_lshlrev_b32 v60, 16, v60
    v_and_b32 v63, v9, v62
    v_lshlrev_b32 v62, 16, v62
    v_and_b32 v65, v9, v64
    v_lshlrev_b32 v64, 16, v64
    v_and_b32 v67, v9, v66
    v_lshlrev_b32 v66, 16, v66
    v_mul_f32 v56, v56, v44
    v_mul_f32 v57, v57, v45
    v_mul_f32 v58, v58, v46
    v_mul_f32 v59, v59, v47
    v_mul_f32 v60, v60, v48
    v_mul_f32 v61, v61, v49
    v_mul_f32 v62, v62, v50
    v_mul_f32 v63, v63, v51
    v_mul_f32 v64, v64, v52
    v_mul_f32 v65, v65, v53
    v_mul_f32 v66, v66, v54
    v_mul_f32 v67, v67, v55
    v_cvt_pk_bf16_f32 v80, v56, v57
    v_cvt_pk_bf16_f32 v81, v58, v59
    buffer_store_dwordx2 v[80:81], v4, s[24:27], s46 offen
    v_cvt_pk_bf16_f32 v82, v60, v61
    v_cvt_pk_bf16_f32 v83, v62, v63
    buffer_store_dwordx2 v[82:83], v4, s[24:27], s47 offen
    v_cvt_pk_bf16_f32 v84, v64, v65
    v_cvt_pk_bf16_f32 v85, v66, v67
    buffer_store_dwordx2 v[84:85], v4, s[24:27], s48 offen
    v_cvt_pk_bf16_f32 v32, v200, v201
    v_cvt_pk_bf16_f32 v44, v212, v213
    v_cvt_pk_bf16_f32 v34, v202, v203
    v_cvt_pk_bf16_f32 v46, v214, v215
    v_cvt_pk_bf16_f32 v36, v204, v205
    v_cvt_pk_bf16_f32 v48, v216, v217
    v_cvt_pk_bf16_f32 v38, v206, v207
    v_cvt_pk_bf16_f32 v50, v218, v219
    v_cvt_pk_bf16_f32 v40, v208, v209
    v_cvt_pk_bf16_f32 v52, v220, v221
    v_cvt_pk_bf16_f32 v42, v210, v211
    v_cvt_pk_bf16_f32 v54, v222, v223
    v_and_b32 v33, v9, v32
    v_lshlrev_b32 v32, 16, v32
    v_and_b32 v35, v9, v34
    v_lshlrev_b32 v34, 16, v34
    v_and_b32 v37, v9, v36
    v_lshlrev_b32 v36, 16, v36
    v_and_b32 v39, v9, v38
    v_lshlrev_b32 v38, 16, v38
    v_and_b32 v41, v9, v40
    v_lshlrev_b32 v40, 16, v40
    v_and_b32 v43, v9, v42
    v_lshlrev_b32 v42, 16, v42
    v_mul_f32 v56, v32, v32
    v_mul_f32 v57, v33, v33
    v_mul_f32 v58, v34, v34
    v_mul_f32 v59, v35, v35
    v_mul_f32 v60, v36, v36
    v_mul_f32 v61, v37, v37
    v_mul_f32 v62, v38, v38
    v_mul_f32 v63, v39, v39
    v_mul_f32 v64, v40, v40
    v_mul_f32 v65, v41, v41
    v_mul_f32 v66, v42, v42
    v_mul_f32 v67, v43, v43
    v_fma_f32 v56, v56, v10, v11
    v_fma_f32 v57, v57, v10, v11
    v_fma_f32 v58, v58, v10, v11
    v_fma_f32 v59, v59, v10, v11
    v_fma_f32 v60, v60, v10, v11
    v_fma_f32 v61, v61, v10, v11
    v_fma_f32 v62, v62, v10, v11
    v_fma_f32 v63, v63, v10, v11
    v_fma_f32 v64, v64, v10, v11
    v_fma_f32 v65, v65, v10, v11
    v_fma_f32 v66, v66, v10, v11
    v_fma_f32 v67, v67, v10, v11
    v_mul_f32 v56, v32, v56
    v_mul_f32 v57, v33, v57
    v_mul_f32 v58, v34, v58
    v_mul_f32 v59, v35, v59
    v_mul_f32 v60, v36, v60
    v_mul_f32 v61, v37, v61
    v_mul_f32 v62, v38, v62
    v_mul_f32 v63, v39, v63
    v_mul_f32 v64, v40, v64
    v_mul_f32 v65, v41, v65
    v_mul_f32 v66, v42, v66
    v_mul_f32 v67, v43, v67
    v_exp_f32 v56, v56
    v_exp_f32 v57, v57
    v_exp_f32 v58, v58
    v_exp_f32 v59, v59
    v_exp_f32 v60, v60
    v_exp_f32 v61, v61
    v_exp_f32 v62, v62
    v_exp_f32 v63, v63
    v_exp_f32 v64, v64
    v_exp_f32 v65, v65
    v_exp_f32 v66, v66
    v_exp_f32 v67, v67
    v_and_b32 v45, v9, v44
    v_lshlrev_b32 v44, 16, v44
    v_and_b32 v47, v9, v46
    v_lshlrev_b32 v46, 16, v46
    v_and_b32 v49, v9, v48
    v_lshlrev_b32 v48, 16, v48
    v_and_b32 v51, v9, v50
    v_lshlrev_b32 v50, 16, v50
    v_and_b32 v53, v9, v52
    v_lshlrev_b32 v52, 16, v52
    v_and_b32 v55, v9, v54
    v_lshlrev_b32 v54, 16, v54
    v_add_f32 v56, v8, v56
    v_add_f32 v57, v8, v57
    v_add_f32 v58, v8, v58
    v_add_f32 v59, v8, v59
    v_add_f32 v60, v8, v60
    v_add_f32 v61, v8, v61
    v_add_f32 v62, v8, v62
    v_add_f32 v63, v8, v63
    v_add_f32 v64, v8, v64
    v_add_f32 v65, v8, v65
    v_add_f32 v66, v8, v66
    v_add_f32 v67, v8, v67
    v_rcp_f32 v56, v56
    v_rcp_f32 v57, v57
    v_rcp_f32 v58, v58
    v_rcp_f32 v59, v59
    v_rcp_f32 v60, v60
    v_rcp_f32 v61, v61
    v_rcp_f32 v62, v62
    v_rcp_f32 v63, v63
    v_rcp_f32 v64, v64
    v_rcp_f32 v65, v65
    v_rcp_f32 v66, v66
    v_rcp_f32 v67, v67
    s_nop 0
    v_mul_f32 v56, v32, v56
    v_mul_f32 v57, v33, v57
    v_mul_f32 v58, v34, v58
    v_mul_f32 v59, v35, v59
    v_mul_f32 v60, v36, v60
    v_mul_f32 v61, v37, v61
    v_mul_f32 v62, v38, v62
    v_mul_f32 v63, v39, v63
    v_mul_f32 v64, v40, v64
    v_mul_f32 v65, v41, v65
    v_mul_f32 v66, v42, v66
    v_mul_f32 v67, v43, v67
    v_cvt_pk_bf16_f32 v56, v56, v57
    v_cvt_pk_bf16_f32 v58, v58, v59
    v_cvt_pk_bf16_f32 v60, v60, v61
    v_cvt_pk_bf16_f32 v62, v62, v63
    v_cvt_pk_bf16_f32 v64, v64, v65
    v_cvt_pk_bf16_f32 v66, v66, v67
    v_and_b32 v57, v9, v56
    v_lshlrev_b32 v56, 16, v56
    v_and_b32 v59, v9, v58
    v_lshlrev_b32 v58, 16, v58
    v_and_b32 v61, v9, v60
    v_lshlrev_b32 v60, 16, v60
    v_and_b32 v63, v9, v62
    v_lshlrev_b32 v62, 16, v62
    v_and_b32 v65, v9, v64
    v_lshlrev_b32 v64, 16, v64
    v_and_b32 v67, v9, v66
    v_lshlrev_b32 v66, 16, v66
    v_mul_f32 v56, v56, v44
    v_mul_f32 v57, v57, v45
    v_mul_f32 v58, v58, v46
    v_mul_f32 v59, v59, v47
    v_mul_f32 v60, v60, v48
    v_mul_f32 v61, v61, v49
    v_mul_f32 v62, v62, v50
    v_mul_f32 v63, v63, v51
    v_mul_f32 v64, v64, v52
    v_mul_f32 v65, v65, v53
    v_mul_f32 v66, v66, v54
    v_mul_f32 v67, v67, v55
    v_cvt_pk_bf16_f32 v86, v56, v57
    v_cvt_pk_bf16_f32 v87, v58, v59
    buffer_store_dwordx2 v[86:87], v4, s[24:27], s49 offen
    v_cvt_pk_bf16_f32 v88, v60, v61
    v_cvt_pk_bf16_f32 v89, v62, v63
    buffer_store_dwordx2 v[88:89], v4, s[24:27], s50 offen
    v_cvt_pk_bf16_f32 v90, v64, v65
    v_cvt_pk_bf16_f32 v91, v66, v67
    buffer_store_dwordx2 v[90:91], v4, s[24:27], s51 offen
k4_kernel_END:
    s_endpgm
    .globl k5_kernel
    .p2align 8
    .type k5_kernel,@function
k5_kernel:
    s_cmp_ge_u32 s2, 256
    s_cbranch_scc1 k5_kernel_END
    s_load_dwordx2 s[6:7], s[0:1], 56
    s_load_dwordx2 s[8:9], s[0:1], 72
    v_lshrrev_b32 v1, 6, v0
    v_and_b32 v2, 63, v0
    s_and_b32 s28, s2, 7
    v_readfirstlane_b32 s33, v1
    s_lshr_b32 s29, s2, 3
    s_lshr_b32 s30, s28, 1
    s_lshl_b32 s30, s30, 3
    s_and_b32 s31, s29, 7
    s_add_u32 s30, s30, s31
    s_and_b32 s31, s28, 1
    s_lshl_b32 s31, s31, 2
    s_lshr_b32 s32, s29, 3
    s_add_u32 s31, s31, s32
    v_lshlrev_b32 v3, 4, v2
    s_mul_i32 s34, s30, 196608
    s_mul_i32 s35, s33, 12288
    s_add_u32 s34, s34, s35
    s_add_u32 s36, s33, 1
    s_and_b32 s36, s36, 3
    s_mov_b32 s44, s36
    s_mul_i32 s36, s36, 49152
    s_add_u32 s40, s34, s36
    s_add_u32 s36, s33, 2
    s_and_b32 s36, s36, 3
    s_mov_b32 s45, s36
    s_mul_i32 s36, s36, 49152
    s_add_u32 s41, s34, s36
    s_add_u32 s36, s33, 3
    s_and_b32 s36, s36, 3
    s_mov_b32 s46, s36
    s_mul_i32 s36, s36, 49152
    s_add_u32 s42, s34, s36
    s_add_u32 s36, s33, 4
    s_and_b32 s36, s36, 3
    s_mov_b32 s47, s36
    s_mul_i32 s36, s36, 49152
    s_add_u32 s43, s34, s36
    s_mul_i32 s35, s31, 245760
    s_mul_i32 s36, s33, 61440
    s_add_u32 s35, s35, s36
    s_waitcnt lgkmcnt(0)
    s_add_u32 s12, s8, 12582912
    s_addc_u32 s13, s9, 0
    s_mov_b32 s14, 6291456
    s_mov_b32 s15, 0x00020000
    s_add_u32 s16, s8, 27262976
    s_addc_u32 s17, s9, 0
    s_mov_b32 s18, 1966080
    s_mov_b32 s19, 0x00020000
    buffer_load_dwordx4 v[16:19], v3, s[12:15], s40 offen offset:0
    buffer_load_dwordx4 v[20:23], v3, s[12:15], s41 offen offset:0
    buffer_load_dwordx4 v[24:27], v3, s[12:15], s42 offen offset:0
    buffer_load_dwordx4 v[28:31], v3, s[12:15], s43 offen offset:0
    s_add_u32 s37, s35, 0
    buffer_load_dwordx4 v[32:35], v3, s[16:19], s37 offen offset:0
    buffer_load_dwordx4 v[36:39], v3, s[16:19], s37 offen offset:1024
    buffer_load_dwordx4 v[40:43], v3, s[16:19], s37 offen offset:2048
    buffer_load_dwordx4 v[44:47], v3, s[16:19], s37 offen offset:3072
    s_add_u32 s37, s35, 4096
    buffer_load_dwordx4 v[48:51], v3, s[16:19], s37 offen offset:0
    buffer_load_dwordx4 v[52:55], v3, s[12:15], s40 offen offset:1024
    buffer_load_dwordx4 v[56:59], v3, s[12:15], s41 offen offset:1024
    buffer_load_dwordx4 v[60:63], v3, s[12:15], s42 offen offset:1024
    buffer_load_dwordx4 v[64:67], v3, s[12:15], s43 offen offset:1024
    s_add_u32 s37, s35, 5120
    buffer_load_dwordx4 v[68:71], v3, s[16:19], s37 offen offset:0
    buffer_load_dwordx4 v[72:75], v3, s[16:19], s37 offen offset:1024
    buffer_load_dwordx4 v[76:79], v3, s[16:19], s37 offen offset:2048
    buffer_load_dwordx4 v[80:83], v3, s[16:19], s37 offen offset:3072
    s_add_u32 s37, s35, 9216
    buffer_load_dwordx4 v[84:87], v3, s[16:19], s37 offen offset:0
    buffer_load_dwordx4 v[88:91], v3, s[12:15], s40 offen offset:2048
    buffer_load_dwordx4 v[92:95], v3, s[12:15], s41 offen offset:2048
    buffer_load_dwordx4 v[96:99], v3, s[12:15], s42 offen offset:2048
    buffer_load_dwordx4 v[100:103], v3, s[12:15], s43 offen offset:2048
    s_add_u32 s37, s35, 10240
    buffer_load_dwordx4 v[104:107], v3, s[16:19], s37 offen offset:0
    buffer_load_dwordx4 v[108:111], v3, s[16:19], s37 offen offset:1024
    buffer_load_dwordx4 v[112:115], v3, s[16:19], s37 offen offset:2048
    buffer_load_dwordx4 v[116:119], v3, s[16:19], s37 offen offset:3072
    s_add_u32 s37, s35, 14336
    buffer_load_dwordx4 v[120:123], v3, s[16:19], s37 offen offset:0
    s_add_u32 s20, s8, 6291456
    s_addc_u32 s21, s9, 0
    s_mov_b32 s22, 2621440
    s_mov_b32 s23, 0x00020000
    s_mov_b32 s24, s6
    s_mov_b32 s25, s7
    s_mov_b32 s26, 2621440
    s_mov_b32 s27, 0x00020000
    v_and_b32 v11, 15, v2
    v_lshrrev_b32 v12, 4, v2
    s_lshl_b32 s37, s30, 6
    s_lshl_b32 s38, s33, 4
    s_add_u32 s37, s37, s38
    v_add_u32 v10, s37, v11
    v_mul_u32_u24 v10, 1280, v10
    v_lshl_add_u32 v10, v12, 3, v10
    s_mul_i32 s37, s31, 160
    v_add_u32 v10, s37, v10
    s_mul_i32 s36, s44, 15360
    s_add_u32 s36, s36, 0
    v_add_u32 v13, s36, v3
    s_mul_i32 s36, s45, 15360
    s_add_u32 s36, s36, 5120
    v_add_u32 v14, s36, v3
    s_mul_i32 s36, s46, 15360
    s_add_u32 s36, s36, 10240
    v_add_u32 v15, s36, v3
    s_mul_i32 s36, s33, 15360
    v_add_u32 v9, s36, v3
    s_waitcnt vmcnt(18)
    v_mfma_f32_16x16x32_bf16 v[160:163], v[32:35], v[16:19], 0
    v_mfma_f32_16x16x32_bf16 v[164:167], v[36:39], v[16:19], 0
    buffer_load_dwordx4 v[124:127], v3, s[12:15], s40 offen offset:3072
    v_mfma_f32_16x16x32_bf16 v[168:171], v[40:43], v[16:19], 0
    v_mfma_f32_16x16x32_bf16 v[172:175], v[44:47], v[16:19], 0
    buffer_load_dwordx4 v[128:131], v3, s[12:15], s41 offen offset:3072
    v_mfma_f32_16x16x32_bf16 v[176:179], v[48:51], v[16:19], 0
    v_mfma_f32_16x16x32_bf16 v[180:183], v[32:35], v[20:23], 0
    buffer_load_dwordx4 v[132:135], v3, s[12:15], s42 offen offset:3072
    v_mfma_f32_16x16x32_bf16 v[184:187], v[36:39], v[20:23], 0
    v_mfma_f32_16x16x32_bf16 v[188:191], v[40:43], v[20:23], 0
    buffer_load_dwordx4 v[136:139], v3, s[12:15], s43 offen offset:3072
    v_mfma_f32_16x16x32_bf16 v[192:195], v[44:47], v[20:23], 0
    v_mfma_f32_16x16x32_bf16 v[196:199], v[48:51], v[20:23], 0
    s_add_u32 s37, s35, 15360
    buffer_load_dwordx4 v[140:143], v3, s[16:19], s37 offen offset:0
    v_mfma_f32_16x16x32_bf16 v[200:203], v[32:35], v[24:27], 0
    v_mfma_f32_16x16x32_bf16 v[204:207], v[36:39], v[24:27], 0
    buffer_load_dwordx4 v[144:147], v3, s[16:19], s37 offen offset:1024
    v_mfma_f32_16x16x32_bf16 v[208:211], v[40:43], v[24:27], 0
    v_mfma_f32_16x16x32_bf16 v[212:215], v[44:47], v[24:27], 0
    buffer_load_dwordx4 v[148:151], v3, s[16:19], s37 offen offset:2048
    v_mfma_f32_16x16x32_bf16 v[216:219], v[48:51], v[24:27], 0
    v_mfma_f32_16x16x32_bf16 v[220:223], v[32:35], v[28:31], 0
    buffer_load_dwordx4 v[152:155], v3, s[16:19], s37 offen offset:3072
    v_mfma_f32_16x16x32_bf16 v[224:227], v[36:39], v[28:31], 0
    v_mfma_f32_16x16x32_bf16 v[228:231], v[40:43], v[28:31], 0
    s_add_u32 s37, s35, 19456
    buffer_load_dwordx4 v[156:159], v3, s[16:19], s37 offen offset:0
    v_mfma_f32_16x16x32_bf16 v[232:235], v[44:47], v[28:31], 0
    v_mfma_f32_16x16x32_bf16 v[236:239], v[48:51], v[28:31], 0
    s_waitcnt vmcnt(18)
    v_mfma_f32_16x16x32_bf16 v[160:163], v[68:71], v[52:55], v[160:163]
    v_mfma_f32_16x16x32_bf16 v[164:167], v[72:75], v[52:55], v[164:167]
    s_add_u32 s37, s40, 4096
    buffer_load_dwordx4 v[16:19], v3, s[12:15], s37 offen
    v_mfma_f32_16x16x32_bf16 v[168:171], v[76:79], v[52:55], v[168:171]
    v_mfma_f32_16x16x32_bf16 v[172:175], v[80:83], v[52:55], v[172:175]
    s_add_u32 s37, s41, 4096
    buffer_load_dwordx4 v[20:23], v3, s[12:15], s37 offen
    v_mfma_f32_16x16x32_bf16 v[176:179], v[84:87], v[52:55], v[176:179]
    v_mfma_f32_16x16x32_bf16 v[180:183], v[68:71], v[56:59], v[180:183]
    s_add_u32 s37, s42, 4096
    buffer_load_dwordx4 v[24:27], v3, s[12:15], s37 offen
    v_mfma_f32_16x16x32_bf16 v[184:187], v[72:75], v[56:59], v[184:187]
    v_mfma_f32_16x16x32_bf16 v[188:191], v[76:79], v[56:59], v[188:191]
    s_add_u32 s37, s43, 4096
    buffer_load_dwordx4 v[28:31], v3, s[12:15], s37 offen
    v_mfma_f32_16x16x32_bf16 v[192:195], v[80:83], v[56:59], v[192:195]
    v_mfma_f32_16x16x32_bf16 v[196:199], v[84:87], v[56:59], v[196:199]
    s_add_u32 s37, s35, 20480
    buffer_load_dwordx4 v[32:35], v3, s[16:19], s37 offen offset:0
    v_mfma_f32_16x16x32_bf16 v[200:203], v[68:71], v[60:63], v[200:203]
    v_mfma_f32_16x16x32_bf16 v[204:207], v[72:75], v[60:63], v[204:207]
    buffer_load_dwordx4 v[36:39], v3, s[16:19], s37 offen offset:1024
    v_mfma_f32_16x16x32_bf16 v[208:211], v[76:79], v[60:63], v[208:211]
    v_mfma_f32_16x16x32_bf16 v[212:215], v[80:83], v[60:63], v[212:215]
    buffer_load_dwordx4 v[40:43], v3, s[16:19], s37 offen offset:2048
    v_mfma_f32_16x16x32_bf16 v[216:219], v[84:87], v[60:63], v[216:219]
    v_mfma_f32_16x16x32_bf16 v[220:223], v[68:71], v[64:67], v[220:223]
    buffer_load_dwordx4 v[44:47], v3, s[16:19], s37 offen offset:3072
    v_mfma_f32_16x16x32_bf16 v[224:227], v[72:75], v[64:67], v[224:227]
    v_mfma_f32_16x16x32_bf16 v[228:231], v[76:79], v[64:67], v[228:231]
    s_add_u32 s37, s35, 24576
    buffer_load_dwordx4 v[48:51], v3, s[16:19], s37 offen offset:0
    v_mfma_f32_16x16x32_bf16 v[232:235], v[80:83], v[64:67], v[232:235]
    v_mfma_f32_16x16x32_bf16 v[236:239], v[84:87], v[64:67], v[236:239]
    s_waitcnt vmcnt(18)
    v_mfma_f32_16x16x32_bf16 v[160:163], v[104:107], v[88:91], v[160:163]
    v_mfma_f32_16x16x32_bf16 v[164:167], v[108:111], v[88:91], v[164:167]
    s_add_u32 s37, s40, 5120
    buffer_load_dwordx4 v[52:55], v3, s[12:15], s37 offen
    v_mfma_f32_16x16x32_bf16 v[168:171], v[112:115], v[88:91], v[168:171]
    v_mfma_f32_16x16x32_bf16 v[172:175], v[116:119], v[88:91], v[172:175]
    s_add_u32 s37, s41, 5120
    buffer_load_dwordx4 v[56:59], v3, s[12:15], s37 offen
    v_mfma_f32_16x16x32_bf16 v[176:179], v[120:123], v[88:91], v[176:179]
    v_mfma_f32_16x16x32_bf16 v[180:183], v[104:107], v[92:95], v[180:183]
    s_add_u32 s37, s42, 5120
    buffer_load_dwordx4 v[60:63], v3, s[12:15], s37 offen
    v_mfma_f32_16x16x32_bf16 v[184:187], v[108:111], v[92:95], v[184:187]
    v_mfma_f32_16x16x32_bf16 v[188:191], v[112:115], v[92:95], v[188:191]
    s_add_u32 s37, s43, 5120
    buffer_load_dwordx4 v[64:67], v3, s[12:15], s37 offen
    v_mfma_f32_16x16x32_bf16 v[192:195], v[116:119], v[92:95], v[192:195]
    v_mfma_f32_16x16x32_bf16 v[196:199], v[120:123], v[92:95], v[196:199]
    s_add_u32 s37, s35, 25600
    buffer_load_dwordx4 v[68:71], v3, s[16:19], s37 offen offset:0
    v_mfma_f32_16x16x32_bf16 v[200:203], v[104:107], v[96:99], v[200:203]
    v_mfma_f32_16x16x32_bf16 v[204:207], v[108:111], v[96:99], v[204:207]
    buffer_load_dwordx4 v[72:75], v3, s[16:19], s37 offen offset:1024
    v_mfma_f32_16x16x32_bf16 v[208:211], v[112:115], v[96:99], v[208:211]
    v_mfma_f32_16x16x32_bf16 v[212:215], v[116:119], v[96:99], v[212:215]
    buffer_load_dwordx4 v[76:79], v3, s[16:19], s37 offen offset:2048
    v_mfma_f32_16x16x32_bf16 v[216:219], v[120:123], v[96:99], v[216:219]
    v_mfma_f32_16x16x32_bf16 v[220:223], v[104:107], v[100:103], v[220:223]
    buffer_load_dwordx4 v[80:83], v3, s[16:19], s37 offen offset:3072
    v_mfma_f32_16x16x32_bf16 v[224:227], v[108:111], v[100:103], v[224:227]
    v_mfma_f32_16x16x32_bf16 v[228:231], v[112:115], v[100:103], v[228:231]
    s_add_u32 s37, s35, 29696
    buffer_load_dwordx4 v[84:87], v3, s[16:19], s37 offen offset:0
    v_mfma_f32_16x16x32_bf16 v[232:235], v[116:119], v[100:103], v[232:235]
    v_mfma_f32_16x16x32_bf16 v[236:239], v[120:123], v[100:103], v[236:239]
    s_waitcnt vmcnt(18)
    v_mfma_f32_16x16x32_bf16 v[160:163], v[140:143], v[124:127], v[160:163]
    v_mfma_f32_16x16x32_bf16 v[164:167], v[144:147], v[124:127], v[164:167]
    s_add_u32 s37, s40, 6144
    buffer_load_dwordx4 v[88:91], v3, s[12:15], s37 offen
    v_mfma_f32_16x16x32_bf16 v[168:171], v[148:151], v[124:127], v[168:171]
    v_mfma_f32_16x16x32_bf16 v[172:175], v[152:155], v[124:127], v[172:175]
    s_add_u32 s37, s41, 6144
    buffer_load_dwordx4 v[92:95], v3, s[12:15], s37 offen
    v_mfma_f32_16x16x32_bf16 v[176:179], v[156:159], v[124:127], v[176:179]
    v_mfma_f32_16x16x32_bf16 v[180:183], v[140:143], v[128:131], v[180:183]
    s_add_u32 s37, s42, 6144
    buffer_load_dwordx4 v[96:99], v3, s[12:15], s37 offen
    v_mfma_f32_16x16x32_bf16 v[184:187], v[144:147], v[128:131], v[184:187]
    v_mfma_f32_16x16x32_bf16 v[188:191], v[148:151], v[128:131], v[188:191]
    s_add_u32 s37, s43, 6144
    buffer_load_dwordx4 v[100:103], v3, s[12:15], s37 offen
    v_mfma_f32_16x16x32_bf16 v[192:195], v[152:155], v[128:131], v[192:195]
    v_mfma_f32_16x16x32_bf16 v[196:199], v[156:159], v[128:131], v[196:199]
    s_add_u32 s37, s35, 30720
    buffer_load_dwordx4 v[104:107], v3, s[16:19], s37 offen offset:0
    v_mfma_f32_16x16x32_bf16 v[200:203], v[140:143], v[132:135], v[200:203]
    v_mfma_f32_16x16x32_bf16 v[204:207], v[144:147], v[132:135], v[204:207]
    buffer_load_dwordx4 v[108:111], v3, s[16:19], s37 offen offset:1024
    v_mfma_f32_16x16x32_bf16 v[208:211], v[148:151], v[132:135], v[208:211]
    v_mfma_f32_16x16x32_bf16 v[212:215], v[152:155], v[132:135], v[212:215]
    buffer_load_dwordx4 v[112:115], v3, s[16:19], s37 offen offset:2048
    v_mfma_f32_16x16x32_bf16 v[216:219], v[156:159], v[132:135], v[216:219]
    v_mfma_f32_16x16x32_bf16 v[220:223], v[140:143], v[136:139], v[220:223]
    buffer_load_dwordx4 v[116:119], v3, s[16:19], s37 offen offset:3072
    v_mfma_f32_16x16x32_bf16 v[224:227], v[144:147], v[136:139], v[224:227]
    v_mfma_f32_16x16x32_bf16 v[228:231], v[148:151], v[136:139], v[228:231]
    s_add_u32 s37, s35, 34816
    buffer_load_dwordx4 v[120:123], v3, s[16:19], s37 offen offset:0
    v_mfma_f32_16x16x32_bf16 v[232:235], v[152:155], v[136:139], v[232:235]
    v_mfma_f32_16x16x32_bf16 v[236:239], v[156:159], v[136:139], v[236:239]
    s_waitcnt vmcnt(18)
    v_mfma_f32_16x16x32_bf16 v[160:163], v[32:35], v[16:19], v[160:163]
    v_mfma_f32_16x16x32_bf16 v[164:167], v[36:39], v[16:19], v[164:167]
    s_add_u32 s37, s40, 7168
    buffer_load_dwordx4 v[124:127], v3, s[12:15], s37 offen
    v_mfma_f32_16x16x32_bf16 v[168:171], v[40:43], v[16:19], v[168:171]
    v_mfma_f32_16x16x32_bf16 v[172:175], v[44:47], v[16:19], v[172:175]
    s_add_u32 s37, s41, 7168
    buffer_load_dwordx4 v[128:131], v3, s[12:15], s37 offen
    v_mfma_f32_16x16x32_bf16 v[176:179], v[48:51], v[16:19], v[176:179]
    v_mfma_f32_16x16x32_bf16 v[180:183], v[32:35], v[20:23], v[180:183]
    s_add_u32 s37, s42, 7168
    buffer_load_dwordx4 v[132:135], v3, s[12:15], s37 offen
    v_mfma_f32_16x16x32_bf16 v[184:187], v[36:39], v[20:23], v[184:187]
    v_mfma_f32_16x16x32_bf16 v[188:191], v[40:43], v[20:23], v[188:191]
    s_add_u32 s37, s43, 7168
    buffer_load_dwordx4 v[136:139], v3, s[12:15], s37 offen
    v_mfma_f32_16x16x32_bf16 v[192:195], v[44:47], v[20:23], v[192:195]
    v_mfma_f32_16x16x32_bf16 v[196:199], v[48:51], v[20:23], v[196:199]
    s_add_u32 s37, s35, 35840
    buffer_load_dwordx4 v[140:143], v3, s[16:19], s37 offen offset:0
    v_mfma_f32_16x16x32_bf16 v[200:203], v[32:35], v[24:27], v[200:203]
    v_mfma_f32_16x16x32_bf16 v[204:207], v[36:39], v[24:27], v[204:207]
    buffer_load_dwordx4 v[144:147], v3, s[16:19], s37 offen offset:1024
    v_mfma_f32_16x16x32_bf16 v[208:211], v[40:43], v[24:27], v[208:211]
    v_mfma_f32_16x16x32_bf16 v[212:215], v[44:47], v[24:27], v[212:215]
    buffer_load_dwordx4 v[148:151], v3, s[16:19], s37 offen offset:2048
    v_mfma_f32_16x16x32_bf16 v[216:219], v[48:51], v[24:27], v[216:219]
    v_mfma_f32_16x16x32_bf16 v[220:223], v[32:35], v[28:31], v[220:223]
    buffer_load_dwordx4 v[152:155], v3, s[16:19], s37 offen offset:3072
    v_mfma_f32_16x16x32_bf16 v[224:227], v[36:39], v[28:31], v[224:227]
    v_mfma_f32_16x16x32_bf16 v[228:231], v[40:43], v[28:31], v[228:231]
    s_add_u32 s37, s35, 39936
    buffer_load_dwordx4 v[156:159], v3, s[16:19], s37 offen offset:0
    v_mfma_f32_16x16x32_bf16 v[232:235], v[44:47], v[28:31], v[232:235]
    v_mfma_f32_16x16x32_bf16 v[236:239], v[48:51], v[28:31], v[236:239]
    s_waitcnt vmcnt(18)
    v_mfma_f32_16x16x32_bf16 v[160:163], v[68:71], v[52:55], v[160:163]
    v_mfma_f32_16x16x32_bf16 v[164:167], v[72:75], v[52:55], v[164:167]
    s_add_u32 s37, s40, 8192
    buffer_load_dwordx4 v[16:19], v3, s[12:15], s37 offen
    v_mfma_f32_16x16x32_bf16 v[168:171], v[76:79], v[52:55], v[168:171]
    v_mfma_f32_16x16x32_bf16 v[172:175], v[80:83], v[52:55], v[172:175]
    s_add_u32 s37, s41, 8192
    buffer_load_dwordx4 v[20:23], v3, s[12:15], s37 offen
    v_mfma_f32_16x16x32_bf16 v[176:179], v[84:87], v[52:55], v[176:179]
    v_mfma_f32_16x16x32_bf16 v[180:183], v[68:71], v[56:59], v[180:183]
    s_add_u32 s37, s42, 8192
    buffer_load_dwordx4 v[24:27], v3, s[12:15], s37 offen
    v_mfma_f32_16x16x32_bf16 v[184:187], v[72:75], v[56:59], v[184:187]
    v_mfma_f32_16x16x32_bf16 v[188:191], v[76:79], v[56:59], v[188:191]
    s_add_u32 s37, s43, 8192
    buffer_load_dwordx4 v[28:31], v3, s[12:15], s37 offen
    v_mfma_f32_16x16x32_bf16 v[192:195], v[80:83], v[56:59], v[192:195]
    v_mfma_f32_16x16x32_bf16 v[196:199], v[84:87], v[56:59], v[196:199]
    s_add_u32 s37, s35, 40960
    buffer_load_dwordx4 v[32:35], v3, s[16:19], s37 offen offset:0
    v_mfma_f32_16x16x32_bf16 v[200:203], v[68:71], v[60:63], v[200:203]
    v_mfma_f32_16x16x32_bf16 v[204:207], v[72:75], v[60:63], v[204:207]
    buffer_load_dwordx4 v[36:39], v3, s[16:19], s37 offen offset:1024
    v_mfma_f32_16x16x32_bf16 v[208:211], v[76:79], v[60:63], v[208:211]
    v_mfma_f32_16x16x32_bf16 v[212:215], v[80:83], v[60:63], v[212:215]
    buffer_load_dwordx4 v[40:43], v3, s[16:19], s37 offen offset:2048
    v_mfma_f32_16x16x32_bf16 v[216:219], v[84:87], v[60:63], v[216:219]
    v_mfma_f32_16x16x32_bf16 v[220:223], v[68:71], v[64:67], v[220:223]
    buffer_load_dwordx4 v[44:47], v3, s[16:19], s37 offen offset:3072
    v_mfma_f32_16x16x32_bf16 v[224:227], v[72:75], v[64:67], v[224:227]
    v_mfma_f32_16x16x32_bf16 v[228:231], v[76:79], v[64:67], v[228:231]
    s_add_u32 s37, s35, 45056
    buffer_load_dwordx4 v[48:51], v3, s[16:19], s37 offen offset:0
    v_mfma_f32_16x16x32_bf16 v[232:235], v[80:83], v[64:67], v[232:235]
    v_mfma_f32_16x16x32_bf16 v[236:239], v[84:87], v[64:67], v[236:239]
    s_waitcnt vmcnt(18)
    v_mfma_f32_16x16x32_bf16 v[160:163], v[104:107], v[88:91], v[160:163]
    v_mfma_f32_16x16x32_bf16 v[164:167], v[108:111], v[88:91], v[164:167]
    s_add_u32 s37, s40, 9216
    buffer_load_dwordx4 v[52:55], v3, s[12:15], s37 offen
    v_mfma_f32_16x16x32_bf16 v[168:171], v[112:115], v[88:91], v[168:171]
    v_mfma_f32_16x16x32_bf16 v[172:175], v[116:119], v[88:91], v[172:175]
    s_add_u32 s37, s41, 9216
    buffer_load_dwordx4 v[56:59], v3, s[12:15], s37 offen
    v_mfma_f32_16x16x32_bf16 v[176:179], v[120:123], v[88:91], v[176:179]
    v_mfma_f32_16x16x32_bf16 v[180:183], v[104:107], v[92:95], v[180:183]
    s_add_u32 s37, s42, 9216
    buffer_load_dwordx4 v[60:63], v3, s[12:15], s37 offen
    v_mfma_f32_16x16x32_bf16 v[184:187], v[108:111], v[92:95], v[184:187]
    v_mfma_f32_16x16x32_bf16 v[188:191], v[112:115], v[92:95], v[188:191]
    s_add_u32 s37, s43, 9216
    buffer_load_dwordx4 v[64:67], v3, s[12:15], s37 offen
    v_mfma_f32_16x16x32_bf16 v[192:195], v[116:119], v[92:95], v[192:195]
    v_mfma_f32_16x16x32_bf16 v[196:199], v[120:123], v[92:95], v[196:199]
    s_add_u32 s37, s35, 46080
    buffer_load_dwordx4 v[68:71], v3, s[16:19], s37 offen offset:0
    v_mfma_f32_16x16x32_bf16 v[200:203], v[104:107], v[96:99], v[200:203]
    v_mfma_f32_16x16x32_bf16 v[204:207], v[108:111], v[96:99], v[204:207]
    buffer_load_dwordx4 v[72:75], v3, s[16:19], s37 offen offset:1024
    v_mfma_f32_16x16x32_bf16 v[208:211], v[112:115], v[96:99], v[208:211]
    v_mfma_f32_16x16x32_bf16 v[212:215], v[116:119], v[96:99], v[212:215]
    buffer_load_dwordx4 v[76:79], v3, s[16:19], s37 offen offset:2048
    v_mfma_f32_16x16x32_bf16 v[216:219], v[120:123], v[96:99], v[216:219]
    v_mfma_f32_16x16x32_bf16 v[220:223], v[104:107], v[100:103], v[220:223]
    buffer_load_dwordx4 v[80:83], v3, s[16:19], s37 offen offset:3072
    v_mfma_f32_16x16x32_bf16 v[224:227], v[108:111], v[100:103], v[224:227]
    v_mfma_f32_16x16x32_bf16 v[228:231], v[112:115], v[100:103], v[228:231]
    s_add_u32 s37, s35, 50176
    buffer_load_dwordx4 v[84:87], v3, s[16:19], s37 offen offset:0
    v_mfma_f32_16x16x32_bf16 v[232:235], v[116:119], v[100:103], v[232:235]
    v_mfma_f32_16x16x32_bf16 v[236:239], v[120:123], v[100:103], v[236:239]
    s_waitcnt vmcnt(18)
    v_mfma_f32_16x16x32_bf16 v[160:163], v[140:143], v[124:127], v[160:163]
    v_mfma_f32_16x16x32_bf16 v[164:167], v[144:147], v[124:127], v[164:167]
    s_add_u32 s37, s40, 10240
    buffer_load_dwordx4 v[88:91], v3, s[12:15], s37 offen
    v_mfma_f32_16x16x32_bf16 v[168:171], v[148:151], v[124:127], v[168:171]
    v_mfma_f32_16x16x32_bf16 v[172:175], v[152:155], v[124:127], v[172:175]
    s_add_u32 s37, s41, 10240
    buffer_load_dwordx4 v[92:95], v3, s[12:15], s37 offen
    v_mfma_f32_16x16x32_bf16 v[176:179], v[156:159], v[124:127], v[176:179]
    v_mfma_f32_16x16x32_bf16 v[180:183], v[140:143], v[128:131], v[180:183]
    s_add_u32 s37, s42, 10240
    buffer_load_dwordx4 v[96:99], v3, s[12:15], s37 offen
    v_mfma_f32_16x16x32_bf16 v[184:187], v[144:147], v[128:131], v[184:187]
    v_mfma_f32_16x16x32_bf16 v[188:191], v[148:151], v[128:131], v[188:191]
    s_add_u32 s37, s43, 10240
    buffer_load_dwordx4 v[100:103], v3, s[12:15], s37 offen
    v_mfma_f32_16x16x32_bf16 v[192:195], v[152:155], v[128:131], v[192:195]
    v_mfma_f32_16x16x32_bf16 v[196:199], v[156:159], v[128:131], v[196:199]
    s_add_u32 s37, s35, 51200
    buffer_load_dwordx4 v[104:107], v3, s[16:19], s37 offen offset:0
    v_mfma_f32_16x16x32_bf16 v[200:203], v[140:143], v[132:135], v[200:203]
    v_mfma_f32_16x16x32_bf16 v[204:207], v[144:147], v[132:135], v[204:207]
    buffer_load_dwordx4 v[108:111], v3, s[16:19], s37 offen offset:1024
    v_mfma_f32_16x16x32_bf16 v[208:211], v[148:151], v[132:135], v[208:211]
    v_mfma_f32_16x16x32_bf16 v[212:215], v[152:155], v[132:135], v[212:215]
    buffer_load_dwordx4 v[112:115], v3, s[16:19], s37 offen offset:2048
    v_mfma_f32_16x16x32_bf16 v[216:219], v[156:159], v[132:135], v[216:219]
    v_mfma_f32_16x16x32_bf16 v[220:223], v[140:143], v[136:139], v[220:223]
    buffer_load_dwordx4 v[116:119], v3, s[16:19], s37 offen offset:3072
    v_mfma_f32_16x16x32_bf16 v[224:227], v[144:147], v[136:139], v[224:227]
    v_mfma_f32_16x16x32_bf16 v[228:231], v[148:151], v[136:139], v[228:231]
    s_add_u32 s37, s35, 55296
    buffer_load_dwordx4 v[120:123], v3, s[16:19], s37 offen offset:0
    v_mfma_f32_16x16x32_bf16 v[232:235], v[152:155], v[136:139], v[232:235]
    v_mfma_f32_16x16x32_bf16 v[236:239], v[156:159], v[136:139], v[236:239]
    s_waitcnt vmcnt(18)
    v_mfma_f32_16x16x32_bf16 v[160:163], v[32:35], v[16:19], v[160:163]
    v_mfma_f32_16x16x32_bf16 v[164:167], v[36:39], v[16:19], v[164:167]
    s_add_u32 s37, s40, 11264
    buffer_load_dwordx4 v[124:127], v3, s[12:15], s37 offen
    v_mfma_f32_16x16x32_bf16 v[168:171], v[40:43], v[16:19], v[168:171]
    v_mfma_f32_16x16x32_bf16 v[172:175], v[44:47], v[16:19], v[172:175]
    s_add_u32 s37, s41, 11264
    buffer_load_dwordx4 v[128:131], v3, s[12:15], s37 offen
    v_mfma_f32_16x16x32_bf16 v[176:179], v[48:51], v[16:19], v[176:179]
    v_mfma_f32_16x16x32_bf16 v[180:183], v[32:35], v[20:23], v[180:183]
    s_add_u32 s37, s42, 11264
    buffer_load_dwordx4 v[132:135], v3, s[12:15], s37 offen
    v_mfma_f32_16x16x32_bf16 v[184:187], v[36:39], v[20:23], v[184:187]
    v_mfma_f32_16x16x32_bf16 v[188:191], v[40:43], v[20:23], v[188:191]
    s_add_u32 s37, s43, 11264
    buffer_load_dwordx4 v[136:139], v3, s[12:15], s37 offen
    v_mfma_f32_16x16x32_bf16 v[192:195], v[44:47], v[20:23], v[192:195]
    v_mfma_f32_16x16x32_bf16 v[196:199], v[48:51], v[20:23], v[196:199]
    s_add_u32 s37, s35, 56320
    buffer_load_dwordx4 v[140:143], v3, s[16:19], s37 offen offset:0
    v_mfma_f32_16x16x32_bf16 v[200:203], v[32:35], v[24:27], v[200:203]
    v_mfma_f32_16x16x32_bf16 v[204:207], v[36:39], v[24:27], v[204:207]
    buffer_load_dwordx4 v[144:147], v3, s[16:19], s37 offen offset:1024
    v_mfma_f32_16x16x32_bf16 v[208:211], v[40:43], v[24:27], v[208:211]
    v_mfma_f32_16x16x32_bf16 v[212:215], v[44:47], v[24:27], v[212:215]
    buffer_load_dwordx4 v[148:151], v3, s[16:19], s37 offen offset:2048
    v_mfma_f32_16x16x32_bf16 v[216:219], v[48:51], v[24:27], v[216:219]
    v_mfma_f32_16x16x32_bf16 v[220:223], v[32:35], v[28:31], v[220:223]
    buffer_load_dwordx4 v[152:155], v3, s[16:19], s37 offen offset:3072
    v_mfma_f32_16x16x32_bf16 v[224:227], v[36:39], v[28:31], v[224:227]
    v_mfma_f32_16x16x32_bf16 v[228:231], v[40:43], v[28:31], v[228:231]
    s_add_u32 s37, s35, 60416
    buffer_load_dwordx4 v[156:159], v3, s[16:19], s37 offen offset:0
    v_mfma_f32_16x16x32_bf16 v[232:235], v[44:47], v[28:31], v[232:235]
    v_mfma_f32_16x16x32_bf16 v[236:239], v[48:51], v[28:31], v[236:239]
    s_waitcnt vmcnt(18)
    v_mfma_f32_16x16x32_bf16 v[160:163], v[68:71], v[52:55], v[160:163]
    v_mfma_f32_16x16x32_bf16 v[164:167], v[72:75], v[52:55], v[164:167]
    buffer_load_dwordx2 v[240:241], v10, s[20:23], 0 offen offset:0
    v_mfma_f32_16x16x32_bf16 v[168:171], v[76:79], v[52:55], v[168:171]
    v_mfma_f32_16x16x32_bf16 v[172:175], v[80:83], v[52:55], v[172:175]
    buffer_load_dwordx2 v[242:243], v10, s[20:23], 0 offen offset:32
    v_mfma_f32_16x16x32_bf16 v[176:179], v[84:87], v[52:55], v[176:179]
    v_mfma_f32_16x16x32_bf16 v[180:183], v[68:71], v[56:59], v[180:183]
    buffer_load_dwordx2 v[244:245], v10, s[20:23], 0 offen offset:64
    v_mfma_f32_16x16x32_bf16 v[184:187], v[72:75], v[56:59], v[184:187]
    v_mfma_f32_16x16x32_bf16 v[188:191], v[76:79], v[56:59], v[188:191]
    buffer_load_dwordx2 v[246:247], v10, s[20:23], 0 offen offset:96
    v_mfma_f32_16x16x32_bf16 v[192:195], v[80:83], v[56:59], v[192:195]
    v_mfma_f32_16x16x32_bf16 v[196:199], v[84:87], v[56:59], v[196:199]
    buffer_load_dwordx2 v[248:249], v10, s[20:23], 0 offen offset:128
    v_mfma_f32_16x16x32_bf16 v[200:203], v[68:71], v[60:63], v[200:203]
    v_mfma_f32_16x16x32_bf16 v[204:207], v[72:75], v[60:63], v[204:207]
    v_mfma_f32_16x16x32_bf16 v[208:211], v[76:79], v[60:63], v[208:211]
    v_mfma_f32_16x16x32_bf16 v[212:215], v[80:83], v[60:63], v[212:215]
    v_mfma_f32_16x16x32_bf16 v[216:219], v[84:87], v[60:63], v[216:219]
    v_mfma_f32_16x16x32_bf16 v[220:223], v[68:71], v[64:67], v[220:223]
    v_mfma_f32_16x16x32_bf16 v[224:227], v[72:75], v[64:67], v[224:227]
    v_mfma_f32_16x16x32_bf16 v[228:231], v[76:79], v[64:67], v[228:231]
    v_mfma_f32_16x16x32_bf16 v[232:235], v[80:83], v[64:67], v[232:235]
    v_mfma_f32_16x16x32_bf16 v[236:239], v[84:87], v[64:67], v[236:239]
    s_waitcnt vmcnt(14)
    v_mfma_f32_16x16x32_bf16 v[160:163], v[104:107], v[88:91], v[160:163]
    v_mfma_f32_16x16x32_bf16 v[164:167], v[108:111], v[88:91], v[164:167]
    v_mfma_f32_16x16x32_bf16 v[168:171], v[112:115], v[88:91], v[168:171]
    v_mfma_f32_16x16x32_bf16 v[172:175], v[116:119], v[88:91], v[172:175]
    v_mfma_f32_16x16x32_bf16 v[176:179], v[120:123], v[88:91], v[176:179]
    v_mfma_f32_16x16x32_bf16 v[180:183], v[104:107], v[92:95], v[180:183]
    v_mfma_f32_16x16x32_bf16 v[184:187], v[108:111], v[92:95], v[184:187]
    v_mfma_f32_16x16x32_bf16 v[188:191], v[112:115], v[92:95], v[188:191]
    v_mfma_f32_16x16x32_bf16 v[192:195], v[116:119], v[92:95], v[192:195]
    v_mfma_f32_16x16x32_bf16 v[196:199], v[120:123], v[92:95], v[196:199]
    v_mfma_f32_16x16x32_bf16 v[200:203], v[104:107], v[96:99], v[200:203]
    v_mfma_f32_16x16x32_bf16 v[204:207], v[108:111], v[96:99], v[204:207]
    v_mfma_f32_16x16x32_bf16 v[208:211], v[112:115], v[96:99], v[208:211]
    v_mfma_f32_16x16x32_bf16 v[212:215], v[116:119], v[96:99], v[212:215]
    v_mfma_f32_16x16x32_bf16 v[216:219], v[120:123], v[96:99], v[216:219]
    v_mfma_f32_16x16x32_bf16 v[220:223], v[104:107], v[100:103], v[220:223]
    v_mfma_f32_16x16x32_bf16 v[224:227], v[108:111], v[100:103], v[224:227]
    v_mfma_f32_16x16x32_bf16 v[228:231], v[112:115], v[100:103], v[228:231]
    v_mfma_f32_16x16x32_bf16 v[232:235], v[116:119], v[100:103], v[232:235]
    v_mfma_f32_16x16x32_bf16 v[236:239], v[120:123], v[100:103], v[236:239]
    s_waitcnt vmcnt(5)
    v_mfma_f32_16x16x32_bf16 v[160:163], v[140:143], v[124:127], v[160:163]
    v_mfma_f32_16x16x32_bf16 v[164:167], v[144:147], v[124:127], v[164:167]
    v_mfma_f32_16x16x32_bf16 v[168:171], v[148:151], v[124:127], v[168:171]
    v_mfma_f32_16x16x32_bf16 v[172:175], v[152:155], v[124:127], v[172:175]
    v_mfma_f32_16x16x32_bf16 v[176:179], v[156:159], v[124:127], v[176:179]
    v_mfma_f32_16x16x32_bf16 v[180:183], v[140:143], v[128:131], v[180:183]
    v_mfma_f32_16x16x32_bf16 v[184:187], v[144:147], v[128:131], v[184:187]
    v_mfma_f32_16x16x32_bf16 v[188:191], v[148:151], v[128:131], v[188:191]
    v_mfma_f32_16x16x32_bf16 v[192:195], v[152:155], v[128:131], v[192:195]
    v_mfma_f32_16x16x32_bf16 v[196:199], v[156:159], v[128:131], v[196:199]
    ds_write_b128 v13, v[160:163] offset:0
    v_mfma_f32_16x16x32_bf16 v[200:203], v[140:143], v[132:135], v[200:203]
    ds_write_b128 v13, v[164:167] offset:1024
    v_mfma_f32_16x16x32_bf16 v[204:207], v[144:147], v[132:135], v[204:207]
    ds_write_b128 v13, v[168:171] offset:2048
    v_mfma_f32_16x16x32_bf16 v[208:211], v[148:151], v[132:135], v[208:211]
    ds_write_b128 v13, v[172:175] offset:3072
    v_mfma_f32_16x16x32_bf16 v[212:215], v[152:155], v[132:135], v[212:215]
    ds_write_b128 v13, v[176:179] offset:4096
    v_mfma_f32_16x16x32_bf16 v[216:219], v[156:159], v[132:135], v[216:219]
    ds_write_b128 v14, v[180:183] offset:0
    v_mfma_f32_16x16x32_bf16 v[220:223], v[140:143], v[136:139], v[220:223]
    ds_write_b128 v14, v[184:187] offset:1024
    v_mfma_f32_16x16x32_bf16 v[224:227], v[144:147], v[136:139], v[224:227]
    ds_write_b128 v14, v[188:191] offset:2048
    v_mfma_f32_16x16x32_bf16 v[228:231], v[148:151], v[136:139], v[228:231]
    ds_write_b128 v14, v[192:195] offset:3072
    v_mfma_f32_16x16x32_bf16 v[232:235], v[152:155], v[136:139], v[232:235]
    ds_write_b128 v14, v[196:199] offset:4096
    v_mfma_f32_16x16x32_bf16 v[236:239], v[156:159], v[136:139], v[236:239]
    ds_write_b128 v15, v[200:203] offset:0
    s_nop 2
    ds_write_b128 v15, v[204:207] offset:1024
    ds_write_b128 v15, v[208:211] offset:2048
    ds_write_b128 v15, v[212:215] offset:3072
    ds_write_b128 v15, v[216:219] offset:4096
    s_waitcnt lgkmcnt(0)
    s_barrier
    ds_read_b128 v[16:19], v9 offset:0
    ds_read_b128 v[20:23], v9 offset:5120
    ds_read_b128 v[24:27], v9 offset:10240
    ds_read_b128 v[28:31], v9 offset:1024
    ds_read_b128 v[32:35], v9 offset:6144
    ds_read_b128 v[36:39], v9 offset:11264
    ds_read_b128 v[40:43], v9 offset:2048
    ds_read_b128 v[44:47], v9 offset:7168
    ds_read_b128 v[48:51], v9 offset:12288
    ds_read_b128 v[52:55], v9 offset:3072
    ds_read_b128 v[56:59], v9 offset:8192
    ds_read_b128 v[60:63], v9 offset:13312
    ds_read_b128 v[64:67], v9 offset:4096
    ds_read_b128 v[68:71], v9 offset:9216
    ds_read_b128 v[72:75], v9 offset:14336
    v_mov_b32 v8, 0xffff0000
    s_waitcnt vmcnt(0)
    v_lshlrev_b32 v80, 16, v240
    v_and_b32 v81, v8, v240
    v_lshlrev_b32 v82, 16, v241
    v_and_b32 v83, v8, v241
    v_lshlrev_b32 v84, 16, v242
    v_and_b32 v85, v8, v242
    v_lshlrev_b32 v86, 16, v243
    v_and_b32 v87, v8, v243
    v_lshlrev_b32 v88, 16, v244
    v_and_b32 v89, v8, v244
    v_lshlrev_b32 v90, 16, v245
    v_and_b32 v91, v8, v245
    v_lshlrev_b32 v92, 16, v246
    v_and_b32 v93, v8, v246
    v_lshlrev_b32 v94, 16, v247
    v_and_b32 v95, v8, v247
    v_lshlrev_b32 v96, 16, v248
    v_and_b32 v97, v8, v248
    v_lshlrev_b32 v98, 16, v249
    v_and_b32 v99, v8, v249
    s_waitcnt lgkmcnt(0)
    v_add_f32 v16, v16, v20
    v_add_f32 v220, v220, v24
    v_add_f32 v17, v17, v21
    v_add_f32 v221, v221, v25
    v_add_f32 v18, v18, v22
    v_add_f32 v222, v222, v26
    v_add_f32 v19, v19, v23
    v_add_f32 v223, v223, v27
    v_add_f32 v28, v28, v32
    v_add_f32 v224, v224, v36
    v_add_f32 v29, v29, v33
    v_add_f32 v225, v225, v37
    v_add_f32 v30, v30, v34
    v_add_f32 v226, v226, v38
    v_add_f32 v31, v31, v35
    v_add_f32 v227, v227, v39
    v_add_f32 v40, v40, v44
    v_add_f32 v228, v228, v48
    v_add_f32 v41, v41, v45
    v_add_f32 v229, v229, v49
    v_add_f32 v42, v42, v46
    v_add_f32 v230, v230, v50
    v_add_f32 v43, v43, v47
    v_add_f32 v231, v231, v51
    v_add_f32 v52, v52, v56
    v_add_f32 v232, v232, v60
    v_add_f32 v53, v53, v57
    v_add_f32 v233, v233, v61
    v_add_f32 v54, v54, v58
    v_add_f32 v234, v234, v62
    v_add_f32 v55, v55, v59
    v_add_f32 v235, v235, v63
    v_add_f32 v64, v64, v68
    v_add_f32 v236, v236, v72
    v_add_f32 v65, v65, v69
    v_add_f32 v237, v237, v73
    v_add_f32 v66, v66, v70
    v_add_f32 v238, v238, v74
    v_add_f32 v67, v67, v71
    v_add_f32 v239, v239, v75
    v_add_f32 v16, v16, v220
    v_add_f32 v17, v17, v221
    v_add_f32 v18, v18, v222
    v_add_f32 v19, v19, v223
    v_add_f32 v28, v28, v224
    v_add_f32 v29, v29, v225
    v_add_f32 v30, v30, v226
    v_add_f32 v31, v31, v227
    v_add_f32 v40, v40, v228
    v_add_f32 v41, v41, v229
    v_add_f32 v42, v42, v230
    v_add_f32 v43, v43, v231
    v_add_f32 v52, v52, v232
    v_add_f32 v53, v53, v233
    v_add_f32 v54, v54, v234
    v_add_f32 v55, v55, v235
    v_add_f32 v64, v64, v236
    v_add_f32 v65, v65, v237
    v_add_f32 v66, v66, v238
    v_add_f32 v67, v67, v239
    v_cvt_pk_bf16_f32 v20, v16, v17
    v_cvt_pk_bf16_f32 v21, v18, v19
    v_cvt_pk_bf16_f32 v32, v28, v29
    v_cvt_pk_bf16_f32 v33, v30, v31
    v_cvt_pk_bf16_f32 v44, v40, v41
    v_cvt_pk_bf16_f32 v45, v42, v43
    v_cvt_pk_bf16_f32 v56, v52, v53
    v_cvt_pk_bf16_f32 v57, v54, v55
    v_cvt_pk_bf16_f32 v68, v64, v65
    v_cvt_pk_bf16_f32 v69, v66, v67
    v_lshlrev_b32 v24, 16, v20
    v_and_b32 v25, v8, v20
    v_lshlrev_b32 v26, 16, v21
    v_and_b32 v27, v8, v21
    v_lshlrev_b32 v36, 16, v32
    v_and_b32 v37, v8, v32
    v_lshlrev_b32 v38, 16, v33
    v_and_b32 v39, v8, v33
    v_lshlrev_b32 v48, 16, v44
    v_and_b32 v49, v8, v44
    v_lshlrev_b32 v50, 16, v45
    v_and_b32 v51, v8, v45
    v_lshlrev_b32 v60, 16, v56
    v_and_b32 v61, v8, v56
    v_lshlrev_b32 v62, 16, v57
    v_and_b32 v63, v8, v57
    v_lshlrev_b32 v72, 16, v68
    v_and_b32 v73, v8, v68
    v_lshlrev_b32 v74, 16, v69
    v_and_b32 v75, v8, v69
    v_add_f32 v24, v24, v80
    v_add_f32 v25, v25, v81
    v_add_f32 v26, v26, v82
    v_add_f32 v27, v27, v83
    v_add_f32 v36, v36, v84
    v_add_f32 v37, v37, v85
    v_add_f32 v38, v38, v86
    v_add_f32 v39, v39, v87
    v_add_f32 v48, v48, v88
    v_add_f32 v49, v49, v89
    v_add_f32 v50, v50, v90
    v_add_f32 v51, v51, v91
    v_add_f32 v60, v60, v92
    v_add_f32 v61, v61, v93
    v_add_f32 v62, v62, v94
    v_add_f32 v63, v63, v95
    v_add_f32 v72, v72, v96
    v_add_f32 v73, v73, v97
    v_add_f32 v74, v74, v98
    v_add_f32 v75, v75, v99
    v_cvt_pk_bf16_f32 v16, v24, v25
    v_cvt_pk_bf16_f32 v17, v26, v27
    buffer_store_dwordx2 v[16:17], v10, s[24:27], 0 offen offset:0
    v_cvt_pk_bf16_f32 v28, v36, v37
    v_cvt_pk_bf16_f32 v29, v38, v39
    buffer_store_dwordx2 v[28:29], v10, s[24:27], 0 offen offset:32
    v_cvt_pk_bf16_f32 v40, v48, v49
    v_cvt_pk_bf16_f32 v41, v50, v51
    buffer_store_dwordx2 v[40:41], v10, s[24:27], 0 offen offset:64
    v_cvt_pk_bf16_f32 v52, v60, v61
    v_cvt_pk_bf16_f32 v53, v62, v63
    buffer_store_dwordx2 v[52:53], v10, s[24:27], 0 offen offset:96
    v_cvt_pk_bf16_f32 v64, v72, v73
    v_cvt_pk_bf16_f32 v65, v74, v75
    buffer_store_dwordx2 v[64:65], v10, s[24:27], 0 offen offset:128
k5_kernel_END:
    s_endpgm
.section .rodata,"a"
.p2align 6
.amdhsa_kernel k1_kernel
  .amdhsa_next_free_vgpr 212
  .amdhsa_next_free_sgpr 102
  .amdhsa_accum_offset 212
  .amdhsa_group_segment_fixed_size 0
  .amdhsa_kernarg_size 80
  .amdhsa_user_sgpr_count 2
  .amdhsa_user_sgpr_kernarg_segment_ptr 1
  .amdhsa_system_sgpr_workgroup_id_x 1
.end_amdhsa_kernel
.p2align 6
.amdhsa_kernel k2_kernel
  .amdhsa_next_free_vgpr 224
  .amdhsa_next_free_sgpr 102
  .amdhsa_accum_offset 224
  .amdhsa_group_segment_fixed_size 0
  .amdhsa_kernarg_size 80
  .amdhsa_user_sgpr_count 2
  .amdhsa_user_sgpr_kernarg_segment_ptr 1
  .amdhsa_system_sgpr_workgroup_id_x 1
.end_amdhsa_kernel
.p2align 6
.amdhsa_kernel k3_kernel
  .amdhsa_next_free_vgpr 168
  .amdhsa_next_free_sgpr 102
  .amdhsa_accum_offset 168
  .amdhsa_group_segment_fixed_size 0
  .amdhsa_kernarg_size 80
  .amdhsa_user_sgpr_count 2
  .amdhsa_user_sgpr_kernarg_segment_ptr 1
  .amdhsa_system_sgpr_workgroup_id_x 1
.end_amdhsa_kernel
.p2align 6
.amdhsa_kernel k4_kernel
  .amdhsa_next_free_vgpr 224
  .amdhsa_next_free_sgpr 102
  .amdhsa_accum_offset 224
  .amdhsa_group_segment_fixed_size 0
  .amdhsa_kernarg_size 80
  .amdhsa_user_sgpr_count 2
  .amdhsa_user_sgpr_kernarg_segment_ptr 1
  .amdhsa_system_sgpr_workgroup_id_x 1
.end_amdhsa_kernel
.p2align 6
.amdhsa_kernel k5_kernel
  .amdhsa_next_free_vgpr 250
  .amdhsa_next_free_sgpr 102
  .amdhsa_accum_offset 252
  .amdhsa_group_segment_fixed_size 0
  .amdhsa_kernarg_size 80
  .amdhsa_user_sgpr_count 2
  .amdhsa_user_sgpr_kernarg_segment_ptr 1
  .amdhsa_system_sgpr_workgroup_id_x 1
.end_amdhsa_kernel
.p2align 8
g64tab:
.quad 0x3000300030003000,0x3000300030003000,0x2fa82fd92ff63000,0xa8a5a63ea2460000,0x2ea72f642fd93000,0xaea7af64afd9b000,0x2d132ea72fa83000,0x2e2f2c7228a58000,0x2a1f2da82f643000,0x2a1f2da82f643000,0x22462c722f0e3000,0xaff6aea7ab8b0000,0xa63e2a1f2ea73000,0x263eaa1faea7b000,0xab8b263e2e2f3000,0x2f0e2fd92d138000
.quad 0xada800002da83000,0xada800002da83000,0xaf0ea63e2d133000,0xab8bafd9ae2f0000,0xafd9aa1f2c723000,0x2fd92a1fac72b000,0xaff6ac722b8b3000,0xa2462ea72f0e8000,0xaf64ada82a1f3000,0xaf64ada82a1f3000,0xae2faea728a53000,0x2d13ac72afa80000,0xac72af64263e3000,0x2c722f64a63eb000,0xa8a5afd922463000,0xafa8263e2ff68000
.quad 0x3000300030003000,0x3000300030003000,0x2e2f2ea72f0e2f64,0xad13ac72ab8baa1f,0x263e2a1f2c722da8,0xa63eaa1fac72ada8,0xab8ba63e22462a1f,0x2f0e2fd92ff62f64,0xaf64ada8aa1f0000,0xaf64ada8aa1f0000,0xafa8afd9ae2faa1f,0x28a5a63ead13af64,0xac72af64afd9ada8,0x2c722f642fd92da8,0x2246ac72afa8af64,0xaff6aea7a8a52a1f
.quad 0x2da88000ada8b000,0x2da88000ada8b000,0x2ff62c72a8a5af64,0x22462ea72fa82a1f,0x2ea72f64263eada8,0xaea7af64a63e2da8,0x28a52fd92d13aa1f,0x2fa8263eae2faf64,0xaa1f2da82f648000,0xaa1f2da82f648000,0xaf0e263e2ff62a1f,0xab8bafd9a2462f64,0xafd9aa1f2ea72da8,0x2fd92a1faea7ada8,0xad13aea72b8b2f64,0xae2f2c722f0eaa1f
.quad 0x3000300030003000,0x3000300030003000,0x2b8b2c722d132da8,0xaf0eaea7ae2fada8,0xac72aa1fa63e0000,0x2c722a1f263e8000,0xaff6afd9af0eada8,0xa246263e2b8b2da8,0xaa1fada8af64b000,0xaa1fada8af64b000,0x2d13263ea8a5ada8,0x2e2f2fd92fa82da8,0x2fd92f642c728000,0xafd9af64ac720000,0x28a52ea72ff62da8,0x2fa82c72a246ada8
.quad 0xada800002da83000,0xada800002da83000,0xafa8aea7a2462da8,0x28a5ac72aff6ada8,0xa63eaf64aea70000,0x263e2f642ea78000,0x2e2fa63eafa8ada8,0xad13afd9a8a52da8,0x2f642da8aa1fb000,0x2f642da8aa1fb000,0x22462fd92b8bada8,0xaff6a63e2f0e2da8,0xaea72a1f2fd98000,0x2ea7aa1fafd90000,0xaf0eac722e2f2da8,0xab8b2ea72d13ada8
.quad 0x3000300030003000,0x3000300030003000,0x2246263e28a52a1f,0xaff6afd9afa8af64,0xafd9af64aea7ada8,0x2fd92f642ea72da8,0xa8a5ac72ae2faf64,0xafa8aea7ad13aa1f,0x2f642da82a1f8000,0x2f642da82a1f8000,0x2b8b2ea72ff62f64,0xaf0eac72a2462a1f,0xaea7aa1f263e2da8,0x2ea72a1fa63eada8,0xad13afd9af0eaa1f,0xae2fa63e2b8b2f64
.quad 0x2da88000ada8b000,0x2da88000ada8b000,0x2e2f2fd92b8baa1f,0xad13263e2f0e2f64,0xac722a1f2fd92da8,0x2c72aa1fafd9ada8,0xaf0eaea722462f64,0xab8b2c722ff62a1f,0x2a1fada8af640000,0x2a1fada8af640000,0x2fa82c72ad13af64,0xa8a52ea72e2faa1f,0xa63e2f642c72ada8,0x263eaf64ac722da8,0xaff6a63e2fa82a1f,0xa2462fd928a5af64
.quad 0x3000300030003000,0x3000300030003000,0xafa8afd9aff6b000,0x28a5263e22468000,0x2ea72f642fd93000,0xaea7af64afd9b000,0xad13aea7afa8b000,0xae2fac72a8a50000,0x2a1f2da82f643000,0x2a1f2da82f643000,0xa246ac72af0eb000,0x2ff62ea72b8b8000,0xa63e2a1f2ea73000,0x263eaa1faea7b000,0x2b8ba63eae2fb000,0xaf0eafd9ad130000
.quad 0xada800002da83000,0xada800002da83000,0x2f0e263ead13b000,0x2b8b2fd92e2f8000,0xafd9aa1f2c723000,0x2fd92a1fac72b000,0x2ff62c72ab8bb000,0x2246aea7af0e0000,0xaf64ada82a1f3000,0xaf64ada82a1f3000,0x2e2f2ea7a8a5b000,0xad132c722fa88000,0xac72af64263e3000,0x2c722f64a63eb000,0x28a52fd9a246b000,0x2fa8a63eaff60000
.quad 0x3000300030003000,0x3000300030003000,0xae2faea7af0eaf64,0x2d132c722b8b2a1f,0x263e2a1f2c722da8,0xa63eaa1fac72ada8,0x2b8b263ea246aa1f,0xaf0eafd9aff6af64,0xaf64ada8aa1f0000,0xaf64ada8aa1f0000,0x2fa82fd92e2f2a1f,0xa8a5263e2d132f64,0xac72af64afd9ada8,0x2c722f642fd92da8,0xa2462c722fa82f64,0x2ff62ea728a5aa1f
.quad 0x2da88000ada8b000,0x2da88000ada8b000,0xaff6ac7228a52f64,0xa246aea7afa8aa1f,0x2ea72f64263eada8,0xaea7af64a63e2da8,0xa8a5afd9ad132a1f,0xafa8a63e2e2f2f64,0xaa1f2da82f648000,0xaa1f2da82f648000,0x2f0ea63eaff6aa1f,0x2b8b2fd92246af64,0xafd9aa1f2ea72da8,0x2fd92a1faea7ada8,0x2d132ea7ab8baf64,0x2e2fac72af0e2a1f
.quad 0x3000300030003000,0x3000300030003000,0xab8bac72ad13ada8,0x2f0e2ea72e2f2da8,0xac72aa1fa63e0000,0x2c722a1f263e8000,0x2ff62fd92f0e2da8,0x2246a63eab8bada8,0xaa1fada8af64b000,0xaa1fada8af64b000,0xad13a63e28a52da8,0xae2fafd9afa8ada8,0x2fd92f642c728000,0xafd9af64ac720000,0xa8a5aea7aff6ada8,0xafa8ac7222462da8
.quad 0xada800002da83000,0xada800002da83000,0x2fa82ea72246ada8,0xa8a52c722ff62da8,0xa63eaf64aea70000,0x263e2f642ea78000,0xae2f263e2fa82da8,0x2d132fd928a5ada8,0x2f642da8aa1fb000,0x2f642da8aa1fb000,0xa246afd9ab8b2da8,0x2ff6263eaf0eada8,0xaea72a1f2fd98000,0x2ea7aa1fafd90000,0x2f0e2c72ae2fada8,0x2b8baea7ad132da8
.quad 0x3000300030003000,0x3000300030003000,0xa246a63ea8a5aa1f,0x2ff62fd92fa82f64,0xafd9af64aea7ada8,0x2fd92f642ea72da8,0x28a52c722e2f2f64,0x2fa82ea72d132a1f,0x2f642da82a1f8000,0x2f642da82a1f8000,0xab8baea7aff6af64,0x2f0e2c722246aa1f,0xaea7aa1f263e2da8,0x2ea72a1fa63eada8,0x2d132fd92f0e2a1f,0x2e2f263eab8baf64
.quad 0x2da88000ada8b000,0x2da88000ada8b000,0xae2fafd9ab8b2a1f,0x2d13a63eaf0eaf64,0xac722a1f2fd92da8,0x2c72aa1fafd9ada8,0x2f0e2ea7a246af64,0x2b8bac72aff6aa1f,0x2a1fada8af640000,0x2a1fada8af640000,0xafa8ac722d132f64,0x28a5aea7ae2f2a1f,0xa63e2f642c72ada8,0x263eaf64ac722da8,0x2ff6263eafa8aa1f,0x2246afd9a8a52f64
.quad 0x8000b00000003000,0x8000b00000003000,0x28a5afd9a2463000,0x2fa8263eaff60000,0x2c72af64a63e3000,0xac722f64263eb000,0x2e2faea7a8a53000,0xad13ac722fa88000,0x2f64ada8aa1f3000,0x2f64ada8aa1f3000,0x2ff6ac72ab8b3000,0x22462ea7af0e0000,0x2fd9aa1fac723000,0xafd92a1f2c72b000,0x2f0ea63ead133000,0x2b8bafd92e2f8000
.quad 0x2da88000ada83000,0x2da88000ada83000,0x2b8b263eae2f3000,0xaf0e2fd9ad130000,0x263e2a1faea73000,0xa63eaa1f2ea7b000,0xa2462c72af0e3000,0x2ff6aea72b8b8000,0xaa1f2da8af643000,0xaa1f2da8af643000,0xad132ea7afa83000,0xae2f2c72a8a50000,0xaea72f64afd93000,0x2ea7af642fd9b000,0xafa82fd9aff63000,0x28a5a63e22468000
.quad 0x8000b00000003000,0x8000b00000003000,0x2d13aea7ab8b2f64,0x2e2f2c72af0eaa1f,0x2fd9aa1faea72da8,0xafd92a1f2ea7ada8,0x2f0e263eaff62a1f,0x2b8bafd922462f64,0x2a1f2da8af640000,0x2a1f2da8af640000,0xa8a52fd9ad13aa1f,0xafa8263e2e2faf64,0xaea72f64a63eada8,0x2ea7af64263e2da8,0xaff62c7228a5af64,0xa2462ea7afa82a1f
.quad 0xada800002da8b000,0xada800002da8b000,0xa246ac722fa8af64,0x2ff6aea728a52a1f,0x2c72af642fd9ada8,0xac722f64afd92da8,0x2fa8afd92e2faa1f,0xa8a5a63e2d13af64,0x2f64ada82a1f8000,0x2f64ada82a1f8000,0x2b8ba63ea2462a1f,0xaf0e2fd9aff62f64,0xa63e2a1fac722da8,0x263eaa1f2c72ada8,0xae2f2ea7af0e2f64,0x2d13ac722b8baa1f
.quad 0x8000b00000003000,0x8000b00000003000,0x2f0eac72ae2f2da8,0x2b8b2ea7ad13ada8,0x2ea72a1fafd90000,0xaea7aa1f2fd98000,0xa2462fd9ab8bada8,0x2ff6a63eaf0e2da8,0xaf642da82a1fb000,0xaf642da82a1fb000,0xae2fa63e2fa8ada8,0x2d13afd928a52da8,0x263eaf642ea78000,0xa63e2f64aea70000,0x2fa8aea722462da8,0xa8a5ac722ff6ada8
.quad 0x2da88000ada83000,0x2da88000ada83000,0xa8a52ea7aff62da8,0xafa82c722246ada8,0xafd92f64ac720000,0x2fd9af642c728000,0xad13263e28a5ada8,0xae2f2fd9afa82da8,0x2a1fada82f64b000,0x2a1fada82f64b000,0x2ff6afd92f0eada8,0x2246263eab8b2da8,0x2c72aa1f263e8000,0xac722a1fa63e0000,0xab8b2c72ad132da8,0x2f0eaea72e2fada8
.quad 0x8000b00000003000,0x8000b00000003000,0x2ff6a63eafa82a1f,0x22462fd9a8a5af64,0x263e2f64ac72ada8,0xa63eaf642c722da8,0xafa82c722d13af64,0x28a52ea7ae2faa1f,0xaa1fada82f648000,0xaa1fada82f648000,0x2f0eaea7a2462f64,0x2b8b2c72aff62a1f,0x2c722a1fafd92da8,0xac72aa1f2fd9ada8,0xae2f2fd9ab8baa1f,0x2d13263eaf0e2f64
.quad 0xada800002da8b000,0xada800002da8b000,0x2d13afd92f0eaa1f,0x2e2fa63eab8b2f64,0x2ea7aa1fa63e2da8,0xaea72a1f263eada8,0xab8b2ea7aff62f64,0x2f0eac7222462a1f,0xaf642da8aa1f0000,0xaf642da8aa1f0000,0x28a5ac722e2faf64,0x2fa8aea72d13aa1f,0x2fd9af642ea7ada8,0xafd92f64aea72da8,0xa246263ea8a52a1f,0x2ff6afd92fa8af64
.quad 0x8000b00000003000,0x8000b00000003000,0xa8a52fd92246b000,0xafa8a63e2ff68000,0x2c72af64a63e3000,0xac722f64263eb000,0xae2f2ea728a5b000,0x2d132c72afa80000,0x2f64ada8aa1f3000,0x2f64ada8aa1f3000,0xaff62c722b8bb000,0xa246aea72f0e8000,0x2fd9aa1fac723000,0xafd92a1f2c72b000,0xaf0e263e2d13b000,0xab8b2fd9ae2f0000
.quad 0x2da88000ada83000,0x2da88000ada83000,0xab8ba63e2e2fb000,0x2f0eafd92d138000,0x263e2a1faea73000,0xa63eaa1f2ea7b000,0x2246ac722f0eb000,0xaff62ea7ab8b0000,0xaa1f2da8af643000,0xaa1f2da8af643000,0x2d13aea72fa8b000,0x2e2fac7228a58000,0xaea72f64afd93000,0x2ea7af642fd9b000,0x2fa8afd92ff6b000,0xa8a5263ea2460000
.quad 0x8000b00000003000,0x8000b00000003000,0xad132ea72b8baf64,0xae2fac722f0e2a1f,0x2fd9aa1faea72da8,0xafd92a1f2ea7ada8,0xaf0ea63e2ff6aa1f,0xab8b2fd9a246af64,0x2a1f2da8af640000,0x2a1f2da8af640000,0x28a5afd92d132a1f,0x2fa8a63eae2f2f64,0xaea72f64a63eada8,0x2ea7af64263e2da8,0x2ff6ac72a8a52f64,0x2246aea72fa8aa1f
.quad 0xada800002da8b000,0xada800002da8b000,0x22462c72afa82f64,0xaff62ea7a8a5aa1f,0x2c72af642fd9ada8,0xac722f64afd92da8,0xafa82fd9ae2f2a1f,0x28a5263ead132f64,0x2f64ada82a1f8000,0x2f64ada82a1f8000,0xab8b263e2246aa1f,0x2f0eafd92ff6af64,0xa63e2a1fac722da8,0x263eaa1f2c72ada8,0x2e2faea72f0eaf64,0xad132c72ab8b2a1f
.quad 0x8000b00000003000,0x8000b00000003000,0xaf0e2c722e2fada8,0xab8baea72d132da8,0x2ea72a1fafd90000,0xaea7aa1f2fd98000,0x2246afd92b8b2da8,0xaff6263e2f0eada8,0xaf642da82a1fb000,0xaf642da82a1fb000,0x2e2f263eafa82da8,0xad132fd9a8a5ada8,0x263eaf642ea78000,0xa63e2f64aea70000,0xafa82ea7a246ada8,0x28a52c72aff62da8
.quad 0x2da88000ada83000,0x2da88000ada83000,0x28a5aea72ff6ada8,0x2fa8ac72a2462da8,0xafd92f64ac720000,0x2fd9af642c728000,0x2d13a63ea8a52da8,0x2e2fafd92fa8ada8,0x2a1fada82f64b000,0x2a1fada82f64b000,0xaff62fd9af0e2da8,0xa246a63e2b8bada8,0x2c72aa1f263e8000,0xac722a1fa63e0000,0x2b8bac722d13ada8,0xaf0e2ea7ae2f2da8
.quad 0x8000b00000003000,0x8000b00000003000,0xaff6263e2fa8aa1f,0xa246afd928a52f64,0x263e2f64ac72ada8,0xa63eaf642c722da8,0x2fa8ac72ad132f64,0xa8a5aea72e2f2a1f,0xaa1fada82f648000,0xaa1fada82f648000,0xaf0e2ea72246af64,0xab8bac722ff6aa1f,0x2c722a1fafd92da8,0xac72aa1f2fd9ada8,0x2e2fafd92b8b2a1f,0xad13a63e2f0eaf64
.quad 0xada800002da8b000,0xada800002da8b000,0xad132fd9af0e2a1f,0xae2f263e2b8baf64,0x2ea7aa1fa63e2da8,0xaea72a1f263eada8,0x2b8baea72ff6af64,0xaf0e2c72a246aa1f,0xaf642da8aa1f0000,0xaf642da8aa1f0000,0xa8a52c72ae2f2f64,0xafa82ea7ad132a1f,0x2fd9af642ea7ada8,0xafd92f64aea72da8,0x2246a63e28a5aa1f,0xaff62fd9afa82f64
.quad 0xb0003000b0003000,0xb0003000b0003000,0xafa82fd9aff63000,0x28a5a63e22460000,0xaea72f64afd93000,0x2ea7af642fd9b000,0xad132ea7afa83000,0xae2f2c72a8a58000,0xaa1f2da8af643000,0xaa1f2da8af643000,0xa2462c72af0e3000,0x2ff6aea72b8b0000,0x263e2a1faea73000,0xa63eaa1f2ea7b000,0x2b8b263eae2f3000,0xaf0e2fd9ad138000
.quad 0x2da80000ada83000,0x2da80000ada83000,0x2f0ea63ead133000,0x2b8bafd92e2f0000,0x2fd9aa1fac723000,0xafd92a1f2c72b000,0x2ff6ac72ab8b3000,0x22462ea7af0e8000,0x2f64ada8aa1f3000,0x2f64ada8aa1f3000,0x2e2faea7a8a53000,0xad13ac722fa80000,0x2c72af64a63e3000,0xac722f64263eb000,0x28a5afd9a2463000,0x2fa8263eaff68000
.quad 0xb0003000b0003000,0xb0003000b0003000,0xae2f2ea7af0e2f64,0x2d13ac722b8baa1f,0xa63e2a1fac722da8,0x263eaa1f2c72ada8,0x2b8ba63ea2462a1f,0xaf0e2fd9aff62f64,0x2f64ada82a1f0000,0x2f64ada82a1f0000,0x2fa8afd92e2faa1f,0xa8a5a63e2d13af64,0x2c72af642fd9ada8,0xac722f64afd92da8,0xa246ac722fa8af64,0x2ff6aea728a52a1f
.quad 0xada880002da8b000,0xada880002da8b000,0xaff62c7228a5af64,0xa2462ea7afa82a1f,0xaea72f64a63eada8,0x2ea7af64263e2da8,0xa8a52fd9ad13aa1f,0xafa8263e2e2faf64,0x2a1f2da8af648000,0x2a1f2da8af648000,0x2f0e263eaff62a1f,0x2b8bafd922462f64,0x2fd9aa1faea72da8,0xafd92a1f2ea7ada8,0x2d13aea7ab8b2f64,0x2e2f2c72af0eaa1f
.quad 0xb0003000b0003000,0xb0003000b0003000,0xab8b2c72ad132da8,0x2f0eaea72e2fada8,0x2c72aa1f263e0000,0xac722a1fa63e8000,0x2ff6afd92f0eada8,0x2246263eab8b2da8,0x2a1fada82f64b000,0x2a1fada82f64b000,0xad13263e28a5ada8,0xae2f2fd9afa82da8,0xafd92f64ac728000,0x2fd9af642c720000,0xa8a52ea7aff62da8,0xafa82c722246ada8
.quad 0x2da80000ada83000,0x2da80000ada83000,0x2fa8aea722462da8,0xa8a5ac722ff6ada8,0x263eaf642ea70000,0xa63e2f64aea78000,0xae2fa63e2fa8ada8,0x2d13afd928a52da8,0xaf642da82a1fb000,0xaf642da82a1fb000,0xa2462fd9ab8bada8,0x2ff6a63eaf0e2da8,0x2ea72a1fafd98000,0xaea7aa1f2fd90000,0x2f0eac72ae2f2da8,0x2b8b2ea7ad13ada8
.quad 0xb0003000b0003000,0xb0003000b0003000,0xa246263ea8a52a1f,0x2ff6afd92fa8af64,0x2fd9af642ea7ada8,0xafd92f64aea72da8,0x28a5ac722e2faf64,0x2fa8aea72d13aa1f,0xaf642da8aa1f8000,0xaf642da8aa1f8000,0xab8b2ea7aff62f64,0x2f0eac7222462a1f,0x2ea7aa1fa63e2da8,0xaea72a1f263eada8,0x2d13afd92f0eaa1f,0x2e2fa63eab8b2f64
.quad 0xada880002da8b000,0xada880002da8b000,0xae2f2fd9ab8baa1f,0x2d13263eaf0e2f64,0x2c722a1fafd92da8,0xac72aa1f2fd9ada8,0x2f0eaea7a2462f64,0x2b8b2c72aff62a1f,0xaa1fada82f640000,0xaa1fada82f640000,0xafa82c722d13af64,0x28a52ea7ae2faa1f,0x263e2f64ac72ada8,0xa63eaf642c722da8,0x2ff6a63eafa82a1f,0x22462fd9a8a5af64
.quad 0xb0003000b0003000,0xb0003000b0003000,0x2fa8afd92ff6b000,0xa8a5263ea2468000,0xaea72f64afd93000,0x2ea7af642fd9b000,0x2d13aea72fa8b000,0x2e2fac7228a50000,0xaa1f2da8af643000,0xaa1f2da8af643000,0x2246ac722f0eb000,0xaff62ea7ab8b8000,0x263e2a1faea73000,0xa63eaa1f2ea7b000,0xab8ba63e2e2fb000,0x2f0eafd92d130000
.quad 0x2da80000ada83000,0x2da80000ada83000,0xaf0e263e2d13b000,0xab8b2fd9ae2f8000,0x2fd9aa1fac723000,0xafd92a1f2c72b000,0xaff62c722b8bb000,0xa246aea72f0e0000,0x2f64ada8aa1f3000,0x2f64ada8aa1f3000,0xae2f2ea728a5b000,0x2d132c72afa88000,0x2c72af64a63e3000,0xac722f64263eb000,0xa8a52fd92246b000,0xafa8a63e2ff60000
.quad 0xb0003000b0003000,0xb0003000b0003000,0x2e2faea72f0eaf64,0xad132c72ab8b2a1f,0xa63e2a1fac722da8,0x263eaa1f2c72ada8,0xab8b263e2246aa1f,0x2f0eafd92ff6af64,0x2f64ada82a1f0000,0x2f64ada82a1f0000,0xafa82fd9ae2f2a1f,0x28a5263ead132f64,0x2c72af642fd9ada8,0xac722f64afd92da8,0x22462c72afa82f64,0xaff62ea7a8a5aa1f
.quad 0xada880002da8b000,0xada880002da8b000,0x2ff6ac72a8a52f64,0x2246aea72fa8aa1f,0xaea72f64a63eada8,0x2ea7af64263e2da8,0x28a5afd92d132a1f,0x2fa8a63eae2f2f64,0x2a1f2da8af648000,0x2a1f2da8af648000,0xaf0ea63e2ff6aa1f,0xab8b2fd9a246af64,0x2fd9aa1faea72da8,0xafd92a1f2ea7ada8,0xad132ea72b8baf64,0xae2fac722f0e2a1f
.quad 0xb0003000b0003000,0xb0003000b0003000,0x2b8bac722d13ada8,0xaf0e2ea7ae2f2da8,0x2c72aa1f263e0000,0xac722a1fa63e8000,0xaff62fd9af0e2da8,0xa246a63e2b8bada8,0x2a1fada82f64b000,0x2a1fada82f64b000,0x2d13a63ea8a52da8,0x2e2fafd92fa8ada8,0xafd92f64ac728000,0x2fd9af642c720000,0x28a5aea72ff6ada8,0x2fa8ac72a2462da8
.quad 0x2da80000ada83000,0x2da80000ada83000,0xafa82ea7a246ada8,0x28a52c72aff62da8,0x263eaf642ea70000,0xa63e2f64aea78000,0x2e2f263eafa82da8,0xad132fd9a8a5ada8,0xaf642da82a1fb000,0xaf642da82a1fb000,0x2246afd92b8b2da8,0xaff6263e2f0eada8,0x2ea72a1fafd98000,0xaea7aa1f2fd90000,0xaf0e2c722e2fada8,0xab8baea72d132da8
.quad 0xb0003000b0003000,0xb0003000b0003000,0x2246a63e28a5aa1f,0xaff62fd9afa82f64,0x2fd9af642ea7ada8,0xafd92f64aea72da8,0xa8a52c72ae2f2f64,0xafa82ea7ad132a1f,0xaf642da8aa1f8000,0xaf642da8aa1f8000,0x2b8baea72ff6af64,0xaf0e2c72a246aa1f,0x2ea7aa1fa63e2da8,0xaea72a1f263eada8,0xad132fd9af0e2a1f,0xae2f263e2b8baf64
.quad 0xada880002da8b000,0xada880002da8b000,0x2e2fafd92b8b2a1f,0xad13a63e2f0eaf64,0x2c722a1fafd92da8,0xac72aa1f2fd9ada8,0xaf0e2ea72246af64,0xab8bac722ff6aa1f,0xaa1fada82f640000,0xaa1fada82f640000,0x2fa8ac72ad132f64,0xa8a5aea72e2f2a1f,0x263e2f64ac72ada8,0xa63eaf642c722da8,0xaff6263e2fa8aa1f,0xa246afd928a52f64
.quad 0xb00080003000,0xb00080003000,0xa8a5afd922463000,0xafa8263e2ff60000,0xac72af64263e3000,0x2c722f64a63eb000,0xae2faea728a53000,0x2d13ac72afa88000,0xaf64ada82a1f3000,0xaf64ada82a1f3000,0xaff6ac722b8b3000,0xa2462ea72f0e0000,0xafd9aa1f2c723000,0x2fd92a1fac72b000,0xaf0ea63e2d133000,0xab8bafd9ae2f8000
.quad 0xada880002da83000,0xada880002da83000,0xab8b263e2e2f3000,0x2f0e2fd92d130000,0xa63e2a1f2ea73000,0x263eaa1faea7b000,0x22462c722f0e3000,0xaff6aea7ab8b8000,0x2a1f2da82f643000,0x2a1f2da82f643000,0x2d132ea72fa83000,0x2e2f2c7228a50000,0x2ea72f642fd93000,0xaea7af64afd9b000,0x2fa82fd92ff63000,0xa8a5a63ea2468000
.quad 0xb00080003000,0xb00080003000,0xad13aea72b8b2f64,0xae2f2c722f0eaa1f,0xafd9aa1f2ea72da8,0x2fd92a1faea7ada8,0xaf0e263e2ff62a1f,0xab8bafd9a2462f64,0xaa1f2da82f640000,0xaa1f2da82f640000,0x28a52fd92d13aa1f,0x2fa8263eae2faf64,0x2ea72f64263eada8,0xaea7af64a63e2da8,0x2ff62c72a8a5af64,0x22462ea72fa82a1f
.quad 0x2da80000ada8b000,0x2da80000ada8b000,0x2246ac72afa8af64,0xaff6aea7a8a52a1f,0xac72af64afd9ada8,0x2c722f642fd92da8,0xafa8afd9ae2faa1f,0x28a5a63ead13af64,0xaf64ada8aa1f8000,0xaf64ada8aa1f8000,0xab8ba63e22462a1f,0x2f0e2fd92ff62f64,0x263e2a1f2c722da8,0xa63eaa1fac72ada8,0x2e2f2ea72f0e2f64,0xad13ac72ab8baa1f
.quad 0xb00080003000,0xb00080003000,0xaf0eac722e2f2da8,0xab8b2ea72d13ada8,0xaea72a1f2fd90000,0x2ea7aa1fafd98000,0x22462fd92b8bada8,0xaff6a63e2f0e2da8,0x2f642da8aa1fb000,0x2f642da8aa1fb000,0x2e2fa63eafa8ada8,0xad13afd9a8a52da8,0xa63eaf64aea78000,0x263e2f642ea70000,0xafa8aea7a2462da8,0x28a5ac72aff6ada8
.quad 0xada880002da83000,0xada880002da83000,0x28a52ea72ff62da8,0x2fa82c72a246ada8,0x2fd92f642c720000,0xafd9af64ac728000,0x2d13263ea8a5ada8,0x2e2f2fd92fa82da8,0xaa1fada8af64b000,0xaa1fada8af64b000,0xaff6afd9af0eada8,0xa246263e2b8b2da8,0xac72aa1fa63e8000,0x2c722a1f263e0000,0x2b8b2c722d132da8,0xaf0eaea7ae2fada8
.quad 0xb00080003000,0xb00080003000,0xaff6a63e2fa82a1f,0xa2462fd928a5af64,0xa63e2f642c72ada8,0x263eaf64ac722da8,0x2fa82c72ad13af64,0xa8a52ea72e2faa1f,0x2a1fada8af648000,0x2a1fada8af648000,0xaf0eaea722462f64,0xab8b2c722ff62a1f,0xac722a1f2fd92da8,0x2c72aa1fafd9ada8,0x2e2f2fd92b8baa1f,0xad13263e2f0e2f64
.quad 0x2da80000ada8b000,0x2da80000ada8b000,0xad13afd9af0eaa1f,0xae2fa63e2b8b2f64,0xaea7aa1f263e2da8,0x2ea72a1fa63eada8,0x2b8b2ea72ff62f64,0xaf0eac72a2462a1f,0x2f642da82a1f0000,0x2f642da82a1f0000,0xa8a5ac72ae2faf64,0xafa8aea7ad13aa1f,0xafd9af64aea7ada8,0x2fd92f642ea72da8,0x2246263e28a52a1f,0xaff6afd9afa8af64
.quad 0xb00080003000,0xb00080003000,0x28a52fd9a246b000,0x2fa8a63eaff68000,0xac72af64263e3000,0x2c722f64a63eb000,0x2e2f2ea7a8a5b000,0xad132c722fa80000,0xaf64ada82a1f3000,0xaf64ada82a1f3000,0x2ff62c72ab8bb000,0x2246aea7af0e8000,0xafd9aa1f2c723000,0x2fd92a1fac72b000,0x2f0e263ead13b000,0x2b8b2fd92e2f0000
.quad 0xada880002da83000,0xada880002da83000,0x2b8ba63eae2fb000,0xaf0eafd9ad138000,0xa63e2a1f2ea73000,0x263eaa1faea7b000,0xa246ac72af0eb000,0x2ff62ea72b8b0000,0x2a1f2da82f643000,0x2a1f2da82f643000,0xad13aea7afa8b000,0xae2fac72a8a58000,0x2ea72f642fd93000,0xaea7af64afd9b000,0xafa8afd9aff6b000,0x28a5263e22460000
.quad 0xb00080003000,0xb00080003000,0x2d132ea7ab8baf64,0x2e2fac72af0e2a1f,0xafd9aa1f2ea72da8,0x2fd92a1faea7ada8,0x2f0ea63eaff6aa1f,0x2b8b2fd92246af64,0xaa1f2da82f640000,0xaa1f2da82f640000,0xa8a5afd9ad132a1f,0xafa8a63e2e2f2f64,0x2ea72f64263eada8,0xaea7af64a63e2da8,0xaff6ac7228a52f64,0xa246aea7afa8aa1f
.quad 0x2da80000ada8b000,0x2da80000ada8b000,0xa2462c722fa82f64,0x2ff62ea728a5aa1f,0xac72af64afd9ada8,0x2c722f642fd92da8,0x2fa82fd92e2f2a1f,0xa8a5263e2d132f64,0xaf64ada8aa1f8000,0xaf64ada8aa1f8000,0x2b8b263ea246aa1f,0xaf0eafd9aff6af64,0x263e2a1f2c722da8,0xa63eaa1fac72ada8,0xae2faea7af0eaf64,0x2d132c722b8b2a1f
.quad 0xb00080003000,0xb00080003000,0x2f0e2c72ae2fada8,0x2b8baea7ad132da8,0xaea72a1f2fd90000,0x2ea7aa1fafd98000,0xa246afd9ab8b2da8,0x2ff6263eaf0eada8,0x2f642da8aa1fb000,0x2f642da8aa1fb000,0xae2f263e2fa82da8,0x2d132fd928a5ada8,0xa63eaf64aea78000,0x263e2f642ea70000,0x2fa82ea72246ada8,0xa8a52c722ff62da8
.quad 0xada880002da83000,0xada880002da83000,0xa8a5aea7aff6ada8,0xafa8ac7222462da8,0x2fd92f642c720000,0xafd9af64ac728000,0xad13a63e28a52da8,0xae2fafd9afa8ada8,0xaa1fada8af64b000,0xaa1fada8af64b000,0x2ff62fd92f0e2da8,0x2246a63eab8bada8,0xac72aa1fa63e8000,0x2c722a1f263e0000,0xab8bac72ad13ada8,0x2f0e2ea72e2f2da8
.quad 0xb00080003000,0xb00080003000,0x2ff6263eafa8aa1f,0x2246afd9a8a52f64,0xa63e2f642c72ada8,0x263eaf64ac722da8,0xafa8ac722d132f64,0x28a5aea7ae2f2a1f,0x2a1fada8af648000,0x2a1fada8af648000,0x2f0e2ea7a246af64,0x2b8bac72aff6aa1f,0xac722a1f2fd92da8,0x2c72aa1fafd9ada8,0xae2fafd9ab8b2a1f,0x2d13a63eaf0eaf64
.quad 0x2da80000ada8b000,0x2da80000ada8b000,0x2d132fd92f0e2a1f,0x2e2f263eab8baf64,0xaea7aa1f263e2da8,0x2ea72a1fa63eada8,0xab8baea7aff6af64,0x2f0e2c722246aa1f,0x2f642da82a1f0000,0x2f642da82a1f0000,0x28a52c722e2f2f64,0x2fa82ea72d132a1f,0xafd9af64aea7ada8,0x2fd92f642ea72da8,0xa246a63ea8a5aa1f,0x2ff62fd92fa82f64
.quad 0x8000800080008000,0x8000800080008000,0xa8a5a63ea2468000,0xafa8afd9aff6b000,0xac72aa1fa63e8000,0x2c722a1f263e8000,0xae2fac72a8a58000,0x2d132ea72fa83000,0xaf64ada8aa1f8000,0xaf64ada8aa1f8000,0xaff6aea7ab8b8000,0xa246ac72af0eb000,0xafd9af64ac728000,0x2fd92f642c728000,0xaf0eafd9ad138000,0xab8b263e2e2f3000
.quad 0xada8b000ada88000,0xada8b000ada88000,0xab8bafd9ae2f8000,0x2f0e263ead13b000,0xa63eaf64aea78000,0x263e2f642ea78000,0x2246aea7af0e8000,0xaff6ac722b8b3000,0x2a1fada8af648000,0x2a1fada8af648000,0x2d13ac72afa88000,0x2e2f2ea7a8a5b000,0x2ea7aa1fafd98000,0xaea72a1f2fd98000,0x2fa8a63eaff68000,0xa8a5afd922463000
.quad 0x8000800080008000,0x8000800080008000,0xad13ac72ab8baa1f,0xae2faea7af0eaf64,0xafd9af64aea7ada8,0x2fd92f642ea72da8,0xaf0eafd9aff6af64,0xab8ba63e22462a1f,0xaa1fada8af64b000,0xaa1fada8af64b000,0x28a5a63ead13af64,0x2fa82fd92e2f2a1f,0x2ea72a1fa63eada8,0xaea7aa1f263e2da8,0x2ff62ea728a5aa1f,0x2246ac72afa8af64
.quad 0x2da830002da88000,0x2da830002da88000,0x22462ea72fa82a1f,0xaff6ac7228a52f64,0xac722a1f2fd92da8,0x2c72aa1fafd9ada8,0xafa8a63e2e2f2f64,0x28a52fd92d13aa1f,0xaf64ada82a1f3000,0xaf64ada82a1f3000,0xab8bafd9a2462f64,0x2f0ea63eaff6aa1f,0x263eaf64ac722da8,0xa63e2f642c72ada8,0x2e2fac72af0e2a1f,0xad13aea72b8b2f64
.quad 0x8000800080008000,0x8000800080008000,0xaf0eaea7ae2fada8,0xab8bac72ad13ada8,0xaea7af64afd9b000,0x2ea72f642fd93000,0x2246a63eab8bada8,0xaff6afd9af0eada8,0x2f642da82a1f8000,0x2f642da82a1f8000,0x2e2f2fd92fa82da8,0xad13a63e28a52da8,0xa63e2a1f2ea73000,0x263eaa1faea7b000,0xafa8ac7222462da8,0x28a52ea72ff62da8
.quad 0xada8b000ada88000,0xada8b000ada88000,0x28a5ac72aff6ada8,0x2fa82ea72246ada8,0x2fd92a1fac72b000,0xafd9aa1f2c723000,0x2d132fd928a5ada8,0x2e2fa63eafa8ada8,0xaa1f2da82f648000,0xaa1f2da82f648000,0xaff6a63e2f0e2da8,0xa246afd9ab8b2da8,0xac72af64263e3000,0x2c722f64a63eb000,0x2b8baea7ad132da8,0xaf0eac722e2f2da8
.quad 0x8000800080008000,0x8000800080008000,0xaff6afd9afa8af64,0xa246a63ea8a5aa1f,0xa63eaa1fac72ada8,0x263e2a1f2c722da8,0x2fa82ea72d132a1f,0xa8a5ac72ae2faf64,0x2a1f2da82f643000,0x2a1f2da82f643000,0xaf0eac72a2462a1f,0xab8baea7aff6af64,0xac72af64afd9ada8,0x2c722f642fd92da8,0x2e2f263eab8baf64,0xad13afd9af0eaa1f
.quad 0x2da830002da88000,0x2da830002da88000,0xad13263e2f0e2f64,0xae2fafd9ab8b2a1f,0xaea7af64a63e2da8,0x2ea72f64263eada8,0x2b8bac72aff6aa1f,0xaf0eaea722462f64,0x2f642da8aa1fb000,0x2f642da8aa1fb000,0xa8a52ea72e2faa1f,0xafa8ac722d132f64,0xafd9aa1f2ea72da8,0x2fd92a1faea7ada8,0x2246afd9a8a52f64,0xaff6a63e2fa82a1f
.quad 0x8000800080008000,0x8000800080008000,0x28a5263e22468000,0x2fa82fd92ff63000,0xac72aa1fa63e8000,0x2c722a1f263e8000,0x2e2f2c7228a58000,0xad13aea7afa8b000,0xaf64ada8aa1f8000,0xaf64ada8aa1f8000,0x2ff62ea72b8b8000,0x22462c722f0e3000,0xafd9af64ac728000,0x2fd92f642c728000,0x2f0e2fd92d138000,0x2b8ba63eae2fb000
.quad 0xada8b000ada88000,0xada8b000ada88000,0x2b8b2fd92e2f8000,0xaf0ea63e2d133000,0xa63eaf64aea78000,0x263e2f642ea78000,0xa2462ea72f0e8000,0x2ff62c72ab8bb000,0x2a1fada8af648000,0x2a1fada8af648000,0xad132c722fa88000,0xae2faea728a53000,0x2ea7aa1fafd98000,0xaea72a1f2fd98000,0xafa8263e2ff68000,0x28a52fd9a246b000
.quad 0x8000800080008000,0x8000800080008000,0x2d132c722b8b2a1f,0x2e2f2ea72f0e2f64,0xafd9af64aea7ada8,0x2fd92f642ea72da8,0x2f0e2fd92ff62f64,0x2b8b263ea246aa1f,0xaa1fada8af64b000,0xaa1fada8af64b000,0xa8a5263e2d132f64,0xafa8afd9ae2faa1f,0x2ea72a1fa63eada8,0xaea7aa1f263e2da8,0xaff6aea7a8a52a1f,0xa2462c722fa82f64
.quad 0x2da830002da88000,0x2da830002da88000,0xa246aea7afa8aa1f,0x2ff62c72a8a5af64,0xac722a1f2fd92da8,0x2c72aa1fafd9ada8,0x2fa8263eae2faf64,0xa8a5afd9ad132a1f,0xaf64ada82a1f3000,0xaf64ada82a1f3000,0x2b8b2fd92246af64,0xaf0e263e2ff62a1f,0x263eaf64ac722da8,0xa63e2f642c72ada8,0xae2f2c722f0eaa1f,0x2d132ea7ab8baf64
.quad 0x8000800080008000,0x8000800080008000,0x2f0e2ea72e2f2da8,0x2b8b2c722d132da8,0xaea7af64afd9b000,0x2ea72f642fd93000,0xa246263e2b8b2da8,0x2ff62fd92f0e2da8,0x2f642da82a1f8000,0x2f642da82a1f8000,0xae2fafd9afa8ada8,0x2d13263ea8a5ada8,0xa63e2a1f2ea73000,0x263eaa1faea7b000,0x2fa82c72a246ada8,0xa8a5aea7aff6ada8
.quad 0xada8b000ada88000,0xada8b000ada88000,0xa8a52c722ff62da8,0xafa8aea7a2462da8,0x2fd92a1fac72b000,0xafd9aa1f2c723000,0xad13afd9a8a52da8,0xae2f263e2fa82da8,0xaa1f2da82f648000,0xaa1f2da82f648000,0x2ff6263eaf0eada8,0x22462fd92b8bada8,0xac72af64263e3000,0x2c722f64a63eb000,0xab8b2ea72d13ada8,0x2f0e2c72ae2fada8
.quad 0x8000800080008000,0x8000800080008000,0x2ff62fd92fa82f64,0x2246263e28a52a1f,0xa63eaa1fac72ada8,0x263e2a1f2c722da8,0xafa8aea7ad13aa1f,0x28a52c722e2f2f64,0x2a1f2da82f643000,0x2a1f2da82f643000,0x2f0e2c722246aa1f,0x2b8b2ea72ff62f64,0xac72af64afd9ada8,0x2c722f642fd92da8,0xae2fa63e2b8b2f64,0x2d132fd92f0e2a1f
.quad 0x2da830002da88000,0x2da830002da88000,0x2d13a63eaf0eaf64,0x2e2f2fd92b8baa1f,0xaea7af64a63e2da8,0x2ea72f64263eada8,0xab8b2c722ff62a1f,0x2f0e2ea7a246af64,0x2f642da8aa1fb000,0x2f642da8aa1fb000,0x28a5aea7ae2f2a1f,0x2fa82c72ad13af64,0xafd9aa1f2ea72da8,0x2fd92a1faea7ada8,0xa2462fd928a5af64,0x2ff6263eafa8aa1f
.quad 0x30008000b0008000,0x30008000b0008000,0x2fa8263eaff68000,0xa8a52fd92246b000,0x2ea72a1fafd98000,0xaea7aa1f2fd98000,0x2d132c72afa88000,0x2e2faea7a8a53000,0x2a1f2da8af648000,0x2a1f2da8af648000,0x22462ea7af0e8000,0xaff62c722b8bb000,0xa63e2f64aea78000,0x263eaf642ea78000,0xab8b2fd9ae2f8000,0x2f0ea63ead133000
.quad 0xada83000ada88000,0xada83000ada88000,0xaf0e2fd9ad138000,0xab8ba63e2e2fb000,0xafd92f64ac728000,0x2fd9af642c728000,0xaff62ea7ab8b8000,0xa2462c72af0e3000,0xaf642da8aa1f8000,0xaf642da8aa1f8000,0xae2f2c72a8a58000,0x2d13aea72fa8b000,0xac722a1fa63e8000,0x2c72aa1f263e8000,0xa8a5263ea2468000,0xafa82fd9aff63000
.quad 0x30008000b0008000,0x30008000b0008000,0x2e2f2c72af0eaa1f,0xad132ea72b8baf64,0x263e2f64ac72ada8,0xa63eaf642c722da8,0xab8b2fd9a246af64,0x2f0e263eaff62a1f,0xaf642da82a1fb000,0xaf642da82a1fb000,0xafa8263e2e2faf64,0x28a5afd92d132a1f,0xac72aa1f2fd9ada8,0x2c722a1fafd92da8,0x2246aea72fa8aa1f,0xaff62c7228a5af64
.quad 0x2da8b0002da88000,0x2da8b0002da88000,0x2ff6aea728a52a1f,0x22462c72afa82f64,0x2ea7aa1fa63e2da8,0xaea72a1f263eada8,0x28a5263ead132f64,0x2fa8afd92e2faa1f,0xaa1f2da8af643000,0xaa1f2da8af643000,0xaf0e2fd9aff62f64,0xab8b263e2246aa1f,0xafd92f64aea72da8,0x2fd9af642ea7ada8,0xad132c72ab8b2a1f,0xae2f2ea7af0e2f64
.quad 0x30008000b0008000,0x30008000b0008000,0x2b8b2ea7ad13ada8,0xaf0e2c722e2fada8,0xac722f64263eb000,0x2c72af64a63e3000,0xaff6263e2f0eada8,0xa2462fd9ab8bada8,0xaa1fada82f648000,0xaa1fada82f648000,0x2d13afd928a52da8,0x2e2f263eafa82da8,0x2fd9aa1fac723000,0xafd92a1f2c72b000,0x28a52c72aff62da8,0x2fa8aea722462da8
.quad 0xada83000ada88000,0xada83000ada88000,0xafa82c722246ada8,0x28a5aea72ff6ada8,0xa63eaa1f2ea7b000,0x263e2a1faea73000,0x2e2fafd92fa8ada8,0xad13263e28a5ada8,0x2f64ada82a1f8000,0x2f64ada82a1f8000,0x2246263eab8b2da8,0xaff62fd9af0e2da8,0xaea72f64afd93000,0x2ea7af642fd9b000,0xaf0e2ea7ae2f2da8,0xab8b2c72ad132da8
.quad 0x30008000b0008000,0x30008000b0008000,0x22462fd9a8a5af64,0xaff6263e2fa8aa1f,0xafd92a1f2ea7ada8,0x2fd9aa1faea72da8,0xa8a5aea72e2f2a1f,0xafa82c722d13af64,0x2f64ada8aa1f3000,0x2f64ada8aa1f3000,0x2b8b2c72aff62a1f,0xaf0e2ea72246af64,0xaea72f64a63eada8,0x2ea7af64263e2da8,0xad13a63e2f0eaf64,0xae2f2fd9ab8baa1f
.quad 0x2da8b0002da88000,0x2da8b0002da88000,0x2e2fa63eab8b2f64,0xad132fd9af0e2a1f,0xac722f64afd92da8,0x2c72af642fd9ada8,0xaf0e2c72a246aa1f,0xab8b2ea7aff62f64,0x2a1fada82f64b000,0x2a1fada82f64b000,0x2fa8aea72d13aa1f,0xa8a52c72ae2f2f64,0xa63e2a1fac722da8,0x263eaa1f2c72ada8,0xaff62fd9afa82f64,0xa246263ea8a52a1f
.quad 0x30008000b0008000,0x30008000b0008000,0xafa8a63e2ff68000,0x28a5afd9a2463000,0x2ea72a1fafd98000,0xaea7aa1f2fd98000,0xad13ac722fa88000,0xae2f2ea728a5b000,0x2a1f2da8af648000,0x2a1f2da8af648000,0xa246aea72f0e8000,0x2ff6ac72ab8b3000,0xa63e2f64aea78000,0x263eaf642ea78000,0x2b8bafd92e2f8000,0xaf0e263e2d13b000
.quad 0xada83000ada88000,0xada83000ada88000,0x2f0eafd92d138000,0x2b8b263eae2f3000,0xafd92f64ac728000,0x2fd9af642c728000,0x2ff6aea72b8b8000,0x2246ac722f0eb000,0xaf642da8aa1f8000,0xaf642da8aa1f8000,0x2e2fac7228a58000,0xad132ea7afa83000,0xac722a1fa63e8000,0x2c72aa1f263e8000,0x28a5a63e22468000,0x2fa8afd92ff6b000
.quad 0x30008000b0008000,0x30008000b0008000,0xae2fac722f0e2a1f,0x2d13aea7ab8b2f64,0x263e2f64ac72ada8,0xa63eaf642c722da8,0x2b8bafd922462f64,0xaf0ea63e2ff6aa1f,0xaf642da82a1fb000,0xaf642da82a1fb000,0x2fa8a63eae2f2f64,0xa8a52fd9ad13aa1f,0xac72aa1f2fd9ada8,0x2c722a1fafd92da8,0xa2462ea7afa82a1f,0x2ff6ac72a8a52f64
.quad 0x2da8b0002da88000,0x2da8b0002da88000,0xaff62ea7a8a5aa1f,0xa246ac722fa8af64,0x2ea7aa1fa63e2da8,0xaea72a1f263eada8,0xa8a5a63e2d13af64,0xafa82fd9ae2f2a1f,0xaa1f2da8af643000,0xaa1f2da8af643000,0x2f0eafd92ff6af64,0x2b8ba63ea2462a1f,0xafd92f64aea72da8,0x2fd9af642ea7ada8,0x2d13ac722b8baa1f,0x2e2faea72f0eaf64
.quad 0x30008000b0008000,0x30008000b0008000,0xab8baea72d132da8,0x2f0eac72ae2f2da8,0xac722f64263eb000,0x2c72af64a63e3000,0x2ff6a63eaf0e2da8,0x2246afd92b8b2da8,0xaa1fada82f648000,0xaa1fada82f648000,0xad132fd9a8a5ada8,0xae2fa63e2fa8ada8,0x2fd9aa1fac723000,0xafd92a1f2c72b000,0xa8a5ac722ff6ada8,0xafa82ea7a246ada8
.quad 0xada83000ada88000,0xada83000ada88000,0x2fa8ac72a2462da8,0xa8a52ea7aff62da8,0xa63eaa1f2ea7b000,0x263e2a1faea73000,0xae2f2fd9afa82da8,0x2d13a63ea8a52da8,0x2f64ada82a1f8000,0x2f64ada82a1f8000,0xa246a63e2b8bada8,0x2ff6afd92f0eada8,0xaea72f64afd93000,0x2ea7af642fd9b000,0x2f0eaea72e2fada8,0x2b8bac722d13ada8
.quad 0x30008000b0008000,0x30008000b0008000,0xa246afd928a52f64,0x2ff6a63eafa82a1f,0xafd92a1f2ea7ada8,0x2fd9aa1faea72da8,0x28a52ea7ae2faa1f,0x2fa8ac72ad132f64,0x2f64ada8aa1f3000,0x2f64ada8aa1f3000,0xab8bac722ff6aa1f,0x2f0eaea7a2462f64,0xaea72f64a63eada8,0x2ea7af64263e2da8,0x2d13263eaf0e2f64,0x2e2fafd92b8b2a1f
.quad 0x2da8b0002da88000,0x2da8b0002da88000,0xae2f263e2b8baf64,0x2d13afd92f0eaa1f,0xac722f64afd92da8,0x2c72af642fd9ada8,0x2f0eac7222462a1f,0x2b8baea72ff6af64,0x2a1fada82f64b000,0x2a1fada82f64b000,0xafa82ea7ad132a1f,0x28a5ac722e2faf64,0xa63e2a1fac722da8,0x263eaa1f2c72ada8,0x2ff6afd92fa8af64,0x2246a63e28a5aa1f
.quad 0x8000800080008000,0x8000800080008000,0x28a5a63e22468000,0x2fa8afd92ff6b000,0x2c72aa1f263e8000,0xac722a1fa63e8000,0x2e2fac7228a58000,0xad132ea7afa83000,0x2f64ada82a1f8000,0x2f64ada82a1f8000,0x2ff6aea72b8b8000,0x2246ac722f0eb000,0x2fd9af642c728000,0xafd92f64ac728000,0x2f0eafd92d138000,0x2b8b263eae2f3000
.quad 0x2da8b0002da88000,0x2da8b0002da88000,0x2b8bafd92e2f8000,0xaf0e263e2d13b000,0x263eaf642ea78000,0xa63e2f64aea78000,0xa246aea72f0e8000,0x2ff6ac72ab8b3000,0xaa1fada82f648000,0xaa1fada82f648000,0xad13ac722fa88000,0xae2f2ea728a5b000,0xaea7aa1f2fd98000,0x2ea72a1fafd98000,0xafa8a63e2ff68000,0x28a5afd9a2463000
.quad 0x8000800080008000,0x8000800080008000,0x2d13ac722b8baa1f,0x2e2faea72f0eaf64,0x2fd9af642ea7ada8,0xafd92f64aea72da8,0x2f0eafd92ff6af64,0x2b8ba63ea2462a1f,0x2a1fada82f64b000,0x2a1fada82f64b000,0xa8a5a63e2d13af64,0xafa82fd9ae2f2a1f,0xaea72a1f263eada8,0x2ea7aa1fa63e2da8,0xaff62ea7a8a5aa1f,0xa246ac722fa8af64
.quad 0xada83000ada88000,0xada83000ada88000,0xa2462ea7afa82a1f,0x2ff6ac72a8a52f64,0x2c722a1fafd92da8,0xac72aa1f2fd9ada8,0x2fa8a63eae2f2f64,0xa8a52fd9ad13aa1f,0x2f64ada8aa1f3000,0x2f64ada8aa1f3000,0x2b8bafd922462f64,0xaf0ea63e2ff6aa1f,0xa63eaf642c722da8,0x263e2f64ac72ada8,0xae2fac722f0e2a1f,0x2d13aea7ab8b2f64
.quad 0x8000800080008000,0x8000800080008000,0x2f0eaea72e2fada8,0x2b8bac722d13ada8,0x2ea7af642fd9b000,0xaea72f64afd93000,0xa246a63e2b8bada8,0x2ff6afd92f0eada8,0xaf642da8aa1f8000,0xaf642da8aa1f8000,0xae2f2fd9afa82da8,0x2d13a63ea8a52da8,0x263e2a1faea73000,0xa63eaa1f2ea7b000,0x2fa8ac72a2462da8,0xa8a52ea7aff62da8
.quad 0x2da8b0002da88000,0x2da8b0002da88000,0xa8a5ac722ff6ada8,0xafa82ea7a246ada8,0xafd92a1f2c72b000,0x2fd9aa1fac723000,0xad132fd9a8a5ada8,0xae2fa63e2fa8ada8,0x2a1f2da8af648000,0x2a1f2da8af648000,0x2ff6a63eaf0e2da8,0x2246afd92b8b2da8,0x2c72af64a63e3000,0xac722f64263eb000,0xab8baea72d132da8,0x2f0eac72ae2f2da8
.quad 0x8000800080008000,0x8000800080008000,0x2ff6afd92fa8af64,0x2246a63e28a5aa1f,0x263eaa1f2c72ada8,0xa63e2a1fac722da8,0xafa82ea7ad132a1f,0x28a5ac722e2faf64,0xaa1f2da8af643000,0xaa1f2da8af643000,0x2f0eac7222462a1f,0x2b8baea72ff6af64,0x2c72af642fd9ada8,0xac722f64afd92da8,0xae2f263e2b8baf64,0x2d13afd92f0eaa1f
.quad 0xada83000ada88000,0xada83000ada88000,0x2d13263eaf0e2f64,0x2e2fafd92b8b2a1f,0x2ea7af64263e2da8,0xaea72f64a63eada8,0xab8bac722ff6aa1f,0x2f0eaea7a2462f64,0xaf642da82a1fb000,0xaf642da82a1fb000,0x28a52ea7ae2faa1f,0x2fa8ac72ad132f64,0x2fd9aa1faea72da8,0xafd92a1f2ea7ada8,0xa246afd928a52f64,0x2ff6a63eafa82a1f
.quad 0x8000800080008000,0x8000800080008000,0xa8a5263ea2468000,0xafa82fd9aff63000,0x2c72aa1f263e8000,0xac722a1fa63e8000,0xae2f2c72a8a58000,0x2d13aea72fa8b000,0x2f64ada82a1f8000,0x2f64ada82a1f8000,0xaff62ea7ab8b8000,0xa2462c72af0e3000,0x2fd9af642c728000,0xafd92f64ac728000,0xaf0e2fd9ad138000,0xab8ba63e2e2fb000
.quad 0x2da8b0002da88000,0x2da8b0002da88000,0xab8b2fd9ae2f8000,0x2f0ea63ead133000,0x263eaf642ea78000,0xa63e2f64aea78000,0x22462ea7af0e8000,0xaff62c722b8bb000,0xaa1fada82f648000,0xaa1fada82f648000,0x2d132c72afa88000,0x2e2faea7a8a53000,0xaea7aa1f2fd98000,0x2ea72a1fafd98000,0x2fa8263eaff68000,0xa8a52fd92246b000
.quad 0x8000800080008000,0x8000800080008000,0xad132c72ab8b2a1f,0xae2f2ea7af0e2f64,0x2fd9af642ea7ada8,0xafd92f64aea72da8,0xaf0e2fd9aff62f64,0xab8b263e2246aa1f,0x2a1fada82f64b000,0x2a1fada82f64b000,0x28a5263ead132f64,0x2fa8afd92e2faa1f,0xaea72a1f263eada8,0x2ea7aa1fa63e2da8,0x2ff6aea728a52a1f,0x22462c72afa82f64
.quad 0xada83000ada88000,0xada83000ada88000,0x2246aea72fa8aa1f,0xaff62c7228a5af64,0x2c722a1fafd92da8,0xac72aa1f2fd9ada8,0xafa8263e2e2faf64,0x28a5afd92d132a1f,0x2f64ada8aa1f3000,0x2f64ada8aa1f3000,0xab8b2fd9a246af64,0x2f0e263eaff62a1f,0xa63eaf642c722da8,0x263e2f64ac72ada8,0x2e2f2c72af0eaa1f,0xad132ea72b8baf64
.quad 0x8000800080008000,0x8000800080008000,0xaf0e2ea7ae2f2da8,0xab8b2c72ad132da8,0x2ea7af642fd9b000,0xaea72f64afd93000,0x2246263eab8b2da8,0xaff62fd9af0e2da8,0xaf642da8aa1f8000,0xaf642da8aa1f8000,0x2e2fafd92fa8ada8,0xad13263e28a5ada8,0x263e2a1faea73000,0xa63eaa1f2ea7b000,0xafa82c722246ada8,0x28a5aea72ff6ada8
.quad 0x2da8b0002da88000,0x2da8b0002da88000,0x28a52c72aff62da8,0x2fa8aea722462da8,0xafd92a1f2c72b000,0x2fd9aa1fac723000,0x2d13afd928a52da8,0x2e2f263eafa82da8,0x2a1f2da8af648000,0x2a1f2da8af648000,0xaff6263e2f0eada8,0xa2462fd9ab8bada8,0x2c72af64a63e3000,0xac722f64263eb000,0x2b8b2ea7ad13ada8,0xaf0e2c722e2fada8
.quad 0x8000800080008000,0x8000800080008000,0xaff62fd9afa82f64,0xa246263ea8a52a1f,0x263eaa1f2c72ada8,0xa63e2a1fac722da8,0x2fa8aea72d13aa1f,0xa8a52c72ae2f2f64,0xaa1f2da8af643000,0xaa1f2da8af643000,0xaf0e2c72a246aa1f,0xab8b2ea7aff62f64,0x2c72af642fd9ada8,0xac722f64afd92da8,0x2e2fa63eab8b2f64,0xad132fd9af0e2a1f
.quad 0xada83000ada88000,0xada83000ada88000,0xad13a63e2f0eaf64,0xae2f2fd9ab8baa1f,0x2ea7af64263e2da8,0xaea72f64a63eada8,0x2b8b2c72aff62a1f,0xaf0e2ea72246af64,0xaf642da82a1fb000,0xaf642da82a1fb000,0xa8a5aea72e2f2a1f,0xafa82c722d13af64,0x2fd9aa1faea72da8,0xafd92a1f2ea7ada8,0x22462fd9a8a5af64,0xaff6263e2fa8aa1f
.quad 0xb000800030008000,0xb000800030008000,0xafa8263e2ff68000,0x28a52fd9a246b000,0xaea72a1f2fd98000,0x2ea7aa1fafd98000,0xad132c722fa88000,0xae2faea728a53000,0xaa1f2da82f648000,0xaa1f2da82f648000,0xa2462ea72f0e8000,0x2ff62c72ab8bb000,0x263e2f642ea78000,0xa63eaf64aea78000,0x2b8b2fd92e2f8000,0xaf0ea63e2d133000
.quad 0x2da830002da88000,0x2da830002da88000,0x2f0e2fd92d138000,0x2b8ba63eae2fb000,0x2fd92f642c728000,0xafd9af64ac728000,0x2ff62ea72b8b8000,0x22462c722f0e3000,0x2f642da82a1f8000,0x2f642da82a1f8000,0x2e2f2c7228a58000,0xad13aea7afa8b000,0x2c722a1f263e8000,0xac72aa1fa63e8000,0x28a5263e22468000,0x2fa82fd92ff63000
.quad 0xb000800030008000,0xb000800030008000,0xae2f2c722f0eaa1f,0x2d132ea7ab8baf64,0xa63e2f642c72ada8,0x263eaf64ac722da8,0x2b8b2fd92246af64,0xaf0e263e2ff62a1f,0x2f642da8aa1fb000,0x2f642da8aa1fb000,0x2fa8263eae2faf64,0xa8a5afd9ad132a1f,0x2c72aa1fafd9ada8,0xac722a1f2fd92da8,0xa246aea7afa8aa1f,0x2ff62c72a8a5af64
.quad 0xada8b000ada88000,0xada8b000ada88000,0xaff6aea7a8a52a1f,0xa2462c722fa82f64,0xaea7aa1f263e2da8,0x2ea72a1fa63eada8,0xa8a5263e2d132f64,0xafa8afd9ae2faa1f,0x2a1f2da82f643000,0x2a1f2da82f643000,0x2f0e2fd92ff62f64,0x2b8b263ea246aa1f,0x2fd92f642ea72da8,0xafd9af64aea7ada8,0x2d132c722b8b2a1f,0x2e2f2ea72f0e2f64
.quad 0xb000800030008000,0xb000800030008000,0xab8b2ea72d13ada8,0x2f0e2c72ae2fada8,0x2c722f64a63eb000,0xac72af64263e3000,0x2ff6263eaf0eada8,0x22462fd92b8bada8,0x2a1fada8af648000,0x2a1fada8af648000,0xad13afd9a8a52da8,0xae2f263e2fa82da8,0xafd9aa1f2c723000,0x2fd92a1fac72b000,0xa8a52c722ff62da8,0xafa8aea7a2462da8
.quad 0x2da830002da88000,0x2da830002da88000,0x2fa82c72a246ada8,0xa8a5aea7aff6ada8,0x263eaa1faea7b000,0xa63e2a1f2ea73000,0xae2fafd9afa8ada8,0x2d13263ea8a5ada8,0xaf64ada8aa1f8000,0xaf64ada8aa1f8000,0xa246263e2b8b2da8,0x2ff62fd92f0e2da8,0x2ea72f642fd93000,0xaea7af64afd9b000,0x2f0e2ea72e2f2da8,0x2b8b2c722d132da8
.quad 0xb000800030008000,0xb000800030008000,0xa2462fd928a5af64,0x2ff6263eafa8aa1f,0x2fd92a1faea7ada8,0xafd9aa1f2ea72da8,0x28a5aea7ae2f2a1f,0x2fa82c72ad13af64,0xaf64ada82a1f3000,0xaf64ada82a1f3000,0xab8b2c722ff62a1f,0x2f0e2ea7a246af64,0x2ea72f64263eada8,0xaea7af64a63e2da8,0x2d13a63eaf0eaf64,0x2e2f2fd92b8baa1f
.quad 0xada8b000ada88000,0xada8b000ada88000,0xae2fa63e2b8b2f64,0x2d132fd92f0e2a1f,0x2c722f642fd92da8,0xac72af64afd9ada8,0x2f0e2c722246aa1f,0x2b8b2ea72ff62f64,0xaa1fada8af64b000,0xaa1fada8af64b000,0xafa8aea7ad13aa1f,0x28a52c722e2f2f64,0x263e2a1f2c722da8,0xa63eaa1fac72ada8,0x2ff62fd92fa82f64,0x2246263e28a52a1f
.quad 0xb000800030008000,0xb000800030008000,0x2fa8a63eaff68000,0xa8a5afd922463000,0xaea72a1f2fd98000,0x2ea7aa1fafd98000,0x2d13ac72afa88000,0x2e2f2ea7a8a5b000,0xaa1f2da82f648000,0xaa1f2da82f648000,0x2246aea7af0e8000,0xaff6ac722b8b3000,0x263e2f642ea78000,0xa63eaf64aea78000,0xab8bafd9ae2f8000,0x2f0e263ead13b000
.quad 0x2da830002da88000,0x2da830002da88000,0xaf0eafd9ad138000,0xab8b263e2e2f3000,0x2fd92f642c728000,0xafd9af64ac728000,0xaff6aea7ab8b8000,0xa246ac72af0eb000,0x2f642da82a1f8000,0x2f642da82a1f8000,0xae2fac72a8a58000,0x2d132ea72fa83000,0x2c722a1f263e8000,0xac72aa1fa63e8000,0xa8a5a63ea2468000,0xafa8afd9aff6b000
.quad 0xb000800030008000,0xb000800030008000,0x2e2fac72af0e2a1f,0xad13aea72b8b2f64,0xa63e2f642c72ada8,0x263eaf64ac722da8,0xab8bafd9a2462f64,0x2f0ea63eaff6aa1f,0x2f642da8aa1fb000,0x2f642da8aa1fb000,0xafa8a63e2e2f2f64,0x28a52fd92d13aa1f,0x2c72aa1fafd9ada8,0xac722a1f2fd92da8,0x22462ea72fa82a1f,0xaff6ac7228a52f64
.quad 0xada8b000ada88000,0xada8b000ada88000,0x2ff62ea728a5aa1f,0x2246ac72afa8af64,0xaea7aa1f263e2da8,0x2ea72a1fa63eada8,0x28a5a63ead13af64,0x2fa82fd92e2f2a1f,0x2a1f2da82f643000,0x2a1f2da82f643000,0xaf0eafd9aff6af64,0xab8ba63e22462a1f,0x2fd92f642ea72da8,0xafd9af64aea7ada8,0xad13ac72ab8baa1f,0xae2faea7af0eaf64
.quad 0xb000800030008000,0xb000800030008000,0x2b8baea7ad132da8,0xaf0eac722e2f2da8,0x2c722f64a63eb000,0xac72af64263e3000,0xaff6a63e2f0e2da8,0xa246afd9ab8b2da8,0x2a1fada8af648000,0x2a1fada8af648000,0x2d132fd928a5ada8,0x2e2fa63eafa8ada8,0xafd9aa1f2c723000,0x2fd92a1fac72b000,0x28a5ac72aff6ada8,0x2fa82ea72246ada8
.quad 0x2da830002da88000,0x2da830002da88000,0xafa8ac7222462da8,0x28a52ea72ff62da8,0x263eaa1faea7b000,0xa63e2a1f2ea73000,0x2e2f2fd92fa82da8,0xad13a63e28a52da8,0xaf64ada8aa1f8000,0xaf64ada8aa1f8000,0x2246a63eab8bada8,0xaff6afd9af0eada8,0x2ea72f642fd93000,0xaea7af64afd9b000,0xaf0eaea7ae2fada8,0xab8bac72ad13ada8
.quad 0xb000800030008000,0xb000800030008000,0x2246afd9a8a52f64,0xaff6a63e2fa82a1f,0x2fd92a1faea7ada8,0xafd9aa1f2ea72da8,0xa8a52ea72e2faa1f,0xafa8ac722d132f64,0xaf64ada82a1f3000,0xaf64ada82a1f3000,0x2b8bac72aff6aa1f,0xaf0eaea722462f64,0x2ea72f64263eada8,0xaea7af64a63e2da8,0xad13263e2f0e2f64,0xae2fafd9ab8b2a1f
.quad 0xada8b000ada88000,0xada8b000ada88000,0x2e2f263eab8baf64,0xad13afd9af0eaa1f,0x2c722f642fd92da8,0xac72af64afd9ada8,0xaf0eac72a2462a1f,0xab8baea7aff6af64,0xaa1fada8af64b000,0xaa1fada8af64b000,0x2fa82ea72d132a1f,0xa8a5ac72ae2faf64,0x263e2a1f2c722da8,0xa63eaa1fac72ada8,0xaff6afd9afa8af64,0xa246a63ea8a5aa1f
.quad 0x0,0x0,0x28a5263e22460000,0x2fa82fd92ff63000,0x2c722a1f263e0000,0xac72aa1fa63e0000,0x2e2f2c7228a50000,0xad13aea7afa8b000,0x2f642da82a1f0000,0x2f642da82a1f0000,0x2ff62ea72b8b0000,0x22462c722f0e3000,0x2fd92f642c720000,0xafd9af64ac720000,0x2f0e2fd92d130000,0x2b8ba63eae2fb000
.quad 0x2da830002da80000,0x2da830002da80000,0x2b8b2fd92e2f0000,0xaf0ea63e2d133000,0x263e2f642ea70000,0xa63eaf64aea70000,0xa2462ea72f0e0000,0x2ff62c72ab8bb000,0xaa1f2da82f640000,0xaa1f2da82f640000,0xad132c722fa80000,0xae2faea728a53000,0xaea72a1f2fd90000,0x2ea7aa1fafd90000,0xafa8263e2ff60000,0x28a52fd9a246b000
.quad 0x0,0x0,0x2d132c722b8b2a1f,0x2e2f2ea72f0e2f64,0x2fd92f642ea72da8,0xafd9af64aea7ada8,0x2f0e2fd92ff62f64,0x2b8b263ea246aa1f,0x2a1f2da82f643000,0x2a1f2da82f643000,0xa8a5263e2d132f64,0xafa8afd9ae2faa1f,0xaea7aa1f263e2da8,0x2ea72a1fa63eada8,0xaff6aea7a8a52a1f,0xa2462c722fa82f64
.quad 0xada8b000ada80000,0xada8b000ada80000,0xa246aea7afa8aa1f,0x2ff62c72a8a5af64,0x2c72aa1fafd9ada8,0xac722a1f2fd92da8,0x2fa8263eae2faf64,0xa8a5afd9ad132a1f,0x2f642da8aa1fb000,0x2f642da8aa1fb000,0x2b8b2fd92246af64,0xaf0e263e2ff62a1f,0xa63e2f642c72ada8,0x263eaf64ac722da8,0xae2f2c722f0eaa1f,0x2d132ea7ab8baf64
.quad 0x0,0x0,0x2f0e2ea72e2f2da8,0x2b8b2c722d132da8,0x2ea72f642fd93000,0xaea7af64afd9b000,0xa246263e2b8b2da8,0x2ff62fd92f0e2da8,0xaf64ada8aa1f0000,0xaf64ada8aa1f0000,0xae2fafd9afa8ada8,0x2d13263ea8a5ada8,0x263eaa1faea7b000,0xa63e2a1f2ea73000,0x2fa82c72a246ada8,0xa8a5aea7aff6ada8
.quad 0x2da830002da80000,0x2da830002da80000,0xa8a52c722ff62da8,0xafa8aea7a2462da8,0xafd9aa1f2c723000,0x2fd92a1fac72b000,0xad13afd9a8a52da8,0xae2f263e2fa82da8,0x2a1fada8af640000,0x2a1fada8af640000,0x2ff6263eaf0eada8,0x22462fd92b8bada8,0x2c722f64a63eb000,0xac72af64263e3000,0xab8b2ea72d13ada8,0x2f0e2c72ae2fada8
.quad 0x0,0x0,0x2ff62fd92fa82f64,0x2246263e28a52a1f,0x263e2a1f2c722da8,0xa63eaa1fac72ada8,0xafa8aea7ad13aa1f,0x28a52c722e2f2f64,0xaa1fada8af64b000,0xaa1fada8af64b000,0x2f0e2c722246aa1f,0x2b8b2ea72ff62f64,0x2c722f642fd92da8,0xac72af64afd9ada8,0xae2fa63e2b8b2f64,0x2d132fd92f0e2a1f
.quad 0xada8b000ada80000,0xada8b000ada80000,0x2d13a63eaf0eaf64,0x2e2f2fd92b8baa1f,0x2ea72f64263eada8,0xaea7af64a63e2da8,0xab8b2c722ff62a1f,0x2f0e2ea7a246af64,0xaf64ada82a1f3000,0xaf64ada82a1f3000,0x28a5aea7ae2f2a1f,0x2fa82c72ad13af64,0x2fd92a1faea7ada8,0xafd9aa1f2ea72da8,0xa2462fd928a5af64,0x2ff6263eafa8aa1f
.quad 0x0,0x0,0xa8a5a63ea2460000,0xafa8afd9aff6b000,0x2c722a1f263e0000,0xac72aa1fa63e0000,0xae2fac72a8a50000,0x2d132ea72fa83000,0x2f642da82a1f0000,0x2f642da82a1f0000,0xaff6aea7ab8b0000,0xa246ac72af0eb000,0x2fd92f642c720000,0xafd9af64ac720000,0xaf0eafd9ad130000,0xab8b263e2e2f3000
.quad 0x2da830002da80000,0x2da830002da80000,0xab8bafd9ae2f0000,0x2f0e263ead13b000,0x263e2f642ea70000,0xa63eaf64aea70000,0x2246aea7af0e0000,0xaff6ac722b8b3000,0xaa1f2da82f640000,0xaa1f2da82f640000,0x2d13ac72afa80000,0x2e2f2ea7a8a5b000,0xaea72a1f2fd90000,0x2ea7aa1fafd90000,0x2fa8a63eaff60000,0xa8a5afd922463000
.quad 0x0,0x0,0xad13ac72ab8baa1f,0xae2faea7af0eaf64,0x2fd92f642ea72da8,0xafd9af64aea7ada8,0xaf0eafd9aff6af64,0xab8ba63e22462a1f,0x2a1f2da82f643000,0x2a1f2da82f643000,0x28a5a63ead13af64,0x2fa82fd92e2f2a1f,0xaea7aa1f263e2da8,0x2ea72a1fa63eada8,0x2ff62ea728a5aa1f,0x2246ac72afa8af64
.quad 0xada8b000ada80000,0xada8b000ada80000,0x22462ea72fa82a1f,0xaff6ac7228a52f64,0x2c72aa1fafd9ada8,0xac722a1f2fd92da8,0xafa8a63e2e2f2f64,0x28a52fd92d13aa1f,0x2f642da8aa1fb000,0x2f642da8aa1fb000,0xab8bafd9a2462f64,0x2f0ea63eaff6aa1f,0xa63e2f642c72ada8,0x263eaf64ac722da8,0x2e2fac72af0e2a1f,0xad13aea72b8b2f64
.quad 0x0,0x0,0xaf0eaea7ae2fada8,0xab8bac72ad13ada8,0x2ea72f642fd93000,0xaea7af64afd9b000,0x2246a63eab8bada8,0xaff6afd9af0eada8,0xaf64ada8aa1f0000,0xaf64ada8aa1f0000,0x2e2f2fd92fa82da8,0xad13a63e28a52da8,0x263eaa1faea7b000,0xa63e2a1f2ea73000,0xafa8ac7222462da8,0x28a52ea72ff62da8
.quad 0x2da830002da80000,0x2da830002da80000,0x28a5ac72aff6ada8,0x2fa82ea72246ada8,0xafd9aa1f2c723000,0x2fd92a1fac72b000,0x2d132fd928a5ada8,0x2e2fa63eafa8ada8,0x2a1fada8af640000,0x2a1fada8af640000,0xaff6a63e2f0e2da8,0xa246afd9ab8b2da8,0x2c722f64a63eb000,0xac72af64263e3000,0x2b8baea7ad132da8,0xaf0eac722e2f2da8
.quad 0x0,0x0,0xaff6afd9afa8af64,0xa246a63ea8a5aa1f,0x263e2a1f2c722da8,0xa63eaa1fac72ada8,0x2fa82ea72d132a1f,0xa8a5ac72ae2faf64,0xaa1fada8af64b000,0xaa1fada8af64b000,0xaf0eac72a2462a1f,0xab8baea7aff6af64,0x2c722f642fd92da8,0xac72af64afd9ada8,0x2e2f263eab8baf64,0xad13afd9af0eaa1f
.quad 0xada8b000ada80000,0xada8b000ada80000,0xad13263e2f0e2f64,0xae2fafd9ab8b2a1f,0x2ea72f64263eada8,0xaea7af64a63e2da8,0x2b8bac72aff6aa1f,0xaf0eaea722462f64,0xaf64ada82a1f3000,0xaf64ada82a1f3000,0xa8a52ea72e2faa1f,0xafa8ac722d132f64,0x2fd92a1faea7ada8,0xafd9aa1f2ea72da8,0x2246afd9a8a52f64,0xaff6a63e2fa82a1f
.quad 0xb000000030000000,0xb000000030000000,0xafa8a63e2ff60000,0x28a5afd9a2463000,0xaea7aa1f2fd90000,0x2ea72a1fafd90000,0xad13ac722fa80000,0xae2f2ea728a5b000,0xaa1fada82f640000,0xaa1fada82f640000,0xa246aea72f0e0000,0x2ff6ac72ab8b3000,0x263eaf642ea70000,0xa63e2f64aea70000,0x2b8bafd92e2f0000,0xaf0e263e2d13b000
.quad 0x2da8b0002da80000,0x2da8b0002da80000,0x2f0eafd92d130000,0x2b8b263eae2f3000,0x2fd9af642c720000,0xafd92f64ac720000,0x2ff6aea72b8b0000,0x2246ac722f0eb000,0x2f64ada82a1f0000,0x2f64ada82a1f0000,0x2e2fac7228a50000,0xad132ea7afa83000,0x2c72aa1f263e0000,0xac722a1fa63e0000,0x28a5a63e22460000,0x2fa8afd92ff6b000
.quad 0xb000000030000000,0xb000000030000000,0xae2fac722f0e2a1f,0x2d13aea7ab8b2f64,0xa63eaf642c722da8,0x263e2f64ac72ada8,0x2b8bafd922462f64,0xaf0ea63e2ff6aa1f,0x2f64ada8aa1f3000,0x2f64ada8aa1f3000,0x2fa8a63eae2f2f64,0xa8a52fd9ad13aa1f,0x2c722a1fafd92da8,0xac72aa1f2fd9ada8,0xa2462ea7afa82a1f,0x2ff6ac72a8a52f64
.quad 0xada83000ada80000,0xada83000ada80000,0xaff62ea7a8a5aa1f,0xa246ac722fa8af64,0xaea72a1f263eada8,0x2ea7aa1fa63e2da8,0xa8a5a63e2d13af64,0xafa82fd9ae2f2a1f,0x2a1fada82f64b000,0x2a1fada82f64b000,0x2f0eafd92ff6af64,0x2b8ba63ea2462a1f,0x2fd9af642ea7ada8,0xafd92f64aea72da8,0x2d13ac722b8baa1f,0x2e2faea72f0eaf64
.quad 0xb000000030000000,0xb000000030000000,0xab8baea72d132da8,0x2f0eac72ae2f2da8,0x2c72af64a63e3000,0xac722f64263eb000,0x2ff6a63eaf0e2da8,0x2246afd92b8b2da8,0x2a1f2da8af640000,0x2a1f2da8af640000,0xad132fd9a8a5ada8,0xae2fa63e2fa8ada8,0xafd92a1f2c72b000,0x2fd9aa1fac723000,0xa8a5ac722ff6ada8,0xafa82ea7a246ada8
.quad 0x2da8b0002da80000,0x2da8b0002da80000,0x2fa8ac72a2462da8,0xa8a52ea7aff62da8,0x263e2a1faea73000,0xa63eaa1f2ea7b000,0xae2f2fd9afa82da8,0x2d13a63ea8a52da8,0xaf642da8aa1f0000,0xaf642da8aa1f0000,0xa246a63e2b8bada8,0x2ff6afd92f0eada8,0x2ea7af642fd9b000,0xaea72f64afd93000,0x2f0eaea72e2fada8,0x2b8bac722d13ada8
.quad 0xb000000030000000,0xb000000030000000,0xa246afd928a52f64,0x2ff6a63eafa82a1f,0x2fd9aa1faea72da8,0xafd92a1f2ea7ada8,0x28a52ea7ae2faa1f,0x2fa8ac72ad132f64,0xaf642da82a1fb000,0xaf642da82a1fb000,0xab8bac722ff6aa1f,0x2f0eaea7a2462f64,0x2ea7af64263e2da8,0xaea72f64a63eada8,0x2d13263eaf0e2f64,0x2e2fafd92b8b2a1f
.quad 0xada83000ada80000,0xada83000ada80000,0xae2f263e2b8baf64,0x2d13afd92f0eaa1f,0x2c72af642fd9ada8,0xac722f64afd92da8,0x2f0eac7222462a1f,0x2b8baea72ff6af64,0xaa1f2da8af643000,0xaa1f2da8af643000,0xafa82ea7ad132a1f,0x28a5ac722e2faf64,0x263eaa1f2c72ada8,0xa63e2a1fac722da8,0x2ff6afd92fa8af64,0x2246a63e28a5aa1f
.quad 0xb000000030000000,0xb000000030000000,0x2fa8263eaff60000,0xa8a52fd92246b000,0xaea7aa1f2fd90000,0x2ea72a1fafd90000,0x2d132c72afa80000,0x2e2faea7a8a53000,0xaa1fada82f640000,0xaa1fada82f640000,0x22462ea7af0e0000,0xaff62c722b8bb000,0x263eaf642ea70000,0xa63e2f64aea70000,0xab8b2fd9ae2f0000,0x2f0ea63ead133000
.quad 0x2da8b0002da80000,0x2da8b0002da80000,0xaf0e2fd9ad130000,0xab8ba63e2e2fb000,0x2fd9af642c720000,0xafd92f64ac720000,0xaff62ea7ab8b0000,0xa2462c72af0e3000,0x2f64ada82a1f0000,0x2f64ada82a1f0000,0xae2f2c72a8a50000,0x2d13aea72fa8b000,0x2c72aa1f263e0000,0xac722a1fa63e0000,0xa8a5263ea2460000,0xafa82fd9aff63000
.quad 0xb000000030000000,0xb000000030000000,0x2e2f2c72af0eaa1f,0xad132ea72b8baf64,0xa63eaf642c722da8,0x263e2f64ac72ada8,0xab8b2fd9a246af64,0x2f0e263eaff62a1f,0x2f64ada8aa1f3000,0x2f64ada8aa1f3000,0xafa8263e2e2faf64,0x28a5afd92d132a1f,0x2c722a1fafd92da8,0xac72aa1f2fd9ada8,0x2246aea72fa8aa1f,0xaff62c7228a5af64
.quad 0xada83000ada80000,0xada83000ada80000,0x2ff6aea728a52a1f,0x22462c72afa82f64,0xaea72a1f263eada8,0x2ea7aa1fa63e2da8,0x28a5263ead132f64,0x2fa8afd92e2faa1f,0x2a1fada82f64b000,0x2a1fada82f64b000,0xaf0e2fd9aff62f64,0xab8b263e2246aa1f,0x2fd9af642ea7ada8,0xafd92f64aea72da8,0xad132c72ab8b2a1f,0xae2f2ea7af0e2f64
.quad 0xb000000030000000,0xb000000030000000,0x2b8b2ea7ad13ada8,0xaf0e2c722e2fada8,0x2c72af64a63e3000,0xac722f64263eb000,0xaff6263e2f0eada8,0xa2462fd9ab8bada8,0x2a1f2da8af640000,0x2a1f2da8af640000,0x2d13afd928a52da8,0x2e2f263eafa82da8,0xafd92a1f2c72b000,0x2fd9aa1fac723000,0x28a52c72aff62da8,0x2fa8aea722462da8
.quad 0x2da8b0002da80000,0x2da8b0002da80000,0xafa82c722246ada8,0x28a5aea72ff6ada8,0x263e2a1faea73000,0xa63eaa1f2ea7b000,0x2e2fafd92fa8ada8,0xad13263e28a5ada8,0xaf642da8aa1f0000,0xaf642da8aa1f0000,0x2246263eab8b2da8,0xaff62fd9af0e2da8,0x2ea7af642fd9b000,0xaea72f64afd93000,0xaf0e2ea7ae2f2da8,0xab8b2c72ad132da8
.quad 0xb000000030000000,0xb000000030000000,0x22462fd9a8a5af64,0xaff6263e2fa8aa1f,0x2fd9aa1faea72da8,0xafd92a1f2ea7ada8,0xa8a5aea72e2f2a1f,0xafa82c722d13af64,0xaf642da82a1fb000,0xaf642da82a1fb000,0x2b8b2c72aff62a1f,0xaf0e2ea72246af64,0x2ea7af64263e2da8,0xaea72f64a63eada8,0xad13a63e2f0eaf64,0xae2f2fd9ab8baa1f
.quad 0xada83000ada80000,0xada83000ada80000,0x2e2fa63eab8b2f64,0xad132fd9af0e2a1f,0x2c72af642fd9ada8,0xac722f64afd92da8,0xaf0e2c72a246aa1f,0xab8b2ea7aff62f64,0xaa1f2da8af643000,0xaa1f2da8af643000,0x2fa8aea72d13aa1f,0xa8a52c72ae2f2f64,0x263eaa1f2c72ada8,0xa63e2a1fac722da8,0xaff62fd9afa82f64,0xa246263ea8a52a1f
.quad 0x0,0x0,0xa8a5263ea2460000,0xafa82fd9aff63000,0xac722a1fa63e0000,0x2c72aa1f263e0000,0xae2f2c72a8a50000,0x2d13aea72fa8b000,0xaf642da8aa1f0000,0xaf642da8aa1f0000,0xaff62ea7ab8b0000,0xa2462c72af0e3000,0xafd92f64ac720000,0x2fd9af642c720000,0xaf0e2fd9ad130000,0xab8ba63e2e2fb000
.quad 0xada83000ada80000,0xada83000ada80000,0xab8b2fd9ae2f0000,0x2f0ea63ead133000,0xa63e2f64aea70000,0x263eaf642ea70000,0x22462ea7af0e0000,0xaff62c722b8bb000,0x2a1f2da8af640000,0x2a1f2da8af640000,0x2d132c72afa80000,0x2e2faea7a8a53000,0x2ea72a1fafd90000,0xaea7aa1f2fd90000,0x2fa8263eaff60000,0xa8a52fd92246b000
.quad 0x0,0x0,0xad132c72ab8b2a1f,0xae2f2ea7af0e2f64,0xafd92f64aea72da8,0x2fd9af642ea7ada8,0xaf0e2fd9aff62f64,0xab8b263e2246aa1f,0xaa1f2da8af643000,0xaa1f2da8af643000,0x28a5263ead132f64,0x2fa8afd92e2faa1f,0x2ea7aa1fa63e2da8,0xaea72a1f263eada8,0x2ff6aea728a52a1f,0x22462c72afa82f64
.quad 0x2da8b0002da80000,0x2da8b0002da80000,0x2246aea72fa8aa1f,0xaff62c7228a5af64,0xac72aa1f2fd9ada8,0x2c722a1fafd92da8,0xafa8263e2e2faf64,0x28a5afd92d132a1f,0xaf642da82a1fb000,0xaf642da82a1fb000,0xab8b2fd9a246af64,0x2f0e263eaff62a1f,0x263e2f64ac72ada8,0xa63eaf642c722da8,0x2e2f2c72af0eaa1f,0xad132ea72b8baf64
.quad 0x0,0x0,0xaf0e2ea7ae2f2da8,0xab8b2c72ad132da8,0xaea72f64afd93000,0x2ea7af642fd9b000,0x2246263eab8b2da8,0xaff62fd9af0e2da8,0x2f64ada82a1f0000,0x2f64ada82a1f0000,0x2e2fafd92fa8ada8,0xad13263e28a5ada8,0xa63eaa1f2ea7b000,0x263e2a1faea73000,0xafa82c722246ada8,0x28a5aea72ff6ada8
.quad 0xada83000ada80000,0xada83000ada80000,0x28a52c72aff62da8,0x2fa8aea722462da8,0x2fd9aa1fac723000,0xafd92a1f2c72b000,0x2d13afd928a52da8,0x2e2f263eafa82da8,0xaa1fada82f640000,0xaa1fada82f640000,0xaff6263e2f0eada8,0xa2462fd9ab8bada8,0xac722f64263eb000,0x2c72af64a63e3000,0x2b8b2ea7ad13ada8,0xaf0e2c722e2fada8
.quad 0x0,0x0,0xaff62fd9afa82f64,0xa246263ea8a52a1f,0xa63e2a1fac722da8,0x263eaa1f2c72ada8,0x2fa8aea72d13aa1f,0xa8a52c72ae2f2f64,0x2a1fada82f64b000,0x2a1fada82f64b000,0xaf0e2c72a246aa1f,0xab8b2ea7aff62f64,0xac722f64afd92da8,0x2c72af642fd9ada8,0x2e2fa63eab8b2f64,0xad132fd9af0e2a1f
.quad 0x2da8b0002da80000,0x2da8b0002da80000,0xad13a63e2f0eaf64,0xae2f2fd9ab8baa1f,0xaea72f64a63eada8,0x2ea7af64263e2da8,0x2b8b2c72aff62a1f,0xaf0e2ea72246af64,0x2f64ada8aa1f3000,0x2f64ada8aa1f3000,0xa8a5aea72e2f2a1f,0xafa82c722d13af64,0xafd92a1f2ea7ada8,0x2fd9aa1faea72da8,0x22462fd9a8a5af64,0xaff6263e2fa8aa1f
.quad 0x0,0x0,0x28a5a63e22460000,0x2fa8afd92ff6b000,0xac722a1fa63e0000,0x2c72aa1f263e0000,0x2e2fac7228a50000,0xad132ea7afa83000,0xaf642da8aa1f0000,0xaf642da8aa1f0000,0x2ff6aea72b8b0000,0x2246ac722f0eb000,0xafd92f64ac720000,0x2fd9af642c720000,0x2f0eafd92d130000,0x2b8b263eae2f3000
.quad 0xada83000ada80000,0xada83000ada80000,0x2b8bafd92e2f0000,0xaf0e263e2d13b000,0xa63e2f64aea70000,0x263eaf642ea70000,0xa246aea72f0e0000,0x2ff6ac72ab8b3000,0x2a1f2da8af640000,0x2a1f2da8af640000,0xad13ac722fa80000,0xae2f2ea728a5b000,0x2ea72a1fafd90000,0xaea7aa1f2fd90000,0xafa8a63e2ff60000,0x28a5afd9a2463000
.quad 0x0,0x0,0x2d13ac722b8baa1f,0x2e2faea72f0eaf64,0xafd92f64aea72da8,0x2fd9af642ea7ada8,0x2f0eafd92ff6af64,0x2b8ba63ea2462a1f,0xaa1f2da8af643000,0xaa1f2da8af643000,0xa8a5a63e2d13af64,0xafa82fd9ae2f2a1f,0x2ea7aa1fa63e2da8,0xaea72a1f263eada8,0xaff62ea7a8a5aa1f,0xa246ac722fa8af64
.quad 0x2da8b0002da80000,0x2da8b0002da80000,0xa2462ea7afa82a1f,0x2ff6ac72a8a52f64,0xac72aa1f2fd9ada8,0x2c722a1fafd92da8,0x2fa8a63eae2f2f64,0xa8a52fd9ad13aa1f,0xaf642da82a1fb000,0xaf642da82a1fb000,0x2b8bafd922462f64,0xaf0ea63e2ff6aa1f,0x263e2f64ac72ada8,0xa63eaf642c722da8,0xae2fac722f0e2a1f,0x2d13aea7ab8b2f64
.quad 0x0,0x0,0x2f0eaea72e2fada8,0x2b8bac722d13ada8,0xaea72f64afd93000,0x2ea7af642fd9b000,0xa246a63e2b8bada8,0x2ff6afd92f0eada8,0x2f64ada82a1f0000,0x2f64ada82a1f0000,0xae2f2fd9afa82da8,0x2d13a63ea8a52da8,0xa63eaa1f2ea7b000,0x263e2a1faea73000,0x2fa8ac72a2462da8,0xa8a52ea7aff62da8
.quad 0xada83000ada80000,0xada83000ada80000,0xa8a5ac722ff6ada8,0xafa82ea7a246ada8,0x2fd9aa1fac723000,0xafd92a1f2c72b000,0xad132fd9a8a5ada8,0xae2fa63e2fa8ada8,0xaa1fada82f640000,0xaa1fada82f640000,0x2ff6a63eaf0e2da8,0x2246afd92b8b2da8,0xac722f64263eb000,0x2c72af64a63e3000,0xab8baea72d132da8,0x2f0eac72ae2f2da8
.quad 0x0,0x0,0x2ff6afd92fa8af64,0x2246a63e28a5aa1f,0xa63e2a1fac722da8,0x263eaa1f2c72ada8,0xafa82ea7ad132a1f,0x28a5ac722e2faf64,0x2a1fada82f64b000,0x2a1fada82f64b000,0x2f0eac7222462a1f,0x2b8baea72ff6af64,0xac722f64afd92da8,0x2c72af642fd9ada8,0xae2f263e2b8baf64,0x2d13afd92f0eaa1f
.quad 0x2da8b0002da80000,0x2da8b0002da80000,0x2d13263eaf0e2f64,0x2e2fafd92b8b2a1f,0xaea72f64a63eada8,0x2ea7af64263e2da8,0xab8bac722ff6aa1f,0x2f0eaea7a2462f64,0x2f64ada8aa1f3000,0x2f64ada8aa1f3000,0x28a52ea7ae2faa1f,0x2fa8ac72ad132f64,0xafd92a1f2ea7ada8,0x2fd9aa1faea72da8,0xa246afd928a52f64,0x2ff6a63eafa82a1f
.quad 0x30000000b0000000,0x30000000b0000000,0x2fa8a63eaff60000,0xa8a5afd922463000,0x2ea7aa1fafd90000,0xaea72a1f2fd90000,0x2d13ac72afa80000,0x2e2f2ea7a8a5b000,0x2a1fada8af640000,0x2a1fada8af640000,0x2246aea7af0e0000,0xaff6ac722b8b3000,0xa63eaf64aea70000,0x263e2f642ea70000,0xab8bafd9ae2f0000,0x2f0e263ead13b000
.quad 0xada8b000ada80000,0xada8b000ada80000,0xaf0eafd9ad130000,0xab8b263e2e2f3000,0xafd9af64ac720000,0x2fd92f642c720000,0xaff6aea7ab8b0000,0xa246ac72af0eb000,0xaf64ada8aa1f0000,0xaf64ada8aa1f0000,0xae2fac72a8a50000,0x2d132ea72fa83000,0xac72aa1fa63e0000,0x2c722a1f263e0000,0xa8a5a63ea2460000,0xafa8afd9aff6b000
.quad 0x30000000b0000000,0x30000000b0000000,0x2e2fac72af0e2a1f,0xad13aea72b8b2f64,0x263eaf64ac722da8,0xa63e2f642c72ada8,0xab8bafd9a2462f64,0x2f0ea63eaff6aa1f,0xaf64ada82a1f3000,0xaf64ada82a1f3000,0xafa8a63e2e2f2f64,0x28a52fd92d13aa1f,0xac722a1f2fd92da8,0x2c72aa1fafd9ada8,0x22462ea72fa82a1f,0xaff6ac7228a52f64
.quad 0x2da830002da80000,0x2da830002da80000,0x2ff62ea728a5aa1f,0x2246ac72afa8af64,0x2ea72a1fa63eada8,0xaea7aa1f263e2da8,0x28a5a63ead13af64,0x2fa82fd92e2f2a1f,0xaa1fada8af64b000,0xaa1fada8af64b000,0xaf0eafd9aff6af64,0xab8ba63e22462a1f,0xafd9af64aea7ada8,0x2fd92f642ea72da8,0xad13ac72ab8baa1f,0xae2faea7af0eaf64
.quad 0x30000000b0000000,0x30000000b0000000,0x2b8baea7ad132da8,0xaf0eac722e2f2da8,0xac72af64263e3000,0x2c722f64a63eb000,0xaff6a63e2f0e2da8,0xa246afd9ab8b2da8,0xaa1f2da82f640000,0xaa1f2da82f640000,0x2d132fd928a5ada8,0x2e2fa63eafa8ada8,0x2fd92a1fac72b000,0xafd9aa1f2c723000,0x28a5ac72aff6ada8,0x2fa82ea72246ada8
.quad 0xada8b000ada80000,0xada8b000ada80000,0xafa8ac7222462da8,0x28a52ea72ff62da8,0xa63e2a1f2ea73000,0x263eaa1faea7b000,0x2e2f2fd92fa82da8,0xad13a63e28a52da8,0x2f642da82a1f0000,0x2f642da82a1f0000,0x2246a63eab8bada8,0xaff6afd9af0eada8,0xaea7af64afd9b000,0x2ea72f642fd93000,0xaf0eaea7ae2fada8,0xab8bac72ad13ada8
.quad 0x30000000b0000000,0x30000000b0000000,0x2246afd9a8a52f64,0xaff6a63e2fa82a1f,0xafd9aa1f2ea72da8,0x2fd92a1faea7ada8,0xa8a52ea72e2faa1f,0xafa8ac722d132f64,0x2f642da8aa1fb000,0x2f642da8aa1fb000,0x2b8bac72aff6aa1f,0xaf0eaea722462f64,0xaea7af64a63e2da8,0x2ea72f64263eada8,0xad13263e2f0e2f64,0xae2fafd9ab8b2a1f
.quad 0x2da830002da80000,0x2da830002da80000,0x2e2f263eab8baf64,0xad13afd9af0eaa1f,0xac72af64afd9ada8,0x2c722f642fd92da8,0xaf0eac72a2462a1f,0xab8baea7aff6af64,0x2a1f2da82f643000,0x2a1f2da82f643000,0x2fa82ea72d132a1f,0xa8a5ac72ae2faf64,0xa63eaa1fac72ada8,0x263e2a1f2c722da8,0xaff6afd9afa8af64,0xa246a63ea8a5aa1f
.quad 0x30000000b0000000,0x30000000b0000000,0xafa8263e2ff60000,0x28a52fd9a246b000,0x2ea7aa1fafd90000,0xaea72a1f2fd90000,0xad132c722fa80000,0xae2faea728a53000,0x2a1fada8af640000,0x2a1fada8af640000,0xa2462ea72f0e0000,0x2ff62c72ab8bb000,0xa63eaf64aea70000,0x263e2f642ea70000,0x2b8b2fd92e2f0000,0xaf0ea63e2d133000
.quad 0xada8b000ada80000,0xada8b000ada80000,0x2f0e2fd92d130000,0x2b8ba63eae2fb000,0xafd9af64ac720000,0x2fd92f642c720000,0x2ff62ea72b8b0000,0x22462c722f0e3000,0xaf64ada8aa1f0000,0xaf64ada8aa1f0000,0x2e2f2c7228a50000,0xad13aea7afa8b000,0xac72aa1fa63e0000,0x2c722a1f263e0000,0x28a5263e22460000,0x2fa82fd92ff63000
.quad 0x30000000b0000000,0x30000000b0000000,0xae2f2c722f0eaa1f,0x2d132ea7ab8baf64,0x263eaf64ac722da8,0xa63e2f642c72ada8,0x2b8b2fd92246af64,0xaf0e263e2ff62a1f,0xaf64ada82a1f3000,0xaf64ada82a1f3000,0x2fa8263eae2faf64,0xa8a5afd9ad132a1f,0xac722a1f2fd92da8,0x2c72aa1fafd9ada8,0xa246aea7afa8aa1f,0x2ff62c72a8a5af64
.quad 0x2da830002da80000,0x2da830002da80000,0xaff6aea7a8a52a1f,0xa2462c722fa82f64,0x2ea72a1fa63eada8,0xaea7aa1f263e2da8,0xa8a5263e2d132f64,0xafa8afd9ae2faa1f,0xaa1fada8af64b000,0xaa1fada8af64b000,0x2f0e2fd92ff62f64,0x2b8b263ea246aa1f,0xafd9af64aea7ada8,0x2fd92f642ea72da8,0x2d132c722b8b2a1f,0x2e2f2ea72f0e2f64
.quad 0x30000000b0000000,0x30000000b0000000,0xab8b2ea72d13ada8,0x2f0e2c72ae2fada8,0xac72af64263e3000,0x2c722f64a63eb000,0x2ff6263eaf0eada8,0x22462fd92b8bada8,0xaa1f2da82f640000,0xaa1f2da82f640000,0xad13afd9a8a52da8,0xae2f263e2fa82da8,0x2fd92a1fac72b000,0xafd9aa1f2c723000,0xa8a52c722ff62da8,0xafa8aea7a2462da8
.quad 0xada8b000ada80000,0xada8b000ada80000,0x2fa82c72a246ada8,0xa8a5aea7aff6ada8,0xa63e2a1f2ea73000,0x263eaa1faea7b000,0xae2fafd9afa8ada8,0x2d13263ea8a5ada8,0x2f642da82a1f0000,0x2f642da82a1f0000,0xa246263e2b8b2da8,0x2ff62fd92f0e2da8,0xaea7af64afd9b000,0x2ea72f642fd93000,0x2f0e2ea72e2f2da8,0x2b8b2c722d132da8
.quad 0x30000000b0000000,0x30000000b0000000,0xa2462fd928a5af64,0x2ff6263eafa8aa1f,0xafd9aa1f2ea72da8,0x2fd92a1faea7ada8,0x28a5aea7ae2f2a1f,0x2fa82c72ad13af64,0x2f642da8aa1fb000,0x2f642da8aa1fb000,0xab8b2c722ff62a1f,0x2f0e2ea7a246af64,0xaea7af64a63e2da8,0x2ea72f64263eada8,0x2d13a63eaf0eaf64,0x2e2f2fd92b8baa1f
.quad 0x2da830002da80000,0x2da830002da80000,0xae2fa63e2b8b2f64,0x2d132fd92f0e2a1f,0xac72af64afd9ada8,0x2c722f642fd92da8,0x2f0e2c722246aa1f,0x2b8b2ea72ff62f64,0x2a1f2da82f643000,0x2a1f2da82f643000,0xafa8aea7ad13aa1f,0x28a52c722e2f2f64,0xa63eaa1fac72ada8,0x263e2a1f2c722da8,0x2ff62fd92fa82f64,0x2246263e28a52a1f
.p2align 8
rowtab:
.quad 0x290f290f290f290f,0x290f290f290f290f,0x290d290e290f290f,0x290329062909290b,0x2906290b290e290f,0x28df28eb28f628ff,0x28fb2906290d290f,0x28a328bf28d728eb,0x28eb28ff290b290f,0x2850288228ad28d0,0x28d728f62909290f,0x27d32835287628ad,0x28bf28eb2906290f,0x26de27b228352882,0x28a328df2903290f,0x25c926de27d32850
.quad 0x288228d028ff290f,0x249825f327282818,0x285d28bf28fb290f,0x22a124f2266b27b2,0x283528ad28f6290f,0x1fe623bf259f2728,0x2809289828f1290f,0x18c4217e24c52692,0x27b2288228eb290f,0x9a5a1e5523bf25f3,0x274b286a28e5290f,0xa056165b21e0254a,0x26de285028df290f,0xa3019a5a1fe62498,0x266b283528d7290f,0xa4c59fe61bef23bf
.quad 0x290f290f290f290f,0x290f290f290f290f,0x28f128f628fb28ff,0x28d728df28e528eb,0x289828ad28bf28d0,0x28352850286a2882,0x28092835285d2882,0x266b26de274b27b2,0x2692272827b22818,0x23bf2498254a25f3,0x24c5259f266b2728,0x1bef1fe621e023bf,0x217e23bf24f225f3,0x9fe69a5a165b1e55,0x18c41fe622a12498,0xa4c5a301a0569a5a
.quad 0x9e5500001e552241,0xa728a5f3a498a241,0xa3609fe6925c1e55,0xa876a7f2a6b9a54a,0xa59fa3bf9fe60000,0xa8f6a8ada835a728,0xa74ba59fa3609e55,0xa909a906a8c8a850,0xa850a728a54aa241,0xa8ada8ffa90ba8d0,0xa8c8a835a6b9a498,0xa7d3a898a8fba90b,0xa906a8ada7f2a5f3,0xa59fa7b2a898a8ff,0xa909a8f6a876a728,0xa1e0a59fa7d3a8ad
.quad 0x290f290f290f290f,0x290f290f290f290f,0x28b628bf28c828d0,0x288d289828a328ad,0x276e27b227f22818,0x2644269226de2728,0x246b24f2257525f3,0x2056217e22a123bf,0x1a5a1e5520b92241,0xa0b99e559a5a0000,0xa1e09fe69bef0000,0xa66ba59fa4c5a3bf,0xa644a54aa43da241,0xa898a850a7f2a728,0xa85da7f2a703a5f3,0xa90fa906a8e5a8ad
.quad 0xa8ffa8d0a882a818,0xa882a8d0a8ffa90f,0xa8f1a90ea903a8d0,0xa61ca76ea843a8ad,0xa835a8ada8f6a90f,0x9fe6a3bfa59fa728,0xa5c9a76ea85da8d0,0x211c165b9f1ea3bf,0xa0b9a498a692a818,0x2692249820b98000,0x1d8c9cc2a360a5f3,0x28a327f2261c23bf,0x24f220b9965ba241,0x290e28eb286a2728,0x27d3259f21e08000,0x287628f6290928ad
.quad 0x290f290f290f290f,0x290f290f290f290f,0x285d286a28762882,0x2827283528432850,0x24f2254a259f25f3,0x230123bf243d2498,0x925c165b1bef1e55,0xa11c9fe69d8c9a5a,0xa54aa498a3bfa241,0xa7b2a728a692a5f3,0xa876a835a7d3a728,0xa909a8f6a8d7a8ad,0xa90ea90ba8f6a8d0,0xa86aa8ada8dfa8ff,0xa843a898a8d7a8ff,0xa46ba59fa6b9a7b2
.quad 0xa498a5f3a728a818,0x1e5580009e55a241,0x18c49cc2a1e0a498,0x2703259f240e20b9,0x259f23bf1fe68000,0x28f628ad28352728,0x288d27f2266b2498,0x28a328f6290f28eb,0x290b28ff28ad2818,0x254a2728285028d0,0x282728bf290928ff,0x98c41fe6246b2692,0x243d2692283528d0,0xa644a3bf9cc21e55,0x9bef1fe624c52728,0xa8d7a835a66ba3bf
.quad 0x290f290f290f290f,0x290f290f290f290f,0x27d327f228092818,0x274b276e279027b2,0x1fe620b9217e2241,0x165b1a5a1cc21e55,0xa4c5a43da360a241,0xa6b9a644a5c9a54a,0xa8ada882a850a818,0xa90ba8ffa8eba8d0,0xa8d7a8f6a909a90f,0xa7d3a835a876a8ad,0xa59fa692a76ea818,0x9cc2a0b9a301a498,0x1bef965b9f1ea241,0x261c24f2236020b9
.quad 0x272825f324982241,0x28ff28d028822818,0x290928df288d2818,0x2827289828e5290b,0x283528ad28f6290f,0x1fe623bf259f2728,0x21e024f226b92818,0xa575a3019d8c1a5a,0xa3bf9e551a5a2241,0xa8eba882a7b2a5f3,0xa876a76ea575a241,0xa85da8dfa90fa8eb,0xa8f6a90ba8bfa818,0xa17ea54aa76ea882,0xa66ba835a8d7a90f,0x24c51fe69befa3bf
.quad 0x290f290f290f290f,0x290f290f290f290f,0x26b926de27032728,0x261c2644266b2692,0x9cc29a5a965b0000,0xa17ea0b99fe69e55,0xa827a7f2a790a728,0xa8b6a898a876a850,0xa8eba8ffa90ba90f,0xa850a882a8ada8d0,0xa4c5a59fa66ba728,0x9bef9fe6a1e0a3bf,0x230120b91cc28000,0x276e2692259f2498,0x28b6286a28092728,0x28fb290e290928eb
.quad 0x288228d028ff290f,0x249825f327282818,0x211c243d25c92728,0xa46ba17e9bef1a5a,0xa59fa3bf9fe60000,0xa8f6a8ada835a728,0xa903a8bfa843a728,0xa790a86aa8d7a90b,0xa7b2a882a8eba90f,0x1a5a9e55a3bfa5f3,0x925ca17ea51ea728,0x284326de24c520b9,0x276e254a217e8000,0x28bf290b28f62882,0x290928f628762728,0x21e0259f27d328ad
.quad 0x290f290f290f290f,0x290f290f290f290f,0x2575259f25c925f3,0x24c524f2251e254a,0xa43da3bfa301a241,0xa59fa54aa4f2a498,0xa903a8f6a8e5a8d0,0xa909a90ea90fa90b,0xa692a728a7b2a818,0xa3bfa498a54aa5f3,0x21e01fe61bef8000,0x266b259f24c523bf,0x28df28ad286a2818,0x28f6290b290e28ff,0x27902835288d28d0,0x21e0243d25752692
.quad 0x9e5500001e552241,0xa728a5f3a498a241,0xa8a3a835a74ba5f3,0xa8d7a906a90da8eb,0xa835a8ada8f6a90f,0x9fe6a3bfa59fa728,0x125c9fe6a40ea5f3,0x27d32644246b20b9,0x28502728254a2241,0x28ad28ff290b28d0,0x288d28f6290d28d0,0x1bef230125c927b2,0x1cc223bf26442818,0xa835a692a43d9e55,0xa7d3a59fa1e00000,0xa876a8f6a909a8ad
.quad 0x290f290f290f290f,0x290f290f290f290f,0x240e243d246b2498,0x22a12301236023bf,0xa6dea692a644a5f3,0xa7f2a7b2a76ea728,0xa8c8a8dfa8f1a8ff,0xa843a86aa88da8ad,0x9a5a9e55a0b9a241,0x20b91e551a5a8000,0x2876283527d32728,0x290928f628d728ad,0x27f22850289828d0,0x243d254a26442728,0xa11c9cc2125c1e55,0xa74ba644a51ea3bf
.quad 0xa8ffa8d0a882a818,0xa882a8d0a8ffa90f,0xa575a6dea809a882,0x1d8c965ba056a3bf,0x259f23bf1fe68000,0x28f628ad28352728,0x28fb290e28e52882,0x251e26de282728ad,0x20b9249826922818,0xa692a498a0b90000,0xa809a644a40e9e55,0xa8b6a906a903a8ad,0xa86aa8eba90ea8d0,0x165ba0b9a4f2a728,0x1bef9fe6a4c5a728,0x28d72835266b23bf
.quad 0x290f290f290f290f,0x290f290f290f290f,0x211c217e21e02241,0x1f1e1fe6205620b9,0xa86aa850a835a818,0xa8bfa8ada898a882,0xa703a76ea7d3a818,0xa51ea59fa61ca692,0x254a249823bf2241,0x27b22728269225f3,0x28d728f62909290f,0x27d32835287628ad,0x965b1a5a1fe62241,0xa4f2a3bfa17e9e55,0xa8f1a8bfa876a818,0xa8c8a8f6a90da90b
.quad 0xa498a5f3a728a818,0x1e5580009e55a241,0x2790264424c52241,0x290f28f628b62850,0x283528ad28f6290f,0x1fe623bf259f2728,0xa2a19cc21bef2241,0xa8b6a835a703a54a,0xa90ba8ffa8ada818,0xa54aa728a850a8d0,0x9f1ea43da66ba818,0x2790259f22a11a5a,0x289827b2259f2241,0x27f228ad290628ff,0x266b283528d7290f,0xa4c59fe61bef23bf
.quad 0x290f290f290f290f,0x290f290f290f290f,0x1bef1cc21d8c1e55,0x125c165b18c41a5a,0xa8f6a8eba8dfa8d0,0xa90ea90ba906a8ff,0xa1e0a301a40ea498,0x98c49cc29f1ea0b9,0x28ad288228502818,0x290b28ff28eb28d0,0x24c5259f266b2728,0x1bef1fe621e023bf,0xa835a7b2a6dea5f3,0xa906a8eba8bfa882,0xa66ba76ea827a882,0x9d8ca17ea40ea54a
.quad 0x272825f324982241,0x28ff28d028822818,0x27d3286a28c828ff,0x1f1e2301251e2692,0xa59fa3bf9fe60000,0xa8f6a8ada835a728,0xa876a8dfa90da8ff,0xa056a43da61ca7b2,0x23bf1e559a5aa241,0x28eb288227b225f3,0x28d7290e28f12882,0x211c24f227032850,0x9fe61a5a230125f3,0xa8dfa850a6dea498,0xa909a8f6a876a728,0xa1e0a59fa7d3a8ad
.quad 0x290f290f290f290f,0x290f290f290f290f,0x98c4965b925c0000,0x9d8c9cc29bef9a5a,0xa906a90ba90ea90f,0xa8dfa8eba8f6a8ff,0x1f1e1cc218c48000,0x240e230121e020b9,0x28eb28ff290b290f,0x2850288228ad28d0,0xa1e09fe69bef0000,0xa66ba59fa4c5a3bf,0xa8bfa8eba906a90f,0xa6dea7b2a835a882,0x240e217e1d8c8000,0x2827276e266b254a
.quad 0x288228d028ff290f,0x249825f327282818,0xa51ea3019f1e0000,0xa8c8a86aa7d3a692,0xa835a8ada8f6a90f,0x9fe6a3bfa59fa728,0x261c243d20568000,0x290d28df287627b2,0x27b2288228eb290f,0x9a5a1e5523bf25f3,0xa703a4f2a11c0000,0xa8f1a90ea8d7a850,0xa6dea850a8dfa90f,0x23011a5a9fe6a498,0x27d3259f21e08000,0x287628f6290928ad
.quad 0x290f290f290f290f,0x290f290f290f290f,0xa0569fe69f1e9e55,0xa1e0a17ea11ca0b9,0xa898a8ada8bfa8d0,0xa835a850a86aa882,0x261c259f251e2498,0x27d3276e27032692,0x2692272827b22818,0x23bf2498254a25f3,0xa876a835a7d3a728,0xa909a8f6a8d7a8ad,0xa17ea3bfa4f2a5f3,0x1fe61a5a965b9e55,0x290d28f628c82882,0x287628bf28f1290b
.quad 0x9e5500001e552241,0xa728a5f3a498a241,0xa8b6a8f6a90fa8ff,0xa4c5a644a790a850,0x259f23bf1fe68000,0x28f628ad28352728,0x2703283528b628ff,0x9bef1cc222a1254a,0xa850a728a54aa241,0xa8ada8ffa90ba8d0,0xa2a1a59fa790a882,0x266b243d1f1e9a5a,0x290628ad27f225f3,0x259f27b2289828ff,0x9bef1fe624c52728,0xa8d7a835a66ba3bf
.quad 0x290f290f290f290f,0x290f290f290f290f,0xa360a301a2a1a241,0xa46ba43da40ea3bf,0xa76ea7b2a7f2a818,0xa644a692a6dea728,0x288d286a28432818,0x28f128df28c828ad,0x1a5a1e5520b92241,0xa0b99e559a5a0000,0xa8d7a8f6a909a90f,0xa7d3a835a876a8ad,0x2644254a243d2241,0x2898285027f22728,0x251e2644274b2818,0x925c1cc2211c23bf
.quad 0xa8ffa8d0a882a818,0xa882a8d0a8ffa90f,0x2056165b9d8ca241,0x280926de257523bf,0x283528ad28f6290f,0x1fe623bf259f2728,0xa827a6dea51ea241,0xa8e5a90ea8fba8ad,0xa0b9a498a692a818,0x2692249820b98000,0x2903290628b62818,0x240e2644280928ad,0xa4f2a0b9165b2241,0xa90ea8eba86aa728,0xa66ba835a8d7a90f,0x24c51fe69befa3bf
.quad 0x290f290f290f290f,0x290f290f290f290f,0xa51ea4f2a4c5a498,0xa5c9a59fa575a54a,0xa4f2a54aa59fa5f3,0xa301a3bfa43da498,0x290f290e290928ff,0x28e528f62903290b,0xa54aa498a3bfa241,0xa7b2a728a692a5f3,0xa4c5a59fa66ba728,0x9bef9fe6a1e0a3bf,0x290e290b28f628d0,0x286a28ad28df28ff,0xa575a43da1e09e55,0xa88da835a790a692
.quad 0xa498a5f3a728a818,0x1e5580009e55a241,0x290d290628d72882,0x274b283528a328eb,0xa59fa3bf9fe60000,0xa8f6a8ada835a728,0xa46ba644a7d3a882,0x240e1fe6925ca0b9,0x290b28ff28ad2818,0x254a2728285028d0,0xa5c9a3019bef1e55,0xa90da8f6a88da7b2,0xa43da692a835a8d0,0x264423bf1cc29e55,0x290928f628762728,0x21e0259f27d328ad
.quad 0x290f290f290f290f,0x290f290f290f290f,0xa66ba644a61ca5f3,0xa703a6dea6b9a692,0x9fe6a0b9a17ea241,0x965b9a5a9cc29e55,0x2876289828b628d0,0x279027f228272850,0xa8ada882a850a818,0xa90ba8ffa8eba8d0,0x21e01fe61bef8000,0x266b259f24c523bf,0x259f2692276e2818,0x1cc220b923012498,0xa909a90ea8fba8d0,0xa809a86aa8b6a8eb
.quad 0x272825f324982241,0x28ff28d028822818,0x1bef217e246b25f3,0xa5c9a43da11c9a5a,0xa835a8ada8f6a90f,0x9fe6a3bfa59fa728,0x28d7286a279025f3,0x284328bf2903290b,0xa3bf9e551a5a2241,0xa8eba882a7b2a5f3,0xa4c5a6dea843a8d0,0x251e217e125ca0b9,0x28f6290b28bf2818,0x217e254a276e2882,0xa7d3a59fa1e00000,0xa876a8f6a909a8ad
.quad 0x290f290f290f290f,0x290f290f290f290f,0xa790a76ea74ba728,0xa809a7f2a7d3a7b2,0x1cc21a5a165b8000,0x217e20b91fe61e55,0x25c9264426b92728,0x2360243d24c5254a,0xa8eba8ffa90ba90f,0xa850a882a8ada8d0,0x2876283527d32728,0x290928f628d728ad,0xa301a0b99cc20000,0xa76ea692a59fa498,0xa360a4f2a61ca728,0x1f1e165b9befa0b9
.quad 0x288228d028ff290f,0x249825f327282818,0xa8e5a898a827a728,0xa88da8dfa909a90b,0x259f23bf1fe68000,0x28f628ad28352728,0x1d8c230125752728,0xa6b9a4f2a1e09a5a,0xa7b2a882a8eba90f,0x1a5a9e55a3bfa5f3,0x290f28df285d2728,0x2575276e287628eb,0xa76ea54aa17e0000,0xa8bfa90ba8f6a882,0x1bef9fe6a4c5a728,0x28d72835266b23bf
.quad 0x290f290f290f290f,0x290f290f290f290f,0xa843a835a827a818,0xa876a86aa85da850,0x243d23bf23012241,0x259f254a24f22498,0x1d8c1fe6211c2241,0x9bef965b125c1a5a,0xa692a728a7b2a818,0xa3bfa498a54aa5f3,0x28d728f62909290f,0x27d32835287628ad,0xa8dfa8ada86aa818,0xa8f6a90ba90ea8ff,0x26b9259f246b2241,0x28d72898284327b2
.quad 0x9e5500001e552241,0xa728a5f3a498a241,0xa40ea59fa703a818,0x21e01cc298c4a0b9,0x283528ad28f6290f,0x1fe623bf259f2728,0xa90fa8f6a8a3a818,0xa66ba7f2a88da8eb,0x28502728254a2241,0x28ad28ff290b28d0,0xa46b9fe618c42241,0xa909a8bfa827a692,0x9cc2a3bfa644a818,0x28352692243d1e55,0x266b283528d7290f,0xa4c59fe61bef23bf
.quad 0x290f290f290f290f,0x290f290f290f290f,0xa8a3a898a88da882,0xa8c8a8bfa8b6a8ad,0x26de2692264425f3,0x27f227b2276e2728,0xa2a1a17ea0569e55,0xa575a4f2a46ba3bf,0x9a5a9e55a0b9a241,0x20b91e551a5a8000,0x24c5259f266b2728,0x1bef1fe621e023bf,0xa7f2a850a898a8d0,0xa43da54aa644a728,0x28e52906290f28ff,0x270327f2285d28ad
.quad 0xa8ffa8d0a882a818,0xa882a8d0a8ffa90f,0x2843276e261c2498,0x2903290e28f128ad,0xa59fa3bf9fe60000,0xa8f6a8ada835a728,0x1f1e965ba11ca498,0x285d276e25c923bf,0x20b9249826922818,0xa692a498a0b90000,0xa61ca7f2a8a3a8ff,0x23601cc29d8ca3bf,0x286a28eb290e28d0,0x965b20b924f22728,0xa909a8f6a876a728,0xa1e0a59fa7d3a8ad
.quad 0x290f290f290f290f,0x290f290f290f290f,0xa8e5a8dfa8d7a8d0,0xa8fba8f6a8f1a8eb,0x286a285028352818,0x28bf28ad28982882,0xa74ba6dea66ba5f3,0xa85da835a809a7b2,0x254a249823bf2241,0x27b22728269225f3,0xa1e09fe69bef0000,0xa66ba59fa4c5a3bf,0x165b9a5a9fe6a241,0x24f223bf217e1e55,0x2056230124c525f3,0xa2a19fe698c41a5a
.quad 0xa498a5f3a728a818,0x1e5580009e55a241,0x26b927f2287628d0,0x125c1fe62360254a,0xa835a8ada8f6a90f,0x9fe6a3bfa59fa728,0x28c82906290928d0,0x2360259f274b2850,0xa90ba8ffa8ada818,0xa54aa728a850a8d0,0x28fb289827d325f3,0x26b9283528c8290b,0xa898a7b2a59fa241,0xa7f2a8ada906a8ff,0x27d3259f21e08000,0x287628f6290928ad
.quad 0x290f290f290f290f,0x290f290f290f290f,0xa909a906a903a8ff,0xa90fa90ea90da90b,0x28f628eb28df28d0,0x290e290b290628ff,0xa8d7a8bfa8a3a882,0xa90da906a8fba8eb,0x28ad288228502818,0x290b28ff28eb28d0,0xa876a835a7d3a728,0xa909a8f6a8d7a8ad,0x283527b226de25f3,0x290628eb28bf2882,0xa7d3a6dea5c9a498,0xa903a8dfa8a3a850
.quad 0x272825f324982241,0x28ff28d028822818,0xa66ba4f2a2a19e55,0xa8fba8bfa85da7b2,0x259f23bf1fe68000,0x28f628ad28352728,0xa4c5a17e98c41e55,0xa8f1a898a809a692,0x23bf1e559a5aa241,0x28eb288227b225f3,0xa1e0965b20562498,0xa8e5a86aa74ba54a,0x1fe69a5aa301a5f3,0x28df285026de2498,0x9bef1fe624c52728,0xa8d7a835a66ba3bf
.quad 0x290f,0x0,0xa90f,0x0,0x290f,0x0,0xa90f,0x0,0x290f,0x0,0xa90f,0x0,0x290f,0x0,0xa90f,0x0
.quad 0x290f,0x0,0xa90f,0x0,0x290f,0x0,0xa90f,0x0,0x290f,0x0,0xa90f,0x0,0x290f,0x0,0xa90f
.zero 776
.quad 0x290f290f290f290f,0x290f290f290f290f,0x290c290e290f290f,0x290129052908290a,0x29032909290d290f,0x28d728e528f128fb,0x28f42901290a290f,0x289328b128cc28e2,0x28df28f62906290e,0x2835286a289828bf,0x28c428e82901290e,0x277f281028572893,0x28a328d728fb290d,0x266b274b2809285d,0x287c28c428f4290c,0x25342658275d281f
.quad 0x285028ad28eb290b,0x23bf254a269227b2,0x281f289328e2290a,0x20eb242525b42716,0x27d3287628d72909,0x1bef21e024c5266b,0x275d285728cc2908,0x97f21eb9239025b4,0x26de283528bf2906,0x9fe6165b217e24f2,0x2658281028b12905,0xa2d19b251eb92425,0x25c927d328a32903,0xa4c5a05618c422a1,0x2534277f28932901,0xa607a2d197f220eb
.quad 0x290f290f290f290f,0x290f290f290f290f,0x28ee28f428f928fd,0x28d428db28e228e8,0x288d28a328b628c8,0x28272843285d2876,0x27e3281f284a2870,0x263026a62716277f,0x264426de276e27f2,0x2301243d24f2259f,0x24542534260726cc,0x17f21df020eb22d1,0x205622a1246b2575,0xa11c9d8c925c1bef,0x8e5c1d27214d23ee,0xa55fa425a1af9df0
.quad 0xa0b99a5a1a5a20b9,0xa7b2a692a54aa3bf,0xa481a1af9c5d198f,0xa8a8a83ca75da607,0xa66ba4c5a1e09bef,0xa909a8d7a876a7d3,0xa801a67fa4afa14d,0xa8f4a90fa8eea893,0xa898a7f2a644a43d,0xa86aa8dfa90ea8f6,0xa8f4a888a7a1a5b4,0xa6f1a84aa8d4a90e,0xa90fa8e5a85da703,0xa46ba6b9a843a8d7,0xa8e8a90ea8c4a810,0x9df0a454a6cca857
.quad 0x290f290f290f290f,0x290f290f290f290f,0x28b128bb28c428cc,0x28882893289e28a8,0x274b279027d32809,0x261c266b26b92703,0x242524af253425b4,0x1f8220eb22112331,0x165b1cc21fe6217e,0xa17e9fe69cc2965b,0xa2d1a0eb9df097f2,0xa6cca607a534a454,0xa6b9a5c9a4c5a360,0xa8b6a876a827a790,0xa888a82ea77fa67f,0xa90aa90ea8f9a8cc
.quad 0xa90ba8eba8ada850,0xa850a8ada8eba90b,0xa8d4a905a90ea8ee,0xa55fa6cca801a87c,0xa7d3a876a8d7a909,0x9befa1e0a4c5a66b,0xa4dca6a6a810a89e,0x23311df0998fa1af,0x9cc2a301a59fa76e,0x276e259f23011cc2,0x214d0e5ca0eba4dc,0x28db285727162508,0x261c23601bef9f1e,0x28fb290928b62809,0x285726cc24541df0,0x281028c4290e28e8
.quad 0x290f290f290f290f,0x290f290f290f290f,0x285728642870287c,0x281f282e283c284a,0x24c5251e257525c9,0x22a12360240e246b,0x97f20e5c198f1d27,0xa1afa0889eb99c5d,0xa59fa4f2a43da301,0xa7f2a76ea6dea644,0xa893a857a810a77f,0xa90ea901a8e8a8c4,0xa909a90fa903a8e5,0xa843a88da8c8a8f1,0xa810a870a8bba8ee,0xa390a508a630a73a
.quad 0xa3bfa54aa692a7b2,0x20b91a5a9a5aa0b9,0x1df094c5a025a390,0x27a1265824dc2271,0x266b24c521e01bef,0x290928d7287627d3,0x28c4284a273a258a,0x286428d4290a2905,0x28f6290e28df286a,0x243d264427f22898,0x277f287c28ee290f,0x9f82198f2271258a,0x21e025752790288d,0xa74ba51ea11c125c,0xa0eb17f222d12607,0xa901a893a77fa534
.quad 0x290f290f290f290f,0x290f290f290f290f,0x27c227e328012810,0x273a275d277f27a1,0x1f1e2056211c21e0,0x125c18c41bef1d8c,0xa508a481a3eea2d1,0xa6f1a67fa607a58a,0xa8bfa898a86aa835,0xa90ea906a8f6a8df,0xa8c4a8e8a901a90e,0xa77fa810a857a893,0xa51ea61ca703a7d3,0x98c49f1ea1e0a40e,0x1eb914c59c5da0eb,0x26a6258a24542211
.quad 0x27b22692254a23bf,0x290b28eb28ad2850,0x290f28f928bb2857,0x27c2286428c428fd,0x27d3287628d72909,0x1bef21e024c5266b,0x1f8223ee25de277f,0xa658a481a0eb94c5,0xa4f2a17e965b1fe6,0xa906a8bfa835a6de,0xa8bba81fa67fa454,0xa801a8a8a901a908,0xa8c8a90da8f1a876,0x9d8ca40ea66ba827,0xa534a77fa893a901,0x260722d117f2a0eb
.quad 0x290f290f290f290f,0x290f290f290f290f,0x26a626cc26f12716,0x260726302658267f,0x9d8c9bef98c4925c,0xa1e0a11ca0569f1e,0xa83ca810a7c2a75d,0xa8c4a8a8a888a864,0xa8dfa8f6a906a90e,0xa835a86aa898a8bf,0xa454a534a607a6cc,0x97f29df0a0eba2d1,0x240e21e01f1e18c4,0x27d32703261c251e,0x28d42893283c27a1,0x28e82908290f28fd
.quad 0x285028ad28eb290b,0x23bf254a269227b2,0x1eb922d12508267f,0xa534a3319f828e5c,0xa66ba4c5a1e09bef,0xa909a8d7a876a7d3,0xa90fa8e8a888a7e3,0xa6cca81fa8a8a8f9,0xa6dea835a8bfa906,0x1fe6965ba17ea4f2,0x1c5d9df0a3eea630,0x289327c225de2331,0x2827266b240e1d8c,0x287628f1290d28c8,0x28e8290e28c42810,0x1df0245426cc2857
.quad 0x290f290f290f290f,0x290f290f290f290f,0x255f258a25b425de,0x24af24dc25082534,0xa46ba40ea360a2a1,0xa5c9a575a51ea4c5,0xa908a8fda8eea8db,0xa905a90ca90fa90e,0xa644a6dea76ea7f2,0xa301a43da4f2a59f,0x22d120eb1df017f2,0x26cc260725342454,0x28f128c8288d2843,0x28e52903290f2909,0x27162801286428b1,0x2088233124dc2607
.quad 0xa0b99a5a1a5a20b9,0xa7b2a692a54aa3bf,0xa8cca870a7e3a6a6,0xa8b1a8f4a90fa901,0xa7d3a876a8d7a909,0x9befa1e0a4c5a66b,0x1d279b25a211a508,0x283c2716255f22d1,0x289827f22644243d,0x286a28df290e28f6,0x283c28cc290c28f9,0x94c5208824af26cc,0x925c211c251e274b,0xa88da790a575a1e0,0xa857a6cca4549df0,0xa810a8c4a90ea8e8
.quad 0x290f290f290f290f,0x290f290f290f290f,0x23ee242524542481,0x227122d123312390,0xa703a6b9a66ba61c,0xa809a7d3a790a74b,0xa8bba8d4a8e8a8f9,0xa82ea857a87ca89e,0x965b9cc29fe6a17e,0x217e1fe61cc2165b,0x289328572810277f,0x290e290128e828c4,0x27902827287628b6,0x236024c525c926b9,0xa2719f8297f21b25,0xa7c2a6cca5b4a481
.quad 0xa90ba8eba8ada850,0xa850a8ada8eba90b,0xa4afa630a77fa84a,0x208817f29d27a211,0x266b24c521e01bef,0x290928d7287627d3,0x28db290c290128bb,0x2425260727a12870,0x1cc22301259f276e,0xa76ea59fa3019cc2,0xa864a73aa534a1af,0xa870a8e8a90fa8e2,0xa809a8b6a909a8fb,0x1f1e9befa360a61c,0x20eb97f2a2d1a607,0x29012893277f2534
.quad 0x290f290f290f290f,0x290f290f290f290f,0x20eb214d21af2211,0x1eb91f8220252088,0xa876a85da843a827,0xa8c8a8b6a8a3a88d,0xa6cca73aa7a1a801,0xa4dca55fa5dea658,0x259f24f2243d2301,0x27f2276e26de2644,0x28c428e82901290e,0x277f281028572893,0x9bef125c1d8c211c,0xa575a46ba2a1a056,0xa901a8dba89ea84a,0xa8a8a8e2a905a90f
.quad 0xa3bfa54aa692a7b2,0x20b91a5a9a5aa0b9,0x281026f1258a23ee,0x290c290828db2888,0x27d3287628d72909,0x1bef21e024c5266b,0xa454a0888e5c2025,0xa8e2a87ca7c2a630,0xa8f6a90ea8dfa86a,0xa43da644a7f2a898,0x97f2a211a55fa75d,0x282e26a624812025,0x28d7284326b9246b,0x2703285d28e5290f,0x2534277f28932901,0xa607a2d197f220eb
.quad 0x290f290f290f290f,0x290f290f290f290f,0x1b251c5d1d271df0,0xe5c14c517f2198f,0xa8fba8f1a8e5a8d7,0xa90fa90da909a903,0xa14da271a390a454,0x94c59b259df0a025,0x28bf2898286a2835,0x290e290628f628df,0x24542534260726cc,0x17f21df020eb22d1,0xa85da809a74ba66b,0xa90da8fba8d7a8a3,0xa5dea6f1a7e3a857,0x998fa025a2d1a4af
.quad 0x27b22692254a23bf,0x290b28eb28ad2850,0x273a282e289e28e8,0x1b25214d245425de,0xa66ba4c5a1e09bef,0xa909a8d7a876a7d3,0xa82ea8b1a8fda90e,0x9c5da271a534a6f1,0x24f2217e165b9fe6,0x290628bf283526de,0x289e28fd290a28c4,0x1d272390260727e3,0xa2a198c4205624c5,0xa903a8a3a7d3a5c9,0xa8e8a90ea8c4a810,0x9df0a454a6cca857
.quad 0x290f290f290f290f,0x290f290f290f290f,0x998f97f294c58e5c,0x9df09d279c5d9b25,0xa903a909a90da90f,0xa8d7a8e5a8f1a8fb,0x20251df01b2514c5,0x245423902271214d,0x28df28f62906290e,0x2835286a289828bf,0xa2d1a0eb9df097f2,0xa6cca607a534a454,0xa8a3a8d7a8fba90d,0xa66ba74ba809a85d,0x24af22d12025198f,0x285727e326f125de
.quad 0x285028ad28eb290b,0x23bf254a269227b2,0xa5dea454a14d9b25,0xa8e8a89ea82ea73a,0xa7d3a876a8d7a909,0x9befa1e0a4c5a66b,0x26f1253422711c5d,0x290e28fd28b1282e,0x26de283528bf2906,0x9fe6165b217e24f2,0xa7e3a607a3909d27,0xa8c4a90aa8fda89e,0xa5c9a7d3a8a3a903,0x24c5205698c4a2a1,0x285726cc24541df0,0x281028c4290e28e8
.quad 0x290f290f290f290f,0x290f290f290f290f,0xa088a0259f829eb9,0xa211a1afa14da0eb,0xa88da8a3a8b6a8c8,0xa827a843a85da876,0x265825de255f24dc,0x280127a1273a26cc,0x264426de276e27f2,0x2301243d24f2259f,0xa893a857a810a77f,0xa90ea901a8e8a8c4,0xa056a2a1a46ba575,0x211c1d8c125c9bef,0x290f290528e228a8,0x284a289e28db2901
.quad 0xa0b99a5a1a5a20b9,0xa7b2a692a54aa3bf,0xa888a8dba908a90c,0xa3eea58aa6f1a810,0x266b24c521e01bef,0x290928d7287627d3,0x263027c2287c28e2,0xa0250e5c20882454,0xa898a7f2a644a43d,0xa86aa8dfa90ea8f6,0xa025a481a6a6a82e,0x275d255f221117f2,0x290f28e5285d2703,0x246b26b9284328d7,0xa0eb17f222d12607,0xa901a893a77fa534
.quad 0x290f290f290f290f,0x290f290f290f290f,0xa390a331a2d1a271,0xa481a454a425a3ee,0xa74ba790a7d3a809,0xa61ca66ba6b9a703,0x289e287c2857282e,0x28f928e828d428bb,0x165b1cc21fe6217e,0xa17e9fe69cc2965b,0xa8c4a8e8a901a90e,0xa77fa810a857a893,0x26b925c924c52360,0x28b6287628272790,0x248125b426cc27c2,0x9b2517f21f822271
.quad 0xa90ba8eba8ada850,0xa850a8ada8eba90b,0x22111d2797f2a088,0x284a277f263024af,0x27d3287628d72909,0x1bef21e024c5266b,0xa870a7a1a607a425,0xa8bba901a90ca8db,0x9cc2a301a59fa76e,0x276e259f23011cc2,0x28e2290f28e82870,0x21af2534273a2864,0xa61ca3609bef1f1e,0xa8fba909a8b6a809,0xa534a77fa893a901,0x260722d117f2a0eb
.quad 0x290f290f290f290f,0x290f290f290f290f,0xa534a508a4dca4af,0xa5dea5b4a58aa55f,0xa4c5a51ea575a5c9,0xa2a1a360a40ea46b,0x290e290f290c2905,0x28db28ee28fd2908,0xa59fa4f2a43da301,0xa7f2a76ea6dea644,0xa454a534a607a6cc,0x97f29df0a0eba2d1,0x2909290f290328e5,0x2843288d28c828f1,0xa607a4dca331a088,0xa8b1a864a801a716
.quad 0xa3bfa54aa692a7b2,0x20b91a5a9a5aa0b9,0x2901290f28f428b1,0x26a627e3287028cc,0xa66ba4c5a1e09bef,0xa909a8d7a876a7d3,0xa2d1a55fa716a83c,0x250822111b259d27,0x28f6290e28df286a,0x243d264427f22898,0xa6cca4afa08814c5,0xa8f9a90ca8cca83c,0xa1e0a575a790a88d,0x274b251e211c925c,0x28e8290e28c42810,0x1df0245426cc2857
.quad 0x290f290f290f290f,0x290f290f290f290f,0xa67fa658a630a607,0xa716a6f1a6cca6a6,0x9f1ea056a11ca1e0,0x925c98c49bef9d8c,0x2864288828a828c4,0x275d27c22810283c,0xa8bfa898a86aa835,0xa90ea906a8f6a8df,0x22d120eb1df017f2,0x26cc260725342454,0x251e261c270327d3,0x18c41f1e21e0240e,0xa8fda90fa908a8e8,0xa7a1a83ca893a8d4
.quad 0x27b22692254a23bf,0x290b28eb28ad2850,0xe5c1f8223312534,0xa67fa508a2d19eb9,0xa7d3a876a8d7a909,0x9befa1e0a4c5a66b,0x28f928a8281f26cc,0x27e3288828e8290f,0xa4f2a17e965b1fe6,0xa906a8bfa835a6de,0xa331a5dea7c2a893,0x263023ee1df09c5d,0x28c8290d28f12876,0x1d8c240e266b2827,0xa857a6cca4549df0,0xa810a8c4a90ea8e8
.quad 0x290f290f290f290f,0x290f290f290f290f,0xa7a1a77fa75da73a,0xa810a801a7e3a7c2,0x1d8c1bef18c4125c,0x21e0211c20561f1e,0x258a2607267f26f1,0x22d123ee24812508,0xa8dfa8f6a906a90e,0xa835a86aa898a8bf,0x289328572810277f,0x290e290128e828c4,0xa40ea1e09f1e98c4,0xa7d3a703a61ca51e,0xa211a454a58aa6a6,0x20eb1c5d94c59eb9
.quad 0x285028ad28eb290b,0x23bf254a269227b2,0xa8fda8c4a864a7c2,0xa857a8bba8f9a90f,0x266b24c521e01bef,0x290928d7287627d3,0x14c520eb24812658,0xa77fa5dea3ee9f82,0xa6dea835a8bfa906,0x1fe6965ba17ea4f2,0x2908290128a82801,0x2454267f281f28bb,0xa827a66ba40e9d8c,0xa876a8f1a90da8c8,0x20eb97f2a2d1a607,0x29012893277f2534
.quad 0x290f290f290f290f,0x290f290f290f290f,0xa84aa83ca82ea81f,0xa87ca870a864a857,0x246b240e236022a1,0x25c92575251e24c5,0x1c5d1eb9208821af,0x9d27998f8e5c17f2,0xa644a6dea76ea7f2,0xa301a43da4f2a59f,0x28c428e82901290e,0x277f281028572893,0xa8f1a8c8a88da843,0xa8e5a903a90fa909,0x273a263025082390,0x28ee28bb28702810
.quad 0xa0b99a5a1a5a20b9,0xa7b2a692a54aa3bf,0xa271a4dca658a7a1,0x2390202514c59df0,0x27d3287628d72909,0x1bef21e024c5266b,0xa905a90aa8d4a864,0xa58aa73aa84aa8c4,0x289827f22644243d,0x286a28df290e28f6,0xa58aa271998f1f82,0xa90fa8eea87ca77f,0x125ca11ca51ea74b,0x288d2790257521e0,0x2534277f28932901,0xa607a2d197f220eb
.quad 0x290f290f290f290f,0x290f290f290f290f,0xa8a8a89ea893a888,0xa8cca8c4a8bba8b1,0x270326b9266b261c,0x280927d32790274b,0xa331a211a0eb9f82,0xa5b4a534a4afa425,0x965b9cc29fe6a17e,0x217e1fe61cc2165b,0x24542534260726cc,0x17f21df020eb22d1,0xa790a827a876a8b6,0xa360a4c5a5c9a6b9,0x28cc28f9290e290a,0x267f277f282e2888
.quad 0xa90ba8eba8ada850,0xa850a8ada8eba90b,0x287c280126cc255f,0x28ee290e290528d4,0xa66ba4c5a1e09bef,0xa909a8d7a876a7d3,0x21af198f9df0a331,0x289e281026a624dc,0x1cc22301259f276e,0xa76ea59fa3019cc2,0xa508a716a857a8db,0x24dc20eb8e5ca14d,0x280928b6290928fb,0x9f1e1bef2360261c,0xa8e8a90ea8c4a810,0x9df0a454a6cca857
.quad 0x290f290f290f290f,0x290f290f290f290f,0xa8e8a8e2a8dba8d4,0xa8fda8f9a8f4a8ee,0x2876285d28432827,0x28c828b628a3288d,0xa77fa716a6a6a630,0xa870a84aa81fa7e3,0x259f24f2243d2301,0x27f2276e26de2644,0xa2d1a0eb9df097f2,0xa6cca607a534a454,0x1bef925c9d8ca11c,0x2575246b22a12056,0x1df021af2425255f,0xa3eea14d9d270e5c
.quad 0xa3bfa54aa692a7b2,0x20b91a5a9a5aa0b9,0x2607275d283c28a8,0x998f1c5d21af2481,0xa7d3a876a8d7a909,0x9befa1e0a4c5a66b,0x289328ee290f28f4,0x214d24af267f2801,0xa8f6a90ea8dfa86a,0xa43da644a7f2a898,0x290e28d4284a26f1,0x25b427a1288828f4,0xa8d7a843a6b9a46b,0xa703a85da8e5a90f,0x285726cc24541df0,0x281028c4290e28e8
.quad 0x290f290f290f290f,0x290f290f290f290f,0xa90aa908a905a901,0xa90fa90fa90ea90c,0x28fb28f128e528d7,0x290f290d29092903,0xa8e2a8cca8b1a893,0xa90fa90aa901a8f4,0x28bf2898286a2835,0x290e290628f628df,0xa893a857a810a77f,0xa90ea901a8e8a8c4,0x285d2809274b266b,0x290d28fb28d728a3,0xa81fa75da658a534,0xa90ca8f4a8c4a87c
.quad 0x27b22692254a23bf,0x290b28eb28ad2850,0xa716a5b4a425a0eb,0xa90aa8e2a893a81f,0x266b24c521e01bef,0x290928d7287627d3,0xa5b4a3909eb917f2,0xa908a8cca857a75d,0x24f2217e165b9fe6,0x290628bf283526de,0xa4259eb91b2522d1,0xa905a8b1a810a658,0x22a118c4a056a4c5,0x290328a327d325c9,0xa0eb17f222d12607,0xa901a893a77fa534
.quad 0x0,0x0,0x18c4165b125c0000,0x1d8c1cc21bef1a5a,0x1cc21a5a165b0000,0x217e20b91fe61e55,0x1f1e1cc218c40000,0x240e230121e020b9,0x20b91e551a5a0000,0x254a249823bf2241,0x21e01fe61bef0000,0x266b259f24c523bf,0x230120b91cc20000,0x276e2692259f2498,0x240e217e1d8c0000,0x2827276e266b254a
.quad 0x249822411e550000,0x28822818272825f3,0x251e23011f1e0000,0x28c8286a27d32692,0x259f23bf1fe60000,0x28f628ad28352728,0x261c243d20560000,0x290d28df287627b2,0x2692249820b90000,0x290b28ff28ad2818,0x270324f2211c0000,0x28f1290e28d72850,0x276e254a217e0000,0x28bf290b28f62882,0x27d3259f21e00000,0x287628f6290928ad
.quad 0x0,0x0,0x20561fe61f1e1e55,0x21e0217e211c20b9,0x243d23bf23012241,0x259f254a24f22498,0x261c259f251e2498,0x27d3276e27032692,0x27b22728269225f3,0x28ad288228502818,0x2876283527d32728,0x290928f628d728ad,0x28df28ad286a2818,0x28f6290b290e28ff,0x290d28f628c82882,0x287628bf28f1290b
.quad 0x28ff290f28ff28d0,0x27282818288228d0,0x28b628f6290f28ff,0x24c5264427902850,0x283528ad28f6290f,0x1fe623bf259f2728,0x2703283528b628ff,0x9bef1cc222a1254a,0x254a2728285028d0,0xa3bf9e551a5a2241,0x22a1259f27902882,0xa66ba43d9f1e1a5a,0x1cc223bf26442818,0xa835a692a43d9e55,0x9bef1fe624c52728,0xa8d7a835a66ba3bf
.quad 0x0,0x0,0x2360230122a12241,0x246b243d240e23bf,0x26de2692264425f3,0x27f227b2276e2728,0x288d286a28432818,0x28f128df28c828ad,0x290b28ff28eb28d0,0x28eb28ff290b290f,0x28d728f62909290f,0x27d32835287628ad,0x27f22850289828d0,0x243d254a26442728,0x251e2644274b2818,0x925c1cc2211c23bf
.quad 0x1e552241249825f3,0xa498a2419e550000,0xa056965b1d8c2241,0xa809a6dea575a3bf,0xa59fa3bf9fe60000,0xa8f6a8ada835a728,0xa827a6dea51ea241,0xa8e5a90ea8fba8ad,0xa8eba882a7b2a5f3,0xa7b2a882a8eba90f,0xa903a906a8b6a818,0xa40ea644a809a8ad,0xa86aa8eba90ea8d0,0x165ba0b9a4f2a728,0xa66ba835a8d7a90f,0x24c51fe69befa3bf
.quad 0x0,0x0,0x251e24f224c52498,0x25c9259f2575254a,0x286a285028352818,0x28bf28ad28982882,0x290f290e290928ff,0x28e528f62903290b,0x2850288228ad28d0,0x2692272827b22818,0x24c5259f266b2728,0x1bef1fe621e023bf,0x965b1a5a1fe62241,0xa4f2a3bfa17e9e55,0xa575a43da1e09e55,0xa88da835a790a692
.quad 0xa882a818a728a5f3,0xa8ffa90fa8ffa8d0,0xa90da906a8d7a882,0xa74ba835a8a3a8eb,0xa835a8ada8f6a90f,0x9fe6a3bfa59fa728,0xa46ba644a7d3a882,0x240e1fe6925ca0b9,0x1a5a9e55a3bfa5f3,0x28502728254a2241,0x25c923011bef9e55,0x290d28f6288d27b2,0x289827b2259f2241,0x27f228ad290628ff,0x290928f628762728,0x21e0259f27d328ad
.quad 0x0,0x0,0x266b2644261c25f3,0x270326de26b92692,0x28f628eb28df28d0,0x290e290b290628ff,0x2876289828b628d0,0x279027f228272850,0x23bf2498254a25f3,0x1a5a1e5520b92241,0xa1e09fe69bef0000,0xa66ba59fa4c5a3bf,0xa835a7b2a6dea5f3,0xa906a8eba8bfa882,0xa909a90ea8fba8d0,0xa809a86aa8b6a8eb
.quad 0xa728a818a882a8d0,0x9e55a241a498a5f3,0x9befa17ea46ba5f3,0x25c9243d211c1a5a,0x259f23bf1fe60000,0x28f628ad28352728,0x28d7286a279025f3,0x284328bf2903290b,0x28ad28ff290b28d0,0x20b9249826922818,0x24c526de284328d0,0xa51ea17e925c20b9,0x9fe61a5a230125f3,0xa8dfa850a6dea498,0xa7d3a59fa1e00000,0xa876a8f6a909a8ad
.quad 0x0,0x0,0x2790276e274b2728,0x280927f227d327b2,0x2906290b290e290f,0x28df28eb28f628ff,0x25c9264426b92728,0x2360243d24c5254a,0xa0b99e559a5a0000,0xa54aa498a3bfa241,0xa876a835a7d3a728,0xa909a8f6a8d7a8ad,0xa8bfa8eba906a90f,0xa6dea7b2a835a882,0xa360a4f2a61ca728,0x1f1e165b9befa0b9
.quad 0x249822411e550000,0x28822818272825f3,0x28e5289828272728,0x288d28df2909290b,0x283528ad28f6290f,0x1fe623bf259f2728,0x1d8c230125752728,0xa6b9a4f2a1e09a5a,0xa692a498a0b90000,0xa90ba8ffa8ada818,0xa90fa8dfa85da728,0xa575a76ea876a8eb,0xa6dea850a8dfa90f,0x23011a5a9fe6a498,0x1bef9fe6a4c5a728,0x28d72835266b23bf
.quad 0x0,0x0,0x2843283528272818,0x2876286a285d2850,0x289828ad28bf28d0,0x28352850286a2882,0x1d8c1fe6211c2241,0x9bef965b125c1a5a,0xa7b2a728a692a5f3,0xa8ada882a850a818,0xa8d7a8f6a909a90f,0xa7d3a835a876a8ad,0xa17ea3bfa4f2a5f3,0x1fe61a5a965b9e55,0x26b9259f246b2241,0x28d72898284327b2
.quad 0x28ff290f28ff28d0,0x27282818288228d0,0x240e259f27032818,0xa1e09cc218c420b9,0xa59fa3bf9fe60000,0xa8f6a8ada835a728,0xa90fa8f6a8a3a818,0xa66ba7f2a88da8eb,0xa54aa728a850a8d0,0x23bf1e559a5aa241,0x246b1fe698c4a241,0x290928bf28272692,0x290628ad27f225f3,0x259f27b2289828ff,0x266b283528d7290f,0xa4c59fe61bef23bf
.quad 0x0,0x0,0x28a32898288d2882,0x28c828bf28b628ad,0x276e27b227f22818,0x2644269226de2728,0xa2a1a17ea0569e55,0xa575a4f2a46ba3bf,0xa90ba8ffa8eba8d0,0xa8eba8ffa90ba90f,0xa4c5a59fa66ba728,0x9bef9fe6a1e0a3bf,0x2644254a243d2241,0x2898285027f22728,0x28e52906290f28ff,0x270327f2285d28ad
.quad 0x1e552241249825f3,0xa498a2419e550000,0xa843a76ea61ca498,0xa903a90ea8f1a8ad,0xa835a8ada8f6a90f,0x9fe6a3bfa59fa728,0x1f1e965ba11ca498,0x285d276e25c923bf,0x28eb288227b225f3,0x27b2288228eb290f,0x261c27f228a328ff,0xa3609cc21d8c23bf,0xa4f2a0b9165b2241,0xa90ea8eba86aa728,0xa909a8f6a876a728,0xa1e0a59fa7d3a8ad
.quad 0x0,0x0,0x28e528df28d728d0,0x28fb28f628f128eb,0x24f2254a259f25f3,0x230123bf243d2498,0xa74ba6dea66ba5f3,0xa85da835a809a7b2,0xa850a882a8ada8d0,0xa692a728a7b2a818,0x21e01fe61bef0000,0x266b259f24c523bf,0x290e290b28f628d0,0x286a28ad28df28ff,0x2056230124c525f3,0xa2a19fe698c41a5a
.quad 0xa882a818a728a5f3,0xa8ffa90fa8ffa8d0,0xa6b9a7f2a876a8d0,0x925c9fe6a360a54a,0x259f23bf1fe60000,0x28f628ad28352728,0x28c82906290928d0,0x2360259f274b2850,0x9a5a1e5523bf25f3,0xa850a728a54aa241,0xa8fba898a7d3a5f3,0xa6b9a835a8c8a90b,0xa43da692a835a8d0,0x264423bf1cc29e55,0x27d3259f21e00000,0x287628f6290928ad
.quad 0x0,0x0,0x29092906290328ff,0x290f290e290d290b,0x1fe620b9217e2241,0x165b1a5a1cc21e55,0xa8d7a8bfa8a3a882,0xa90da906a8fba8eb,0xa3bfa498a54aa5f3,0x9a5a9e55a0b9a241,0x2876283527d32728,0x290928f628d728ad,0x259f2692276e2818,0x1cc220b923012498,0xa7d3a6dea5c9a498,0xa903a8dfa8a3a850
.quad 0xa728a818a882a8d0,0x9e55a241a498a5f3,0x266b24f222a11e55,0x28fb28bf285d27b2,0x283528ad28f6290f,0x1fe623bf259f2728,0xa4c5a17e98c41e55,0xa8f1a898a809a692,0xa8ada8ffa90ba8d0,0xa0b9a498a692a818,0x21e0165ba056a498,0x28e5286a274b254a,0x28f6290b28bf2818,0x217e254a276e2882,0x9bef1fe624c52728,0xa8d7a835a66ba3bf
.quad 0x0,0x0,0x290d290e290f290f,0x290329062909290b,0x9cc29a5a965b0000,0xa17ea0b99fe69e55,0xa8fba906a90da90f,0xa8a3a8bfa8d7a8eb,0x20b91e551a5a0000,0x254a249823bf2241,0x28d728f62909290f,0x27d32835287628ad,0xa301a0b99cc20000,0xa76ea692a59fa498,0xa8a3a8dfa903a90f,0xa5c9a6dea7d3a850
.quad 0x249822411e550000,0x28822818272825f3,0x285d28bf28fb290f,0x22a124f2266b27b2,0xa59fa3bf9fe60000,0xa8f6a8ada835a728,0xa809a898a8f1a90f,0x98c4a17ea4c5a692,0x2692249820b90000,0x290b28ff28ad2818,0x274b286a28e5290f,0xa056165b21e0254a,0xa76ea54aa17e0000,0xa8bfa90ba8f6a882,0xa66ba835a8d7a90f,0x24c51fe69befa3bf
.quad 0x0,0x0,0x28f128f628fb28ff,0x28d728df28e528eb,0xa43da3bfa301a241,0xa59fa54aa4f2a498,0xa809a835a85da882,0xa66ba6dea74ba7b2,0x27b22728269225f3,0x28ad288228502818,0x24c5259f266b2728,0x1bef1fe621e023bf,0xa8dfa8ada86aa818,0xa8f6a90ba90ea8ff,0x98c49fe6a2a1a498,0x24c5230120561a5a
.quad 0x28ff290f28ff28d0,0x27282818288228d0,0xa3609fe6925c1e55,0xa876a7f2a6b9a54a,0xa835a8ada8f6a90f,0x9fe6a3bfa59fa728,0x274b259f23601e55,0x2909290628c82850,0x254a2728285028d0,0xa3bf9e551a5a2241,0xa8c8a835a6b9a498,0xa7d3a898a8fba90b,0x9cc2a3bfa644a818,0x28352692243d1e55,0x290928f628762728,0x21e0259f27d328ad
.quad 0x0,0x0,0x28b628bf28c828d0,0x288d289828a328ad,0xa6dea692a644a5f3,0xa7f2a7b2a76ea728,0xa46ba4f2a575a5f3,0xa056a17ea2a1a3bf,0x290b28ff28eb28d0,0x28eb28ff290b290f,0xa1e09fe69bef0000,0xa66ba59fa4c5a3bf,0xa7f2a850a898a8d0,0xa43da54aa644a728,0x285d27f2270325f3,0x290f290628e528ad
.quad 0x1e552241249825f3,0xa498a2419e550000,0xa8f1a90ea903a8d0,0xa61ca76ea843a8ad,0x259f23bf1fe60000,0x28f628ad28352728,0x25c9276e285d28d0,0xa11c965b1f1e23bf,0xa8eba882a7b2a5f3,0xa7b2a882a8eba90f,0x1d8c9cc2a360a5f3,0x28a327f2261c23bf,0x286a28eb290e28d0,0x965b20b924f22728,0xa7d3a59fa1e00000,0xa876a8f6a909a8ad
.quad 0x0,0x0,0x285d286a28762882,0x2827283528432850,0xa86aa850a835a818,0xa8bfa8ada898a882,0x125c965b9bef9e55,0x211c1fe61d8c1a5a,0x2850288228ad28d0,0x2692272827b22818,0xa876a835a7d3a728,0xa909a8f6a8d7a8ad,0x165b9a5a9fe6a241,0x24f223bf217e1e55,0x2843289828d728ff,0x246b259f26b927b2
.quad 0xa882a818a728a5f3,0xa8ffa90fa8ffa8d0,0x18c49cc2a1e0a498,0x2703259f240e20b9,0x283528ad28f6290f,0x1fe623bf259f2728,0xa88da7f2a66ba498,0xa8a3a8f6a90fa8eb,0x1a5a9e55a3bfa5f3,0x28502728254a2241,0x282728bf290928ff,0x98c41fe6246b2692,0xa898a7b2a59fa241,0xa7f2a8ada906a8ff,0x1bef9fe6a4c5a728,0x28d72835266b23bf
.quad 0x0,0x0,0x27d327f228092818,0x274b276e279027b2,0xa8f6a8eba8dfa8d0,0xa90ea90ba906a8ff,0x24c5243d23602241,0x26b9264425c9254a,0x23bf2498254a25f3,0x1a5a1e5520b92241,0xa8d7a8f6a909a90f,0xa7d3a835a876a8ad,0x283527b226de25f3,0x290628eb28bf2882,0x9bef165b1f1e2241,0xa61ca4f2a360a0b9
.quad 0xa728a818a882a8d0,0x9e55a241a498a5f3,0x290928df288d2818,0x2827289828e5290b,0xa59fa3bf9fe60000,0xa8f6a8ada835a728,0xa1e0a4f2a6b9a818,0x257523011d8c9a5a,0x28ad28ff290b28d0,0x20b9249826922818,0xa876a76ea575a241,0xa85da8dfa90fa8eb,0x1fe69a5aa301a5f3,0x28df285026de2498,0x266b283528d7290f,0xa4c59fe61bef23bf
.quad 0x0,0x0,0x26b926de27032728,0x261c2644266b2692,0xa906a90ba90ea90f,0xa8dfa8eba8f6a8ff,0x282727f227902728,0x28b6289828762850,0xa0b99e559a5a0000,0xa54aa498a3bfa241,0xa4c5a59fa66ba728,0x9bef9fe6a1e0a3bf,0x28bf28eb2906290f,0x26de27b228352882,0xa8b6a86aa809a728,0xa8fba90ea909a8eb
.quad 0x249822411e550000,0x28822818272825f3,0x211c243d25c92728,0xa46ba17e9bef1a5a,0xa835a8ada8f6a90f,0x9fe6a3bfa59fa728,0x290328bf28432728,0x2790286a28d7290b,0xa692a498a0b90000,0xa90ba8ffa8ada818,0x925ca17ea51ea728,0x284326de24c520b9,0x26de285028df290f,0xa3019a5a1fe62498,0xa909a8f6a876a728,0xa1e0a59fa7d3a8ad
.quad 0x0,0x0,0x2575259f25c925f3,0x24c524f2251e254a,0xa898a8ada8bfa8d0,0xa835a850a86aa882,0x290328f628e528d0,0x2909290e290f290b,0xa7b2a728a692a5f3,0xa8ada882a850a818,0x21e01fe61bef0000,0x266b259f24c523bf,0x217e23bf24f225f3,0x9fe69a5a165b1e55,0xa790a835a88da8d0,0xa1e0a43da575a692
.quad 0x28ff290f28ff28d0,0x27282818288228d0,0xa8a3a835a74ba5f3,0xa8d7a906a90da8eb,0x259f23bf1fe60000,0x28f628ad28352728,0x925c1fe6240e25f3,0xa7d3a644a46ba0b9,0xa54aa728a850a8d0,0x23bf1e559a5aa241,0x288d28f6290d28d0,0x1bef230125c927b2,0xa906a8ada7f2a5f3,0xa59fa7b2a898a8ff,0x27d3259f21e00000,0x287628f6290928ad
.quad 0x0,0x0,0x240e243d246b2498,0x22a12301236023bf,0xa76ea7b2a7f2a818,0xa644a692a6dea728,0x28c828df28f128ff,0x2843286a288d28ad,0xa90ba8ffa8eba8d0,0xa8eba8ffa90ba90f,0x2876283527d32728,0x290928f628d728ad,0xa644a54aa43da241,0xa898a850a7f2a728,0x211c1cc2925c9e55,0x274b2644251e23bf
.quad 0x1e552241249825f3,0xa498a2419e550000,0xa575a6dea809a882,0x1d8c965ba056a3bf,0x283528ad28f6290f,0x1fe623bf259f2728,0xa8fba90ea8e5a882,0xa51ea6dea827a8ad,0x28eb288227b225f3,0x27b2288228eb290f,0xa809a644a40e9e55,0xa8b6a906a903a8ad,0x24f220b9965ba241,0x290e28eb286a2728,0x9bef1fe624c52728,0xa8d7a835a66ba3bf
.quad 0x0,0x0,0x211c217e21e02241,0x1f1e1fe6205620b9,0xa4f2a54aa59fa5f3,0xa301a3bfa43da498,0x2703276e27d32818,0x251e259f261c2692,0xa850a882a8ada8d0,0xa692a728a7b2a818,0x28d728f62909290f,0x27d32835287628ad,0xa90ea90ba8f6a8d0,0xa86aa8ada8dfa8ff,0x28f128bf28762818,0x28c828f6290d290b
.quad 0xa882a818a728a5f3,0xa8ffa90fa8ffa8d0,0x2790264424c52241,0x290f28f628b62850,0xa59fa3bf9fe60000,0xa8f6a8ada835a728,0x22a11cc29befa241,0x28b628352703254a,0x9a5a1e5523bf25f3,0xa850a728a54aa241,0x9f1ea43da66ba818,0x2790259f22a11a5a,0x243d2692283528d0,0xa644a3bf9cc21e55,0xa66ba835a8d7a90f,0x24c51fe69befa3bf
.quad 0x0,0x0,0x1bef1cc21d8c1e55,0x125c165b18c41a5a,0x9fe6a0b9a17ea241,0x965b9a5a9cc29e55,0x21e02301240e2498,0x18c41cc21f1e20b9,0xa3bfa498a54aa5f3,0x9a5a9e55a0b9a241,0x24c5259f266b2728,0x1bef1fe621e023bf,0xa59fa692a76ea818,0x9cc2a0b9a301a498,0x266b276e28272882,0x1d8c217e240e254a
.quad 0xa728a818a882a8d0,0x9e55a241a498a5f3,0x27d3286a28c828ff,0x1f1e2301251e2692,0xa835a8ada8f6a90f,0x9fe6a3bfa59fa728,0x287628df290d28ff,0x2056243d261c27b2,0xa8ada8ffa90ba8d0,0xa0b9a498a692a818,0x28d7290e28f12882,0x211c24f227032850,0xa8f6a90ba8bfa818,0xa17ea54aa76ea882,0x290928f628762728,0x21e0259f27d328ad
.quad 0x0,0x0,0x198f17f214c50e5c,0x1df01d271c5d1b25,0x1d8c1bef18c4125c,0x21e0211c20561f1e,0x20251df01b2514c5,0x245423902271214d,0x217e1fe61cc2165b,0x259f24f2243d2301,0x22d120eb1df017f2,0x26cc260725342454,0x240e21e01f1e18c4,0x27d32703261c251e,0x24af22d12025198f,0x285727e326f125de
.quad 0x254a23bf20b91a5a,0x28ad285027b22692,0x25de2454214d1b25,0x28e8289e282e273a,0x266b24c521e01bef,0x290928d7287627d3,0x26f1253422711c5d,0x290e28fd28b1282e,0x276e259f23011cc2,0x28f6290e28df286a,0x27e3260723901d27,0x28c4290a28fd289e,0x2827266b240e1d8c,0x287628f1290d28c8,0x285726cc24541df0,0x281028c4290e28e8
.quad 0x0,0x0,0x208820251f821eb9,0x221121af214d20eb,0x246b240e236022a1,0x25c92575251e24c5,0x265825de255f24dc,0x280127a1273a26cc,0x27f2276e26de2644,0x28bf2898286a2835,0x289328572810277f,0x290e290128e828c4,0x28f128c8288d2843,0x28e52903290f2909,0x290f290528e228a8,0x284a289e28db2901
.quad 0x28eb290b290b28eb,0x269227b2285028ad,0x288828db2908290c,0x23ee258a26f12810,0x27d3287628d72909,0x1bef21e024c5266b,0x263027c2287c28e2,0xa0250e5c20882454,0x243d264427f22898,0xa4f2a17e965b1fe6,0x2025248126a6282e,0xa75da55fa21197f2,0x925c211c251e274b,0xa88da790a575a1e0,0xa0eb17f222d12607,0xa901a893a77fa534
.quad 0x0,0x0,0x2390233122d12271,0x24812454242523ee,0x270326b9266b261c,0x280927d32790274b,0x289e287c2857282e,0x28f928e828d428bb,0x290e290628f628df,0x28df28f62906290e,0x28c428e82901290e,0x277f281028572893,0x27902827287628b6,0x236024c525c926b9,0x248125b426cc27c2,0x9b2517f21f822271
.quad 0x1a5a20b923bf254a,0xa54aa3bfa0b99a5a,0xa2119d2717f22088,0xa84aa77fa630a4af,0xa66ba4c5a1e09bef,0xa909a8d7a876a7d3,0xa870a7a1a607a425,0xa8bba901a90ca8db,0xa906a8bfa835a6de,0xa6dea835a8bfa906,0xa8e2a90fa8e8a870,0xa1afa534a73aa864,0xa809a8b6a909a8fb,0x1f1e9befa360a61c,0xa534a77fa893a901,0x260722d117f2a0eb
.quad 0x0,0x0,0x2534250824dc24af,0x25de25b4258a255f,0x2876285d28432827,0x28c828b628a3288d,0x290e290f290c2905,0x28db28ee28fd2908,0x2835286a289828bf,0x264426de276e27f2,0x24542534260726cc,0x17f21df020eb22d1,0x9bef125c1d8c211c,0xa575a46ba2a1a056,0xa607a4dca331a088,0xa8b1a864a801a716
.quad 0xa8ada850a7b2a692,0xa8eba90ba90ba8eb,0xa901a90fa8f4a8b1,0xa6a6a7e3a870a8cc,0xa7d3a876a8d7a909,0x9befa1e0a4c5a66b,0xa2d1a55fa716a83c,0x250822111b259d27,0x1fe6965ba17ea4f2,0x289827f22644243d,0x26cc24af208894c5,0x28f9290c28cc283c,0x28d7284326b9246b,0x2703285d28e5290f,0x28e8290e28c42810,0x1df0245426cc2857
.quad 0x0,0x0,0x267f265826302607,0x271626f126cc26a6,0x28fb28f128e528d7,0x290f290d29092903,0x2864288828a828c4,0x275d27c22810283c,0x2301243d24f2259f,0x165b1cc21fe6217e,0xa2d1a0eb9df097f2,0xa6cca607a534a454,0xa85da809a74ba66b,0xa90da8fba8d7a8a3,0xa8fda90fa908a8e8,0xa7a1a83ca893a8d4
.quad 0xa692a7b2a850a8ad,0x9a5aa0b9a3bfa54a,0x8e5c9f82a331a534,0x267f250822d11eb9,0x266b24c521e01bef,0x290928d7287627d3,0x28f928a8281f26cc,0x27e3288828e8290f,0x286a28df290e28f6,0x1cc22301259f276e,0x233125de27c22893,0xa630a3ee9df01c5d,0xa2a198c4205624c5,0xa903a8a3a7d3a5c9,0xa857a6cca4549df0,0xa810a8c4a90ea8e8
.quad 0x0,0x0,0x27a1277f275d273a,0x2810280127e327c2,0x29032909290d290f,0x28d728e528f128fb,0x258a2607267f26f1,0x22d123ee24812508,0xa17e9fe69cc2965b,0xa59fa4f2a43da301,0xa893a857a810a77f,0xa90ea901a8e8a8c4,0xa8a3a8d7a8fba90d,0xa66ba74ba809a85d,0xa211a454a58aa6a6,0x20eb1c5d94c59eb9
.quad 0x254a23bf20b91a5a,0x28ad285027b22692,0x28fd28c4286427c2,0x285728bb28f9290f,0x27d3287628d72909,0x1bef21e024c5266b,0x14c520eb24812658,0xa77fa5dea3ee9f82,0xa76ea59fa3019cc2,0xa8f6a90ea8dfa86a,0xa908a901a8a8a801,0xa454a67fa81fa8bb,0xa5c9a7d3a8a3a903,0x24c5205698c4a2a1,0x20eb97f2a2d1a607,0x29012893277f2534
.quad 0x0,0x0,0x284a283c282e281f,0x287c287028642857,0x288d28a328b628c8,0x28272843285d2876,0x1c5d1eb9208821af,0x9d27998f8e5c17f2,0xa7f2a76ea6dea644,0xa8bfa898a86aa835,0xa8c4a8e8a901a90e,0xa77fa810a857a893,0xa056a2a1a46ba575,0x211c1d8c125c9bef,0x273a263025082390,0x28ee28bb28702810
.quad 0x28eb290b290b28eb,0x269227b2285028ad,0x227124dc265827a1,0xa390a02594c51df0,0xa66ba4c5a1e09bef,0xa909a8d7a876a7d3,0xa905a90aa8d4a864,0xa58aa73aa84aa8c4,0xa43da644a7f2a898,0x24f2217e165b9fe6,0x258a2271198f9f82,0x290f28ee287c277f,0x290f28e5285d2703,0x246b26b9284328d7,0x2534277f28932901,0xa607a2d197f220eb
.quad 0x0,0x0,0x28a8289e28932888,0x28cc28c428bb28b1,0x274b279027d32809,0x261c266b26b92703,0xa331a211a0eb9f82,0xa5b4a534a4afa425,0xa90ea906a8f6a8df,0xa8dfa8f6a906a90e,0xa454a534a607a6cc,0x97f29df0a0eba2d1,0x26b925c924c52360,0x28b6287628272790,0x28cc28f9290e290a,0x267f277f282e2888
.quad 0x1a5a20b923bf254a,0xa54aa3bfa0b99a5a,0xa87ca801a6cca55f,0xa8eea90ea905a8d4,0xa7d3a876a8d7a909,0x9befa1e0a4c5a66b,0x21af198f9df0a331,0x289e281026a624dc,0x290628bf283526de,0x26de283528bf2906,0x25082716285728db,0xa4dca0eb0e5c214d,0xa61ca3609bef1f1e,0xa8fba909a8b6a809,0xa8e8a90ea8c4a810,0x9df0a454a6cca857
.quad 0x0,0x0,0x28e828e228db28d4,0x28fd28f928f428ee,0x24c5251e257525c9,0x22a12360240e246b,0xa77fa716a6a6a630,0xa870a84aa81fa7e3,0xa835a86aa898a8bf,0xa644a6dea76ea7f2,0x22d120eb1df017f2,0x26cc260725342454,0x2909290f290328e5,0x2843288d28c828f1,0x1df021af2425255f,0xa3eea14d9d270e5c
.quad 0xa8ada850a7b2a692,0xa8eba90ba90ba8eb,0xa607a75da83ca8a8,0x198f9c5da1afa481,0x266b24c521e01bef,0x290928d7287627d3,0x289328ee290f28f4,0x214d24af267f2801,0x9fe6165b217e24f2,0xa898a7f2a644a43d,0xa90ea8d4a84aa6f1,0xa5b4a7a1a888a8f4,0xa1e0a575a790a88d,0x274b251e211c925c,0x285726cc24541df0,0x281028c4290e28e8
.quad 0x0,0x0,0x290a290829052901,0x290f290f290e290c,0x1f1e2056211c21e0,0x125c18c41bef1d8c,0xa8e2a8cca8b1a893,0xa90fa90aa901a8f4,0xa301a43da4f2a59f,0x965b9cc29fe6a17e,0x289328572810277f,0x290e290128e828c4,0x251e261c270327d3,0x18c41f1e21e0240e,0xa81fa75da658a534,0xa90ca8f4a8c4a87c
.quad 0xa692a7b2a850a8ad,0x9a5aa0b9a3bfa54a,0x271625b4242520eb,0x290a28e22893281f,0x27d3287628d72909,0x1bef21e024c5266b,0xa5b4a3909eb917f2,0xa908a8cca857a75d,0xa86aa8dfa90ea8f6,0x9cc2a301a59fa76e,0x24251eb99b25a2d1,0x290528b128102658,0x28c8290d28f12876,0x1d8c240e266b2827,0xa0eb17f222d12607,0xa901a893a77fa534
.quad 0x0,0x0,0x290c290e290f290f,0x290129052908290a,0x9d8c9bef98c4925c,0xa1e0a11ca0569f1e,0xa8f4a901a90aa90f,0xa893a8b1a8cca8e2,0x217e1fe61cc2165b,0x259f24f2243d2301,0x28c428e82901290e,0x277f281028572893,0xa40ea1e09f1e98c4,0xa7d3a703a61ca51e,0xa87ca8c4a8f4a90c,0xa534a658a75da81f
.quad 0x254a23bf20b91a5a,0x28ad285027b22692,0x281f289328e2290a,0x20eb242525b42716,0xa66ba4c5a1e09bef,0xa909a8d7a876a7d3,0xa75da857a8cca908,0x17f29eb9a390a5b4,0x276e259f23011cc2,0x28f6290e28df286a,0x2658281028b12905,0xa2d19b251eb92425,0xa827a66ba40e9d8c,0xa876a8f1a90da8c8,0xa534a77fa893a901,0x260722d117f2a0eb
.quad 0x0,0x0,0x28ee28f428f928fd,0x28d428db28e228e8,0xa46ba40ea360a2a1,0xa5c9a575a51ea4c5,0xa7e3a81fa84aa870,0xa630a6a6a716a77f,0x27f2276e26de2644,0x28bf2898286a2835,0x24542534260726cc,0x17f21df020eb22d1,0xa8f1a8c8a88da843,0xa8e5a903a90fa909,0xe5c9d27a14da3ee,0x255f242521af1df0
.quad 0x28eb290b290b28eb,0x269227b2285028ad,0xa481a1af9c5d198f,0xa8a8a83ca75da607,0xa7d3a876a8d7a909,0x9befa1e0a4c5a66b,0x2801267f24af214d,0x28f4290f28ee2893,0x243d264427f22898,0xa4f2a17e965b1fe6,0xa8f4a888a7a1a5b4,0xa6f1a84aa8d4a90e,0x125ca11ca51ea74b,0x288d2790257521e0,0x28e8290e28c42810,0x1df0245426cc2857
.quad 0x0,0x0,0x28b128bb28c428cc,0x28882893289e28a8,0xa703a6b9a66ba61c,0xa809a7d3a790a74b,0xa425a4afa534a5b4,0x9f82a0eba211a331,0x290e290628f628df,0x28df28f62906290e,0xa2d1a0eb9df097f2,0xa6cca607a534a454,0xa790a827a876a8b6,0xa360a4c5a5c9a6b9,0x2888282e277f267f,0x290a290e28f928cc
.quad 0x1a5a20b923bf254a,0xa54aa3bfa0b99a5a,0xa8d4a905a90ea8ee,0xa55fa6cca801a87c,0x266b24c521e01bef,0x290928d7287627d3,0x24dc26a62810289e,0xa3319df0198f21af,0xa906a8bfa835a6de,0xa6dea835a8bfa906,0x214d0e5ca0eba4dc,0x28db285727162508,0x280928b6290928fb,0x9f1e1bef2360261c,0xa857a6cca4549df0,0xa810a8c4a90ea8e8
.quad 0x0,0x0,0x285728642870287c,0x281f282e283c284a,0xa876a85da843a827,0xa8c8a8b6a8a3a88d,0x17f28e5c998f9d27,0x21af20881eb91c5d,0x2835286a289828bf,0x264426de276e27f2,0xa893a857a810a77f,0xa90ea901a8e8a8c4,0x1bef925c9d8ca11c,0x2575246b22a12056,0x2810287028bb28ee,0x239025082630273a
.quad 0xa8ada850a7b2a692,0xa8eba90ba90ba8eb,0x1df094c5a025a390,0x27a1265824dc2271,0x27d3287628d72909,0x1bef21e024c5266b,0xa8c4a84aa73aa58a,0xa864a8d4a90aa905,0x1fe6965ba17ea4f2,0x289827f22644243d,0x277f287c28ee290f,0x9f82198f2271258a,0xa8d7a843a6b9a46b,0xa703a85da8e5a90f,0x20eb97f2a2d1a607,0x29012893277f2534
.quad 0x0,0x0,0x27c227e328012810,0x273a275d277f27a1,0xa8fba8f1a8e5a8d7,0xa90fa90da909a903,0x2508248123ee22d1,0x26f1267f2607258a,0x2301243d24f2259f,0x165b1cc21fe6217e,0xa8c4a8e8a901a90e,0xa77fa810a857a893,0x285d2809274b266b,0x290d28fb28d728a3,0x9eb994c51c5d20eb,0xa6a6a58aa454a211
.quad 0xa692a7b2a850a8ad,0x9a5aa0b9a3bfa54a,0x290f28f928bb2857,0x27c2286428c428fd,0xa66ba4c5a1e09bef,0xa909a8d7a876a7d3,0x9f82a3eea5dea77f,0x2658248120eb14c5,0x286a28df290e28f6,0x1cc22301259f276e,0xa8bba81fa67fa454,0xa801a8a8a901a908,0x22a118c4a056a4c5,0x290328a327d325c9,0x2534277f28932901,0xa607a2d197f220eb
.quad 0x0,0x0,0x26a626cc26f12716,0x260726302658267f,0xa903a909a90da90f,0xa8d7a8e5a8f1a8fb,0x283c281027c2275d,0x28c428a828882864,0xa17e9fe69cc2965b,0xa59fa4f2a43da301,0xa454a534a607a6cc,0x97f29df0a0eba2d1,0x28a328d728fb290d,0x266b274b2809285d,0xa8d4a893a83ca7a1,0xa8e8a908a90fa8fd
.quad 0x254a23bf20b91a5a,0x28ad285027b22692,0x1eb922d12508267f,0xa534a3319f828e5c,0xa7d3a876a8d7a909,0x9befa1e0a4c5a66b,0x290f28e8288827e3,0x26cc281f28a828f9,0xa76ea59fa3019cc2,0xa8f6a90ea8dfa86a,0x1c5d9df0a3eea630,0x289327c225de2331,0x25c927d328a32903,0xa4c5a05618c422a1,0xa8e8a90ea8c4a810,0x9df0a454a6cca857
.quad 0x0,0x0,0x255f258a25b425de,0x24af24dc25082534,0xa88da8a3a8b6a8c8,0xa827a843a85da876,0x290828fd28ee28db,0x2905290c290f290e,0xa7f2a76ea6dea644,0xa8bfa898a86aa835,0x22d120eb1df017f2,0x26cc260725342454,0x205622a1246b2575,0xa11c9d8c925c1bef,0xa716a801a864a8b1,0xa088a331a4dca607
.quad 0x28eb290b290b28eb,0x269227b2285028ad,0xa8cca870a7e3a6a6,0xa8b1a8f4a90fa901,0x266b24c521e01bef,0x290928d7287627d3,0x9d271b2522112508,0xa83ca716a55fa2d1,0xa43da644a7f2a898,0x24f2217e165b9fe6,0x283c28cc290c28f9,0x94c5208824af26cc,0xa90fa8e5a85da703,0xa46ba6b9a843a8d7,0x285726cc24541df0,0x281028c4290e28e8
.quad 0x0,0x0,0x23ee242524542481,0x227122d123312390,0xa74ba790a7d3a809,0xa61ca66ba6b9a703,0x28bb28d428e828f9,0x282e2857287c289e,0xa90ea906a8f6a8df,0xa8dfa8f6a906a90e,0x289328572810277f,0x290e290128e828c4,0xa6b9a5c9a4c5a360,0xa8b6a876a827a790,0x22711f8217f29b25,0x27c226cc25b42481
.quad 0x1a5a20b923bf254a,0xa54aa3bfa0b99a5a,0xa4afa630a77fa84a,0x208817f29d27a211,0x27d3287628d72909,0x1bef21e024c5266b,0xa8dba90ca901a8bb,0xa425a607a7a1a870,0x290628bf283526de,0x26de283528bf2906,0xa864a73aa534a1af,0xa870a8e8a90fa8e2,0x261c23601bef9f1e,0x28fb290928b62809,0xa0eb17f222d12607,0xa901a893a77fa534
.quad 0x0,0x0,0x20eb214d21af2211,0x1eb91f8220252088,0xa4c5a51ea575a5c9,0xa2a1a360a40ea46b,0x26cc273a27a12801,0x24dc255f25de2658,0xa835a86aa898a8bf,0xa644a6dea76ea7f2,0x28c428e82901290e,0x277f281028572893,0xa909a90fa903a8e5,0xa843a88da8c8a8f1,0x290128db289e284a,0x28a828e22905290f
.quad 0xa8ada850a7b2a692,0xa8eba90ba90ba8eb,0x281026f1258a23ee,0x290c290828db2888,0xa66ba4c5a1e09bef,0xa909a8d7a876a7d3,0x245420880e5ca025,0x28e2287c27c22630,0x9fe6165b217e24f2,0xa898a7f2a644a43d,0x97f2a211a55fa75d,0x282e26a624812025,0x21e025752790288d,0xa74ba51ea11c125c,0xa534a77fa893a901,0x260722d117f2a0eb
.quad 0x0,0x0,0x1b251c5d1d271df0,0xe5c14c517f2198f,0x9f1ea056a11ca1e0,0x925c98c49bef9d8c,0x214d227123902454,0x14c51b251df02025,0xa301a43da4f2a59f,0x965b9cc29fe6a17e,0x24542534260726cc,0x17f21df020eb22d1,0xa51ea61ca703a7d3,0x98c49f1ea1e0a40e,0x25de26f127e32857,0x198f202522d124af
.quad 0xa692a7b2a850a8ad,0x9a5aa0b9a3bfa54a,0x273a282e289e28e8,0x1b25214d245425de,0xa7d3a876a8d7a909,0x9befa1e0a4c5a66b,0x282e28b128fd290e,0x1c5d2271253426f1,0xa86aa8dfa90ea8f6,0x9cc2a301a59fa76e,0x289e28fd290a28c4,0x1d272390260727e3,0xa8c8a90da8f1a876,0x9d8ca40ea66ba827,0x28e8290e28c42810,0x1df0245426cc2857
.quad 0x25f3281828d0290f,0xa5f3a24100002241,0x257527f228c8290f,0xa703a43d9bef20b9,0x24f227b228bf290f,0xa7f2a54a9fe61e55,0x246b276e28b6290f,0xa85da644a1e01a5a,0x23bf272828ad290f,0xa8ada728a3bf0000,0x22a126de28a3290f,0xa8e5a7f2a4c59a5a,0x217e26922898290f,0xa906a850a59f9e55,0x20562644288d290f,0xa90fa898a66ba0b9
.quad 0x1e5525f32882290f,0xa8ffa8d0a728a241,0x1bef259f2876290f,0xa8d7a8f6a7d3a3bf,0x165b254a286a290f,0xa898a90ba835a498,0x925c24f2285d290f,0xa843a90ea876a54a,0x9a5a24982850290f,0xa7b2a8ffa8ada5f3,0x9d8c243d2843290f,0xa6b9a8dfa8d7a692,0x9fe623bf2835290f,0xa59fa8ada8f6a728,0xa11c23012827290f,0xa46ba86aa909a7b2
.quad 0xa8d0a90fa8d0a818,0x8000a241a5f3a818,0xa85da8f6a903a882,0x21e0965ba360a692,0xa76ea8ada90ea8d0,0x259f20b99cc2a498,0xa5c9a835a8f1a8ff,0x27d324f21d8ca0b9,0xa3bfa728a8ada90f,0x28ad272823bf8000,0x9f1ea59fa843a8ff,0x2909286a261c20b9,0x165ba3bfa76ea8d0,0x28f628eb27f22498,0x211c9fe6a61ca882,0x2876290e28a32692
.quad 0x24988000a498a818,0x272828d028ff2818,0x266b1fe6a1e0a728,0x24c52835290928ad,0x27f223bf9cc2a5f3,0x1fe6269228bf28ff,0x288d259f18c4a498,0x9bef243d2827290b,0x28eb272820b9a241,0xa3bf1e55269228d0,0x290f2835240e9e55,0xa66b9cc2246b2850,0x28f628ad259f8000,0xa835a3bf1fe62728,0x28a328f627031e55,0xa8d7a64498c4254a
.quad 0x28d0281825f32241,0x25f3281828d0290f,0x290d28df282725f3,0x1f1e24f2279028ad,0x2898290b28df2818,0xa17e1a5a243d2728,0x27032898290d28d0,0xa6b9a301125c23bf,0x23bf272828ad290f,0xa8ada728a3bf0000,0x125c243d279028d0,0xa90da8bfa74ba3bf,0xa3011a5a24f22818,0xa86aa90ba8bfa728,0xa6b9a17e1f1e25f3,0xa5c9a86aa90da8ad
.quad 0xa882a5f39e552241,0x9e55a5f3a882a90f,0xa909a835a4c50000,0x21e09fe6a66ba8ad,0xa8dfa8eba76ea241,0x26de20b9a17ea728,0xa809a906a8a3a5f3,0x28b626441d8ca3bf,0xa54aa882a90ba818,0x290b2882254a8000,0x9f1ea6dea8e5a8d0,0x285d290e282723bf,0x1fe6a3bfa835a90f,0x259f28ad28f62728,0x2575965ba61ca8d0,0x1d8c26de28f128ad
.quad 0xa5f3a24100002241,0xa8d0a90fa8d0a818,0xa8a3a76ea4c59e55,0xa61ca835a8e5a90b,0xa906a8eba835a5f3,0x965ba3bfa6dea882,0xa809a8dfa909a882,0x25751fe69f1ea54a,0xa3bfa728a8ada90f,0x28ad272823bf8000,0x1d8ca17ea66ba882,0x28f128f62827254a,0x264420b99fe6a5f3,0x26de28ad290e2882,0x28b626de21e09e55,0x1d8c259f285d290b
.quad 0x28ff28d027282241,0xa498000024982818,0x27d328f628d72728,0xa876a59f9bef23bf,0x230127b228f628d0,0xa906a8ada6449e55,0x9f1e230127d328ff,0xa790a8f6a8c8a692,0xa6929e5523bf2818,0xa0b9a728a8eba8d0,0xa8c8a6449bef2498,0x23609fe6a703a8eb,0xa8f6a8ada59f0000,0x283523bf9fe6a728,0xa790a906a876a498,0x290f28352360a0b9
.quad 0x8000a241a5f3a818,0x28d0281825f32241,0x266b2301125ca241,0x288d290628f12850,0x28f6285026442241,0x23012692286a28ff,0x2876290628e52818,0xa40e965b22a12692,0x23bf272828ad290f,0xa8ada728a3bf0000,0xa1e01cc2251e2818,0xa8b6a90ea88da692,0xa835a54a9cc22241,0xa43da7b2a8dfa8ff,0xa909a8bfa703a241,0x22a19cc2a575a850
.quad 0xa728a8d0a8ffa818,0x288225f31e55a241,0x9befa59fa876a90f,0x28d728f627d323bf,0x259f1a5aa43da818,0x24f22850290e2882,0x28d726de2056a241,0xa11c217e274b28eb,0x28ad28ff27b22241,0xa850a4981a5a25f3,0x24c5286a290d2818,0xa8f1a8bfa61c9a5a,0x9fe623bf2835290f,0xa59fa8ada8f6a728,0xa7d3a17e22a12818,0x1f1ea43da85da90b
.quad 0x25f3281828d0290f,0xa5f3a24100002241,0xa0561cc2246b2728,0xa90fa8bfa7d3a54a,0xa86aa692a3010000,0xa644a850a8f6a8ff,0xa8c8a90ea8a3a728,0x211c9cc2a4c5a7b2,0xa3bfa728a8ada90f,0x28ad272823bf8000,0x246b165ba360a728,0x285d290628d727b2,0x28df27b2243d8000,0x1cc2254a283528ff,0x2843290628c82728,0xa74ba3011bef254a
.quad 0x1e5525f32882290f,0xa8ffa8d0a728a241,0xa66b9fe621e02728,0xa4c5a835a909a8ad,0xa90ea850a4f20000,0x243d9a5aa59fa882,0xa703a8dfa8e5a728,0x28f1276e21e0a0b9,0x1a5aa498a850a90f,0x27b228ff28ad25f3,0x28092301a056a728,0x98c424f22876290b,0x28f628ad259f8000,0xa835a3bf1fe62728,0x251e289828fb2728,0xa8c8a8dfa66b9a5a
.quad 0xa8d0a90fa8d0a818,0x8000a241a5f3a818,0xa11ca59fa809a8d0,0x287626de240e1a5a,0x26de23bf165ba241,0x283528eb29062882,0x28fb28f6284325f3,0x9bef217e261c2850,0x23bf272828ad290f,0xa8ada728a3bf0000,0xa5c99fe6205625f3,0xa7d3a8dfa903a850,0xa90ea8ada6dea241,0x1fe6a0b9a644a882,0xa51ea835a903a8d0,0x28d7276e23609a5a
.quad 0x24988000a498a818,0x272828d028ff2818,0x2909283524c58000,0xa1e01fe6266b28ad,0x264428ad29062818,0xa8f6a7b2a3011e55,0xa2a11fe626b928d0,0xa66ba8bfa8fba7b2,0xa8eba728a0b92241,0x23bf9e55a692a8d0,0xa74ba8f6a8b6a5f3,0x290927f222a1a0b9,0x1fe6a3bfa835a90f,0x259f28ad28f62728,0x28b6259f925ca5f3,0xa4c51cc226b928eb
.quad 0x28d0281825f32241,0x25f3281828d0290f,0x26b9286a28fb28ff,0xa5c9a17e18c423bf,0xa43d9a5a217e25f3,0xa8dfa90ba898a728,0xa90fa8bfa790a498,0x98c4a43da74ba8ad,0xa3bfa728a8ada90f,0x28ad272823bf8000,0x2703230198c4a498,0x26b92898290f28ad,0x28bf290b286a25f3,0xa4f29a5a23012728,0x18c424f2282728ff,0xa8fba8dfa790a3bf
.quad 0xa882a5f39e552241,0x9e55a5f3a882a90f,0xa7d3a8f6a8d7a728,0x2876259f1befa3bf,0x217ea0b9a6dea8d0,0x276e28eb28df2728,0x290327f223609e55,0xa40e1cc2261c28ad,0x254a2882290b2818,0xa90ba882a54a0000,0xa5c9965b251e2882,0xa11ca76ea8fba8ad,0xa8f6a8ada59f0000,0x283523bf9fe6a728,0xa056a76ea903a882,0x2809290e284323bf
.quad 0xa5f3a24100002241,0xa8d0a90fa8d0a818,0xa8b6a90ea8d7a818,0x1d8c9fe6a51ea7b2,0x1cc2a0b9a59fa818,0x290e28ad276e2498,0x2903286a266b2241,0x2056259f282728eb,0x23bf272828ad290f,0xa8ada728a3bf0000,0xa809a4f29bef2241,0xa575a835a8fba8eb,0xa7f2a8eba8f6a818,0x276e23bf965ba498,0x240e965ba4c5a818,0x280928f628e527b2
.quad 0x28ff28d027282241,0xa498000024982818,0x1bef259f2876290f,0xa8d7a8f6a7d3a3bf,0xa8bfa6929fe62241,0x1cc2a3bfa7f2a8ff,0xa5c9a898a909a818,0x290d2835246b9a5a,0x26921e55a3bfa818,0x20b9272828eb28d0,0x288d290627d32241,0xa8a3a59f925c254a,0x9fe623bf2835290f,0xa59fa8ada8f6a728,0xa90da7f2a1e02241,0x274b1fe6a40ea850
.quad 0x8000a241a5f3a818,0x28d0281825f32241,0x29092898274b2498,0x22a12644284328eb,0x1fe6254a27f228d0,0xa8bfa7b2a4f29e55,0xa8d7a7f2a51e9e55,0xa360a6dea88da90b,0xa3bfa728a8ada90f,0x28ad272823bf8000,0x28762644211c9e55,0x240e276e28c8290b,0x259f2850290628d0,0xa898a692a17e1e55,0xa7d3a43d125c2498,0xa46ba7f2a8f1a8eb
.quad 0xa728a8d0a8ffa818,0x288225f31e55a241,0x266b1fe6a1e0a728,0x24c52835290928ad,0x2835290b289825f3,0xa86aa54a965b2498,0xa4c5165b25752882,0xa51ea86aa90fa850,0xa8ada8ffa7b2a241,0x285024989a5aa5f3,0x21e0a17ea790a8ff,0x25752898290327b2,0x28f628ad259f8000,0xa835a3bf1fe62728,0x9bef24f2288d28ff,0xa5c9a8bfa8e5a692
.quad 0x25f3281828d0290f,0xa5f3a24100002241,0xa843a644a2a10000,0xa74ba898a909a8eb,0xa4f2a7b2a8bfa90f,0x27f2254a1fe69e55,0x288d26de23608000,0x251e27f228d7290b,0x23bf272828ad290f,0xa8ada728a3bf0000,0xa8c8a76ea40e0000,0xa11ca644a876a90b,0xa17ea692a898a90f,0x29062850259f1e55,0x28f127f2246b8000,0x925c243d27d328eb
.quad 0x1e5525f32882290f,0xa8ffa8d0a728a241,0xa909a835a4c50000,0x21e09fe6a66ba8ad,0x965ba54aa86aa90f,0x2898290b28352498,0x290f286a251e8000,0xa575965b24c52850,0x9a5a24982850290f,0xa7b2a8ffa8ada5f3,0xa903a898a5750000,0x2790217ea1e0a7b2,0x1fe6a3bfa835a90f,0x259f28ad28f62728,0x28e528bf25c98000,0xa88da4f21bef2692
.quad 0xa8d0a90fa8d0a818,0x8000a241a5f3a818,0x251e1fe69d8ca498,0x28d7290e28b627b2,0x276e28ad290e28d0,0xa59fa0b91cc22498,0xa827a59fa0561e55,0xa66ba86aa903a8eb,0xa3bfa728a8ada90f,0x28ad272823bf8000,0x28fb283525751e55,0x1bef24f2280928eb,0x965b23bf276e28d0,0xa8f6a8eba7f2a498,0xa8e5a8f6a809a498,0x24c5165ba40ea7b2
.quad 0x24988000a498a818,0x272828d028ff2818,0x27d328f628d72728,0xa876a59f9bef23bf,0xa7f2a3bf1cc225f3,0x9fe6a692a8bfa8ff,0xa46ba835a90da882,0x2909289825c91a5a,0x28eb272820b9a241,0xa3bf1e55269228d0,0x125c259f28a328ff,0xa7d3a906a88da54a,0xa8f6a8ada59f0000,0x283523bf9fe6a728,0x240e9fe6a74ba8ff,0x21e027f2290d2850
.quad 0x28d0281825f32241,0x25f3281828d0290f,0x98c4217e25c92818,0xa8fba86aa6b9a3bf,0xa898a90ba8dfa818,0x217e9a5aa43da728,0x274b243d18c4a241,0x279028bf290f28ad,0x23bf272828ad290f,0xa8ada728a3bf0000,0xa90fa898a6b9a241,0x18c4a301a703a8ad,0x23019a5aa4f2a818,0x286a290b28bf2728,0x279028df28fb2818,0xa827a4f298c423bf
.quad 0xa882a5f39e552241,0x9e55a5f3a882a90f,0x9befa59fa876a90f,0x28d728f627d323bf,0x28df28eb276e2241,0xa6dea0b9217e2728,0xa61c9cc2240e2818,0xa360a7f2a903a8ad,0xa54aa882a90ba818,0x290b2882254a8000,0x28fb276e211ca241,0xa51e165b25c928ad,0x9fe623bf2835290f,0xa59fa8ada8f6a728,0xa843a90ea809a241,0x2903276e2056a3bf
.quad 0xa5f3a24100002241,0xa8d0a90fa8d0a818,0xa40ea6dea876a8ff,0x2809259f211c9a5a,0x290628eb283525f3,0x165b23bf26de2882,0xa61ca17e1bef2498,0xa843a8f6a8fba850,0xa3bfa728a8ada90f,0x28ad272823bf8000,0x290328df27d32498,0xa0561fe625c92850,0xa644a0b91fe625f3,0xa6dea8ada90ea882,0xa360a76ea8d7a8ff,0x29032835251e1a5a
.quad 0x28ff28d027282241,0xa498000024982818,0xa66b9fe621e02728,0xa4c5a835a909a8ad,0xa301a7b2a8f6a8d0,0x290628ad26441e55,0x28fb28bf266b1e55,0xa6b99fe622a127b2,0xa6929e5523bf2818,0xa0b9a728a8eba8d0,0xa2a1a7f2a909a882,0x28b628f6274b20b9,0x28f628ad259f8000,0xa835a3bf1fe62728,0xa6b99cc224c52882,0x125ca59fa8b6a8eb
.quad 0x8000a241a5f3a818,0x28d0281825f32241,0x27d328bf290f28d0,0xa46b9cc22056254a,0xa8f6a850a644a241,0xa301a692a86aa8ff,0x24c51cc2a11ca5f3,0x28a3290e28c827b2,0x23bf272828ad290f,0xa8ada728a3bf0000,0xa8d7a906a85da5f3,0x2360965ba46ba7b2,0x2835254a1cc2a241,0x243d27b228df28ff,0x9bef2301274b28d0,0xa8c8a906a843a54a
.quad 0xa728a8d0a8ffa818,0x288225f31e55a241,0x2909283524c58000,0xa1e01fe6266b28ad,0xa59f9a5a243d2818,0xa4f2a850a90ea882,0xa1e0a76ea8f1a8d0,0x28e528df270320b9,0x28ad28ff27b22241,0xa850a4981a5a25f3,0xa876a4f218c425f3,0x2056a301a809a90b,0x1fe6a3bfa835a90f,0x259f28ad28f62728,0x266b28df28c825f3,0xa8fba898a51e1a5a
.quad 0x25f3281828d0290f,0xa5f3a24100002241,0xa8f1a906a88da728,0x925ca301a66ba850,0x286a269223018000,0x2644285028f628ff,0xa2a1165b240e2728,0xa8e5a906a876a692,0xa3bfa728a8ada90f,0x28ad272823bf8000,0x288d290e28b62728,0xa51e9cc221e02692,0xa8dfa7b2a43d0000,0x9cc2a54aa835a8ff,0x25751cc2a2a1a728,0x270328bf29092850
.quad 0x1e5525f32882290f,0xa8ffa8d0a728a241,0xa7d3a8f6a8d7a728,0x2876259f1befa3bf,0x290e285024f28000,0xa43d1a5a259f2882,0xa74ba17e211c2728,0xa056a6dea8d7a8eb,0x1a5aa498a850a90f,0x27b228ff28ad25f3,0x261c28bf28f12728,0xa90da86aa4c51a5a,0xa8f6a8ada59f0000,0x283523bf9fe6a728,0x285d243d9f1ea728,0xa2a1217e27d3290b
.quad 0xa8d0a90fa8d0a818,0x8000a241a5f3a818,0x28e52835261c2241,0x24c5276e28a3290b,0xa6dea3bf965b2241,0xa835a8eba906a882,0x1f1e9fe6a575a818,0x290928df2809254a,0x23bf272828ad290f,0xa8ada728a3bf0000,0xa827a8f6a8f1a818,0x266b217e9d8ca54a,0x290e28ad26de2241,0x9fe620b926442882,0xa85da59f9d8c2241,0xa1e0a6dea8b6a90b
.quad 0x24988000a498a818,0x272828d028ff2818,0x1bef259f2876290f,0xa8d7a8f6a7d3a3bf,0xa644a8ada906a818,0x28f627b223019e55,0x28c828f627902241,0xa7d3a3011f1e2692,0xa8eba728a0b92241,0x23bf9e55a692a8d0,0x27031fe6a360a818,0x1bef264428c828eb,0x9fe623bf2835290f,0xa59fa8ada8f6a728,0xa360a835a90fa818,0x28762906279020b9
.quad 0x28d0281825f32241,0x25f3281828d0290f,0xa790a4f29f1e1e55,0xa827a8dfa90da8ad,0x243d1a5aa17ea5f3,0x28df290b28982728,0x925c230126b92882,0xa90da898a703a3bf,0xa3bfa728a8ada90f,0x28ad272823bf8000,0x274b28bf290d2882,0xa790a43d925c23bf,0xa8bfa90ba86aa5f3,0x24f21a5aa301a728,0x290d286a25c91e55,0x9f1e217e26b928ad
.quad 0xa882a5f39e552241,0x9e55a5f3a882a90f,0x266b1fe6a1e0a728,0x24c52835290928ad,0xa17e20b926de28d0,0xa76ea8eba8dfa728,0x9d8ca644a8b6a8ff,0x28a32906280923bf,0x254a2882290b2818,0xa90ba882a54a0000,0xa827a90ea85da498,0x28e526de1f1ea3bf,0x28f628ad259f8000,0xa835a3bf1fe62728,0xa8f1a6de9d8c2498,0x261c165ba575a8ad
.quad 0xa5f3a24100002241,0xa8d0a90fa8d0a818,0x2360165ba1e0a5f3,0x290328f6285d2692,0x9cc220b9259f2818,0xa90ea8ada76ea498,0x9d8ca4f2a7d3a8d0,0x28f1283525c920b9,0x23bf272828ad290f,0xa8ada728a3bf0000,0xa61ca86aa909a8d0,0x2843259f1f1ea0b9,0x27f228eb28f62818,0xa76ea3bf165b2498,0xa8a3a90ea876a5f3,0x261c1fe6a11ca692
.quad 0x28ff28d027282241,0xa498000024982818,0xa909a835a4c50000,0x21e09fe6a66ba8ad,0x28bf26921fe6a241,0x9cc223bf27f228ff,0xa827a43d1bef25f3,0x98c4a59fa88da90b,0x26921e55a3bfa818,0x20b9272828eb28d0,0xa46b1cc2266b28d0,0xa40ea835a90fa850,0x1fe6a3bfa835a90f,0x259f28ad28f62728,0x18c4264428d728d0,0xa703a8f6a8a3a54a
.quad 0x8000a241a5f3a818,0x28d0281825f32241,0x1bef243d27032882,0xa8c8a7f2a575a0b9,0x9fe6a54aa7f2a8d0,0x28bf27b224f21e55,0x21e02644285d28ff,0xa8b6a76ea46b9a5a,0xa3bfa728a8ada90f,0x28ad272823bf8000,0x24c527f228e528ff,0xa8a3a6dea2a11a5a,0xa59fa850a906a8d0,0x28982692217e9e55,0x266b2898290f2882,0xa88da644a05620b9
.quad 0xa728a8d0a8ffa818,0x288225f31e55a241,0x27d328f628d72728,0xa876a59f9bef23bf,0xa835a90ba898a5f3,0x286a254a165ba498,0x2876290e28432498,0xa85da4f2125c254a,0xa8ada8ffa7b2a241,0x285024989a5aa5f3,0x28d728df26b91e55,0xa843a43d1d8c2692,0xa8f6a8ada59f0000,0x283523bf9fe6a728,0x2909286a246b9e55,0xa827a301211c27b2
.quad 0x290f,0x0,0xa90f,0x0,0x290f,0x0,0xa90f,0x0,0x290f,0x0,0xa90f,0x0,0x290f,0x0,0xa90f,0x0
.quad 0x290f,0x0,0xa90f,0x0,0x290f,0x0,0xa90f,0x0,0x290f,0x0,0xa90f,0x0,0x290f,0x0,0xa90f
.zero 776
.quad 0x24982728288228ff,0xa728a4989e551e55,0x23ee26cc287028fd,0xa810a5b4a14d198f,0x22a1266b285d28fb,0xa876a6b9a360925c,0x214d2607284a28f9,0xa8c4a7a1a4af9c5d,0x1fe6259f283528f6,0xa8f6a835a59f9fe6,0x1d272534281f28f4,0xa90ea888a67fa1af,0x18c424c5280928f1,0xa909a8c8a74ba360,0x8e5c245427e328ee,0xa8e8a8f4a801a481
.quad 0x9a5a23bf27b228eb,0xa8ada90ba850a54a,0x9df022d1277f28e8,0xa857a90ea893a607,0xa05621e0274b28e5,0xa7d3a8fba8c8a6b9,0xa1af20eb271628e2,0xa6cca8d4a8eea75d,0xa3011fe626de28df,0xa59fa898a906a7f2,0xa4251df026a628db,0xa454a84aa90fa83c,0xa4c51bef266b28d7,0xa1e0a7d3a909a876,0xa55f17f2263028d4,0x9df0a6f1a8f4a8a8
.quad 0xa882a8ffa8ffa882,0x1e559e55a498a728,0xa7c2a8bba90fa8d4,0x24811d27a025a534,0xa61ca843a8f1a903,0x2703240e18c4a1e0,0xa425a73aa8a8a90f,0x2870267f227197f2,0x9fe6a59fa835a8f6,0x28f62835259f1fe6,0x14c5a390a73aa8bb,0x290828d427a12454,0x211c9f1ea5c9a85d,0x28a3290f288d266b,0x24af14c5a425a7c2,0x27a128e228f92810
.quad 0x269220b9a0b9a692,0x254a2850290b28ad,0x2810245497f2a534,0x20eb26cc28c42901,0x28a3261c1d8ca360,0x98c4246b28272909,0x28f927a12271a025,0xa3311eb9267f28c4,0x290e286a24f2965b,0xa6449cc2243d2835,0x28e228d4267f1d27,0xa82ea3ee1eb926cc,0x2876290927d321e0,0xa8d7a66b9bef24c5,0x27a1290828702481,0xa90fa82ea33120eb
.quad 0x28ff288227282498,0x24982728288228ff,0x28ee29082893273a,0xe5c22d12658284a,0x282728e52909288d,0xa46b9bef211c25c9,0x258a281f28e82905,0xa801a5349eb92025,0x1fe6259f283528f6,0xa8f6a835a59f9fe6,0x9f82208826072864,0xa8e2a901a84aa5b4,0xa5759d8c21e026b9,0xa790a8d7a903a843,0xa81fa4dc97f223ee,0xa390a77fa8dba8fd
.quad 0xa8eba7b2a3bf1a5a,0x1a5aa3bfa7b2a8eb,0xa901a8c4a6cca0eb,0x253417f2a454a810,0xa85da90fa876a575,0x284324c5925ca51e,0xa630a8b1a901a7e3,0x2908281023ee9d27,0xa17ea76ea8f6a8bf,0x28bf28f6276e217e,0x1c5da481a857a90f,0x26f128e828cc2658,0x24c59befa66ba8d7,0x21e027d329092876,0x27c2214da2d1a81f,0x9eb924542864290a
.quad 0xa728a4989e551e55,0xa882a8ffa8ffa882,0xa8e8a83ca630a271,0xa4afa75da89ea90a,0xa8d7a90da8a3a74b,0x1d8ca056a575a809,0xa6cca888a90aa8db,0x26f123900e5ca331,0x9fe6a59fa835a8f6,0x28f62835259f1fe6,0x22d1998fa4afa7e3,0x289e290f28a826f1,0x27d3246b125ca40e,0x251e282728fb28e5,0x2901282e2508198f,0x9b252331275d28d4
.quad 0x28ad290b2850254a,0xa692a0b920b92692,0x26072893290e2857,0xa8e8a77fa2d11df0,0x1bef25c9288d290d,0xa8b6a903a809a40e,0xa4541b2525de289e,0xa58aa888a90ca82e,0xa835a43d1cc22644,0x165ba4f2a86aa90e,0xa90ea81fa3901f82,0x26301b25a4afa864,0xa876a909a7d3a1e0,0x28d7266b1befa4c5,0xa534a89ea8f9a716,0x28cc28db2658198f
.quad 0x1e559e55a498a728,0x28ff288227282498,0x27a125081f829df0,0x281f28db290e28b1,0x290f28b6279024c5,0x1f1e251e27d328c8,0x27e328d4290c2893,0xa5b4a0881df02508,0x1fe6259f283528f6,0xa8f6a835a59f9fe6,0xa4dc9b25227126cc,0xa83ca8fda8e8a801,0xa8b6a703a2a11bef,0xa056a61ca876a90d,0xa8cca905a83ca534,0x255f1c5da2d1a73a
.quad 0xa54aa850a90ba8ad,0x28eb27b223bf9a5a,0x1df0a2d1a77fa8e8,0x2857290e28932607,0x279022a19f1ea66b,0x211c270328d728f1,0x290f284a24af97f2,0xa5080e5c25342870,0x27f229062898259f,0xa8dfa6de9fe62301,0x2025271628ee28c4,0xa870a90ca810a331,0xa4c51bef266b28d7,0xa1e0a7d3a909a876,0xa8b1a58a14c52607,0x24af9d27a6cca8ee
.quad 0x24982728288228ff,0xa728a4989e551e55,0xa39097f221af25de,0xa901a8f9a864a6a6,0xa8c8a7d3a51e9f1e,0xa4c5a790a8b6a90f,0xa864a901a8eea82e,0x2454198fa211a658,0x9fe6a59fa835a8f6,0x28f62835259f1fe6,0x263020eb9eb9a58a,0x277f28cc290a2870,0x290d2876261c2056,0x9bef22a1270328b6,0x271628c42908284a,0xa857a58a9d272271
.quad 0x9a5a23bf27b228eb,0xa8ada90ba850a54a,0xa810a45417f22534,0xa0eba6cca8c4a901,0xa8f1a8d7a703a11c,0x266b1f1ea2a1a790,0xa4dca857a90fa864,0x290e287c255f14c5,0x23019fe6a6dea8df,0x259f2898290627f2,0x28bb2607198fa4dc,0xa2d12088273a28f4,0x2876290927d321e0,0xa8d7a66b9bef24c5,0x2088277f2905287c,0xa810a90fa83ca390
.quad 0xa882a8ffa8ffa882,0x1e559e55a498a728,0x9b25a425a6f1a87c,0x28cc2801258a20eb,0x2809257520569d8c,0x274b28a3290d28d7,0x28bb290f28b1275d,0xa1af1b252481277f,0x1fe6259f283528f6,0xa8f6a835a59f9fe6,0xa75da3ee0e5c2425,0xa658a87ca90ca8c4,0xa8e5a8fba827a51e,0x240e925ca46ba7d3,0xa211a6f1a8bba90a,0x290c286425b41df0
.quad 0x269220b9a0b9a692,0x254a2850290b28ad,0x290128c426cc20eb,0xa53497f224542810,0x240e2809290328b6,0xa90da88da5c99bef,0xa5b4998f2481283c,0xa425a81fa90aa893,0xa90ea86aa4f2165b,0x26441cc2a43da835,0xa508a87ca90aa801,0x28f928b125de17f2,0x24c59befa66ba8d7,0x21e027d329092876,0x290c27e321afa271,0xa73a9f8224252857
.quad 0x28ff288227282498,0x24982728288228ff,0x255f27e328c4290f,0xa716a4549c5d2088,0xa5c9a11c1bef246b,0xa88da909a8e5a827,0xa8f4a8fda857a630,0x1d27a0eba5dea83c,0x9fe6a59fa835a8f6,0x28f62835259f1fe6,0x282e255f1df0a14d,0x2508281028ee28f9,0x2843290328d72790,0xa6b9a1e01d8c2575,0x9eb921af26cc28b1,0xa8a8a90ea870a5de
.quad 0xa8eba7b2a3bf1a5a,0x1a5aa3bfa7b2a8eb,0xa607a893a90ea857,0x28e8277f22d19df0,0x251e125ca4c5a843,0x25752876290f285d,0x290528a826071c5d,0xa6589df023902801,0x217e276e28f628bf,0xa8bfa8f6a76ea17e,0xa7e3a27120eb275d,0x14c5a534a888a908,0xa876a909a7d3a1e0,0x28d7266b1befa4c5,0x1b25a508a893a8fd,0x25de28c428e2267f
.quad 0xa728a4989e551e55,0xa882a8ffa8ffa882,0xa857a8f4a905a888,0x221194c5a331a67f,0x21e098c4a40ea703,0x290328f12843261c,0x290e28cc27c224dc,0x14c523ee2716289e,0x1fe6259f283528f6,0xa8f6a835a59f9fe6,0xa893a6a6a2111c5d,0xa331a716a8b1a90f,0xa66ba88da90fa8a3,0x285d25c91f1ea11c,0x26071f82a14da6a6,0x267f289e290f287c
.quad 0x28ad290b2850254a,0xa692a0b920b92692,0x9df022d1277f28e8,0xa857a90ea893a607,0xa909a827a46b18c4,0x23609d8ca61ca8a3,0xa2d1a7c2a8fda8bb,0x28f428cc26a61f82,0x2835243d9cc2a644,0x965b24f2286a290e,0x277f28fd28a825b4,0xa905a7c2a211214d,0xa4c51bef266b28d7,0xa1e0a7d3a909a876,0xa8e8a8bba5b40e5c,0x288824dc9c5da6a6
.quad 0x1e559e55a498a728,0x28ff288227282498,0x290c28e2282e2607,0x1eb924dc277f28a8,0x125c236026b92876,0xa8fba85da66ba2a1,0xa908a87ca6a6a2d1,0x9f82a55fa810a8e2,0x9fe6a59fa835a8f6,0x28f62835259f1fe6,0x28db27c2248117f2,0x202525de28572905,0x2360274b28c82909,0xa8f1a809a4c598c4,0xa888a630a02520eb,0xa088a658a893a90f
.quad 0xa54aa850a90ba8ad,0x28eb27b223bf9a5a,0x2810245497f2a534,0x20eb26cc28c42901,0x26b928c828fb27d3,0xa8e5a74ba1e02056,0xa6f1a0882211277f,0xa14da73aa8e8a8db,0xa7f2a906a898a59f,0x28df26de1fe6a301,0x258a0e5ca55fa893,0x21af27a12901289e,0x2876290927d321e0,0xa8d7a66b9bef24c5,0xa3ee2025275d2901,0xa211a801a90ea84a
.quad 0x24982728288228ff,0xa728a4989e551e55,0xa8a8a77fa4dc9eb9,0xa607a82ea8e2a90c,0xa2a1a66ba85da8fb,0x287626b92360125c,0x28e22810255f1f82,0x22d126a6287c2908,0x1fe6259f283528f6,0xa8f6a835a59f9fe6,0xa905a857a5dea025,0x97f2a481a7c2a8db,0x98c4a4c5a809a8f1,0x290928c8274b2360,0x290f289326582088,0xa0eb202526302888
.quad 0x9a5a23bf27b228eb,0xa8ada90ba850a54a,0xa901a8c4a6cca0eb,0x253417f2a454a810,0x2056a1e0a74ba8e5,0x27d328fb28c826b9,0x28db28e8273a214d,0xa77fa211208826f1,0xa3011fe626de28df,0xa59fa898a906a7f2,0xa89ea901a7a1a1af,0x2893255f8e5ca58a,0x24c59befa66ba8d7,0x21e027d329092876,0x284a290e28012211,0xa901a75da02523ee
.quad 0xa882a8ffa8ffa882,0x1e559e55a498a728,0x267f233114c5a211,0x2888290528f42857,0x261c284328f12903,0xa703a40e98c421e0,0xa89ea716a3ee94c5,0xa4dca7c2a8cca90e,0x9fe6a59fa835a8f6,0x28f62835259f1fe6,0x290f28b127162331,0x9c5d221126a62893,0xa11c1f1e25c9285d,0xa8a3a90fa88da66b,0xa87ca90fa89ea67f,0x26a6214d9f82a607
.quad 0x269220b9a0b9a692,0x254a2850290b28ad,0x26072893290e2857,0xa8e8a77fa2d11df0,0xa8a3a61c9d8c2360,0x18c4a46ba827a909,0x9f82a6a6a8cca8f4,0x28bb28fd27c222d1,0x290e286a24f2965b,0xa6449cc2243d2835,0xa14d221127c22905,0xa5b4a8a8a8fda77f,0xa876a909a7d3a1e0,0x28d7266b1befa4c5,0x26a61c5da4dca888,0x8e5c25b428bb28e8
.quad 0x28ff288227282498,0x24982728288228ff,0xa0881c5d24542716,0xa90fa8c4a7e3a55f,0xa827a8e5a909a88d,0x246b1befa11ca5c9,0x283c25de20eb9d27,0x2630285728fd28f4,0x1fe6259f283528f6,0xa8f6a835a59f9fe6,0xa8f9a8eea810a508,0x214d9df0a55fa82e,0x25751d8ca1e0a6b9,0x279028d729032843,0x25de2870290e28a8,0xa8b1a6cca1af1eb9
.quad 0xa8eba7b2a3bf1a5a,0x1a5aa3bfa7b2a8eb,0x1df0a2d1a77fa8e8,0x2857290e28932607,0x285d290f28762575,0xa843a4c5125c251e,0xa801a3901df02658,0x9c5da607a8a8a905,0xa17ea76ea8f6a8bf,0x28bf28f6276e217e,0x29082888253494c5,0xa75da0eb227127e3,0xa4c51bef266b28d7,0xa1e0a7d3a909a876,0xa67fa8e2a8c4a5de,0x28fd289325089b25
.quad 0xa728a4989e551e55,0xa882a8ffa8ffa882,0xa0eba58aa801a8cc,0x287c26f124251b25,0x28d7290d28a3274b,0x9d8c205625752809,0xa77fa4819b2521af,0xa75da8b1a90fa8bb,0x9fe6a59fa835a8f6,0x28f62835259f1fe6,0x28c4290c287c2658,0xa4258e5c23ee275d,0xa7d3a46b925c240e,0xa51ea827a8fba8e5,0x9df0a5b4a864a90c,0x290a28bb26f12211
.quad 0x28ad290b2850254a,0xa692a0b920b92692,0xa810a45417f22534,0xa0eba6cca8c4a901,0x9befa5c9a88da90d,0x28b629032809240e,0x2893290a281f2425,0xa83ca481198f25b4,0xa835a43d1cc22644,0x165ba4f2a86aa90e,0x97f2a5dea8b1a8f9,0x2801290a287c2508,0x2876290927d321e0,0xa8d7a66b9bef24c5,0xa857a4251f82273a,0x2271a1afa7e3a90c
.quad 0x1e559e55a498a728,0x28ff288227282498,0x26a6286428f92901,0xa5dea1af17f22390,0xa90fa8b6a790a4c5,0x9f1ea51ea7d3a8c8,0x26582211998fa454,0x282e28ee29012864,0x1fe6259f283528f6,0xa8f6a835a59f9fe6,0xa870a90aa8cca77f,0x258a1eb9a0eba630,0x28b6270322a19bef,0x2056261c2876290d,0xa2711d27258a2857,0xa84aa908a8c4a716
.quad 0xa54aa850a90ba8ad,0x28eb27b223bf9a5a,0x290128c426cc20eb,0xa53497f224542810,0xa790a2a11f1e266b,0xa11ca703a8d7a8f1,0x94c5a55fa87ca90e,0x2864290f285724dc,0x27f229062898259f,0xa8dfa6de9fe62301,0xa8f4a73aa08822d1,0x24dc998fa607a8bb,0x24c59befa66ba8d7,0x21e027d329092876,0x2390283c290f2810,0xa87ca905a77fa088
.quad 0x24982728288228ff,0xa728a4989e551e55,0xa8b1a90ea8dba81f,0x1df09f82a508a7a1,0x28c827d3251e1f1e,0x24c5279028b6290f,0xa5089df0208825b4,0xa893a90ca8d4a7e3,0x9fe6a59fa835a8f6,0x28f62835259f1fe6,0x280128e828fd283c,0xa6cca2711b2524dc,0xa90da876a61ca056,0x1befa2a1a703a8b6,0x273a22d19c5da55f,0x2534283c290528cc
.quad 0x9a5a23bf27b228eb,0xa8ada90ba850a54a,0xa607a893a90ea857,0x28e8277f22d19df0,0x28f128d72703211c,0xa66b9f1e22a12790,0xa870a5348e5c2508,0x17f2a4afa84aa90f,0x23019fe6a6dea8df,0x259f2898290627f2,0x23312810290c2870,0xa8c4a8eea716a025,0xa876a909a7d3a1e0,0x28d7266b1befa4c5,0x28ee26cc1d27a4af,0xa60794c5258a28b1
.quad 0xa882a8ffa8ffa882,0x1e559e55a498a728,0x290a289e275d24af,0x22712630283c28e8,0xa809a575a0561d8c,0xa74ba8a3a90da8d7,0x23318e5ca390a6f1,0x28db290a288826cc,0x1fe6259f283528f6,0xa8f6a835a59f9fe6,0xa6f1a8a8a90fa89e,0x27e324af198fa2d1,0x28e528fb2827251e,0xa40e125c246b27d3,0xa8d4a75da3311b25,0x998fa508a82ea901
.quad 0x269220b9a0b9a692,0x254a2850290b28ad,0x9df022d1277f28e8,0xa857a90ea893a607,0xa40ea809a903a8b6,0x290d288d25c91bef,0x282e290c2888258a,0xa89ea5de9b252454,0xa90ea86aa4f2165b,0x26441cc2a43da835,0x286424af9b25a630,0x9f822390281f290e,0xa4c51bef266b28d7,0xa1e0a7d3a909a876,0x998fa658a8dba8cc,0x271628f9289e2534
.quad 0x28ff288227282498,0x24982728288228ff,0xa84aa658a2d18e5c,0xa73aa893a908a8ee,0x25c9211c9befa46b,0x288d290928e52827,0xa0251eb925342801,0xa905a8e8a81fa58a,0x9fe6a59fa835a8f6,0x28f62835259f1fe6,0x25b4284a290128e2,0xa864a607a0881f82,0xa843a903a8d7a790,0x26b921e09d8ca575,0x28fd28db277f2390,0xa3ee17f224dc281f
.quad 0xa8eba7b2a3bf1a5a,0x1a5aa3bfa7b2a8eb,0x2810245497f2a534,0x20eb26cc28c42901,0xa51e925c24c52843,0xa575a876a90fa85d,0x1d27a3eea810a908,0x27e3290128b12630,0x217e276e28f628bf,0xa8bfa8f6a76ea17e,0xa658a8cca8e8a6f1,0x290f285724819c5d,0x2876290927d321e0,0xa8d7a66b9bef24c5,0xa90aa864a4541eb9,0x281f22d1a14da7c2
.quad 0xa728a4989e551e55,0xa882a8ffa8ffa882,0x253420259d27a481,0x28d4290f28bb27c2,0xa1e018c4240e2703,0xa903a8f1a843a61c,0x17f2a271a67fa870,0x290f28a8273a2425,0x1fe6259f283528f6,0xa8f6a835a59f9fe6,0xa454a7a1a8d4a908,0x28bb273a239094c5,0x266b288d290f28a3,0xa85da5c99f1e211c,0xa810a8f9a8e2a7a1,0x27c2242594c5a4af
.quad 0x28ad290b2850254a,0xa692a0b920b92692,0xa901a8c4a6cca0eb,0x253417f2a454a810,0x29092827246b98c4,0xa3601d8c261c28a3,0xa8c4a67f9eb92331,0x2025a271a7a1a8f9,0x2835243d9cc2a644,0x965b24f2286a290e,0xa6cc9eb923ee282e,0x9d27a67fa8d4a8e2,0x24c59befa66ba8d7,0x21e027d329092876,0xa0eb2331282e290f,0xa481a870a908a7a1
.quad 0x1e559e55a498a728,0x28ff288227282498,0x998f214d25b42810,0xa8fda870a6cca3ee,0x925ca360a6b9a876,0x28fb285d266b22a1,0x1c5d24af27a128c4,0xa8f9a84aa607a14d,0x9fe6a59fa835a8f6,0x28f62835259f1fe6,0x21af267f2888290e,0xa8f4a81fa5349d27,0xa360a74ba8c8a909,0x28f1280924c518c4,0x2481280128f428e8,0xa8eea7e3a4540e5c
.quad 0xa54aa850a90ba8ad,0x28eb27b223bf9a5a,0x26072893290e2857,0xa8e8a77fa2d11df0,0xa6b9a8c8a8fba7d3,0x28e5274b21e0a056,0x275d28ee28d426cc,0xa8e2a716a0eb21af,0xa7f2a906a898a59f,0x28df26de1fe6a301,0x283c290f284a2454,0xa8dba6a69df02425,0xa876a909a7d3a1e0,0x28d7266b1befa4c5,0x28a828f426f11df0,0xa8d4a63097f2255f
.quad 0x281825f322410000,0x281828d0290f28d0,0x2843264422a10000,0x274b2898290928eb,0x286a269223010000,0x2644285028f628ff,0x288d26de23600000,0x251e27f228d7290b,0x28ad272823bf0000,0x23bf272828ad290f,0x28c8276e240e0000,0x211c26442876290b,0x28df27b2243d0000,0x1cc2254a283528ff,0x28f127f2246b0000,0x925c243d27d328eb
.quad 0x28ff281824980000,0x9e552241272828d0,0x2909283524c50000,0xa1e01fe6266b28ad,0x290e285024f20000,0xa43d1a5a259f2882,0x290f286a251e0000,0xa575965b24c52850,0x290b2882254a0000,0xa6929e5523bf2818,0x2903289825750000,0xa790a17e21e027b2,0x28f628ad259f0000,0xa835a3bf1fe62728,0x28e528bf25c90000,0xa88da4f21bef2692
.quad 0xa2410000224125f3,0xa90fa8d0a818a5f3,0xa51e9fe61d8c2498,0xa8d7a90ea8b6a7b2,0xa6dea3bf965b2241,0xa835a8eba906a882,0xa827a59fa0561e55,0xa66ba86aa903a8eb,0xa8ada728a3bf0000,0xa3bfa728a8ada90f,0xa8fba835a5759e55,0x9befa4f2a809a8eb,0xa90ea8ada6dea241,0x1fe6a0b9a644a882,0xa8e5a8f6a809a498,0x24c5165ba40ea7b2
.quad 0xa882a90fa882a5f3,0x272822419e55a5f3,0xa7d3a8f6a8d7a728,0x2876259f1befa3bf,0xa644a8ada906a818,0x28f627b223019e55,0xa46ba835a90da882,0x2909289825c91a5a,0xa0b9a728a8eba8d0,0x28ad28ff27b22241,0x925ca59fa8a3a8ff,0x27d32906288d254a,0x1fe6a3bfa835a90f,0x259f28ad28f62728,0x240e9fe6a74ba8ff,0x21e027f2290d2850
.quad 0xa241a5f3a818a8d0,0x281825f322410000,0x18c4a17ea5c9a818,0x28fb286a26b923bf,0x243d1a5aa17ea5f3,0x28df290b28982728,0x274b243d18c4a241,0x279028bf290f28ad,0x28ad272823bf0000,0x23bf272828ad290f,0x290f289826b92241,0x98c42301270328ad,0x28bf290b286a25f3,0xa4f29a5a23012728,0x279028df28fb2818,0xa827a4f298c423bf
.quad 0x2498281828ff28d0,0xa8ffa818a4980000,0x1bef259f2876290f,0xa8d7a8f6a7d3a3bf,0xa17e20b926de28d0,0xa76ea8eba8dfa728,0xa61c9cc2240e2818,0xa360a7f2a903a8ad,0xa850a4981a5a25f3,0x1a5aa498a850a90f,0xa8fba76ea11c2241,0x251e965ba5c9a8ad,0xa8f6a8ada59f0000,0x283523bf9fe6a728,0xa843a90ea809a241,0x2903276e2056a3bf
.quad 0x281828d0290f28d0,0xa2410000224125f3,0x240e26de287628ff,0xa809a59fa11c1a5a,0x9cc220b9259f2818,0xa90ea8ada76ea498,0xa61ca17e1bef2498,0xa843a8f6a8fba850,0xa8ada728a3bf0000,0xa3bfa728a8ada90f,0xa903a8dfa7d3a498,0x20569fe6a5c9a850,0xa7f2a8eba8f6a818,0x276e23bf965ba498,0xa360a76ea8d7a8ff,0x29032835251e1a5a
.quad 0x1e55a241a728a8d0,0x2882290f288225f3,0x266b1fe6a1e0a728,0x24c52835290928ad,0x28bf26921fe6a241,0x9cc223bf27f228ff,0x28fb28bf266b1e55,0xa6b99fe622a127b2,0x27b228ff28ad25f3,0xa8eba728a0b92241,0x22a127f229092882,0xa8b6a8f6a74ba0b9,0x9fe623bf2835290f,0xa59fa8ada8f6a728,0xa6b99cc224c52882,0x125ca59fa8b6a8eb
.quad 0xa90fa8d0a818a5f3,0xa241a5f3a818a8d0,0xa7d3a8bfa90fa8d0,0x246b1cc2a056a54a,0x9fe6a54aa7f2a8d0,0x28bf27b224f21e55,0x24c51cc2a11ca5f3,0x28a3290e28c827b2,0x28ad272823bf0000,0x23bf272828ad290f,0x28d72906285d25f3,0xa360165b246b27b2,0x259f2850290628d0,0xa898a692a17e1e55,0x9bef2301274b28d0,0xa8c8a906a843a54a
.quad 0xa728a2411e5525f3,0xa498a818a8ffa8d0,0xa909a835a4c50000,0x21e09fe6a66ba8ad,0xa835a90ba898a5f3,0x286a254a165ba498,0xa1e0a76ea8f1a8d0,0x28e528df270320b9,0x23bf9e55a692a8d0,0x254a2882290b2818,0x287624f298c4a5f3,0xa05623012809290b,0x28f628ad259f0000,0xa835a3bf1fe62728,0x266b28df28c825f3,0xa8fba898a51e1a5a
.quad 0x281825f322410000,0x281828d0290f28d0,0x28f12906288d2728,0x125c2301266b2850,0x24f227b228bf290f,0xa7f2a54a9fe61e55,0xa2a1165b240e2728,0xa8e5a906a876a692,0xa8ada728a3bf0000,0xa3bfa728a8ada90f,0xa88da90ea8b6a728,0x251e1cc2a1e0a692,0xa17ea692a898a90f,0x29062850259f1e55,0x25751cc2a2a1a728,0x270328bf29092850
.quad 0x28ff281824980000,0x9e552241272828d0,0x27d328f628d72728,0xa876a59f9bef23bf,0x165b254a286a290f,0xa898a90ba835a498,0xa74ba17e211c2728,0xa056a6dea8d7a8eb,0xa90ba882a54a0000,0x26921e55a3bfa818,0xa61ca8bfa8f1a728,0x290d286a24c59a5a,0x1fe6a3bfa835a90f,0x259f28ad28f62728,0x285d243d9f1ea728,0xa2a1217e27d3290b
.quad 0xa2410000224125f3,0xa90fa8d0a818a5f3,0xa8e5a835a61ca241,0xa4c5a76ea8a3a90b,0xa76ea8ada90ea8d0,0x259f20b99cc2a498,0x1f1e9fe6a575a818,0x290928df2809254a,0x28ad272823bf0000,0x23bf272828ad290f,0x282728f628f12818,0xa66ba17e1d8c254a,0x965b23bf276e28d0,0xa8f6a8eba7f2a498,0xa85da59f9d8c2241,0xa1e0a6dea8b6a90b
.quad 0xa882a90fa882a5f3,0x272822419e55a5f3,0x9befa59fa876a90f,0x28d728f627d323bf,0x27f223bf9cc2a5f3,0x1fe6269228bf28ff,0x28c828f627902241,0xa7d3a3011f1e2692,0x20b9272828eb28d0,0xa8ada8ffa7b2a241,0xa7039fe623602818,0x9befa644a8c8a8eb,0xa8f6a8ada59f0000,0x283523bf9fe6a728,0xa360a835a90fa818,0x28762906279020b9
.quad 0xa241a5f3a818a8d0,0x281825f322410000,0x279024f21f1e9e55,0x282728df290d28ad,0x2898290b28df2818,0xa17e1a5a243d2728,0x925c230126b92882,0xa90da898a703a3bf,0xa8ada728a3bf0000,0xa3bfa728a8ada90f,0xa74ba8bfa90da882,0x2790243d125ca3bf,0x23019a5aa4f2a818,0x286a290b28bf2728,0x290d286a25c91e55,0x9f1e217e26b928ad
.quad 0x2498281828ff28d0,0xa8ffa818a4980000,0xa66b9fe621e02728,0xa4c5a835a909a8ad,0xa8dfa8eba76ea241,0x26de20b9a17ea728,0x9d8ca644a8b6a8ff,0x28a32906280923bf,0x285024989a5aa5f3,0x9a5a24982850290f,0x2827290e285d2498,0xa8e5a6de9f1e23bf,0x9fe623bf2835290f,0xa59fa8ada8f6a728,0xa8f1a6de9d8c2498,0x261c165ba575a8ad
.quad 0x281828d0290f28d0,0xa2410000224125f3,0xa360965b21e025f3,0xa903a8f6a85da692,0xa906a8eba835a5f3,0x965ba3bfa6dea882,0x9d8ca4f2a7d3a8d0,0x28f1283525c920b9,0x28ad272823bf0000,0x23bf272828ad290f,0x261c286a290928d0,0xa843a59f9f1e20b9,0xa644a0b91fe625f3,0xa6dea8ada90ea882,0xa8a3a90ea876a5f3,0x261c1fe6a11ca692
.quad 0x1e55a241a728a8d0,0x2882290f288225f3,0x2909283524c50000,0xa1e01fe6266b28ad,0x230127b228f628d0,0xa906a8ada6449e55,0xa827a43d1bef25f3,0x98c4a59fa88da90b,0xa7b2a8ffa8ada5f3,0x28eb272820b9a241,0x246b9cc2a66ba8d0,0x240e2835290f2850,0x28f628ad259f0000,0xa835a3bf1fe62728,0x18c4264428d728d0,0xa703a8f6a8a3a54a
.quad 0xa90fa8d0a818a5f3,0xa241a5f3a818a8d0,0x9befa43da703a882,0x28c827f2257520b9,0x28f6285026442241,0x23012692286a28ff,0x21e02644285d28ff,0xa8b6a76ea46b9a5a,0xa8ada728a3bf0000,0xa3bfa728a8ada90f,0xa4c5a7f2a8e5a8ff,0x28a326de22a19a5a,0x2835254a1cc2a241,0x243d27b228df28ff,0x266b2898290f2882,0xa88da644a05620b9
.quad 0xa728a2411e5525f3,0xa498a818a8ffa8d0,0xa7d3a8f6a8d7a728,0x2876259f1befa3bf,0x259f1a5aa43da818,0x24f22850290e2882,0x2876290e28432498,0xa85da4f2125c254a,0xa3bf1e55269228d0,0xa54aa882a90ba818,0xa8d7a8dfa6b99e55,0x2843243d9d8ca692,0x1fe6a3bfa835a90f,0x259f28ad28f62728,0x2909286a246b9e55,0xa827a301211c27b2
.quad 0x281825f322410000,0x281828d0290f28d0,0x257527f228c8290f,0xa703a43d9bef20b9,0xa86aa692a3010000,0xa644a850a8f6a8ff,0xa46ba76ea8b6a90f,0x285d264421e09a5a,0x28ad272823bf0000,0x23bf272828ad290f,0x22a126de28a3290f,0xa8e5a7f2a4c59a5a,0xa8dfa7b2a43d0000,0x9cc2a54aa835a8ff,0xa056a644a88da90f,0x290f2898266b20b9
.quad 0x28ff281824980000,0x9e552241272828d0,0x1bef259f2876290f,0xa8d7a8f6a7d3a3bf,0xa90ea850a4f20000,0x243d9a5aa59fa882,0x125ca4f2a85da90f,0x2843290e2876254a,0x290b2882254a0000,0xa6929e5523bf2818,0x9d8c243d2843290f,0xa6b9a8dfa8d7a692,0xa8f6a8ada59f0000,0x283523bf9fe6a728,0x211ca301a827a90f,0x246b286a290927b2
.quad 0xa2410000224125f3,0xa90fa8d0a818a5f3,0xa85da8f6a903a882,0x21e0965ba360a692,0x26de23bf165ba241,0x283528eb29062882,0x25c9283528f128ff,0xa7d3a4f29d8c20b9,0xa8ada728a3bf0000,0xa3bfa728a8ada90f,0x9f1ea59fa843a8ff,0x2909286a261c20b9,0x290e28ad26de2241,0x9fe620b926442882,0xa11c1fe6261c2882,0xa876a90ea8a3a692
.quad 0xa882a90fa882a5f3,0x272822419e55a5f3,0x266b1fe6a1e0a728,0x24c52835290928ad,0x264428ad29062818,0xa8f6a7b2a3011e55,0xa88da59f98c42498,0x1befa43da827a90b,0xa0b9a728a8eba8d0,0x28ad28ff27b22241,0x290f2835240e9e55,0xa66b9cc2246b2850,0x9fe623bf2835290f,0xa59fa8ada8f6a728,0xa8a3a8f6a7039e55,0x28d7264418c4a54a
.quad 0xa241a5f3a818a8d0,0x281825f322410000,0x290d28df282725f3,0x1f1e24f2279028ad,0xa43d9a5a217e25f3,0xa8dfa90ba898a728,0xa703a898a90da8d0,0x26b92301925ca3bf,0x28ad272823bf0000,0x23bf272828ad290f,0x125c243d279028d0,0xa90da8bfa74ba3bf,0xa8bfa90ba86aa5f3,0x24f21a5aa301a728,0x26b9217e9f1ea5f3,0x25c9286a290d28ad
.quad 0x2498281828ff28d0,0xa8ffa818a4980000,0xa909a835a4c50000,0x21e09fe6a66ba8ad,0x217ea0b9a6dea8d0,0x276e28eb28df2728,0x2809290628a325f3,0xa8b6a6449d8c23bf,0xa850a4981a5a25f3,0x1a5aa498a850a90f,0x9f1ea6dea8e5a8d0,0x285d290e282723bf,0x28f628ad259f0000,0xa835a3bf1fe62728,0xa575165b261c28d0,0x9d8ca6dea8f1a8ad
.quad 0x281828d0290f28d0,0xa2410000224125f3,0xa8a3a76ea4c59e55,0xa61ca835a8e5a90b,0x1cc2a0b9a59fa818,0x290e28ad276e2498,0x280928df29092882,0xa5759fe61f1e254a,0xa8ada728a3bf0000,0xa3bfa728a8ada90f,0x1d8ca17ea66ba882,0x28f128f62827254a,0x27f228eb28f62818,0xa76ea3bf165b2498,0xa8b6a6dea1e01e55,0x9d8ca59fa85da90b
.quad 0x1e55a241a728a8d0,0x2882290f288225f3,0x27d328f628d72728,0xa876a59f9bef23bf,0xa8bfa6929fe62241,0x1cc2a3bfa7f2a8ff,0x1f1ea301a7d3a8ff,0x279028f628c82692,0x27b228ff28ad25f3,0xa8eba728a0b92241,0xa8c8a6449bef2498,0x23609fe6a703a8eb,0x1fe6a3bfa835a90f,0x259f28ad28f62728,0x2790290628762498,0xa90fa835a36020b9
.quad 0xa90fa8d0a818a5f3,0xa241a5f3a818a8d0,0x266b2301125ca241,0x288d290628f12850,0x1fe6254a27f228d0,0xa8bfa7b2a4f29e55,0xa876a906a8e5a818,0x240e165ba2a1a692,0x28ad272823bf0000,0x23bf272828ad290f,0xa1e01cc2251e2818,0xa8b6a90ea88da692,0xa59fa850a906a8d0,0x28982692217e9e55,0x290928bf27032241,0xa2a11cc225752850
.quad 0xa728a2411e5525f3,0xa498a818a8ffa8d0,0x9befa59fa876a90f,0x28d728f627d323bf,0x2835290b289825f3,0xa86aa54a965b2498,0xa8d7a6dea0562241,0x211ca17ea74ba8eb,0x23bf9e55a692a8d0,0x254a2882290b2818,0x24c5286a290d2818,0xa8f1a8bfa61c9a5a,0xa8f6a8ada59f0000,0x283523bf9fe6a728,0x27d3217ea2a1a818,0x9f1e243d285d290b
.quad 0x281825f322410000,0x281828d0290f28d0,0xa0561cc2246b2728,0xa90fa8bfa7d3a54a,0xa4f2a7b2a8bfa90f,0x27f2254a1fe69e55,0x28c8290e28a32728,0xa11c1cc224c527b2,0xa8ada728a3bf0000,0xa3bfa728a8ada90f,0x246b165ba360a728,0x285d290628d727b2,0x217e26922898290f,0xa906a850a59f9e55,0xa843a906a8c8a728,0x274b23019befa54a
.quad 0x28ff281824980000,0x9e552241272828d0,0xa66b9fe621e02728,0xa4c5a835a909a8ad,0x965ba54aa86aa90f,0x2898290b28352498,0x270328df28e52728,0xa8f1a76ea1e020b9,0xa90ba882a54a0000,0x26921e55a3bfa818,0x28092301a056a728,0x98c424f22876290b,0x9fe623bf2835290f,0xa59fa8ada8f6a728,0xa51ea898a8fba728,0x28c828df266b1a5a
.quad 0xa2410000224125f3,0xa90fa8d0a818a5f3,0xa11ca59fa809a8d0,0x287626de240e1a5a,0x276e28ad290e28d0,0xa59fa0b91cc22498,0xa8fba8f6a843a5f3,0x1befa17ea61ca850,0x28ad272823bf0000,0x23bf272828ad290f,0xa5c99fe6205625f3,0xa7d3a8dfa903a850,0x165ba3bfa76ea8d0,0x28f628eb27f22498,0x251e2835290328d0,0xa8d7a76ea3601a5a
.quad 0xa882a90fa882a5f3,0x272822419e55a5f3,0x2909283524c50000,0xa1e01fe6266b28ad,0xa7f2a3bf1cc225f3,0x9fe6a692a8bfa8ff,0x22a19fe6a6b9a8d0,0x266b28bf28fb27b2,0x20b9272828eb28d0,0xa8ada8ffa7b2a241,0xa74ba8f6a8b6a5f3,0x290927f222a1a0b9,0x28f628ad259f0000,0xa835a3bf1fe62728,0xa8b6a59f125c25f3,0x24c59cc2a6b9a8eb
.quad 0xa241a5f3a818a8d0,0x281825f322410000,0x26b9286a28fb28ff,0xa5c9a17e18c423bf,0xa898a90ba8dfa818,0x217e9a5aa43da728,0x290f28bf27902498,0x18c4243d274b28ad,0xa8ada728a3bf0000,0xa3bfa728a8ada90f,0x2703230198c4a498,0x26b92898290f28ad,0xa3011a5a24f22818,0xa86aa90ba8bfa728,0x98c4a4f2a827a8ff,0x28fb28df279023bf
.quad 0x2498281828ff28d0,0xa8ffa818a4980000,0xa7d3a8f6a8d7a728,0x2876259f1befa3bf,0x28df28eb276e2241,0xa6dea0b9217e2728,0xa903a7f2a3601e55,0x240e9cc2a61ca8ad,0x285024989a5aa5f3,0x9a5a24982850290f,0xa5c9965b251e2882,0xa11ca76ea8fba8ad,0x1fe6a3bfa835a90f,0x259f28ad28f62728,0x2056276e29032882,0xa809a90ea843a3bf
.quad 0x281828d0290f28d0,0xa2410000224125f3,0xa8b6a90ea8d7a818,0x1d8c9fe6a51ea7b2,0x290628eb283525f3,0x165b23bf26de2882,0xa903a86aa66ba241,0xa056a59fa827a8eb,0x28ad272823bf0000,0x23bf272828ad290f,0xa809a4f29bef2241,0xa575a835a8fba8eb,0x264420b99fe6a5f3,0x26de28ad290e2882,0xa40e165b24c52818,0xa809a8f6a8e5a7b2
.quad 0x1e55a241a728a8d0,0x2882290f288225f3,0x1bef259f2876290f,0xa8d7a8f6a7d3a3bf,0xa301a7b2a8f6a8d0,0x290628ad26441e55,0x25c9289829092818,0xa90da835a46b1a5a,0xa7b2a8ffa8ada5f3,0x28eb272820b9a241,0x288d290627d32241,0xa8a3a59f925c254a,0xa8f6a8ada59f0000,0x283523bf9fe6a728,0x290d27f221e0a241,0xa74b9fe6240e2850
.quad 0xa90fa8d0a818a5f3,0xa241a5f3a818a8d0,0x29092898274b2498,0x22a12644284328eb,0xa8f6a850a644a241,0xa301a692a86aa8ff,0x28d727f2251e1e55,0x236026de288d290b,0xa8ada728a3bf0000,0xa3bfa728a8ada90f,0x28762644211c9e55,0x240e276e28c8290b,0xa835a54a9cc22241,0xa43da7b2a8dfa8ff,0x27d3243d925ca498,0x246b27f228f128eb
.quad 0xa728a2411e5525f3,0xa498a818a8ffa8d0,0x266b1fe6a1e0a728,0x24c52835290928ad,0xa59f9a5a243d2818,0xa4f2a850a90ea882,0x24c5965ba575a882,0x251e286a290f2850,0xa3bf1e55269228d0,0xa54aa882a90ba818,0x21e0a17ea790a8ff,0x25752898290327b2,0x9fe623bf2835290f,0xa59fa8ada8f6a728,0x1befa4f2a88da8ff,0x25c928bf28e52692
.quad 0x2882272824981e55,0x2728288228ff28ff,0x28a8277f24dc1eb9,0x2607282e28e2290c,0x28c827d3251e1f1e,0x24c5279028b6290f,0x28e22810255f1f82,0x22d126a6287c2908,0x28f62835259f1fe6,0x1fe6259f283528f6,0x2905285725de2025,0x17f2248127c228db,0x290d2876261c2056,0x9bef22a1270328b6,0x290f289326582088,0xa0eb202526302888
.quad 0x290b28ad269220b9,0xa3bf1a5a254a2850,0x290128c426cc20eb,0xa53497f224542810,0x28f128d72703211c,0xa66b9f1e22a12790,0x28db28e8273a214d,0xa77fa211208826f1,0x28bf28f6276e217e,0xa835a43d1cc22644,0x289e290127a121af,0xa893a55f0e5c258a,0x2876290927d321e0,0xa8d7a66b9bef24c5,0x284a290e28012211,0xa901a75da02523ee
.quad 0xa4989e551e552498,0xa8ffa8ffa882a728,0xa67fa33194c52211,0xa888a905a8f4a857,0xa809a575a0561d8c,0xa74ba8a3a90da8d7,0xa89ea716a3ee94c5,0xa4dca7c2a8cca90e,0xa8f6a835a59f9fe6,0x9fe6a59fa835a8f6,0xa90fa8b1a716a331,0x1c5da211a6a6a893,0xa8e5a8fba827a51e,0x240e925ca46ba7d3,0xa87ca90fa89ea67f,0x26a6214d9f82a607
.quad 0xa7b2a8eba8eba7b2,0x2850254a1a5aa3bf,0xa607a893a90ea857,0x28e8277f22d19df0,0xa40ea809a903a8b6,0x290d288d25c91bef,0x9f82a6a6a8cca8f4,0x28bb28fd27c222d1,0x165ba4f2a86aa90e,0x27f229062898259f,0x214da211a7c2a905,0x25b428a828fd277f,0x24c59befa66ba8d7,0x21e027d329092876,0x26a61c5da4dca888,0x8e5c25b428bb28e8
.quad 0x9e55a498a728a882,0x2882272824981e55,0x20889c5da454a716,0x290f28c427e3255f,0x25c9211c9befa46b,0x288d290928e52827,0x283c25de20eb9d27,0x2630285728fd28f4,0x28f62835259f1fe6,0x1fe6259f283528f6,0x28f928ee28102508,0xa14d1df0255f282e,0x2843290328d72790,0xa6b9a1e01d8c2575,0x25de2870290e28a8,0xa8b1a6cca1af1eb9
.quad 0x20b9269228ad290b,0xa90ba8ada692a0b9,0x9df022d1277f28e8,0xa857a90ea893a607,0xa51e925c24c52843,0xa575a876a90fa85d,0xa801a3901df02658,0x9c5da607a8a8a905,0xa8dfa6de9fe62301,0x23019fe6a6dea8df,0xa908a888a53414c5,0x275d20eba271a7e3,0xa876a909a7d3a1e0,0x28d7266b1befa4c5,0xa67fa8e2a8c4a5de,0x28fd289325089b25
.quad 0x2728288228ff28ff,0xa4989e551e552498,0x20eb258a280128cc,0xa87ca6f1a4259b25,0xa1e018c4240e2703,0xa903a8f1a843a61c,0xa77fa4819b2521af,0xa75da8b1a90fa8bb,0xa8f6a835a59f9fe6,0x9fe6a59fa835a8f6,0xa8c4a90ca87ca658,0x24250e5ca3eea75d,0xa66ba88da90fa8a3,0x285d25c91f1ea11c,0x9df0a5b4a864a90c,0x290a28bb26f12211
.quad 0x23bf9a5aa54aa850,0x27b228eb28eb27b2,0x2810245497f2a534,0x20eb26cc28c42901,0x29092827246b98c4,0xa3601d8c261c28a3,0x2893290a281f2425,0xa83ca481198f25b4,0x259f2898290627f2,0xa90ea86aa4f2165b,0x17f225de28b128f9,0xa801a90aa87ca508,0xa4c51bef266b28d7,0xa1e0a7d3a909a876,0xa857a4251f82273a,0x2271a1afa7e3a90c
.quad 0xa8ffa8ffa882a728,0x9e55a498a728a882,0xa6a6a864a8f9a901,0x25de21af97f2a390,0x925ca360a6b9a876,0x28fb285d266b22a1,0x26582211998fa454,0x282e28ee29012864,0x28f62835259f1fe6,0x1fe6259f283528f6,0x2870290a28cc277f,0xa58a9eb920eb2630,0x2360274b28c82909,0xa8f1a809a4c598c4,0xa2711d27258a2857,0xa84aa908a8c4a716
.quad 0xa850a54a9a5a23bf,0xa0b9a692a8ada90b,0xa901a8c4a6cca0eb,0x253417f2a454a810,0xa6b9a8c8a8fba7d3,0x28e5274b21e0a056,0x94c5a55fa87ca90e,0x2864290f285724dc,0x26441cc2a43da835,0x217e276e28f628bf,0x28f4273a2088a2d1,0xa4dc198f260728bb,0x2876290927d321e0,0xa8d7a66b9bef24c5,0x2390283c290f2810,0xa87ca905a77fa088
.quad 0x2882272824981e55,0x2728288228ff28ff,0x28b1290e28db281f,0x9df01f82250827a1,0x22a1266b285d28fb,0xa876a6b9a360925c,0xa5089df0208825b4,0xa893a90ca8d4a7e3,0xa8f6a835a59f9fe6,0x9fe6a59fa835a8f6,0xa801a8e8a8fda83c,0x26cc22719b25a4dc,0x98c4a4c5a809a8f1,0x290928c8274b2360,0x273a22d19c5da55f,0x2534283c290528cc
.quad 0x290b28ad269220b9,0xa3bf1a5a254a2850,0x26072893290e2857,0xa8e8a77fa2d11df0,0xa05621e0274b28e5,0xa7d3a8fba8c8a6b9,0xa870a5348e5c2508,0x17f2a4afa84aa90f,0xa8bfa8f6a76ea17e,0x2835243d9cc2a644,0xa331a810a90ca870,0x28c428ee27162025,0x24c59befa66ba8d7,0x21e027d329092876,0x28ee26cc1d27a4af,0xa60794c5258a28b1
.quad 0xa4989e551e552498,0xa8ffa8ffa882a728,0xa90aa89ea75da4af,0xa271a630a83ca8e8,0xa61ca843a8f1a903,0x2703240e18c4a1e0,0x23318e5ca390a6f1,0x28db290a288826cc,0x28f62835259f1fe6,0x1fe6259f283528f6,0x26f128a8290f289e,0xa7e3a4af998f22d1,0xa11c1f1e25c9285d,0xa8a3a90fa88da66b,0xa8d4a75da3311b25,0x998fa508a82ea901
.quad 0xa7b2a8eba8eba7b2,0x2850254a1a5aa3bf,0x1df0a2d1a77fa8e8,0x2857290e28932607,0x28a3261c1d8ca360,0x98c4246b28272909,0x282e290c2888258a,0xa89ea5de9b252454,0x965b24f2286a290e,0xa7f2a906a898a59f,0xa864a4af1b252630,0x1f82a390a81fa90e,0xa876a909a7d3a1e0,0x28d7266b1befa4c5,0x998fa658a8dba8cc,0x271628f9289e2534
.quad 0x9e55a498a728a882,0x2882272824981e55,0x284a265822d10e5c,0x273a2893290828ee,0x282728e52909288d,0xa46b9bef211c25c9,0xa0251eb925342801,0xa905a8e8a81fa58a,0xa8f6a835a59f9fe6,0x9fe6a59fa835a8f6,0xa5b4a84aa901a8e2,0x2864260720889f82,0x25751d8ca1e0a6b9,0x279028d729032843,0x28fd28db277f2390,0xa3ee17f224dc281f
.quad 0x20b9269228ad290b,0xa90ba8ada692a0b9,0xa810a45417f22534,0xa0eba6cca8c4a901,0xa85da90fa876a575,0x284324c5925ca51e,0x1d27a3eea810a908,0x27e3290128b12630,0x28df26de1fe6a301,0xa3011fe626de28df,0x265828cc28e826f1,0xa90fa857a4811c5d,0xa4c51bef266b28d7,0xa1e0a7d3a909a876,0xa90aa864a4541eb9,0x281f22d1a14da7c2
.quad 0x2728288228ff28ff,0xa4989e551e552498,0xa534a0251d272481,0xa8d4a90fa8bba7c2,0xa8d7a90da8a3a74b,0x1d8ca056a575a809,0x17f2a271a67fa870,0x290f28a8273a2425,0x28f62835259f1fe6,0x1fe6259f283528f6,0x245427a128d42908,0xa8bba73aa39014c5,0xa7d3a46b925c240e,0xa51ea827a8fba8e5,0xa810a8f9a8e2a7a1,0x27c2242594c5a4af
.quad 0x23bf9a5aa54aa850,0x27b228eb28eb27b2,0x290128c426cc20eb,0xa53497f224542810,0x1bef25c9288d290d,0xa8b6a903a809a40e,0xa8c4a67f9eb92331,0x2025a271a7a1a8f9,0xa59fa898a906a7f2,0x290e286a24f2965b,0x26cc1eb9a3eea82e,0x1d27267f28d428e2,0x2876290927d321e0,0xa8d7a66b9bef24c5,0xa0eb2331282e290f,0xa481a870a908a7a1
.quad 0xa8ffa8ffa882a728,0x9e55a498a728a882,0x198fa14da5b4a810,0x28fd287026cc23ee,0x290f28b6279024c5,0x1f1e251e27d328c8,0x1c5d24af27a128c4,0xa8f9a84aa607a14d,0xa8f6a835a59f9fe6,0x9fe6a59fa835a8f6,0xa1afa67fa888a90e,0x28f4281f25341d27,0x28b6270322a19bef,0x2056261c2876290d,0x2481280128f428e8,0xa8eea7e3a4540e5c
.quad 0xa850a54a9a5a23bf,0xa0b9a692a8ada90b,0xa607a893a90ea857,0x28e8277f22d19df0,0x279022a19f1ea66b,0x211c270328d728f1,0x275d28ee28d426cc,0xa8e2a716a0eb21af,0xa6449cc2243d2835,0xa17ea76ea8f6a8bf,0xa83ca90fa84aa454,0x28db26a61df0a425,0x24c59befa66ba8d7,0x21e027d329092876,0x28a828f426f11df0,0xa8d4a63097f2255f
.quad 0x2882272824981e55,0x2728288228ff28ff,0x23ee26cc287028fd,0xa810a5b4a14d198f,0xa8c8a7d3a51e9f1e,0xa4c5a790a8b6a90f,0xa14da607a84aa8f9,0x28c427a124af1c5d,0x28f62835259f1fe6,0x1fe6259f283528f6,0x1d272534281f28f4,0xa90ea888a67fa1af,0xa90da876a61ca056,0x1befa2a1a703a8b6,0xe5ca454a7e3a8ee,0x28e828f428012481
.quad 0x290b28ad269220b9,0xa3bf1a5a254a2850,0x9df022d1277f28e8,0xa857a90ea893a607,0xa8f1a8d7a703a11c,0x266b1f1ea2a1a790,0x21afa0eba716a8e2,0x26cc28d428ee275d,0x28bf28f6276e217e,0xa835a43d1cc22644,0xa4251df026a628db,0xa454a84aa90fa83c,0xa876a909a7d3a1e0,0x28d7266b1befa4c5,0x255f97f2a630a8d4,0x1df026f128f428a8
.quad 0xa4989e551e552498,0xa8ffa8ffa882a728,0xa7c2a8bba90fa8d4,0x24811d27a025a534,0x2809257520569d8c,0x274b28a3290d28d7,0x2425273a28a8290f,0xa870a67fa27117f2,0xa8f6a835a59f9fe6,0x9fe6a59fa835a8f6,0x14c5a390a73aa8bb,0x290828d427a12454,0x28e528fb2827251e,0xa40e125c246b27d3,0xa4af94c5242527c2,0xa7a1a8e2a8f9a810
.quad 0xa7b2a8eba8eba7b2,0x2850254a1a5aa3bf,0x2810245497f2a534,0x20eb26cc28c42901,0x240e2809290328b6,0xa90da88da5c99bef,0xa8f9a7a1a2712025,0x23319eb9a67fa8c4,0x165ba4f2a86aa90e,0x27f229062898259f,0x28e228d4267f1d27,0xa82ea3ee1eb926cc,0xa4c51bef266b28d7,0xa1e0a7d3a909a876,0xa7a1a908a870a481,0x290f282e2331a0eb
.quad 0x9e55a498a728a882,0x2882272824981e55,0x28ee29082893273a,0xe5c22d12658284a,0xa5c9a11c1bef246b,0xa88da909a8e5a827,0xa58aa81fa8e8a905,0x280125341eb9a025,0x28f62835259f1fe6,0x1fe6259f283528f6,0x9f82208826072864,0xa8e2a901a84aa5b4,0xa843a903a8d7a790,0x26b921e09d8ca575,0x281f24dc17f2a3ee,0x2390277f28db28fd
.quad 0x20b9269228ad290b,0xa90ba8ada692a0b9,0xa901a8c4a6cca0eb,0x253417f2a454a810,0x251e125ca4c5a843,0x25752876290f285d,0x263028b1290127e3,0xa908a810a3ee1d27,0xa8dfa6de9fe62301,0x23019fe6a6dea8df,0x1c5da481a857a90f,0x26f128e828cc2658,0x2876290927d321e0,0xa8d7a66b9bef24c5,0xa7c2a14d22d1281f,0x1eb9a454a864a90a
.quad 0x2728288228ff28ff,0xa4989e551e552498,0xa8e8a83ca630a271,0xa4afa75da89ea90a,0x21e098c4a40ea703,0x290328f12843261c,0x26cc2888290a28db,0xa6f1a3908e5c2331,0xa8f6a835a59f9fe6,0x9fe6a59fa835a8f6,0x22d1998fa4afa7e3,0x289e290f28a826f1,0x266b288d290f28a3,0xa85da5c99f1e211c,0xa901a82ea508998f,0x1b25a331a75da8d4
.quad 0x23bf9a5aa54aa850,0x27b228eb28eb27b2,0x26072893290e2857,0xa8e8a77fa2d11df0,0xa909a827a46b18c4,0x23609d8ca61ca8a3,0x24549b25a5dea89e,0x258a2888290c282e,0x259f2898290627f2,0xa90ea86aa4f2165b,0xa90ea81fa3901f82,0x26301b25a4afa864,0x24c59befa66ba8d7,0x21e027d329092876,0x2534289e28f92716,0xa8cca8dba658998f
.quad 0xa8ffa8ffa882a728,0x9e55a498a728a882,0x27a125081f829df0,0x281f28db290e28b1,0x125c236026b92876,0xa8fba85da66ba2a1,0xa7e3a8d4a90ca893,0x25b420889df0a508,0x28f62835259f1fe6,0x1fe6259f283528f6,0xa4dc9b25227126cc,0xa83ca8fda8e8a801,0xa360a74ba8c8a909,0x28f1280924c518c4,0x28cc2905283c2534,0xa55f9c5d22d1273a
.quad 0xa850a54a9a5a23bf,0xa0b9a692a8ada90b,0x1df0a2d1a77fa8e8,0x2857290e28932607,0x26b928c828fb27d3,0xa8e5a74ba1e02056,0xa90fa84aa4af17f2,0x25088e5ca534a870,0x26441cc2a43da835,0x217e276e28f628bf,0x2025271628ee28c4,0xa870a90ca810a331,0xa876a909a7d3a1e0,0x28d7266b1befa4c5,0x28b1258a94c5a607,0xa4af1d2726cc28ee
.quad 0x2882272824981e55,0x2728288228ff28ff,0xa39097f221af25de,0xa901a8f9a864a6a6,0xa2a1a66ba85da8fb,0x287626b92360125c,0x2864290128ee282e,0xa454998f22112658,0xa8f6a835a59f9fe6,0x9fe6a59fa835a8f6,0x263020eb9eb9a58a,0x277f28cc290a2870,0x18c424c5280928f1,0xa909a8c8a74ba360,0xa716a8c4a908a84a,0x2857258a1d27a271
.quad 0x290b28ad269220b9,0xa3bf1a5a254a2850,0xa810a45417f22534,0xa0eba6cca8c4a901,0x2056a1e0a74ba8e5,0x27d328fb28c826b9,0x24dc2857290f2864,0xa90ea87ca55f94c5,0xa8bfa8f6a76ea17e,0x2835243d9cc2a644,0x28bb2607198fa4dc,0xa2d12088273a28f4,0xa4c51bef266b28d7,0xa1e0a7d3a909a876,0xa088a77fa905a87c,0x2810290f283c2390
.quad 0xa4989e551e552498,0xa8ffa8ffa882a728,0x9b25a425a6f1a87c,0x28cc2801258a20eb,0x261c284328f12903,0xa703a40e98c421e0,0xa8bba90fa8b1a75d,0x21af9b25a481a77f,0x28f62835259f1fe6,0x1fe6259f283528f6,0xa75da3ee0e5c2425,0xa658a87ca90ca8c4,0x211c9f1ea5c9a85d,0x28a3290f288d266b,0x221126f128bb290a,0xa90ca864a5b49df0
.quad 0xa7b2a8eba8eba7b2,0x2850254a1a5aa3bf,0x290128c426cc20eb,0xa53497f224542810,0xa8a3a61c9d8c2360,0x18c4a46ba827a909,0x25b4198fa481a83c,0x2425281f290a2893,0x965b24f2286a290e,0xa7f2a906a898a59f,0xa508a87ca90aa801,0x28f928b125de17f2,0x2876290927d321e0,0xa8d7a66b9bef24c5,0xa90ca7e3a1af2271,0x273a1f82a425a857
.quad 0x9e55a498a728a882,0x2882272824981e55,0x255f27e328c4290f,0xa716a4549c5d2088,0xa827a8e5a909a88d,0x246b1befa11ca5c9,0x28f428fd28572630,0x9d2720eb25de283c,0xa8f6a835a59f9fe6,0x9fe6a59fa835a8f6,0x282e255f1df0a14d,0x2508281028ee28f9,0xa5759d8c21e026b9,0xa790a8d7a903a843,0x1eb9a1afa6cca8b1,0x28a8290e287025de
.quad 0x20b9269228ad290b,0xa90ba8ada692a0b9,0xa607a893a90ea857,0x28e8277f22d19df0,0x285d290f28762575,0xa843a4c5125c251e,0xa905a8a8a6079c5d,0x26581df0a390a801,0x28df26de1fe6a301,0xa3011fe626de28df,0xa7e3a27120eb275d,0x14c5a534a888a908,0x24c59befa66ba8d7,0x21e027d329092876,0x9b252508289328fd,0xa5dea8c4a8e2a67f
.quad 0x2728288228ff28ff,0xa4989e551e552498,0xa857a8f4a905a888,0x221194c5a331a67f,0x28d7290d28a3274b,0x9d8c205625752809,0xa90ea8cca7c2a4dc,0x94c5a3eea716a89e,0x28f62835259f1fe6,0x1fe6259f283528f6,0xa893a6a6a2111c5d,0xa331a716a8b1a90f,0x27d3246b125ca40e,0x251e282728fb28e5,0xa6079f82214d26a6,0xa67fa89ea90fa87c
.quad 0x23bf9a5aa54aa850,0x27b228eb28eb27b2,0x9df022d1277f28e8,0xa857a90ea893a607,0x9befa5c9a88da90d,0x28b629032809240e,0x22d127c228fd28bb,0xa8f4a8cca6a69f82,0xa59fa898a906a7f2,0x290e286a24f2965b,0x277f28fd28a825b4,0xa905a7c2a211214d,0xa876a909a7d3a1e0,0x28d7266b1befa4c5,0x28e828bb25b48e5c,0xa888a4dc1c5d26a6
.quad 0xa8ffa8ffa882a728,0x9e55a498a728a882,0x290c28e2282e2607,0x1eb924dc277f28a8,0xa90fa8b6a790a4c5,0x9f1ea51ea7d3a8c8,0x2908287c26a622d1,0x1f82255f281028e2,0xa8f6a835a59f9fe6,0x9fe6a59fa835a8f6,0x28db27c2248117f2,0x202525de28572905,0xa8b6a703a2a11bef,0xa056a61ca876a90d,0x288826302025a0eb,0x208826582893290f
.quad 0xa850a54a9a5a23bf,0xa0b9a692a8ada90b,0x2810245497f2a534,0x20eb26cc28c42901,0xa790a2a11f1e266b,0xa11ca703a8d7a8f1,0x26f12088a211a77f,0x214d273a28e828db,0xa6449cc2243d2835,0xa17ea76ea8f6a8bf,0x258a0e5ca55fa893,0x21af27a12901289e,0xa4c51bef266b28d7,0xa1e0a7d3a909a876,0x23eea025a75da901,0x22112801290e284a
.quad 0xa24122412818290f,0xa241a818a90fa818,0xa360217e2809290f,0x9f1ea76ea909a850,0xa43d20b927f2290f,0x965ba692a8f6a882,0xa4c51fe627d3290f,0x1befa59fa8d7a8ad,0xa54a1e5527b2290f,0x20b9a498a8ada8d0,0xa5c91cc22790290f,0x2360a301a876a8eb,0xa6441a5a276e290f,0x24f2a0b9a835a8ff,0xa6b9165b274b290f,0x261c9cc2a7d3a90b
.quad 0xa72800002728290f,0x27288000a728a90f,0xa790965b2703290f,0x28091cc2a66ba90b,0xa7f29a5a26de290f,0x286a20b9a59fa8ff,0xa8279cc226b9290f,0x28b62301a4c5a8eb,0xa8509e552692290f,0x28eb2498a3bfa8d0,0xa8769fe6266b290f,0x2909259fa1e0a8ad,0xa898a0b92644290f,0x290e26929fe6a882,0xa8b6a17e261c290f,0x28fb276e9befa850
.quad 0x2818290f28182241,0xa90fa818a2412241,0x26b928f6288d2498,0xa8d7a8bfa5751a5a,0x24f228ad28df25f3,0xa835a90ba76e9e55,0x21e0283529092728,0xa66ba8f6a876a3bf,0x1a5a2728290b2818,0xa3bfa882a8eba5f3,0x9d8c259f28e52882,0x9befa76ea90fa7b2,0xa30123bf289828d0,0x1fe6a54aa8dfa882,0xa5751fe6282728ff,0x24c5a17ea85da8eb
.quad 0xa72800002728290f,0x27288000a728a90f,0xa8439fe625c928ff,0x2876217ea51ea8eb,0xa8bfa3bf243d28d0,0x28f6254aa17ea882,0xa903a59f211c2882,0x2909276e925ca7b2,0xa90ba7281a5a2818,0x28ad288220b9a5f3,0xa8d7a8359bef2728,0x27d328f624c5a3bf,0xa86aa8ada17e25f3,0x259f290b26de9e55,0xa790a8f6a46b2498,0x21e028bf28431a5a
.quad 0x28182241a241a818,0xa24122412818290f,0x28e52644125ca5f3,0xa7039cc2251e28ad,0x290628502301a241,0xa8bfa54a1cc22728,0x287628f6266b8000,0xa909a835a1e023bf,0x269228ff28502241,0xa850a8ffa6920000,0x22a1286a28f125f3,0xa575a8dfa88da3bf,0x965b269229062818,0x9cc2a7b2a90ea728,0xa40e2301288d28d0,0x22a1a43da8b6a8ad
.quad 0xa72800002728290f,0x27288000a728a90f,0xa8a3a301246b28d0,0x28c8243da360a8ad,0xa90ea6921cc22818,0x290627b2165ba728,0xa8c8a86aa05625f3,0x284328df246ba3bf,0xa7b2a8ffa54a2241,0x254a28ff27b28000,0xa4c5a8f6a7d30000,0x1bef283528d723bf,0x9cc2a850a8bfa241,0xa301254a29062728,0x211ca644a90fa5f3,0xa74b1cc2285d28ad
.quad 0xa241a818a90fa818,0x2818290f28182241,0x2056a43da876a8ff,0x22a12835290d27b2,0x26de1a5aa59fa8d0,0xa17e23bf286a28ff,0x28d7259f9befa728,0xa7d39fe624c528ad,0x28eb288223bfa241,0xa90ba7289a5a25f3,0x274b290e27d31e55,0xa85da8f6a61c1a5a,0x217e285028f625f3,0xa43da8ada8bfa498,0xa11c24f228d72882,0x1f1ea59fa8f1a850
.quad 0xa72800002728290f,0x27288000a728a90f,0xa8e5a4f221e02882,0x28fb259fa056a850,0xa8dfa8509fe625f3,0x289828ad2301a498,0xa703a90ea66b1e55,0x251e28f628091a5a,0xa0b9a882a8ada241,0x9a5a2728290b25f3,0x21e0a59fa909a728,0xa66b1fe6287628ad,0x276e9a5aa835a8d0,0xa8dfa3bf24f228ff,0x28f1243da4c5a8ff,0xa8c8a83598c427b2
.quad 0xa90fa818a2412241,0x28182241a241a818,0xa7d3a90ea827a241,0x2903286a240ea0b9,0x9fe6a7b2a90ea818,0x264428eb28982498,0x24c59fe6a7d3a90f,0x9bef259f28d728ad,0x28ad2498a0b9a818,0xa7b29e55254a28d0,0x28d72898240ea241,0xa90da7f29f1e254a,0x259f28eb286a2241,0xa6dea90ba7f29e55,0x9bef264429032818,0x125ca6dea90da7b2
.quad 0xa72800002728290f,0x27288000a728a90f,0xa909a6441d8c2818,0x290f26de98c4a7b2,0xa835a8eba4f22241,0x276e290b26449e55,0xa1e0a898a8a3a241,0x18c427f228fb254a,0x23bfa498a8eba818,0xa6921e55285028d0,0x28761fe6a66ba90f,0xa909a59f21e028ad,0x28f627b2965ba818,0xa7f2a8eba43d2498,0x266b290e25c9a241,0x9d8ca86aa8a3a0b9
.quad 0xa24122412818290f,0xa241a818a90fa818,0xa8a3a4f21d8c2728,0x25c9965ba66ba8eb,0xa898a8eba6440000,0x290e27b21fe6a498,0xa1e0a835a909a728,0x266b28f6287623bf,0x254a9e55a7b2a90f,0xa0b9249828ad28d0,0x28fb264498c4a728,0xa8a3a43d21e02850,0x27f2290b26de8000,0xa86aa8eba59f1e55,0x18c4276e290f2728,0x9d8ca7f2a909a692
.quad 0xa72800002728290f,0x27288000a728a90f,0xa90da76e925c2728,0x290327f21befa692,0xa644a90ba76e0000,0x24f228eb28351e55,0x1f1ea644a90da728,0xa40e243d28d72850,0x28501e55a692a90f,0xa8eba49823bf28d0,0x28d728351befa728,0xa7d3a8f6a4c523bf,0x243d28eb27f28000,0x165ba7b2a8f6a498,0xa40e24f229032728,0x2827165ba7d3a8eb
.quad 0x2818290f28182241,0xa90fa818a2412241,0x98c4259f28c828d0,0xa4c5a898a8f1a692,0xa86aa3bf217e2818,0x259f9a5aa6dea8ff,0xa876a8f6a66b0000,0x2909283521e0a3bf,0x9a5aa728a90ba818,0x23bf288228eb25f3,0x28091fe6a51ea8d0,0xa66b165b2703290b,0x28bf28ad243da241,0xa8f6a850a17e2498,0x2056283528fb25f3,0xa1e0a86aa8e5a54a
.quad 0xa72800002728290f,0x27288000a728a90f,0xa8f1a8359f1e25f3,0x28d7286a211ca54a,0xa301a8ada898a241,0x1fe6285028df2498,0x261c9fe6a85da8d0,0xa7d3965b274b290b,0x290b27289a5aa818,0xa8ada882a0b925f3,0x24c528f627d38000,0x9befa835a8d7a3bf,0xa4f223bf28df2818,0x28351a5aa76ea8ff,0xa90da59f22a128d0,0x287628982056a692
.quad 0x28182241a241a818,0xa24122412818290f,0x285d2906274b1e55,0xa90fa7f2a11c23bf,0x9cc2254a28bf28d0,0xa301a850a906a728,0xa8d7a59f1bef2728,0x27d31fe6a4c5a8ad,0xa692a8ffa850a241,0x285028ff26928000,0x246ba17ea843a8ff,0xa05624f228c828ad,0x290e27b21cc2a5f3,0xa906a692165b2728,0x2360289828c82498,0xa46ba8bfa8a3a3bf
.quad 0xa72800002728290f,0x27288000a728a90f,0xa8b6a898a2a12498,0x288d28bf240ea3bf,0x965ba7b2a906a5f3,0x9cc22692290e2728,0x288d217ea575a8ff,0xa8f1a4f222a128ad,0x27b228ff254aa241,0xa54aa8ffa7b20000,0xa1e0259f29092728,0x266b9fe6a876a8ad,0xa906a54a230128d0,0x28bf28501cc2a728,0xa51ea906a7031e55,0x925c27f228e523bf
.quad 0xa241a818a90fa818,0x2818290f28182241,0x28432301a1e0a818,0xa46b1fe62790290b,0x276e290b28352241,0xa8dfa8ada4f21e55,0xa4c51fe627d3290f,0x1befa59fa8d7a8ad,0xa8eba882a3bf2241,0x290b27281a5aa5f3,0x925ca6dea909a818,0x211c283529032692,0x28df254a9fe6a818,0xa898a3bf23012882,0x251e28df28762241,0xa5c9a8f6a843a0b9
.quad 0xa72800002728290f,0x27288000a728a90f,0xa85da8dfa4c52241,0x282728f62575a0b9,0x217ea54aa8f6a818,0xa43d23bf28bf2882,0x290f26de9befa818,0xa8e5a8359d8c2692,0x20b9288228ad2241,0x1a5aa728a90ba5f3,0xa8769fe6266b290f,0x2909259fa1e0a8ad,0xa6dea90ba59f2241,0x217e28ad286a1e55,0x2575a301a8d7a818,0xa88d9fe626b9290b
.quad 0xa90fa818a2412241,0x28182241a241a818,0x9befa6dea8fba882,0x261c28df28b6254a,0x28f62692165ba5f3,0xa7f2a0b9243d2882,0x21e0283529092728,0xa66ba8f6a876a3bf,0xa8ada49820b92818,0x27b21e55a54aa8d0,0xa4c5a8bfa8b6a498,0x26b92906282720b9,0x283520b9a4f2a8d0,0xa76e9a5a264428ff,0x266b290628091e55,0xa703a90ea7909a5a
.quad 0xa72800002728290f,0x27288000a728a90f,0xa7d3a906a61c1e55,0x274b290e26b99a5a,0x259fa0b9a86aa8d0,0xa6de1a5a27f228ff,0x287628bf2360a498,0xa790a906a5c920b9,0xa3bf249828eb2818,0x26929e55a850a8d0,0xa8d7a8359bef2728,0x27d328f624c5a3bf,0x1fe6a692a90ea5f3,0xa64420b928982882,0x290926de9f1ea882,0xa809a8dfa360254a
.quad 0xa24122412818290f,0xa241a818a90fa818,0xa8b6a8dfa61c0000,0x28fb26de1befa54a,0x243da0b9a7f2a90f,0x165b269228f62882,0x287628f6266b8000,0xa909a835a1e023bf,0xa54a1e5527b2290f,0x20b9a498a8ada8d0,0xa827a906a6b90000,0x28b628bf24c5a0b9,0x26449a5aa76ea90f,0xa4f220b9283528ff,0x2790290e27038000,0xa809a906a66b1a5a
.quad 0xa72800002728290f,0x27288000a728a90f,0xa6b9a90ea74b0000,0x261c290627d31a5a,0x27f21a5aa6dea90f,0xa86aa0b9259f28ff,0x25c9290627908000,0xa360a8bfa876a0b9,0xa8509e552692290f,0x28eb2498a3bfa8d0,0xa4c5a8f6a7d30000,0x1bef283528d723bf,0x289820b9a644a90f,0xa90ea6921fe62882,0x236028df28098000,0x1f1ea6dea909a54a
.quad 0x2818290f28182241,0xa90fa818a2412241,0xa7909fe6246b2882,0x21e0a301a843a90b,0xa4f2a8ada8dfa5f3,0x2835290b276e1e55,0x28d7259f9befa728,0xa7d39fe624c528ad,0x1a5a2728290b2818,0xa3bfa882a8eba5f3,0xa903a835a11c2498,0x290926de125ca692,0x2301a3bfa898a8d0,0x9fe6254a28df2882,0x284328f625c99e55,0xa876a8dfa51e20b9
.quad 0xa72800002728290f,0x27288000a728a90f,0xa575a8f6a8279e55,0x24c528df285d20b9,0x28bf23bfa43da8d0,0xa8f6a54a217e2882,0x1d8c283528e52498,0x1befa6dea90fa692,0xa90ba7281a5a2818,0x28ad288220b9a5f3,0x21e0a59fa909a728,0xa66b1fe6287628ad,0x286a28ad217ea5f3,0xa59fa90ba6de1e55,0xa6b91fe6288d2882,0x28d72301a575a90b
.quad 0x28182241a241a818,0xa24122412818290f,0x211c27f2290f2818,0xa74ba906a85da3bf,0xa906a850a3012241,0x28bf254a9cc2a728,0x24c59fe6a7d3a90f,0x9bef259f28d728ad,0x269228ff28502241,0xa850a8ffa6920000,0xa8c8a4f220562818,0x2843217ea46ba8ad,0x165ba692a906a818,0x1cc227b2290e2728,0x28a328bf246ba241,0xa8c8a898a36023bf
.quad 0xa72800002728290f,0x27288000a728a90f,0xa40ea8bfa88da241,0x22a1289828b623bf,0x290e26929cc2a818,0xa906a7b2965b2728,0xa2a124f228f12818,0x2575a17ea88da8ad,0xa7b2a8ffa54a2241,0x254a28ff27b28000,0x28761fe6a66ba90f,0xa909a59f21e028ad,0x1cc2285028bf2241,0x2301a54aa906a728,0xa8e5a7f2125c2818,0x27032906251ea3bf
.quad 0xa241a818a90fa818,0x2818290f28182241,0x28f1289824c59e55,0xa8c8a59f18c42692,0xa6de9a5a259f28d0,0x217ea3bfa86aa8ff,0xa1e0a835a909a728,0x266b28f6287623bf,0x28eb288223bfa241,0xa90ba7289a5a25f3,0xa703965b266b28ff,0x251e9fe6a809a90b,0xa17ea850a8f6a5f3,0x243d28ad28bf2498,0x28e5286a21e0a498,0xa8fba835a056254a
.quad 0xa72800002728290f,0x27288000a728a90f,0xa11ca86aa8d7a498,0x1f1e283528f1254a,0x28df28501fe6a5f3,0xa898a8ada3012498,0xa74b165b27d328ff,0x285d1fe6a61ca90b,0xa0b9a882a8ada241,0x9a5a2728290b25f3,0x28d728351befa728,0xa7d3a8f6a4c523bf,0xa76e1a5a283528d0,0x28df23bfa4f2a8ff,0xa056a898a8769e55,0xa2a1259f290d2692
.quad 0xa90fa818a2412241,0x28182241a241a818,0x266b165ba5c9a8d0,0x9d8c24f228a328eb,0x1fe627b2290e2818,0xa644a8eba898a498,0xa876a8f6a66b0000,0x2909283521e0a3bf,0x28ad2498a0b9a818,0xa7b29e55254a28d0,0xa1e0243d28a328d0,0x18c4a644a8fba850,0xa59fa8eba86aa241,0x26de290b27f21e55,0x290927f21d8ca5f3,0xa90fa76e98c42692
.quad 0xa72800002728290f,0x27288000a728a90f,0x9befa7f2a903a5f3,0x125c276e290d2692,0x283528eb24f2a241,0xa76ea90ba6441e55,0xa8d7a43d240e28d0,0x290d26449f1ea850,0x23bfa498a8eba818,0xa6921e55285028d0,0x24c528f627d38000,0x9befa835a8d7a3bf,0xa8f6a7b2165b2818,0x27f228eb243da498,0x27d3965ba827a8d0,0xa903a4f2240e28eb
.quad 0xa24122412818290f,0xa241a818a90fa818,0xa40ea86aa903a728,0x2827290e27d320b9,0x289828eb26448000,0xa90ea7b29fe62498,0xa8d7a59f1bef2728,0x27d31fe6a4c5a8ad,0x254a9e55a7b2a90f,0xa0b9249828ad28d0,0x1f1e27f2290d2728,0xa40ea898a8d7a54a,0xa7f2a90ba6de0000,0x286a28eb259f9e55,0x290d26de925ca728,0xa903a6441bef27b2
.quad 0xa72800002728290f,0x27288000a728a90f,0x18c4a6dea90fa728,0x9d8c2644290927b2,0x2644290b276e8000,0xa4f2a8eba8359e55,0xa8fba7f298c42728,0x28a3289821e0a54a,0x28501e55a692a90f,0xa8eba49823bf28d0,0xa1e0259f29092728,0x266b9fe6a876a8ad,0xa43da8eba7f20000,0x965b27b228f62498,0x28a3286a1d8ca728,0xa5c9a90ea66b20b9
.quad 0x2818290f28182241,0xa90fa818a2412241,0xa90da835a2a12241,0x2876243da056a7b2,0x286a23bfa17ea818,0xa59f1a5a26de28ff,0xa4c51fe627d3290f,0x1befa59fa8d7a8ad,0x9a5aa728a90ba818,0x23bf288228eb25f3,0x261c28f6285d2241,0xa7d3a90ea74b9a5a,0xa8bfa8ada43d2241,0x28f62850217ea498,0x28f1259f9f1ea818,0xa8d7a4f2211c2850
.quad 0xa72800002728290f,0x27288000a728a90f,0x2056a59fa8fba818,0xa1e024f228e52850,0x230128ad28982241,0x9fe6a850a8dfa498,0xa809a8f6a51e2241,0x266b290e27039a5a,0x290b27289a5aa818,0xa8ada882a0b925f3,0xa8769fe6266b290f,0x2909259fa1e0a8ad,0x24f2a3bfa8dfa818,0xa8359a5a276e28ff,0x18c4283528c82241,0x24c5a43da8f1a7b2
.quad 0x28182241a241a818,0xa24122412818290f,0xa51e1cc2270328ff,0x925ca644a8e5a8ad,0x1cc2a54aa8bfa8d0,0x2301285029062728,0x21e0283529092728,0xa66ba8f6a876a3bf,0xa692a8ffa850a241,0x285028ff26928000,0x288d28df25759e55,0xa8f1a86aa2a123bf,0xa90ea7b29cc225f3,0x29062692965ba728,0x28b6243da2a1a882,0xa88da301240e28ad
.quad 0xa72800002728290f,0x27288000a728a90f,0x2360a43da8c8a882,0xa46b230128a328ad,0x165b27b2290625f3,0x1cc2a692a90ea728,0xa46ba8dfa8439e55,0x2056286a28c823bf,0x27b228ff254aa241,0xa54aa8ffa7b20000,0xa8d7a8359bef2728,0x27d328f624c5a3bf,0x2906254aa301a8d0,0xa8bfa8509cc22728,0xa85d9cc2274b28ff,0x290f2644a11ca8ad
.quad 0xa241a818a90fa818,0x2818290f28182241,0x257528bf28d725f3,0xa88da8f6a6b99a5a,0xa76ea90ba835a241,0x28df28ad24f29e55,0x287628f6266b8000,0xa909a835a1e023bf,0xa8eba882a3bf2241,0x290b27281a5aa5f3,0x290f276e1befa5f3,0xa8e5a59f1d8c27b2,0xa8dfa54a1fe62818,0x289823bfa301a882,0x285d217ea4c5a8d0,0xa8279fe6257528eb
.quad 0xa72800002728290f,0x27288000a728a90f,0x251ea17ea876a8d0,0xa5c91fe6284328eb,0xa17e254a28f62818,0x243da3bfa8bfa882,0x125ca76ea909a5f3,0xa11c259f290327b2,0x20b9288228ad2241,0x1a5aa728a90ba5f3,0xa4c5a8f6a7d30000,0x1bef283528d723bf,0x26de290b259fa241,0xa17ea8ada86a9e55,0xa843a8bfa1e025f3,0x246b28f627909a5a
.quad 0xa90fa818a2412241,0x28182241a241a818,0x2909276e1f1ea498,0xa809a17e23602850,0xa8f6a692965b25f3,0x27f220b9a43da882,0x28d7259f9befa728,0xa7d39fe624c528ad,0xa8ada49820b92818,0x27b21e55a54aa8d0,0x28762301a360a882,0xa7909cc225c928eb,0xa835a0b924f228d0,0x276e1a5aa644a8ff,0x27d31cc2a61ca8ff,0xa74b965b26b9290b
.quad 0xa72800002728290f,0x27288000a728a90f,0x266b9cc2a809a8ff,0xa703165b2790290b,0xa59f20b9286a28d0,0x26de9a5aa7f2a8ff,0x24c5a301a8b6a882,0xa6b91cc2282728eb,0xa3bf249828eb2818,0x26929e55a850a8d0,0x21e0a59fa909a728,0xa66b1fe6287628ad,0x9fe62692290e25f3,0x2644a0b9a898a882,0x1befa76ea8fba498,0xa61c217e28b62850
.quad 0x290f,0x0,0xa90f,0x0,0x290f,0x0,0xa90f,0x0,0x290f,0x0,0xa90f,0x0,0x290f,0x0,0xa90f,0x0
.quad 0x290f,0x0,0xa90f,0x0,0x290f,0x0,0xa90f,0x0,0x290f,0x0,0xa90f,0x0,0x290f,0x0,0xa90f
.zero 776
.quad 0xa5f3000025f328d0,0x8000a5f3a8d0a8d0,0xa67f97f225b428cc,0x1df0a4dca89ea8ee,0xa7039bef257528c8,0x21e0a360a85da903,0xa77f9df0253428c4,0x2454a0eba810a90e,0xa7f29fe624f228bf,0x259f9cc2a76ea90e,0xa82ea0eb24af28bb,0x26cc0e5ca6a6a905,0xa85da1e0246b28b6,0x27d31d8ca5c9a8f1,0xa888a2d1242528b1,0x2857214da4dca8d4
.quad 0xa8ada3bf23bf28ad,0x28ad23bfa3bfa8ad,0xa8cca454233128a8,0x28e82508a1afa87c,0xa8e5a4c522a128a3,0x2909261c9f1ea843,0xa8f9a5342211289e,0x290e2716998fa801,0xa906a59f217e2898,0x28f627f2165ba76e,0xa90ea60720eb2893,0x28c428571df0a6cc,0xa90fa66b2056288d,0x287628a3211ca61c,0xa90aa6cc1f822888,0x281028db2331a55f
.quad 0x25f328d028d025f3,0xa8d0a8d0a5f30000,0x23ee28642905273a,0xa81fa90fa7e3a0eb,0x1f1e2790290d2827,0xa61ca8e5a8a3a4c5,0x97f2260728e82893,0xa2d1a857a901a6cc,0xa17e243d289828df,0x965ba6dea906a835,0xa4dc2088281f2908,0x214da481a8b1a8c4,0xa6b9125c2703290d,0x25759f1ea809a909,0xa81f9f82258a28ee,0x27c21c5da630a901
.quad 0xa8ada3bf23bf28ad,0x28ad23bfa3bfa8ad,0xa8fda5b42025284a,0x290a26589d27a810,0xa90da74b125c2790,0x28f128271d8ca66b,0xa8dba84a9eb92658,0x286428cc23eea454,0xa86aa8bfa30124f2,0x26de290e26449fe6,0xa77fa901a53422d1,0x245428e8281017f2,0xa5c9a90da6b91f1e,0x1d8c285d28b621e0,0xa390a8e2a8010e5c,0x9eb926f129082534
.quad 0x28d025f38000a5f3,0xa5f3000025f328d0,0x290c283c22d1a211,0xa87ca454202527a1,0x288d28f1266b125c,0xa90fa7d3a056246b,0x26cc2901285722d1,0xa893a8e8a60717f2,0x2301286a28f62644,0xa644a8f6a86aa301,0x94c5267f2901283c,0xa025a810a90aa6f1,0xa40e22a1287628e5,0x211ca4c5a8c8a8a3,0xa73a94c526cc290c,0x26a697f2a75da90f
.quad 0xa8ada3bf23bf28ad,0x28ad23bfa3bfa8ad,0xa90fa6f117f227a1,0x290c277f14c5a716,0xa8b6a88da1e0251e,0x285d28d7246ba360,0xa75da90aa6072025,0x258a290127c214c5,0xa43da8dfa8359cc2,0x1cc2283528df243d,0x97f2a810a8e8a454,0xa2d125342901277f,0x22a1a575a909a703,0xa74b1bef284328c8,0x26a6a025a893a87c,0xa8d4a2d1258a290c
.quad 0x8000a5f3a8d0a8d0,0x25f328d028d025f3,0x25349c5da6f1a8fd,0xe5c263028e228b1,0x2876240ea11ca809,0xa5c918c426b928fb,0x290e281020eba454,0xa8c4a5341df0277f,0x2835290626de165b,0xa8dfa898a43d217e,0x245428a828cc2508,0xa658a8fda84aa1af,0x9bef261c28fb2843,0x98c4a74ba90fa790,0xa6071d2727e3290a,0x255fa025a82ea8fd
.quad 0xa8ada3bf23bf28ad,0x28ad23bfa3bfa8ad,0xa901a8019c5d267f,0x28ee283c1f82a5de,0xa7d3a903a5c92056,0x26b9290f270398c4,0xa2d1a8b1a888a14d,0x1c5d281f28ee24dc,0x1fe6a644a90ea6de,0xa4f2230128bf286a,0x26cc9df0a857a8c4,0xa893a0eb2607290e,0x28d72360a51ea903,0xa8fba79018c42827,0x28e827e394c5a81f,0xa716a905a50823ee
.quad 0xa8d0a8d0a5f30000,0x28d025f38000a5f3,0xa55fa8bba8dba607,0x288828f926cc1b25,0x1d8ca51ea8b6a8d7,0x22a128432909274b,0x277f1df0a534a8c4,0xa45420eb2810290e,0x290e276e1cc2a59f,0xa8bfa4f21fe627f2,0x2801290c271617f2,0xa89ea8d4a5341f82,0x205628272903266b,0xa360a88da8d7a51e,0xa4af21af286428e8,0x23eea331a893a8cc
.quad 0xa8ada3bf23bf28ad,0x28ad23bfa3bfa8ad,0xa8d4a870a14d2534,0x28b1289e22d1a481,0xa575a8fba8099bef,0x240e28c82876211c,0x1d27a6a6a90fa6cc,0xa33124af28e8282e,0x276e965ba7f2a8f6,0xa898a17e259f2906,0x290e2607a0eba893,0xa8c4a8579df026cc,0x280928e5240ea4c5,0xa46ba8f1a7d3125c,0x2088289e28701df0,0x2271a5b4a90ea67f
.quad 0xa5f3000025f328d0,0x8000a5f3a8d0a8d0,0xa90aa77f9f822481,0x281021afa331a84a,0xa74ba909a843a2a1,0x28d728b6251e9d8c,0x17f2a607a8e8a893,0x22d12857290126cc,0x27f21fe6a4f2a8bf,0xa59f1cc2276e290e,0x28f928572211a425,0xa90ea73a998f2630,0x251e28d7288d2360,0xa66ba903a827a056,0xa271245428bb28a8,0x20eba508a8dba87c
.quad 0xa8ada3bf23bf28ad,0x28ad23bfa3bfa8ad,0xa888a8c4a4252390,0x285728e224dca211,0xa11ca876a8c8a40e,0x1bef280928fb2575,0x25b4a0eba87ca8bb,0xa77f0e5c27a12905,0x2906259fa17ea898,0xa8f6a7f2965b276e,0x277f29012534a2d1,0xa454a8e8a81097f2,0x925c27d328f1246b,0x24c5a40ea8e5a809,0xa7c217f2282e28cc,0x290124dca425a8ee
.quad 0x25f328d028d025f3,0xa8d0a8d0a5f30000,0xa390214d2801290f,0x9eb9a75da908a857,0xa8fba6b998c425c9,0x2809211ca40ea876,0xa6cca901a857a2d1,0x289328e8260797f2,0x217ea43da898a8df,0x165b26de29062835,0x28db255f9eb9a7e3,0xa864a27123ee2893,0x2790290f274b18c4,0xa843a8fba61c1bef,0x9eb925b428f4284a,0x1b25a658a905a810
.quad 0xa8ada3bf23bf28ad,0x28ad23bfa3bfa8ad,0xa81fa8f9a58a2088,0x27c2290826309df0,0x18c4a703a90fa6b9,0xa05625c9290327d3,0x28702088a5dea908,0xa8e2a481239028c4,0x286a28bf2301a4f2,0xa6dea90ea6441fe6,0x17f2281028e82454,0x22d1a534a901a77f,0xa82798c4279028fb,0x2903251ea360a8d7,0xa8a8a8649d27273a,0x25de290f2658a0eb
.quad 0x28d025f38000a5f3,0xa5f3000025f328d0,0x26a628f4289324af,0xa8d4a8c4a58a198f,0xa46b205627d3290f,0x925ca66ba8f1a88d,0xa90ea810a0eb2454,0x28c425349df0a77f,0xa301a86aa8f6a644,0x264428f6286a2301,0x275d1b25a607a8f4,0xa58a1df027c2290f,0x28a328c824c5a11c,0xa8e5a876a2a1240e,0x8e5c26f1290e27a1,0x998fa77fa90fa716
.quad 0xa8ada3bf23bf28ad,0x28ad23bfa3bfa8ad,0xa73aa90fa6cc198f,0x26a6290e275d0e5c,0x2360a46ba8d7a85d,0xa51e21e0288d28b6,0x290f267f9df0a83c,0xa8f4a8109b2526f1,0x243d28df28351cc2,0x9cc2a835a8dfa43d,0xa6cc1df0285728c4,0x289320eba607a90e,0xa8c8a8439bef274b,0x270329092575a2a1,0x998fa83ca8c4a211,0xa4af245428f427a1
.quad 0x8000a5f3a8d0a8d0,0x25f328d028d025f3,0x28e8265814c5a5de,0xa7169d27250828a8,0x24c528a328e5261c,0xa827a90da7909f1e,0xa77f9df0253428c4,0x2454a0eba810a90e,0xa835a906a6de965b,0x28df2898243da17e,0x22d1a390a888a8e2,0x9c5d25de28ee2870,0x290928091f1ea575,0xa90da703925c26b9,0x1df028012908267f,0xa088a83ca8f9a5de
.quad 0xa8ada3bf23bf28ad,0x28ad23bfa3bfa8ad,0xa607a905a7e39b25,0x255f28f4282e1eb9,0x266b9d8ca827a8f1,0xa790925c274b290d,0x289328a82271a508,0xa7e3a8fda55f21af,0x9fe62644290e26de,0x24f2a301a8bfa86a,0xa90ea60720eb2893,0x28c428571df0a6cc,0xa1e0a8b6a85d9d8c,0x9f1e26b9290d25c9,0x28571c5da75da8fd,0xa90fa630214d28b1
.quad 0xa8d0a8d0a5f30000,0x28d025f38000a5f3,0x2088a425a870a901,0x2271282e290e27c2,0x2903285d2360a1e0,0xa8c8a5751bef2703,0x97f2260728e82893,0xa2d1a857a901a6cc,0xa90ea76e9cc2259f,0x28bf24f29fe6a7f2,0x9d27a7a1a90fa77f,0x2331287c28e825b4,0x28f125c99d8ca7d3,0xa8b6a46b21e0285d,0x2211287028e22534,0xa390a89ea8c4a481
.quad 0xa8ada3bf23bf28ad,0x28ad23bfa3bfa8ad,0xa4afa8dba864a0eb,0x23ee28bb28932271,0x28431f1ea61ca909,0xa8a3a2a124c528e5,0x2630290c273a97f2,0xa425a8d4a8579f82,0xa76e165b27f228f6,0x2898217ea59fa906,0xa77fa901a53422d1,0x245428e8281017f2,0x261ca11ca8a3a876,0xa88da056266b290f,0x284a28bb21afa607,0xa481a8f9a77f1b25
.quad 0xa5f3000025f328d0,0x8000a5f3a8d0a8d0,0xa7c2a90ea82ea271,0x290128702425a088,0x27031befa575a8c8,0xa1e02360285d2903,0x26cc2901285722d1,0xa893a8e8a60717f2,0xa7f29fe624f228bf,0x259f9cc2a76ea90e,0xa5b4a8e8a87ca331,0x277f290f27a11d27,0x285d21e0a46ba8b6,0xa7d39d8c25c928f1,0x248128c4289e2390,0xa534a8e2a870a211
.quad 0xa8ada3bf23bf28ad,0x28ad23bfa3bfa8ad,0xa271a893a8bba3ee,0x20eb286428db24af,0x28e524c5a2a1a8a3,0xa909a61c1f1e2843,0x1f82285728d42425,0x17f2a73aa90ca630,0xa906a59f217e2898,0x28f627f2165ba76e,0x97f2a810a8e8a454,0xa2d125342901277f,0x290f266ba056a88d,0xa876a8a3a11c261c,0x9b25277f28f92481,0x2607a1afa8bba84a
.quad 0x25f328d028d025f3,0xa8d0a8d0a5f30000,0xa8a8a5081d272716,0x25de94c5a658a8e8,0x9f1ea790a90da827,0x261c28e528a324c5,0x290e281020eba454,0xa8c4a5341df0277f,0xa17e243d289828df,0x965ba6dea906a835,0xa870a8eea5de1c5d,0x28e228882390a2d1,0x26b9925ca703a90d,0xa5751f1e28092909,0x25de28f9283c2088,0xa67fa908a8019df0
.quad 0xa8ada3bf23bf28ad,0x28ad23bfa3bfa8ad,0x9eb9a82ea8f4a55f,0x1b2527e329052607,0x290d274b925ca790,0xa8f1a8279d8c266b,0xa1af255f28fd27e3,0x2508a271a8a8a893,0xa86aa8bfa30124f2,0x26de290e26449fe6,0x26cc9df0a857a8c4,0xa893a0eb2607290e,0x25c9290d26b99f1e,0x9d8ca85da8b6a1e0,0xa8b1a14d2630290f,0x28fd275d9c5da857
.quad 0x28d025f38000a5f3,0xa5f3000025f328d0,0x998f258a28c428d4,0xa4afa893a8f4a6a6,0xa88da8f1a66b925c,0x290f27d32056a46b,0x277f1df0a534a8c4,0xa45420eb2810290e,0x2301286a28f62644,0xa644a8f6a86aa301,0xa90fa7c29df0258a,0x28f426079b25a75d,0x240ea2a1a876a8e5,0xa11c24c528c828a3,0x2716290f277f198f,0xa7a1a90ea6f10e5c
.quad 0xa8ada3bf23bf28ad,0x28ad23bfa3bfa8ad,0x8e5ca75da90ea6a6,0x998f26cc290f273a,0x28b6288d21e0a51e,0xa85da8d7a46b2360,0xa6f11b25281028f4,0x283c1df0a67fa90f,0xa43da8dfa8359cc2,0x1cc2283528df243d,0x290e2607a0eba893,0xa8c4a8579df026cc,0xa2a1257529092703,0x274b9befa843a8c8,0xa7a1a8f4a45424af,0x221128c4283c198f
.quad 0x8000a5f3a8d0a8d0,0x25f328d028d025f3,0x28572908275d1eb9,0xa90fa801a14d2390,0xa876a40e211c2809,0x25c998c4a6b9a8fb,0x17f2a607a8e8a893,0x22d12857290126cc,0x2835290626de165b,0xa8dfa898a43d217e,0xa893a3ee22712864,0x27e31eb9a55fa8db,0x1befa61ca8fba843,0x18c4274b290f2790,0x2810290526589b25,0xa84aa8f4a5b41eb9
.quad 0xa8ada3bf23bf28ad,0x28ad23bfa3bfa8ad,0x1df0a630a908a7c2,0xa088258a28f9281f,0x27d3290325c9a056,0xa6b9a90fa70318c4,0xa8c4a390248128e2,0x290825dea088a870,0x1fe6a644a90ea6de,0xa4f2230128bf286a,0x277f29012534a2d1,0xa454a8e8a81097f2,0xa8d7a360251e2903,0x28fb279098c4a827,0x20eba658a90fa5de,0xa73a1d27286428a8
.quad 0xa8d0a8d0a5f30000,0x28d025f38000a5f3,0x284a2331a1afa810,0xa4811f82277f290a,0x9d8c251e28b628d7,0xa2a1a843a909a74b,0xa6cca901a857a2d1,0x289328e8260797f2,0x290e276e1cc2a59f,0xa8bfa4f21fe627f2,0xa630198f273a290e,0x2425a211a857a8f9,0xa056a827a903a66b,0x2360288d28d7251e,0x287c28db2508a0eb,0xa8a8a8bba4542271
.quad 0xa8ada3bf23bf28ad,0x28ad23bfa3bfa8ad,0x2211a4dca8e2a857,0xa390242528c42888,0x257528fb28091bef,0xa40ea8c8a876a11c,0xa905a7a18e5c277f,0x28bb287c20eba5b4,0x276e965ba7f2a8f6,0xa898a17e259f2906,0x17f2281028e82454,0x22d1a534a901a77f,0xa809a8e5a40e24c5,0x246b28f127d3925c,0x28ee2425a4dca901,0xa8cca82e97f227c2
.quad 0xa5f3000025f328d0,0x8000a5f3a8d0a8d0,0x9b25a6cca8f9a888,0x260728db28bb255f,0x274b2909284322a1,0xa8d7a8b6a51e1d8c,0xa90ea810a0eb2454,0x28c425349df0a77f,0x27f21fe6a4f2a8bf,0xa59f1cc2276e290e,0x9f82253428d4289e,0x97f2a716a90ca801,0xa51ea8d7a88da360,0x266b290328272056,0x28cc28932331a3ee,0xa8e8a864a1af24af
.quad 0xa8ada3bf23bf28ad,0x28ad23bfa3bfa8ad,0x2481a2d1a89ea8b1,0xa534214d287028d4,0x211c287628c8240e,0x9befa809a8fba575,0xa82ea8e8a4af2331,0x26cc290f26a69d27,0x2906259fa17ea898,0xa8f6a7f2965b276e,0xa6cc1df0285728c4,0x289320eba607a90e,0x125ca7d3a8f1a46b,0xa4c5240e28e52809,0x267f290e25b4a271,0x9df0a870a89ea088
.quad 0x25f328d028d025f3,0xa8d0a8d0a5f30000,0xa8b1a8e2a6308e5c,0x28fd26f11c5da534,0x28fb26b918c4a5c9,0xa809a11c240e2876,0xa77f9df0253428c4,0x2454a0eba810a90e,0x217ea43da898a8df,0x165b26de29062835,0x21af284a28fd2658,0xa508a8cca8a8a454,0xa790a90fa74b98c4,0x284328fb261c9bef,0x28fd282e2025a55f,0xa90aa7e39d272607
.quad 0xa8ada3bf23bf28ad,0x28ad23bfa3bfa8ad,0x25de9f82a83ca8ee,0xa67f1c5d28012901,0x98c42703290f26b9,0x2056a5c9a903a7d3,0xa4dca8eea81f9c5d,0x214d288828b122d1,0x286a28bf2301a4f2,0xa6dea90ea6441fe6,0xa90ea60720eb2893,0x28c428571df0a6cc,0x282718c4a790a8fb,0xa903a51e236028d7,0xa3ee250829052716,0x281f14c5a7e3a8e8
.quad 0x28d025f38000a5f3,0xa5f3000025f328d0,0xa7a1a0252454287c,0x2211a2d1a83ca90c,0x246ba056a7d3a90f,0x125c266b28f1288d,0x97f2260728e82893,0xa2d1a857a901a6cc,0xa301a86aa8f6a644,0x264428f6286a2301,0x26f1290a28102025,0xa83ca901a67f14c5,0xa8a3a8c8a4c5211c,0x28e5287622a1a40e,0x290f275d17f2a6a6,0xa90ca6cc14c5273a
.quad 0xa8ada3bf23bf28ad,0x28ad23bfa3bfa8ad,0x271694c5a77fa90c,0xa7a197f226f1290f,0xa360246b28d7285d,0x251ea1e0a88da8b6,0x94c5a7c2a901a58a,0xa0252607290a275d,0x243d28df28351cc2,0x9cc2a835a8dfa43d,0xa77fa901a53422d1,0x245428e8281017f2,0x28c828431befa74b,0xa703a909a57522a1,0xa90ca58a22d128d4,0x287c28932025a6a6
.quad 0x8000a5f3a8d0a8d0,0x25f328d028d025f3,0x20eb27e3290f281f,0xa73aa905a864a3ee,0xa4c5a8a3a8e5a61c,0x2827290d27901f1e,0x26cc2901285722d1,0xa893a8e8a60717f2,0xa835a906a6de965b,0x28df2898243da17e,0x28c428b12481a14d,0xa908a81fa08824dc,0xa909a8099f1e2575,0x290d2703125ca6b9,0x290126309c5da7c2,0xa8eea58a1f82281f
.quad 0xa8ada3bf23bf28ad,0x28ad23bfa3bfa8ad,0x28101d27a658a90a,0xa84aa02525b428fd,0xa66b1d8c282728f1,0x2790125ca74ba90d,0x2454a3eea8cca864,0xa6581eb9284a28db,0x9fe62644290e26de,0x24f2a301a8bfa86a,0x97f2a810a8e8a454,0xa2d125342901277f,0x21e028b6285d1d8c,0x1f1ea6b9a90da5c9,0xa534a908a6f11eb9,0x8e5c280128e22390
.quad 0xa8d0a8d0a5f30000,0x28d025f38000a5f3,0x28ee289e24dc9df0,0xa8cca5b417f2267f,0xa903a85da36021e0,0x28c825759befa703,0x290e281020eba454,0xa8c4a5341df0277f,0xa90ea76e9cc2259f,0x28bf24f29fe6a7f2,0x290526a68e5ca6cc,0xa8bba4af20eb282e,0xa8f1a5c91d8c27d3,0x28b6246ba1e0a85d,0x28d424dca14da857,0xa8b1a42522d12888
.quad 0xa8ada3bf23bf28ad,0x28ad23bfa3bfa8ad,0x287c21afa508a8e8,0xa8a8a331245428cc,0xa8439f1e261c2909,0x28a322a1a4c5a8e5,0x2801198fa716a90e,0xa89ea211253428f9,0xa76e165b27f228f6,0x2898217ea59fa906,0x26cc9df0a857a8c4,0xa893a0eb2607290e,0xa61c211c28a32876,0x288d2056a66ba90f,0x255fa331a8dba810,0xa8889f8226cc290a
.quad 0x28d028d025f30000,0xa8d0a5f3000025f3,0x28b628df261c0000,0xa8fba6de9bef254a,0x289828eb26440000,0xa90ea7b29fe62498,0x287628f6266b0000,0xa909a835a1e023bf,0x285028ff26920000,0xa8eba882a3bf2241,0x2827290626b90000,0xa8b6a8bfa4c520b9,0x27f2290b26de0000,0xa86aa8eba59f1e55,0x2790290e27030000,0xa809a906a66b1a5a
.quad 0x2728290f27280000,0xa728a90fa7280000,0x26b9290e274b0000,0xa61ca906a7d39a5a,0x2644290b276e0000,0xa4f2a8eba8359e55,0x25c9290627900000,0xa360a8bfa876a0b9,0x254a28ff27b20000,0xa0b9a882a8ada241,0x24c528f627d30000,0x9befa835a8d7a3bf,0x243d28eb27f20000,0x165ba7b2a8f6a498,0x236028df28090000,0x1f1ea6dea909a54a
.quad 0x25f30000a5f3a8d0,0x25f328d028d0,0x27901fe6a46ba882,0xa1e023012843290b,0x286a23bfa17ea818,0xa59f1a5a26de28ff,0x28d7259f9befa728,0xa7d39fe624c528ad,0x290b27281a5aa5f3,0xa8ada49820b92818,0x29032835211ca498,0xa909a6de925c2692,0x28bf28ad243da241,0xa8f6a850a17e2498,0x284328f625c99e55,0xa876a8dfa51e20b9
.quad 0x2728290f27280000,0xa728a90fa7280000,0x257528f628271e55,0xa4c5a8dfa85da0b9,0x230128ad28982241,0x9fe6a850a8dfa498,0x1d8c283528e52498,0x1befa6dea90fa692,0x9a5a2728290b25f3,0x23bfa498a8eba818,0xa1e0259f29092728,0x266b9fe6a876a8ad,0xa4f223bf28df2818,0x28351a5aa76ea8ff,0xa6b91fe6288d2882,0x28d72301a575a90b
.quad 0xa5f3a8d0a8d0a5f3,0x28d028d025f30000,0xa11ca7f2a90fa818,0x274b2906285d23bf,0x1cc2a54aa8bfa8d0,0x2301285029062728,0x24c59fe6a7d3a90f,0x9bef259f28d728ad,0x27b21e55a54aa8d0,0xa54a1e5527b2290f,0x28c824f2a056a818,0xa843a17e246b28ad,0x290e27b21cc2a5f3,0xa906a692165b2728,0x28a328bf246ba241,0xa8c8a898a36023bf
.quad 0x2728290f27280000,0xa728a90fa7280000,0x240e28bf288d2241,0xa2a1a898a8b6a3bf,0x165b27b2290625f3,0x1cc2a692a90ea728,0xa2a124f228f12818,0x2575a17ea88da8ad,0xa6921e55285028d0,0x28501e55a692a90f,0xa8769fe6266b290f,0x2909259fa1e0a8ad,0xa906a54a230128d0,0x28bf28501cc2a728,0xa8e5a7f2125c2818,0x27032906251ea3bf
.quad 0xa8d0a5f3000025f3,0x25f30000a5f3a8d0,0xa8f1a898a4c51e55,0x28c8259f98c4a692,0xa76ea90ba835a241,0x28df28ad24f29e55,0xa1e0a835a909a728,0x266b28f6287623bf,0x20b9a498a8ada8d0,0x1a5a2728290b2818,0x2703165ba66ba8ff,0xa51e1fe62809290b,0x28df254a9fe6a818,0xa898a3bf23012882,0x28e5286a21e0a498,0xa8fba835a056254a
.quad 0x2728290f27280000,0xa728a90fa7280000,0x211c286a28d72498,0x9f1ea835a8f1a54a,0xa17e254a28f62818,0x243da3bfa8bfa882,0xa74b165b27d328ff,0x285d1fe6a61ca90b,0xa8eba49823bf28d0,0x290b27289a5aa818,0xa8d7a8359bef2728,0x27d328f624c5a3bf,0xa6dea90ba59f2241,0x217e28ad286a1e55,0xa056a898a8769e55,0xa2a1259f290d2692
.quad 0x25f328d028d0,0xa5f3a8d0a8d0a5f3,0xa66b965b25c928d0,0x1d8ca4f2a8a3a8eb,0xa8f6a692965b25f3,0x27f220b9a43da882,0xa876a8f6a66b0000,0x2909283521e0a3bf,0xa3bfa882a8eba5f3,0x269228ff28502241,0x21e0a43da8a3a8d0,0x98c4264428fb2850,0x283520b9a4f2a8d0,0xa76e9a5a264428ff,0x290927f21d8ca5f3,0xa90fa76e98c42692
.quad 0x2728290f27280000,0xa728a90fa7280000,0x1bef27f2290325f3,0x925ca76ea90da692,0xa59f20b9286a28d0,0x26de9a5aa7f2a8ff,0xa8d7a43d240e28d0,0x290d26449f1ea850,0xa8ada882a0b925f3,0x27b228ff254aa241,0xa4c5a8f6a7d30000,0x1bef283528d723bf,0x1fe6a692a90ea5f3,0xa64420b928982882,0x27d3965ba827a8d0,0xa903a4f2240e28eb
.quad 0x28d028d025f30000,0xa8d0a5f3000025f3,0x240e286a29032728,0xa827a90ea7d3a0b9,0xa43d20b927f2290f,0x965ba692a8f6a882,0xa8d7a59f1bef2728,0x27d31fe6a4c5a8ad,0xa850a8ffa6920000,0x28eb288223bfa241,0x9f1ea7f2a90da728,0x240e289828d7254a,0x26449a5aa76ea90f,0xa4f220b9283528ff,0x290d26de925ca728,0xa903a6441bef27b2
.quad 0x2728290f27280000,0xa728a90fa7280000,0x98c426de290f2728,0x1d8ca644a909a7b2,0xa7f29a5a26de290f,0x286a20b9a59fa8ff,0xa8fba7f298c42728,0x28a3289821e0a54a,0xa54aa8ffa7b20000,0x20b9288228ad2241,0x21e0a59fa909a728,0xa66b1fe6287628ad,0x289820b9a644a90f,0xa90ea6921fe62882,0x28a3286a1d8ca728,0xa5c9a90ea66b20b9
.quad 0x25f30000a5f3a8d0,0x25f328d028d0,0x290d283522a1a241,0xa876a43d205627b2,0x24f228ad28df25f3,0xa835a90ba76e9e55,0xa4c51fe627d3290f,0x1befa59fa8d7a8ad,0xa90ba7289a5a25f3,0x28ad2498a0b9a818,0xa61ca8f6a85da241,0x27d3290e274b1a5a,0x2301a3bfa898a8d0,0x9fe6254a28df2882,0x28f1259f9f1ea818,0xa8d7a4f2211c2850
.quad 0x2728290f27280000,0xa728a90fa7280000,0xa056259f28fb2818,0x21e0a4f2a8e5a850,0xa8bfa3bf243d28d0,0x28f6254aa17ea882,0xa809a8f6a51e2241,0x266b290e27039a5a,0x1a5aa728a90ba5f3,0xa3bf249828eb2818,0x28761fe6a66ba90f,0xa909a59f21e028ad,0x286a28ad217ea5f3,0xa59fa90ba6de1e55,0x18c4283528c82241,0x24c5a43da8f1a7b2
.quad 0xa5f3a8d0a8d0a5f3,0x28d028d025f30000,0x251e9cc2a703a8ff,0x125c264428e528ad,0x290628502301a241,0xa8bfa54a1cc22728,0x21e0283529092728,0xa66ba8f6a876a3bf,0xa7b29e55254a28d0,0x254a9e55a7b2a90f,0xa88da8dfa5751e55,0x28f1286a22a1a3bf,0x165ba692a906a818,0x1cc227b2290e2728,0x28b6243da2a1a882,0xa88da301240e28ad
.quad 0x2728290f27280000,0xa728a90fa7280000,0xa360243d28c82882,0x246ba301a8a3a8ad,0xa90ea6921cc22818,0x290627b2165ba728,0xa46ba8dfa8439e55,0x2056286a28c823bf,0x26929e55a850a8d0,0xa8509e552692290f,0x28d728351befa728,0xa7d3a8f6a4c523bf,0x1cc2285028bf2241,0x2301a54aa906a728,0xa85d9cc2274b28ff,0x290f2644a11ca8ad
.quad 0xa8d0a5f3000025f3,0x25f30000a5f3a8d0,0xa575a8bfa8d7a5f3,0x288d28f626b91a5a,0x26de1a5aa59fa8d0,0xa17e23bf286a28ff,0x287628f6266b0000,0xa909a835a1e023bf,0xa0b9249828ad28d0,0x9a5aa728a90ba818,0xa90fa76e9bef25f3,0x28e5259f9d8ca7b2,0xa17ea850a8f6a5f3,0x243d28ad28bf2498,0x285d217ea4c5a8d0,0xa8279fe6257528eb
.quad 0x2728290f27280000,0xa728a90fa7280000,0xa51e217e287628d0,0x25c99fe6a843a8eb,0xa8dfa8509fe625f3,0x289828ad2301a498,0x125ca76ea909a5f3,0xa11c259f290327b2,0x28eb2498a3bfa8d0,0xa90ba7281a5a2818,0x24c528f627d30000,0x9befa835a8d7a3bf,0xa76e1a5a283528d0,0x28df23bfa4f2a8ff,0xa843a8bfa1e025f3,0x246b28f627909a5a
.quad 0x25f328d028d0,0xa5f3a8d0a8d0a5f3,0xa909a76e9f1e2498,0x2809217ea360a850,0x9fe6a7b2a90ea818,0x264428eb28982498,0x28d7259f9befa728,0xa7d39fe624c528ad,0x23bf288228eb25f3,0xa692a8ffa850a241,0xa876a30123602882,0x27901cc2a5c9a8eb,0xa59fa8eba86aa241,0x26de290b27f21e55,0x27d31cc2a61ca8ff,0xa74b965b26b9290b
.quad 0x2728290f27280000,0xa728a90fa7280000,0xa66b1cc2280928ff,0x2703965ba790a90b,0xa835a8eba4f22241,0x276e290b26449e55,0x24c5a301a8b6a882,0xa6b91cc2282728eb,0x28ad288220b9a5f3,0xa7b2a8ffa54a2241,0xa1e0259f29092728,0x266b9fe6a876a8ad,0xa8f6a7b2165b2818,0x27f228eb243da498,0x1befa76ea8fba498,0xa61c217e28b62850
.quad 0x28d028d025f30000,0xa8d0a5f3000025f3,0xa360217e2809290f,0x9f1ea76ea909a850,0xa898a8eba6440000,0x290e27b21fe6a498,0x24c59fe6a7d3a90f,0x9bef259f28d728ad,0x285028ff26920000,0xa8eba882a3bf2241,0xa5c91cc22790290f,0x2360a301a876a8eb,0xa7f2a90ba6de0000,0x286a28eb259f9e55,0x26b9965ba74ba90f,0xa61c1cc227d3290b
.quad 0x2728290f27280000,0xa728a90fa7280000,0xa790965b2703290f,0x28091cc2a66ba90b,0xa644a90ba76e0000,0x24f228eb28351e55,0x28271cc2a6b9a90f,0xa8b6a30124c528eb,0x254a28ff27b20000,0xa0b9a882a8ada241,0xa8769fe6266b290f,0x2909259fa1e0a8ad,0xa43da8eba7f20000,0x965b27b228f62498,0x28b6217ea61ca90f,0xa8fba76e1bef2850
.quad 0x25f30000a5f3a8d0,0x25f328d028d0,0x26b928f6288d2498,0xa8d7a8bfa5751a5a,0xa86aa3bf217e2818,0x259f9a5aa6dea8ff,0xa1e0a835a909a728,0x266b28f6287623bf,0x290b27281a5aa5f3,0xa8ada49820b92818,0x9d8c259f28e52882,0x9befa76ea90fa7b2,0xa8bfa8ada43d2241,0x28f62850217ea498,0x25759fe6a827a8ff,0xa4c5217e285d28eb
.quad 0x2728290f27280000,0xa728a90fa7280000,0xa8439fe625c928ff,0x2876217ea51ea8eb,0xa301a8ada898a241,0x1fe6285028df2498,0x2903259fa11ca882,0xa909a76e125c27b2,0x9a5a2728290b25f3,0x23bfa498a8eba818,0xa8d7a8359bef2728,0x27d328f624c5a3bf,0x24f2a3bfa8dfa818,0xa8359a5a276e28ff,0x279028f6246ba498,0xa1e0a8bfa8439a5a
.quad 0xa5f3a8d0a8d0a5f3,0x28d028d025f30000,0x28e52644125ca5f3,0xa7039cc2251e28ad,0x9cc2254a28bf28d0,0xa301a850a906a728,0xa876a8f6a66b0000,0x2909283521e0a3bf,0x27b21e55a54aa8d0,0xa54a1e5527b2290f,0x22a1286a28f125f3,0xa575a8dfa88da3bf,0xa90ea7b29cc225f3,0x29062692965ba728,0x240ea301a88da8d0,0xa2a1243d28b628ad
.quad 0x2728290f27280000,0xa728a90fa7280000,0xa8a3a301246b28d0,0x28c8243da360a8ad,0x965ba7b2a906a5f3,0x9cc22692290e2728,0x28c8286a2056a5f3,0xa843a8dfa46b23bf,0xa6921e55285028d0,0x28501e55a692a90f,0xa4c5a8f6a7d30000,0x1bef283528d723bf,0x2906254aa301a8d0,0xa8bfa8509cc22728,0xa11c2644290f25f3,0x274b9cc2a85da8ad
.quad 0xa8d0a5f3000025f3,0x25f30000a5f3a8d0,0x2056a43da876a8ff,0x22a12835290d27b2,0x276e290b28352241,0xa8dfa8ada4f21e55,0xa8d7a59f1bef2728,0x27d31fe6a4c5a8ad,0x20b9a498a8ada8d0,0x1a5a2728290b2818,0x274b290e27d31e55,0xa85da8f6a61c1a5a,0xa8dfa54a1fe62818,0x289823bfa301a882,0x211ca4f2a8d7a882,0x9f1e259f28f12850
.quad 0x2728290f27280000,0xa728a90fa7280000,0xa8e5a4f221e02882,0x28fb259fa056a850,0x217ea54aa8f6a818,0xa43d23bf28bf2882,0x2703290e266b9e55,0xa51ea8f6a8099a5a,0xa8eba49823bf28d0,0x290b27289a5aa818,0x21e0a59fa909a728,0xa66b1fe6287628ad,0x26de290b259fa241,0xa17ea8ada86a9e55,0xa8f1a43d24c528ff,0x28c8283518c4a7b2
.quad 0x25f328d028d0,0xa5f3a8d0a8d0a5f3,0xa7d3a90ea827a241,0x2903286a240ea0b9,0x28f62692165ba5f3,0xa7f2a0b9243d2882,0xa4c51fe627d3290f,0x1befa59fa8d7a8ad,0xa3bfa882a8eba5f3,0x269228ff28502241,0x28d72898240ea241,0xa90da7f29f1e254a,0xa835a0b924f228d0,0x276e1a5aa644a8ff,0x1befa644a903a818,0x925c26de290d27b2
.quad 0x2728290f27280000,0xa728a90fa7280000,0xa909a6441d8c2818,0x290f26de98c4a7b2,0x259fa0b9a86aa8d0,0xa6de1a5a27f228ff,0x21e0289828a32241,0x98c4a7f2a8fba54a,0xa8ada882a0b925f3,0x27b228ff254aa241,0x28761fe6a66ba90f,0xa909a59f21e028ad,0x9fe62692290e25f3,0x2644a0b9a898a882,0xa66ba90ea5c92241,0x1d8c286a28a320b9
.quad 0x28d028d025f30000,0xa8d0a5f3000025f3,0xa8a3a4f21d8c2728,0x25c9965ba66ba8eb,0x243da0b9a7f2a90f,0x165b269228f62882,0x21e0283529092728,0xa66ba8f6a876a3bf,0xa850a8ffa6920000,0x28eb288223bfa241,0x28fb264498c4a728,0xa8a3a43d21e02850,0xa6441a5a276e290f,0x24f2a0b9a835a8ff,0x98c4a76ea90fa728,0x1d8c27f229092692
.quad 0x2728290f27280000,0xa728a90fa7280000,0xa90da76e925c2728,0x290327f21befa692,0x27f21a5aa6dea90f,0xa86aa0b9259f28ff,0x9f1e2644290d2728,0x240ea43da8d7a850,0xa54aa8ffa7b20000,0x20b9288228ad2241,0x28d728351befa728,0xa7d3a8f6a4c523bf,0xa898a0b92644290f,0x290e26929fe6a882,0x240ea4f2a903a728,0xa827965b27d328eb
.quad 0x25f30000a5f3a8d0,0x25f328d028d0,0x98c4259f28c828d0,0xa4c5a898a8f1a692,0xa4f2a8ada8dfa5f3,0x2835290b276e1e55,0x287628f6266b0000,0xa909a835a1e023bf,0xa90ba7289a5a25f3,0x28ad2498a0b9a818,0x28091fe6a51ea8d0,0xa66b165b2703290b,0xa30123bf289828d0,0x1fe6a54aa8dfa882,0xa056a835a8fba5f3,0x21e0286a28e5254a
.quad 0x2728290f27280000,0xa728a90fa7280000,0xa8f1a8359f1e25f3,0x28d7286a211ca54a,0x28bf23bfa43da8d0,0xa8f6a54a217e2882,0xa61c1fe6285d28d0,0x27d3165ba74ba90b,0x1a5aa728a90ba5f3,0xa3bf249828eb2818,0x24c528f627d30000,0x9befa835a8d7a3bf,0xa86aa8ada17e25f3,0x259f290b26de9e55,0x290d259fa2a1a8d0,0xa876a898a0562692
.quad 0xa5f3a8d0a8d0a5f3,0x28d028d025f30000,0x285d2906274b1e55,0xa90fa7f2a11c23bf,0xa906a850a3012241,0x28bf254a9cc2a728,0x28d7259f9befa728,0xa7d39fe624c528ad,0xa7b29e55254a28d0,0x254a9e55a7b2a90f,0x246ba17ea843a8ff,0xa05624f228c828ad,0x965b269229062818,0x9cc2a7b2a90ea728,0xa360a898a8c8a498,0x246b28bf28a323bf
.quad 0x2728290f27280000,0xa728a90fa7280000,0xa8b6a898a2a12498,0x288d28bf240ea3bf,0x290e26929cc2a818,0xa906a7b2965b2728,0xa88da17e257528ff,0x28f124f2a2a1a8ad,0x26929e55a850a8d0,0xa8509e552692290f,0xa1e0259f29092728,0x266b9fe6a876a8ad,0x9cc2a850a8bfa241,0xa301254a29062728,0x251e290627039e55,0x125ca7f2a8e5a3bf
.quad 0xa8d0a5f3000025f3,0x25f30000a5f3a8d0,0x28432301a1e0a818,0xa46b1fe62790290b,0xa6de9a5a259f28d0,0x217ea3bfa86aa8ff,0x24c59fe6a7d3a90f,0x9bef259f28d728ad,0xa0b9249828ad28d0,0x9a5aa728a90ba818,0x925ca6dea909a818,0x211c283529032692,0x217e285028f625f3,0xa43da8ada8bfa498,0xa51ea8dfa876a241,0x25c928f6284320b9
.quad 0x2728290f27280000,0xa728a90fa7280000,0xa85da8dfa4c52241,0x282728f62575a0b9,0x28df28501fe6a5f3,0xa898a8ada3012498,0xa90fa6de1bef2818,0x28e528351d8ca692,0x28eb2498a3bfa8d0,0xa90ba7281a5a2818,0xa8769fe6266b290f,0x2909259fa1e0a8ad,0x276e9a5aa835a8d0,0xa8dfa3bf24f228ff,0xa575230128d72818,0x288d1fe6a6b9a90b
.quad 0x25f328d028d0,0xa5f3a8d0a8d0a5f3,0x9befa6dea8fba882,0x261c28df28b6254a,0x1fe627b2290e2818,0xa644a8eba898a498,0xa1e0a835a909a728,0x266b28f6287623bf,0x23bf288228eb25f3,0xa692a8ffa850a241,0xa4c5a8bfa8b6a498,0x26b92906282720b9,0x259f28eb286a2241,0xa6dea90ba7f29e55,0xa66ba906a8099e55,0x2703290e27901a5a
.quad 0x2728290f27280000,0xa728a90fa7280000,0xa7d3a906a61c1e55,0x274b290e26b99a5a,0x283528eb24f2a241,0xa76ea90ba6441e55,0xa876a8bfa3602498,0x2790290625c9a0b9,0x28ad288220b9a5f3,0xa7b2a8ffa54a2241,0xa8d7a8359bef2728,0x27d328f624c5a3bf,0x28f627b2965ba818,0xa7f2a8eba43d2498,0xa909a6de1f1e2882,0x280928df2360a54a
.quad 0x2818290f28182241,0xa90fa818a2412241,0x27c2290e282e2271,0xa901a870a4252088,0x274b2909284322a1,0xa8d7a8b6a51e1d8c,0x26cc2901285722d1,0xa893a8e8a60717f2,0x264428f6286a2301,0xa835a906a6de965b,0x25b428e8287c2331,0xa77fa90fa7a19d27,0x251e28d7288d2360,0xa66ba903a827a056,0x248128c4289e2390,0xa534a8e2a870a211
.quad 0x23bf28ad28ad23bf,0xa3bfa8ada8ada3bf,0x2271289328bb23ee,0xa0eba864a8dba4af,0x211c287628c8240e,0x9befa809a8fba575,0x1f82285728d42425,0x17f2a73aa90ca630,0x1cc2283528df243d,0x1fe6a644a90ea6de,0x17f2281028e82454,0x22d1a534a901a77f,0x925c27d328f1246b,0x24c5a40ea8e5a809,0x9b25277f28f92481,0x2607a1afa8bba84a
.quad 0x28182241a241a818,0xa24122412818290f,0x28a825089d27a716,0xa5de14c5265828e8,0x28fb26b918c4a5c9,0xa809a11c240e2876,0x290e281020eba454,0xa8c4a5341df0277f,0x28df2898243da17e,0xa90ea76e9cc2259f,0x287028ee25de9c5d,0xa8e2a888a39022d1,0x2790290f274b18c4,0xa843a8fba61c1bef,0x25de28f9283c2088,0xa67fa908a8019df0
.quad 0x23bf28ad28ad23bf,0xa3bfa8ada8ada3bf,0x1eb9282e28f4255f,0x9b25a7e3a905a607,0x98c42703290f26b9,0x2056a5c9a903a7d3,0xa1af255f28fd27e3,0x2508a271a8a8a893,0xa4f2230128bf286a,0x276e965ba7f2a8f6,0xa6cc1df0285728c4,0x289320eba607a90e,0xa82798c4279028fb,0x2903251ea360a8d7,0xa8b1a14d2630290f,0x28fd275d9c5da857
.quad 0xa241a818a90fa818,0x2818290f28182241,0x198fa58aa8c4a8d4,0x24af289328f426a6,0x246ba056a7d3a90f,0x125c266b28f1288d,0x277f1df0a534a8c4,0xa45420eb2810290e,0x28bf24f29fe6a7f2,0xa7f29fe624f228bf,0x290f27c21df0a58a,0xa8f4a6071b25275d,0x28a328c824c5a11c,0xa8e5a876a2a1240e,0x2716290f277f198f,0xa7a1a90ea6f10e5c
.quad 0x23bf28ad28ad23bf,0xa3bfa8ada8ada3bf,0xe5c275d290e26a6,0x198fa6cca90fa73a,0xa360246b28d7285d,0x251ea1e0a88da8b6,0xa6f11b25281028f4,0x283c1df0a67fa90f,0xa898a17e259f2906,0x2906259fa17ea898,0xa90ea60720eb2893,0x28c428571df0a6cc,0xa8c8a8439bef274b,0x270329092575a2a1,0xa7a1a8f4a45424af,0x221128c4283c198f
.quad 0xa90fa818a2412241,0x28182241a241a818,0xa857a908a75d9eb9,0x290f2801214da390,0xa4c5a8a3a8e5a61c,0x2827290d27901f1e,0x17f2a607a8e8a893,0x22d12857290126cc,0x259f9cc2a76ea90e,0xa17e243d289828df,0x289323eea271a864,0xa7e39eb9255f28db,0x290928091f1ea575,0xa90da703925c26b9,0x2810290526589b25,0xa84aa8f4a5b41eb9
.quad 0x23bf28ad28ad23bf,0xa3bfa8ada8ada3bf,0x9df02630290827c2,0x2088a58aa8f9a81f,0xa66b1d8c282728f1,0x2790125ca74ba90d,0xa8c4a390248128e2,0x290825dea088a870,0xa8f6a7f2965b276e,0x286a28bf2301a4f2,0xa77fa901a53422d1,0x245428e8281017f2,0xa1e0a8b6a85d9d8c,0x9f1e26b9290d25c9,0x20eba658a90fa5de,0xa73a1d27286428a8
.quad 0xa24122412818290f,0xa241a818a90fa818,0xa84aa33121af2810,0x24819f82a77fa90a,0xa903a85da36021e0,0x28c825759befa703,0xa6cca901a857a2d1,0x289328e8260797f2,0x965ba6dea906a835,0x2301286a28f62644,0x2630998fa73aa90e,0xa4252211285728f9,0x28f125c99d8ca7d3,0xa8b6a46b21e0285d,0x287c28db2508a0eb,0xa8a8a8bba4542271
.quad 0x23bf28ad28ad23bf,0xa3bfa8ada8ada3bf,0xa21124dc28e22857,0x2390a425a8c4a888,0xa8439f1e261c2909,0x28a322a1a4c5a8e5,0xa905a7a18e5c277f,0x28bb287c20eba5b4,0xa6dea90ea6441fe6,0x243d28df28351cc2,0x97f2a810a8e8a454,0xa2d125342901277f,0x261ca11ca8a3a876,0xa88da056266b290f,0x28ee2425a4dca901,0xa8cca82e97f227c2
.quad 0x2818290f28182241,0xa90fa818a2412241,0x1b2526cc28f92888,0xa607a8dba8bba55f,0xa7039bef257528c8,0x21e0a360a85da903,0xa90ea810a0eb2454,0x28c425349df0a77f,0xa644a8f6a86aa301,0x2835290626de165b,0x1f82a534a8d4a89e,0x17f22716290c2801,0x285d21e0a46ba8b6,0xa7d39d8c25c928f1,0x28cc28932331a3ee,0xa8e8a864a1af24af
.quad 0x23bf28ad28ad23bf,0xa3bfa8ada8ada3bf,0xa48122d1289e28b1,0x2534a14da870a8d4,0xa8e5a4c522a128a3,0x2909261c9f1ea843,0xa82ea8e8a4af2331,0x26cc290f26a69d27,0x9cc2a835a8dfa43d,0x9fe62644290e26de,0x26cc9df0a857a8c4,0xa893a0eb2607290e,0x290f266ba056a88d,0xa876a8a3a11c261c,0x267f290e25b4a271,0x9df0a870a89ea088
.quad 0x28182241a241a818,0xa24122412818290f,0x28b128e226300e5c,0xa8fda6f19c5d2534,0x1f1e2790290d2827,0xa61ca8e5a8a3a4c5,0xa77f9df0253428c4,0x2454a0eba810a90e,0xa8dfa898a43d217e,0x290e276e1cc2a59f,0xa1afa84aa8fda658,0x250828cc28a82454,0x26b9925ca703a90d,0xa5751f1e28092909,0x28fd282e2025a55f,0xa90aa7e39d272607
.quad 0x23bf28ad28ad23bf,0xa3bfa8ada8ada3bf,0xa5de1f82283c28ee,0x267f9c5da801a901,0xa90da74b125c2790,0x28f128271d8ca66b,0xa4dca8eea81f9c5d,0x214d288828b122d1,0x24f2a301a8bfa86a,0xa76e165b27f228f6,0x290e2607a0eba893,0xa8c4a8579df026cc,0x25c9290d26b99f1e,0x9d8ca85da8b6a1e0,0xa3ee250829052716,0x281f14c5a7e3a8e8
.quad 0xa241a818a90fa818,0x2818290f28182241,0x27a12025a454a87c,0xa21122d1283c290c,0x288d28f1266b125c,0xa90fa7d3a056246b,0x97f2260728e82893,0xa2d1a857a901a6cc,0xa8bfa4f21fe627f2,0x27f21fe6a4f2a8bf,0xa6f1a90aa810a025,0x283c2901267f94c5,0x240ea2a1a876a8e5,0xa11c24c528c828a3,0x290f275d17f2a6a6,0xa90ca6cc14c5273a
.quad 0x23bf28ad28ad23bf,0xa3bfa8ada8ada3bf,0xa71614c5277f290c,0x27a117f2a6f1a90f,0xa8b6a88da1e0251e,0x285d28d7246ba360,0x94c5a7c2a901a58a,0xa0252607290a275d,0x2898217ea59fa906,0xa906a59f217e2898,0x277f29012534a2d1,0xa454a8e8a81097f2,0xa2a1257529092703,0x274b9befa843a8c8,0xa90ca58a22d128d4,0x287c28932025a6a6
.quad 0xa90fa818a2412241,0x28182241a241a818,0xa0eba7e3a90fa81f,0x273a2905286423ee,0x2876240ea11ca809,0xa5c918c426b928fb,0x26cc2901285722d1,0xa893a8e8a60717f2,0xa59f1cc2276e290e,0x217ea43da898a8df,0xa8c4a8b1a481214d,0x2908281f2088a4dc,0x1befa61ca8fba843,0x18c4274b290f2790,0x290126309c5da7c2,0xa8eea58a1f82281f
.quad 0x23bf28ad28ad23bf,0xa3bfa8ada8ada3bf,0xa8109d272658290a,0x284a2025a5b4a8fd,0xa7d3a903a5c92056,0x26b9290f270398c4,0x2454a3eea8cca864,0xa6581eb9284a28db,0x28f627f2165ba76e,0xa86aa8bfa30124f2,0x17f2281028e82454,0x22d1a534a901a77f,0xa8d7a360251e2903,0x28fb279098c4a827,0xa534a908a6f11eb9,0x8e5c280128e22390
.quad 0xa24122412818290f,0xa241a818a90fa818,0xa8eea89ea4dc1df0,0x28cc25b497f2a67f,0x1d8ca51ea8b6a8d7,0x22a128432909274b,0x290e281020eba454,0xa8c4a5341df0277f,0x165b26de29062835,0xa301a86aa8f6a644,0xa905a6a60e5c26cc,0x28bb24afa0eba82e,0xa056a827a903a66b,0x2360288d28d7251e,0x28d424dca14da857,0xa8b1a42522d12888
.quad 0x23bf28ad28ad23bf,0xa3bfa8ada8ada3bf,0xa87ca1af250828e8,0x28a82331a454a8cc,0xa575a8fba8099bef,0x240e28c82876211c,0x2801198fa716a90e,0xa89ea211253428f9,0x26de290e26449fe6,0xa43da8dfa8359cc2,0xa6cc1df0285728c4,0x289320eba607a90e,0xa809a8e5a40e24c5,0x246b28f127d3925c,0x255fa331a8dba810,0xa8889f8226cc290a
.quad 0x2818290f28182241,0xa90fa818a2412241,0xa67f97f225b428cc,0x1df0a4dca89ea8ee,0xa74ba909a843a2a1,0x28d728b6251e9d8c,0x277f1df0a534a8c4,0xa45420eb2810290e,0x264428f6286a2301,0xa835a906a6de965b,0xa82ea0eb24af28bb,0x26cc0e5ca6a6a905,0xa51ea8d7a88da360,0x266b290328272056,0x288822d1a425a8b1,0xa857a14d24dc28d4
.quad 0x23bf28ad28ad23bf,0xa3bfa8ada8ada3bf,0xa8cca454233128a8,0x28e82508a1afa87c,0xa11ca876a8c8a40e,0x1bef280928fb2575,0x28f92534a211a89e,0xa90ea716198f2801,0x1cc2283528df243d,0x1fe6a644a90ea6de,0xa90ea60720eb2893,0x28c428571df0a6cc,0x125ca7d3a8f1a46b,0xa4c5240e28e52809,0x290a26cc9f82a888,0xa810a8dba331255f
.quad 0x28182241a241a818,0xa24122412818290f,0x23ee28642905273a,0xa81fa90fa7e3a0eb,0xa8fba6b998c425c9,0x2809211ca40ea876,0x17f2a607a8e8a893,0x22d12857290126cc,0x28df2898243da17e,0xa90ea76e9cc2259f,0xa4dc2088281f2908,0x214da481a8b1a8c4,0xa790a90fa74b98c4,0x284328fb261c9bef,0x281f1f82a58aa8ee,0xa7c29c5d26302901
.quad 0x23bf28ad28ad23bf,0xa3bfa8ada8ada3bf,0xa8fda5b42025284a,0x290a26589d27a810,0x18c4a703a90fa6b9,0xa05625c9290327d3,0x28db284a1eb9a658,0xa864a8cca3ee2454,0xa4f2230128bf286a,0x276e965ba7f2a8f6,0xa77fa901a53422d1,0x245428e8281017f2,0x282718c4a790a8fb,0xa903a51e236028d7,0x239028e228018e5c,0x1eb9a6f1a908a534
.quad 0xa241a818a90fa818,0x2818290f28182241,0x290c283c22d1a211,0xa87ca454202527a1,0xa46b205627d3290f,0x925ca66ba8f1a88d,0xa6cca901a857a2d1,0x289328e8260797f2,0x28bf24f29fe6a7f2,0xa7f29fe624f228bf,0x94c5267f2901283c,0xa025a810a90aa6f1,0xa8a3a8c8a4c5211c,0x28e5287622a1a40e,0x273a14c5a6cca90c,0xa6a617f2275d290f
.quad 0x23bf28ad28ad23bf,0xa3bfa8ada8ada3bf,0xa90fa6f117f227a1,0x290c277f14c5a716,0x2360a46ba8d7a85d,0xa51e21e0288d28b6,0x275d290a2607a025,0xa58aa901a7c294c5,0xa898a17e259f2906,0x2906259fa17ea898,0x97f2a810a8e8a454,0xa2d125342901277f,0x28c828431befa74b,0xa703a909a57522a1,0xa6a620252893287c,0x28d422d1a58aa90c
.quad 0xa90fa818a2412241,0x28182241a241a818,0x25349c5da6f1a8fd,0xe5c263028e228b1,0x24c528a328e5261c,0xa827a90da7909f1e,0xa90ea810a0eb2454,0x28c425349df0a77f,0x259f9cc2a76ea90e,0xa17e243d289828df,0x245428a828cc2508,0xa658a8fda84aa1af,0xa909a8099f1e2575,0x290d2703125ca6b9,0x26079d27a7e3a90a,0xa55f2025282e28fd
.quad 0x23bf28ad28ad23bf,0xa3bfa8ada8ada3bf,0xa901a8019c5d267f,0x28ee283c1f82a5de,0x266b9d8ca827a8f1,0xa790925c274b290d,0x22d128b12888214d,0x9c5da81fa8eea4dc,0xa8f6a7f2965b276e,0x286a28bf2301a4f2,0x26cc9df0a857a8c4,0xa893a0eb2607290e,0x21e028b6285d1d8c,0x1f1ea6b9a90da5c9,0xa8e8a7e314c5281f,0x271629052508a3ee
.quad 0xa24122412818290f,0xa241a818a90fa818,0xa55fa8bba8dba607,0x288828f926cc1b25,0x2903285d2360a1e0,0xa8c8a5751bef2703,0xa77f9df0253428c4,0x2454a0eba810a90e,0x965ba6dea906a835,0x2301286a28f62644,0x2801290c271617f2,0xa89ea8d4a5341f82,0xa8f1a5c91d8c27d3,0x28b6246ba1e0a85d,0x24afa1afa864a8e8,0xa3ee2331289328cc
.quad 0x23bf28ad28ad23bf,0xa3bfa8ada8ada3bf,0xa8d4a870a14d2534,0x28b1289e22d1a481,0x28431f1ea61ca909,0xa8a3a2a124c528e5,0x9d2726a6290f26cc,0x2331a4afa8e8a82e,0xa6dea90ea6441fe6,0x243d28df28351cc2,0x290e2607a0eba893,0xa8c4a8579df026cc,0xa61c211c28a32876,0x288d2056a66ba90f,0xa088a89ea8709df0,0xa27125b4290e267f
.quad 0x2818290f28182241,0xa90fa818a2412241,0xa90aa77f9f822481,0x281021afa331a84a,0x27031befa575a8c8,0xa1e02360285d2903,0x97f2260728e82893,0xa2d1a857a901a6cc,0xa644a8f6a86aa301,0x2835290626de165b,0x28f928572211a425,0xa90ea73a998f2630,0xa85da1e0246b28b6,0x27d31d8ca5c9a8f1,0x2271a454a8bba8a8,0xa0eb250828db287c
.quad 0x23bf28ad28ad23bf,0xa3bfa8ada8ada3bf,0xa888a8c4a4252390,0x285728e224dca211,0x28e524c5a2a1a8a3,0xa909a61c1f1e2843,0xa5b420eb287c28bb,0x277f8e5ca7a1a905,0x9cc2a835a8dfa43d,0x9fe62644290e26de,0x277f29012534a2d1,0xa454a8e8a81097f2,0xa90fa66b2056288d,0x287628a3211ca61c,0x27c297f2a82ea8cc,0xa901a4dc242528ee
.quad 0x28182241a241a818,0xa24122412818290f,0xa390214d2801290f,0x9eb9a75da908a857,0x9f1ea790a90da827,0x261c28e528a324c5,0x26cc2901285722d1,0xa893a8e8a60717f2,0xa8dfa898a43d217e,0x290e276e1cc2a59f,0x28db255f9eb9a7e3,0xa864a27123ee2893,0xa6b9125c2703290d,0x25759f1ea809a909,0x1eb9a5b4a8f4a84a,0x9b25265829052810
.quad 0x23bf28ad28ad23bf,0xa3bfa8ada8ada3bf,0xa81fa8f9a58a2088,0x27c2290826309df0,0x290d274b925ca790,0xa8f1a8279d8c266b,0xa870a08825de2908,0x28e22481a390a8c4,0x24f2a301a8bfa86a,0xa76e165b27f228f6,0x17f2281028e82454,0x22d1a534a901a77f,0xa5c9a90da6b91f1e,0x1d8c285d28b621e0,0x28a828641d27a73a,0xa5dea90fa65820eb
.quad 0xa241a818a90fa818,0x2818290f28182241,0x26a628f4289324af,0xa8d4a8c4a58a198f,0xa88da8f1a66b925c,0x290f27d32056a46b,0x290e281020eba454,0xa8c4a5341df0277f,0xa8bfa4f21fe627f2,0x27f21fe6a4f2a8bf,0x275d1b25a607a8f4,0xa58a1df027c2290f,0xa40e22a1287628e5,0x211ca4c5a8c8a8a3,0xe5ca6f1a90ea7a1,0x198f277f290f2716
.quad 0x23bf28ad28ad23bf,0xa3bfa8ada8ada3bf,0xa73aa90fa6cc198f,0x26a6290e275d0e5c,0x28b6288d21e0a51e,0xa85da8d7a46b2360,0xa90fa67f1df0283c,0x28f428101b25a6f1,0x2898217ea59fa906,0xa906a59f217e2898,0xa6cc1df0285728c4,0x289320eba607a90e,0x22a1a575a909a703,0xa74b1bef284328c8,0x198f283c28c42211,0x24afa454a8f4a7a1
.quad 0xa90fa818a2412241,0x28182241a241a818,0x28e8265814c5a5de,0xa7169d27250828a8,0xa876a40e211c2809,0x25c998c4a6b9a8fb,0x277f1df0a534a8c4,0xa45420eb2810290e,0xa59f1cc2276e290e,0x217ea43da898a8df,0x22d1a390a888a8e2,0x9c5d25de28ee2870,0x9bef261c28fb2843,0x98c4a74ba90fa790,0x9df0a801a908a67f,0x2088283c28f925de
.quad 0x23bf28ad28ad23bf,0xa3bfa8ada8ada3bf,0xa607a905a7e39b25,0x255f28f4282e1eb9,0x27d3290325c9a056,0xa6b9a90fa70318c4,0xa893a8a8a2712508,0x27e328fd255fa1af,0x28f627f2165ba76e,0xa86aa8bfa30124f2,0xa90ea60720eb2893,0x28c428571df0a6cc,0x28d72360a51ea903,0xa8fba79018c42827,0xa8579c5d275d28fd,0x290f2630a14da8b1
.quad 0xa24122412818290f,0xa241a818a90fa818,0x2088a425a870a901,0x2271282e290e27c2,0x9d8c251e28b628d7,0xa2a1a843a909a74b,0x17f2a607a8e8a893,0x22d12857290126cc,0x165b26de29062835,0xa301a86aa8f6a644,0x9d27a7a1a90fa77f,0x2331287c28e825b4,0x205628272903266b,0xa360a88da8d7a51e,0xa211a870a8e2a534,0x2390289e28c42481
.quad 0x23bf28ad28ad23bf,0xa3bfa8ada8ada3bf,0xa4afa8dba864a0eb,0x23ee28bb28932271,0x257528fb28091bef,0xa40ea8c8a876a11c,0xa630a90ca73a17f2,0x242528d428571f82,0x26de290e26449fe6,0xa43da8dfa8359cc2,0xa77fa901a53422d1,0x245428e8281017f2,0x280928e5240ea4c5,0xa46ba8f1a7d3125c,0xa84aa8bba1af2607,0x248128f9277f9b25
.quad 0xa8d0a24125f3290f,0x28d028188000a818,0xa8e5a30125c9290f,0x288d286a1befa7b2,0xa8f6a3bf259f290f,0x283528ad1fe6a728,0xa903a43d2575290f,0x279028df21e0a692,0xa90ba498254a290f,0x269228ff23bfa5f3,0xa90fa4f2251e290f,0x2575290e24c5a54a,0xa90ea54a24f2290f,0x243d290b259fa498,0xa909a59f24c5290f,0x21e028f6266ba3bf
.quad 0xa8ffa5f32498290f,0x1e5528d02728a241,0xa8f1a644246b290f,0x125c289827d3a0b9,0xa8dfa692243d290f,0x9cc2285028359e55,0xa8c8a6de240e290f,0xa11c27f228769a5a,0xa8ada72823bf290f,0xa3bf272828ad8000,0xa88da76e2360290f,0xa51e264428d71a5a,0xa86aa7b22301290f,0xa644254a28f61e55,0xa843a7f222a1290f,0xa74b243d290920b9
.quad 0xa5f3a90fa5f32241,0x281828d02241,0xa40ea8f6a74b1e55,0xa1e02644290d254a,0x9fe6a8ada8350000,0xa59f23bf28f62728,0x125ca835a8a39e55,0xa7d31cc2288d2850,0x20b9a728a8eba241,0xa8ad9e5527b228d0,0x246ba59fa90da498,0xa909a43d25c9290b,0x2644a3bfa906a5f3,0xa8f6a692230128ff,0x27d39fe6a8d7a728,0xa876a8351bef28ad
.quad 0x28828000a882a818,0xa728a8d09e552818,0x28e51fe6a809a882,0xa4c5a90ea40e2692,0x290e23bfa6dea8d0,0x9fe6a8eba6442498,0x28fb259fa575a8ff,0x1befa86aa80920b9,0x28ad2728a3bfa90f,0x23bfa728a8ad0000,0x28272835a056a8ff,0x266ba4f2a903a0b9,0x26de28ad965ba8d0,0x2835a0b9a906a498,0x251e28f61d8ca882,0x28d7165ba8b6a692
.quad 0x25f3a241a8d0a818,0xa8d0a24125f3290f,0x2843165ba809a8d0,0xa903a6de205628ad,0x28f623bfa59fa90f,0xa835a8ad9fe62728,0x28fb26dea11ca8d0,0xa51ea90ea5c923bf,0x285028821a5aa818,0x9a5aa882a8500000,0x261c2906240ea5f3,0x2360a644a903a3bf,0x217e28eb26dea241,0x276ea0b9a8dfa728,0x9bef283528768000,0x28d71fe6a7d3a8ad
.quad 0xa49825f328ff2241,0x28ff25f3a498a90f,0xa790217e28fb25f3,0x2827286a98c4a8ad,0xa8bf9a5a286a2818,0x24f2290b2301a728,0xa90fa43d26b928d0,0x18c428bf2703a3bf,0xa8ada72823bf290f,0xa3bf272828ad8000,0xa74ba89818c428d0,0xa7902301290f23bf,0xa43da90ba17e2818,0xa8df9a5a28982728,0x98c4a8dfa5c925f3,0xa8fba4f226b928ad
.quad 0x28d028188000a818,0xa5f3a90fa5f32241,0x26b9290624c5a498,0x925ca835a8b6a0b9,0x1fe628ad28358000,0x259fa3bfa8f6a728,0xa2a1264429092498,0x28b61fe6a74ba8eb,0xa7b21e5528ad2818,0x28eb2728a0b9a8d0,0xa8fba301266b28ff,0x26b928f622a1a692,0xa8bfa7b21fe628d0,0x1cc228ad27f29e55,0xa66ba8f6a1e02728,0xa4c5259f290923bf
.quad 0x9e55a8d0a7282241,0xa882000028822818,0x2360a6dea8d79e55,0xa903a59f251e290b,0x27f2a0b9a8f6a5f3,0xa76ea8ad965b2882,0x2903217ea7d3a882,0xa056a8f6a5c9254a,0x28ad2728a3bfa90f,0x23bfa728a8ad0000,0x261c28df1befa882,0x28439fe6a8fba54a,0x1cc228eb259fa5f3,0x290e23bfa76ea882,0xa40e276e28769e55,0x28092835a11ca90b
.quad 0x281828d02241,0x25f3a241a8d0a818,0xa66b217e28c82818,0x28fb243da51ea90b,0xa8f6a3bf259f290f,0x283528ad1fe6a728,0xa876a86a98c42818,0x205628bf28099a5a,0xa3bfa8ffa6922241,0xa54a2498290b25f3,0x21e0a6dea8f1a241,0xa8e5a17e270328eb,0x28359a5aa898a818,0xa86aa850165b2882,0x2909259fa4c5a90f,0xa1e0a8f6a66b23bf
.quad 0x272828d01e55a818,0x2498a5f3a8ffa241,0x1bef28bf274ba241,0x28c81cc2a843a850,0xa59f254a29062241,0x289827b2a17ea8ff,0xa8d79cc2285d2818,0x2360290e246ba692,0xa8ada72823bf290f,0xa3bf272828ad8000,0xa4c5a906a11c2818,0xa8a3165b28c82692,0x1fe6a850a7f22241,0xa8bfa69224f228ff,0x27d3a301a90fa241,0xa46ba906a0562850
.quad 0xa8d0a24125f3290f,0x28d028188000a818,0xa85da8989f1e2728,0x22a128df27d39a5a,0x9fe6a8ada8350000,0xa59f23bf28f62728,0x261ca301a8f1a728,0xa90da4f224c5290b,0x290b2498a54aa90f,0xa692a8ffa3bf25f3,0x274b28df211ca728,0x2056a76ea8d7a0b9,0x965b2850286a8000,0x28981a5aa835a882,0xa7d31fe628d72728,0x287628359befa8ad
.quad 0xa8ffa5f32498290f,0x1e5528d02728a241,0xa575a906a2a12728,0xa70323012909254a,0x217ea7b2a8980000,0xa906a54a259f28ff,0x288d965ba8b6a728,0xa51ea906a1e027b2,0x28ad2728a3bfa90f,0x23bfa728a8ad0000,0x22a1290e240ea728,0x28e51cc2a876a7b2,0xa4f2269228bf8000,0x27f228509fe6a8ff,0xa8f19cc2288d2728,0x925c28bf266ba54a
.quad 0xa5f3a90fa5f32241,0x281828d02241,0x2360a59fa90fa5f3,0xa8769cc2279028eb,0x28f623bfa59fa90f,0xa835a8ad9fe62728,0x270328f62360a5f3,0x1befa7f2a8c8a0b9,0xa0b9272828eb2241,0x28ad1e55a7b2a8d0,0xa8c89fe6279028d0,0x27d328bf1f1ea7b2,0xa7f2a8ad9cc22818,0x9fe627b228bf1e55,0x1befa835a8760000,0xa8d79fe627d328ad
.quad 0x28828000a882a818,0xa728a8d09e552818,0x285d28359d8ca8d0,0x21e0a76ea8b69a5a,0x165b28ad276ea241,0x28f620b9a7f2a882,0xa8271fe628f125f3,0x266b28df1d8ca850,0xa8ada72823bf290f,0xa3bf272828ad8000,0x9f1ea8f6a57525f3,0xa909a17e28092850,0x276ea3bfa90ea241,0xa59fa8eb9cc22882,0x28e5259fa61ca8d0,0x24c5a6dea8a31a5a
.quad 0x25f3a241a8d0a818,0xa8d0a24125f3290f,0x28f1276e9d8ca882,0xa61ca90ea57523bf,0x1fe628ad28358000,0x259fa3bfa8f6a728,0xa827165b285d2882,0x28e5276e9f1ea8ad,0xa850a8829a5a2818,0x1a5a288228508000,0x1d8ca7f2a8b69e55,0xa8a39cc2280928ad,0x28df20b9a76ea8d0,0xa6dea8eba17e2728,0x266b28f621e0a728,0x24c5a59fa909a3bf
.quad 0xa49825f328ff2241,0x28ff25f3a498a90f,0xa90da4f225c928ff,0x1f1e28df26b9a3bf,0xa301a90ba4f225f3,0xa86a1a5a28bf2728,0x274ba301a90da498,0xa790a898125c28ad,0x28ad2728a3bfa90f,0x23bfa728a8ad0000,0x125c28bf26b9a498,0x290d243da703a8ad,0xa8981a5a28df25f3,0x217e290b243da728,0xa790a86a1f1e28ff,0xa827217e290d23bf
.quad 0x28d028188000a818,0xa5f3a90fa5f32241,0x98c427f228d72241,0x27039fe6a8a3a850,0xa8f6a3bf259f290f,0x283528ad1fe6a728,0xa46ba906a66b2241,0xa40e259f290f254a,0x27b29e55a8ada818,0xa8eba72820b928d0,0x282728981befa818,0x18c4a835a88d9a5a,0xa301269228f62241,0x290623bfa644a8ff,0xa909a59f24c5290f,0x21e028f6266ba3bf
.quad 0x9e55a8d0a7282241,0xa882000028822818,0x28a3165ba876a818,0xa61ca8f6a11c27b2,0x264428eb1fe6a818,0x26dea3bfa90ea498,0xa61c24f229092241,0x284328359f1ea8eb,0xa8ada72823bf290f,0xa3bf272828ad8000,0x1d8ca86aa7d32241,0xa8f1a59f25c928eb,0x290620b9a835a818,0x165ba8ada6de2498,0x2360290e21e0a818,0x29031fe6a85da7b2
.quad 0x281828d02241,0x25f3a241a8d0a818,0xa909a4f2246b28ff,0x282728bf211ca692,0x9fe6a8ada8350000,0xa59f23bf28f62728,0x28d7217ea6b9a8ff,0xa843a8989d8c27b2,0x23bf28ff2692a241,0x254aa498a90ba5f3,0xa876965b28432882,0x285d286a125ca850,0xa59fa90ba43d25f3,0xa4f2254a290e2498,0x27d39fe6a8d7a728,0xa876a8351bef28ad
.quad 0x272828d01e55a818,0x2498a5f3a8ffa241,0xa66b243d290f2498,0x288d27f2a056a8eb,0xa835a8501cc228d0,0xa43d269228df1e55,0x24c5a644a8e59e55,0xa8a3a76e22a1290b,0x28ad2728a3bfa90f,0x23bfa728a8ad0000,0xa1e027f2285d9e55,0x28b626dea46ba90b,0xa8f6a54a264428d0,0xa30127b2286a9e55,0x1befa898a7032498,0xa8c8a644257528eb
.quad 0xa8d0a24125f3290f,0x28d028188000a818,0xa11ca8bfa8270000,0xa46b24f229092692,0x28f623bfa59fa90f,0xa835a8ad9fe62728,0x1d8c289828438000,0x26b9a17ea8d7a7b2,0xa90ba498254a290f,0x269228ff23bfa5f3,0x925ca86aa85d0000,0xa843165b28762850,0x290e254aa4f2a90f,0xa43da90ba59f2498,0x9bef283528768000,0x28d71fe6a7d3a8ad
.quad 0xa8ffa5f32498290f,0x1e5528d02728a241,0x2056a7f2a88d0000,0xa90fa43d266b28eb,0x28df2692a43da90f,0x1cc2a850a8351e55,0xa2a1276e28a38000,0x28e52644a4c5a90b,0xa8ada72823bf290f,0xa3bf272828ad8000,0x246ba6dea8b60000,0xa85da7f221e0290b,0x286a27b2a301a90f,0x2644a54aa8f69e55,0xa575264428c88000,0x270328989befa8eb
.quad 0xa5f3a90fa5f32241,0x281828d02241,0x28a31fe6a703a8ff,0xa8d7a7f218c42850,0x1fe628ad28358000,0x259fa3bfa8f6a728,0xa90fa59f240e28ff,0x266b2906246ba54a,0x20b9a728a8eba241,0xa8ad9e5527b228d0,0x288d283598c4a882,0x9befa898a8271a5a,0xa64423bf290625f3,0x28f62692a301a8ff,0xa66ba8f6a1e02728,0xa4c5259f290923bf
.quad 0x28828000a882a818,0xa728a8d09e552818,0x211c28f6261ca498,0x2876965ba8a3a7b2,0xa90ea3bf26de28d0,0x1fe628eb2644a498,0x1f1ea835a8431e55,0xa909a4f2261c28eb,0x28ad2728a3bfa90f,0x23bfa728a8ad0000,0xa5c9259f28f11e55,0x27d3286a9d8ca8eb,0xa6dea8ad165b28d0,0xa83520b929062498,0x285d9fe6a903a498,0xa1e0a90ea36027b2
.quad 0x25f3a241a8d0a818,0xa8d0a24125f3290f,0x2575290e261ca241,0x1d8ca76ea8f1a3bf,0xa8f6a3bf259f290f,0x283528ad1fe6a728,0x1f1ea76ea8e5a241,0xa85d965b282728ad,0x285028821a5aa818,0x9a5aa882a8500000,0xa8091cc228a32818,0x28b627f29d8ca8ad,0xa17ea8eba6de2241,0xa76e20b928df2728,0x2909259fa4c5a90f,0xa1e0a8f6a66b23bf
.quad 0xa49825f328ff2241,0x28ff25f3a498a90f,0xa6b9a8df9f1e2818,0xa5c924f2290d23bf,0x28bf1a5aa86aa818,0xa4f2a90ba3012728,0x925c28982790a241,0x290d2301a74ba8ad,0xa8ada72823bf290f,0xa3bf272828ad8000,0x2703a43da90da241,0xa6b9a8bf925c28ad,0x243d290b217ea818,0x28df1a5aa898a728,0xa90da17e28272818,0x9f1e286a2790a3bf
.quad 0x28d028188000a818,0xa5f3a90fa5f32241,0xa7901cc228762882,0x290f259fa360a8eb,0x9fe6a8ada8350000,0xa59f23bf28f62728,0x28c827f29befa882,0xa360a8f6a70320b9,0xa7b21e5528ad2818,0x28eb2728a0b9a8d0,0x9f1ea8bfa7d31e55,0xa7901fe628c827b2,0x28bf27b29fe6a8d0,0x9cc2a8ada7f21e55,0xa7d31fe628d72728,0x287628359befa8ad
.quad 0x9e55a8d0a7282241,0xa882000028822818,0x28b6276ea1e0a8ff,0x1d8ca835a85d1a5a,0xa7f220b928f625f3,0x276e28ad165ba882,0x9d8ca8dfa66b2498,0xa8f19fe628272850,0x28ad2728a3bfa90f,0x23bfa728a8ad0000,0xa809217e29092498,0x257528f61f1ea850,0x9cc2a8eba59f25f3,0xa90ea3bf276e2882,0x28a326dea4c5a8ff,0x261ca59fa8e59a5a
.quad 0x281828d02241,0x25f3a241a8d0a818,0xa7d3a8dfa2a125f3,0x1f1e2898285d1a5a,0x28f623bfa59fa90f,0xa835a8ad9fe62728,0xa4c524f2290d25f3,0x28f12301a61ca90b,0xa3bfa8ffa6922241,0xa54a2498290b25f3,0x28d7276ea056a8d0,0xa11ca8dfa74b20b9,0xa8351a5a28982818,0x286a2850965ba882,0x1befa835a8760000,0xa8d79fe627d328ad
.quad 0x272828d01e55a818,0x2498a5f3a8ffa241,0xa909a301270328d0,0x22a129062575a54a,0x259fa54aa906a241,0xa898a7b2217e28ff,0x21e02906251ea5f3,0x28b6165ba88da7b2,0xa8ada72823bf290f,0xa3bf272828ad8000,0x28769cc2a8e5a5f3,0xa40ea90ea2a127b2,0x9fe6285027f2a241,0x28bf2692a4f2a8ff,0xa66ba8bf125c28d0,0xa88d1cc228f1254a
.quad 0xa8d0a24125f3290f,0x28d028188000a818,0x251ea43da8fba728,0xa8c8a17e266b290b,0x1fe628ad28358000,0x259fa3bfa8f6a728,0xa809a8bfa0562728,0x18c4286a28761a5a,0x290b2498a54aa90f,0xa692a8ffa3bf25f3,0xa703217e28e52728,0x28f126dea1e0a8eb,0x165ba850a86a0000,0xa8989a5a28352882,0x266b28f621e0a728,0x24c5a59fa909a3bf
.quad 0xa8ffa5f32498290f,0x1e5528d02728a241,0x28439cc2a8c8a728,0xa74ba8bf9bef2850,0xa17e27b228988000,0x2906254aa59fa8ff,0xa46ba90ea3602728,0xa85d1cc228d72692,0x28ad2728a3bfa90f,0x23bfa728a8ad0000,0xa8c8965b28a32728,0x211c290624c5a692,0x24f2a692a8bf0000,0xa7f2a8501fe628ff,0x20562906246ba728,0x290f2301a7d3a850
.quad 0xa5f3a90fa5f32241,0x281828d02241,0x28b62835125ca818,0xa4c5a906a6b920b9,0xa8f6a3bf259f290f,0x283528ad1fe6a728,0x274b9fe6a8b6a818,0xa909a64422a128eb,0xa0b9272828eb2241,0x28ad1e55a7b2a8d0,0xa2a1a8f6a6b92241,0xa66b230128fb2692,0x27f228ad1cc2a818,0x1fe6a7b2a8bf9e55,0xa909a59f24c5290f,0x21e028f6266ba3bf
.quad 0x28828000a882a818,0xa728a8d09e552818,0xa51e259f29032241,0x28d726dea360a90b,0x965ba8ada76e2241,0xa8f6a0b927f22882,0x25c928f62056a818,0x27d3a17ea903a54a,0xa8ada72823bf290f,0xa3bf272828ad8000,0x28fb1fe6a843a818,0x9befa8dfa61c254a,0xa76e23bf290e2241,0x259f28eb1cc2a882,0x211ca835a8092241,0xa876a76e240e290b
.quad 0x25f3a241a8d0a818,0xa8d0a24125f3290f,0xa05626de29032498,0x2809965ba843a8ad,0x9fe6a8ada8350000,0xa59f23bf28f62728,0x25c9290e251ea498,0x211ca6dea8fba3bf,0xa850a8829a5a2818,0x1a5a288228508000,0x29032644a360a8ff,0xa40ea906a61c23bf,0xa8dfa0b9276e28d0,0x26de28eb217ea728,0x27d39fe6a8d7a728,0xa876a8351bef28ad
.quad 0xa49825f328ff2241,0x28ff25f3a498a90f,0x18c4a86aa8271e55,0xa8fba17e279028ad,0x2301290b24f2a5f3,0x286a9a5aa8bfa728,0xa703a8bf98c42882,0xa6b9243d290f23bf,0x28ad2728a3bfa90f,0x23bfa728a8ad0000,0xa90fa30127902882,0x98c42898274ba3bf,0x28989a5aa8dfa5f3,0xa17ea90ba43d2728,0xa6b924f228fb1e55,0x25c928df18c4a8ad
.quad 0x28d028188000a818,0xa5f3a90fa5f32241,0xa90da64421e028d0,0x274b28f6240ea54a,0x28f623bfa59fa90f,0xa835a8ad9fe62728,0xa88d9cc227d328d0,0x28a32835925ca850,0x27b29e55a8ada818,0xa8eba72820b928d0,0xa5c9243d290925f3,0x290d259fa46ba90b,0x2301a692a8f6a241,0xa906a3bf264428ff,0x9bef283528768000,0x28d71fe6a7d3a8ad
.quad 0x9e55a8d0a7282241,0xa882000028822818,0x240e290e24c5a5f3,0x28099fe6a8e5a692,0xa644a8eb9fe62818,0xa6de23bf290e2498,0x2809286a9befa8d0,0x2575a59fa8fba0b9,0xa8ada72823bf290f,0xa3bf272828ad8000,0x290324f2a66ba8d0,0x2056a835a82720b9,0xa906a0b928352818,0x965b28ad26dea498,0x28b6965ba8d7a5f3,0x9d8ca8f6a51e2692
.quad 0x281828d02241,0x25f3a241a8d0a818,0x9befa86aa88d9e55,0xa5c9230128e527b2,0x1fe628ad28358000,0x259fa3bfa8f6a728,0xa1e0a8dfa7901e55,0xa575243d29032692,0x23bf28ff2692a241,0x254aa498a90ba5f3,0xa4c5a90ea5752498,0xa51e24f2290f254a,0x259f290b243da5f3,0x24f2a54aa90ea498,0xa66ba8f6a1e02728,0xa4c5259f290923bf
.quad 0x272828d01e55a818,0x2498a5f3a8ffa241,0xa7d3a898925c2882,0xa46b264428f120b9,0x283528509cc2a8d0,0x243da692a8df9e55,0xa876a7f2211c28ff,0xa40e26de28c81a5a,0x28ad2728a3bfa90f,0x23bfa728a8ad0000,0xa8d7a644251e28ff,0xa360276e288d9a5a,0x28f6254aa644a8d0,0x2301a7b2a86a1e55,0xa909a43d274b2882,0xa2a127f22843a0b9
.quad 0x290f,0x0,0xa90f,0x0,0x290f,0x0,0xa90f,0x0,0x290f,0x0,0xa90f,0x0,0x290f,0x0,0xa90f,0x0
.quad 0x290f,0x0,0xa90f,0x0,0x290f,0x0,0xa90f,0x0,0x290f,0x0,0xa90f,0x0,0x290f,0x0,0xa90f
.zero 776
.quad 0xa8ffa7281e552882,0x272828ff2498a498,0xa8eea77f1d27287c,0x2607290f258aa390,0xa8d7a7d31bef2876,0x24c52909266ba1e0,0xa8bba810198f2870,0x22d128ee273aa025,0xa898a835165b286a,0x1fe628bf27f29cc2,0xa870a8570e5c2864,0x17f2287c284a94c5,0xa843a876925c285d,0x9bef2827288d18c4,0xa810a89397f22857,0xa0eb277f28c41df0
.quad 0xa7b2a8ad9a5a2850,0xa3bf269228eb20b9,0xa73aa8c49c5d284a,0xa534258a29052271,0xa6b9a8d79d8c2843,0xa66b246b290f240e,0xa630a8e89eb9283c,0xa77f2271290a24dc,0xa59fa8f69fe62835,0xa8351fe628f6259f,0xa508a901a088282e,0xa893198f28d42658,0xa46ba909a11c2827,0xa8d798c428a32703,0xa390a90ea1af281f,0xa9019f82286427a1
.quad 0x9e55a882a8829e55,0xa498249828ff2728,0x198fa7e3a8dba271,0xa7161f82289e2857,0x21e0a66ba909a4c5,0xa8769bef27d328d7,0x2508a4afa90aa630,0xa8f9a39025de290e,0x26dea17ea8dfa76e,0xa906a644230128f6,0x282e998fa888a83c,0xa89ea81f1b252893,0x28b61d8ca809a8a3,0xa790a8c89f1e27d3,0x290122d1a6cca8e8,0xa534a90ea4542607
.quad 0x290b254aa54aa90b,0xa0b9a8eba69223bf,0x28d426f1a331a90a,0x198fa864a82e1df0,0x285d28279f1ea8e5,0x2360a703a8c89bef,0x275d28a80e5ca89e,0x2658a4afa90ca2d1,0x259f28f61fe6a835,0x28359fe6a8f6a59f,0x2331290f2390a75d,0x28db1b25a888a77f,0x1d8c28f12575a61c,0x290f2360a790a876,0x9b25289e26f1a4af,0x28cc2630a58aa8e8
.quad 0x28821e55a728a8ff,0xa8ffa7281e552882,0x290a2508a454a8fd,0xa81fa8c4a14d267f,0x28d727d39befa876,0xa4c5a909a66b21e0,0x27e328cc20eba6f1,0x94c5a857a8889c5d,0x24f2290e259fa43d,0x243da59fa90ea4f2,0x1d2728a828109c5d,0x27e39df0a8b1a801,0xa11c274b28d72056,0x28f121e0a703a8e5,0xa6072454290e2534,0x28e826cca2d1a901
.quad 0xa8501a5a28ad27b2,0x27b228ad1a5aa850,0xa8fda1af277f28b1,0x23ee290e24dca5de,0xa8f1a61c24c5290d,0x98c428762809a056,0xa82ea84a1df028e2,0xa508260728ee1f82,0xa59fa8f69fe62835,0xa8351fe628f6259f,0xa025a8fda5342630,0xa905a0eb281f283c,0x1f1ea85da7d322a1,0xa8c8a66b251e28fb,0x255fa658a8c40e5c,0xa716a8931c5d28ee
.quad 0x272828ff2498a498,0x9e55a882a8829e55,0x20eb28bb282e0e5c,0x2481a4dca908a6a6,0xa1e0266b290924c5,0x28761befa7d3a8d7,0xa77f1eb928a8282e,0x2905267fa211a8e2,0xa8f6a30126442906,0x276e28df217ea6de,0xa8c4a7c21eb928bb,0x202528cc27a19f82,0xa66ba8fba2a126b9,0xa40e261c29032360,0x9df0a8c4a77f20eb,0xa85717f228932810
.quad 0x23bfa692a8eba0b9,0xa90ba54a254a290b,0x28109f82a8e2a6a6,0xa7c2a89e94c5287c,0x290922a1a74ba8b6,0xa11ca8fba5c9251e,0x289327a1a211a908,0x2331a73aa8b194c5,0x259f28f61fe6a835,0x28359fe6a8f6a59f,0x17f228cc267fa4dc,0x290f23eea73aa89e,0xa4c526b928b6925c,0x28092843a056a903,0xa857202529052481,0x2211290f2331a7c2
.quad 0xa498249828ff2728,0x28821e55a728a8ff,0xa8a8a02526f12901,0x28d4280197f2a84a,0xa8d7a7d31bef2876,0x24c52909266ba1e0,0xa58aa90fa55f2454,0xa1af26a629012425,0x1cc2a7f2a8bf9fe6,0xa86a965b28352898,0x275da088a8d4a77f,0xa8e2a73a20eb28db,0x290d246ba5c9a909,0xa51ea90fa4c52575,0x2810289317f2a857,0x20eba77fa8c49df0
.quad 0x20b928eb2692a3bf,0x28509a5aa8ada7b2,0xa481263028f420eb,0x28ee2658a454a90f,0xa8a3925c288d27d3,0x2575290321e0a790,0xa8dba67f2481290e,0xa025281f28579d27,0xa59fa8f69fe62835,0xa8351fe628f6259f,0x1c5da87ca7a122d1,0xa8f9a55f260728e2,0x274ba40ea90da1e0,0xa5c9a8e59bef288d,0x290c214da82ea810,0x1eb9a870a77f23ee
.quad 0xa8ffa7281e552882,0x272828ff2498a498,0xa55fa90ea6302211,0x9df0275d28f423ee,0x21e0a66ba909a4c5,0xa8769bef27d328d7,0x289e1df0a7a1a8db,0xa893a84a8e5c283c,0x28982835965ba86a,0x9fe6a8bfa7f21cc2,0x21af28e82716a14d,0x26cca211a8eea6f1,0xa57524c5290f251e,0x290925c9a46ba90d,0xa901a2d126cc28e8,0x2534290e2454a607
.quad 0xa7b2a8ad9a5a2850,0xa3bf269228eb20b9,0x8e5ca893a7e32088,0xa8e8a02528012888,0x2790a1e0a903a575,0xa7d3a88d125c28a3,0x29052534a5dea8f4,0x17f2a888a7c221af,0x259f28f61fe6a835,0x28359fe6a8f6a59f,0xa14d2810284a9f82,0x28c426a6a4afa908,0xa88d1bef28e525c9,0x21e0290d240ea74b,0xa8a8a6cc24dc28fd,0xa60725b428e2198f
.quad 0x9e55a882a8829e55,0xa498249828ff2728,0x27a19c5da870a888,0xa90fa5b4233128e8,0x28d727d39befa876,0xa4c5a909a66b21e0,0x214d28d427c29d27,0x25b4a3eea8fda6cc,0xa6de217e28df276e,0x29062644a301a8f6,0xa8f9a6a6227128f4,0x233128fd267fa2d1,0xa360a903a61c240e,0xa6b922a128fb266b,0x2607a454a90ea534,0xa8e8a6cc22d12901
.quad 0x290b254aa54aa90b,0xa0b9a8eba69223bf,0x24af290f2425a67f,0x27a1a14da8f9a607,0xa51e25c928fb211c,0x28b6274ba2a1a909,0xa90fa390271628bb,0x1c5d28d426a6a454,0xa59fa8f69fe62835,0xa8351fe628f6259f,0x2425a716a8a814c5,0xa870a7c22271290e,0x29032056a843a809,0x125ca8b6a6b924c5,0x267f28bb94c5a8d4,0x28889d27a8f4a534
.quad 0x28821e55a728a8ff,0xa8ffa7281e552882,0x27c228e222d1a5de,0x9eb9a893a8649b25,0xa1e0266b290924c5,0x28761befa7d3a8d7,0xa908a4812534290f,0x275d28e82271a658,0xa4f2a90ea59f243d,0xa43d259f290e24f2,0x2630a390a901a658,0xa908a60723ee2905,0x28e52703a1e0a8f1,0xa056a8d7a74b211c,0x1df028c4277fa0eb,0x285797f2a893a810
.quad 0xa8501a5a28ad27b2,0x27b228ad1a5aa850,0xa81fa87017f228a8,0xa39026cc28db1eb9,0x2056a809a87618c4,0xa90da4c5261c28f1,0x28f92088a810a864,0xa14da901a55f25b4,0x259f28f61fe6a835,0x28359fe6a8f6a59f,0xa58a25de28e81d27,0x280128579eb9a8f4,0xa8fba51e266b28c8,0xa2a127d3285d9f1e,0xa088a908a454273a,0xa90fa2d127e3284a
.quad 0x272828ff2498a498,0x9e55a882a8829e55,0xa534242528f9273a,0x28cc21afa658a90c,0xa8d7a7d31bef2876,0x24c52909266ba1e0,0x17f2a81fa8b19f82,0xa8011b25287c2864,0x28f62301a644a906,0xa76ea8dfa17e26de,0x2454290a25dea425,0x258aa481a90ca5b4,0xa7d31f1e28c82790,0x28a328099d8ca8b6,0xa810a89397f22857,0xa0eb277f28c41df0
.quad 0x23bfa692a8eba0b9,0xa90ba54a254a290b,0x290125b4a508a90c,0x9b25a8bba75d2211,0x1bef28c82703a360,0x28e51f1ea827a85d,0xa8c4998f287c27e3,0x2425290f23eea6f1,0xa59fa8f69fe62835,0xa8351fe628f6259f,0x26cca481a90aa1af,0xa6f1a8b10e5c28bb,0x28762790a360a90f,0x261ca575a8f19d8c,0xa0eb283c2801a271,0x287c275da425a90a
.quad 0xa498249828ff2728,0x28821e55a728a8ff,0xa8b1a83c94c52810,0x24af290526cca088,0x21e0a66ba909a4c5,0xa8769bef27d328d7,0x28f42716a088a8c4,0xa4dca90ca6072331,0x9cc227f228bf1fe6,0x286a165ba835a898,0xa90fa55f24af290e,0x2508290f2534a4dc,0x98c4a88da8271bef,0xa85d125c28762843,0x290122d1a6cca8e8,0xa534a90ea4542607
.quad 0x20b928eb2692a3bf,0x28509a5aa8ada7b2,0xa8cc9d27283c2857,0x255f290822d1a716,0xa40ea90fa46b266b,0xa8431d8c28d726b9,0x28709b25a8cca6cc,0xa58aa8fda0eb2801,0x259f28f61fe6a835,0x28359fe6a8f6a59f,0xa7e32211290c2454,0x25b428ee1df0a864,0xa703a8a318c428d7,0xa827211c2909246b,0x26a6a508a8f99df0,0xa5dea8db97f228b1
.quad 0xa8ffa7281e552882,0x272828ff2498a498,0x2088a6cca905a4af,0xa81014c5283c28b1,0x28d727d39befa876,0xa4c5a909a66b21e0,0xa3312607290c24dc,0x28c42088a716a8f4,0xa898a835165b286a,0x1fe628bf27f29cc2,0x24dca534a90fa508,0xa90ea4af255f290f,0x28432876125ca85d,0x1befa827a88d98c4,0xa6072454290e2534,0x28e826cca2d1a901
.quad 0xa7b2a8ad9a5a2850,0xa3bf269228eb20b9,0x2716a2d1a908a55f,0xa857a83c1d2728cc,0x26b928d71d8ca843,0x266ba46ba90fa40e,0xa80120eb28fd258a,0x26cc28cc1b25a870,0xa59fa8f69fe62835,0xa8351fe628f6259f,0x28649df0a8eea5b4,0xa454a90ca21127e3,0x246b2909211ca827,0x28d718c4a8a3a703,0xa8b117f228db25de,0x1df028f92508a6a6
.quad 0x9e55a882a8829e55,0xa498249828ff2728,0x290c2658a1afa8cc,0xa73aa8f9a4252534,0xa1e0266b290924c5,0x28761befa7d3a8d7,0xa864a87c9b252801,0x1f8228b1281f97f2,0x26dea17ea8dfa76e,0xa906a644230128f6,0x25b4290c2481a58a,0x2425a5dea90aa454,0xa8b69d8c280928a3,0x279028c81f1ea7d3,0x9df0a8c4a77f20eb,0xa85717f228932810
.quad 0x290b254aa54aa90b,0xa0b9a8eba69223bf,0xa211275d28bb1b25,0x290c2508a5b4a901,0xa85da8271f1e28e5,0xa360270328c81bef,0x26f1a3eea90fa425,0xa7e3a87c198f28c4,0x259f28f61fe6a835,0x28359fe6a8f6a59f,0xa8bb8e5c28b126f1,0x21af290a2481a6cc,0x9d8ca8f1a575261c,0xa90fa36027902876,0x290a2425a75da87c,0x2271a801a83c20eb
.quad 0x28821e55a728a8ff,0xa8ffa7281e552882,0x1b25286428931eb9,0x25dea2d1a8e2a7c2,0xa8d7a7d31bef2876,0x24c52909266ba1e0,0x2658a271a8e8a75d,0xa90fa53424812908,0x24f2290e259fa43d,0x243da59fa90ea4f2,0xa905a3ee26072908,0x265829012390a630,0x211ca74ba8d7a056,0xa8f1a1e0270328e5,0x2810289317f2a857,0x20eba77fa8c49df0
.quad 0xa8501a5a28ad27b2,0x27b228ad1a5aa850,0x9eb9a8dba6cc2390,0xa8a897f22870281f,0x28f1261ca4c5a90d,0x18c4a876a8092056,0xa5b4255f2901214d,0x28642810a088a8f9,0xa59fa8f69fe62835,0xa8351fe628f6259f,0x28f41eb9a857a801,0x9d27a8e8a5de258a,0x9f1e285d27d3a2a1,0x28c8266ba51ea8fb,0xa84aa7e322d1290f,0xa73a245429082088
.quad 0x272828ff2498a498,0x9e55a882a8829e55,0xa8e8a33125b4290f,0x288828701c5da7a1,0x21e0a66ba909a4c5,0xa8769bef27d328d7,0x26cc28fd23eea5b4,0x1d27a7c2a8d4a14d,0xa8f6a30126442906,0x276e28df217ea6de,0x22d1a67fa8fda331,0xa8f4a27126a628f9,0x266b28fb22a1a6b9,0x240ea61ca903a360,0xa901a2d126cc28e8,0x2534290e2454a607
.quad 0x23bfa692a8eba0b9,0xa90ba54a254a290b,0x260728f9214da7a1,0x267fa425a90fa4af,0xa909a2a1274b28b6,0x211c28fb25c9a51e,0x2454a6a6a8d49c5d,0xa8bba7162390290f,0x259f28f61fe6a835,0x28359fe6a8f6a59f,0xa90ea27127c22870,0x94c528a82716a425,0x24c5a6b9a8b6125c,0xa809a84320562903,0x253428f41d27a888,0x28d414c5a8bba67f
.quad 0xa498249828ff2728,0x28821e55a728a8ff,0xa3eea8f4a75d1df0,0xa2112630290e255f,0x28d727d39befa876,0xa4c5a909a66b21e0,0xa83c0e5c284a2893,0x28db27a19df0a89e,0x1cc2a7f2a8bf9fe6,0xa86a965b28352898,0x26f128ee2211a6cc,0x214da716a8e8a1af,0xa90da46b25c92909,0x251e290f24c5a575,0x2607a454a90ea534,0xa8e8a6cc22d12901
.quad 0x20b928eb2692a3bf,0x28509a5aa8ada7b2,0xa888a801202528e8,0xa08827e328930e5c,0x28a3125ca88da7d3,0xa575a903a1e02790,0xa1af27c2288897f2,0x28f425dea534a905,0xa59fa8f69fe62835,0xa8351fe628f6259f,0x290824afa6a6a8c4,0x1f82a84aa810214d,0xa74b240e290d21e0,0x25c928e51befa88d,0x998fa8e2a5b42607,0xa8fda4dc26cc28a8
.quad 0xa8ffa7281e552882,0x272828ff2498a498,0x284a17f2a801a8d4,0xa901a6f1202528a8,0xa1e0266b290924c5,0x28761befa7d3a8d7,0xa425a901a6a621af,0xa454255f290f258a,0x28982835965ba86a,0x9fe6a8bfa7f21cc2,0xa8dba0eb273a28e2,0x277f28d42088a75d,0x2575a4c5a90fa51e,0xa909a5c9246b290d,0x1df028c4277fa0eb,0x285797f2a893a810
.quad 0xa7b2a8ad9a5a2850,0xa3bf269228eb20b9,0x290f2454a658a8ee,0xa0eba8f4a6302481,0xa79021e029032575,0x27d3288d925ca8a3,0x1d27a857a81f2025,0xa90ea481267f28db,0x259f28f61fe6a835,0x28359fe6a8f6a59f,0xa8e2a607255f28f9,0xa2d127a1287c9c5d,0x288d9befa8e5a5c9,0xa1e0a90da40e274b,0xa3ee277f28709eb9,0x2810282ea14da90c
.quad 0x9e55a882a8829e55,0xa498249828ff2728,0x26a6290824dca481,0x8e5ca82ea8bba0eb,0xa8d7a7d31bef2876,0x24c52909266ba1e0,0x28e22211a67fa905,0xa82ea8a89eb9277f,0xa6de217e28df276e,0x29062644a301a8f6,0x1f82a7a1a8cca025,0xa8bb9eb927c228c4,0x23602903261ca40e,0x26b9a2a1a8fba66b,0xa810a89397f22857,0xa0eb277f28c41df0
.quad 0x290b254aa54aa90b,0xa0b9a8eba69223bf,0xa87c14c5289e27c2,0x26a628e21f82a810,0x251ea5c9a8fba11c,0xa8b6a74b22a12909,0x14c528b1273aa331,0x29082211a7a1a893,0xa59fa8f69fe62835,0xa8351fe628f6259f,0x289e273aa3eea90f,0x24dca67fa8cc97f2,0xa903a05628432809,0x925c28b626b9a4c5,0x27c2a331a90fa211,0xa481a905a0252857
.quad 0x28821e55a728a8ff,0xa8ffa7281e552882,0xa67f214d28c4281f,0x28fd2454a508a90a,0x21e0a66ba909a4c5,0xa8769bef27d328d7,0x1c5d2888285714c5,0x26f1a0eba8cca7e3,0xa4f2a90ea59f243d,0xa43d259f290e24f2,0x280128b11df0a7e3,0x1c5da810a8a89d27,0xa8e5a70321e028f1,0x205628d7274ba11c,0x290122d1a6cca8e8,0xa534a90ea4542607
.quad 0xa8501a5a28ad27b2,0x27b228ad1a5aa850,0x25dea4dca90ea3ee,0xa8b1a77f21af28fd,0xa0562809287698c4,0x290d24c5a61ca8f1,0x9f82a8eea6072508,0xa8e29df0284a282e,0x259f28f61fe6a835,0x28359fe6a8f6a59f,0xa83ca81f20eb2905,0xa630253428fd2025,0x28fb251ea66ba8c8,0x22a1a7d3a85d1f1e,0xa8ee9c5d28932716,0x8e5c28c42658a55f
.quad 0x272828ff2498a498,0x9e55a882a8829e55,0xa857a89e9f822716,0x227128db27e3998f,0x28d727d39befa876,0xa4c5a909a66b21e0,0xa90ea5de239028f9,0x2630290a24afa508,0x28f62301a644a906,0xa76ea8dfa17e26de,0xa8939b25281f289e,0x283c2888198fa82e,0x27d39f1ea8c8a790,0xa8a3a8091d8c28b6,0xa6072454290e2534,0x28e826cca2d1a901
.quad 0x23bfa692a8eba0b9,0xa90ba54a254a290b,0x9df0282e2864998f,0x290a2331a6f1a8d4,0x9befa8c8a7032360,0xa8e59f1e2827285d,0x22d1290c24afa658,0x289e8e5ca8a8a75d,0xa59fa8f69fe62835,0xa8351fe628f6259f,0x277f28889b25a8db,0x275da390a90fa331,0xa876a7902360290f,0xa61c257528f11d8c,0x28e8258aa630a8cc,0x24afa6f1a89e1b25
.quad 0xa498249828ff2728,0x28821e55a728a8ff,0x2390a58aa90fa607,0xa87c9d27277f28ee,0xa1e0266b290924c5,0x28761befa7d3a8d7,0x2025a73aa8eea2d1,0xa870998f281028bb,0x9cc227f228bf1fe6,0x286a165ba835a898,0x14c5a84aa87c97f2,0xa8648e5c28572870,0x18c4288d28279bef,0x285d925ca876a843,0x9df0a8c4a77f20eb,0xa85717f228932810
.quad 0x20b928eb2692a3bf,0x28509a5aa8ada7b2,0xa271a905a58a2534,0xa84a1c5d28c4273a,0x240e290f246ba66b,0x28439d8ca8d7a6b9,0xa4dca90aa271277f,0xa83c1eb928e82630,0x259f28f61fe6a835,0x28359fe6a8f6a59f,0xa658a8d4998f2893,0xa82e208829012508,0x270328a398c4a8d7,0x2827a11ca909a46b,0xa7a1a8641f822901,0xa81f21af290e2390
.quad 0x224128d028180000,0x2241a5f3a90fa5f3,0x211c28bf28270000,0x246ba4f2a909a692,0x1fe628ad28350000,0x259fa3bfa8f6a728,0x1d8c289828430000,0x26b9a17ea8d7a7b2,0x1a5a288228500000,0x27b29e55a8ada818,0x125c286a285d0000,0x2843965ba876a850,0x965b2850286a0000,0x28981a5aa835a882,0x9bef283528760000,0x28d71fe6a7d3a8ad
.quad 0x9e55281828820000,0x28ff2241a728a8d0,0xa05627f2288d0000,0x290f243da66ba8eb,0xa17e27b228980000,0x2906254aa59fa8ff,0xa2a1276e28a30000,0x28e52644a4c5a90b,0xa3bf272828ad0000,0x28ad2728a3bfa90f,0xa46b26de28b60000,0x285d27f2a1e0a90b,0xa4f2269228bf0000,0x27f228509fe6a8ff,0xa575264428c80000,0x270328989befa8eb
.quad 0xa8180000281828d0,0x290f25f3a241a8d0,0xa8a39fe6270328ff,0x28d727f298c4a850,0xa8f6a3bf259f290f,0x283528ad1fe6a728,0xa90fa59f240e28ff,0x266b2906246ba54a,0xa8eba72820b928d0,0x23bf28ff2692a241,0xa88da83518c42882,0x1bef289828279a5a,0xa7f2a8ad9cc22818,0x9fe627b228bf1e55,0xa66ba8f6a1e02728,0xa4c5259f290923bf
.quad 0xa498a90fa49825f3,0xa728224128ff25f3,0xa11ca8f6a61c2498,0xa876165b28a327b2,0x965ba8ada76e2241,0xa8f6a0b927f22882,0x1f1ea835a8431e55,0xa909a4f2261c28eb,0x23bfa728a8ad0000,0xa8ada72823bf290f,0x25c9a59fa8f19e55,0xa7d3a86a1d8c28eb,0x276ea3bfa90ea241,0xa59fa8eb9cc22882,0x285d9fe6a903a498,0xa1e0a90ea36027b2
.quad 0xa818a8d0a24125f3,0x224128d028180000,0xa575a90ea61c2241,0x9d8c276e28f123bf,0x9fe6a8ada8350000,0xa59f23bf28f62728,0x1f1ea76ea8e5a241,0xa85d965b282728ad,0x254aa498a90ba5f3,0xa90ba498254a290f,0x28099cc2a8a3a818,0xa8b6a7f21d8c28ad,0x28df20b9a76ea8d0,0xa6dea8eba17e2728,0x2909259fa4c5a90f,0xa1e0a8f6a66b23bf
.quad 0x288228189e55a8d0,0x1e55a818a8820000,0x26b928df1f1ea818,0x25c9a4f2a90da3bf,0x2301290b24f2a5f3,0x286a9a5aa8bfa728,0x925c28982790a241,0x290d2301a74ba8ad,0xa3bf272828ad0000,0x28ad2728a3bfa90f,0xa703243d290d2241,0x26b928bf125ca8ad,0xa8981a5a28df25f3,0x217e290b243da728,0xa90da17e28272818,0x9f1e286a2790a3bf
.quad 0x2241a5f3a90fa5f3,0xa8180000281828d0,0x27909cc2a876a882,0xa90fa59f236028eb,0x28f623bfa59fa90f,0xa835a8ad9fe62728,0x28c827f29befa882,0xa360a8f6a70320b9,0x269228ff23bfa5f3,0x20b9a728a8eba241,0x1f1e28bf27d39e55,0x27909fe6a8c8a7b2,0xa301269228f62241,0x290623bfa644a8ff,0xa7d31fe628d72728,0x287628359befa8ad
.quad 0xa8ffa241272828d0,0x2498290f2498a5f3,0xa8b6a76e21e028ff,0x9d8c2835285d9a5a,0xa644a8eb9fe62818,0xa6de23bf290e2498,0x9d8ca8dfa66b2498,0xa8f19fe628272850,0x23bfa728a8ad0000,0xa8ada72823bf290f,0x2809a17ea909a498,0xa575a8f69f1e2850,0x290620b9a835a818,0x165ba8ada6de2498,0x28a326dea4c5a8ff,0x261ca59fa8e59a5a
.quad 0x290f25f3a241a8d0,0xa818a8d0a24125f3,0x27d328df22a1a5f3,0x9f1ea898a85d9a5a,0x1fe628ad28350000,0x259fa3bfa8f6a728,0xa4c524f2290d25f3,0x28f12301a61ca90b,0xa8ad9e5527b228d0,0x285028821a5aa818,0xa8d7a76e205628d0,0x211c28df274ba0b9,0xa59fa90ba43d25f3,0xa4f2254a290e2498,0x1befa835a8760000,0xa8d79fe627d328ad
.quad 0x2728a241a8ffa5f3,0xa882a8181e5528d0,0x29092301a703a8d0,0xa2a1a906a575254a,0x283528509cc2a8d0,0x243da692a8df9e55,0x21e02906251ea5f3,0x28b6165ba88da7b2,0xa3bf272828ad0000,0x28ad2728a3bfa90f,0xa8761cc228e525f3,0x240e290e22a1a7b2,0xa8f6a54a264428d0,0xa30127b2286a9e55,0xa66ba8bf125c28d0,0xa88d1cc228f1254a
.quad 0x224128d028180000,0x2241a5f3a90fa5f3,0xa51e243d28fb2728,0x28c8217ea66ba90b,0xa8f6a3bf259f290f,0x283528ad1fe6a728,0xa809a8bfa0562728,0x18c4286a28761a5a,0x9a5aa882a8500000,0xa7b21e5528ad2818,0x2703a17ea8e5a728,0xa8f1a6de21e028eb,0x290e254aa4f2a90f,0xa43da90ba59f2498,0x266b28f621e0a728,0x24c5a59fa909a3bf
.quad 0x9e55281828820000,0x28ff2241a728a8d0,0xa8431cc228c82728,0x274b28bf1befa850,0xa8dfa692243d290f,0x9cc2285028359e55,0xa46ba90ea3602728,0xa85d1cc228d72692,0x23bfa728a8ad0000,0xa8ada72823bf290f,0x28c8165ba8a3a728,0xa11ca906a4c52692,0x286a27b2a301a90f,0x2644a54aa8f69e55,0x20562906246ba728,0x290f2301a7d3a850
.quad 0xa8180000281828d0,0x290f25f3a241a8d0,0xa8b6a835925c2818,0x24c5290626b9a0b9,0x9fe6a8ada8350000,0xa59f23bf28f62728,0x274b9fe6a8b6a818,0xa909a64422a128eb,0x28eb2728a0b9a8d0,0xa3bfa8ffa6922241,0x22a128f626b9a241,0x266ba301a8fba692,0xa64423bf290625f3,0x28f62692a301a8ff,0xa909a59f24c5290f,0x21e028f6266ba3bf
.quad 0xa498a90fa49825f3,0xa728224128ff25f3,0x251ea59fa903a241,0xa8d7a6de2360290b,0x290e23bfa6dea8d0,0x9fe6a8eba6442498,0x25c928f62056a818,0x27d3a17ea903a54a,0xa3bf272828ad0000,0x28ad2728a3bfa90f,0xa8fb9fe628432818,0x1bef28df261ca54a,0xa6dea8ad165b28d0,0xa83520b929062498,0x211ca835a8092241,0xa876a76e240e290b
.quad 0xa818a8d0a24125f3,0x224128d028180000,0x2056a6dea903a498,0xa809165b284328ad,0x28f623bfa59fa90f,0xa835a8ad9fe62728,0x25c9290e251ea498,0x211ca6dea8fba3bf,0xa54a2498290b25f3,0x290b2498a54aa90f,0xa903a644236028ff,0x240e2906261ca3bf,0xa17ea8eba6de2241,0xa76e20b928df2728,0x27d39fe6a8d7a728,0xa876a8351bef28ad
.quad 0x288228189e55a8d0,0x1e55a818a8820000,0x98c4286a28279e55,0x28fb217ea790a8ad,0xa8bf9a5a286a2818,0x24f2290b2301a728,0xa703a8bf98c42882,0xa6b9243d290f23bf,0x23bfa728a8ad0000,0xa8ada72823bf290f,0x290f2301a790a882,0x18c4a898a74b23bf,0x243d290b217ea818,0x28df1a5aa898a728,0xa6b924f228fb1e55,0x25c928df18c4a8ad
.quad 0x2241a5f3a90fa5f3,0xa8180000281828d0,0x290d2644a1e0a8d0,0xa74ba8f6a40e254a,0x1fe628ad28350000,0x259fa3bfa8f6a728,0xa88d9cc227d328d0,0x28a32835925ca850,0xa692a8ffa3bf25f3,0xa0b9272828eb2241,0x25c9a43da909a5f3,0xa90da59f246b290b,0x28bf27b29fe6a8d0,0x9cc2a8ada7f21e55,0x9bef283528760000,0x28d71fe6a7d3a8ad
.quad 0xa8ffa241272828d0,0x2498290f2498a5f3,0xa40ea90ea4c525f3,0xa8091fe628e52692,0x27f2a0b9a8f6a5f3,0xa76ea8ad965b2882,0x2809286a9befa8d0,0x2575a59fa8fba0b9,0xa3bf272828ad0000,0x28ad2728a3bfa90f,0xa903a4f2266b28d0,0xa05628352827a0b9,0x9cc2a8eba59f25f3,0xa90ea3bf276e2882,0x28b6965ba8d7a5f3,0x9d8ca8f6a51e2692
.quad 0x290f25f3a241a8d0,0xa818a8d0a24125f3,0x1bef286a288d1e55,0x25c9a301a8e5a7b2,0xa8f6a3bf259f290f,0x283528ad1fe6a728,0xa1e0a8dfa7901e55,0xa575243d29032692,0x28ad1e55a7b2a8d0,0xa850a8829a5a2818,0x24c5290e2575a498,0x251ea4f2a90fa54a,0xa8351a5a28982818,0x286a2850965ba882,0xa66ba8f6a1e02728,0xa4c5259f290923bf
.quad 0x2728a241a8ffa5f3,0xa882a8181e5528d0,0x27d32898125ca882,0x246ba644a8f1a0b9,0xa59f254a29062241,0x289827b2a17ea8ff,0xa876a7f2211c28ff,0xa40e26de28c81a5a,0x23bfa728a8ad0000,0xa8ada72823bf290f,0x28d72644a51ea8ff,0x2360a76ea88d1a5a,0x9fe6285027f2a241,0x28bf2692a4f2a8ff,0xa909a43d274b2882,0xa2a127f22843a0b9
.quad 0x224128d028180000,0x2241a5f3a90fa5f3,0xa8e5a30125c9290f,0x288d286a1befa7b2,0x9fe6a8ada8350000,0xa59f23bf28f62728,0x2903243da575a90f,0xa790a8dfa1e02692,0x1a5a288228500000,0x27b29e55a8ada818,0xa90fa4f2251e290f,0x2575290e24c5a54a,0x165ba850a86a0000,0xa8989a5a28352882,0x2909259fa4c5a90f,0xa1e0a8f6a66b23bf
.quad 0x9e55281828820000,0x28ff2241a728a8d0,0xa8f1a644246b290f,0x125c289827d3a0b9,0x217ea7b2a8980000,0xa906a54a259f28ff,0x28c826dea40ea90f,0x211ca7f2a8761a5a,0xa3bf272828ad0000,0x28ad2728a3bfa90f,0xa88da76e2360290f,0xa51e264428d71a5a,0x24f2a692a8bf0000,0xa7f2a8501fe628ff,0x284327f2a2a1a90f,0x274ba43da909a0b9
.quad 0xa8180000281828d0,0x290f25f3a241a8d0,0xa40ea8f6a74b1e55,0xa1e02644290d254a,0x28f623bfa59fa90f,0xa835a8ad9fe62728,0x925c283528a31e55,0x27d39cc2a88da850,0xa8eba72820b928d0,0x23bf28ff2692a241,0x246ba59fa90da498,0xa909a43d25c9290b,0x27f228ad1cc2a818,0x1fe6a7b2a8bf9e55,0xa7d31fe628d72728,0x287628359befa8ad
.quad 0xa498a90fa49825f3,0xa728224128ff25f3,0x28e51fe6a809a882,0xa4c5a90ea40e2692,0x165b28ad276ea241,0x28f620b9a7f2a882,0xa8fba59f257528ff,0x9bef286a2809a0b9,0x23bfa728a8ad0000,0xa8ada72823bf290f,0x28272835a056a8ff,0x266ba4f2a903a0b9,0xa76e23bf290e2241,0x259f28eb1cc2a882,0xa51ea8f69d8c2882,0xa8d7965b28b62692
.quad 0xa818a8d0a24125f3,0x224128d028180000,0x2843165ba809a8d0,0xa903a6de205628ad,0x1fe628ad28350000,0x259fa3bfa8f6a728,0xa8fba6de211c28d0,0x251e290e25c9a3bf,0x254aa498a90ba5f3,0xa90ba498254a290f,0x261c2906240ea5f3,0x2360a644a903a3bf,0xa8dfa0b9276e28d0,0x26de28eb217ea728,0x1befa835a8760000,0xa8d79fe627d328ad
.quad 0x288228189e55a8d0,0x1e55a818a8820000,0xa790217e28fb25f3,0x2827286a98c4a8ad,0xa301a90ba4f225f3,0xa86a1a5a28bf2728,0x290f243da6b9a8d0,0x98c4a8bfa70323bf,0xa3bf272828ad0000,0x28ad2728a3bfa90f,0xa74ba89818c428d0,0xa7902301290f23bf,0x28989a5aa8dfa5f3,0xa17ea90ba43d2728,0x18c428df25c9a5f3,0x28fb24f2a6b9a8ad
.quad 0x2241a5f3a90fa5f3,0xa8180000281828d0,0x26b9290624c5a498,0x925ca835a8b6a0b9,0xa8f6a3bf259f290f,0x283528ad1fe6a728,0x22a1a644a909a498,0xa8b69fe6274b28eb,0x269228ff23bfa5f3,0x20b9a728a8eba241,0xa8fba301266b28ff,0x26b928f622a1a692,0x2301a692a8f6a241,0xa906a3bf264428ff,0x266b28f621e0a728,0x24c5a59fa909a3bf
.quad 0xa8ffa241272828d0,0x2498290f2498a5f3,0x2360a6dea8d79e55,0xa903a59f251e290b,0x264428eb1fe6a818,0x26dea3bfa90ea498,0xa903a17e27d32882,0x205628f625c9a54a,0x23bfa728a8ad0000,0xa8ada72823bf290f,0x261c28df1befa882,0x28439fe6a8fba54a,0xa906a0b928352818,0x965b28ad26dea498,0x240ea76ea8761e55,0xa809a835211c290b
.quad 0x290f25f3a241a8d0,0xa818a8d0a24125f3,0xa66b217e28c82818,0x28fb243da51ea90b,0x9fe6a8ada8350000,0xa59f23bf28f62728,0x2876286a18c4a818,0xa056a8bfa8091a5a,0xa8ad9e5527b228d0,0x285028821a5aa818,0x21e0a6dea8f1a241,0xa8e5a17e270328eb,0x259f290b243da5f3,0x24f2a54aa90ea498,0xa909a59f24c5290f,0x21e028f6266ba3bf
.quad 0x2728a241a8ffa5f3,0xa882a8181e5528d0,0x1bef28bf274ba241,0x28c81cc2a843a850,0xa835a8501cc228d0,0xa43d269228df1e55,0x28d71cc2a85da818,0xa360a90ea46b2692,0xa3bf272828ad0000,0x28ad2728a3bfa90f,0xa4c5a906a11c2818,0xa8a3165b28c82692,0x28f6254aa644a8d0,0x2301a7b2a86a1e55,0xa7d32301290f2241,0x246b29062056a850
.quad 0x224128d028180000,0x2241a5f3a90fa5f3,0xa85da8989f1e2728,0x22a128df27d39a5a,0x28f623bfa59fa90f,0xa835a8ad9fe62728,0xa61c230128f12728,0x290d24f2a4c5a90b,0x9a5aa882a8500000,0xa7b21e5528ad2818,0x274b28df211ca728,0x2056a76ea8d7a0b9,0xa90ea54a24f2290f,0x243d290b259fa498,0x27d39fe6a8d7a728,0xa876a8351bef28ad
.quad 0x9e55281828820000,0x28ff2241a728a8d0,0xa575a906a2a12728,0xa70323012909254a,0x28df2692a43da90f,0x1cc2a850a8351e55,0xa88d165b28b62728,0x251e290621e0a7b2,0x23bfa728a8ad0000,0xa8ada72823bf290f,0x22a1290e240ea728,0x28e51cc2a876a7b2,0xa86aa7b22301290f,0xa644254a28f61e55,0x28f11cc2a88da728,0x125ca8bfa66b254a
.quad 0xa8180000281828d0,0x290f25f3a241a8d0,0x2360a59fa90fa5f3,0xa8769cc2279028eb,0x1fe628ad28350000,0x259fa3bfa8f6a728,0xa703a8f6a36025f3,0x9bef27f228c820b9,0x28eb2728a0b9a8d0,0xa3bfa8ffa6922241,0xa8c89fe6279028d0,0x27d328bf1f1ea7b2,0x2644a3bfa906a5f3,0xa8f6a692230128ff,0x9bef283528760000,0x28d71fe6a7d3a8ad
.quad 0xa498a90fa49825f3,0xa728224128ff25f3,0x285d28359d8ca8d0,0x21e0a76ea8b69a5a,0xa90ea3bf26de28d0,0x1fe628eb2644a498,0x28279fe6a8f1a5f3,0xa66ba8df9d8c2850,0xa3bf272828ad0000,0x28ad2728a3bfa90f,0x9f1ea8f6a57525f3,0xa909a17e28092850,0x26de28ad965ba8d0,0x2835a0b9a906a498,0xa8e5a59f261c28d0,0xa4c526de28a39a5a
.quad 0xa818a8d0a24125f3,0x224128d028180000,0x28f1276e9d8ca882,0xa61ca90ea57523bf,0xa8f6a3bf259f290f,0x283528ad1fe6a728,0x2827965ba85da882,0xa8e5a76e1f1e28ad,0xa54a2498290b25f3,0x290b2498a54aa90f,0x1d8ca7f2a8b69e55,0xa8a39cc2280928ad,0x217e28eb26dea241,0x276ea0b9a8dfa728,0xa66ba8f6a1e02728,0xa4c5259f290923bf
.quad 0x288228189e55a8d0,0x1e55a818a8820000,0xa90da4f225c928ff,0x1f1e28df26b9a3bf,0x28bf1a5aa86aa818,0xa4f2a90ba3012728,0xa74b2301290d2498,0x27902898925ca8ad,0x23bfa728a8ad0000,0xa8ada72823bf290f,0x125c28bf26b9a498,0x290d243da703a8ad,0xa43da90ba17e2818,0xa8df9a5a28982728,0x2790286a9f1ea8ff,0x2827a17ea90da3bf
.quad 0x2241a5f3a90fa5f3,0xa8180000281828d0,0x98c427f228d72241,0x27039fe6a8a3a850,0x9fe6a8ada8350000,0xa59f23bf28f62728,0x246b2906266ba241,0x240ea59fa90fa54a,0xa692a8ffa3bf25f3,0xa0b9272828eb2241,0x282728981befa818,0x18c4a835a88d9a5a,0xa8bfa7b21fe628d0,0x1cc228ad27f29e55,0x2909259fa4c5a90f,0xa1e0a8f6a66b23bf
.quad 0xa8ffa241272828d0,0x2498290f2498a5f3,0x28a3165ba876a818,0xa61ca8f6a11c27b2,0xa7f220b928f625f3,0x276e28ad165ba882,0x261ca4f2a909a241,0xa843a8351f1e28eb,0xa3bf272828ad0000,0x28ad2728a3bfa90f,0x1d8ca86aa7d32241,0xa8f1a59f25c928eb,0x1cc228eb259fa5f3,0x290e23bfa76ea882,0xa360a90ea1e02818,0xa9039fe6285d27b2
.quad 0x290f25f3a241a8d0,0xa818a8d0a24125f3,0xa909a4f2246b28ff,0x282728bf211ca692,0x28f623bfa59fa90f,0xa835a8ad9fe62728,0xa8d7a17e26b928ff,0x284328981d8ca7b2,0x28ad1e55a7b2a8d0,0xa850a8829a5a2818,0xa876965b28432882,0x285d286a125ca850,0x28359a5aa898a818,0xa86aa850165b2882,0xa7d31fe628d72728,0x287628359befa8ad
.quad 0x2728a241a8ffa5f3,0xa882a8181e5528d0,0xa66b243d290f2498,0x288d27f2a056a8eb,0x259fa54aa906a241,0xa898a7b2217e28ff,0xa4c5264428e51e55,0x28a3276ea2a1a90b,0x23bfa728a8ad0000,0xa8ada72823bf290f,0xa1e027f2285d9e55,0x28b626dea46ba90b,0x1fe6a850a7f22241,0xa8bfa69224f228ff,0x9bef28982703a498,0x28c82644a575a8eb
.quad 0x9e55272828ff2498,0x27289e55a882a882,0xa08826cc290524af,0x281094c5a83ca8b1,0xa1e0266b290924c5,0x28761befa7d3a8d7,0xa3312607290c24dc,0x28c42088a716a8f4,0xa43d259f290e24f2,0x28f62301a644a906,0xa4dc2534290f2508,0x290e24afa55fa90f,0xa57524c5290f251e,0x290925c9a46ba90d,0xa6072454290e2534,0x28e826cca2d1a901
.quad 0xa69223bf290b254a,0x28ad27b2a0b9a8eb,0xa71622d12908255f,0x2857283c9d27a8cc,0xa79021e029032575,0x27d3288d925ca8a3,0xa80120eb28fd258a,0x26cc28cc1b25a870,0xa8351fe628f6259f,0x259f28f61fe6a835,0xa8641df028ee25b4,0x2454290c2211a7e3,0xa88d1bef28e525c9,0x21e0290d240ea74b,0xa8b117f228db25de,0x1df028f92508a6a6
.quad 0xa8ffa498249828ff,0x288228821e55a728,0xa90ca65821af28cc,0x273a28f92425a534,0xa8d7a7d31bef2876,0x24c52909266ba1e0,0xa864a87c9b252801,0x1f8228b1281f97f2,0xa76ea8dfa17e26de,0x9cc227f228bf1fe6,0xa5b4a90ca481258a,0xa42525de290a2454,0xa360a903a61c240e,0xa6b922a128fb266b,0x9df0a8c4a77f20eb,0xa85717f228932810
.quad 0x1a5aa850a8501a5a,0xa8eba0b927b228ad,0x2211a75da8bb9b25,0xa90ca50825b42901,0x251ea5c9a8fba11c,0xa8b6a74b22a12909,0x26f1a3eea90fa425,0xa7e3a87c198f28c4,0x28359fe6a8f6a59f,0xa59fa8f69fe62835,0x28bb0e5ca8b1a6f1,0xa1afa90aa48126cc,0x29032056a843a809,0x125ca8b6a6b924c5,0x290a2425a75da87c,0x2271a801a83c20eb
.quad 0xa498a8ffa7281e55,0x9e55272828ff2498,0x9b25a864a8939eb9,0xa5de22d128e227c2,0x21e0a66ba909a4c5,0xa8769bef27d328d7,0x2658a271a8e8a75d,0xa90fa53424812908,0x286a165ba835a898,0xa898a835165b286a,0x290523eea607a908,0xa658a901a3902630,0x28e52703a1e0a8f1,0xa056a8d7a74b211c,0x2810289317f2a857,0x20eba77fa8c49df0
.quad 0x254a290b23bfa692,0x2692a3bfa90ba54a,0x1eb928db26cca390,0x28a817f2a870a81f,0xa0562809287698c4,0x290d24c5a61ca8f1,0xa5b4255f2901214d,0x28642810a088a8f9,0xa8351fe628f6259f,0x259f28f61fe6a835,0xa8f49eb928572801,0x1d2728e825dea58a,0xa8fba51e266b28c8,0xa2a127d3285d9f1e,0xa84aa7e322d1290f,0xa73a245429082088
.quad 0x27289e55a882a882,0xa8ffa498249828ff,0x28e82331a5b4a90f,0xa888a8709c5d27a1,0x28d727d39befa876,0xa4c5a909a66b21e0,0x26cc28fd23eea5b4,0x1d27a7c2a8d4a14d,0x1fe628bf27f29cc2,0x26dea17ea8dfa76e,0xa2d1267f28fd2331,0x28f42271a6a6a8f9,0xa7d31f1e28c82790,0x28a328099d8ca8b6,0xa901a2d126cc28e8,0x2534290e2454a607
.quad 0xa8ada7b220b928eb,0x9a5a285028509a5a,0xa607a8f9a14d27a1,0xa67f2425290f24af,0x9befa8c8a7032360,0xa8e59f1e2827285d,0x2454a6a6a8d49c5d,0xa8bba7162390290f,0x28359fe6a8f6a59f,0xa59fa8f69fe62835,0x290e2271a7c2a870,0x14c5a8a8a7162425,0x28762790a360a90f,0x261ca575a8f19d8c,0x253428f41d27a888,0x28d414c5a8bba67f
.quad 0x288228821e55a728,0xa498a8ffa7281e55,0x23ee28f4275d9df0,0x2211a630a90ea55f,0xa1e0266b290924c5,0x28761befa7d3a8d7,0xa83c0e5c284a2893,0x28db27a19df0a89e,0xa906a644230128f6,0x24f2290e259fa43d,0xa6f1a8eea21126cc,0xa14d271628e821af,0x98c4a88da8271bef,0xa85d125c28762843,0x2607a454a90ea534,0xa8e8a6cc22d12901
.quad 0x28eb20b9a7b2a8ad,0xa54aa90ba3bf2692,0x28882801a025a8e8,0x2088a7e3a8938e5c,0x240e290f246ba66b,0x28439d8ca8d7a6b9,0xa1af27c2288897f2,0x28f425dea534a905,0xa8351fe628f6259f,0x259f28f61fe6a835,0xa908a4af26a628c4,0x9f82284a2810a14d,0xa703a8a318c428d7,0xa827211c2909246b,0x998fa8e2a5b42607,0xa8fda4dc26cc28a8
.quad 0x9e55272828ff2498,0x27289e55a882a882,0xa84a97f2280128d4,0x290126f1a025a8a8,0xa8d7a7d31bef2876,0x24c52909266ba1e0,0xa425a901a6a621af,0xa454255f290f258a,0x243da59fa90ea4f2,0xa8f6a30126442906,0x28db20eba73aa8e2,0xa77fa8d4a088275d,0x28432876125ca85d,0x1befa827a88d98c4,0x1df028c4277fa0eb,0x285797f2a893a810
.quad 0xa69223bf290b254a,0x28ad27b2a0b9a8eb,0xa90fa454265828ee,0x20eb28f42630a481,0xa6b9a8d79d8c2843,0xa66b246b290f240e,0x1d27a857a81f2025,0xa90ea481267f28db,0x28359fe6a8f6a59f,0xa59fa8f69fe62835,0x28e22607a55fa8f9,0x22d1a7a1a87c1c5d,0x246b2909211ca827,0x28d718c4a8a3a703,0xa3ee277f28709eb9,0x2810282ea14da90c
.quad 0xa8ffa498249828ff,0x288228821e55a728,0xa6a6a908a4dc2481,0xe5c282e28bb20eb,0x21e0a66ba909a4c5,0xa8769bef27d328d7,0x28e22211a67fa905,0xa82ea8a89eb9277f,0x276e28df217ea6de,0x1cc2a7f2a8bf9fe6,0x9f8227a128cc2025,0x28bb1eb9a7c2a8c4,0xa8b69d8c280928a3,0x279028c81f1ea7d3,0xa810a89397f22857,0xa0eb277f28c41df0
.quad 0x1a5aa850a8501a5a,0xa8eba0b927b228ad,0x287c94c5a89ea7c2,0xa6a6a8e29f822810,0x285d28279f1ea8e5,0x2360a703a8c89bef,0x14c528b1273aa331,0x29082211a7a1a893,0xa8351fe628f6259f,0x259f28f61fe6a835,0xa89ea73a23ee290f,0xa4dc267f28cc17f2,0x9d8ca8f1a575261c,0xa90fa36027902876,0x27c2a331a90fa211,0xa481a905a0252857
.quad 0xa498a8ffa7281e55,0x9e55272828ff2498,0x267fa14da8c4a81f,0xa8fda4542508290a,0x28d727d39befa876,0xa4c5a909a66b21e0,0x1c5d2888285714c5,0x26f1a0eba8cca7e3,0xa86a965b28352898,0x28982835965ba86a,0xa801a8b19df027e3,0x9c5d281028a81d27,0x211ca74ba8d7a056,0xa8f1a1e0270328e5,0x290122d1a6cca8e8,0xa534a90ea4542607
.quad 0x254a290b23bfa692,0x2692a3bfa90ba54a,0xa5de24dc290e23ee,0x28b1277fa1afa8fd,0xa8f1a61c24c5290d,0x98c428762809a056,0x9f82a8eea6072508,0xa8e29df0284a282e,0x28359fe6a8f6a59f,0xa59fa8f69fe62835,0x283c281fa0eba905,0x2630a534a8fda025,0x9f1e285d27d3a2a1,0x28c8266ba51ea8fb,0xa8ee9c5d28932716,0x8e5c28c42658a55f
.quad 0x27289e55a882a882,0xa8ffa498249828ff,0x2857289e1f82a716,0xa271a8dba7e3198f,0xa1e0266b290924c5,0x28761befa7d3a8d7,0xa90ea5de239028f9,0x2630290a24afa508,0x9fe6a8bfa7f21cc2,0xa6de217e28df276e,0x28931b25a81fa89e,0xa83ca888998f282e,0x266b28fb22a1a6b9,0x240ea61ca903a360,0xa6072454290e2534,0x28e826cca2d1a901
.quad 0xa8ada7b220b928eb,0x9a5a285028509a5a,0x1df0a82ea864198f,0xa90aa33126f128d4,0x290922a1a74ba8b6,0xa11ca8fba5c9251e,0x22d1290c24afa658,0x289e8e5ca8a8a75d,0xa8351fe628f6259f,0x259f28f61fe6a835,0xa77fa8881b2528db,0xa75d2390290f2331,0x24c5a6b9a8b6125c,0xa809a84320562903,0x28e8258aa630a8cc,0x24afa6f1a89e1b25
.quad 0x288228821e55a728,0xa498a8ffa7281e55,0xa390258a290f2607,0x287c1d27a77fa8ee,0xa8d7a7d31bef2876,0x24c52909266ba1e0,0x2025a73aa8eea2d1,0xa870998f281028bb,0x29062644a301a8f6,0xa4f2a90ea59f243d,0x94c5284a287c17f2,0x28640e5ca857a870,0xa90da46b25c92909,0x251e290f24c5a575,0x9df0a8c4a77f20eb,0xa85717f228932810
.quad 0x28eb20b9a7b2a8ad,0xa54aa90ba3bf2692,0x22712905258aa534,0x284a9c5da8c4a73a,0xa8a3925c288d27d3,0x2575290321e0a790,0xa4dca90aa271277f,0xa83c1eb928e82630,0x28359fe6a8f6a59f,0xa59fa8f69fe62835,0x265828d4198fa893,0x282ea088a901a508,0xa74b240e290d21e0,0x25c928e51befa88d,0xa7a1a8641f822901,0xa81f21af290e2390
.quad 0x9e55272828ff2498,0x27289e55a882a882,0xa8eea77f1d27287c,0x2607290f258aa390,0x21e0a66ba909a4c5,0xa8769bef27d328d7,0x28bb2810998fa870,0xa2d1a8eea73a2025,0xa43d259f290e24f2,0x28f62301a644a906,0xa870a8570e5c2864,0x17f2287c284a94c5,0x2575a4c5a90fa51e,0xa909a5c9246b290d,0x2810289317f2a857,0x20eba77fa8c49df0
.quad 0xa69223bf290b254a,0x28ad27b2a0b9a8eb,0xa73aa8c49c5d284a,0xa534258a29052271,0x2790a1e0a903a575,0xa7d3a88d125c28a3,0x263028e81eb9a83c,0x277fa271a90aa4dc,0xa8351fe628f6259f,0x259f28f61fe6a835,0xa508a901a088282e,0xa893198f28d42658,0x288d9befa8e5a5c9,0xa1e0a90da40e274b,0x2390290e21afa81f,0x29011f82a864a7a1
.quad 0xa8ffa498249828ff,0x288228821e55a728,0x198fa7e3a8dba271,0xa7161f82289e2857,0x28d727d39befa876,0xa4c5a909a66b21e0,0xa50824af290a2630,0x28f92390a5dea90e,0xa76ea8dfa17e26de,0x9cc227f228bf1fe6,0x282e998fa888a83c,0xa89ea81f1b252893,0x23602903261ca40e,0x26b9a2a1a8fba66b,0xa901a2d126cc28e8,0x2534290e2454a607
.quad 0x1a5aa850a8501a5a,0xa8eba0b927b228ad,0x28d426f1a331a90a,0x198fa864a82e1df0,0xa51e25c928fb211c,0x28b6274ba2a1a909,0xa75da8a88e5c289e,0xa65824af290c22d1,0x28359fe6a8f6a59f,0xa59fa8f69fe62835,0x2331290f2390a75d,0x28db1b25a888a77f,0xa903a05628432809,0x925c28b626b9a4c5,0x1b25a89ea6f124af,0xa8cca630258a28e8
.quad 0xa498a8ffa7281e55,0x9e55272828ff2498,0x290a2508a454a8fd,0xa81fa8c4a14d267f,0xa1e0266b290924c5,0x28761befa7d3a8d7,0xa7e3a8cca0eb26f1,0x14c5285728881c5d,0x286a165ba835a898,0xa898a835165b286a,0x1d2728a828109c5d,0x27e39df0a8b1a801,0xa8e5a70321e028f1,0x205628d7274ba11c,0x2607a454a90ea534,0xa8e8a6cc22d12901
.quad 0x254a290b23bfa692,0x2692a3bfa90ba54a,0xa8fda1af277f28b1,0x23ee290e24dca5de,0x2056a809a87618c4,0xa90da4c5261c28f1,0x282e284a9df0a8e2,0x2508a607a8ee9f82,0xa8351fe628f6259f,0x259f28f61fe6a835,0xa025a8fda5342630,0xa905a0eb281f283c,0x28fb251ea66ba8c8,0x22a1a7d3a85d1f1e,0xa55f265828c48e5c,0x271628939c5da8ee
.quad 0x27289e55a882a882,0xa8ffa498249828ff,0x20eb28bb282e0e5c,0x2481a4dca908a6a6,0xa8d7a7d31bef2876,0x24c52909266ba1e0,0x277f9eb9a8a8a82e,0xa905a67f221128e2,0x1fe628bf27f29cc2,0x26dea17ea8dfa76e,0xa8c4a7c21eb928bb,0x202528cc27a19f82,0x27d39f1ea8c8a790,0xa8a3a8091d8c28b6,0x1df028c4277fa0eb,0x285797f2a893a810
.quad 0xa8ada7b220b928eb,0x9a5a285028509a5a,0x28109f82a8e2a6a6,0xa7c2a89e94c5287c,0x1bef28c82703a360,0x28e51f1ea827a85d,0xa893a7a122112908,0xa331273a28b114c5,0x28359fe6a8f6a59f,0xa59fa8f69fe62835,0x17f228cc267fa4dc,0x290f23eea73aa89e,0xa876a7902360290f,0xa61c257528f11d8c,0x2857a025a905a481,0xa211a90fa33127c2
.quad 0x288228821e55a728,0xa498a8ffa7281e55,0xa8a8a02526f12901,0x28d4280197f2a84a,0x21e0a66ba909a4c5,0xa8769bef27d328d7,0x258a290f255fa454,0x21afa6a6a901a425,0xa906a644230128f6,0x24f2290e259fa43d,0x275da088a8d4a77f,0xa8e2a73a20eb28db,0x18c4288d28279bef,0x285d925ca876a843,0xa810a89397f22857,0xa0eb277f28c41df0
.quad 0x28eb20b9a7b2a8ad,0xa54aa90ba3bf2692,0xa481263028f420eb,0x28ee2658a454a90f,0xa40ea90fa46b266b,0xa8431d8c28d726b9,0x28db267fa481a90e,0x2025a81fa8571d27,0xa8351fe628f6259f,0x259f28f61fe6a835,0x1c5da87ca7a122d1,0xa8f9a55f260728e2,0x270328a398c4a8d7,0x2827a11ca909a46b,0xa90ca14d282e2810,0x9eb92870277fa3ee
.quad 0x9e55272828ff2498,0x27289e55a882a882,0xa55fa90ea6302211,0x9df0275d28f423ee,0x28d727d39befa876,0xa4c5a909a66b21e0,0xa89e9df027a128db,0x2893284a0e5ca83c,0x243da59fa90ea4f2,0xa8f6a30126442906,0x21af28e82716a14d,0x26cca211a8eea6f1,0xa843a876925c285d,0x9bef2827288d18c4,0x290122d1a6cca8e8,0xa534a90ea4542607
.quad 0xa69223bf290b254a,0x28ad27b2a0b9a8eb,0x8e5ca893a7e32088,0xa8e8a02528012888,0x26b928d71d8ca843,0x266ba46ba90fa40e,0xa905a53425de28f4,0x97f2288827c2a1af,0x28359fe6a8f6a59f,0xa59fa8f69fe62835,0xa14d2810284a9f82,0x28c426a6a4afa908,0xa46ba909a11c2827,0xa8d798c428a32703,0x28a826cca4dca8fd,0x2607a5b4a8e2998f
.quad 0xa8ffa498249828ff,0x288228821e55a728,0x27a19c5da870a888,0xa90fa5b4233128e8,0xa1e0266b290924c5,0x28761befa7d3a8d7,0xa14da8d4a7c21d27,0xa5b423ee28fd26cc,0x276e28df217ea6de,0x1cc2a7f2a8bf9fe6,0xa8f9a6a6227128f4,0x233128fd267fa2d1,0x28b61d8ca809a8a3,0xa790a8c89f1e27d3,0xa6072454290e2534,0x28e826cca2d1a901
.quad 0x1a5aa850a8501a5a,0xa8eba0b927b228ad,0x24af290f2425a67f,0x27a1a14da8f9a607,0xa85da8271f1e28e5,0xa360270328c81bef,0x290f2390a716a8bb,0x9c5da8d4a6a62454,0xa8351fe628f6259f,0x259f28f61fe6a835,0x2425a716a8a814c5,0xa870a7c22271290e,0x1d8c28f12575a61c,0x290f2360a790a876,0xa67fa8bb14c528d4,0xa8881d2728f42534
.quad 0xa498a8ffa7281e55,0x9e55272828ff2498,0x27c228e222d1a5de,0x9eb9a893a8649b25,0xa8d7a7d31bef2876,0x24c52909266ba1e0,0x29082481a534a90f,0xa75da8e8a2712658,0xa86a965b28352898,0x28982835965ba86a,0x2630a390a901a658,0xa908a60723ee2905,0xa11c274b28d72056,0x28f121e0a703a8e5,0x9df0a8c4a77f20eb,0xa85717f228932810
.quad 0x254a290b23bfa692,0x2692a3bfa90ba54a,0xa81fa87017f228a8,0xa39026cc28db1eb9,0x28f1261ca4c5a90d,0x18c4a876a8092056,0xa8f9a08828102864,0x214d2901255fa5b4,0x28359fe6a8f6a59f,0xa59fa8f69fe62835,0xa58a25de28e81d27,0x280128579eb9a8f4,0x1f1ea85da7d322a1,0xa8c8a66b251e28fb,0x208829082454a73a,0x290f22d1a7e3a84a
.quad 0x27289e55a882a882,0xa8ffa498249828ff,0xa534242528f9273a,0x28cc21afa658a90c,0x21e0a66ba909a4c5,0xa8769bef27d328d7,0x97f2281f28b11f82,0x28019b25a87ca864,0x9fe6a8bfa7f21cc2,0xa6de217e28df276e,0x2454290a25dea425,0x258aa481a90ca5b4,0xa66ba8fba2a126b9,0xa40e261c29032360,0x2810289317f2a857,0x20eba77fa8c49df0
.quad 0xa8ada7b220b928eb,0x9a5a285028509a5a,0x290125b4a508a90c,0x9b25a8bba75d2211,0xa909a2a1274b28b6,0x211c28fb25c9a51e,0x28c4198fa87ca7e3,0xa425a90fa3ee26f1,0xa8351fe628f6259f,0x259f28f61fe6a835,0x26cca481a90aa1af,0xa6f1a8b10e5c28bb,0xa4c526b928b6925c,0x28092843a056a903,0x20eba83ca8012271,0xa87ca75d2425290a
.quad 0x288228821e55a728,0xa498a8ffa7281e55,0xa8b1a83c94c52810,0x24af290526cca088,0x28d727d39befa876,0xa4c5a909a66b21e0,0xa8f4a716208828c4,0x24dc290c2607a331,0x29062644a301a8f6,0xa4f2a90ea59f243d,0xa90fa55f24af290e,0x2508290f2534a4dc,0x290d246ba5c9a909,0xa51ea90fa4c52575,0xa901a2d126cc28e8,0x2534290e2454a607
.quad 0x28eb20b9a7b2a8ad,0xa54aa90ba3bf2692,0xa8cc9d27283c2857,0x255f290822d1a716,0x28a3125ca88da7d3,0xa575a903a1e02790,0xa8701b2528cc26cc,0x258a28fd20eba801,0x28359fe6a8f6a59f,0xa59fa8f69fe62835,0xa7e32211290c2454,0x25b428ee1df0a864,0x274ba40ea90da1e0,0xa5c9a8e59bef288d,0xa6a6250828f91df0,0x25de28db17f2a8b1
.quad 0xa818a8182241290f,0xa8182241290f2241,0xa7d3a83521e0290f,0xa8761fe6290923bf,0xa76ea850217e290f,0xa8bf1a5a28f62498,0xa703a86a211c290f,0xa8f1965b28d7254a,0xa692a88220b9290f,0xa90b9e5528ad25f3,0xa61ca8982056290f,0xa90da17e28762692,0xa59fa8ad1fe6290f,0xa8f6a3bf28352728,0xa51ea8bf1f1e290f,0xa8c8a4f227d327b2
.quad 0xa498a8d01e55290f,0xa882a5f327282818,0xa40ea8df1d8c290f,0xa827a6de266b2850,0xa301a8eb1cc2290f,0xa76ea7b2259f2882,0xa1e0a8f61bef290f,0xa66ba83524c528ad,0xa0b9a8ff1a5a290f,0xa54aa88223bf28d0,0x9f1ea90618c4290f,0xa40ea8bf21e028eb,0x9cc2a90b165b290f,0xa17ea8eb1fe628ff,0x98c4a90e125c290f,0x9d8ca9061bef290b
.quad 0x2241290f2241a818,0x290f2241a818a818,0x1bef28f624c5a728,0x28d7259fa66ba8ad,0x9cc228ad2644a5f3,0x283527b2a43da8ff,0xa2a128352790a498,0x266b28989f1ea90b,0xa54a27282850a241,0x23bf28ff1a5aa8d0,0xa703259f28b69e55,0x1bef290622a1a850,0xa83523bf28f68000,0x9fe628ad259fa728,0xa8b61fe6290f1e55,0xa4c527f22790a54a
.quad 0xa8ff000028ff2241,0xa72825f32882a241,0xa90d9fe628c82498,0xa876230128f19a5a,0xa8dfa3bf286a25f3,0xa8f61a5a290e1e55,0xa876a59f27d32728,0xa9099fe628d723bf,0xa7b2a72826922818,0xa8ada498285025f3,0xa61ca835251e2882,0xa7d3a6de270327b2,0xa43da8ad230128d0,0xa59fa85024f22882,0xa056a8f61f1e28ff,0xa1e0a8df211c28eb
.quad 0x2241a818a8182241,0xa818a8182241290f,0x266ba59fa8d70000,0xa4c5a8f69bef28ad,0x286aa0b9a90ea241,0x965ba8eba4f22728,0x29031cc2a8b6a5f3,0x240ea7f2a80923bf,0x28eb2498a7b2a818,0x27b2a498a8eb0000,0x2827276ea51ea8d0,0x28e5965ba8fba3bf,0x259f28ad9fe6a90f,0x28f623bfa835a728,0x2056290e1d8ca8d0,0x2809276ea575a8ad
.quad 0x9e5528d02498a818,0x249828d09e55a90f,0xa51e27f2274ba5f3,0x125c2906211ca8ad,0xa7f2254a2898a241,0xa43d28502644a728,0xa8d71fe629098000,0xa7d3259f2876a3bf,0xa90b9e5528eb2241,0xa8eb1e55290b8000,0xa88da4f2284325f3,0xa8f1a17e28c823bf,0xa6dea7b226442818,0xa7f2a692276e2728,0xa360a8bf22a128d0,0xa46ba898240e28ad
.quad 0xa8182241290f2241,0x2241290f2241a818,0xa9099fe628762728,0xa1e0283527d3a3bf,0xa898a692259f28d0,0xa7f223bf29061e55,0xa5c9a8bf1bef28ff,0xa90d9fe6288d2692,0x9a5aa8ffa3bf2818,0xa850a728254a28d0,0x246ba7f2a7d32498,0xa40ea8f6925c28eb,0x2835a3bfa8f60000,0x1fe6a8ada59f2728,0x290d1cc2a8d7a498,0x274ba59fa8a320b9
.quad 0x288225f3a728a818,0x28ff8000a8ffa241,0x25752898a1e0a8ff,0x288d259fa790a7b2,0x165b290b1fe6a8d0,0x24f228ada17ea8ff,0xa4c52835266ba728,0x9bef28f621e0a8ad,0xa850249828ada241,0xa692272827b2a5f3,0xa90f965b29091e55,0xa8e51fe629039a5a,0xa86aa54a283525f3,0xa8bfa3bf28982498,0xa51ea86a24c52882,0xa5c9a83525752850
.quad 0x290f2241a818a818,0x2241a818a8182241,0x27d32835a1e0a90f,0x28769fe6a909a3bf,0x1fe6290b2301a818,0x28df254aa6dea882,0xa4c5276e2843a241,0x251e28df925ca8eb,0xa8ad1e55290b2241,0xa0b928822692a5f3,0xa8d7a4f227902818,0xa843230129031a5a,0xa59fa8ad1fe6290f,0xa8f6a3bf28352728,0x1befa8dfa46b2818,0xa5c9a898211c290b
.quad 0x2728a5f3a8822241,0x1e55a8d0a4982818,0x2909165ba8fba241,0x2809a4f2a8b620b9,0x28352692a6dea818,0x290620b9a8bfa498,0x21e028f69befa90f,0x266b2835a4c5a8ad,0xa3bf2882254aa818,0x9a5a28ff20b9a8d0,0xa876243d28b6a241,0xa79026442827a54a,0xa8f6a0b928df2241,0xa90e9a5a29061e55,0xa66ba7f2261c2818,0xa703a76e26b927b2
.quad 0xa818a8182241290f,0xa8182241290f2241,0x9befa8f6a4c52728,0xa8d7a59f266b28ad,0x26dea54aa8df0000,0xa301a90b9fe62882,0x290f217ea85da728,0x2575a6dea87620b9,0x26922882a0b9a90f,0x290b1e55a8ada5f3,0x9d8c28bf2575a728,0x26b9286aa1e0a90b,0xa83523bf28f68000,0x9fe628ad259fa728,0xa8e5a43d28272728,0xa88d217e29091a5a
.quad 0xa498a8d01e55290f,0xa882a5f327282818,0x2360a86aa61c2728,0x9f1ea90e9bef28eb,0x28bfa0b9a9060000,0x26dea692a8352498,0x2876259fa7d3a728,0x29091fe6a8d7a3bf,0x20b928ff9a5aa90f,0x254a2882a3bfa8d0,0xa5c927f226b9a728,0xa360289824c5a850,0xa9061a5a290e8000,0xa8df20b928f69e55,0xa790a6de274b2728,0xa809a64427d32692
.quad 0x2241290f2241a818,0x290f2241a818a818,0xa66b259f28d78000,0x24c528f61befa8ad,0xa906a3bf27f22818,0xa59f269228989e55,0xa46ba8f698c428d0,0xa909a301282727b2,0x254aa728a8502241,0xa3bfa8ff9a5a28d0,0x290f1fe6a8a3a5f3,0x266ba644a88d20b9,0x259f28ad9fe6a90f,0x28f623bfa835a728,0xa40e28352703a5f3,0x21e0290618c4a8eb
.quad 0xa8ff000028ff2241,0xa72825f32882a241,0xa6b9a835246b28d0,0xa8d7a43d28432692,0x217ea8ada4f22818,0x9fe6a90b965b28ff,0x28d79fe6a9090000,0x27d3a59fa87623bf,0x27b22728a692a818,0x28ad2498a850a5f3,0x9d8c28f6211ca8d0,0x1bef290e125ca90b,0xa89823bf28bfa241,0xa835254a286aa498,0xa843a59f282725f3,0xa876a4f2285d254a
.quad 0x2241a818a8182241,0xa818a8182241290f,0x29091fe6a876a728,0x21e0a835a7d323bf,0x24f228eb165ba8d0,0x290e20b9a86aa728,0xa61c264428a39e55,0x236029061d8ca8ad,0xa8eba49827b22818,0xa7b2249828eb8000,0x9f1ea90ea11c2882,0xa85da6de25c928ad,0x2835a3bfa8f60000,0x1fe6a8ada59f2728,0x284326dea61ca882,0x2903165ba8f1a3bf
.quad 0x9e5528d02498a818,0x249828d09e55a90f,0xa8e51cc2290f1e55,0xa7032644285da3bf,0xa644a850243d28d0,0xa898a54a27f22728,0x24c5a835a66b2728,0x1befa8f6a1e028ad,0x290b1e55a8eba241,0x28eb9e55a90b0000,0x22a128dfa056a8ff,0x2575286aa46ba8ad,0xa76e269227f2a5f3,0xa64427b226dea728,0xa8a3a43d288d2498,0xa8c8a30128b623bf
.quad 0xa8182241290f2241,0x2241290f2241a818,0xa7d3a83521e0290f,0xa8761fe6290923bf,0x243da7b2a8352241,0xa644a8ad1cc228ff,0x28fb243da7d3a818,0x26b9a59fa8c81a5a,0x1a5a28ff23bfa818,0x28502728a54aa8d0,0xa8c81cc229092241,0xa3602835274ba54a,0xa59fa8ad1fe6290f,0xa8f6a3bf28352728,0x26b9a644a8762241,0x125ca8f6a3602850
.quad 0x288225f3a728a818,0x28ff8000a8ffa241,0xa05628bf24c5a818,0x22a128f698c4a90b,0xa90e9a5a28f62241,0xa86a23bf28df9e55,0xa1e0a8f61bef290f,0xa66ba83524c528ad,0x2850a498a8ad2241,0x2692a728a7b225f3,0x274b276ea66ba818,0x285d259fa809a692,0xa4f22850259fa818,0xa30128ad243da882,0xa8e5a17e28d72241,0xa8fb9fe628f120b9
.quad 0x290f2241a818a818,0x2241a818a8182241,0x1bef28f624c5a728,0x28d7259fa66ba8ad,0xa8f69a5a28bf25f3,0xa17e2850276ea498,0xa1e0a90ea0562882,0xa8e5a4f2274b2850,0x28ad9e55a90ba241,0x20b9a882a69225f3,0x24c528df98c4a8ff,0x28f1243da809a7b2,0xa83523bf28f68000,0x9fe628ad259fa728,0xa66ba86a22a128ff,0xa8fba301285d2692
.quad 0x2728a5f3a8822241,0x1e55a8d0a4982818,0x27d3276ea5c9a882,0x2903217ea8a3a54a,0xa59f27b2276ea5f3,0x9cc228eb2301a882,0xa876a59f27d32728,0xa9099fe628d723bf,0x23bfa882a54a2818,0x1a5aa8ffa0b928d0,0x28d72301a8a3a498,0x290d1cc2a8fba0b9,0x9fe628eb217ea8d0,0x965b290b1cc2a8ff,0xa9099cc229031e55,0xa90f965b290d1a5a
.quad 0xa818a8182241290f,0xa8182241290f2241,0x266ba59fa8d70000,0xa4c5a8f69bef28ad,0x276e2850a17ea90f,0x28bf9a5aa8f6a498,0xa74b24f228e58000,0x2056290e21e0a850,0xa692a88220b9290f,0xa90b9e5528ad25f3,0x2809a43da8f10000,0x18c4a8dfa4c527b2,0x259f28ad9fe6a90f,0x28f623bfa835a728,0xa85d230128fb8000,0xa2a1286a266ba692
.quad 0xa498a8d01e55290f,0xa882a5f327282818,0x28a3a17ea9030000,0x25c9a76ea7d3254a,0x230128eb9cc2a90f,0x276e27b2a59fa882,0xa8d71fe629098000,0xa7d3259f2876a3bf,0xa0b9a8ff1a5a290f,0xa54aa88223bf28d0,0x28fb9cc2a90d0000,0x28a3a301a8d720b9,0x1cc2290b965ba90f,0x217e28eb9fe6a8ff,0xa90d165b290f8000,0xa9031cc229099a5a
.quad 0x2241290f2241a818,0x290f2241a818a818,0xa9099fe628762728,0xa1e0283527d3a3bf,0x1cc2a8ada64425f3,0xa835a7b2243d28ff,0x28c8259fa6b9a882,0x27d3a43da8fb9a5a,0xa54a27282850a241,0x23bf28ff1a5aa8d0,0xa74ba835236028ff,0xa9099cc228c8254a,0x2835a3bfa8f60000,0x1fe6a8ada59f2728,0x236028f6925ca8ff,0x28762644a6b9a850
.quad 0xa8ff000028ff2241,0xa72825f32882a241,0x18c4a8f6a2a12882,0xa4c5a8bf2056290b,0x28df23bfa86aa5f3,0x28f69a5aa90e9e55,0xa4c52835266ba728,0x9bef28f621e0a8ad,0xa7b2a72826922818,0xa8ada498285025f3,0x2809a59fa85d2498,0x266ba76ea74b2692,0x243d28ada301a8d0,0x259f2850a4f2a882,0xa8f11fe628fb9e55,0xa8d7217e28e5a0b9
.quad 0x2241a818a8182241,0xa818a8182241290f,0x27d32835a1e0a90f,0x28769fe6a909a3bf,0xa86a20b9290e2241,0x165b28eb24f2a728,0x9d8ca906a3602818,0xa8a3a644261c28ad,0x28eb2498a7b2a818,0x27b2a498a8eb0000,0xa5c926de285da241,0x211c290e1f1ea8ad,0xa59fa8ad1fe6290f,0xa8f6a3bf28352728,0x28f1965ba903a241,0x261ca6dea84323bf
.quad 0x9e5528d02498a818,0x249828d09e55a90f,0xa85da64427032818,0xa90f9cc228e523bf,0x27f2a54aa8982241,0x243da850a6442728,0x21e028f69befa90f,0x266b2835a4c5a8ad,0xa90b9e5528eb2241,0xa8eb1e55290b8000,0x246ba86aa5752818,0x2056a8dfa2a128ad,0x26de27b2a644a818,0x27f22692a76ea728,0xa8b6230128c8a241,0xa88d243d28a3a3bf
.quad 0xa8182241290f2241,0x2241290f2241a818,0x9befa8f6a4c52728,0xa8d7a59f266b28ad,0x28982692a59fa8d0,0x27f2a3bfa9069e55,0xa827230129091e55,0x18c428f6246ba7b2,0x9a5aa8ffa3bf2818,0xa850a728254a28d0,0x288d2644a66ba882,0x28a39fe6a90fa0b9,0xa83523bf28f68000,0x9fe628ad259fa728,0x98c4a906a1e02882,0xa703a835240e28eb
.quad 0x288225f3a728a818,0x28ff8000a8ffa241,0xa843243d28d79e55,0xa46b283526b9a692,0x965ba90b9fe628d0,0xa4f2a8ad217e28ff,0x2876259fa7d3a728,0x29091fe6a8d7a3bf,0xa850249828ada241,0xa692272827b2a5f3,0x925ca90e9bef28ff,0xa11ca8f61d8c290b,0x286a254aa835a5f3,0x28bf23bfa898a498,0xa85d24f22876a498,0xa827259f2843a54a
.quad 0x290f2241a818a818,0x2241a818a8182241,0xa66b259f28d78000,0x24c528f61befa8ad,0x9fe6a90ba3012818,0xa8dfa54a26de2882,0x287626dea575a8d0,0x285da17ea90fa0b9,0xa8ad1e55290b2241,0xa0b928822692a5f3,0x21e0a86aa6b925f3,0xa575a8bf1d8c290b,0x259f28ad9fe6a90f,0x28f623bfa835a728,0xa909a17e288d25f3,0xa827243d28e59a5a
.quad 0x2728a5f3a8822241,0x1e55a8d0a4982818,0x1bef290e1f1ea8d0,0x261c286aa360a8eb,0xa835a69226de2818,0xa906a0b928bf2498,0x28d79fe6a9090000,0x27d3a59fa87623bf,0xa3bf2882254aa818,0x9a5a28ff20b9a8d0,0xa4c5a898236028d0,0xa6b9a7f225c92850,0x28f620b9a8dfa241,0x290e1a5aa9069e55,0xa7d326442809a5f3,0xa74b26de2790a692
.quad 0xa818a8182241290f,0xa8182241290f2241,0x29091fe6a876a728,0x21e0a835a7d323bf,0xa6de254a28df8000,0x2301290b1fe6a882,0x125ca8dfa51e2728,0xa843a76e24c528eb,0x26922882a0b9a90f,0x290b1e55a8ada5f3,0xa903a30128432728,0xa79024f228d79a5a,0x2835a3bfa8f60000,0x1fe6a8ada59f2728,0xa11c289825c9a728,0x246b28df9befa90b
.quad 0xa498a8d01e55290f,0xa882a5f327282818,0x28b624f2a809a728,0x28fb965ba909a0b9,0xa8bf20b929068000,0xa6de26922835a498,0x24c5a835a66b2728,0x1befa8f6a1e028ad,0x20b928ff9a5aa90f,0x254a2882a3bfa8d0,0xa827a64427902728,0xa8b6a43d2876254a,0x29069a5aa90e0000,0x28dfa0b9a8f61e55,0xa6b9276e2703a728,0xa61c27f2266ba7b2
.quad 0x2241290f2241a818,0x290f2241a818a818,0xa7d3a83521e0290f,0xa8761fe6290923bf,0x290623bfa7f2a818,0x259fa692a8981e55,0xa88d1fe6290d2241,0x9bef28bf25c9a692,0x254aa728a8502241,0xa3bfa8ff9a5a28d0,0x125c28f6240ea818,0x27d327f2a46ba8eb,0xa59fa8ad1fe6290f,0xa8f6a3bf28352728,0x28a3259fa74ba818,0x28d79cc2a90da0b9
.quad 0xa8ff000028ff2241,0xa72825f32882a241,0x2790a59fa88d2241,0x21e0a898a57527b2,0xa17e28ad24f2a818,0x1fe6290b165ba8ff,0xa1e0a8f61bef290f,0xa66ba83524c528ad,0x27b22728a692a818,0x28ad2498a850a5f3,0xa9039fe628e52241,0xa909165b290f1a5a,0x2898a3bfa8bf2241,0x2835a54aa86a2498,0xa575283525c9a818,0xa4c5286a251ea850
.quad 0x2241a818a8182241,0xa818a8182241290f,0x1bef28f624c5a728,0x28d7259fa66ba8ad,0xa4f2a8eb965b28d0,0xa90ea0b9286a2728,0x280927f2a40ea8ff,0x28b69cc2a903a3bf,0xa8eba49827b22818,0xa7b2249828eb8000,0x28fb165ba8e5a498,0x251ea76ea82723bf,0xa83523bf28f68000,0x9fe628ad259fa728,0x2575a76ea8092498,0x9d8ca90ea05628ad
.quad 0x9e5528d02498a818,0x249828d09e55a90f,0xa11ca906925c28ff,0xa74ba7f2251e28ad,0x26442850a43da8d0,0x2898254aa7f2a728,0xa876a59f27d32728,0xa9099fe628d723bf,0x290b1e55a8eba241,0x28eb9e55a90b0000,0xa8c8217e28f19e55,0xa84324f2288da3bf,0x276ea692a7f225f3,0x2644a7b2a6de2728,0xa40e2898246ba882,0xa2a128bf2360a8ad
.quad 0xa8182241290f2241,0x2241290f2241a818,0x266ba59fa8d70000,0xa4c5a8f69bef28ad,0xa43d27b22835a241,0x264428ad9cc2a8ff,0x1f1ea898a66b25f3,0xa790a83522a1290b,0x1a5a28ff23bfa818,0x28502728a54aa8d0,0xa2a1a9069bef28d0,0xa8b6a59f27032850,0x259f28ad9fe6a90f,0x28f623bfa835a728,0xa790a7f224c528d0,0xa90f9fe628b6254a
.quad 0x288225f3a728a818,0x28ff8000a8ffa241,0xa8f1a301287625f3,0xa8c81fe6290d1a5a,0x290e1a5aa8f6a241,0x286aa3bfa8df1e55,0xa8d71fe629098000,0xa7d3259f2876a3bf,0x2850a498a8ad2241,0x2692a728a7b225f3,0xa70326de27d3a5f3,0xa51e2835261ca7b2,0x24f2a850a59f2818,0x2301a8ada43d2882,0xa11c28df21e0a8d0,0x9f1e28f62056a8eb
.quad 0x290f2241a818a818,0x2241a818a8182241,0xa9099fe628762728,0xa1e0283527d3a3bf,0x28f61a5aa8bfa5f3,0x217ea850a76e2498,0xa8d7165b28f12498,0xa11c286a2703a54a,0x28ad9e55a90ba241,0x20b9a882a69225f3,0xa876217e290d1e55,0xa0562898261ca692,0x2835a3bfa8f60000,0x1fe6a8ada59f2728,0xa7d324f228c89e55,0x9f1e28bf251ea7b2
.quad 0x2728a5f3a8822241,0x1e55a8d0a4982818,0xa66b26de2827a498,0x9d8c28df240ea850,0x259fa7b2a76e25f3,0x1cc2a8eba3012882,0xa4c52835266ba728,0x9bef28f621e0a8ad,0x23bfa882a54a2818,0x1a5aa8ffa0b928d0,0xa1e028bf240ea882,0x98c429061f1ea8eb,0x1fe6a8eba17e28d0,0x165ba90b9cc228ff,0x9bef29061d8ca8ff,0x925c290e18c4a90b
.quad 0x290f,0x0,0xa90f,0x0,0x290f,0x0,0xa90f,0x0,0x290f,0x0,0xa90f,0x0,0x290f,0x0,0xa90f,0x0
.quad 0x290f,0x0,0xa90f,0x0,0x290f,0x0,0xa90f,0x0,0x290f,0x0,0xa90f,0x0,0x290f,0x0,0xa90f
.zero 776
.quad 0xa241a90fa2412818,0xa90fa24128182818,0xa0eba90ea2d12810,0xa901a454277f2857,0x9f1ea909a3602809,0xa8d7a57526b9288d,0x9c5da901a3ee2801,0xa893a67f25de28bb,0x965ba8f6a43d27f2,0xa835a76e24f228df,0x14c5a8e8a48127e3,0xa77fa81f23ee28f9,0x1befa8d7a4c527d3,0xa66ba87621e02909,0x1eb9a8c4a50827c2,0xa534a8bb1f82290f
.quad 0x20b9a8ada54a27b2,0xa3bfa8eb1a5a290b,0x2211a893a58a27a1,0xa0eba90894c528fd,0x2360a876a5c92790,0x9befa90f9d8c28e5,0x2454a857a607277f,0x17f2a901a0eb28c4,0x24f2a835a644276e,0x1fe6a8dfa3012898,0x258aa810a67f275d,0x22d1a8a8a4812864,0x261ca7d3a6b9274b,0x24c5a85da5752827,0x26a6a77fa6f1273a,0x2607a801a65827c2
.quad 0xa24128182818a241,0x28182818a241a90f,0xa53426cc28939df0,0x260728c497f2a8e8,0xa703251e28e5125c,0x22a1290d2056a876,0xa83c2271290c1f82,0x14c528ee24afa77f,0xa8bf1cc229062301,0xa17e286a26dea59f,0xa9059b2528d42508,0xa58a2716284aa2d1,0xa909a1e02876266b,0xa7d324c528d79bef,0xa8cca4dc27e327a1,0xa8b12025290f1df0
.quad 0xa850a69226922850,0xa90b9a5a28eb23bf,0xa73aa801250828b1,0xa8eea33128702607,0xa575a88d22a128f1,0xa85da61c274b27d3,0xa2d1a8e81df0290e,0xa6cca81025342893,0x9cc2a90e965b2906,0xa43da8bf217e28f6,0x1c5da8fda08828db,0x9d27a90c0e5c290e,0x22a1a8b6a40e288d,0x1f1ea8f1a11c28d7,0x255fa83ca5b4281f,0x24afa870a5082857
.quad 0x2818a241a90fa241,0xa241a90fa2412818,0x28e817f2a8c4a607,0x1df0a893a6cc2534,0x2903240ea7d3a827,0x25c9a66ba8a31d8c,0x28642716a534a8db,0x2870a0eba90fa14d,0x264428989fe6a90e,0x290e1fe6a898a644,0x21af290c1df0a8bb,0x289e2607a6a6a870,0x9bef28d724c5a7d3,0x266b2876a1e0a909,0xa4af2801277fa55f,0x2088290e1d27a8d4
.quad 0xa7b2254a28ada0b9,0xa0b928ad254aa7b2,0xa8cc1f82290e1b25,0xa67f26cc282ea481,0xa90d9f1e28d7240e,0xa8a321e028fb98c4,0xa893a534281026cc,0xa90e9df028e822d1,0xa6dea7f2259f286a,0xa86aa59f27f226de,0xa331a8d420eb28f9,0xa5b4a85724af289e,0x125ca90d9bef2903,0x9d8ca90918c4290f,0x23eea89ea4542888,0x2271a8c4a33128b1
.quad 0xa90fa24128182818,0xa24128182818a241,0xa857a77f24542901,0xa81022d1290e20eb,0xa4c5a8f198c428c8,0xa90fa11c285d274b,0x17f2a8d4a55f26f1,0xa82ea7a1248128f4,0x259fa6dea86a217e,0xa301a9069cc228bf,0x2893a088a90fa025,0x214da87ca67f2630,0x290921e0a876a66b,0x27d3a4c5a8d71bef,0x2810275da58aa8a8,0x290c1c5da8dba481
.quad 0x23bf28eb9a5aa90b,0x28502692a692a850,0x9df028db2425a84a,0x23ee28e29d27a90f,0xa66b27032809a51e,0xa05628c8246ba843,0xa8c420eb290197f2,0xa77f26072857a454,0xa8f6a17e28bf243d,0xa906165b290e1cc2,0xa77fa73a26a62801,0xa870a55f281f2658,0xa1e0a8e5205628fb,0xa46ba8a3236028c8,0x20eba8e2a1af28d4,0x1eb9a8f9a02528ee
.quad 0x28182818a241a90f,0x2818a241a90fa241,0x20eb290e22d1a810,0x29012454a77fa857,0xa46b27902843a1e0,0x261c28b69befa8fb,0xa89e1eb9290a22d1,0x9d2728b12607a658,0xa8dfa4f2276e2835,0xa7f2243d28f6165b,0xa5b4a8b11eb9290e,0xa908a271285726f1,0x1befa8d7a4c527d3,0xa66ba87621e02909,0x273aa5b4a89e20eb,0x1b25a8e2a454281f
.quad 0x290b1a5aa8eba3bf,0x27b2a54aa8ad20b9,0x281f26f1a658a857,0x290c2025a8c4a4af,0x211c2903925ca909,0x26b92827a4c5a8b6,0xa45428572607a77f,0x97f2290120eba8c4,0xa898230128df9fe6,0xa76e26442835a4f2,0xa8e2a27128b12454,0xa90f9b2529012025,0xa5c9a843251e2876,0xa703a790266b2809,0x1b25a9089d272901,0xe5ca90f97f2290c
.quad 0xa241a90fa2412818,0xa90fa24128182818,0x2534a6cca8931df0,0xa607a8c417f228e8,0x28fb1befa8b6a61c,0x21e0a843a790246b,0x27e32810a390a905,0x28c49b25a8fda425,0x165b28f6243da7f2,0x2835276ea4f2a8df,0xa75d253428cc9c5d,0x17f228fd2390a82e,0xa909a1e02876266b,0xa7d324c528d79bef,0xa5dea893214d290a,0xa8e8a425282e2716
.quad 0x20b9a8ada54a27b2,0xa3bfa8eb1a5a290b,0x287ca2d1a8f4198f,0x2534a7e3a75d25de,0x28b624c5a827a6b9,0x2909125ca903a11c,0x22d128e89df0a90e,0x26cc2810a534a893,0xa4f228352644a76e,0x9fe628df2301a898,0xa8f41df0290a94c5,0xa893239028cca14d,0xa809a66b27902703,0xa876a51e284325c9,0x998fa90e14c5290f,0x9df0a9051c5d290a
.quad 0xa24128182818a241,0x28182818a241a90f,0xa8e897f228c42607,0x9df0289326cca534,0xa74ba85d211c290f,0xa8c818c428f124c5,0x2025a888a6a625b4,0xa75da84a2211290e,0x28bf9cc2a906a301,0x217ea86aa6de259f,0x280127c2a4afa8e2,0x28f40e5ca8eea454,0x9bef28d724c5a7d3,0x266b2876a1e0a909,0xa88821af2908198f,0xa3ee283c26f1a607
.quad 0xa850a69226922850,0xa90b9a5a28eb23bf,0x8e5ca905a14d28a8,0xa55fa89e21af2901,0x2843a46ba8c82056,0x251ea809a703266b,0x28932534a810a6cc,0x290e1df0a8e8a2d1,0x1cc2290e165ba906,0x243d28bfa17ea8f6,0xa7e325de284aa4dc,0xa63027a12716a6cc,0xa8c8a36028a3246b,0xa8fba05628e521e0,0xa088a8f41f8228fd,0xa211a8db214d28e8
.quad 0x2818a241a90fa241,0xa241a90fa2412818,0x2857277fa454a901,0x2810a2d1a90ea0eb,0x9d8c28a3266ba5c9,0x282727d3a40ea903,0xa8e20e5c28e824dc,0xa1af2857273aa508,0xa644a8981fe6290e,0xa90e9fe628982644,0x24dca7a1a8102425,0xa331a901998f28db,0x290921e0a876a66b,0x27d3a4c5a8d71bef,0x2211290517f2a8ee,0x284a26cca630a87c
.quad 0xa7b2254a28ada0b9,0xa0b928ad254aa7b2,0xa888a5b4277f27c2,0xa90a97f228f92271,0x18c4a8fba1e028a3,0xa40ea8d71f1e290d,0x28c4a0eba90117f2,0x277fa607a8572454,0x26de27f2a59fa86a,0x286a259fa7f2a6de,0xa425287c2534a82e,0x9f8228e82211a8bb,0xa90f98c429091d8c,0xa9031bef290d925c,0xa390a8bb22d128cc,0xa481a893242528a8
.quad 0xa90fa24128182818,0xa24128182818a241,0xa0eba90ea2d12810,0xa901a454277f2857,0x2876a056a90da2a1,0x925ca8e5a51e2703,0x26cc287ca088a90f,0x28f9198fa8cca58a,0xa59f26de286aa17e,0x230129061cc2a8bf,0xa8c4a55f273a283c,0xa8642211290a1d27,0x1befa8d7a4c527d3,0xa66ba87621e02909,0x290114c5a8f4a390,0x26a6a658a8702271
.quad 0x23bf28eb9a5aa90b,0x28502692a692a850,0xa81024dc28bba088,0xa39028642630a716,0xa7d3a74b261c285d,0xa8f1a2a1288d2575,0x2454a857a607277f,0x17f2a901a0eb28c4,0x28f6217ea8bfa43d,0x2906965ba90e9cc2,0x17f2290f198fa905,0x21af28ee9eb9a908,0xa8d7211c28f19f1e,0xa88d240e28b6a2a1,0xa534a86424dc287c,0xa5dea82e258a284a
.quad 0x28182818a241a90f,0x2818a241a90fa241,0xa53426cc28939df0,0x260728c497f2a8e8,0xa88da6b9257528d7,0xa809236029091f1e,0x2331a81fa7c22454,0xa630a8a81df02908,0x28df24f2a76ea835,0x27f2a43da8f6965b,0x9f8228a825dea6cc,0x26582888a0eba90f,0xa909a1e02876266b,0xa7d324c528d79bef,0xe5ca8f9a3312857,0xa67fa86422d128fd
.quad 0x290b1a5aa8eba3bf,0x27b2a54aa8ad20b9,0x1eb9290f1c5da8e8,0x26a6283ca454a8d4,0xa8e51d8c290f1bef,0xa79025c92876a360,0xa2d1a8e81df0290e,0xa6cca81025342893,0x2898a301a8df1fe6,0x276ea644a83524f2,0x25082888a3eea8c4,0x26f127c2a607a83c,0xa8272575285da4c5,0xa74b26b927d3a61c,0xa67fa7e326302810,0xa716a75d26cc27a1
.quad 0xa241a90fa2412818,0xa90fa24128182818,0x28e817f2a8c4a607,0x1df0a893a6cc2534,0x1f1e29092360a809,0x28d72575a6b9a88d,0xa9089df028a82630,0xa45427c2281fa331,0x965ba8f6a43d27f2,0xa835a76e24f228df,0x290f20eba888a658,0x26cca5dea8a81f82,0x9bef28d724c5a7d3,0x266b2876a1e0a909,0xa8fda2d12864267f,0xa857233128f98e5c
.quad 0x20b9a8ada54a27b2,0xa3bfa8eb1a5a290b,0x28d42454a83ca6a6,0x28e89c5da90f9eb9,0xa360287625c9a790,0x1bef290f1d8ca8e5,0xa893a534281026cc,0xa90e9df028e822d1,0x24f2a835a644276e,0x1fe6a8dfa3012898,0x283c2607a7c2a6f1,0x28c423eea888a508,0xa61c27d326b9a74b,0xa4c5285d2575a827,0xa7a1a6cc275d2716,0xa810a63027e3267f
.quad 0xa24128182818a241,0x28182818a241a90f,0xa857a77f24542901,0xa81022d1290e20eb,0x2703a51ea8e5925c,0xa2a1a90da0562876,0x258a28cc998fa8f9,0x290f2088a87ca6cc,0xa8bf1cc229062301,0xa17e286a26dea59f,0x9d27a90aa2112864,0xa83ca73a255f28c4,0x290921e0a876a66b,0x27d3a4c5a8d71bef,0xa27128702658a6a6,0x239028f494c5a901
.quad 0xa850a69226922850,0xa90b9a5a28eb23bf,0x2716a630a8642390,0x2088a8bba4dc2810,0x2575288da2a1a8f1,0x285d261ca74ba7d3,0xa8c420eb290197f2,0xa77f26072857a454,0x9cc2a90e965b2906,0xa43da8bf217e28f6,0x29081eb9a8eea1af,0x2905998fa90f97f2,0xa2a128b6240ea88d,0x9f1e28f1211ca8d7,0xa84aa58a282e25de,0xa87ca4dc28642534
.quad 0x2818a241a90fa241,0xa241a90fa2412818,0x20eb290e22d1a810,0x29012454a77fa857,0xa903a40e27d32827,0xa5c9266b28a39d8c,0x2508a73aa85721af,0xa4dca8e88e5c28e2,0x264428989fe6a90e,0x290e1fe6a898a644,0xa8db198f29012331,0xa425281027a1a4dc,0x1befa8d7a4c527d3,0xa66ba87621e02909,0x287c2630a6cca84a,0x28ee97f2a905a211
.quad 0xa7b2254a28ada0b9,0xa0b928ad254aa7b2,0xa271a8f917f2290a,0xa7c2a77f25b42888,0x290d1f1ea8d7a40e,0x28a3a1e0a8fb18c4,0xa45428572607a77f,0x97f2290120eba8c4,0xa6dea7f2259f286a,0xa86aa59f27f226de,0x28bba211a8e81f82,0x282ea534a87c2425,0x925c290d1befa903,0x1d8c290998c4a90f,0xa8a8a42528932481,0xa8cca2d128bb2390
.quad 0xa90fa24128182818,0xa24128182818a241,0x2534a6cca8931df0,0xa607a8c417f228e8,0x24c528f118c4a8c8,0x290f211ca85da74b,0xa90ea211284a275d,0xa5b426a62888a025,0x259fa6dea86a217e,0xa301a9069cc228bf,0x245428ee8e5ca8f4,0x28e224afa7c2a801,0xa909a1e02876266b,0xa7d324c528d79bef,0x2607a6f1a83c23ee,0x998fa908a1af2888
.quad 0x23bf28eb9a5aa90b,0x28502692a692a850,0xa901a1af289e255f,0xa8a8214d29050e5c,0x266ba703a809251e,0x2056a8c8a46b2843,0x22d128e89df0a90e,0x26cc2810a534a893,0xa8f6a17e28bf243d,0xa906165b290e1cc2,0x26cca716a7a12630,0x24dca84aa5de27e3,0x21e028e5a056a8fb,0x246b28a3a360a8c8,0xa8e8a14d28db2211,0xa8fd9f8228f42088
.quad 0x28182818a241a90f,0x2818a241a90fa241,0xa8e897f228c42607,0x9df0289326cca534,0x246ba790a84321e0,0xa61ca8b61bef28fb,0x242528fd1b25a8c4,0x29052390a810a7e3,0xa8dfa4f2276e2835,0xa7f2243d28f6165b,0x282ea390a8fd97f2,0x1c5da8cca534275d,0x9bef28d724c5a7d3,0x266b2876a1e0a909,0xa716a82e242528e8,0xa90aa14d289325de
.quad 0x290b1a5aa8eba3bf,0x27b2a54aa8ad20b9,0xa5de275d27e3a534,0x998f28f422d1a87c,0xa11ca903125c2909,0xa6b9a82724c528b6,0x28932534a810a6cc,0x290e1df0a8e8a2d1,0xa898230128df9fe6,0xa76e26442835a4f2,0x214da8cca3902893,0x14c5a90a9df028f4,0x25c92843a51ea876,0x27032790a66ba809,0xa90a9c5d29051df0,0xa90f94c5290e198f
.quad 0xa241a90fa2412818,0xa90fa24128182818,0x2857277fa454a901,0x2810a2d1a90ea0eb,0xa8fb9bef28b6261c,0xa1e028432790a46b,0x2658a607a8b11d27,0xa2d1a90a9eb9289e,0x165b28f6243da7f2,0x2835276ea4f2a8df,0xa6f1a85722712908,0xa90e9eb928b125b4,0x290921e0a876a66b,0x27d3a4c5a8d71bef,0xa81f245428e29b25,0xa0eb289e25b4a73a
.quad 0x20b9a8ada54a27b2,0xa3bfa8eb1a5a290b,0x24af28c4a025a90c,0x28572658a6f1a81f,0xa8b6a4c5282726b9,0xa909925c2903211c,0x28c4a0eba90117f2,0x277fa607a8572454,0xa4f228352644a76e,0x9fe628df2301a898,0xa025a9011b25290f,0xa454a8b1227128e2,0x2809266ba790a703,0x2876251ea843a5c9,0xa90c17f2290f8e5c,0xa9011d2729089b25
.quad 0xa24128182818a241,0x28182818a241a90f,0xa0eba90ea2d12810,0xa901a454277f2857,0x274b285da11ca90f,0x28c898c4a8f1a4c5,0xa8f4a48127a1282e,0xa6f1255f28d497f2,0x28bf9cc2a906a301,0x217ea86aa6de259f,0xa630267f287ca14d,0x2025290f2088a893,0x1befa8d7a4c527d3,0xa66ba87621e02909,0x248128db9c5da90c,0x28a8258aa75da810
.quad 0xa850a69226922850,0xa90b9a5a28eb23bf,0x290f1d27a8e2a3ee,0x284aa425a8db1df0,0xa843246b28c8a056,0xa51e28092703a66b,0x2454a857a607277f,0x17f2a901a0eb28c4,0x1cc2290e165ba906,0x243d28bfa17ea8f6,0xa658a81f255f2870,0xa801a6a6273a277f,0x28c82360a8a3a46b,0x28fb2056a8e5a1e0,0xa8ee202528f99eb9,0xa8d421af28e2a0eb
.quad 0x2818a241a90fa241,0xa241a90fa2412818,0xa53426cc28939df0,0x260728c497f2a8e8,0x1d8ca8a3a66b25c9,0xa827a7d3240e2903,0x214d290f20eba870,0x28db2534a716a864,0xa644a8981fe6290e,0xa90e9fe628982644,0x287026a6a607a89e,0x28bb9df0a90ca1af,0xa909a1e02876266b,0xa7d324c528d79bef,0x28d49d27a90ea088,0x255fa77fa80124af
.quad 0xa7b2254a28ada0b9,0xa0b928ad254aa7b2,0x2481a82ea6cc267f,0x9b25a90e9f8228cc,0x98c428fb21e0a8a3,0x240e28d79f1ea90d,0xa2d1a8e81df0290e,0xa6cca81025342893,0x26de27f2a59fa86a,0x286a259fa7f2a6de,0xa89ea4af285725b4,0xa8f9a0eb28d42331,0x290f18c4a9099d8c,0x29039befa90d125c,0xa8b1233128c4a271,0xa8882454289ea3ee
.quad 0xa90fa24128182818,0xa24128182818a241,0x28e817f2a8c4a607,0x1df0a893a6cc2534,0xa8762056290d22a1,0x125c28e5251ea703,0x277fa4afa8ee94c5,0x9f82a90ca271283c,0xa59f26de286aa17e,0x230129061cc2a8bf,0x22d1a84aa716258a,0xa508a8d41b252905,0x9bef28d724c5a7d3,0x266b2876a1e0a909,0x9df0a90fa02528b1,0xa7a1a7e324dc28cc
.quad 0x23bf28eb9a5aa90b,0x28502692a692a850,0xa607a870233128ee,0xa8b1a5082801273a,0x27d3274ba61ca85d,0x28f122a1a88da575,0xa893a534281026cc,0xa90e9df028e822d1,0x28f6217ea8bfa43d,0x2906965ba90e9cc2,0xa90e8e5c290c1d27,0xa8db208828fd9c5d,0x28d7a11ca8f11f1e,0x288da40ea8b622a1,0xa85725082870a4af,0xa81f25b4283ca55f
.quad 0x28182818a241a90f,0x2818a241a90fa241,0xa857a77f24542901,0xa81022d1290e20eb,0x288d26b9a575a8d7,0x2809a360a9099f1e,0xa8bba5de267f2893,0xa80123ee29011c5d,0x28df24f2a76ea835,0x27f2a43da8f6965b,0xa8f9a3ee281f277f,0xa7e3248128e894c5,0x290921e0a876a66b,0x27d3a4c5a8d71bef,0xa90f9f8228bb2534,0xa7c2250828c49eb9
.quad 0x290b1a5aa8eba3bf,0x27b2a54aa8ad20b9,0xa8fd14c5290820eb,0xa7a1258a2893a211,0x28e59d8ca90f9bef,0x2790a5c9a8762360,0xa8c420eb290197f2,0xa77f26072857a454,0x2898a301a8df1fe6,0x276ea644a83524f2,0xa864248128a8a2d1,0xa75d267f2810a58a,0x2827a575a85d24c5,0x274ba6b9a7d3261c,0xa7c226582801a607,0xa73a26f1277fa6a6
.quad 0xa5f325f328d00000,0x25f328d00000a8d0,0xa66b259f28d70000,0x24c528f61befa8ad,0xa6de254a28df0000,0x2301290b1fe6a882,0xa74b24f228e50000,0x2056290e21e0a850,0xa7b2249828eb0000,0x1a5a28ff23bfa818,0xa809243d28f10000,0x98c428df24c5a7b2,0xa83523bf28f60000,0x9fe628ad259fa728,0xa85d230128fb0000,0xa2a1286a266ba692
.quad 0xa882224128ff0000,0xa49828182728a5f3,0xa8a3217e29030000,0xa5c9276e27d3a54a,0xa8bf20b929060000,0xa6de26922835a498,0xa8d71fe629090000,0xa7d3259f2876a3bf,0xa8eb1e55290b0000,0xa850249828ada241,0xa8fb1cc2290d0000,0xa8a3230128d7a0b9,0xa9061a5a290e0000,0xa8df20b928f69e55,0xa90d165b290f0000,0xa9031cc229099a5a
.quad 0x28d00000a8d0a5f3,0xa8d0a5f325f3,0x29091fe6a876a728,0x21e0a835a7d323bf,0x290623bfa7f2a818,0x259fa692a8981e55,0x28c8259fa6b9a882,0x27d3a43da8fb9a5a,0x28502728a54aa8d0,0x28ad9e55a90ba241,0x274b2835a360a8ff,0x29091cc2a8c8a54a,0x259f28ad9fe6a90f,0x28f623bfa835a728,0x236028f6925ca8ff,0x28762644a6b9a850
.quad 0x1e55290f1e55a8d0,0x27282818a498a8d0,0x98c428f622a1a882,0x24c528bfa056a90b,0xa17e28ad24f2a818,0x1fe6290b165ba8ff,0xa4c52835266ba728,0x9bef28f621e0a8ad,0xa692272827b2a5f3,0xa3bf2882254aa818,0xa809259f285da498,0xa66b276e274ba692,0xa89823bf28bfa241,0xa835254a286aa498,0xa8f11fe628fb9e55,0xa8d7217e28e5a0b9
.quad 0xa8d0a5f325f328d0,0xa5f325f328d00000,0xa7d3a83521e0290f,0xa8761fe6290923bf,0xa4f2a8eb965b28d0,0xa90ea0b9286a2728,0x9d8ca906a3602818,0xa8a3a644261c28ad,0x20b9a882a69225f3,0xa692a88220b9290f,0x25c9a6dea85d2241,0xa11ca90e9f1e28ad,0x2835a3bfa8f60000,0x1fe6a8ada59f2728,0x28f1965ba903a241,0x261ca6dea84323bf
.quad 0x28ff2241a882a5f3,0x2882a241a8ff0000,0x285d2644a703a818,0x290f1cc2a8e5a3bf,0x26442850a43da8d0,0x2898254aa7f2a728,0x21e028f69befa90f,0x266b2835a4c5a8ad,0x9a5a28ff20b9a8d0,0x20b928ff9a5aa90f,0xa46b286a2575a818,0xa05628df22a1a8ad,0xa76e269227f2a5f3,0xa64427b226dea728,0xa8b6230128c8a241,0xa88d243d28a3a3bf
.quad 0x25f328d00000a8d0,0x28d00000a8d0a5f3,0x1bef28f624c5a728,0x28d7259fa66ba8ad,0xa43d27b22835a241,0x264428ad9cc2a8ff,0xa827230129091e55,0x18c428f6246ba7b2,0xa90b9e5528ad25f3,0xa54a27282850a241,0xa88da644266b2882,0xa8a31fe6290f20b9,0xa59fa8ad1fe6290f,0xa8f6a3bf28352728,0x98c4a906a1e02882,0xa703a835240e28eb
.quad 0x2498a818a72825f3,0x9e55a90f9e5528d0,0x2843a43da8d71e55,0x246ba835a6b92692,0x290e1a5aa8f6a241,0x286aa3bfa8df1e55,0x2876259fa7d3a728,0x29091fe6a8d7a3bf,0x254a2882a3bfa8d0,0x27b22728a692a818,0x125c290e1befa8ff,0x211c28f69d8ca90b,0xa4f22850259fa818,0xa30128ad243da882,0xa85d24f22876a498,0xa827259f2843a54a
.quad 0xa8d0a5f325f3,0xa8d0a5f325f328d0,0x266ba59fa8d70000,0xa4c5a8f69bef28ad,0x28f61a5aa8bfa5f3,0x217ea850a76e2498,0x287626dea575a8d0,0x285da17ea90fa0b9,0x23bf28ff1a5aa8d0,0x28eb2498a7b2a818,0xa1e0286a26b9a5f3,0x257528bf9d8ca90b,0xa83523bf28f60000,0x9fe628ad259fa728,0xa909a17e288d25f3,0xa827243d28e59a5a
.quad 0xa728a818249828d0,0xa8ffa241288225f3,0x9befa90e9f1e28d0,0xa61ca86a236028eb,0x259fa7b2a76e25f3,0x1cc2a8eba3012882,0x28d79fe6a9090000,0x27d3a59fa87623bf,0x28ad2498a850a5f3,0x290b1e55a8eba241,0x24c52898a360a8d0,0x26b927f2a5c9a850,0x9fe628eb217ea8d0,0x965b290b1cc2a8ff,0xa7d326442809a5f3,0xa74b26de2790a692
.quad 0xa5f325f328d00000,0x25f328d00000a8d0,0xa9099fe628762728,0xa1e0283527d3a3bf,0xa76ea850217e290f,0xa8bf1a5a28f62498,0x125ca8dfa51e2728,0xa843a76e24c528eb,0x27b2a498a8eb0000,0x9a5aa8ffa3bf2818,0x29032301a843a728,0x2790a4f2a8d71a5a,0x259f28ad9fe6a90f,0x28f623bfa835a728,0xa11c289825c9a728,0x246b28df9befa90b
.quad 0xa882224128ff0000,0xa49828182728a5f3,0xa8b6a4f228092728,0xa8fb165b290920b9,0xa301a8eb1cc2290f,0xa76ea7b2259f2882,0x24c5a835a66b2728,0x1befa8f6a1e028ad,0x28eb9e55a90b0000,0x2850a498a8ad2241,0x28272644a790a728,0x28b6243da876a54a,0x1cc2290b965ba90f,0x217e28eb9fe6a8ff,0xa6b9276e2703a728,0xa61c27f2266ba7b2
.quad 0x28d00000a8d0a5f3,0xa8d0a5f325f3,0x27d32835a1e0a90f,0x28769fe6a909a3bf,0x9cc228ad2644a5f3,0x283527b2a43da8ff,0xa88d1fe6290d2241,0x9bef28bf25c9a692,0xa850a728254a28d0,0xa8ad1e55290b2241,0x925ca8f6a40e2818,0xa7d3a7f2246b28eb,0x2835a3bfa8f60000,0x1fe6a8ada59f2728,0x28a3259fa74ba818,0x28d79cc2a90da0b9
.quad 0x1e55290f1e55a8d0,0x27282818a498a8d0,0xa790259f288da241,0xa1e028982575a7b2,0xa8dfa3bf286a25f3,0xa8f61a5a290e1e55,0xa1e0a8f61bef290f,0xa66ba83524c528ad,0x2692a728a7b225f3,0x23bfa882a54a2818,0x29031fe6a8e5a241,0x2909965ba90f9a5a,0x243d28ada301a8d0,0x259f2850a4f2a882,0xa575283525c9a818,0xa4c5286a251ea850
.quad 0xa8d0a5f325f328d0,0xa5f325f328d00000,0x9befa8f6a4c52728,0xa8d7a59f266b28ad,0x286aa0b9a90ea241,0x965ba8eba4f22728,0x280927f2a40ea8ff,0x28b69cc2a903a3bf,0xa0b928822692a5f3,0x26922882a0b9a90f,0xa8fb965b28e52498,0xa51e276e2827a3bf,0xa59fa8ad1fe6290f,0xa8f6a3bf28352728,0x2575a76ea8092498,0x9d8ca90ea05628ad
.quad 0x28ff2241a882a5f3,0x2882a241a8ff0000,0x211c2906125ca8ff,0x274b27f2a51ea8ad,0xa7f2254a2898a241,0xa43d28502644a728,0xa876a59f27d32728,0xa9099fe628d723bf,0x1a5aa8ffa0b928d0,0xa0b9a8ff1a5a290f,0x28c8a17ea8f11e55,0x2843a4f2a88d23bf,0x26de27b2a644a818,0x27f22692a76ea728,0xa40e2898246ba882,0xa2a128bf2360a8ad
.quad 0x25f328d00000a8d0,0x28d00000a8d0a5f3,0xa66b259f28d70000,0x24c528f61befa8ad,0xa898a692259f28d0,0xa7f223bf29061e55,0x1f1ea898a66b25f3,0xa790a83522a1290b,0x290b1e55a8ada5f3,0x254aa728a8502241,0x22a129061befa8d0,0x28b6259fa703a850,0xa83523bf28f60000,0x9fe628ad259fa728,0xa790a7f224c528d0,0xa90f9fe628b6254a
.quad 0x2498a818a72825f3,0x9e55a90f9e5528d0,0x28f12301a876a5f3,0x28c89fe6a90d9a5a,0x165b290b1fe6a8d0,0x24f228ada17ea8ff,0xa8d71fe629090000,0xa7d3259f2876a3bf,0xa54aa88223bf28d0,0xa7b2a72826922818,0x2703a6dea7d325f3,0x251ea835a61c27b2,0x286a254aa835a5f3,0x28bf23bfa898a498,0xa11c28df21e0a8d0,0x9f1e28f62056a8eb
.quad 0xa8d0a5f325f3,0xa8d0a5f325f328d0,0x29091fe6a876a728,0x21e0a835a7d323bf,0x1fe6290b2301a818,0x28df254aa6dea882,0xa8d7165b28f12498,0xa11c286a2703a54a,0xa3bfa8ff9a5a28d0,0xa8eba49827b22818,0x2876a17ea90d9e55,0x2056a898a61c2692,0x259f28ad9fe6a90f,0x28f623bfa835a728,0xa7d324f228c89e55,0x9f1e28bf251ea7b2
.quad 0xa728a818249828d0,0xa8ffa241288225f3,0x266ba6dea8272498,0x1d8ca8dfa40e2850,0x28352692a6dea818,0x290620b9a8bfa498,0xa4c52835266ba728,0x9bef28f621e0a8ad,0xa8ada498285025f3,0xa90b9e5528eb2241,0x21e0a8bfa40e2882,0x18c4a9069f1e28eb,0x28f620b9a8dfa241,0x290e1a5aa9069e55,0x9bef29061d8ca8ff,0x925c290e18c4a90b
.quad 0xa5f325f328d00000,0x25f328d00000a8d0,0xa7d3a83521e0290f,0xa8761fe6290923bf,0x26dea54aa8df0000,0xa301a90b9fe62882,0x2703286aa11ca90f,0x28f1165ba8d7a54a,0xa7b2249828eb0000,0x1a5a28ff23bfa818,0xa61ca8982056290f,0xa90da17e28762692,0x2835a3bfa8f60000,0x1fe6a8ada59f2728,0x251e28bf9f1ea90f,0x28c824f2a7d3a7b2
.quad 0xa882224128ff0000,0xa49828182728a5f3,0xa40ea8df1d8c290f,0xa827a6de266b2850,0x28bfa0b9a9060000,0x26dea692a8352498,0x21e028f69befa90f,0x266b2835a4c5a8ad,0xa8eb1e55290b0000,0xa850249828ada241,0x9f1ea90618c4290f,0xa40ea8bf21e028eb,0x29069a5aa90e0000,0x28dfa0b9a8f61e55,0x18c4290e925ca90f,0x1d8c29069befa90b
.quad 0x28d00000a8d0a5f3,0xa8d0a5f325f3,0x1bef28f624c5a728,0x28d7259fa66ba8ad,0xa906a3bf27f22818,0xa59f269228989e55,0x22a1a835a7902498,0xa66ba8981f1e290b,0x28502728a54aa8d0,0x28ad9e55a90ba241,0xa703259f28b69e55,0x1bef290622a1a850,0xa59fa8ad1fe6290f,0xa8f6a3bf28352728,0x28b69fe6a90f9e55,0x24c5a7f2a790254a
.quad 0x1e55290f1e55a8d0,0x27282818a498a8d0,0xa90d9fe628c82498,0xa876230128f19a5a,0x217ea8ada4f22818,0x9fe6a90b965b28ff,0x2876259fa7d3a728,0x29091fe6a8d7a3bf,0xa692272827b2a5f3,0xa3bf2882254aa818,0xa61ca835251e2882,0xa7d3a6de270327b2,0x2898a3bfa8bf2241,0x2835a54aa86a2498,0x205628f69f1ea8ff,0x21e028dfa11ca8eb
.quad 0xa8d0a5f325f328d0,0xa5f325f328d00000,0x266ba59fa8d70000,0xa4c5a8f69bef28ad,0x24f228eb165ba8d0,0x290e20b9a86aa728,0xa9039cc228b625f3,0xa40e27f22809a3bf,0x20b9a882a69225f3,0xa692a88220b9290f,0x2827276ea51ea8d0,0x28e5965ba8fba3bf,0xa83523bf28f60000,0x9fe628ad259fa728,0xa056a90e9d8c28d0,0xa809a76e257528ad
.quad 0x28ff2241a882a5f3,0x2882a241a8ff0000,0xa51e27f2274ba5f3,0x125c2906211ca8ad,0xa644a850243d28d0,0xa898a54a27f22728,0x28d79fe6a9090000,0x27d3a59fa87623bf,0x9a5a28ff20b9a8d0,0x20b928ff9a5aa90f,0xa88da4f2284325f3,0xa8f1a17e28c823bf,0x276ea692a7f225f3,0x2644a7b2a6de2728,0x236028bfa2a1a8d0,0x246b2898a40ea8ad
.quad 0x25f328d00000a8d0,0x28d00000a8d0a5f3,0xa9099fe628762728,0xa1e0283527d3a3bf,0x243da7b2a8352241,0xa644a8ad1cc228ff,0x25c928bf9befa8ff,0x290d1fe6a88da692,0xa90b9e5528ad25f3,0xa54a27282850a241,0x246ba7f2a7d32498,0xa40ea8f6925c28eb,0x259f28ad9fe6a90f,0x28f623bfa835a728,0xa90d9cc228d72498,0xa74b259f28a3a0b9
.quad 0x2498a818a72825f3,0x9e55a90f9e5528d0,0x25752898a1e0a8ff,0x288d259fa790a7b2,0xa90e9a5a28f62241,0xa86a23bf28df9e55,0x24c5a835a66b2728,0x1befa8f6a1e028ad,0x254a2882a3bfa8d0,0x27b22728a692a818,0xa90f965b29091e55,0xa8e51fe629039a5a,0x24f2a850a59f2818,0x2301a8ada43d2882,0x251e286aa4c5a882,0x25c92835a575a850
.quad 0xa8d0a5f325f3,0xa8d0a5f325f328d0,0x27d32835a1e0a90f,0x28769fe6a909a3bf,0xa8f69a5a28bf25f3,0xa17e2850276ea498,0x24c5a76ea8432241,0xa51ea8df125c28eb,0x23bf28ff1a5aa8d0,0x28eb2498a7b2a818,0xa8d7a4f227902818,0xa843230129031a5a,0x2835a3bfa8f60000,0x1fe6a8ada59f2728,0x9bef28df246ba818,0x25c92898a11ca90b
.quad 0xa728a818249828d0,0xa8ffa241288225f3,0x2909165ba8fba241,0x2809a4f2a8b620b9,0xa59f27b2276ea5f3,0x9cc228eb2301a882,0xa1e0a8f61bef290f,0xa66ba83524c528ad,0x28ad2498a850a5f3,0x290b1e55a8eba241,0xa876243d28b6a241,0xa79026442827a54a,0x1fe6a8eba17e28d0,0x165ba90b9cc228ff,0x266b27f2a61ca818,0x2703276ea6b9a7b2
.quad 0xa5f325f328d00000,0x25f328d00000a8d0,0x9befa8f6a4c52728,0xa8d7a59f266b28ad,0x276e2850a17ea90f,0x28bf9a5aa8f6a498,0xa90fa17e285d2728,0xa57526de2876a0b9,0x27b2a498a8eb0000,0x9a5aa8ffa3bf2818,0x9d8c28bf2575a728,0x26b9286aa1e0a90b,0xa59fa8ad1fe6290f,0xa8f6a3bf28352728,0x28e5243da827a728,0x288da17ea9099a5a
.quad 0xa882224128ff0000,0xa49828182728a5f3,0x2360a86aa61c2728,0x9f1ea90e9bef28eb,0x230128eb9cc2a90f,0x276e27b2a59fa882,0xa876a59f27d32728,0xa9099fe628d723bf,0x28eb9e55a90b0000,0x2850a498a8ad2241,0xa5c927f226b9a728,0xa360289824c5a850,0x9cc2a90b165b290f,0xa17ea8eb1fe628ff,0x279026dea74ba728,0x28092644a7d3a692
.quad 0x28d00000a8d0a5f3,0xa8d0a5f325f3,0xa66b259f28d70000,0x24c528f61befa8ad,0x1cc2a8ada64425f3,0xa835a7b2243d28ff,0x246b28f618c4a8d0,0x29092301a827a7b2,0xa850a728254a28d0,0xa8ad1e55290b2241,0x290f1fe6a8a3a5f3,0x266ba644a88d20b9,0xa83523bf28f60000,0x9fe628ad259fa728,0x240ea835a70325f3,0xa1e0a90698c428eb
.quad 0x1e55290f1e55a8d0,0x27282818a498a8d0,0xa6b9a835246b28d0,0xa8d7a43d28432692,0x28df23bfa86aa5f3,0x28f69a5aa90e9e55,0xa8d71fe629090000,0xa7d3259f2876a3bf,0x2692a728a7b225f3,0x23bfa882a54a2818,0x9d8c28f6211ca8d0,0x1bef290e125ca90b,0xa43da8ad230128d0,0xa59fa85024f22882,0x2843259fa827a5f3,0x287624f2a85da54a
.quad 0xa8d0a5f325f328d0,0xa5f325f328d00000,0x29091fe6a876a728,0x21e0a835a7d323bf,0xa86a20b9290e2241,0x165b28eb24f2a728,0x261ca644a8a31e55,0xa360a9069d8c28ad,0xa0b928822692a5f3,0x26922882a0b9a90f,0x9f1ea90ea11c2882,0xa85da6de25c928ad,0x259f28ad9fe6a90f,0x28f623bfa835a728,0xa843a6de261c2882,0xa903965b28f123bf
.quad 0x28ff2241a882a5f3,0x2882a241a8ff0000,0xa8e51cc2290f1e55,0xa7032644285da3bf,0x27f2a54aa8982241,0x243da850a6442728,0xa4c52835266ba728,0x9bef28f621e0a8ad,0x1a5aa8ffa0b928d0,0xa0b9a8ff1a5a290f,0x22a128dfa056a8ff,0x2575286aa46ba8ad,0xa6dea7b226442818,0xa7f2a692276e2728,0x28a3243da88da498,0x28c82301a8b6a3bf
.quad 0x25f328d00000a8d0,0x28d00000a8d0a5f3,0xa7d3a83521e0290f,0xa8761fe6290923bf,0x28982692a59fa8d0,0x27f2a3bfa9069e55,0xa8fba43d27d32818,0xa6b9259f28c89a5a,0x290b1e55a8ada5f3,0x254aa728a8502241,0xa8c81cc229092241,0xa3602835274ba54a,0x2835a3bfa8f60000,0x1fe6a8ada59f2728,0xa6b926442876a241,0x925c28f62360a850
.quad 0x2498a818a72825f3,0x9e55a90f9e5528d0,0xa05628bf24c5a818,0x22a128f698c4a90b,0x965ba90b9fe628d0,0xa4f2a8ad217e28ff,0x21e028f69befa90f,0x266b2835a4c5a8ad,0xa54aa88223bf28d0,0xa7b2a72826922818,0x274b276ea66ba818,0x285d259fa809a692,0xa86aa54a283525f3,0xa8bfa3bf28982498,0x28e5217ea8d7a241,0x28fb1fe6a8f1a0b9
.quad 0xa8d0a5f325f3,0xa8d0a5f325f328d0,0x1bef28f624c5a728,0x28d7259fa66ba8ad,0x9fe6a90ba3012818,0xa8dfa54a26de2882,0x21e0290e2056a882,0x28e524f2a74ba850,0xa3bfa8ff9a5a28d0,0xa8eba49827b22818,0x24c528df98c4a8ff,0x28f1243da809a7b2,0xa59fa8ad1fe6290f,0xa8f6a3bf28352728,0x266b286aa2a1a8ff,0x28fb2301a85da692
.quad 0xa728a818249828d0,0xa8ffa241288225f3,0x27d3276ea5c9a882,0x2903217ea8a3a54a,0xa835a69226de2818,0xa906a0b928bf2498,0x2876259fa7d3a728,0x29091fe6a8d7a3bf,0xa8ada498285025f3,0xa90b9e5528eb2241,0x28d72301a8a3a498,0x290d1cc2a8fba0b9,0xa8f6a0b928df2241,0xa90e9a5a29061e55,0x29091cc2a9039e55,0x290f165ba90d9a5a
.quad 0xa8d0000028d025f3,0x28d025f3a5f3,0xa8e897f228c42607,0x9df0289326cca534,0xa8fb9bef28b6261c,0xa1e028432790a46b,0xa9089df028a82630,0xa45427c2281fa331,0xa90e9fe628982644,0xa59f26de286aa17e,0xa90fa0eb28882658,0xa6cc25de28a89f82,0xa909a1e02876266b,0xa7d324c528d79bef,0xa8fda2d12864267f,0xa857233128f98e5c
.quad 0xa8eba3bf28502692,0xa8ad20b9290b1a5a,0xa8d4a454283c26a6,0xa8e81c5d290f1eb9,0xa8b6a4c5282726b9,0xa909925c2903211c,0xa893a534281026cc,0xa90e9df028e822d1,0xa86aa59f27f226de,0xa8f6a17e28bf243d,0xa83ca60727c226f1,0xa8c4a3ee28882508,0xa809a66b27902703,0xa876a51e284325c9,0xa7a1a6cc275d2716,0xa810a63027e3267f
.quad 0x28d025f3a5f3a8d0,0x25f3a5f3a8d00000,0x2857277fa454a901,0x2810a2d1a90ea0eb,0x274b285da11ca90f,0x28c898c4a8f1a4c5,0x258a28cc998fa8f9,0x290f2088a87ca6cc,0x230129061cc2a8bf,0x28df24f2a76ea835,0x1d27290a2211a864,0x283c273aa55fa8c4,0x9bef28d724c5a7d3,0x266b2876a1e0a909,0xa27128702658a6a6,0x239028f494c5a901
.quad 0xa54a27b227b2a54a,0x1a5a290b20b9a8ad,0xa71626302864a390,0xa08828bb24dca810,0xa843246b28c8a056,0xa51e28092703a66b,0xa8c420eb290197f2,0xa77f26072857a454,0xa906165b290e1cc2,0xa898230128df9fe6,0xa9089eb928ee21af,0xa905198f290f17f2,0xa8c8a36028a3246b,0xa8fba05628e521e0,0xa84aa58a282e25de,0xa87ca4dc28642534
.quad 0xa5f3a8d0000028d0,0xa8d0000028d025f3,0xa0eba90ea2d12810,0xa901a454277f2857,0x1d8ca8a3a66b25c9,0xa827a7d3240e2903,0x2508a73aa85721af,0xa4dca8e88e5c28e2,0x27f2a43da8f6965b,0x965ba8f6a43d27f2,0x28db998fa901a331,0x2425a810a7a124dc,0x290921e0a876a66b,0x27d3a4c5a8d71bef,0x287c2630a6cca84a,0x28ee97f2a905a211
.quad 0x26922850a3bfa8eb,0x28eb23bfa850a692,0x227128f997f2a90a,0x27c2277fa5b4a888,0x98c428fb21e0a8a3,0x240e28d79f1ea90d,0xa45428572607a77f,0x97f2290120eba8c4,0xa76e26442835a4f2,0xa4f228352644a76e,0xa8bb221128e89f82,0xa82e2534287ca425,0xa90f98c429091d8c,0xa9031bef290d925c,0xa8a8a42528932481,0xa8cca2d128bb2390
.quad 0x28d025f3a5f3,0x28d025f3a5f3a8d0,0xa53426cc28939df0,0x260728c497f2a8e8,0xa8762056290d22a1,0x125c28e5251ea703,0xa90ea211284a275d,0xa5b426a62888a025,0xa835a76e24f228df,0xa8bf1cc229062301,0xa454a8ee0e5c28f4,0xa8e2a4af27c22801,0x1befa8d7a4c527d3,0xa66ba87621e02909,0x2607a6f1a83c23ee,0x998fa908a1af2888
.quad 0x28ada0b9a90b9a5a,0x254aa7b2a7b2254a,0x290121afa89ea55f,0x28a8a14da9058e5c,0x27d3274ba61ca85d,0x28f122a1a88da575,0x22d128e89df0a90e,0x26cc2810a534a893,0x9fe628df2301a898,0x1cc2290e165ba906,0xa6cc271627a1a630,0xa4dc284a25dea7e3,0xa8d7211c28f19f1e,0xa88d240e28b6a2a1,0xa8e8a14d28db2211,0xa8fd9f8228f42088
.quad 0x25f3a5f3a8d00000,0xa5f3a8d0000028d0,0x28e817f2a8c4a607,0x1df0a893a6cc2534,0x288d26b9a575a8d7,0x2809a360a9099f1e,0x242528fd1b25a8c4,0x29052390a810a7e3,0xa17e286a26dea59f,0x264428989fe6a90e,0xa82e239028fd17f2,0x9c5d28cc2534a75d,0xa909a1e02876266b,0xa7d324c528d79bef,0xa716a82e242528e8,0xa90aa14d289325de
.quad 0x9a5aa90ba0b928ad,0xa692a85023bf28eb,0x25dea75da7e32534,0x198fa8f4a2d1287c,0x28e59d8ca90f9bef,0x2790a5c9a8762360,0x28932534a810a6cc,0x290e1df0a8e8a2d1,0x243d28bfa17ea8f6,0x26de27f2a59fa86a,0xa14d28cc2390a893,0x94c5290a1df0a8f4,0xa8272575285da4c5,0xa74b26b927d3a61c,0xa90a9c5d29051df0,0xa90f94c5290e198f
.quad 0xa8d0000028d025f3,0x28d025f3a5f3,0xa857a77f24542901,0xa81022d1290e20eb,0x9f1ea909a3602809,0xa8d7a57526b9288d,0x2658a607a8b11d27,0xa2d1a90a9eb9289e,0x290e1fe6a898a644,0x259fa6dea86a217e,0x26f12857a271a908,0x290e1eb9a8b1a5b4,0x9bef28d724c5a7d3,0x266b2876a1e0a909,0xa81f245428e29b25,0xa0eb289e25b4a73a
.quad 0xa8eba3bf28502692,0xa8ad20b9290b1a5a,0xa4afa8c42025290c,0xa857a65826f1281f,0x2360a876a5c92790,0x9befa90f9d8c28e5,0x28c4a0eba90117f2,0x277fa607a8572454,0x286a259fa7f2a6de,0x28f6217ea8bfa43d,0x202529019b25a90f,0x245428b1a271a8e2,0xa61c27d326b9a74b,0xa4c5285d2575a827,0xa90c17f2290f8e5c,0xa9011d2729089b25
.quad 0x28d025f3a5f3a8d0,0x25f3a5f3a8d00000,0x20eb290e22d1a810,0x29012454a77fa857,0xa703251e28e5125c,0x22a1290d2056a876,0xa8f4a48127a1282e,0xa6f1255f28d497f2,0xa301a9069cc228bf,0xa8dfa4f2276e2835,0x2630a67fa87c214d,0xa025a90fa0882893,0x290921e0a876a66b,0x27d3a4c5a8d71bef,0x248128db9c5da90c,0x28a8258aa75da810
.quad 0xa54a27b227b2a54a,0x1a5a290b20b9a8ad,0xa90f9d2728e223ee,0xa84a242528db9df0,0xa575a88d22a128f1,0xa85da61c274b27d3,0x2454a857a607277f,0x17f2a901a0eb28c4,0x2906965ba90e9cc2,0x2898a301a8df1fe6,0x2658281fa55fa870,0x280126a6a73aa77f,0xa2a128b6240ea88d,0x9f1e28f1211ca8d7,0xa8ee202528f99eb9,0xa8d421af28e2a0eb
.quad 0xa5f3a8d0000028d0,0xa8d0000028d025f3,0x2534a6cca8931df0,0xa607a8c417f228e8,0x2903240ea7d3a827,0x25c9a66ba8a31d8c,0x214d290f20eba870,0x28db2534a716a864,0xa7f2243d28f6165b,0x165b28f6243da7f2,0xa870a6a62607289e,0xa8bb1df0290c21af,0x1befa8d7a4c527d3,0xa66ba87621e02909,0x28d49d27a90ea088,0x255fa77fa80124af
.quad 0x26922850a3bfa8eb,0x28eb23bfa850a692,0xa481282e26cca67f,0x1b25290e1f82a8cc,0xa90d9f1e28d7240e,0xa8a321e028fb98c4,0xa2d1a8e81df0290e,0xa6cca81025342893,0x276ea644a83524f2,0x24f2a835a644276e,0x289e24afa857a5b4,0x28f920eba8d4a331,0x925c290d1befa903,0x1d8c290998c4a90f,0xa8b1233128c4a271,0xa8882454289ea3ee
.quad 0x28d025f3a5f3,0x28d025f3a5f3a8d0,0xa8e897f228c42607,0x9df0289326cca534,0xa4c5a8f198c428c8,0xa90fa11c285d274b,0x277fa4afa8ee94c5,0x9f82a90ca271283c,0x2835276ea4f2a8df,0x28bf9cc2a906a301,0xa2d1284a2716a58a,0x250828d49b25a905,0xa909a1e02876266b,0xa7d324c528d79bef,0x9df0a90fa02528b1,0xa7a1a7e324dc28cc
.quad 0x28ada0b9a90b9a5a,0x254aa7b2a7b2254a,0x26072870a331a8ee,0x28b12508a801a73a,0xa66b27032809a51e,0xa05628c8246ba843,0xa893a534281026cc,0xa90e9df028e822d1,0x1fe6a8dfa3012898,0x9cc2a90e965b2906,0x290e0e5ca90c9d27,0x28dba088a8fd1c5d,0x21e028e5a056a8fb,0x246b28a3a360a8c8,0xa85725082870a4af,0xa81f25b4283ca55f
.quad 0x25f3a5f3a8d00000,0xa5f3a8d0000028d0,0x2857277fa454a901,0x2810a2d1a90ea0eb,0xa46b27902843a1e0,0x261c28b69befa8fb,0xa8bba5de267f2893,0xa80123ee29011c5d,0x217ea86aa6de259f,0xa644a8981fe6290e,0x28f923eea81fa77f,0x27e3a481a8e814c5,0x9bef28d724c5a7d3,0x266b2876a1e0a909,0xa90f9f8228bb2534,0xa7c2250828c49eb9
.quad 0x9a5aa90ba0b928ad,0xa692a85023bf28eb,0x28fd94c5a908a0eb,0x27a1a58aa8932211,0x211c2903925ca909,0x26b92827a4c5a8b6,0xa8c420eb290197f2,0xa77f26072857a454,0xa43da8bf217e28f6,0xa6dea7f2259f286a,0x2864a481a8a822d1,0x275da67fa810258a,0x25c92843a51ea876,0x27032790a66ba809,0xa7c226582801a607,0xa73a26f1277fa6a6
.quad 0xa8d0000028d025f3,0x28d025f3a5f3,0xa0eba90ea2d12810,0xa901a454277f2857,0x28fb1befa8b6a61c,0x21e0a843a790246b,0x1c5d290123eea801,0x2893267fa5dea8bb,0xa90e9fe628982644,0xa59f26de286aa17e,0x14c5a8e8a48127e3,0xa77fa81f23ee28f9,0x290921e0a876a66b,0x27d3a4c5a8d71bef,0x9eb928c42508a7c2,0x253428bb9f82a90f
.quad 0xa8eba3bf28502692,0xa8ad20b9290b1a5a,0x2211a893a58a27a1,0xa0eba90894c528fd,0x28b624c5a827a6b9,0x2909125ca903a11c,0xa45428572607a77f,0x97f2290120eba8c4,0xa86aa59f27f226de,0xa8f6a17e28bf243d,0x258aa810a67f275d,0x22d1a8a8a4812864,0x2809266ba790a703,0x2876251ea843a5c9,0xa6a6277f26f1a73a,0xa60728012658a7c2
.quad 0x28d025f3a5f3a8d0,0x25f3a5f3a8d00000,0xa53426cc28939df0,0x260728c497f2a8e8,0xa74ba85d211c290f,0xa8c818c428f124c5,0x283ca271a90c9f82,0x94c5a8eea4af277f,0x230129061cc2a8bf,0x28df24f2a76ea835,0xa9059b2528d42508,0xa58a2716284aa2d1,0x1befa8d7a4c527d3,0xa66ba87621e02909,0x28cc24dca7e3a7a1,0x28b1a025a90f9df0
.quad 0xa54a27b227b2a54a,0x1a5a290b20b9a8ad,0xa73aa801250828b1,0xa8eea33128702607,0x2843a46ba8c82056,0x251ea809a703266b,0x22d128e89df0a90e,0x26cc2810a534a893,0xa906165b290e1cc2,0xa898230128df9fe6,0x1c5da8fda08828db,0x9d27a90c0e5c290e,0x28c82360a8a3a46b,0x28fb2056a8e5a1e0,0xa55f283c25b4a81f,0xa4af28702508a857
.quad 0xa5f3a8d0000028d0,0xa8d0000028d025f3,0x28e817f2a8c4a607,0x1df0a893a6cc2534,0x9d8c28a3266ba5c9,0x282727d3a40ea903,0xa864a716253428db,0xa87020eb290f214d,0x27f2a43da8f6965b,0x965ba8f6a43d27f2,0x21af290c1df0a8bb,0x289e2607a6a6a870,0xa909a1e02876266b,0xa7d324c528d79bef,0x24afa801a77f255f,0xa088a90e9d2728d4
.quad 0x26922850a3bfa8eb,0x28eb23bfa850a692,0xa8cc1f82290e1b25,0xa67f26cc282ea481,0x18c4a8fba1e028a3,0xa40ea8d71f1e290d,0x28932534a810a6cc,0x290e1df0a8e8a2d1,0xa76e26442835a4f2,0xa4f228352644a76e,0xa331a8d420eb28f9,0xa5b4a85724af289e,0x290f18c4a9099d8c,0x29039befa90d125c,0xa3ee289e2454a888,0xa27128c42331a8b1
.quad 0x28d025f3a5f3,0x28d025f3a5f3a8d0,0xa857a77f24542901,0xa81022d1290e20eb,0x2876a056a90da2a1,0x925ca8e5a51e2703,0x97f228d4255fa6f1,0x282e27a1a481a8f4,0xa835a76e24f228df,0xa8bf1cc229062301,0x2893a088a90fa025,0x214da87ca67f2630,0x9bef28d724c5a7d3,0x266b2876a1e0a909,0xa810a75d258a28a8,0xa90c9c5d28db2481
.quad 0x28ada0b9a90b9a5a,0x254aa7b2a7b2254a,0x9df028db2425a84a,0x23ee28e29d27a90f,0xa7d3a74b261c285d,0xa8f1a2a1288d2575,0x28c4a0eba90117f2,0x277fa607a8572454,0x9fe628df2301a898,0x1cc2290e165ba906,0xa77fa73a26a62801,0xa870a55f281f2658,0x28d7a11ca8f11f1e,0x288da40ea8b622a1,0xa0eb28e221afa8d4,0x9eb928f92025a8ee
.quad 0x25f3a5f3a8d00000,0xa5f3a8d0000028d0,0x20eb290e22d1a810,0x29012454a77fa857,0xa88da6b9257528d7,0xa809236029091f1e,0x289e9eb9a90aa2d1,0x1d27a8b1a6072658,0xa17e286a26dea59f,0x264428989fe6a90e,0xa5b4a8b11eb9290e,0xa908a271285726f1,0x290921e0a876a66b,0x27d3a4c5a8d71bef,0xa73a25b4289ea0eb,0x9b2528e22454a81f
.quad 0x9a5aa90ba0b928ad,0xa692a85023bf28eb,0x281f26f1a658a857,0x290c2025a8c4a4af,0xa8e51d8c290f1bef,0xa79025c92876a360,0x2454a857a607277f,0x17f2a901a0eb28c4,0x243d28bfa17ea8f6,0x26de27f2a59fa86a,0xa8e2a27128b12454,0xa90f9b2529012025,0x2827a575a85d24c5,0x274ba6b9a7d3261c,0x9b2529081d27a901,0x8e5c290f17f2a90c
.quad 0xa8d0000028d025f3,0x28d025f3a5f3,0x2534a6cca8931df0,0xa607a8c417f228e8,0x1f1e29092360a809,0x28d72575a6b9a88d,0xa7e3a81023902905,0xa8c41b2528fd2425,0x290e1fe6a898a644,0x259fa6dea86a217e,0xa75d253428cc9c5d,0x17f228fd2390a82e,0x1befa8d7a4c527d3,0xa66ba87621e02909,0x25de2893a14da90a,0x28e82425a82ea716
.quad 0xa8eba3bf28502692,0xa8ad20b9290b1a5a,0x287ca2d1a8f4198f,0x2534a7e3a75d25de,0xa360287625c9a790,0x1bef290f1d8ca8e5,0xa2d1a8e81df0290e,0xa6cca81025342893,0x286a259fa7f2a6de,0x28f6217ea8bfa43d,0xa8f41df0290a94c5,0xa893239028cca14d,0x261ca7d3a6b9274b,0x24c5a85da5752827,0x198f290e94c5a90f,0x1df029059c5da90a
.quad 0x28d025f3a5f3a8d0,0x25f3a5f3a8d00000,0xa8e897f228c42607,0x9df0289326cca534,0x2703a51ea8e5925c,0xa2a1a90da0562876,0xa025288826a6a5b4,0x275d284aa211a90e,0xa301a9069cc228bf,0xa8dfa4f2276e2835,0x280127c2a4afa8e2,0x28f40e5ca8eea454,0xa909a1e02876266b,0xa7d324c528d79bef,0x2888a1afa908998f,0x23eea83ca6f12607
.quad 0xa54a27b227b2a54a,0x1a5a290b20b9a8ad,0x8e5ca905a14d28a8,0xa55fa89e21af2901,0x2575288da2a1a8f1,0x285d261ca74ba7d3,0xa893a534281026cc,0xa90e9df028e822d1,0x2906965ba90e9cc2,0x2898a301a8df1fe6,0xa7e325de284aa4dc,0xa63027a12716a6cc,0x22a1a8b6a40e288d,0x1f1ea8f1a11c28d7,0x208828f49f82a8fd,0x221128dba14da8e8
.quad 0xa5f3a8d0000028d0,0xa8d0000028d025f3,0x2857277fa454a901,0x2810a2d1a90ea0eb,0xa903a40e27d32827,0xa5c9266b28a39d8c,0x28e28e5ca8e8a4dc,0x21afa857a73a2508,0xa7f2243d28f6165b,0x165b28f6243da7f2,0x24dca7a1a8102425,0xa331a901998f28db,0x9bef28d724c5a7d3,0x266b2876a1e0a909,0xa211a90597f228ee,0xa84aa6cc2630287c
.quad 0x26922850a3bfa8eb,0x28eb23bfa850a692,0xa888a5b4277f27c2,0xa90a97f228f92271,0x290d1f1ea8d7a40e,0x28a3a1e0a8fb18c4,0xa8c420eb290197f2,0xa77f26072857a454,0x276ea644a83524f2,0x24f2a835a644276e,0xa425287c2534a82e,0x9f8228e82211a8bb,0x125ca90d9bef2903,0x9d8ca90918c4290f,0x239028bba2d1a8cc,0x24812893a425a8a8
.quad 0x28d025f3a5f3,0x28d025f3a5f3a8d0,0xa0eba90ea2d12810,0xa901a454277f2857,0x24c528f118c4a8c8,0x290f211ca85da74b,0xa6cca87c2088290f,0xa8f9998f28cc258a,0x2835276ea4f2a8df,0x28bf9cc2a906a301,0xa8c4a55f273a283c,0xa8642211290a1d27,0x290921e0a876a66b,0x27d3a4c5a8d71bef,0xa90194c528f42390,0xa6a626582870a271
.quad 0x28ada0b9a90b9a5a,0x254aa7b2a7b2254a,0xa81024dc28bba088,0xa39028642630a716,0x266ba703a809251e,0x2056a8c8a46b2843,0xa45428572607a77f,0x97f2290120eba8c4,0x1fe6a8dfa3012898,0x9cc2a90e965b2906,0x17f2290f198fa905,0x21af28ee9eb9a908,0xa1e0a8e5205628fb,0xa46ba8a3236028c8,0x25342864a4dca87c,0x25de282ea58aa84a
.quad 0x25f3a5f3a8d00000,0xa5f3a8d0000028d0,0xa53426cc28939df0,0x260728c497f2a8e8,0x246ba790a84321e0,0xa61ca8b61bef28fb,0xa331281f27c2a454,0x263028a89df0a908,0x217ea86aa6de259f,0xa644a8981fe6290e,0x9f8228a825dea6cc,0x26582888a0eba90f,0x1befa8d7a4c527d3,0xa66ba87621e02909,0x8e5c28f92331a857,0x267f2864a2d1a8fd
.quad 0x9a5aa90ba0b928ad,0xa692a85023bf28eb,0x1eb9290f1c5da8e8,0x26a6283ca454a8d4,0xa11ca903125c2909,0xa6b9a82724c528b6,0x22d128e89df0a90e,0x26cc2810a534a893,0xa43da8bf217e28f6,0xa6dea7f2259f286a,0x25082888a3eea8c4,0x26f127c2a607a83c,0xa5c9a843251e2876,0xa703a790266b2809,0x267f27e3a630a810,0x2716275da6cca7a1
.quad 0x8000a90f0000290f,0x8000a90f0000290f,0x18c4a90e925c290f,0x1d8ca9069bef290b,0x1cc2a90b965b290f,0x217ea8eb9fe628ff,0x1f1ea90698c4290f,0x240ea8bfa1e028eb,0x20b9a8ff9a5a290f,0x254aa882a3bf28d0,0x21e0a8f69bef290f,0x266ba835a4c528ad,0x2301a8eb9cc2290f,0x276ea7b2a59f2882,0x240ea8df9d8c290f,0x2827a6dea66b2850
.quad 0x2498a8d09e55290f,0x2882a5f3a7282818,0x251ea8bf9f1e290f,0x28c8a4f2a7d327b2,0x259fa8ad9fe6290f,0x28f6a3bfa8352728,0x261ca898a056290f,0x290da17ea8762692,0x2692a882a0b9290f,0x290b9e55a8ad25f3,0x2703a86aa11c290f,0x28f1965ba8d7254a,0x276ea850a17e290f,0x28bf1a5aa8f62498,0x27d3a835a1e0290f,0x28761fe6a90923bf
.quad 0x8000a90f0000290f,0x8000a90f0000290f,0x2056a8f69f1e28ff,0x21e0a8dfa11c28eb,0x243da8ada30128d0,0x259fa850a4f22882,0x261ca835a51e2882,0x27d3a6dea70327b2,0x27b2a728a6922818,0x28ada498a85025f3,0x2876a59fa7d32728,0x29099fe6a8d723bf,0x28dfa3bfa86a25f3,0x28f61a5aa90e1e55,0x290d9fe6a8c82498,0x28762301a8f19a5a
.quad 0x28ff8000a8ff2241,0x272825f3a882a241,0x28b61fe6a90f1e55,0x24c527f2a790a54a,0x283523bfa8f60000,0x1fe628ada59fa728,0x2703259fa8b69e55,0x9bef2906a2a1a850,0x254a2728a850a241,0xa3bf28ff9a5aa8d0,0x22a12835a790a498,0xa66b28981f1ea90b,0x1cc228ada644a5f3,0xa83527b2243da8ff,0x9bef28f6a4c5a728,0xa8d7259f266ba8ad
.quad 0x8000a90f0000290f,0x8000a90f0000290f,0x2360a8bfa2a128d0,0x246ba898a40e28ad,0x26dea7b2a6442818,0x27f2a692a76e2728,0x288da4f2a84325f3,0x28f1a17ea8c823bf,0x290b9e55a8eb2241,0x28eb1e55a90b0000,0x28d71fe6a9090000,0x27d3259fa876a3bf,0x27f2254aa898a241,0x243d2850a644a728,0x251e27f2a74ba5f3,0x925c2906a11ca8ad
.quad 0x1e5528d0a498a818,0xa49828d01e55a90f,0xa056290e9d8ca8d0,0xa809276e2575a8ad,0xa59f28ad1fe6a90f,0xa8f623bf2835a728,0xa827276e251ea8d0,0xa8e5965b28fba3bf,0xa8eb249827b2a818,0xa7b2a49828eb8000,0xa9031cc228b6a5f3,0xa40ea7f2280923bf,0xa86aa0b9290ea241,0x165ba8eb24f22728,0xa66ba59f28d78000,0x24c5a8f61bef28ad
.quad 0x8000a90f0000290f,0x8000a90f0000290f,0x251ea86aa4c52882,0x25c9a835a5752850,0x286aa54aa83525f3,0x28bfa3bfa8982498,0x290f965ba9091e55,0x28e51fe6a9039a5a,0x28502498a8ada241,0x26922728a7b2a5f3,0x24c52835a66ba728,0x1bef28f6a1e0a8ad,0x965b290b9fe6a8d0,0xa4f228ad217ea8ff,0xa575289821e0a8ff,0xa88d259f2790a7b2
.quad 0xa88225f32728a818,0xa8ff000028ffa241,0xa90d1cc228d7a498,0xa74ba59f28a320b9,0xa835a3bf28f68000,0x9fe6a8ad259f2728,0xa46ba7f227d32498,0x240ea8f6125c28eb,0x1a5aa8ff23bf2818,0x2850a728a54a28d0,0x25c9a8bf9bef28ff,0x290d9fe6a88d2692,0x2898a692a59f28d0,0x27f223bfa9061e55,0x29099fe6a8762728,0x21e02835a7d3a3bf
.quad 0x8000a90f0000290f,0x8000a90f0000290f,0x266ba7f2a61c2818,0x2703a76ea6b927b2,0x28f6a0b9a8df2241,0x290e9a5aa9061e55,0x2876243da8b6a241,0x27902644a827a54a,0x23bf2882a54aa818,0x1a5a28ffa0b9a8d0,0xa1e028f61befa90f,0xa66b283524c5a8ad,0xa835269226dea818,0xa90620b928bfa498,0xa909165b28fba241,0xa809a4f228b620b9
.quad 0xa728a5f328822241,0x9e55a8d024982818,0x9befa8df246b2818,0x25c9a898a11c290b,0x259fa8ad9fe6290f,0x28f6a3bfa8352728,0x28d7a4f2a7902818,0x28432301a9031a5a,0x28ad1e55a90b2241,0x20b92882a692a5f3,0x24c5276ea843a241,0xa51e28df125ca8eb,0x9fe6290ba301a818,0xa8df254a26dea882,0xa7d3283521e0a90f,0xa8769fe62909a3bf
.quad 0x8000a90f0000290f,0x8000a90f0000290f,0x2790a6dea74b2728,0x2809a644a7d32692,0x29061a5aa90e0000,0x28df20b9a8f69e55,0x25c927f2a6b9a728,0x23602898a4c5a850,0xa0b928ff1a5aa90f,0xa54a288223bfa8d0,0xa876259f27d3a728,0xa9091fe628d7a3bf,0xa8bfa0b929068000,0xa6dea69228352498,0xa360a86a261c2728,0x1f1ea90e1bef28eb
.quad 0x2498a8d09e55290f,0x2882a5f3a7282818,0x28e5a43da8272728,0x288d217ea9091a5a,0x283523bfa8f60000,0x1fe628ada59fa728,0x1d8c28bfa575a728,0xa6b9286a21e0a90b,0xa692288220b9a90f,0xa90b1e5528ada5f3,0xa90f217e285da728,0xa575a6de287620b9,0xa6dea54a28df8000,0x2301a90b1fe62882,0x1befa8f624c52728,0x28d7a59fa66b28ad
.quad 0x8000a90f0000290f,0x8000a90f0000290f,0x2843a59fa82725f3,0x2876a4f2a85d254a,0x289823bfa8bfa241,0x2835254aa86aa498,0x1d8c28f6a11ca8d0,0x9bef290e925ca90b,0xa7b227282692a818,0xa8ad24982850a5f3,0xa8d79fe629098000,0xa7d3a59f287623bf,0xa17ea8ad24f22818,0x1fe6a90b165b28ff,0x26b9a835a46b28d0,0x28d7a43da8432692
.quad 0x28ff8000a8ff2241,0x272825f3a882a241,0x240e2835a703a5f3,0xa1e0290698c4a8eb,0xa59f28ad1fe6a90f,0xa8f623bf2835a728,0xa90f1fe628a3a5f3,0xa66ba644288d20b9,0xa54aa72828502241,0x23bfa8ff1a5a28d0,0x246ba8f618c428d0,0x2909a301a82727b2,0x2906a3bfa7f22818,0x259f2692a8989e55,0x266b259fa8d70000,0xa4c528f69befa8ad
.quad 0x8000a90f0000290f,0x8000a90f0000290f,0x28a3a43da88d2498,0x28c8a301a8b623bf,0x276e2692a7f2a5f3,0x264427b2a6dea728,0xa2a128df2056a8ff,0xa575286a246ba8ad,0xa90b1e5528eba241,0xa8eb9e55290b8000,0xa4c5a835266b2728,0x9befa8f621e028ad,0x2644a850a43d28d0,0x2898a54aa7f22728,0x28e51cc2a90f1e55,0x27032644a85da3bf
.quad 0x1e5528d0a498a818,0xa49828d01e55a90f,0xa84326de261ca882,0xa903165b28f1a3bf,0xa835a3bf28f68000,0x9fe6a8ad259f2728,0x1f1ea90e211c2882,0x285da6dea5c928ad,0x28eba498a7b22818,0x27b22498a8eb0000,0x261c2644a8a39e55,0xa36029069d8ca8ad,0xa4f228eb965ba8d0,0xa90e20b9286aa728,0xa9091fe62876a728,0xa1e0a83527d323bf
.quad 0x8000a90f0000290f,0x8000a90f0000290f,0x28e5a17ea8d72241,0x28fb9fe6a8f120b9,0x24f22850a59fa818,0x230128ada43da882,0xa74b276e266ba818,0xa85d259f2809a692,0xa850a49828ad2241,0xa692a72827b225f3,0x21e0a8f69bef290f,0x266ba835a4c528ad,0x290e9a5aa8f62241,0x286a23bfa8df9e55,0x205628bfa4c5a818,0xa2a128f618c4a90b
.quad 0xa88225f32728a818,0xa8ff000028ffa241,0xa6b9a64428762241,0x925ca8f623602850,0x259fa8ad9fe6290f,0x28f6a3bfa8352728,0x28c81cc2a9092241,0x23602835a74ba54a,0x9a5a28ffa3bfa818,0xa8502728254aa8d0,0xa8fb243d27d3a818,0xa6b9a59f28c81a5a,0xa43da7b228352241,0x2644a8ad9cc228ff,0x27d3a835a1e0290f,0x28761fe6a90923bf
.quad 0x8000a90f0000290f,0x8000a90f0000290f,0x29099cc2a9031e55,0x290f965ba90d1a5a,0x1fe628eba17ea8d0,0x165b290b9cc2a8ff,0xa8d7230128a3a498,0xa90d1cc228fba0b9,0xa3bfa882254a2818,0x9a5aa8ff20b928d0,0x2876a59fa7d32728,0x29099fe6a8d723bf,0x259f27b2a76ea5f3,0x1cc228eba301a882,0xa7d3276e25c9a882,0xa903217e28a3a54a
.quad 0xa728a5f328822241,0x9e55a8d024982818,0x266ba86aa2a128ff,0x28fba301a85d2692,0x283523bfa8f60000,0x1fe628ada59fa728,0xa4c528df18c4a8ff,0xa8f1243d2809a7b2,0xa8ad9e55290ba241,0xa0b9a882269225f3,0x21e0a90e20562882,0x28e5a4f2a74b2850,0x28f69a5aa8bf25f3,0x217e2850a76ea498,0x9bef28f6a4c5a728,0xa8d7259f266ba8ad
.quad 0x8000a90f0000290f,0x8000a90f0000290f,0x290d165ba90f0000,0x29031cc2a9099a5a,0x9cc2290b165ba90f,0xa17e28eb1fe6a8ff,0xa8fb9cc2290d8000,0xa8a3a30128d720b9,0x20b9a8ff9a5a290f,0x254aa882a3bf28d0,0x28d71fe6a9090000,0x27d3259fa876a3bf,0xa30128eb1cc2a90f,0xa76e27b2259fa882,0xa8a3a17e29038000,0xa5c9a76e27d3254a
.quad 0x2498a8d09e55290f,0x2882a5f3a7282818,0x285d2301a8fb0000,0x22a1286aa66ba692,0xa59f28ad1fe6a90f,0xa8f623bf2835a728,0xa809a43d28f18000,0x98c4a8df24c527b2,0x2692a882a0b9290f,0x290b9e55a8ad25f3,0x274b24f2a8e50000,0xa056290ea1e0a850,0xa76e2850217ea90f,0xa8bf9a5a28f6a498,0xa66ba59f28d78000,0x24c5a8f61bef28ad
.quad 0x8000a90f0000290f,0x8000a90f0000290f,0x28f11fe6a8fb9e55,0x28d7217ea8e5a0b9,0xa43d28ad2301a8d0,0xa59f285024f2a882,0xa809a59f285d2498,0xa66ba76e274b2692,0x27b2a728a6922818,0x28ada498a85025f3,0x24c52835a66ba728,0x1bef28f6a1e0a8ad,0xa8df23bf286aa5f3,0xa8f69a5a290e9e55,0x98c4a8f622a12882,0x24c5a8bfa056290b
.quad 0x28ff8000a8ff2241,0x272825f3a882a241,0xa36028f6125ca8ff,0xa876264426b9a850,0xa835a3bf28f68000,0x9fe6a8ad259f2728,0x274ba835a36028ff,0x29099cc2a8c8254a,0x254a2728a850a241,0xa3bf28ff9a5aa8d0,0xa8c8259f26b9a882,0xa7d3a43d28fb9a5a,0x9cc2a8ad264425f3,0x2835a7b2a43d28ff,0x29099fe6a8762728,0x21e02835a7d3a3bf
.quad 0x8000a90f0000290f,0x8000a90f0000290f,0x28b62301a8c8a241,0x288d243da8a3a3bf,0xa6de27b22644a818,0xa7f22692276ea728,0xa46ba86a25752818,0xa056a8df22a128ad,0x290b9e55a8eb2241,0x28eb1e55a90b0000,0xa1e028f61befa90f,0xa66b283524c5a8ad,0xa7f2a54a28982241,0xa43da85026442728,0x285da644a7032818,0x290f9cc2a8e523bf
.quad 0x1e5528d0a498a818,0xa49828d01e55a90f,0xa8f1965b2903a241,0xa61ca6de284323bf,0x259fa8ad9fe6290f,0x28f6a3bfa8352728,0x25c926dea85da241,0xa11c290e9f1ea8ad,0xa8eb249827b2a818,0xa7b2a49828eb8000,0x1d8ca90623602818,0x28a3a644a61c28ad,0x286a20b9a90e2241,0x965b28eba4f2a728,0xa7d3283521e0a90f,0xa8769fe62909a3bf
.quad 0x8000a90f0000290f,0x8000a90f0000290f,0x285d24f2a876a498,0x2827259fa843a54a,0xa86a254a2835a5f3,0xa8bf23bf2898a498,0x125ca90e1bef28ff,0x211ca8f69d8c290b,0x28502498a8ada241,0x26922728a7b2a5f3,0xa876259f27d3a728,0xa9091fe628d7a3bf,0x165ba90b1fe628d0,0x24f2a8ada17e28ff,0x2843243da8d79e55,0x246b2835a6b9a692
.quad 0xa88225f32728a818,0xa8ff000028ffa241,0x18c4a90621e02882,0x2703a835a40e28eb,0x283523bfa8f60000,0x1fe628ada59fa728,0xa88d2644266ba882,0xa8a39fe6290fa0b9,0x1a5aa8ff23bf2818,0x2850a728a54a28d0,0x28272301a9091e55,0x98c428f6a46ba7b2,0xa8982692259fa8d0,0xa7f2a3bf29069e55,0x1befa8f624c52728,0x28d7a59fa66b28ad
.quad 0x8000a90f0000290f,0x8000a90f0000290f,0x27d32644a809a5f3,0x274b26dea790a692,0xa8f620b928dfa241,0xa90e1a5a29069e55,0x24c5a898a36028d0,0x26b9a7f2a5c92850,0x23bf2882a54aa818,0x1a5a28ffa0b9a8d0,0xa8d79fe629098000,0xa7d3a59f287623bf,0x2835a692a6de2818,0x2906a0b9a8bf2498,0x9bef290e9f1ea8d0,0xa61c286a2360a8eb
.quad 0xa728a5f328822241,0x9e55a8d024982818,0x2909a17ea88d25f3,0x2827243da8e59a5a,0xa59f28ad1fe6a90f,0xa8f623bf2835a728,0xa1e0a86a26b925f3,0x2575a8bf9d8c290b,0x28ad1e55a90b2241,0x20b92882a692a5f3,0xa87626de2575a8d0,0xa85da17e290fa0b9,0x1fe6a90b23012818,0x28dfa54aa6de2882,0x266b259fa8d70000,0xa4c528f69befa8ad
.quad 0x8000a90f0000290f,0x8000a90f0000290f,0x26b9276ea703a728,0x261c27f2a66ba7b2,0xa9069a5a290e8000,0xa8dfa0b928f61e55,0x2827a644a7902728,0x28b6a43da876254a,0xa0b928ff1a5aa90f,0xa54a288223bfa8d0,0xa4c5a835266b2728,0x9befa8f621e028ad,0x28bf20b9a9060000,0x26de2692a835a498,0xa8b624f22809a728,0xa8fb965b2909a0b9
.quad 0x2498a8d09e55290f,0x2882a5f3a7282818,0x211c2898a5c9a728,0xa46b28df1befa90b,0xa835a3bf28f68000,0x9fe6a8ad259f2728,0x2903a301a8432728,0x279024f2a8d79a5a,0xa692288220b9a90f,0xa90b1e5528ada5f3,0x925ca8df251e2728,0x2843a76ea4c528eb,0x26de254aa8df0000,0xa301290b9fe6a882,0xa9091fe62876a728,0xa1e0a83527d323bf
.quad 0x8000a90f0000290f,0x8000a90f0000290f,0x25752835a5c9a818,0x24c5286aa51ea850,0xa898a3bf28bf2241,0xa835a54a286a2498,0x29039fe6a8e52241,0x2909165ba90f1a5a,0xa7b227282692a818,0xa8ad24982850a5f3,0x21e0a8f69bef290f,0x266ba835a4c528ad,0x217e28ada4f2a818,0x9fe6290b965ba8ff,0xa790a59f288d2241,0xa1e0a898257527b2
.quad 0x28ff8000a8ff2241,0x272825f3a882a241,0xa8a3259f274ba818,0xa8d79cc2290da0b9,0x259fa8ad9fe6290f,0x28f6a3bfa8352728,0x925c28f6a40ea818,0xa7d327f2246ba8eb,0xa54aa72828502241,0x23bfa8ff1a5a28d0,0x288d1fe6a90d2241,0x1bef28bfa5c9a692,0xa90623bf27f2a818,0xa59fa69228981e55,0x27d3a835a1e0290f,0x28761fe6a90923bf
.quad 0x8000a90f0000290f,0x8000a90f0000290f,0x240e2898a46ba882,0x22a128bfa360a8ad,0xa76ea69227f225f3,0xa644a7b226de2728,0x28c8217ea8f19e55,0x284324f2a88da3bf,0xa90b1e5528eba241,0xa8eb9e55290b8000,0x2876a59fa7d32728,0x29099fe6a8d723bf,0xa6442850243da8d0,0xa898254a27f2a728,0x211ca906125c28ff,0x274ba7f2a51e28ad
.quad 0x1e5528d0a498a818,0xa49828d01e55a90f,0xa575a76e28092498,0x1d8ca90e205628ad,0x283523bfa8f60000,0x1fe628ada59fa728,0xa8fb165b28e5a498,0xa51ea76e282723bf,0x28eba498a7b22818,0x27b22498a8eb0000,0xa80927f2240ea8ff,0xa8b69cc22903a3bf,0x24f2a8eb165b28d0,0x290ea0b9a86a2728,0x9bef28f6a4c5a728,0xa8d7259f266ba8ad
.quad 0x8000a90f0000290f,0x8000a90f0000290f,0x211c28dfa1e0a8d0,0x1f1e28f6a056a8eb,0xa4f2a850259f2818,0xa301a8ad243d2882,0x270326dea7d3a5f3,0x251e2835a61ca7b2,0xa850a49828ad2241,0xa692a72827b225f3,0x28d71fe6a9090000,0x27d3259fa876a3bf,0xa90e1a5a28f6a241,0xa86aa3bf28df1e55,0x28f1a301a87625f3,0x28c81fe6a90d1a5a
.quad 0xa88225f32728a818,0xa8ff000028ffa241,0x2790a7f2a4c528d0,0x290f9fe6a8b6254a,0xa59f28ad1fe6a90f,0xa8f623bf2835a728,0x22a1a9061bef28d0,0x28b6a59fa7032850,0x9a5a28ffa3bfa818,0xa8502728254aa8d0,0x9f1ea898266b25f3,0x2790a835a2a1290b,0x243d27b2a835a241,0xa64428ad1cc2a8ff,0xa66ba59f28d78000,0x24c5a8f61bef28ad
.quad 0x8000a90f0000290f,0x8000a90f0000290f,0x1bef29069d8ca8ff,0x125c290e98c4a90b,0x9fe6a8eb217e28d0,0x965ba90b1cc228ff,0x21e028bfa40ea882,0x18c429069f1ea8eb,0xa3bfa882254a2818,0x9a5aa8ff20b928d0,0x24c52835a66ba728,0x1bef28f6a1e0a8ad,0xa59fa7b2276e25f3,0x9cc2a8eb23012882,0x266b26dea827a498,0x1d8c28dfa40ea850
.quad 0xa728a5f328822241,0x9e55a8d024982818,0x27d324f2a8c89e55,0x1f1e28bfa51ea7b2,0xa835a3bf28f68000,0x9fe6a8ad259f2728,0x2876217ea90d1e55,0x20562898a61ca692,0xa8ad9e55290ba241,0xa0b9a882269225f3,0x28d7165ba8f12498,0x211c286aa703a54a,0xa8f61a5a28bfa5f3,0xa17ea850276e2498,0x29099fe6a8762728,0x21e02835a7d3a3bf
.quad 0x290f,0x0,0xa90f,0x0,0x290f,0x0,0xa90f,0x0,0x290f,0x0,0xa90f,0x0,0x290f,0x0,0xa90f,0x0
.quad 0x290f,0x0,0xa90f,0x0,0x290f,0x0,0xa90f,0x0,0x290f,0x0,0xa90f,0x0,0x290f,0x0,0xa90f
.zero 776
.quad 0x2728a728a7282728,0x2728a728a7282728,0x27a1a6cca75d2716,0x2810a630a7e3267f,0x2809a66ba7902703,0x2876a51ea84325c9,0x283ca607a7c226f1,0x28c4a3eea8882508,0x286aa59fa7f226de,0x28f6a17ea8bf243d,0x2893a534a81026cc,0x290e9df0a8e822d1,0x28b6a4c5a82726b9,0x2909925ca903211c,0x28d4a454a83c26a6,0x28e81c5da90f1eb9
.quad 0x28eba3bfa8502692,0x28ad20b9a90b1a5a,0x28fda2d1a864267f,0x28572331a8f98e5c,0x2909a1e0a876266b,0x27d324c5a8d79bef,0x290fa0eba8882658,0x26cc25dea8a89f82,0x290e9fe6a8982644,0x259f26dea86aa17e,0x29089df0a8a82630,0x245427c2a81fa331,0x28fb9befa8b6261c,0x21e02843a790a46b,0x28e897f2a8c42607,0x1df02893a6cca534
.quad 0x2728a728a7282728,0x2728a728a7282728,0x284aa58aa82e25de,0x287ca4dca8642534,0x28c8a360a8a3246b,0x28fba056a8e521e0,0x29089eb9a8ee21af,0x2905198fa90f17f2,0x2906165ba90e1cc2,0x28982301a8df9fe6,0x28c420eba90197f2,0x277f2607a857a454,0x2843246ba8c8a056,0x251e2809a703a66b,0x27162630a864a390,0x208828bba4dca810
.quad 0x254a27b2a7b2a54a,0x9a5a290ba0b9a8ad,0x22712870a658a6a6,0xa39028f414c5a901,0x1bef28d7a4c5a7d3,0xa66b287621e0a909,0x9d27290aa211a864,0xa83c273a255fa8c4,0xa30129069cc2a8bf,0xa8df24f2276ea835,0xa58a28cc198fa8f9,0xa90f2088287ca6cc,0xa74b285d211ca90f,0xa8c898c428f1a4c5,0xa857277f2454a901,0xa810a2d1290ea0eb
.quad 0x2728a728a7282728,0x2728a728a7282728,0x28a8a425a8932481,0x28cca2d1a8bb2390,0x290f98c4a9091d8c,0x29031befa90d925c,0x28bb2211a8e89f82,0x282e2534a87ca425,0x276e2644a835a4f2,0x24f22835a644a76e,0x24542857a607a77f,0x17f22901a0eba8c4,0x18c428fba1e0a8a3,0xa40e28d71f1ea90d,0xa27128f917f2a90a,0xa7c2277f25b4a888
.quad 0xa692285023bfa8eb,0xa8eb23bf2850a692,0xa87c263026cca84a,0xa8ee97f22905a211,0xa90921e02876a66b,0xa7d3a4c528d71bef,0xa8db998f2901a331,0xa425a81027a124dc,0xa7f2a43d28f6965b,0x165ba8f6243d27f2,0xa508a73a285721af,0x24dca8e80e5c28e2,0x9d8ca8a3266b25c9,0x2827a7d3a40e2903,0x20eba90e22d12810,0x2901a454a77f2857
.quad 0x2728a728a7282728,0x2728a728a7282728,0x28e8a14da8db2211,0x28fd9f82a8f42088,0x28d7211ca8f19f1e,0x288d240ea8b6a2a1,0x26cc2716a7a1a630,0x24dc284aa5dea7e3,0x1fe628dfa301a898,0x9cc2290e965ba906,0xa2d128e81df0a90e,0xa6cc28102534a893,0xa7d3274b261ca85d,0xa8f122a1288da575,0xa90121af289ea55f,0xa8a8a14d29058e5c
.quad 0xa8ada0b9290b9a5a,0xa54aa7b227b2254a,0xa607a6f1283c23ee,0x198fa90821af2888,0x9befa8d724c527d3,0x266ba876a1e02909,0x2454a8ee8e5c28f4,0x28e2a4afa7c22801,0x2835a76ea4f228df,0x28bf1cc2a9062301,0x290ea211a84a275d,0x25b426a6a888a025,0x28762056a90d22a1,0x925c28e5a51ea703,0x253426cca8939df0,0xa60728c417f2a8e8
.quad 0x2728a728a7282728,0x2728a728a7282728,0x290a9c5da9051df0,0x290f94c5a90e198f,0x28272575a85da4c5,0x274b26b9a7d3a61c,0x214d28cca390a893,0x14c5290a9df0a8f4,0xa43d28bf217ea8f6,0xa6de27f2259fa86a,0xa89325342810a6cc,0xa90e1df028e8a2d1,0xa8e59d8c290f9bef,0xa790a5c928762360,0xa5dea75d27e32534,0x998fa8f422d1287c
.quad 0x1a5aa90b20b928ad,0x2692a850a3bf28eb,0x2716a82ea42528e8,0x290aa14da89325de,0x2909a1e0a876266b,0x27d324c5a8d79bef,0x282e2390a8fd17f2,0x1c5d28cca534a75d,0x217e286aa6dea59f,0xa64428981fe6a90e,0xa42528fd9b25a8c4,0xa90523902810a7e3,0xa88d26b92575a8d7,0xa809a36029099f1e,0xa8e817f228c4a607,0x9df0a89326cc2534
.quad 0x2728a728a7282728,0x2728a728a7282728,0x290c17f2a90f8e5c,0x29011d27a9089b25,0x261c27d3a6b9a74b,0x24c5285da575a827,0xa02529011b25a90f,0xa45428b12271a8e2,0xa86a259f27f2a6de,0xa8f6217e28bfa43d,0xa8c4a0eb290117f2,0xa77fa60728572454,0xa360a87625c92790,0x1befa90f1d8c28e5,0x24afa8c4a025290c,0x2857a658a6f1281f
.quad 0x28eba3bfa8502692,0x28ad20b9a90b1a5a,0x281f2454a8e29b25,0x20eb289ea5b4a73a,0x1bef28d7a4c5a7d3,0xa66b287621e0a909,0xa6f128572271a908,0xa90e1eb928b1a5b4,0xa90e1fe62898a644,0xa59fa6de286a217e,0xa658a60728b11d27,0x22d1a90a1eb9289e,0x1f1ea90923602809,0x28d7a575a6b9288d,0x2857a77fa4542901,0x281022d1a90e20eb
.quad 0x2728a728a7282728,0x2728a728a7282728,0x28ee2025a8f99eb9,0x28d421afa8e2a0eb,0x22a128b6a40ea88d,0x1f1e28f1a11ca8d7,0xa658281f255fa870,0xa80126a6273aa77f,0xa906965b290e9cc2,0xa898a30128df1fe6,0xa454a8572607277f,0x97f2a90120eb28c4,0x2575a88da2a128f1,0x285da61ca74b27d3,0x290f9d27a8e223ee,0x284a2425a8db9df0
.quad 0x254a27b2a7b2a54a,0x9a5a290ba0b9a8ad,0xa48128db1c5da90c,0xa8a8258a275da810,0xa90921e02876a66b,0xa7d3a4c528d71bef,0xa630a67f287c214d,0x2025a90f20882893,0x2301a9061cc228bf,0x28dfa4f2a76e2835,0x28f4a481a7a1282e,0x26f1255fa8d497f2,0x2703251ea8e5125c,0xa2a1290da056a876,0xa0eb290ea2d1a810,0xa9012454277fa857
.quad 0x2728a728a7282728,0x2728a728a7282728,0x28b12331a8c4a271,0x28882454a89ea3ee,0x125c290d9befa903,0x9d8c290918c4a90f,0xa89e24af2857a5b4,0xa8f920eb28d4a331,0xa76ea644283524f2,0xa4f2a8352644276e,0x22d1a8e89df0290e,0x26cca810a5342893,0x290d9f1ea8d7240e,0x28a321e0a8fb98c4,0x2481282ea6cca67f,0x9b25290e9f82a8cc
.quad 0xa692285023bfa8eb,0xa8eb23bf2850a692,0xa8d49d27290ea088,0xa55fa77f280124af,0x9befa8d724c527d3,0x266ba876a1e02909,0x2870a6a6a607289e,0x28bb1df0a90c21af,0x27f2243da8f6165b,0x965b28f6a43da7f2,0xa14d290fa0eba870,0xa8db25342716a864,0xa903240e27d3a827,0xa5c9a66b28a31d8c,0xa534a6cc28931df0,0x2607a8c497f228e8
.quad 0x2728a728a7282728,0x2728a728a7282728,0x28572508a870a4af,0x281f25b4a83ca55f,0xa1e028e52056a8fb,0xa46b28a32360a8c8,0xa90e0e5c290c9d27,0xa8dba08828fd1c5d,0x9fe6a8df23012898,0x1cc2a90e165b2906,0x2893a534a81026cc,0x290e9df0a8e822d1,0x266b2703a809a51e,0x205628c8a46ba843,0xa60728702331a8ee,0xa8b125082801a73a
.quad 0xa8ada0b9290b9a5a,0xa54aa7b227b2254a,0x1df0a90f202528b1,0x27a1a7e3a4dc28cc,0x2909a1e0a876266b,0x27d324c5a8d79bef,0x22d1284aa716a58a,0xa50828d41b25a905,0xa835276e24f2a8df,0xa8bf9cc22906a301,0xa77fa4af28ee94c5,0x1f82a90c2271283c,0x24c5a8f118c428c8,0x290fa11ca85d274b,0x28e897f2a8c42607,0x1df02893a6cca534
.quad 0x2728a728a7282728,0x2728a728a7282728,0x27c22658a801a607,0x273a26f1a77fa6a6,0xa5c92843251ea876,0xa7032790266ba809,0xa864a48128a822d1,0xa75da67f2810258a,0x243da8bfa17e28f6,0x26dea7f2a59f286a,0x28c420eba90197f2,0x277f2607a857a454,0xa11c2903125ca909,0xa6b9282724c5a8b6,0xa8fd94c52908a0eb,0xa7a1a58a28932211
.quad 0x1a5aa90b20b928ad,0x2692a850a3bf28eb,0x290f9f82a8bb2534,0x27c22508a8c49eb9,0x1bef28d7a4c5a7d3,0xa66b287621e0a909,0xa8f923ee281fa77f,0xa7e3a48128e814c5,0xa17ea86a26de259f,0x2644a8989fe6290e,0x28bba5dea67f2893,0x280123eea9011c5d,0x246b2790a843a1e0,0xa61c28b61befa8fb,0xa857277f2454a901,0xa810a2d1290ea0eb
.quad 0x2728a728a7282728,0x2728a728a7282728,0x26a6277fa6f1a73a,0x26072801a658a7c2,0xa809266b2790a703,0xa876251e2843a5c9,0xa58aa810267f275d,0xa2d1a8a824812864,0x286aa59fa7f226de,0x28f6a17ea8bf243d,0x24542857a607a77f,0x17f22901a0eba8c4,0xa8b624c52827a6b9,0xa909125c2903a11c,0xa211a893258a27a1,0x20eba90814c528fd
.quad 0x28eba3bfa8502692,0x28ad20b9a90b1a5a,0x1eb928c4a508a7c2,0xa53428bb1f82a90f,0xa90921e02876a66b,0xa7d3a4c528d71bef,0x94c5a8e8248127e3,0x277fa81fa3ee28f9,0x290e9fe6a8982644,0x259f26dea86aa17e,0x9c5d2901a3eea801,0xa893267f25dea8bb,0xa8fb1bef28b6a61c,0xa1e0a8432790246b,0x20eba90e22d12810,0x2901a454a77f2857
.quad 0x2728a728a7282728,0x2728a728a7282728,0x255f283ca5b4a81f,0x24af2870a508a857,0xa8c8236028a3a46b,0xa8fb205628e5a1e0,0x9c5da8fd208828db,0x1d27a90c8e5c290e,0x2906165ba90e1cc2,0x28982301a8df9fe6,0xa2d128e81df0a90e,0xa6cc28102534a893,0xa843a46b28c82056,0xa51ea8092703266b,0x273aa801a50828b1,0x28eea331a8702607
.quad 0x254a27b2a7b2a54a,0x9a5a290ba0b9a8ad,0xa8cc24dc27e3a7a1,0xa8b1a025290f9df0,0x9befa8d724c527d3,0x266ba876a1e02909,0x29059b25a8d42508,0x258a2716a84aa2d1,0xa30129069cc2a8bf,0xa8df24f2276ea835,0xa83ca271290c9f82,0x14c5a8ee24af277f,0x274ba85da11c290f,0x28c818c4a8f124c5,0x253426cca8939df0,0xa60728c417f2a8e8
.quad 0x2728a728a7282728,0x2728a728a7282728,0x23ee289ea454a888,0x227128c4a331a8b1,0xa90f18c429099d8c,0xa9039bef290d125c,0x2331a8d4a0eb28f9,0x25b4a857a4af289e,0x276e2644a835a4f2,0x24f22835a644a76e,0xa89325342810a6cc,0xa90e1df028e8a2d1,0x98c4a8fb21e028a3,0x240ea8d79f1e290d,0x28cc1f82a90e1b25,0x267f26cca82ea481
.quad 0xa692285023bfa8eb,0xa8eb23bf2850a692,0xa4afa801277f255f,0x2088a90e1d2728d4,0x2909a1e0a876266b,0x27d324c5a8d79bef,0xa1af290c9df0a8bb,0xa89e260726a6a870,0xa7f2a43d28f6965b,0x165ba8f6243d27f2,0x2864a716a53428db,0x287020eba90f214d,0x1d8c28a3a66ba5c9,0xa82727d3240ea903,0xa8e817f228c4a607,0x9df0a89326cc2534
.quad 0x2728a728a7282728,0x2728a728a7282728,0x20eb28e2a1afa8d4,0x1eb928f9a025a8ee,0xa8d7a11c28f11f1e,0xa88da40e28b622a1,0x277fa73aa6a62801,0x2870a55fa81f2658,0x1fe628dfa301a898,0x9cc2290e965ba906,0xa8c4a0eb290117f2,0xa77fa60728572454,0x27d3a74ba61c285d,0x28f1a2a1a88d2575,0x1df028dba425a84a,0xa3ee28e21d27a90f
.quad 0xa8ada0b9290b9a5a,0xa54aa7b227b2254a,0x2810a75da58a28a8,0x290c9c5da8db2481,0x1bef28d7a4c5a7d3,0xa66b287621e0a909,0xa893a088290fa025,0xa14da87c267f2630,0x2835a76ea4f228df,0x28bf1cc2a9062301,0x17f228d4a55fa6f1,0xa82e27a12481a8f4,0xa876a056290da2a1,0x125ca8e5251e2703,0x2857a77fa4542901,0x281022d1a90e20eb
.quad 0x2728a728a7282728,0x2728a728a7282728,0x1b2529089d27a901,0xe5c290f97f2a90c,0xa827a575285d24c5,0xa74ba6b927d3261c,0x28e2a271a8b12454,0x290f9b25a9012025,0xa43d28bf217ea8f6,0xa6de27f2259fa86a,0xa454a8572607277f,0x97f2a90120eb28c4,0x28e51d8ca90f1bef,0x279025c9a876a360,0xa81f26f12658a857,0xa90c202528c4a4af
.quad 0x1a5aa90b20b928ad,0x2692a850a3bf28eb,0x273a25b4a89ea0eb,0x1b2528e2a454a81f,0xa90921e02876a66b,0xa7d3a4c528d71bef,0x25b4a8b19eb9290e,0x2908a271a85726f1,0x217e286aa6dea59f,0xa64428981fe6a90e,0xa89e9eb9290aa2d1,0x9d27a8b126072658,0x288da6b9a57528d7,0x28092360a9091f1e,0xa0eb290ea2d1a810,0xa9012454277fa857
.quad 0x2728a728a7282728,0x2728a728a7282728,0x998f290e14c5a90f,0x9df029051c5da90a,0xa61ca7d326b9274b,0xa4c5a85d25752827,0x28f41df0a90a94c5,0x28932390a8cca14d,0xa86a259f27f2a6de,0xa8f6217e28bfa43d,0x22d1a8e89df0290e,0x26cca810a5342893,0x23602876a5c9a790,0x9bef290f9d8ca8e5,0xa87ca2d128f4198f,0xa534a7e3275d25de
.quad 0x28eba3bfa8502692,0x28ad20b9a90b1a5a,0xa5de2893214da90a,0xa8e82425282ea716,0x9befa8d724c527d3,0x266ba876a1e02909,0x275d2534a8cc9c5d,0x97f228fda390a82e,0xa90e1fe62898a644,0xa59fa6de286a217e,0x27e3a810a3902905,0x28c41b25a8fd2425,0x9f1e2909a360a809,0xa8d7257526b9a88d,0xa534a6cc28931df0,0x2607a8c497f228e8
.quad 0x2728a728a7282728,0x2728a728a7282728,0xa08828f41f82a8fd,0xa21128db214da8e8,0xa2a1a8b6240e288d,0x9f1ea8f1211c28d7,0x27e325dea84aa4dc,0x263027a1a716a6cc,0xa906965b290e9cc2,0xa898a30128df1fe6,0x2893a534a81026cc,0x290e9df0a8e822d1,0xa575288d22a1a8f1,0xa85d261c274ba7d3,0xe5ca905214d28a8,0x255fa89ea1af2901
.quad 0x254a27b2a7b2a54a,0x9a5a290ba0b9a8ad,0xa888a1af2908998f,0xa3eea83c26f12607,0x2909a1e0a876266b,0x27d324c5a8d79bef,0xa80127c224afa8e2,0xa8f40e5c28eea454,0x2301a9061cc228bf,0x28dfa4f2a76e2835,0x20252888a6a6a5b4,0xa75d284a2211a90e,0xa703a51e28e5925c,0x22a1a90d20562876,0x28e897f2a8c42607,0x1df02893a6cca534
.quad 0x2728a728a7282728,0x2728a728a7282728,0xa39028bb22d1a8cc,0xa48128932425a8a8,0x925ca90d1bef2903,0x1d8ca90998c4290f,0x2425287ca534a82e,0x1f8228e8a211a8bb,0xa76ea644283524f2,0xa4f2a8352644276e,0x28c420eba90197f2,0x277f2607a857a454,0xa90d1f1e28d7a40e,0xa8a3a1e028fb18c4,0x2888a5b4a77f27c2,0x290a97f2a8f92271
.quad 0xa692285023bfa8eb,0xa8eb23bf2850a692,0x2211a90517f228ee,0x284aa6cca630287c,0x1bef28d7a4c5a7d3,0xa66b287621e0a909,0xa4dca7a128102425,0x2331a901198f28db,0x27f2243da8f6165b,0x965b28f6a43da7f2,0xa8e28e5c28e8a4dc,0xa1afa857273a2508,0x2903a40ea7d32827,0x25c9266ba8a39d8c,0xa857277f2454a901,0xa810a2d1290ea0eb
.quad 0x2728a728a7282728,0x2728a728a7282728,0xa534286424dca87c,0xa5de282e258aa84a,0x21e0a8e5a05628fb,0x246ba8a3a36028c8,0x97f2290f998fa905,0xa1af28ee1eb9a908,0x9fe6a8df23012898,0x1cc2a90e165b2906,0x24542857a607a77f,0x17f22901a0eba8c4,0xa66ba7032809251e,0xa056a8c8246b2843,0x281024dca8bba088,0x23902864a630a716
.quad 0xa8ada0b9290b9a5a,0xa54aa7b227b2254a,0x290194c5a8f42390,0x26a62658a870a271,0xa90921e02876a66b,0xa7d3a4c528d71bef,0x28c4a55fa73a283c,0x28642211a90a1d27,0xa835276e24f2a8df,0xa8bf9cc22906a301,0x26cca87ca088290f,0x28f9998fa8cc258a,0xa4c528f198c4a8c8,0xa90f211c285da74b,0x20eba90e22d12810,0x2901a454a77f2857
.quad 0x2728a728a7282728,0x2728a728a7282728,0xa67f27e32630a810,0xa716275d26cca7a1,0x25c9a843a51e2876,0x2703a790a66b2809,0xa508288823eea8c4,0xa6f127c22607a83c,0x243da8bfa17e28f6,0x26dea7f2a59f286a,0xa2d128e81df0a90e,0xa6cc28102534a893,0x211ca903925c2909,0x26b9a827a4c528b6,0x9eb9290f9c5da8e8,0xa6a6283c2454a8d4
.quad 0x1a5aa90b20b928ad,0x2692a850a3bf28eb,0xe5c28f9a331a857,0xa67f286422d1a8fd,0x9befa8d724c527d3,0x266ba876a1e02909,0x1f8228a8a5dea6cc,0xa658288820eba90f,0xa17ea86a26de259f,0x2644a8989fe6290e,0x2331281fa7c2a454,0xa63028a81df0a908,0xa46ba790284321e0,0x261ca8b69bef28fb,0x253426cca8939df0,0xa60728c417f2a8e8
.quad 0xa90f0000290f0000,0xa90f0000290f0000,0xa90d965b290f0000,0xa9039cc229091a5a,0xa9069a5a290e0000,0xa8dfa0b928f61e55,0xa8fb9cc2290d0000,0xa8a3a30128d720b9,0xa8eb9e55290b0000,0xa850a49828ad2241,0xa8d79fe629090000,0xa7d3a59f287623bf,0xa8bfa0b929060000,0xa6dea69228352498,0xa8a3a17e29030000,0xa5c9a76e27d3254a
.quad 0xa882a24128ff0000,0xa498a818272825f3,0xa85da30128fb0000,0xa2a1a86a266b2692,0xa835a3bf28f60000,0x9fe6a8ad259f2728,0xa809a43d28f10000,0x98c4a8df24c527b2,0xa7b2a49828eb0000,0x1a5aa8ff23bf2818,0xa74ba4f228e50000,0x2056a90e21e02850,0xa6dea54a28df0000,0x2301a90b1fe62882,0xa66ba59f28d70000,0x24c5a8f61bef28ad
.quad 0xa90f0000290f0000,0xa90f0000290f0000,0xa8f19fe628fb1e55,0xa8d7a17e28e520b9,0xa898a3bf28bf2241,0xa835a54a286a2498,0xa809a59f285d2498,0xa66ba76e274b2692,0xa692a72827b225f3,0xa3bfa882254a2818,0xa4c5a835266b2728,0x9befa8f621e028ad,0xa17ea8ad24f22818,0x1fe6a90b165b28ff,0x98c4a8f622a12882,0x24c5a8bfa056290b
.quad 0x1e55a90f1e5528d0,0x2728a818a49828d0,0x2360a8f6925c28ff,0x2876a644a6b92850,0x259fa8ad9fe6290f,0x28f6a3bfa8352728,0x274ba835a36028ff,0x29099cc2a8c8254a,0x2850a728a54a28d0,0x28ad1e55a90b2241,0x28c8a59fa6b92882,0x27d3243da8fb1a5a,0x2906a3bfa7f22818,0x259f2692a8989e55,0x29099fe6a8762728,0x21e02835a7d3a3bf
.quad 0xa90f0000290f0000,0xa90f0000290f0000,0xa8b6a30128c82241,0xa88da43d28a323bf,0xa76ea69227f225f3,0xa644a7b226de2728,0xa46ba86a25752818,0xa056a8df22a128ad,0x9a5aa8ff20b928d0,0x20b9a8ff9a5a290f,0x21e0a8f69bef290f,0x266ba835a4c528ad,0x2644a850a43d28d0,0x2898a54aa7f22728,0x285da644a7032818,0x290f9cc2a8e523bf
.quad 0x28ffa241a88225f3,0x28822241a8ff0000,0x28f1165ba9032241,0x261c26dea843a3bf,0x283523bfa8f60000,0x1fe628ada59fa728,0x25c926dea85da241,0xa11c290e9f1ea8ad,0x20b92882a692a5f3,0xa692288220b9a90f,0x9d8c2906a360a818,0xa8a32644261ca8ad,0xa4f228eb965ba8d0,0xa90e20b9286aa728,0xa7d3283521e0a90f,0xa8769fe62909a3bf
.quad 0xa90f0000290f0000,0xa90f0000290f0000,0xa85da4f228762498,0xa827a59f2843254a,0xa4f2a850259f2818,0xa301a8ad243d2882,0x125ca90e1bef28ff,0x211ca8f69d8c290b,0x254aa882a3bf28d0,0x27b2a728a6922818,0x2876a59fa7d32728,0x29099fe6a8d723bf,0x290e9a5aa8f62241,0x286a23bfa8df9e55,0x2843243da8d79e55,0x246b2835a6b9a692
.quad 0x24982818a728a5f3,0x9e55290f9e55a8d0,0x98c42906a1e0a882,0xa7032835240ea8eb,0xa59f28ad1fe6a90f,0xa8f623bf2835a728,0xa88d2644266ba882,0xa8a39fe6290fa0b9,0xa90b1e5528ada5f3,0xa54aa72828502241,0xa827a30129099e55,0x18c4a8f6246b27b2,0xa43da7b228352241,0x2644a8ad9cc228ff,0x1befa8f624c52728,0x28d7a59fa66b28ad
.quad 0xa90f0000290f0000,0xa90f0000290f0000,0xa7d3a644280925f3,0xa74ba6de27902692,0x9fe6a8eb217e28d0,0x965ba90b1cc228ff,0x24c5a898a36028d0,0x26b9a7f2a5c92850,0x28ada498a85025f3,0x290b9e55a8eb2241,0x28d71fe6a9090000,0x27d3259fa876a3bf,0x259f27b2a76ea5f3,0x1cc228eba301a882,0x9bef290e9f1ea8d0,0xa61c286a2360a8eb
.quad 0xa72828182498a8d0,0xa8ff22412882a5f3,0xa909217e288da5f3,0xa827a43d28e51a5a,0xa835a3bf28f60000,0x9fe6a8ad259f2728,0xa1e0a86a26b925f3,0x2575a8bf9d8c290b,0x23bfa8ff1a5a28d0,0x28eba498a7b22818,0x2876a6dea57528d0,0x285d217ea90f20b9,0x28f69a5aa8bf25f3,0x217e2850a76ea498,0x266b259fa8d70000,0xa4c528f69befa8ad
.quad 0xa90f0000290f0000,0xa90f0000290f0000,0xa6b9a76e27032728,0xa61ca7f2266b27b2,0x1cc2a90b965b290f,0x217ea8eb9fe628ff,0x2827a644a7902728,0x28b6a43da876254a,0x28eb1e55a90b0000,0x28502498a8ada241,0x24c52835a66ba728,0x1bef28f6a1e0a8ad,0xa30128eb1cc2a90f,0xa76e27b2259fa882,0xa8b624f22809a728,0xa8fb965b2909a0b9
.quad 0xa882a24128ff0000,0xa498a818272825f3,0xa11ca89825c92728,0x246ba8df9bef290b,0x259fa8ad9fe6290f,0x28f6a3bfa8352728,0x2903a301a8432728,0x279024f2a8d79a5a,0x27b22498a8eb0000,0x9a5a28ffa3bfa818,0x125c28dfa51ea728,0xa843276e24c5a8eb,0xa76e2850217ea90f,0xa8bf9a5a28f6a498,0xa9091fe62876a728,0xa1e0a83527d323bf
.quad 0xa90f0000290f0000,0xa90f0000290f0000,0xa575a83525c92818,0xa4c5a86a251e2850,0x243da8ada30128d0,0x259fa850a4f22882,0x29039fe6a8e52241,0x2909165ba90f1a5a,0x26922728a7b2a5f3,0x23bf2882a54aa818,0xa1e028f61befa90f,0xa66b283524c5a8ad,0xa8df23bf286aa5f3,0xa8f69a5a290e9e55,0xa790a59f288d2241,0xa1e0a898257527b2
.quad 0x1e55a90f1e5528d0,0x2728a818a49828d0,0x28a3a59fa74b2818,0x28d71cc2a90d20b9,0x283523bfa8f60000,0x1fe628ada59fa728,0x925c28f6a40ea818,0xa7d327f2246ba8eb,0xa8502728254aa8d0,0xa8ad9e55290ba241,0xa88d9fe6290da241,0x9befa8bf25c92692,0x9cc2a8ad264425f3,0x2835a7b2a43d28ff,0x27d3a835a1e0290f,0x28761fe6a90923bf
.quad 0xa90f0000290f0000,0xa90f0000290f0000,0xa40ea898246b2882,0xa2a1a8bf236028ad,0x26dea7b2a6442818,0x27f2a692a76e2728,0x28c8217ea8f19e55,0x284324f2a88da3bf,0x1a5a28ffa0b9a8d0,0xa0b928ff1a5aa90f,0xa876259f27d3a728,0xa9091fe628d7a3bf,0xa7f2a54a28982241,0xa43da85026442728,0x211ca906125c28ff,0x274ba7f2a51e28ad
.quad 0x28ffa241a88225f3,0x28822241a8ff0000,0x2575276ea809a498,0x9d8c290ea056a8ad,0xa59f28ad1fe6a90f,0xa8f623bf2835a728,0xa8fb165b28e5a498,0xa51ea76e282723bf,0xa0b9a882269225f3,0x2692a882a0b9290f,0x2809a7f2a40e28ff,0x28b61cc2a90323bf,0x286a20b9a90e2241,0x965b28eba4f2a728,0x9bef28f6a4c5a728,0xa8d7259f266ba8ad
.quad 0xa90f0000290f0000,0xa90f0000290f0000,0xa11ca8df21e028d0,0x9f1ea8f6205628eb,0x286aa54aa83525f3,0x28bfa3bfa8982498,0x270326dea7d3a5f3,0x251e2835a61ca7b2,0xa54a288223bfa8d0,0xa7b227282692a818,0xa8d79fe629090000,0xa7d3a59f287623bf,0x165ba90b1fe628d0,0x24f2a8ada17e28ff,0x28f1a301a87625f3,0x28c81fe6a90d1a5a
.quad 0x24982818a728a5f3,0x9e55290f9e55a8d0,0xa79027f224c5a8d0,0xa90f1fe628b6a54a,0xa835a3bf28f60000,0x9fe6a8ad259f2728,0x22a1a9061bef28d0,0x28b6a59fa7032850,0x290b9e55a8ad25f3,0x254a2728a850a241,0x1f1e2898a66ba5f3,0xa790283522a1a90b,0xa8982692259fa8d0,0xa7f2a3bf29069e55,0xa66ba59f28d70000,0x24c5a8f61bef28ad
.quad 0xa90f0000290f0000,0xa90f0000290f0000,0x9befa9061d8c28ff,0x925ca90e18c4290b,0x28f6a0b9a8df2241,0x290e9a5aa9061e55,0x21e028bfa40ea882,0x18c429069f1ea8eb,0xa8ad24982850a5f3,0xa90b1e5528eba241,0xa4c5a835266b2728,0x9befa8f621e028ad,0x2835a692a6de2818,0x2906a0b9a8bf2498,0x266b26dea827a498,0x1d8c28dfa40ea850
.quad 0xa72828182498a8d0,0xa8ff22412882a5f3,0xa7d3a4f228c81e55,0x9f1ea8bf251e27b2,0x259fa8ad9fe6290f,0x28f6a3bfa8352728,0x2876217ea90d1e55,0x20562898a61ca692,0xa3bf28ff9a5aa8d0,0xa8eb249827b2a818,0xa8d7965b28f1a498,0xa11ca86a2703254a,0x1fe6a90b23012818,0x28dfa54aa6de2882,0x29099fe6a8762728,0x21e02835a7d3a3bf
.quad 0xa90f0000290f0000,0xa90f0000290f0000,0x18c4a90e925c290f,0x1d8ca9069bef290b,0x29061a5aa90e0000,0x28df20b9a8f69e55,0x9f1e290618c4a90f,0xa40e28bf21e0a8eb,0xa8eb9e55290b0000,0xa850a49828ad2241,0x21e0a8f69bef290f,0x266ba835a4c528ad,0x28bf20b9a9060000,0x26de2692a835a498,0xa40e28df1d8ca90f,0xa82726de266ba850
.quad 0xa882a24128ff0000,0xa498a818272825f3,0x251ea8bf9f1e290f,0x28c8a4f2a7d327b2,0x283523bfa8f60000,0x1fe628ada59fa728,0xa61c28982056a90f,0xa90d217e2876a692,0xa7b2a49828eb0000,0x1a5aa8ff23bf2818,0x2703a86aa11c290f,0x28f1965ba8d7254a,0x26de254aa8df0000,0xa301290b9fe6a882,0xa7d3283521e0a90f,0xa8769fe62909a3bf
.quad 0xa90f0000290f0000,0xa90f0000290f0000,0x2056a8f69f1e28ff,0x21e0a8dfa11c28eb,0x289823bfa8bfa241,0x2835254aa86aa498,0xa61c2835251ea882,0xa7d326de2703a7b2,0xa692a72827b225f3,0xa3bfa882254a2818,0x2876a59fa7d32728,0x29099fe6a8d723bf,0x217e28ada4f2a818,0x9fe6290b965ba8ff,0xa90d1fe628c8a498,0xa876a30128f11a5a
.quad 0x1e55a90f1e5528d0,0x2728a818a49828d0,0x28b61fe6a90f1e55,0x24c527f2a790a54a,0xa59f28ad1fe6a90f,0xa8f623bf2835a728,0xa703a59f28b61e55,0x1befa90622a12850,0x2850a728a54a28d0,0x28ad1e55a90b2241,0x22a12835a790a498,0xa66b28981f1ea90b,0xa90623bf27f2a818,0xa59fa69228981e55,0x1befa8f624c52728,0x28d7a59fa66b28ad
.quad 0xa90f0000290f0000,0xa90f0000290f0000,0x2360a8bfa2a128d0,0x246ba898a40e28ad,0x276e2692a7f2a5f3,0x264427b2a6dea728,0xa88d24f22843a5f3,0xa8f1217e28c8a3bf,0x9a5aa8ff20b928d0,0x20b9a8ff9a5a290f,0x28d71fe6a9090000,0x27d3259fa876a3bf,0xa6442850243da8d0,0xa898254a27f2a728,0xa51ea7f2274b25f3,0x125ca906211c28ad
.quad 0x28ffa241a88225f3,0x28822241a8ff0000,0xa056290e9d8ca8d0,0xa809276e2575a8ad,0xa835a3bf28f60000,0x9fe6a8ad259f2728,0x2827a76ea51e28d0,0x28e5165ba8fb23bf,0x20b92882a692a5f3,0xa692288220b9a90f,0xa9031cc228b6a5f3,0xa40ea7f2280923bf,0x24f2a8eb165b28d0,0x290ea0b9a86a2728,0x266b259fa8d70000,0xa4c528f69befa8ad
.quad 0xa90f0000290f0000,0xa90f0000290f0000,0x251ea86aa4c52882,0x25c9a835a5752850,0x24f22850a59fa818,0x230128ada43da882,0xa90f165b29099e55,0xa8e59fe629031a5a,0x254aa882a3bf28d0,0x27b2a728a6922818,0x24c52835a66ba728,0x1bef28f6a1e0a8ad,0xa90e1a5a28f6a241,0xa86aa3bf28df1e55,0x2575a898a1e028ff,0x288da59fa79027b2
.quad 0x24982818a728a5f3,0x9e55290f9e55a8d0,0xa90d1cc228d7a498,0xa74ba59f28a320b9,0x259fa8ad9fe6290f,0x28f6a3bfa8352728,0x246b27f2a7d3a498,0xa40e28f6925ca8eb,0xa90b1e5528ada5f3,0xa54aa72828502241,0x25c9a8bf9bef28ff,0x290d9fe6a88d2692,0x243d27b2a835a241,0xa64428ad1cc2a8ff,0xa9091fe62876a728,0xa1e0a83527d323bf
.quad 0xa90f0000290f0000,0xa90f0000290f0000,0x266ba7f2a61c2818,0x2703a76ea6b927b2,0x1fe628eba17ea8d0,0x165b290b9cc2a8ff,0xa876a43d28b62241,0xa790a6442827254a,0x28ada498a85025f3,0x290b9e55a8eb2241,0xa1e028f61befa90f,0xa66b283524c5a8ad,0xa59fa7b2276e25f3,0x9cc2a8eb23012882,0x2909965ba8fb2241,0x280924f2a8b6a0b9
.quad 0xa72828182498a8d0,0xa8ff22412882a5f3,0x9befa8df246b2818,0x25c9a898a11c290b,0x283523bfa8f60000,0x1fe628ada59fa728,0xa8d724f22790a818,0xa843a30129039a5a,0x23bfa8ff1a5a28d0,0x28eba498a7b22818,0x24c5276ea843a241,0xa51e28df125ca8eb,0xa8f61a5a28bfa5f3,0xa17ea850276e2498,0x27d3a835a1e0290f,0x28761fe6a90923bf
.quad 0xa90f0000290f0000,0xa90f0000290f0000,0x2790a6dea74b2728,0x2809a644a7d32692,0x9cc2290b165ba90f,0xa17e28eb1fe6a8ff,0xa5c9a7f226b92728,0xa360a89824c52850,0x28eb1e55a90b0000,0x28502498a8ada241,0xa876259f27d3a728,0xa9091fe628d7a3bf,0x2301a8eb9cc2290f,0x276ea7b2a59f2882,0x2360286aa61ca728,0x9f1e290e9befa8eb
.quad 0xa882a24128ff0000,0xa498a818272825f3,0x28e5a43da8272728,0x288d217ea9091a5a,0xa59f28ad1fe6a90f,0xa8f623bf2835a728,0x9d8ca8bf25752728,0x26b9a86aa1e0290b,0x27b22498a8eb0000,0x9a5a28ffa3bfa818,0xa90f217e285da728,0xa575a6de287620b9,0x276ea850a17e290f,0x28bf1a5aa8f62498,0x9bef28f6a4c5a728,0xa8d7259f266ba8ad
.quad 0xa90f0000290f0000,0xa90f0000290f0000,0x2843a59fa82725f3,0x2876a4f2a85d254a,0xa43d28ad2301a8d0,0xa59f285024f2a882,0x9d8ca8f6211c28d0,0x1befa90e125c290b,0x26922728a7b2a5f3,0x23bf2882a54aa818,0xa8d79fe629090000,0xa7d3a59f287623bf,0x28dfa3bfa86a25f3,0x28f61a5aa90e1e55,0xa6b92835246ba8d0,0xa8d7243d2843a692
.quad 0x1e55a90f1e5528d0,0x2728a818a49828d0,0x240e2835a703a5f3,0xa1e0290698c4a8eb,0xa835a3bf28f60000,0x9fe6a8ad259f2728,0x290f9fe6a8a325f3,0x266b2644a88da0b9,0xa8502728254aa8d0,0xa8ad9e55290ba241,0x246ba8f618c428d0,0x2909a301a82727b2,0x1cc228ada644a5f3,0xa83527b2243da8ff,0xa66ba59f28d70000,0x24c5a8f61bef28ad
.quad 0xa90f0000290f0000,0xa90f0000290f0000,0x28a3a43da88d2498,0x28c8a301a8b623bf,0xa6de27b22644a818,0xa7f22692276ea728,0x22a1a8dfa05628ff,0x2575a86aa46b28ad,0x1a5a28ffa0b9a8d0,0xa0b928ff1a5aa90f,0xa4c5a835266b2728,0x9befa8f621e028ad,0x27f2254aa898a241,0x243d2850a644a728,0xa8e59cc2290f9e55,0xa703a644285d23bf
.quad 0x28ffa241a88225f3,0x28822241a8ff0000,0xa84326de261ca882,0xa903165b28f1a3bf,0x259fa8ad9fe6290f,0x28f6a3bfa8352728,0x9f1e290ea11ca882,0xa85d26de25c9a8ad,0xa0b9a882269225f3,0x2692a882a0b9290f,0x261c2644a8a39e55,0xa36029069d8ca8ad,0xa86aa0b9290ea241,0x165ba8eb24f22728,0x29099fe6a8762728,0x21e02835a7d3a3bf
.quad 0xa90f0000290f0000,0xa90f0000290f0000,0x28e5a17ea8d72241,0x28fb9fe6a8f120b9,0xa86a254a2835a5f3,0xa8bf23bf2898a498,0x274ba76ea66b2818,0x285da59fa8092692,0xa54a288223bfa8d0,0xa7b227282692a818,0x21e0a8f69bef290f,0x266ba835a4c528ad,0x965b290b9fe6a8d0,0xa4f228ad217ea8ff,0xa056a8bf24c52818,0x22a1a8f698c4290b
.quad 0x24982818a728a5f3,0x9e55290f9e55a8d0,0xa6b9a64428762241,0x925ca8f623602850,0x283523bfa8f60000,0x1fe628ada59fa728,0xa8c89cc22909a241,0xa360a835274b254a,0x290b9e55a8ad25f3,0x254a2728a850a241,0xa8fb243d27d3a818,0xa6b9a59f28c81a5a,0x2898a692a59f28d0,0x27f223bfa9061e55,0xa7d3283521e0a90f,0xa8769fe62909a3bf
.quad 0xa90f0000290f0000,0xa90f0000290f0000,0x29099cc2a9031e55,0x290f965ba90d1a5a,0xa8f620b928dfa241,0xa90e1a5a29069e55,0x28d7a301a8a32498,0x290d9cc2a8fb20b9,0xa8ad24982850a5f3,0xa90b1e5528eba241,0x2876a59fa7d32728,0x29099fe6a8d723bf,0xa835269226dea818,0xa90620b928bfa498,0x27d3a76ea5c92882,0x2903a17ea8a3254a
.quad 0xa72828182498a8d0,0xa8ff22412882a5f3,0x266ba86aa2a128ff,0x28fba301a85d2692,0xa59f28ad1fe6a90f,0xa8f623bf2835a728,0x24c5a8df98c428ff,0x28f1a43da80927b2,0xa3bf28ff9a5aa8d0,0xa8eb249827b2a818,0x21e0a90e20562882,0x28e5a4f2a74b2850,0x9fe6290ba301a818,0xa8df254a26dea882,0x1befa8f624c52728,0x28d7a59fa66b28ad
.quad 0xa728a72827282728,0xa728a72827282728,0xa6a6a77f26f1273a,0xa607a801265827c2,0xa61ca7d326b9274b,0xa4c5a85d25752827,0xa58aa810267f275d,0xa2d1a8a824812864,0xa4f2a8352644276e,0x9fe6a8df23012898,0xa454a8572607277f,0x97f2a90120eb28c4,0xa360a87625c92790,0x1befa90f1d8c28e5,0xa211a893258a27a1,0x20eba90814c528fd
.quad 0xa0b9a8ad254a27b2,0x23bfa8eb9a5a290b,0x9eb9a8c4250827c2,0x2534a8bb9f82290f,0x9befa8d724c527d3,0x266ba876a1e02909,0x94c5a8e8248127e3,0x277fa81fa3ee28f9,0x165ba8f6243d27f2,0x2835a76ea4f228df,0x1c5da90123ee2801,0x2893a67fa5de28bb,0x1f1ea90923602809,0x28d7a575a6b9288d,0x20eba90e22d12810,0x2901a454a77f2857
.quad 0xa728a72827282728,0xa728a72827282728,0xa55fa83c25b4281f,0xa4afa87025082857,0xa2a1a8b6240e288d,0x9f1ea8f1211c28d7,0x9c5da8fd208828db,0x1d27a90c8e5c290e,0x1cc2a90e165b2906,0x243da8bfa17e28f6,0x22d1a8e89df0290e,0x26cca810a5342893,0x2575a88da2a128f1,0x285da61ca74b27d3,0x273aa801a50828b1,0x28eea331a8702607
.quad 0x2850a692a6922850,0x290b9a5aa8eb23bf,0x28cca4dca7e327a1,0x28b12025a90f1df0,0x2909a1e0a876266b,0x27d324c5a8d79bef,0x29059b25a8d42508,0x258a2716a84aa2d1,0x28bf1cc2a9062301,0x217e286aa6dea59f,0x283c2271a90c1f82,0x94c528eea4afa77f,0x2703251ea8e5125c,0xa2a1290da056a876,0x253426cca8939df0,0xa60728c417f2a8e8
.quad 0xa728a72827282728,0xa728a72827282728,0xa3eea89e24542888,0xa271a8c4233128b1,0x925ca90d1bef2903,0x1d8ca90998c4290f,0x2331a8d4a0eb28f9,0x25b4a857a4af289e,0x26dea7f2a59f286a,0x286aa59fa7f226de,0x2893a534a81026cc,0x290e9df0a8e822d1,0x290d9f1ea8d7240e,0x28a321e0a8fb98c4,0x28cc1f82a90e1b25,0x267f26cca82ea481
.quad 0x27b2254aa8ada0b9,0x20b928ada54aa7b2,0x24af2801a77fa55f,0xa088290e9d27a8d4,0x1bef28d7a4c5a7d3,0xa66b287621e0a909,0xa1af290c9df0a8bb,0xa89e260726a6a870,0xa64428981fe6a90e,0xa90e1fe62898a644,0xa86427162534a8db,0xa870a0eb290fa14d,0xa903240e27d3a827,0xa5c9a66b28a31d8c,0xa8e817f228c4a607,0x9df0a89326cc2534
.quad 0xa728a72827282728,0xa728a72827282728,0xa0eba8e221af28d4,0x9eb9a8f9202528ee,0x21e0a8e5a05628fb,0x246ba8a3a36028c8,0x277fa73aa6a62801,0x2870a55fa81f2658,0x28f6a17ea8bf243d,0x2906165ba90e1cc2,0x28c420eba90197f2,0x277f2607a857a454,0x266b2703a809a51e,0x205628c8a46ba843,0x1df028dba425a84a,0xa3ee28e21d27a90f
.quad 0xa3bf28eb1a5aa90b,0xa85026922692a850,0xa810275d258aa8a8,0xa90c1c5d28dba481,0xa90921e02876a66b,0xa7d3a4c528d71bef,0xa893a088290fa025,0xa14da87c267f2630,0xa59fa6de286a217e,0x2301a9061cc228bf,0x97f2a8d4255f26f1,0x282ea7a1a48128f4,0x24c5a8f118c428c8,0x290fa11ca85d274b,0x2857a77fa4542901,0x281022d1a90e20eb
.quad 0xa728a72827282728,0xa728a72827282728,0x9b25a9081d272901,0x8e5ca90f17f2290c,0x25c9a843a51e2876,0x2703a790a66b2809,0x28e2a271a8b12454,0x290f9b25a9012025,0x28982301a8df9fe6,0x276e2644a835a4f2,0x24542857a607a77f,0x17f22901a0eba8c4,0xa11c2903125ca909,0xa6b9282724c5a8b6,0xa81f26f12658a857,0xa90c202528c4a4af
.quad 0xa90b1a5a28eba3bf,0xa7b2a54a28ad20b9,0xa73aa5b4289e20eb,0x9b25a8e22454281f,0x9befa8d724c527d3,0x266ba876a1e02909,0x25b4a8b19eb9290e,0x2908a271a85726f1,0x28dfa4f2a76e2835,0x27f2243da8f6165b,0x289e1eb9a90a22d1,0x1d2728b1a607a658,0x246b2790a843a1e0,0xa61c28b61befa8fb,0xa0eb290ea2d1a810,0xa9012454277fa857
.quad 0xa728a72827282728,0xa728a72827282728,0x198fa90e94c5290f,0x1df0a9059c5d290a,0x2809a66ba7902703,0x2876a51ea84325c9,0x28f41df0a90a94c5,0x28932390a8cca14d,0x24f22835a644a76e,0x1fe628dfa301a898,0xa2d128e81df0a90e,0xa6cc28102534a893,0xa8b624c52827a6b9,0xa909125c2903a11c,0xa87ca2d128f4198f,0xa534a7e3275d25de
.quad 0xa0b9a8ad254a27b2,0x23bfa8eb9a5a290b,0x25dea893a14d290a,0x28e8a425a82e2716,0x2909a1e0a876266b,0x27d324c5a8d79bef,0x275d2534a8cc9c5d,0x97f228fda390a82e,0x965b28f6a43da7f2,0xa835276e24f2a8df,0xa7e328102390a905,0xa8c49b2528fda425,0xa8fb1bef28b6a61c,0xa1e0a8432790246b,0xa534a6cc28931df0,0x2607a8c497f228e8
.quad 0xa728a72827282728,0xa728a72827282728,0x2088a8f49f8228fd,0x2211a8dba14d28e8,0x28c8a360a8a3246b,0x28fba056a8e521e0,0x27e325dea84aa4dc,0x263027a1a716a6cc,0x9cc2290e965ba906,0xa43d28bf217ea8f6,0xa89325342810a6cc,0xa90e1df028e8a2d1,0xa843a46b28c82056,0xa51ea8092703266b,0xe5ca905214d28a8,0x255fa89ea1af2901
.quad 0x2850a692a6922850,0x290b9a5aa8eb23bf,0x288821afa908198f,0x23ee283ca6f1a607,0x1bef28d7a4c5a7d3,0xa66b287621e0a909,0xa80127c224afa8e2,0xa8f40e5c28eea454,0xa8bf9cc22906a301,0xa17ea86a26de259f,0xa025a88826a625b4,0x275da84aa211290e,0x274ba85da11c290f,0x28c818c4a8f124c5,0x28e897f2a8c42607,0x1df02893a6cca534
.quad 0xa728a72827282728,0xa728a72827282728,0x2390a8bba2d128cc,0x2481a893a42528a8,0x290f98c4a9091d8c,0x29031befa90d925c,0x2425287ca534a82e,0x1f8228e8a211a8bb,0xa6de27f2259fa86a,0xa86a259f27f2a6de,0xa8c4a0eb290117f2,0xa77fa60728572454,0x98c4a8fb21e028a3,0x240ea8d79f1e290d,0x2888a5b4a77f27c2,0x290a97f2a8f92271
.quad 0x27b2254aa8ada0b9,0x20b928ada54aa7b2,0xa211290597f2a8ee,0xa84a26cc2630a87c,0xa90921e02876a66b,0xa7d3a4c528d71bef,0xa4dca7a128102425,0x2331a901198f28db,0x2644a8989fe6290e,0x290e9fe6a8982644,0x28e20e5ca8e824dc,0x21af2857a73aa508,0x1d8c28a3a66ba5c9,0xa82727d3240ea903,0xa857277f2454a901,0xa810a2d1290ea0eb
.quad 0xa728a72827282728,0xa728a72827282728,0x2534a864a4dc287c,0x25dea82ea58a284a,0x28d7211ca8f19f1e,0x288d240ea8b6a2a1,0x97f2290f998fa905,0xa1af28ee1eb9a908,0xa8f6217e28bfa43d,0xa906965b290e9cc2,0xa454a8572607277f,0x97f2a90120eb28c4,0x27d3a74ba61c285d,0x28f1a2a1a88d2575,0x281024dca8bba088,0x23902864a630a716
.quad 0xa3bf28eb1a5aa90b,0xa85026922692a850,0xa90114c528f4a390,0xa6a6a65828702271,0x9befa8d724c527d3,0x266ba876a1e02909,0x28c4a55fa73a283c,0x28642211a90a1d27,0x259f26dea86aa17e,0xa30129069cc2a8bf,0xa6cc287c2088a90f,0xa8f9198f28cca58a,0xa876a056290da2a1,0x125ca8e5251e2703,0x20eba90e22d12810,0x2901a454a77f2857
.quad 0xa728a72827282728,0xa728a72827282728,0x267fa7e3a6302810,0x2716a75da6cc27a1,0x28272575a85da4c5,0x274b26b9a7d3a61c,0xa508288823eea8c4,0xa6f127c22607a83c,0xa898a30128df1fe6,0xa76ea644283524f2,0x22d1a8e89df0290e,0x26cca810a5342893,0x28e51d8ca90f1bef,0x279025c9a876a360,0x9eb9290f9c5da8e8,0xa6a6283c2454a8d4
.quad 0xa90b1a5a28eba3bf,0xa7b2a54a28ad20b9,0x8e5ca8f923312857,0x267fa864a2d128fd,0x2909a1e0a876266b,0x27d324c5a8d79bef,0x1f8228a8a5dea6cc,0xa658288820eba90f,0xa8df24f2276ea835,0xa7f2a43d28f6965b,0xa331a81f27c22454,0x2630a8a89df02908,0x288da6b9a57528d7,0x28092360a9091f1e,0x253426cca8939df0,0xa60728c417f2a8e8
.quad 0xa728a72827282728,0xa728a72827282728,0x27a1a6cca75d2716,0x2810a630a7e3267f,0x261c27d3a6b9a74b,0x24c5285da575a827,0xa83c260727c2a6f1,0xa8c423ee2888a508,0xa4f2a8352644276e,0x9fe6a8df23012898,0x2893a534a81026cc,0x290e9df0a8e822d1,0x23602876a5c9a790,0x9bef290f9d8ca8e5,0xa8d42454283ca6a6,0xa8e89c5d290f9eb9
.quad 0xa0b9a8ad254a27b2,0x23bfa8eb9a5a290b,0x28fda2d1a864267f,0x28572331a8f98e5c,0x1bef28d7a4c5a7d3,0xa66b287621e0a909,0xa90f20eb2888a658,0xa6cca5de28a81f82,0x165ba8f6243d27f2,0x2835a76ea4f228df,0x29089df0a8a82630,0x245427c2a81fa331,0x9f1e2909a360a809,0xa8d7257526b9a88d,0xa8e817f228c4a607,0x9df0a89326cc2534
.quad 0xa728a72827282728,0xa728a72827282728,0x284aa58aa82e25de,0x287ca4dca8642534,0x22a128b6a40ea88d,0x1f1e28f1a11ca8d7,0xa9081eb928eea1af,0xa905998f290f97f2,0x1cc2a90e165b2906,0x243da8bfa17e28f6,0x28c420eba90197f2,0x277f2607a857a454,0xa575288d22a1a8f1,0xa85d261c274ba7d3,0xa716a63028642390,0xa088a8bb24dc2810
.quad 0x2850a692a6922850,0x290b9a5aa8eb23bf,0x22712870a658a6a6,0xa39028f414c5a901,0xa90921e02876a66b,0xa7d3a4c528d71bef,0x1d27a90a22112864,0x283ca73aa55f28c4,0x28bf1cc2a9062301,0x217e286aa6dea59f,0xa58a28cc198fa8f9,0xa90f2088287ca6cc,0xa703a51e28e5925c,0x22a1a90d20562876,0x2857a77fa4542901,0x281022d1a90e20eb
.quad 0xa728a72827282728,0xa728a72827282728,0x28a8a425a8932481,0x28cca2d1a8bb2390,0x125c290d9befa903,0x9d8c290918c4a90f,0xa8bba21128e81f82,0xa82ea534287c2425,0x26dea7f2a59f286a,0x286aa59fa7f226de,0x24542857a607a77f,0x17f22901a0eba8c4,0xa90d1f1e28d7a40e,0xa8a3a1e028fb18c4,0x2271a8f997f2290a,0x27c2a77fa5b42888
.quad 0x27b2254aa8ada0b9,0x20b928ada54aa7b2,0xa87c263026cca84a,0xa8ee97f22905a211,0x9befa8d724c527d3,0x266ba876a1e02909,0x28db198fa9012331,0x24252810a7a1a4dc,0xa64428981fe6a90e,0xa90e1fe62898a644,0xa508a73a285721af,0x24dca8e80e5c28e2,0x2903a40ea7d32827,0x25c9266ba8a39d8c,0xa0eb290ea2d1a810,0xa9012454277fa857
.quad 0xa728a72827282728,0xa728a72827282728,0x28e8a14da8db2211,0x28fd9f82a8f42088,0xa1e028e52056a8fb,0xa46b28a32360a8c8,0xa6cca71627a12630,0xa4dca84a25de27e3,0x28f6a17ea8bf243d,0x2906165ba90e1cc2,0xa2d128e81df0a90e,0xa6cc28102534a893,0xa66ba7032809251e,0xa056a8c8246b2843,0x2901a1afa89e255f,0x28a8214da9050e5c
.quad 0xa3bf28eb1a5aa90b,0xa85026922692a850,0xa607a6f1283c23ee,0x198fa90821af2888,0x2909a1e0a876266b,0x27d324c5a8d79bef,0xa45428ee0e5ca8f4,0xa8e224af27c2a801,0xa59fa6de286a217e,0x2301a9061cc228bf,0x290ea211a84a275d,0x25b426a6a888a025,0xa4c528f198c4a8c8,0xa90f211c285da74b,0xa534a6cc28931df0,0x2607a8c497f228e8
.quad 0xa728a72827282728,0xa728a72827282728,0x290a9c5da9051df0,0x290f94c5a90e198f,0xa5c92843251ea876,0xa7032790266ba809,0xa14da8cc23902893,0x94c5a90a1df028f4,0x28982301a8df9fe6,0x276e2644a835a4f2,0xa89325342810a6cc,0xa90e1df028e8a2d1,0x211ca903925c2909,0x26b9a827a4c528b6,0x25de275da7e3a534,0x198f28f4a2d1a87c
.quad 0xa90b1a5a28eba3bf,0xa7b2a54a28ad20b9,0x2716a82ea42528e8,0x290aa14da89325de,0x1bef28d7a4c5a7d3,0xa66b287621e0a909,0xa82ea39028fd97f2,0x9c5da8cc2534275d,0x28dfa4f2a76e2835,0x27f2243da8f6165b,0xa42528fd9b25a8c4,0xa90523902810a7e3,0xa46ba790284321e0,0x261ca8b69bef28fb,0x28e897f2a8c42607,0x1df02893a6cca534
.quad 0xa728a72827282728,0xa728a72827282728,0x290c17f2a90f8e5c,0x29011d27a9089b25,0xa809266b2790a703,0xa876251e2843a5c9,0x2025a9019b25290f,0x2454a8b1a27128e2,0x24f22835a644a76e,0x1fe628dfa301a898,0xa8c4a0eb290117f2,0xa77fa60728572454,0x28b6a4c5a82726b9,0x2909925ca903211c,0xa4af28c42025a90c,0xa857265826f1a81f
.quad 0xa0b9a8ad254a27b2,0x23bfa8eb9a5a290b,0x281f2454a8e29b25,0x20eb289ea5b4a73a,0xa90921e02876a66b,0xa7d3a4c528d71bef,0x26f1a857a2712908,0x290e9eb9a8b125b4,0x965b28f6a43da7f2,0xa835276e24f2a8df,0xa658a60728b11d27,0x22d1a90a1eb9289e,0x28fb9befa8b6261c,0x21e02843a790a46b,0xa857277f2454a901,0xa810a2d1290ea0eb
.quad 0xa728a72827282728,0xa728a72827282728,0x28ee2025a8f99eb9,0x28d421afa8e2a0eb,0xa8c8236028a3a46b,0xa8fb205628e5a1e0,0x2658a81fa55f2870,0x2801a6a6a73a277f,0x9cc2290e965ba906,0xa43d28bf217ea8f6,0xa454a8572607277f,0x97f2a90120eb28c4,0x2843246ba8c8a056,0x251e2809a703a66b,0xa90f1d2728e2a3ee,0xa84aa42528db1df0
.quad 0x2850a692a6922850,0x290b9a5aa8eb23bf,0xa48128db1c5da90c,0xa8a8258a275da810,0x9befa8d724c527d3,0x266ba876a1e02909,0x2630267fa87ca14d,0xa025290fa088a893,0xa8bf9cc22906a301,0xa17ea86a26de259f,0x28f4a481a7a1282e,0x26f1255fa8d497f2,0xa74b285d211ca90f,0xa8c898c428f1a4c5,0x20eba90e22d12810,0x2901a454a77f2857
.quad 0xa728a72827282728,0xa728a72827282728,0x28b12331a8c4a271,0x28882454a89ea3ee,0xa90f18c429099d8c,0xa9039bef290d125c,0x289ea4afa85725b4,0x28f9a0eba8d42331,0xa6de27f2259fa86a,0xa86a259f27f2a6de,0x22d1a8e89df0290e,0x26cca810a5342893,0x18c428fba1e0a8a3,0xa40e28d71f1ea90d,0xa481a82e26cc267f,0x1b25a90e1f8228cc
.quad 0x27b2254aa8ada0b9,0x20b928ada54aa7b2,0xa8d49d27290ea088,0xa55fa77f280124af,0x2909a1e0a876266b,0x27d324c5a8d79bef,0xa87026a62607a89e,0xa8bb9df0290ca1af,0x2644a8989fe6290e,0x290e9fe6a8982644,0xa14d290fa0eba870,0xa8db25342716a864,0x9d8ca8a3266b25c9,0x2827a7d3a40e2903,0x253426cca8939df0,0xa60728c417f2a8e8
.quad 0xa728a72827282728,0xa728a72827282728,0x28572508a870a4af,0x281f25b4a83ca55f,0xa8d7a11c28f11f1e,0xa88da40e28b622a1,0x290e8e5ca90c1d27,0x28db2088a8fd9c5d,0xa8f6217e28bfa43d,0xa906965b290e9cc2,0x2893a534a81026cc,0x290e9df0a8e822d1,0xa7d3274b261ca85d,0xa8f122a1288da575,0x2607a870a33128ee,0x28b1a508a801273a
.quad 0xa3bf28eb1a5aa90b,0xa85026922692a850,0x1df0a90f202528b1,0x27a1a7e3a4dc28cc,0x1bef28d7a4c5a7d3,0xa66b287621e0a909,0xa2d1a84a2716258a,0x2508a8d49b252905,0x259f26dea86aa17e,0xa30129069cc2a8bf,0xa77fa4af28ee94c5,0x1f82a90c2271283c,0x28762056a90d22a1,0x925c28e5a51ea703,0xa8e817f228c4a607,0x9df0a89326cc2534
.quad 0xa728a72827282728,0xa728a72827282728,0x27c22658a801a607,0x273a26f1a77fa6a6,0xa827a575285d24c5,0xa74ba6b927d3261c,0x28642481a8a8a2d1,0x275d267fa810a58a,0xa898a30128df1fe6,0xa76ea644283524f2,0x28c420eba90197f2,0x277f2607a857a454,0xa8e59d8c290f9bef,0xa790a5c928762360,0x28fd14c5a90820eb,0x27a1258aa893a211
.quad 0xa90b1a5a28eba3bf,0xa7b2a54a28ad20b9,0x290f9f82a8bb2534,0x27c22508a8c49eb9,0xa90921e02876a66b,0xa7d3a4c528d71bef,0x28f9a3eea81f277f,0x27e32481a8e894c5,0xa8df24f2276ea835,0xa7f2a43d28f6965b,0x28bba5dea67f2893,0x280123eea9011c5d,0xa88d26b92575a8d7,0xa809a36029099f1e,0x2857a77fa4542901,0x281022d1a90e20eb
.quad 0x2818a818a241290f,0x28182241a90f2241,0x2843a7f2a2a1290f,0x274b243da90920b9,0x286aa7b2a301290f,0x2644254aa8f61e55,0x288da76ea360290f,0x251e2644a8d71a5a,0x28ada728a3bf290f,0x23bf2728a8ad0000,0x28c8a6dea40e290f,0x211c27f2a8769a5a,0x28dfa692a43d290f,0x1cc22850a8359e55,0x28f1a644a46b290f,0x925c2898a7d3a0b9
.quad 0x28ffa5f3a498290f,0x9e5528d0a728a241,0x2909a59fa4c5290f,0xa1e028f6a66ba3bf,0x290ea54aa4f2290f,0xa43d290ba59fa498,0x290fa4f2a51e290f,0xa575290ea4c5a54a,0x290ba498a54a290f,0xa69228ffa3bfa5f3,0x2903a43da575290f,0xa79028dfa1e0a692,0x28f6a3bfa59f290f,0xa83528ad9fe6a728,0x28e5a301a5c9290f,0xa88d286a9befa7b2
.quad 0xa241290fa241a818,0xa90f22412818a818,0xa51e28f69d8ca882,0xa8d7165b28b6a692,0xa6de28ad165ba8d0,0xa835a0b92906a498,0xa82728352056a8ff,0xa66ba4f22903a0b9,0xa8ad272823bfa90f,0xa3bfa72828ad8000,0xa8fb259f2575a8ff,0x9befa86a280920b9,0xa90e23bf26dea8d0,0x1fe6a8eb26442498,0xa8e51fe62809a882,0x24c5a90e240e2692
.quad 0xa88200002882a818,0x2728a8d01e552818,0xa7d39fe628d7a728,0x2876a8359bef28ad,0xa644a3bf2906a5f3,0x28f6a692a30128ff,0xa46ba59f290da498,0x2909a43da5c9290b,0xa0b9a72828eba241,0x28ad9e55a7b228d0,0x925ca83528a39e55,0x27d31cc2a88d2850,0x1fe6a8ad28358000,0x259f23bfa8f62728,0x240ea8f6274b1e55,0x21e02644a90d254a
.quad 0xa241a81828182241,0x2818a818a241290f,0x18c4a8df25c925f3,0x28fba4f2a6b928ad,0x243da90b217e2818,0x28df9a5aa8982728,0x274ba89898c428d0,0x27902301a90f23bf,0x28ada728a3bf290f,0x23bf2728a8ad0000,0x290fa43da6b928d0,0x98c428bfa703a3bf,0x28bf9a5aa86a2818,0xa4f2290ba301a728,0x2790217ea8fb25f3,0xa827286a18c4a8ad
.quad 0x249825f3a8ff2241,0xa8ff25f32498a90f,0x1bef2835a8760000,0xa8d71fe627d3a8ad,0xa17e28eba6dea241,0xa76ea0b928dfa728,0xa61c2906a40ea5f3,0xa360a6442903a3bf,0xa85028829a5aa818,0x1a5aa88228508000,0xa8fb26de211ca8d0,0x251ea90e25c923bf,0xa8f623bf259fa90f,0x2835a8ad1fe62728,0xa843165b2809a8d0,0x2903a6dea05628ad
.quad 0x28182241a90f2241,0xa241290fa241a818,0x240e276ea8769e55,0xa8092835211ca90b,0x9cc228eba59fa5f3,0xa90e23bf276ea882,0xa61c28df9befa882,0xa8439fe628fba54a,0xa8ad272823bfa90f,0xa3bfa72828ad8000,0xa903217e27d3a882,0x2056a8f625c9254a,0xa7f2a0b928f6a5f3,0x276ea8ad165b2882,0xa360a6de28d79e55,0x2903a59fa51e290b
.quad 0x1e55a8d027282241,0x28828000a8822818,0x266ba8f621e02728,0x24c5259fa90923bf,0x28bfa7b29fe628d0,0x9cc228ada7f29e55,0x28fba301a66b28ff,0xa6b928f6a2a1a692,0x27b21e55a8ad2818,0xa8eb272820b9a8d0,0x22a12644a9092498,0xa8b61fe6274ba8eb,0x9fe628ada8350000,0xa59fa3bf28f6a728,0xa6b92906a4c5a498,0x125ca83528b6a0b9
.quad 0xa90f22412818a818,0xa241a81828182241,0xa7d3a301290fa241,0x246ba90620562850,0x9fe6a85027f22241,0x28bfa692a4f228ff,0x24c5a906211c2818,0x28a3165ba8c82692,0x28ada728a3bf290f,0x23bf2728a8ad0000,0x28d79cc2a85d2818,0xa360290ea46ba692,0x259f254aa9062241,0xa89827b2217ea8ff,0x9bef28bfa74ba241,0xa8c81cc22843a850
.quad 0xa72828d09e55a818,0xa498a5f328ffa241,0xa909259f24c5a90f,0x21e0a8f6266b23bf,0xa8359a5a2898a818,0x286aa850965b2882,0xa1e0a6de28f1a241,0x28e5a17ea70328eb,0x23bfa8ff26922241,0x254a2498a90b25f3,0x2876a86a18c42818,0xa05628bfa8099a5a,0x28f6a3bfa59f290f,0xa83528ad9fe6a728,0x266b217ea8c82818,0xa8fb243d251ea90b
.quad 0x2818a818a241290f,0x28182241a90f2241,0x28f19cc2a88d2728,0x125c28bfa66ba54a,0x24f22692a8bf0000,0xa7f228501fe6a8ff,0xa2a1290ea40ea728,0xa8e51cc22876a7b2,0xa8ad272823bfa90f,0xa3bfa72828ad8000,0xa88d965b28b6a728,0x251ea90621e027b2,0xa17ea7b228988000,0x2906a54aa59f28ff,0x2575a90622a12728,0x27032301a909254a
.quad 0x28ffa5f3a498290f,0x9e5528d0a728a241,0x27d31fe6a8d72728,0xa87628351befa8ad,0x165b2850a86a0000,0xa8981a5a2835a882,0xa74b28dfa11ca728,0xa056a76e28d7a0b9,0xa90b2498254aa90f,0x2692a8ff23bf25f3,0xa61ca30128f1a728,0x290da4f2a4c5290b,0x1fe6a8ad28358000,0x259f23bfa8f62728,0x285da8981f1e2728,0xa2a128dfa7d39a5a
.quad 0xa241290fa241a818,0xa90f22412818a818,0xa8e5259f261ca8d0,0xa4c5a6de28a31a5a,0xa76ea3bf290ea241,0x259fa8eb1cc22882,0x1f1ea8f6257525f3,0x2909a17ea8092850,0x28ada728a3bf290f,0x23bf2728a8ad0000,0x28271fe6a8f125f3,0xa66b28df9d8ca850,0x965b28ada76ea241,0xa8f620b927f2a882,0xa85d28351d8ca8d0,0xa1e0a76e28b69a5a
.quad 0xa88200002882a818,0x2728a8d01e552818,0x9befa83528768000,0x28d79fe6a7d328ad,0x27f2a8ad1cc22818,0x1fe627b2a8bf1e55,0x28c89fe6a79028d0,0xa7d328bf9f1ea7b2,0x20b92728a8eb2241,0xa8ad1e5527b2a8d0,0xa70328f6a360a5f3,0x9befa7f228c8a0b9,0xa8f623bf259fa90f,0x2835a8ad1fe62728,0xa360a59f290fa5f3,0x28769cc2a79028eb
.quad 0xa241a81828182241,0x2818a818a241290f,0x2790a86a9f1e28ff,0x2827217ea90d23bf,0x28981a5aa8df25f3,0xa17e290ba43da728,0x925c28bfa6b9a498,0xa90d243d2703a8ad,0xa8ad272823bfa90f,0xa3bfa72828ad8000,0xa74ba301290da498,0x2790a898925c28ad,0x2301a90b24f225f3,0x286a1a5aa8bf2728,0x290da4f2a5c928ff,0x9f1e28dfa6b9a3bf
.quad 0x249825f3a8ff2241,0xa8ff25f32498a90f,0xa66b28f6a1e0a728,0xa4c5a59f2909a3bf,0xa8df20b9276ea8d0,0x26dea8eb217e2728,0x9d8ca7f228b69e55,0x28a39cc2a80928ad,0x2850a8821a5a2818,0x9a5a2882a8500000,0x2827165ba85d2882,0xa8e5276e1f1ea8ad,0x9fe628ada8350000,0xa59fa3bf28f6a728,0xa8f1276e1d8ca882,0x261ca90e257523bf
.quad 0x28182241a90f2241,0xa241290fa241a818,0xa360290ea1e0a818,0xa9031fe6285da7b2,0xa90620b92835a818,0x965ba8ad26de2498,0x9d8ca86a27d32241,0x28f1a59fa5c928eb,0x28ada728a3bf290f,0x23bf2728a8ad0000,0x261c24f2a9092241,0xa84328351f1ea8eb,0xa64428eb9fe6a818,0xa6dea3bf290ea498,0xa8a3165b2876a818,0x261ca8f6211c27b2
.quad 0x1e55a8d027282241,0x28828000a8822818,0x2909a59fa4c5290f,0xa1e028f6a66ba3bf,0x23012692a8f62241,0xa90623bf2644a8ff,0xa82728989befa818,0x98c4a835288d9a5a,0xa7b29e5528ada818,0x28eba728a0b928d0,0x246ba906266b2241,0x240e259fa90f254a,0x28f6a3bfa59f290f,0xa83528ad9fe6a728,0x18c427f2a8d72241,0xa7039fe628a3a850
.quad 0xa90f22412818a818,0xa241a81828182241,0x9befa89827032498,0x28c8a644a57528eb,0x28f6a54aa64428d0,0x230127b2a86a9e55,0x21e027f2a85d9e55,0xa8b626de246ba90b,0xa8ad272823bfa90f,0xa3bfa72828ad8000,0xa4c5a64428e59e55,0x28a3a76ea2a1290b,0x2835a8509cc228d0,0x243d2692a8df1e55,0x266b243da90f2498,0xa88d27f22056a8eb
.quad 0xa72828d09e55a818,0xa498a5f328ffa241,0xa7d39fe628d7a728,0x2876a8359bef28ad,0x259fa90b243d25f3,0x24f2254aa90e2498,0x2876965ba8432882,0xa85d286a925ca850,0xa3bf28ffa692a241,0xa54aa498290ba5f3,0xa8d7217e26b9a8ff,0x2843a8981d8c27b2,0x1fe6a8ad28358000,0x259f23bfa8f62728,0x2909a4f2a46b28ff,0xa82728bfa11ca692
.quad 0x2818a818a241290f,0x28182241a90f2241,0x25752644a8c80000,0xa70328981befa8eb,0xa86a27b22301a90f,0xa644a54a28f69e55,0xa46ba6de28b68000,0x285da7f2a1e0290b,0x28ada728a3bf290f,0x23bf2728a8ad0000,0x22a1276ea8a30000,0xa8e5264424c5a90b,0xa8df2692243da90f,0x9cc2a85028351e55,0xa056a7f2288d8000,0x290fa43da66b28eb
.quad 0x28ffa5f3a498290f,0x9e5528d0a728a241,0x1bef2835a8760000,0xa8d71fe627d3a8ad,0xa90e254a24f2a90f,0x243da90b259f2498,0x125ca86a285d8000,0x2843165ba8762850,0x290ba498a54a290f,0xa69228ffa3bfa5f3,0x9d8c2898a8430000,0xa6b9a17e28d7a7b2,0xa8f623bf259fa90f,0x2835a8ad1fe62728,0x211ca8bf28278000,0x246b24f2a9092692
.quad 0xa241290fa241a818,0xa90f22412818a818,0xa85d9fe62903a498,0x21e0a90e236027b2,0x26dea8ad965b28d0,0x283520b9a9062498,0x25c9259fa8f11e55,0xa7d3286a1d8ca8eb,0xa8ad272823bfa90f,0xa3bfa72828ad8000,0x9f1ea83528431e55,0x2909a4f2a61c28eb,0x290ea3bfa6de28d0,0x9fe628eba644a498,0xa11c28f6a61ca498,0xa876965b28a3a7b2
.quad 0xa88200002882a818,0x2728a8d01e552818,0x266ba8f621e02728,0x24c5259fa90923bf,0x264423bfa90625f3,0xa8f626922301a8ff,0xa88d283518c4a882,0x1befa89828271a5a,0xa0b9a72828eba241,0x28ad9e55a7b228d0,0x290fa59fa40e28ff,0xa66b2906a46ba54a,0x9fe628ada8350000,0xa59fa3bf28f6a728,0xa8a31fe62703a8ff,0x28d7a7f298c42850
.quad 0xa241a81828182241,0x2818a818a241290f,0x290da17ea8272818,0x1f1e286aa790a3bf,0xa43d290ba17ea818,0xa8df1a5a2898a728,0xa703a43d290da241,0x26b9a8bf125c28ad,0x28ada728a3bf290f,0x23bf2728a8ad0000,0x125c2898a790a241,0xa90d2301274ba8ad,0xa8bf1a5a286aa818,0x24f2a90b23012728,0x26b9a8df1f1e2818,0x25c924f2a90d23bf
.quad 0x249825f3a8ff2241,0xa8ff25f32498a90f,0xa909259f24c5a90f,0x21e0a8f6266b23bf,0x217ea8eb26de2241,0x276e20b9a8df2728,0x28091cc2a8a32818,0xa8b627f21d8ca8ad,0xa85028829a5aa818,0x1a5aa88228508000,0x9f1ea76e28e5a241,0x285d965ba82728ad,0x28f6a3bfa59f290f,0xa83528ad9fe6a728,0xa575290ea61ca241,0x9d8ca76e28f1a3bf
.quad 0x28182241a90f2241,0xa241290fa241a818,0xa8a326de24c5a8ff,0xa61ca59f28e59a5a,0x1cc2a8eb259f25f3,0x290ea3bfa76e2882,0x2809217ea9092498,0xa57528f69f1ea850,0xa8ad272823bfa90f,0xa3bfa72828ad8000,0x1d8ca8df266b2498,0x28f19fe6a8272850,0x27f220b9a8f625f3,0xa76e28ad965ba882,0xa8b6276e21e0a8ff,0x9d8ca835285d1a5a
.quad 0x1e55a8d027282241,0x28828000a8822818,0x27d31fe6a8d72728,0xa87628351befa8ad,0xa8bf27b21fe6a8d0,0x1cc2a8ad27f21e55,0x1f1ea8bf27d31e55,0x27901fe6a8c827b2,0x27b21e55a8ad2818,0xa8eb272820b9a8d0,0xa8c827f21befa882,0x2360a8f6270320b9,0x1fe6a8ad28358000,0x259f23bfa8f62728,0x27901cc2a8762882,0xa90f259f2360a8eb
.quad 0xa90f22412818a818,0xa241a81828182241,0x266ba8bf925c28d0,0x288d1cc2a8f1254a,0x1fe62850a7f2a241,0xa8bf269224f2a8ff,0xa8769cc228e5a5f3,0x240ea90e22a127b2,0x28ada728a3bf290f,0x23bf2728a8ad0000,0xa1e02906a51ea5f3,0xa8b6165b288da7b2,0xa59fa54a2906a241,0x2898a7b2a17e28ff,0x2909a301a70328d0,0xa2a12906a575a54a
.quad 0xa72828d09e55a818,0xa498a5f328ffa241,0x9befa83528768000,0x28d79fe6a7d328ad,0x28351a5aa8982818,0xa86a2850165ba882,0xa8d7276e2056a8d0,0x211ca8df274b20b9,0x23bfa8ff26922241,0x254a2498a90b25f3,0x24c524f2a90d25f3,0xa8f12301261ca90b,0xa8f623bf259fa90f,0x2835a8ad1fe62728,0x27d3a8df22a125f3,0x9f1e2898a85d1a5a
.quad 0x2818a818a241290f,0x28182241a90f2241,0xa0562906a46ba728,0xa90f230127d3a850,0xa4f2a69228bf8000,0x27f2a8509fe628ff,0x28c8965ba8a32728,0xa11c2906a4c5a692,0xa8ad272823bfa90f,0xa3bfa72828ad8000,0x246ba90e23602728,0x285d1cc2a8d72692,0x217e27b2a8980000,0xa906254a259fa8ff,0xa8439cc228c8a728,0x274ba8bf1bef2850
.quad 0x28ffa5f3a498290f,0x9e5528d0a728a241,0xa66b28f6a1e0a728,0xa4c5a59f2909a3bf,0x965ba850286a8000,0x28989a5aa8352882,0x2703217ea8e52728,0xa8f126de21e0a8eb,0xa90b2498254aa90f,0x2692a8ff23bf25f3,0x2809a8bf20562728,0x98c4286aa8761a5a,0x9fe628ada8350000,0xa59fa3bf28f6a728,0xa51ea43d28fba728,0x28c8a17ea66b290b
.quad 0xa241290fa241a818,0xa90f22412818a818,0xa11ca83528092241,0x2876a76ea40e290b,0x276e23bfa90e2241,0xa59f28eb9cc2a882,0xa8fb1fe62843a818,0x1befa8df261c254a,0x28ada728a3bf290f,0x23bf2728a8ad0000,0xa5c928f6a056a818,0xa7d3a17e2903a54a,0x165ba8ad276e2241,0x28f6a0b9a7f22882,0x251e259fa9032241,0xa8d726de2360a90b
.quad 0xa88200002882a818,0x2728a8d01e552818,0x2909a59fa4c5290f,0xa1e028f6a66ba3bf,0xa7f228ad9cc2a818,0x9fe6a7b228bf9e55,0x22a1a8f626b92241,0x266b2301a8fb2692,0x20b92728a8eb2241,0xa8ad1e5527b2a8d0,0xa74b9fe628b6a818,0x2909a644a2a128eb,0x28f6a3bfa59f290f,0xa83528ad9fe6a728,0xa8b62835925ca818,0x24c5a90626b920b9
.quad 0xa241a81828182241,0x2818a818a241290f,0x26b924f2a8fb1e55,0xa5c928df98c4a8ad,0xa8989a5a28dfa5f3,0x217ea90b243d2728,0x290fa301a7902882,0x18c42898a74ba3bf,0xa8ad272823bfa90f,0xa3bfa72828ad8000,0x2703a8bf18c42882,0x26b9243da90f23bf,0xa301290ba4f2a5f3,0xa86a9a5a28bfa728,0x98c4a86a28271e55,0x28fba17ea79028ad
.quad 0x249825f3a8ff2241,0xa8ff25f32498a90f,0xa7d39fe628d7a728,0x2876a8359bef28ad,0x28dfa0b9a76e28d0,0xa6de28eba17ea728,0xa90326442360a8ff,0x240ea906261c23bf,0x2850a8821a5a2818,0x9a5a2882a8500000,0xa5c9290ea51ea498,0xa11ca6de28fba3bf,0x1fe6a8ad28358000,0x259f23bfa8f62728,0x205626dea9032498,0xa809965b2843a8ad
.quad 0x28182241a90f2241,0xa241290fa241a818,0xa8b6965b28d7a5f3,0x1d8ca8f6251e2692,0x2906a0b9a8352818,0x165b28ada6dea498,0xa90324f2266ba8d0,0xa056a835282720b9,0x28ada728a3bf290f,0x23bf2728a8ad0000,0xa809286a1befa8d0,0xa575a59f28fba0b9,0x2644a8eb1fe62818,0x26de23bfa90e2498,0xa40e290ea4c5a5f3,0xa8099fe628e5a692
.quad 0x1e55a8d027282241,0x28828000a8822818,0x1bef2835a8760000,0xa8d71fe627d3a8ad,0xa301a69228f6a241,0x2906a3bfa64428ff,0x25c9243da90925f3,0xa90d259f246ba90b,0xa7b29e5528ada818,0x28eba728a0b928d0,0x288d9cc2a7d328d0,0xa8a32835125ca850,0xa8f623bf259fa90f,0x2835a8ad1fe62728,0x290da644a1e028d0,0xa74b28f6a40ea54a
.quad 0xa90f22412818a818,0xa241a81828182241,0x2909a43da74b2882,0x22a127f2a843a0b9,0xa8f6254a2644a8d0,0xa301a7b2286a1e55,0x28d7a644a51e28ff,0x2360276ea88d9a5a,0xa8ad272823bfa90f,0xa3bfa72828ad8000,0x2876a7f2a11c28ff,0x240e26dea8c81a5a,0xa83528501cc2a8d0,0xa43da69228df9e55,0x27d3a898125c2882,0x246b2644a8f120b9
.quad 0xa72828d09e55a818,0xa498a5f328ffa241,0x266ba8f621e02728,0x24c5259fa90923bf,0xa59f290ba43da5f3,0xa4f2a54a290ea498,0x24c5a90e25752498,0x251e24f2a90f254a,0xa3bf28ffa692a241,0xa54aa498290ba5f3,0x21e0a8df27901e55,0x2575243da9032692,0x9fe628ada8350000,0xa59fa3bf28f6a728,0x1befa86a288d9e55,0x25c92301a8e527b2
.quad 0x290f,0x0,0xa90f,0x0,0x290f,0x0,0xa90f,0x0,0x290f,0x0,0xa90f,0x0,0x290f,0x0,0xa90f,0x0
.quad 0x290f,0x0,0xa90f,0x0,0x290f,0x0,0xa90f,0x0,0x290f,0x0,0xa90f,0x0,0x290f,0x0,0xa90f
.zero 776
.quad 0x28d08000a8d025f3,0x28d0a5f3a5f3,0x28b117f2a8db25de,0x9df028f9a508a6a6,0x288d1befa8e525c9,0xa1e0290da40ea74b,0x28641df0a8ee25b4,0xa454290ca211a7e3,0x28351fe6a8f6259f,0xa59f28f69fe6a835,0x280120eba8fd258a,0xa6cc28cc9b25a870,0x279021e0a9032575,0xa7d3288d125ca8a3,0x271622d1a908255f,0xa857283c1d27a8cc
.quad 0x269223bfa90b254a,0xa8ad27b220b9a8eb,0x26072454a90e2534,0xa8e826cc22d1a901,0x257524c5a90f251e,0xa90925c9246ba90d,0x24dc2534a90f2508,0xa90e24af255fa90f,0x243d259fa90e24f2,0xa8f623012644a906,0x23312607a90c24dc,0xa8c420882716a8f4,0x21e0266ba90924c5,0xa8761bef27d3a8d7,0x208826cca90524af,0xa81094c5283ca8b1
.quad 0xa8d025f325f3a8d0,0xa5f3a5f328d08000,0xa90a2425275da87c,0xa271a801283c20eb,0xa90320562843a809,0x925ca8b626b924c5,0xa8bb0e5c28b1a6f1,0x21afa90a248126cc,0xa8359fe628f6a59f,0x259fa8f61fe62835,0xa6f1a3ee290fa425,0x27e3a87c998f28c4,0xa51ea5c928fba11c,0x28b6a74ba2a12909,0xa211a75d28bb9b25,0x290ca508a5b42901
.quad 0x9a5aa85028501a5a,0x28eba0b9a7b228ad,0x1df0a8c4277f20eb,0x285717f2a8932810,0x2360a903261c240e,0x26b922a1a8fb266b,0x25b4a90c2481258a,0x242525dea90a2454,0x276ea8df217e26de,0x1cc227f2a8bf1fe6,0x2864a87c1b252801,0x9f8228b1a81f97f2,0x28d7a7d39bef2876,0xa4c52909a66ba1e0,0x290ca658a1af28cc,0xa73a28f9a425a534
.quad 0x25f3a8d0000028d0,0x28d08000a8d025f3,0x284aa7e3a2d1290f,0x273a2454a9082088,0x28fba51ea66b28c8,0x22a127d3a85d9f1e,0x28f49eb9a8572801,0x9d2728e8a5dea58a,0x28351fe6a8f6259f,0xa59f28f69fe6a835,0x25b4255fa901214d,0xa86428102088a8f9,0x20562809a87698c4,0xa90d24c5261ca8f1,0x9eb928dba6cca390,0xa8a817f22870a81f
.quad 0xa54a290ba3bfa692,0xa692a3bf290ba54a,0xa810289397f2a857,0xa0eba77f28c49df0,0xa8e5270321e0a8f1,0x2056a8d7274b211c,0xa90523ee2607a908,0x2658a90123902630,0xa86a165b2835a898,0x2898a835965b286a,0xa658a27128e8a75d,0x290fa534a4812908,0xa1e0a66b2909a4c5,0x28769befa7d328d7,0x1b25a86428939eb9,0x25de22d1a8e227c2
.quad 0x28d0a5f3a5f3,0xa8d025f325f3a8d0,0xa53428f49d27a888,0xa8d414c528bba67f,0xa87627902360a90f,0xa61ca57528f19d8c,0xa90e227127c2a870,0x94c5a8a827162425,0xa8359fe628f6a59f,0x259fa8f61fe62835,0xa454a6a628d49c5d,0x28bba716a390290f,0x1befa8c827032360,0x28e59f1ea827285d,0x2607a8f9214d27a1,0x267f2425a90f24af
.quad 0x28ada7b2a0b928eb,0x1a5a2850a8509a5a,0x2901a2d1a6cc28e8,0xa534290ea454a607,0x27d31f1ea8c82790,0xa8a328091d8ca8b6,0x22d1267fa8fd2331,0xa8f4227126a6a8f9,0x9fe628bfa7f29cc2,0xa6dea17e28dfa76e,0xa6cc28fda3eea5b4,0x9d27a7c228d4a14d,0xa8d727d31befa876,0x24c5a909266b21e0,0xa8e8233125b4a90f,0x2888a8701c5d27a1
.quad 0xa5f3a5f328d08000,0x25f3a8d0000028d0,0x198fa8e225b42607,0x28fda4dca6cc28a8,0x2703a8a398c428d7,0x2827211ca909246b,0x2908a4afa6a628c4,0x1f82284aa810a14d,0x28351fe6a8f6259f,0xa59f28f69fe6a835,0x21af27c2a88897f2,0xa8f425de2534a905,0xa40e290fa46ba66b,0xa8439d8c28d7a6b9,0xa88828012025a8e8,0xa088a7e328938e5c
.quad 0xa8eb20b927b2a8ad,0x254aa90b23bf2692,0xa607a454290ea534,0x28e8a6cca2d12901,0x18c4a88d28271bef,0x285d125ca8762843,0x26f1a8ee221126cc,0x214d2716a8e821af,0x2906a644a30128f6,0xa4f2290ea59fa43d,0x283c0e5ca84a2893,0xa8db27a11df0a89e,0x21e0266ba90924c5,0xa8761bef27d3a8d7,0xa3ee28f4a75d9df0,0xa211a630290ea55f
.quad 0x28d08000a8d025f3,0x28d0a5f3a5f3,0x23ee277fa8709eb9,0xa810282e214da90c,0xa46b2909a11ca827,0xa8d718c428a3a703,0xa8e22607255fa8f9,0xa2d1a7a1287c1c5d,0xa8359fe628f6a59f,0x259fa8f61fe62835,0x9d27a857281f2025,0x290ea481a67f28db,0x26b9a8d71d8c2843,0x266b246ba90f240e,0x290fa454a65828ee,0xa0eb28f4a630a481
.quad 0x269223bfa90b254a,0xa8ad27b220b9a8eb,0x9df028c4a77fa0eb,0xa85797f22893a810,0xa8432876925ca85d,0x9befa827288d98c4,0xa8db20eb273aa8e2,0x277fa8d42088275d,0xa43da59f290ea4f2,0x28f6a301a6442906,0x2425a90126a621af,0x2454255fa90f258a,0x28d7a7d39bef2876,0xa4c52909a66ba1e0,0x284a97f2a80128d4,0xa90126f12025a8a8
.quad 0xa8d025f325f3a8d0,0xa5f3a5f328d08000,0xa7c2a331290fa211,0x2481a90520252857,0x1d8ca8f12575261c,0x290fa360a7902876,0x289ea73aa3ee290f,0x24dc267fa8cc17f2,0x28351fe6a8f6259f,0xa59f28f69fe6a835,0x94c528b1a73aa331,0xa908221127a1a893,0xa85d28271f1ea8e5,0xa360a70328c89bef,0xa87c94c5289ea7c2,0x26a6a8e21f822810
.quad 0x9a5aa85028501a5a,0x28eba0b9a7b228ad,0x2810a89317f22857,0x20eb277fa8c41df0,0x28b69d8ca80928a3,0xa79028c89f1ea7d3,0x1f8227a1a8cc2025,0xa8bb1eb927c2a8c4,0xa76e28dfa17ea6de,0x9cc2a7f228bf9fe6,0xa8e22211267fa905,0x282ea8a81eb9277f,0xa1e0a66b2909a4c5,0x28769befa7d328d7,0x26a6a90824dc2481,0x8e5c282ea8bb20eb
.quad 0x25f3a8d0000028d0,0x28d08000a8d025f3,0x28ee9c5da8932716,0xe5c28c4a658a55f,0x1f1e285da7d3a2a1,0xa8c8266b251ea8fb,0xa83c281f20eba905,0xa630a53428fda025,0xa8359fe628f6a59f,0x259fa8f61fe62835,0x1f82a8ee26072508,0x28e29df0a84a282e,0x28f1a61ca4c5290d,0x18c42876a809a056,0x25de24dca90e23ee,0xa8b1277f21afa8fd
.quad 0xa54a290ba3bfa692,0xa692a3bf290ba54a,0xa90122d126cca8e8,0x2534a90e24542607,0xa11ca74b28d7a056,0x28f1a1e0a70328e5,0x2801a8b11df027e3,0x1c5d2810a8a81d27,0x286a965ba8352898,0xa8982835165ba86a,0x9c5d2888a85714c5,0xa6f1a0eb28cca7e3,0xa8d727d31befa876,0x24c5a909266b21e0,0xa67fa14d28c4a81f,0x28fda454a508290a
.quad 0x28d0a5f3a5f3,0xa8d025f325f3a8d0,0xa8e8258a2630a8cc,0xa4afa6f1289e1b25,0xa4c5a6b928b6125c,0x2809a843a0562903,0x277fa8889b2528db,0x275d2390a90f2331,0x28351fe6a8f6259f,0xa59f28f69fe6a835,0xa2d1290ca4afa658,0xa89e8e5c28a8a75d,0xa90922a1274ba8b6,0x211ca8fb25c9251e,0x9df0a82e2864198f,0x290aa331a6f128d4
.quad 0x28ada7b2a0b928eb,0x1a5a2850a8509a5a,0x26072454a90e2534,0xa8e826cc22d1a901,0xa66b28fba2a1a6b9,0xa40ea61c2903a360,0xa8931b25281fa89e,0x283ca888198f282e,0x1fe6a8bf27f21cc2,0x26de217ea8df276e,0x290ea5dea39028f9,0xa630290aa4afa508,0x21e0266ba90924c5,0xa8761bef27d3a8d7,0xa857289e9f82a716,0x2271a8db27e3198f
.quad 0xa5f3a5f328d08000,0x25f3a8d0000028d0,0x27a1a8649f822901,0x281f21afa90e2390,0x274b240ea90d21e0,0xa5c928e59befa88d,0xa65828d4998fa893,0xa82ea0882901a508,0xa8359fe628f6a59f,0x259fa8f61fe62835,0x24dca90a2271277f,0x283c1eb9a8e82630,0x28a3925ca88d27d3,0xa5752903a1e0a790,0xa2712905a58aa534,0xa84a9c5d28c4a73a
.quad 0xa8eb20b927b2a8ad,0x254aa90b23bf2692,0x1df0a8c4277f20eb,0x285717f2a8932810,0x290da46ba5c92909,0xa51e290fa4c5a575,0x14c5284aa87c17f2,0xa8640e5c2857a870,0xa90626442301a8f6,0x24f2a90e259f243d,0xa025a73a28eea2d1,0x2870998fa81028bb,0x28d7a7d39bef2876,0xa4c52909a66ba1e0,0x2390258aa90f2607,0xa87c1d27277fa8ee
.quad 0x28d08000a8d025f3,0x28d0a5f3a5f3,0xa390290ea1afa81f,0xa9011f822864a7a1,0xa88d9bef28e5a5c9,0x21e0a90d240e274b,0x2508a9012088282e,0x2893198fa8d42658,0x28351fe6a8f6259f,0xa59f28f69fe6a835,0xa63028e89eb9a83c,0xa77fa271290aa4dc,0xa790a1e02903a575,0x27d3a88d925c28a3,0x273aa8c41c5d284a,0x2534258aa9052271
.quad 0x269223bfa90b254a,0xa8ad27b220b9a8eb,0xa810289397f2a857,0xa0eba77f28c49df0,0xa575a4c5290fa51e,0x2909a5c9a46b290d,0x2870a8578e5c2864,0x97f2287ca84a94c5,0x243d259fa90e24f2,0xa8f623012644a906,0xa8bb2810198fa870,0x22d1a8ee273a2025,0xa1e0a66b2909a4c5,0x28769befa7d328d7,0x28eea77f9d27287c,0xa607290fa58aa390
.quad 0xa8d025f325f3a8d0,0xa5f3a5f328d08000,0x9b25a89e26f124af,0x28cca630a58a28e8,0x2903a056a8432809,0x125c28b6a6b9a4c5,0xa331290fa390a75d,0xa8db1b252888a77f,0xa8359fe628f6a59f,0x259fa8f61fe62835,0x275da8a80e5c289e,0x265824afa90c22d1,0x251e25c9a8fb211c,0xa8b6274b22a1a909,0xa8d426f12331a90a,0x998fa864282e1df0
.quad 0x9a5aa85028501a5a,0x28eba0b9a7b228ad,0x2901a2d1a6cc28e8,0xa534290ea454a607,0xa3602903a61ca40e,0xa6b9a2a128fba66b,0xa82e998f2888a83c,0x289ea81f9b252893,0x276ea8df217e26de,0x1cc227f2a8bf1fe6,0x250824afa90a2630,0xa8f9239025dea90e,0xa8d727d31befa876,0x24c5a909266b21e0,0x998fa7e328dba271,0x27161f82a89e2857
.quad 0x25f3a8d0000028d0,0x28d08000a8d025f3,0x255f2658a8c48e5c,0xa71628931c5da8ee,0xa8fb251e266ba8c8,0xa2a1a7d3285d1f1e,0x2025a8fd25342630,0x2905a0eba81f283c,0x28351fe6a8f6259f,0xa59f28f69fe6a835,0xa82e284a1df0a8e2,0xa508a60728ee9f82,0xa056a809287618c4,0x290da4c5a61c28f1,0x28fda1afa77f28b1,0xa3ee290ea4dca5de
.quad 0xa54a290ba3bfa692,0xa692a3bf290ba54a,0xa607a454290ea534,0x28e8a6cca2d12901,0x28e5a703a1e028f1,0xa05628d7a74ba11c,0x9d2728a8a8109c5d,0xa7e39df028b1a801,0xa86a165b2835a898,0x2898a835965b286a,0x27e3a8cc20eb26f1,0x94c52857a8881c5d,0x21e0266ba90924c5,0xa8761bef27d3a8d7,0xa90a25082454a8fd,0x281fa8c4214d267f
.quad 0x28d0a5f3a5f3,0xa8d025f325f3a8d0,0xa857a0252905a481,0x2211a90f233127c2,0x2876a790a360290f,0x261c2575a8f11d8c,0x97f228cca67fa4dc,0xa90f23ee273aa89e,0xa8359fe628f6a59f,0x259fa8f61fe62835,0x2893a7a1a2112908,0x2331273aa8b114c5,0x9bef28c8a703a360,0xa8e51f1e2827a85d,0xa8109f8228e2a6a6,0x27c2a89e14c5287c
.quad 0x28ada7b2a0b928eb,0x1a5a2850a8509a5a,0x9df028c4a77fa0eb,0xa85797f22893a810,0xa7d39f1e28c8a790,0x28a3a8099d8c28b6,0x28c4a7c29eb928bb,0xa02528cca7a19f82,0x9fe628bfa7f29cc2,0xa6dea17e28dfa76e,0xa77f9eb928a8a82e,0x2905a67fa21128e2,0x28d7a7d39bef2876,0xa4c52909a66ba1e0,0xa0eb28bba82e0e5c,0xa481a4dc2908a6a6
.quad 0xa5f3a5f328d08000,0x25f3a8d0000028d0,0x290ca14da82e2810,0x1eb92870a77fa3ee,0xa70328a318c4a8d7,0xa827a11c2909a46b,0x9c5da87c27a122d1,0x28f9a55fa60728e2,0x28351fe6a8f6259f,0xa59f28f69fe6a835,0xa8db267f2481a90e,0xa025a81f28571d27,0x240ea90f246b266b,0x28431d8ca8d726b9,0x24812630a8f420eb,0xa8ee26582454a90f
.quad 0xa8eb20b927b2a8ad,0x254aa90b23bf2692,0x2810a89317f22857,0x20eb277fa8c41df0,0x98c4288da8279bef,0xa85d925c2876a843,0xa75da08828d4a77f,0x28e2a73aa0eb28db,0x2906a644a30128f6,0xa4f2290ea59fa43d,0xa58a290fa55fa454,0xa1afa6a62901a425,0xa1e0a66b2909a4c5,0x28769befa7d328d7,0x28a8a025a6f12901,0xa8d4280117f2a84a
.quad 0x28d08000a8d025f3,0x28d0a5f3a5f3,0xa8a826cc24dca8fd,0xa607a5b428e2998f,0x246ba909211c2827,0x28d798c4a8a32703,0x214d2810a84a9f82,0xa8c426a624afa908,0xa8359fe628f6a59f,0x259fa8f61fe62835,0x2905a534a5de28f4,0x17f22888a7c2a1af,0xa6b928d79d8ca843,0xa66ba46b290fa40e,0xe5ca89327e32088,0x28e8a025a8012888
.quad 0x269223bfa90b254a,0xa8ad27b220b9a8eb,0xa90122d126cca8e8,0x2534a90e24542607,0x2843a876125c285d,0x1bef2827a88d18c4,0xa1af28e8a716a14d,0xa6cca21128eea6f1,0xa43da59f290ea4f2,0x28f6a301a6442906,0x289e9df0a7a128db,0xa893284a8e5ca83c,0xa8d727d31befa876,0x24c5a909266b21e0,0x255fa90e26302211,0x1df0275da8f423ee
.quad 0xa8d025f325f3a8d0,0xa5f3a5f328d08000,0x267fa8bb94c528d4,0x28881d27a8f42534,0x9d8c28f1a575a61c,0xa90f23602790a876,0xa425a71628a814c5,0x2870a7c2a271290e,0x28351fe6a8f6259f,0xa59f28f69fe6a835,0xa90f23902716a8bb,0x1c5da8d426a62454,0x285da8279f1e28e5,0x23602703a8c81bef,0xa4af290fa425a67f,0xa7a1a14d28f9a607
.quad 0x9a5aa85028501a5a,0x28eba0b9a7b228ad,0x26072454a90e2534,0xa8e826cc22d1a901,0xa8b61d8c2809a8a3,0x2790a8c81f1e27d3,0x28f9a6a6a27128f4,0xa33128fda67fa2d1,0xa76e28dfa17ea6de,0x9cc2a7f228bf9fe6,0x214da8d427c21d27,0x25b423eea8fd26cc,0x21e0266ba90924c5,0xa8761bef27d3a8d7,0xa7a19c5d2870a888,0x290fa5b4a33128e8
.quad 0x25f3a8d0000028d0,0x28d08000a8d025f3,0xa0882908a454a73a,0xa90f22d127e3a84a,0x9f1ea85d27d322a1,0x28c8a66ba51e28fb,0x258a25dea8e81d27,0xa80128571eb9a8f4,0xa8359fe628f6a59f,0x259fa8f61fe62835,0x28f9a088a8102864,0xa14d2901a55fa5b4,0xa8f1261c24c5a90d,0x98c4a87628092056,0x281fa87097f228a8,0x239026cca8db1eb9
.quad 0xa54a290ba3bfa692,0xa692a3bf290ba54a,0x1df0a8c4277f20eb,0x285717f2a8932810,0x211c274ba8d72056,0xa8f121e02703a8e5,0xa630a3902901a658,0x2908a607a3ee2905,0x286a965ba8352898,0xa8982835165ba86a,0xa90824812534a90f,0x275da8e822712658,0x28d7a7d39bef2876,0xa4c52909a66ba1e0,0xa7c228e2a2d1a5de,0x1eb9a89328649b25
.quad 0x28d0a5f3a5f3,0xa8d025f325f3a8d0,0xa0eba83c28012271,0x287ca75da425290a,0x24c526b9a8b6925c,0xa80928432056a903,0xa6cca481290aa1af,0x26f1a8b18e5c28bb,0x28351fe6a8f6259f,0xa59f28f69fe6a835,0xa8c4198f287ca7e3,0x2425a90f23ee26f1,0x2909a2a1a74b28b6,0xa11c28fba5c9a51e,0xa90125b42508a90c,0x1b25a8bb275d2211
.quad 0x28ada7b2a0b928eb,0x1a5a2850a8509a5a,0xa810289397f2a857,0xa0eba77f28c49df0,0x266ba8fb22a126b9,0x240e261ca9032360,0xa454290aa5dea425,0xa58aa481290ca5b4,0x1fe6a8bf27f21cc2,0x26de217ea8df276e,0x17f2281fa8b11f82,0xa8019b25287ca864,0xa1e0a66b2909a4c5,0x28769befa7d328d7,0x25342425a8f9273a,0xa8cc21af2658a90c
.quad 0xa5f3a5f328d08000,0x25f3a8d0000028d0,0x26a62508a8f91df0,0xa5de28db97f2a8b1,0xa74ba40e290da1e0,0x25c9a8e51bef288d,0x27e32211a90c2454,0xa5b428ee9df0a864,0xa8359fe628f6a59f,0x259fa8f61fe62835,0x28701b25a8cc26cc,0xa58a28fda0eba801,0xa8a3125c288da7d3,0x2575a90321e02790,0x28cc9d27a83c2857,0xa55f2908a2d1a716
.quad 0xa8eb20b927b2a8ad,0x254aa90b23bf2692,0x2901a2d1a6cc28e8,0xa534290ea454a607,0xa90d246b25c9a909,0x251ea90f24c52575,0x290fa55fa4af290e,0xa508290fa534a4dc,0xa90626442301a8f6,0x24f2a90e259f243d,0x28f4a716a08828c4,0xa4dc290ca607a331,0xa8d727d31befa876,0x24c5a909266b21e0,0x28b1a83c14c52810,0xa4af2905a6cca088
.quad 0xa5f3a5f328d00000,0x25f3a8d0000028d0,0xa575a64428c80000,0x2703a8989bef28eb,0xa4f2a69228bf0000,0x27f2a8509fe628ff,0xa46ba6de28b60000,0x285da7f2a1e0290b,0xa3bfa72828ad0000,0x28ada728a3bf290f,0xa2a1a76e28a30000,0x28e5a644a4c5290b,0xa17ea7b228980000,0x2906a54aa59f28ff,0xa056a7f2288d0000,0x290fa43da66b28eb
.quad 0x9e55a81828820000,0x28ffa241a72828d0,0x9befa83528760000,0x28d79fe6a7d328ad,0x965ba850286a0000,0x28989a5aa8352882,0x125ca86a285d0000,0x2843165ba8762850,0x1a5aa88228500000,0x27b21e55a8ad2818,0x1d8ca89828430000,0x26b9217ea8d727b2,0x1fe6a8ad28350000,0x259f23bfa8f62728,0x211ca8bf28270000,0x246b24f2a9092692
.quad 0x28d00000a8d025f3,0x28d0a5f3a5f3,0x285d1fe6a9032498,0xa1e0290ea360a7b2,0x276e23bfa90e2241,0xa59f28eb9cc2a882,0x25c9259fa8f11e55,0xa7d3286a1d8ca8eb,0x23bf2728a8ad0000,0xa8ad272823bfa90f,0x1f1e2835a8439e55,0xa90924f2261ca8eb,0x965b28ada76ea241,0xa8f620b927f2a882,0xa11c28f6a61ca498,0xa876965b28a3a7b2
.quad 0xa498290fa498a5f3,0xa728a24128ffa5f3,0xa66b28f6a1e0a728,0xa4c5a59f2909a3bf,0xa7f228ad9cc2a818,0x9fe6a7b228bf9e55,0xa88d283518c4a882,0x1befa89828271a5a,0xa8eb272820b9a8d0,0x23bfa8ff26922241,0xa90f259f240ea8ff,0x266ba906246b254a,0xa8f623bf259fa90f,0x2835a8ad1fe62728,0xa8a31fe62703a8ff,0x28d7a7f298c42850
.quad 0xa8d025f325f3a8d0,0xa5f3a5f328d00000,0xa90d217e2827a818,0x9f1ea86a279023bf,0xa8989a5a28dfa5f3,0x217ea90b243d2728,0xa703a43d290da241,0x26b9a8bf125c28ad,0xa3bfa72828ad0000,0x28ada728a3bf290f,0x925ca89827902241,0x290da301a74b28ad,0x2301a90b24f225f3,0x286a1a5aa8bf2728,0x26b9a8df1f1e2818,0x25c924f2a90d23bf
.quad 0x2882a8189e5528d0,0x1e552818a8820000,0x2909a59fa4c5290f,0xa1e028f6a66ba3bf,0x28dfa0b9a76e28d0,0xa6de28eba17ea728,0x28091cc2a8a32818,0xa8b627f21d8ca8ad,0x254a2498a90b25f3,0xa90b2498254aa90f,0x1f1e276ea8e52241,0xa85d165b2827a8ad,0x9fe628ada8350000,0xa59fa3bf28f6a728,0xa575290ea61ca241,0x9d8ca76e28f1a3bf
.quad 0x25f3a8d0000028d0,0x28d00000a8d025f3,0x28a3a6dea4c528ff,0x261c259fa8e51a5a,0x2906a0b9a8352818,0x165b28ada6dea498,0x2809217ea9092498,0xa57528f69f1ea850,0x23bf2728a8ad0000,0xa8ad272823bfa90f,0x9d8c28dfa66ba498,0xa8f11fe62827a850,0xa64428eb9fe6a818,0xa6dea3bf290ea498,0xa8b6276e21e0a8ff,0x9d8ca835285d1a5a
.quad 0xa8ff22412728a8d0,0x2498a90f249825f3,0xa7d39fe628d7a728,0x2876a8359bef28ad,0xa301a69228f6a241,0x2906a3bfa64428ff,0x1f1ea8bf27d31e55,0x27901fe6a8c827b2,0x2692a8ff23bf25f3,0x20b92728a8eb2241,0x28c8a7f29bef2882,0xa36028f6a703a0b9,0x28f6a3bfa59f290f,0xa83528ad9fe6a728,0x27901cc2a8762882,0xa90f259f2360a8eb
.quad 0x28d0a5f3a5f3,0xa8d025f325f3a8d0,0xa66b28bf125ca8d0,0xa88d9cc228f1a54a,0xa8f6254a2644a8d0,0xa301a7b2286a1e55,0xa8769cc228e5a5f3,0x240ea90e22a127b2,0xa3bfa72828ad0000,0x28ada728a3bf290f,0x21e0a906251e25f3,0x28b6965ba88d27b2,0x2835a8509cc228d0,0x243d2692a8df1e55,0x2909a301a70328d0,0xa2a12906a575a54a
.quad 0x27282241a8ff25f3,0xa88228181e55a8d0,0x1bef2835a8760000,0xa8d71fe627d3a8ad,0xa59f290ba43da5f3,0xa4f2a54a290ea498,0xa8d7276e2056a8d0,0x211ca8df274b20b9,0xa8ad1e5527b2a8d0,0x2850a8821a5a2818,0xa4c5a4f2290da5f3,0x28f1a301a61c290b,0x1fe6a8ad28350000,0x259f23bfa8f62728,0x27d3a8df22a125f3,0x9f1e2898a85d1a5a
.quad 0xa5f3a5f328d00000,0x25f3a8d0000028d0,0x2056a906246b2728,0x290fa301a7d32850,0x286aa7b2a301290f,0x2644254aa8f61e55,0x28c8965ba8a32728,0xa11c2906a4c5a692,0x23bf2728a8ad0000,0xa8ad272823bfa90f,0xa46b290ea360a728,0xa85d9cc228d7a692,0xa8df2692243da90f,0x9cc2a85028351e55,0xa8439cc228c8a728,0x274ba8bf1bef2850
.quad 0x9e55a81828820000,0x28ffa241a72828d0,0x266ba8f621e02728,0x24c5259fa90923bf,0x290ea54aa4f2290f,0xa43d290ba59fa498,0x2703217ea8e52728,0xa8f126de21e0a8eb,0x9a5a2882a8500000,0xa7b29e5528ada818,0xa80928bfa056a728,0x18c4a86a28769a5a,0xa8f623bf259fa90f,0x2835a8ad1fe62728,0xa51ea43d28fba728,0x28c8a17ea66b290b
.quad 0x28d00000a8d025f3,0x28d0a5f3a5f3,0x211c2835a809a241,0xa876276e240ea90b,0xa6de28ad165ba8d0,0xa835a0b92906a498,0xa8fb1fe62843a818,0x1befa8df261c254a,0xa3bfa72828ad0000,0x28ada728a3bf290f,0x25c9a8f620562818,0x27d3217ea903254a,0x290ea3bfa6de28d0,0x9fe628eba644a498,0x251e259fa9032241,0xa8d726de2360a90b
.quad 0xa498290fa498a5f3,0xa728a24128ffa5f3,0xa909259f24c5a90f,0x21e0a8f6266b23bf,0xa644a3bf2906a5f3,0x28f6a692a30128ff,0x22a1a8f626b92241,0x266b2301a8fb2692,0x28eba728a0b928d0,0xa3bf28ffa692a241,0x274b1fe6a8b62818,0xa909264422a1a8eb,0x9fe628ada8350000,0xa59fa3bf28f6a728,0xa8b62835925ca818,0x24c5a90626b920b9
.quad 0xa8d025f325f3a8d0,0xa5f3a5f328d00000,0xa6b9a4f228fb9e55,0x25c9a8df18c428ad,0x243da90b217e2818,0x28df9a5aa8982728,0x290fa301a7902882,0x18c42898a74ba3bf,0x23bf2728a8ad0000,0xa8ad272823bfa90f,0xa70328bf98c4a882,0xa6b9a43d290fa3bf,0xa8bf1a5a286aa818,0x24f2a90b23012728,0x98c4a86a28271e55,0x28fba17ea79028ad
.quad 0x2882a8189e5528d0,0x1e552818a8820000,0x27d31fe6a8d72728,0xa87628351befa8ad,0xa17e28eba6dea241,0xa76ea0b928dfa728,0xa90326442360a8ff,0x240ea906261c23bf,0xa54aa498290ba5f3,0x290ba498a54a290f,0x25c9a90e251e2498,0x211c26dea8fb23bf,0x28f6a3bfa59f290f,0xa83528ad9fe6a728,0x205626dea9032498,0xa809965b2843a8ad
.quad 0x25f3a8d0000028d0,0x28d00000a8d025f3,0x28b6165ba8d725f3,0x9d8c28f6a51ea692,0x9cc228eba59fa5f3,0xa90e23bf276ea882,0xa90324f2266ba8d0,0xa056a835282720b9,0xa3bfa72828ad0000,0x28ada728a3bf290f,0x2809a86a9bef28d0,0x2575259fa8fb20b9,0x27f220b9a8f625f3,0xa76e28ad965ba882,0xa40e290ea4c5a5f3,0xa8099fe628e5a692
.quad 0xa8ff22412728a8d0,0x2498a90f249825f3,0x9befa83528760000,0x28d79fe6a7d328ad,0x28bfa7b29fe628d0,0x9cc228ada7f29e55,0x25c9243da90925f3,0xa90d259f246ba90b,0xa69228ffa3bfa5f3,0xa0b9a72828eba241,0xa88d1cc227d3a8d0,0x28a3a835925c2850,0x1fe6a8ad28350000,0x259f23bfa8f62728,0x290da644a1e028d0,0xa74b28f6a40ea54a
.quad 0x28d0a5f3a5f3,0xa8d025f325f3a8d0,0xa909243d274ba882,0xa2a1a7f2284320b9,0x9fe6a85027f22241,0x28bfa692a4f228ff,0x28d7a644a51e28ff,0x2360276ea88d9a5a,0x23bf2728a8ad0000,0xa8ad272823bfa90f,0xa87627f2211ca8ff,0xa40ea6de28c89a5a,0xa59fa54a2906a241,0x2898a7b2a17e28ff,0x27d3a898125c2882,0x246b2644a8f120b9
.quad 0x27282241a8ff25f3,0xa88228181e55a8d0,0xa66b28f6a1e0a728,0xa4c5a59f2909a3bf,0xa8359a5a2898a818,0x286aa850965b2882,0x24c5a90e25752498,0x251e24f2a90f254a,0x28ad9e55a7b228d0,0xa85028829a5aa818,0xa1e028dfa7909e55,0xa575a43d2903a692,0xa8f623bf259fa90f,0x2835a8ad1fe62728,0x1befa86a288d9e55,0x25c92301a8e527b2
.quad 0xa5f3a5f328d00000,0x25f3a8d0000028d0,0x2843a7f2a2a1290f,0x274b243da90920b9,0x24f22692a8bf0000,0xa7f228501fe6a8ff,0xa88d276e2360a90f,0xa51ea64428d79a5a,0xa3bfa72828ad0000,0x28ada728a3bf290f,0x28c8a6dea40e290f,0x211c27f2a8769a5a,0x217e27b2a8980000,0xa906254a259fa8ff,0xa8f12644246ba90f,0x125ca89827d320b9
.quad 0x9e55a81828820000,0x28ffa241a72828d0,0x2909a59fa4c5290f,0xa1e028f6a66ba3bf,0x165b2850a86a0000,0xa8981a5a2835a882,0xa90f24f2251ea90f,0x2575a90e24c5254a,0x1a5aa88228500000,0x27b21e55a8ad2818,0x2903a43da575290f,0xa79028dfa1e0a692,0x9fe628ada8350000,0xa59fa3bf28f6a728,0xa8e5230125c9a90f,0x288da86a1bef27b2
.quad 0x28d00000a8d025f3,0x28d0a5f3a5f3,0xa51e28f69d8ca882,0xa8d7165b28b6a692,0xa76ea3bf290ea241,0x259fa8eb1cc22882,0x2827a835a05628ff,0x266b24f2a90320b9,0x23bf2728a8ad0000,0xa8ad272823bfa90f,0xa8fb259f2575a8ff,0x9befa86a280920b9,0x165ba8ad276e2241,0x28f6a0b9a7f22882,0x28e59fe6a8092882,0xa4c5290ea40ea692
.quad 0xa498290fa498a5f3,0xa728a24128ffa5f3,0xa7d39fe628d7a728,0x2876a8359bef28ad,0x27f2a8ad1cc22818,0x1fe627b2a8bf1e55,0x246b259fa90d2498,0xa909243d25c9a90b,0xa8eb272820b9a8d0,0x23bfa8ff26922241,0x925ca83528a39e55,0x27d31cc2a88d2850,0x28f6a3bfa59f290f,0xa83528ad9fe6a728,0xa40e28f6a74b9e55,0xa1e0a644290da54a
.quad 0xa8d025f325f3a8d0,0xa5f3a5f328d00000,0x18c4a8df25c925f3,0x28fba4f2a6b928ad,0x28981a5aa8df25f3,0xa17e290ba43da728,0xa74b289818c4a8d0,0xa790a301290fa3bf,0xa3bfa72828ad0000,0x28ada728a3bf290f,0x290fa43da6b928d0,0x98c428bfa703a3bf,0xa301290ba4f2a5f3,0xa86a9a5a28bfa728,0xa790a17e28fba5f3,0x2827a86a98c428ad
.quad 0x2882a8189e5528d0,0x1e552818a8820000,0x1bef2835a8760000,0xa8d71fe627d3a8ad,0xa8df20b9276ea8d0,0x26dea8eb217e2728,0x261ca906240e25f3,0x23602644a90323bf,0x254a2498a90b25f3,0xa90b2498254aa90f,0xa8fb26de211ca8d0,0x251ea90e25c923bf,0x1fe6a8ad28350000,0x259f23bfa8f62728,0x2843965ba80928d0,0xa90326de2056a8ad
.quad 0x25f3a8d0000028d0,0x28d00000a8d025f3,0x240e276ea8769e55,0xa8092835211ca90b,0xa90620b92835a818,0x965ba8ad26de2498,0x261ca8df1bef2882,0x28431fe6a8fb254a,0x23bf2728a8ad0000,0xa8ad272823bfa90f,0xa903217e27d3a882,0x2056a8f625c9254a,0x2644a8eb1fe62818,0x26de23bfa90e2498,0x236026dea8d71e55,0xa903259f251ea90b
.quad 0xa8ff22412728a8d0,0x2498a90f249825f3,0x266ba8f621e02728,0x24c5259fa90923bf,0x23012692a8f62241,0xa90623bf2644a8ff,0xa8fb2301266ba8ff,0x26b9a8f622a12692,0x2692a8ff23bf25f3,0x20b92728a8eb2241,0x22a12644a9092498,0xa8b61fe6274ba8eb,0xa8f623bf259fa90f,0x2835a8ad1fe62728,0x26b9a90624c52498,0x925c2835a8b620b9
.quad 0x28d0a5f3a5f3,0xa8d025f325f3a8d0,0xa7d3a301290fa241,0x246ba90620562850,0x28f6a54aa64428d0,0x230127b2a86a9e55,0xa4c52906a11ca818,0xa8a3965b28c8a692,0xa3bfa72828ad0000,0x28ada728a3bf290f,0x28d79cc2a85d2818,0xa360290ea46ba692,0xa83528501cc2a8d0,0xa43da69228df9e55,0x1befa8bf274b2241,0x28c89cc2a8432850
.quad 0x27282241a8ff25f3,0xa88228181e55a8d0,0xa909259f24c5a90f,0x21e0a8f6266b23bf,0x259fa90b243d25f3,0x24f2254aa90e2498,0x21e026dea8f12241,0xa8e5217e2703a8eb,0xa8ad1e5527b2a8d0,0x2850a8821a5a2818,0x2876a86a18c42818,0xa05628bfa8099a5a,0x9fe628ada8350000,0xa59fa3bf28f6a728,0xa66ba17e28c8a818,0x28fba43da51e290b
.quad 0xa5f3a5f328d00000,0x25f3a8d0000028d0,0x28f19cc2a88d2728,0x125c28bfa66ba54a,0xa86a27b22301a90f,0xa644a54a28f69e55,0x22a1a90e240e2728,0x28e59cc2a87627b2,0x23bf2728a8ad0000,0xa8ad272823bfa90f,0xa88d965b28b6a728,0x251ea90621e027b2,0x28dfa692a43d290f,0x1cc22850a8359e55,0xa5752906a2a1a728,0xa703a3012909a54a
.quad 0x9e55a81828820000,0x28ffa241a72828d0,0x27d31fe6a8d72728,0xa87628351befa8ad,0xa90e254a24f2a90f,0x243da90b259f2498,0x274ba8df211c2728,0x2056276ea8d720b9,0x9a5a2882a8500000,0xa7b29e5528ada818,0xa61ca30128f1a728,0x290da4f2a4c5290b,0x28f6a3bfa59f290f,0xa83528ad9fe6a728,0xa85d28989f1ea728,0x22a1a8df27d31a5a
.quad 0x28d00000a8d025f3,0x28d0a5f3a5f3,0xa8e5259f261ca8d0,0xa4c5a6de28a31a5a,0x26dea8ad965b28d0,0x283520b9a9062498,0x9f1e28f6a575a5f3,0xa909217e2809a850,0xa3bfa72828ad0000,0x28ada728a3bf290f,0x28271fe6a8f125f3,0xa66b28df9d8ca850,0xa90e23bf26dea8d0,0x1fe6a8eb26442498,0x285da8359d8c28d0,0x21e0276ea8b61a5a
.quad 0xa498290fa498a5f3,0xa728a24128ffa5f3,0x9befa83528760000,0x28d79fe6a7d328ad,0x264423bfa90625f3,0xa8f626922301a8ff,0xa8c81fe62790a8d0,0x27d3a8bf1f1e27b2,0x28eba728a0b928d0,0xa3bf28ffa692a241,0xa70328f6a360a5f3,0x9befa7f228c8a0b9,0x1fe6a8ad28350000,0x259f23bfa8f62728,0x2360259fa90f25f3,0xa8761cc22790a8eb
.quad 0xa8d025f325f3a8d0,0xa5f3a5f328d00000,0x2790a86a9f1e28ff,0x2827217ea90d23bf,0xa43d290ba17ea818,0xa8df1a5a2898a728,0x125ca8bf26b92498,0x290da43da70328ad,0x23bf2728a8ad0000,0xa8ad272823bfa90f,0xa74ba301290da498,0x2790a898925c28ad,0x28bf9a5aa86a2818,0xa4f2290ba301a728,0xa90d24f225c9a8ff,0x1f1ea8df26b923bf
.quad 0x2882a8189e5528d0,0x1e552818a8820000,0xa66b28f6a1e0a728,0xa4c5a59f2909a3bf,0x217ea8eb26de2241,0x276e20b9a8df2728,0x1d8c27f2a8b61e55,0xa8a31cc22809a8ad,0xa54aa498290ba5f3,0x290ba498a54a290f,0x2827165ba85d2882,0xa8e5276e1f1ea8ad,0xa8f623bf259fa90f,0x2835a8ad1fe62728,0x28f1a76e9d8c2882,0xa61c290ea575a3bf
.quad 0x25f3a8d0000028d0,0x28d00000a8d025f3,0xa360290ea1e0a818,0xa9031fe6285da7b2,0x1cc2a8eb259f25f3,0x290ea3bfa76e2882,0x1d8c286aa7d3a241,0xa8f1259f25c9a8eb,0xa3bfa72828ad0000,0x28ada728a3bf290f,0x261c24f2a9092241,0xa84328351f1ea8eb,0xa7f2a0b928f6a5f3,0x276ea8ad165b2882,0x28a3965ba8762818,0xa61c28f6a11ca7b2
.quad 0xa8ff22412728a8d0,0x2498a90f249825f3,0x2909a59fa4c5290f,0xa1e028f6a66ba3bf,0xa8bf27b21fe6a8d0,0x1cc2a8ad27f21e55,0x2827a8981bef2818,0x18c42835a88d1a5a,0xa69228ffa3bfa5f3,0xa0b9a72828eba241,0x246ba906266b2241,0x240e259fa90f254a,0x9fe628ada8350000,0xa59fa3bf28f6a728,0x98c4a7f228d7a241,0x27031fe6a8a32850
.quad 0x28d0a5f3a5f3,0xa8d025f325f3a8d0,0x9befa89827032498,0x28c8a644a57528eb,0x1fe62850a7f2a241,0xa8bf269224f2a8ff,0xa1e0a7f2285d1e55,0x28b6a6dea46b290b,0x23bf2728a8ad0000,0xa8ad272823bfa90f,0xa4c5a64428e59e55,0x28a3a76ea2a1290b,0x259f254aa9062241,0xa89827b2217ea8ff,0xa66ba43d290fa498,0x288da7f2a05628eb
.quad 0x27282241a8ff25f3,0xa88228181e55a8d0,0xa7d39fe628d7a728,0x2876a8359bef28ad,0x28351a5aa8982818,0xa86a2850165ba882,0xa876165b2843a882,0x285da86a125c2850,0x28ad9e55a7b228d0,0xa85028829a5aa818,0xa8d7217e26b9a8ff,0x2843a8981d8c27b2,0x28f6a3bfa59f290f,0xa83528ad9fe6a728,0xa90924f2246ba8ff,0x2827a8bf211c2692
.quad 0x2241a90f22412818,0x290fa241a8182818,0x2390a90e21af281f,0x29019f82a86427a1,0x246ba909211c2827,0x28d798c4a8a32703,0x2508a9012088282e,0x2893198fa8d42658,0x259fa8f61fe62835,0x28351fe6a8f6259f,0x2630a8e81eb9283c,0x277f2271a90a24dc,0x26b9a8d71d8c2843,0x266b246ba90f240e,0x273aa8c41c5d284a,0x2534258aa9052271
.quad 0x27b2a8ad1a5a2850,0x23bf2692a8eb20b9,0x2810a89317f22857,0x20eb277fa8c41df0,0x2843a876125c285d,0x1bef2827a88d18c4,0x2870a8578e5c2864,0x97f2287ca84a94c5,0x2898a835965b286a,0x9fe628bfa7f29cc2,0x28bba810998f2870,0xa2d128eea73aa025,0x28d7a7d39bef2876,0xa4c52909a66ba1e0,0x28eea77f9d27287c,0xa607290fa58aa390
.quad 0x22412818a818a241,0xa81828182241a90f,0x1b25289ea6f1a4af,0xa8cc2630258aa8e8,0x9d8c28f1a575a61c,0xa90f23602790a876,0xa331290fa390a75d,0xa8db1b252888a77f,0xa59f28f69fe6a835,0xa8359fe628f6a59f,0xa75d28a88e5ca89e,0xa658a4af290ca2d1,0xa85d28271f1ea8e5,0xa360a70328c89bef,0xa8d426f12331a90a,0x998fa864282e1df0
.quad 0xa90b254a254aa90b,0x20b9a8eb269223bf,0xa90122d126cca8e8,0x2534a90e24542607,0xa8b61d8c2809a8a3,0x2790a8c81f1e27d3,0xa82e998f2888a83c,0x289ea81f9b252893,0xa6dea17e28dfa76e,0x2906a644a30128f6,0xa508a4af290aa630,0x28f9a390a5de290e,0xa1e0a66b2909a4c5,0x28769befa7d328d7,0x998fa7e328dba271,0x27161f82a89e2857
.quad 0xa818a241290fa241,0x2241a90f22412818,0xa55fa65828c40e5c,0x2716a8939c5d28ee,0x9f1ea85d27d322a1,0x28c8a66ba51e28fb,0x2025a8fd25342630,0x2905a0eba81f283c,0x259fa8f61fe62835,0x28351fe6a8f6259f,0x282ea84a9df028e2,0x25082607a8ee1f82,0x28f1a61ca4c5290d,0x18c42876a809a056,0x28fda1afa77f28b1,0xa3ee290ea4dca5de
.quad 0x28501a5aa8ad27b2,0xa7b228ad9a5aa850,0x26072454a90e2534,0xa8e826cc22d1a901,0x211c274ba8d72056,0xa8f121e02703a8e5,0x9d2728a8a8109c5d,0xa7e39df028b1a801,0xa4f2290ea59fa43d,0xa43da59f290ea4f2,0xa7e328cca0eba6f1,0x14c5a85728889c5d,0xa8d727d31befa876,0x24c5a909266b21e0,0xa90a25082454a8fd,0x281fa8c4214d267f
.quad 0x290fa241a8182818,0x22412818a818a241,0x28572025a9052481,0xa211290fa331a7c2,0x24c526b9a8b6925c,0xa80928432056a903,0x97f228cca67fa4dc,0xa90f23ee273aa89e,0xa59f28f69fe6a835,0xa8359fe628f6a59f,0xa89327a12211a908,0xa331a73a28b194c5,0xa90922a1274ba8b6,0x211ca8fb25c9251e,0xa8109f8228e2a6a6,0x27c2a89e14c5287c
.quad 0xa3bfa69228eba0b9,0x290ba54aa54a290b,0x1df0a8c4277f20eb,0x285717f2a8932810,0x266ba8fb22a126b9,0x240e261ca9032360,0x28c4a7c29eb928bb,0xa02528cca7a19f82,0x28f6a301a6442906,0xa76e28dfa17ea6de,0x277f1eb9a8a8282e,0xa905267f2211a8e2,0x21e0266ba90924c5,0xa8761bef27d3a8d7,0xa0eb28bba82e0e5c,0xa481a4dc2908a6a6
.quad 0xa81828182241a90f,0xa818a241290fa241,0xa90c214d282ea810,0x9eb9a870277f23ee,0xa74ba40e290da1e0,0x25c9a8e51bef288d,0x9c5da87c27a122d1,0x28f9a55fa60728e2,0x259fa8f61fe62835,0x28351fe6a8f6259f,0x28dba67fa481290e,0x2025281fa8579d27,0x28a3925ca88d27d3,0xa5752903a1e0a790,0x24812630a8f420eb,0xa8ee26582454a90f
.quad 0xa0b928eba692a3bf,0xa8509a5a28ada7b2,0xa810289397f2a857,0xa0eba77f28c49df0,0xa90d246b25c9a909,0x251ea90f24c52575,0xa75da08828d4a77f,0x28e2a73aa0eb28db,0x9cc2a7f228bf9fe6,0x286a965ba8352898,0x258aa90f255f2454,0x21af26a6a9012425,0x28d7a7d39bef2876,0xa4c52909a66ba1e0,0x28a8a025a6f12901,0xa8d4280117f2a84a
.quad 0x2241a90f22412818,0x290fa241a8182818,0x28a8a6cca4dc28fd,0x260725b4a8e2198f,0x288d1befa8e525c9,0xa1e0290da40ea74b,0x214d2810a84a9f82,0xa8c426a624afa908,0xa59f28f69fe6a835,0xa8359fe628f6a59f,0xa905253425dea8f4,0x97f2a88827c221af,0xa790a1e02903a575,0x27d3a88d925c28a3,0xe5ca89327e32088,0x28e8a025a8012888
.quad 0x27b2a8ad1a5a2850,0x23bf2692a8eb20b9,0x2901a2d1a6cc28e8,0xa534290ea454a607,0x257524c5a90f251e,0xa90925c9246ba90d,0xa1af28e8a716a14d,0xa6cca21128eea6f1,0xa8982835165ba86a,0x1fe6a8bf27f21cc2,0xa89e1df027a1a8db,0x2893a84a0e5c283c,0xa1e0a66b2909a4c5,0x28769befa7d328d7,0x255fa90e26302211,0x1df0275da8f423ee
.quad 0x22412818a818a241,0xa81828182241a90f,0xa67f28bb14c5a8d4,0xa8889d2728f4a534,0xa90320562843a809,0x925ca8b626b924c5,0xa425a71628a814c5,0x2870a7c2a271290e,0x259fa8f61fe62835,0x28351fe6a8f6259f,0x290fa390a71628bb,0x9c5d28d4a6a6a454,0x251e25c9a8fb211c,0xa8b6274b22a1a909,0xa4af290fa425a67f,0xa7a1a14d28f9a607
.quad 0xa90b254a254aa90b,0x20b9a8eb269223bf,0xa607a454290ea534,0x28e8a6cca2d12901,0x2360a903261c240e,0x26b922a1a8fb266b,0x28f9a6a6a27128f4,0xa33128fda67fa2d1,0x26de217ea8df276e,0xa90626442301a8f6,0xa14d28d4a7c29d27,0xa5b4a3ee28fda6cc,0xa8d727d31befa876,0x24c5a909266b21e0,0xa7a19c5d2870a888,0x290fa5b4a33128e8
.quad 0xa818a241290fa241,0x2241a90f22412818,0x2088a9082454273a,0x290fa2d1a7e3284a,0x28fba51ea66b28c8,0x22a127d3a85d9f1e,0x258a25dea8e81d27,0xa80128571eb9a8f4,0xa59f28f69fe6a835,0xa8359fe628f6a59f,0xa8f920882810a864,0x214da901255f25b4,0xa056a809287618c4,0x290da4c5a61c28f1,0x281fa87097f228a8,0x239026cca8db1eb9
.quad 0x28501a5aa8ad27b2,0xa7b228ad9a5aa850,0x9df028c4a77fa0eb,0xa85797f22893a810,0xa8e5270321e0a8f1,0x2056a8d7274b211c,0xa630a3902901a658,0x2908a607a3ee2905,0x24f2a90e259f243d,0x243d259fa90e24f2,0x2908a481a534290f,0xa75d28e8a271a658,0x21e0266ba90924c5,0xa8761bef27d3a8d7,0xa7c228e2a2d1a5de,0x1eb9a89328649b25
.quad 0x290fa241a8182818,0x22412818a818a241,0x20eb283ca801a271,0xa87c275d2425a90a,0xa87627902360a90f,0xa61ca57528f19d8c,0xa6cca481290aa1af,0x26f1a8b18e5c28bb,0x259fa8f61fe62835,0x28351fe6a8f6259f,0x28c4998fa87c27e3,0xa425290fa3eea6f1,0x9bef28c8a703a360,0xa8e51f1e2827a85d,0xa90125b42508a90c,0x1b25a8bb275d2211
.quad 0xa3bfa69228eba0b9,0x290ba54aa54a290b,0x2810a89317f22857,0x20eb277fa8c41df0,0x27d31f1ea8c82790,0xa8a328091d8ca8b6,0xa454290aa5dea425,0xa58aa481290ca5b4,0xa8f623012644a906,0x276ea8df217e26de,0x97f2a81f28b19f82,0x28011b25a87c2864,0x28d7a7d39bef2876,0xa4c52909a66ba1e0,0x25342425a8f9273a,0xa8cc21af2658a90c
.quad 0xa81828182241a90f,0xa818a241290fa241,0xa6a6a50828f99df0,0x25dea8db17f228b1,0x2703a8a398c428d7,0x2827211ca909246b,0x27e32211a90c2454,0xa5b428ee9df0a864,0xa59f28f69fe6a835,0xa8359fe628f6a59f,0xa8709b2528cca6cc,0x258aa8fd20eb2801,0x240ea90f246b266b,0x28431d8ca8d726b9,0x28cc9d27a83c2857,0xa55f2908a2d1a716
.quad 0xa0b928eba692a3bf,0xa8509a5a28ada7b2,0xa90122d126cca8e8,0x2534a90e24542607,0x18c4a88d28271bef,0x285d125ca8762843,0x290fa55fa4af290e,0xa508290fa534a4dc,0x1cc227f2a8bf1fe6,0xa86a165b2835a898,0xa8f427162088a8c4,0x24dca90c26072331,0xa1e0a66b2909a4c5,0x28769befa7d328d7,0x28b1a83c14c52810,0xa4af2905a6cca088
.quad 0x2241a90f22412818,0x290fa241a8182818,0x28b117f2a8db25de,0x9df028f9a508a6a6,0xa46b2909a11ca827,0xa8d718c428a3a703,0xa8649df028eea5b4,0x2454a90c221127e3,0x259fa8f61fe62835,0x28351fe6a8f6259f,0x280120eba8fd258a,0xa6cc28cc9b25a870,0xa6b928d79d8ca843,0xa66ba46b290fa40e,0xa716a2d12908a55f,0x2857a83c9d2728cc
.quad 0x27b2a8ad1a5a2850,0x23bf2692a8eb20b9,0x26072454a90e2534,0xa8e826cc22d1a901,0xa8432876925ca85d,0x9befa827288d98c4,0xa4dca534290fa508,0x290ea4afa55f290f,0x2898a835965b286a,0x9fe628bfa7f29cc2,0x23312607a90c24dc,0xa8c420882716a8f4,0xa8d727d31befa876,0x24c5a909266b21e0,0xa088a6cc2905a4af,0x281014c5a83c28b1
.quad 0x22412818a818a241,0xa81828182241a90f,0xa90a2425275da87c,0xa271a801283c20eb,0x1d8ca8f12575261c,0x290fa360a7902876,0x28bb8e5ca8b126f1,0xa1af290aa481a6cc,0xa59f28f69fe6a835,0xa8359fe628f6a59f,0xa6f1a3ee290fa425,0x27e3a87c998f28c4,0x285da8279f1e28e5,0x23602703a8c81bef,0x2211275da8bb1b25,0xa90c250825b4a901
.quad 0xa90b254a254aa90b,0x20b9a8eb269223bf,0x1df0a8c4277f20eb,0x285717f2a8932810,0x28b69d8ca80928a3,0xa79028c89f1ea7d3,0xa5b4290ca481a58a,0xa425a5de290aa454,0xa6dea17e28dfa76e,0x2906a644a30128f6,0x2864a87c1b252801,0x9f8228b1a81f97f2,0x21e0266ba90924c5,0xa8761bef27d3a8d7,0xa90c265821afa8cc,0x273aa8f924252534
.quad 0xa818a241290fa241,0x2241a90f22412818,0x284aa7e3a2d1290f,0x273a2454a9082088,0x1f1e285da7d3a2a1,0xa8c8266b251ea8fb,0xa8f41eb92857a801,0x1d27a8e825de258a,0x259fa8f61fe62835,0x28351fe6a8f6259f,0x25b4255fa901214d,0xa86428102088a8f9,0xa8f1261c24c5a90d,0x98c4a87628092056,0x1eb9a8db26cc2390,0x28a897f2a870281f
.quad 0x28501a5aa8ad27b2,0xa7b228ad9a5aa850,0xa810289397f2a857,0xa0eba77f28c49df0,0xa11ca74b28d7a056,0x28f1a1e0a70328e5,0x2905a3eea6072908,0xa6582901a390a630,0xa4f2290ea59fa43d,0xa43da59f290ea4f2,0xa658a27128e8a75d,0x290fa534a4812908,0x28d7a7d39bef2876,0xa4c52909a66ba1e0,0x9b252864a8931eb9,0xa5dea2d128e2a7c2
.quad 0x290fa241a8182818,0x22412818a818a241,0xa53428f49d27a888,0xa8d414c528bba67f,0xa4c5a6b928b6125c,0x2809a843a0562903,0x290ea271a7c22870,0x14c528a8a716a425,0xa59f28f69fe6a835,0xa8359fe628f6a59f,0xa454a6a628d49c5d,0x28bba716a390290f,0x2909a2a1a74b28b6,0xa11c28fba5c9a51e,0xa60728f9a14da7a1,0xa67fa425290fa4af
.quad 0xa3bfa69228eba0b9,0x290ba54aa54a290b,0x2901a2d1a6cc28e8,0xa534290ea454a607,0xa66b28fba2a1a6b9,0xa40ea61c2903a360,0xa2d1a67f28fda331,0x28f4a271a6a628f9,0x28f6a301a6442906,0xa76e28dfa17ea6de,0xa6cc28fda3eea5b4,0x9d27a7c228d4a14d,0xa1e0a66b2909a4c5,0x28769befa7d328d7,0x28e8a331a5b4290f,0xa88828709c5da7a1
.quad 0xa81828182241a90f,0xa818a241290fa241,0x198fa8e225b42607,0x28fda4dca6cc28a8,0x274b240ea90d21e0,0xa5c928e59befa88d,0xa90824af26a6a8c4,0x9f82a84a2810214d,0x259fa8f61fe62835,0x28351fe6a8f6259f,0x21af27c2a88897f2,0xa8f425de2534a905,0xa8a3125c288da7d3,0x2575a90321e02790,0x2888a801a02528e8,0x208827e3a8930e5c
.quad 0xa0b928eba692a3bf,0xa8509a5a28ada7b2,0xa607a454290ea534,0x28e8a6cca2d12901,0x290da46ba5c92909,0xa51e290fa4c5a575,0xa6f128eea211a6cc,0xa14da71628e8a1af,0x9cc2a7f228bf9fe6,0x286a965ba8352898,0x283c0e5ca84a2893,0xa8db27a11df0a89e,0xa8d727d31befa876,0x24c5a909266b21e0,0x23eea8f4275d1df0,0x22112630a90e255f
.quad 0x2241a90f22412818,0x290fa241a8182818,0x23ee277fa8709eb9,0xa810282e214da90c,0xa88d9bef28e5a5c9,0x21e0a90d240e274b,0x28e2a607a55f28f9,0x22d127a1a87c9c5d,0xa59f28f69fe6a835,0xa8359fe628f6a59f,0x9d27a857281f2025,0x290ea481a67f28db,0x279021e0a9032575,0xa7d3288d125ca8a3,0xa90f24542658a8ee,0x20eba8f426302481
.quad 0x27b2a8ad1a5a2850,0x23bf2692a8eb20b9,0x9df028c4a77fa0eb,0xa85797f22893a810,0xa575a4c5290fa51e,0x2909a5c9a46b290d,0x28dba0eba73a28e2,0xa77f28d4a088a75d,0xa8982835165ba86a,0x1fe6a8bf27f21cc2,0x2425a90126a621af,0x2454255fa90f258a,0x21e0266ba90924c5,0xa8761bef27d3a8d7,0xa84a17f22801a8d4,0x2901a6f1a02528a8
.quad 0x22412818a818a241,0xa81828182241a90f,0xa7c2a331290fa211,0x2481a90520252857,0x2903a056a8432809,0x125c28b6a6b9a4c5,0xa89e273a23eea90f,0xa4dca67f28cc97f2,0x259fa8f61fe62835,0x28351fe6a8f6259f,0x94c528b1a73aa331,0xa908221127a1a893,0xa51ea5c928fba11c,0x28b6a74ba2a12909,0x287c14c5a89e27c2,0xa6a628e29f82a810
.quad 0xa90b254a254aa90b,0x20b9a8eb269223bf,0x2810a89317f22857,0x20eb277fa8c41df0,0xa3602903a61ca40e,0xa6b9a2a128fba66b,0x9f82a7a128cca025,0x28bb9eb9a7c228c4,0x26de217ea8df276e,0xa90626442301a8f6,0xa8e22211267fa905,0x282ea8a81eb9277f,0x28d7a7d39bef2876,0xa4c52909a66ba1e0,0xa6a62908a4dca481,0xe5ca82e28bba0eb
.quad 0xa818a241290fa241,0x2241a90f22412818,0x28ee9c5da8932716,0xe5c28c4a658a55f,0xa8fb251e266ba8c8,0xa2a1a7d3285d1f1e,0x283ca81fa0eb2905,0x26302534a8fd2025,0xa59f28f69fe6a835,0xa8359fe628f6a59f,0x1f82a8ee26072508,0x28e29df0a84a282e,0x20562809a87698c4,0xa90d24c5261ca8f1,0xa5dea4dc290ea3ee,0x28b1a77fa1af28fd
.quad 0x28501a5aa8ad27b2,0xa7b228ad9a5aa850,0xa90122d126cca8e8,0x2534a90e24542607,0x28e5a703a1e028f1,0xa05628d7a74ba11c,0xa80128b19df0a7e3,0x9c5da81028a89d27,0x24f2a90e259f243d,0x243d259fa90e24f2,0x9c5d2888a85714c5,0xa6f1a0eb28cca7e3,0xa1e0a66b2909a4c5,0x28769befa7d328d7,0x267f214da8c4281f,0xa8fd24542508a90a
.quad 0x290fa241a8182818,0x22412818a818a241,0xa8e8258a2630a8cc,0xa4afa6f1289e1b25,0x2876a790a360290f,0x261c2575a8f11d8c,0xa77f28881b25a8db,0xa75da390290fa331,0x259fa8f61fe62835,0x28351fe6a8f6259f,0xa2d1290ca4afa658,0xa89e8e5c28a8a75d,0x1befa8c827032360,0x28e59f1ea827285d,0x1df0282ea864998f,0xa90a233126f1a8d4
.quad 0xa3bfa69228eba0b9,0x290ba54aa54a290b,0x26072454a90e2534,0xa8e826cc22d1a901,0xa7d39f1e28c8a790,0x28a3a8099d8c28b6,0x28939b25a81f289e,0xa83c2888998fa82e,0xa8f623012644a906,0x276ea8df217e26de,0x290ea5dea39028f9,0xa630290aa4afa508,0xa8d727d31befa876,0x24c5a909266b21e0,0x2857a89e1f822716,0xa27128dba7e3998f
.quad 0xa81828182241a90f,0xa818a241290fa241,0x27a1a8649f822901,0x281f21afa90e2390,0xa70328a318c4a8d7,0xa827a11c2909a46b,0x2658a8d4198f2893,0x282e2088a9012508,0xa59f28f69fe6a835,0xa8359fe628f6a59f,0x24dca90a2271277f,0x283c1eb9a8e82630,0xa40e290fa46ba66b,0xa8439d8c28d7a6b9,0x2271a905258a2534,0x284a1c5da8c4273a
.quad 0xa0b928eba692a3bf,0xa8509a5a28ada7b2,0x1df0a8c4277f20eb,0x285717f2a8932810,0x98c4288da8279bef,0xa85d925c2876a843,0x94c5a84a287c97f2,0x28648e5ca8572870,0x1cc227f2a8bf1fe6,0xa86a165b2835a898,0xa025a73a28eea2d1,0x2870998fa81028bb,0x21e0266ba90924c5,0xa8761bef27d3a8d7,0xa390a58a290fa607,0x287c9d27a77f28ee
.quad 0x28d0a241a5f3290f,0xa8d028188000a818,0x28b6a17ea61c290f,0xa8fb276e1befa850,0x2898a0b9a644290f,0xa90e26921fe6a882,0x28769fe6a66b290f,0xa909259f21e0a8ad,0x28509e55a692290f,0xa8eb249823bfa8d0,0x28279cc2a6b9290f,0xa8b6230124c5a8eb,0x27f29a5aa6de290f,0xa86a20b9259fa8ff,0x2790965ba703290f,0xa8091cc2266ba90b
.quad 0x27288000a728290f,0xa72800002728a90f,0x26b9165ba74b290f,0xa61c9cc227d3a90b,0x26441a5aa76e290f,0xa4f2a0b92835a8ff,0x25c91cc2a790290f,0xa360a3012876a8eb,0x254a1e55a7b2290f,0xa0b9a49828ada8d0,0x24c51fe6a7d3290f,0x9befa59f28d7a8ad,0x243d20b9a7f2290f,0x165ba69228f6a882,0x2360217ea809290f,0x1f1ea76e2909a850
.quad 0x25f3a90f25f32241,0x2818a8d02241,0x2790a8f6246b2498,0xa1e028bfa8431a5a,0x286aa8ad217e25f3,0xa59f290ba6de9e55,0x28d7a8351bef2728,0xa7d328f6a4c5a3bf,0x290ba7289a5a2818,0xa8ad2882a0b9a5f3,0x2903a59fa11c2882,0xa909276e125ca7b2,0x28bfa3bfa43d28d0,0xa8f6254a217ea882,0x28439fe6a5c928ff,0xa876217e251ea8eb
.quad 0x27288000a728290f,0xa72800002728a90f,0x25751fe6a82728ff,0xa4c5a17e285da8eb,0x230123bfa89828d0,0x9fe6a54a28dfa882,0x1d8c259fa8e52882,0x1befa76e290fa7b2,0x9a5a2728a90b2818,0x23bfa88228eba5f3,0xa1e02835a9092728,0x266ba8f62876a3bf,0xa4f228ada8df25f3,0x2835a90b276e9e55,0xa6b928f6a88d2498,0x28d7a8bf25751a5a
.quad 0xa5f3a24128d0a818,0x28d0a241a5f3290f,0xa11ca644290fa5f3,0x274b1cc2a85d28ad,0x1cc2a85028bfa241,0x2301254aa9062728,0x24c5a8f627d38000,0x9bef2835a8d723bf,0x27b2a8ff254a2241,0xa54a28ffa7b20000,0x28c8a86a205625f3,0xa84328dfa46ba3bf,0x290ea6929cc22818,0xa90627b2965ba728,0x28a3a301a46b28d0,0xa8c8243d2360a8ad
.quad 0x27288000a728290f,0xa72800002728a90f,0x240e2301a88d28d0,0xa2a1a43d28b6a8ad,0x165b2692a9062818,0x1cc2a7b2290ea728,0xa2a1286aa8f125f3,0x2575a8df288da3bf,0xa69228ffa8502241,0x2850a8ff26928000,0xa87628f6a66b0000,0x2909a83521e023bf,0xa9062850a301a241,0x28bfa54a9cc22728,0xa8e52644925ca5f3,0x27039cc2a51e28ad
.quad 0xa8d028188000a818,0x25f3a90f25f32241,0xa8f1243d24c5a8ff,0x28c8a83518c427b2,0xa76e9a5a2835a8d0,0x28dfa3bfa4f228ff,0xa1e0a59f2909a728,0x266b1fe6a87628ad,0x20b9a88228ada241,0x1a5a2728a90b25f3,0x2703a90e266b1e55,0xa51e28f6a8091a5a,0x28dfa8501fe625f3,0xa89828ada301a498,0x28e5a4f2a1e02882,0xa8fb259f2056a850
.quad 0x27288000a728290f,0xa72800002728a90f,0x211c24f2a8d72882,0x9f1ea59f28f1a850,0xa17e2850a8f625f3,0x243da8ad28bfa498,0xa74b290ea7d31e55,0x285da8f6261c1a5a,0xa8eb2882a3bfa241,0x290ba7281a5a25f3,0xa8d7259f1befa728,0x27d39fe6a4c528ad,0xa6de1a5a259fa8d0,0x217e23bfa86a28ff,0xa056a43d2876a8ff,0xa2a12835a90d27b2
.quad 0x2818a8d02241,0xa5f3a24128d0a818,0xa66b290ea5c9a241,0x1d8ca86a28a3a0b9,0xa8f627b2165ba818,0x27f2a8eb243d2498,0xa8761fe6266ba90f,0x2909a59fa1e028ad,0xa3bfa49828eba818,0x26921e55a85028d0,0x21e0a89828a3a241,0x98c427f2a8fb254a,0x2835a8eb24f22241,0xa76e290ba6449e55,0x2909a6449d8c2818,0xa90f26de18c4a7b2
.quad 0x27288000a728290f,0xa72800002728a90f,0x1bef2644a9032818,0x925ca6de290da7b2,0xa59f28eba86a2241,0x26dea90b27f29e55,0xa8d72898a40ea241,0x290da7f21f1e254a,0xa8ad249820b9a818,0x27b29e55a54a28d0,0xa4c59fe627d3a90f,0x1bef259fa8d728ad,0x1fe6a7b2290ea818,0xa64428eba8982498,0x27d3a90e2827a241,0xa903286aa40ea0b9
.quad 0x28d0a241a5f3290f,0xa8d028188000a818,0x240e24f2a9032728,0xa827165b27d3a8eb,0xa43d28eba7f20000,0x965ba7b228f6a498,0xa8d728359befa728,0x27d3a8f624c523bf,0xa8501e552692a90f,0x28eba498a3bf28d0,0x9f1ea644290da728,0x240e243da8d72850,0x2644a90b276e8000,0xa4f228eba8351e55,0x290da76e125c2728,0xa90327f29befa692
.quad 0x27288000a728290f,0xa72800002728a90f,0x98c4276ea90f2728,0x1d8ca7f22909a692,0xa7f2290ba6de0000,0x286aa8eb259f1e55,0xa8fb264418c4a728,0x28a3a43da1e02850,0xa54a9e5527b2a90f,0x20b92498a8ad28d0,0x21e0a8352909a728,0xa66b28f6a87623bf,0x2898a8eb26448000,0xa90e27b29fe6a498,0x28a3a4f29d8c2728,0xa5c9965b266ba8eb
.quad 0x25f3a90f25f32241,0x2818a8d02241,0x290da59fa2a128d0,0xa8762898a056a692,0x24f223bfa8df2818,0xa8351a5a276ea8ff,0xa4c528f6a7d30000,0x1befa83528d7a3bf,0xa90b27281a5aa818,0x28ada88220b925f3,0xa61c9fe6285da8d0,0x27d3965ba74b290b,0x2301a8ad2898a241,0x9fe62850a8df2498,0x28f1a8351f1e25f3,0xa8d7286aa11ca54a
.quad 0x27288000a728290f,0xa72800002728a90f,0xa0562835a8fb25f3,0x21e0a86a28e5a54a,0xa8bf28ada43da241,0x28f6a850217e2498,0xa8091fe6251ea8d0,0x266b165ba703290b,0x1a5aa728290ba818,0xa3bf2882a8eb25f3,0x2876a8f6266b8000,0xa9092835a1e0a3bf,0x286aa3bfa17e2818,0xa59f9a5a26dea8ff,0x18c4259fa8c828d0,0x24c5a89828f1a692
.quad 0xa5f3a24128d0a818,0x28d0a241a5f3290f,0x251ea90627031e55,0x125c27f2a8e523bf,0x2906a54aa30128d0,0xa8bf28509cc2a728,0x21e0259fa9092728,0xa66b9fe62876a8ad,0xa7b228ffa54aa241,0x254aa8ff27b28000,0xa88d217e2575a8ff,0x28f1a4f2a2a128ad,0x165ba7b22906a5f3,0x1cc22692a90e2728,0x28b6a89822a12498,0xa88d28bfa40ea3bf
.quad 0x27288000a728290f,0xa72800002728a90f,0xa3602898a8c82498,0x246ba8bf28a3a3bf,0xa90e27b29cc2a5f3,0x2906a692965b2728,0xa46ba17e2843a8ff,0x205624f2a8c828ad,0x2692a8ff2850a241,0xa85028ffa6920000,0x28d7a59f9bef2728,0xa7d31fe624c5a8ad,0x1cc2254aa8bf28d0,0x2301a8502906a728,0xa85d2906a74b1e55,0x290fa7f2211c23bf
.quad 0xa8d028188000a818,0x25f3a90f25f32241,0xa575a30128d7a818,0x288d9fe6a6b9290b,0x26dea90b259f2241,0xa17e28ada86a1e55,0x28769fe6a66b290f,0xa909259f21e0a8ad,0xa0b92882a8ad2241,0x9a5aa728290ba5f3,0xa90f26de1befa818,0x28e5a8351d8c2692,0xa17ea54a28f6a818,0x243d23bfa8bf2882,0x285da8df24c52241,0xa82728f6a575a0b9
.quad 0x27288000a728290f,0xa72800002728a90f,0xa51e28dfa8762241,0x25c9a8f62843a0b9,0xa8df254a1fe6a818,0x2898a3bfa3012882,0x125ca6de2909a818,0xa11c2835a9032692,0x28eba88223bf2241,0xa90b27289a5aa5f3,0x24c51fe6a7d3290f,0x9befa59f28d7a8ad,0xa76e290ba8352241,0x28dfa8ad24f21e55,0xa843230121e0a818,0x246b1fe6a790290b
.quad 0x2818a8d02241,0xa5f3a24128d0a818,0xa90926de1f1ea882,0x2809a8df2360254a,0x9fe6a692290ea5f3,0x264420b9a8982882,0x28d7a8351bef2728,0xa7d328f6a4c5a3bf,0x23bf2498a8eb2818,0xa6929e552850a8d0,0xa87628bfa360a498,0x2790a90625c920b9,0xa59fa0b9286aa8d0,0x26de1a5aa7f228ff,0x27d3a906261c1e55,0xa74b290ea6b99a5a
.quad 0x27288000a728290f,0xa72800002728a90f,0xa66b2906a8091e55,0x2703a90e27909a5a,0xa83520b924f2a8d0,0x276e9a5aa64428ff,0x24c5a8bf28b6a498,0xa6b92906a82720b9,0x28ada498a0b92818,0xa7b21e55254aa8d0,0xa1e02835a9092728,0x266ba8f62876a3bf,0xa8f62692965ba5f3,0x27f2a0b9a43d2882,0x1befa6de28fba882,0xa61c28dfa8b6254a
.quad 0x28d0a241a5f3290f,0xa8d028188000a818,0xa36028dfa8090000,0x9f1ea6de2909a54a,0xa89820b92644a90f,0x290ea6929fe62882,0x24c5a8f627d38000,0x9bef2835a8d723bf,0x28509e55a692290f,0xa8eb249823bfa8d0,0xa5c92906a7900000,0x2360a8bf2876a0b9,0xa7f21a5a26dea90f,0x286aa0b9a59f28ff,0x26b9a90e274b8000,0xa61c2906a7d31a5a
.quad 0x27288000a728290f,0xa72800002728a90f,0xa790290ea7030000,0x2809a906266b1a5a,0xa6449a5a276ea90f,0x24f220b9a83528ff,0x2827a90626b98000,0xa8b628bfa4c5a0b9,0x254a1e55a7b2290f,0xa0b9a49828ada8d0,0xa87628f6a66b0000,0x2909a83521e023bf,0xa43da0b927f2a90f,0x965b2692a8f62882,0x28b6a8df261c8000,0xa8fb26de9befa54a
.quad 0x25f3a90f25f32241,0x2818a8d02241,0x26b91fe6a88d2882,0xa8d723012575a90b,0xa86a28ada17ea5f3,0x259fa90b26de1e55,0xa1e0a59f2909a728,0x266b1fe6a87628ad,0x290ba7289a5a2818,0xa8ad2882a0b9a5f3,0x9d8c2835a8e52498,0x9befa6de290fa692,0xa8bf23bf243da8d0,0x28f6a54aa17e2882,0x2575a8f628279e55,0xa4c528dfa85d20b9
.quad 0x27288000a728290f,0xa72800002728a90f,0xa84328f6a5c99e55,0x2876a8df251e20b9,0xa301a3bf2898a8d0,0x1fe6254aa8df2882,0x2903a835211c2498,0xa90926de925ca692,0x9a5a2728a90b2818,0x23bfa88228eba5f3,0xa8d7259f1befa728,0x27d39fe6a4c528ad,0x24f2a8ad28dfa5f3,0xa835290ba76e1e55,0x27909fe6a46b2882,0xa1e0a3012843a90b
.quad 0xa5f3a24128d0a818,0x28d0a241a5f3290f,0x28e5a7f2925c2818,0xa7032906a51ea3bf,0x9cc22850a8bf2241,0xa301a54a2906a728,0xa8761fe6266ba90f,0x2909a59fa1e028ad,0x27b2a8ff254a2241,0xa54a28ffa7b20000,0x22a124f2a8f12818,0xa575a17e288da8ad,0xa90e26921cc2a818,0x2906a7b2165b2728,0x240ea8bf288da241,0xa2a12898a8b623bf
.quad 0x27288000a728290f,0xa72800002728a90f,0xa8a328bfa46ba241,0x28c8a898236023bf,0x965ba6922906a818,0x9cc227b2a90e2728,0x28c8a4f2a0562818,0xa843217e246ba8ad,0xa69228ffa8502241,0x2850a8ff26928000,0xa4c59fe627d3a90f,0x1bef259fa8d728ad,0x2906a85023012241,0xa8bf254a1cc2a728,0xa11c27f2a90f2818,0x274ba906285da3bf
.quad 0xa8d028188000a818,0x25f3a90f25f32241,0x2056a89828769e55,0x22a1259fa90d2692,0x276e1a5aa83528d0,0xa8df23bf24f2a8ff,0xa8d728359befa728,0x27d3a8f624c523bf,0x20b9a88228ada241,0x1a5a2728a90b25f3,0x274b165ba7d328ff,0xa85d1fe6261ca90b,0xa8df28509fe6a5f3,0x2898a8ad23012498,0x211ca86a28d7a498,0x9f1e2835a8f1254a
.quad 0x27288000a728290f,0xa72800002728a90f,0xa8e5286aa1e0a498,0x28fba8352056254a,0x217ea85028f6a5f3,0xa43d28ada8bf2498,0x2703965ba66b28ff,0xa51e9fe62809a90b,0xa8eb2882a3bfa241,0x290ba7281a5a25f3,0x21e0a8352909a728,0xa66b28f6a87623bf,0x26de9a5aa59f28d0,0xa17ea3bf286aa8ff,0xa8f12898a4c59e55,0x28c8a59f98c42692
.quad 0x2818a8d02241,0xa5f3a24128d0a818,0xa7d3965b2827a8d0,0x2903a4f2a40e28eb,0x28f6a7b2965b2818,0xa7f228eba43da498,0xa4c528f6a7d30000,0x1befa83528d7a3bf,0xa3bfa49828eba818,0x26921e55a85028d0,0x28d7a43da40e28d0,0xa90d26441f1ea850,0xa83528eba4f2a241,0x276ea90b26441e55,0x1befa7f22903a5f3,0x925c276ea90d2692
.quad 0x27288000a728290f,0xa72800002728a90f,0xa90927f29d8ca5f3,0x290fa76e18c42692,0x259fa8eb286aa241,0xa6de290ba7f21e55,0x21e0243da8a328d0,0x98c4a64428fba850,0xa8ad249820b9a818,0x27b29e55a54a28d0,0x2876a8f6266b8000,0xa9092835a1e0a3bf,0x9fe627b2a90e2818,0x2644a8eb2898a498,0xa66b165b25c9a8d0,0x1d8c24f2a8a328eb
.quad 0x28d0a241a5f3290f,0xa8d028188000a818,0xa8a3286a9d8ca728,0x25c9a90e266b20b9,0x243da8eb27f28000,0x165b27b2a8f62498,0x21e0259fa9092728,0xa66b9fe62876a8ad,0xa8501e552692a90f,0x28eba498a3bf28d0,0x28fba7f218c42728,0xa8a32898a1e0a54a,0xa644290ba76e0000,0x24f2a8eb28359e55,0x98c4a6de290fa728,0x1d8c2644a90927b2
.quad 0x27288000a728290f,0xa72800002728a90f,0xa90d26de125ca728,0x2903a6449bef27b2,0x27f2a90b26de8000,0xa86a28eba59f9e55,0x9f1e27f2a90d2728,0x240ea89828d7a54a,0xa54a9e5527b2a90f,0x20b92498a8ad28d0,0x28d7a59f9bef2728,0xa7d31fe624c5a8ad,0xa89828eba6440000,0x290ea7b21fe62498,0x240ea86a2903a728,0xa827290ea7d320b9
.quad 0x25f3a90f25f32241,0x2818a8d02241,0x98c42835a8c82241,0xa4c5a43d28f1a7b2,0xa4f2a3bf28dfa818,0x28359a5aa76e28ff,0x28769fe6a66b290f,0xa909259f21e0a8ad,0xa90b27281a5aa818,0x28ada88220b925f3,0x2809a8f6251e2241,0xa66b290ea7039a5a,0xa30128ada8982241,0x1fe6a85028dfa498,0xa056a59f28fba818,0x21e024f2a8e52850
.quad 0x27288000a728290f,0xa72800002728a90f,0xa8f1259f1f1ea818,0x28d7a4f2a11c2850,0x28bfa8ad243d2241,0xa8f62850a17ea498,0xa61c28f6a85d2241,0x27d3a90e274b9a5a,0x1a5aa728290ba818,0xa3bf2882a8eb25f3,0x24c51fe6a7d3290f,0x9befa59f28d7a8ad,0xa86a23bf217ea818,0x259f1a5aa6de28ff,0x290da83522a12241,0xa876243d2056a7b2
.quad 0xa5f3a24128d0a818,0x28d0a241a5f3290f,0x285d9cc2a74b28ff,0xa90f2644211ca8ad,0xa906254a2301a8d0,0x28bfa8501cc22728,0x28d7a8351bef2728,0xa7d328f6a4c5a3bf,0xa7b228ffa54aa241,0x254aa8ff27b28000,0x246ba8df28439e55,0xa056286aa8c823bf,0x965b27b2a90625f3,0x9cc2a692290ea728,0xa360a43d28c8a882,0x246b2301a8a328ad
.quad 0x27288000a728290f,0xa72800002728a90f,0xa8b6243d22a1a882,0x288da301a40e28ad,0x290ea7b21cc225f3,0xa9062692165ba728,0xa88d28dfa5759e55,0x28f1a86a22a123bf,0x2692a8ff2850a241,0xa85028ffa6920000,0xa1e02835a9092728,0x266ba8f62876a3bf,0x9cc2a54a28bfa8d0,0xa3012850a9062728,0x251e1cc2a70328ff,0x125ca64428e5a8ad
.quad 0xa8d028188000a818,0x25f3a90f25f32241,0x2843a8bf21e025f3,0xa46b28f6a7909a5a,0xa6de290ba59fa241,0x217ea8ad286a9e55,0x24c5a8f627d38000,0x9bef2835a8d723bf,0xa0b92882a8ad2241,0x9a5aa728290ba5f3,0x925ca76e2909a5f3,0x211c259fa90327b2,0x217e254aa8f62818,0xa43da3bf28bfa882,0xa51ea17e2876a8d0,0x25c91fe6a84328eb
.quad 0x27288000a728290f,0xa72800002728a90f,0xa85d217e24c5a8d0,0x28279fe6a57528eb,0x28dfa54a9fe62818,0xa89823bf2301a882,0xa90f276e9befa5f3,0x28e5a59f9d8c27b2,0x28eba88223bf2241,0xa90b27289a5aa5f3,0xa87628f6a66b0000,0x2909a83521e023bf,0x276ea90b2835a241,0xa8df28ada4f29e55,0xa57528bfa8d725f3,0x288da8f626b99a5a
.quad 0x2818a8d02241,0xa5f3a24128d0a818,0x9befa76e28fba498,0x261c217ea8b62850,0x1fe62692a90e25f3,0xa644a0b92898a882,0xa1e0a59f2909a728,0x266b1fe6a87628ad,0x23bf2498a8eb2818,0xa6929e552850a8d0,0xa4c5a30128b6a882,0x26b91cc2a82728eb,0x259f20b9a86a28d0,0xa6de9a5a27f2a8ff,0xa66b9cc22809a8ff,0x2703165ba790290b
.quad 0x27288000a728290f,0xa72800002728a90f,0xa7d31cc2261ca8ff,0x274b965ba6b9290b,0x2835a0b9a4f228d0,0xa76e1a5a2644a8ff,0xa87623012360a882,0x27909cc2a5c928eb,0x28ada498a0b92818,0xa7b21e55254aa8d0,0xa8d7259f1befa728,0x27d39fe6a4c528ad,0x28f6a692165b25f3,0xa7f220b9243da882,0xa909276e9f1ea498,0x2809a17ea3602850
.quad 0x290f,0x0,0xa90f,0x0,0x290f,0x0,0xa90f,0x0,0x290f,0x0,0xa90f,0x0,0x290f,0x0,0xa90f,0x0
.quad 0x290f,0x0,0xa90f,0x0,0x290f,0x0,0xa90f,0x0,0x290f,0x0,0xa90f,0x0,0x290f,0x0,0xa90f
.zero 776
.quad 0x1e552728a8ff2498,0xa7289e552882a882,0x1b25277fa8f92481,0xa607a1af28bba84a,0x125c27d3a8f1246b,0xa4c5a40e28e5a809,0x97f22810a8e82454,0xa2d1a5342901a77f,0x9cc22835a8df243d,0x9fe6a644290ea6de,0x9f822857a8d42425,0x97f2a73a290ca630,0xa11c2876a8c8240e,0x1befa80928fba575,0xa2712893a8bb23ee,0x20eba86428dba4af
.quad 0xa3bf28ada8ad23bf,0x23bfa8ad28ada3bf,0xa48128c4a89e2390,0x2534a8e22870a211,0xa51e28d7a88d2360,0x266ba9032827a056,0xa5b428e8a87c2331,0x277fa90f27a19d27,0xa64428f6a86a2301,0x2835a90626de965b,0xa6cc2901a85722d1,0x2893a8e8260717f2,0xa74b2909a84322a1,0x28d7a8b6251e1d8c,0xa7c2290ea82e2271,0x2901a87024252088
.quad 0x28ffa498a49828ff,0xa88228829e55a728,0x28b1a14da630290f,0xa8fd275d1c5da857,0x282798c4a79028fb,0xa903251e2360a8d7,0x26cc1df0a85728c4,0xa89320eb2607a90e,0x24f22301a8bf286a,0xa76e965b27f2a8f6,0x21af255fa8fd27e3,0xa508a27128a8a893,0x18c42703a90f26b9,0xa056a5c92903a7d3,0x9eb9282ea8f4255f,0x1b25a7e32905a607
.quad 0xa3bf28ada8ad23bf,0x23bfa8ad28ada3bf,0xa5de28f9a83c2088,0x267fa90828019df0,0xa790290fa74b18c4,0x2843a8fb261c1bef,0xa87028eea5de9c5d,0x28e2a888239022d1,0xa8df2898a43da17e,0x290ea76e1cc2259f,0xa90e2810a0eba454,0x28c4a5349df0277f,0xa8fb26b998c4a5c9,0x2809a11ca40e2876,0xa8a825081d27a716,0x25de14c5a65828e8
.quad 0x2498a8ff27281e55,0x1e552728a8ff2498,0x27a1a8f4245424af,0xa21128c4a83c198f,0x28c8a8431bef274b,0xa7032909a575a2a1,0x290ea607a0eb2893,0xa8c428579df0a6cc,0x2898a17ea59f2906,0xa906259f217ea898,0x26f11b25a81028f4,0xa83c1df0267fa90f,0x2360246ba8d7285d,0xa51ea1e0288da8b6,0x8e5c275da90e26a6,0x998fa6cc290fa73a
.quad 0xa3bf28ada8ad23bf,0x23bfa8ad28ada3bf,0xa716290fa77f198f,0x27a1a90e26f10e5c,0xa8a328c8a4c5a11c,0x28e5a87622a1240e,0xa90f27c29df0a58a,0x28f4a6079b25275d,0xa8bf24f21fe6a7f2,0x27f29fe6a4f228bf,0xa77f1df02534a8c4,0x245420eba810290e,0xa46ba05627d3a90f,0x925c266ba8f1288d,0x998fa58a28c4a8d4,0xa4af2893a8f426a6
.quad 0xa7289e552882a882,0x28ffa498a49828ff,0xa0eba658290fa5de,0x273a1d27a86428a8,0x21e0a8b6285d9d8c,0x1f1e26b9a90d25c9,0x277fa901253422d1,0xa45428e8a81017f2,0x28f6a7f2165b276e,0xa86a28bfa301a4f2,0x28c4a390a48128e2,0xa90825de2088a870,0x266b1d8ca82728f1,0xa790125c274ba90d,0x1df02630a90827c2,0xa088a58a28f9a81f
.quad 0xa3bf28ada8ad23bf,0x23bfa8ad28ada3bf,0xa8102905a6589b25,0x284aa8f425b41eb9,0xa90928099f1ea575,0x290da703125c26b9,0xa89323ee2271a864,0x27e39eb9a55f28db,0xa59f9cc2276ea90e,0x217e243da89828df,0x97f2a60728e8a893,0xa2d12857a90126cc,0x24c5a8a328e5a61c,0xa827290da7901f1e,0x2857a908275d9eb9,0xa90f2801a14da390
.quad 0xa88228829e55a728,0x2498a8ff27281e55,0xa8ee242524dca901,0x28cca82e17f227c2,0xa61ca11c28a3a876,0x288da056a66b290f,0x17f2a81028e8a454,0x22d12534a901277f,0x26dea90e26441fe6,0xa43d28dfa8351cc2,0x2905a7a10e5c277f,0xa8bb287ca0eba5b4,0x28439f1ea61c2909,0xa8a322a124c5a8e5,0x221124dca8e22857,0xa390a42528c4a888
.quad 0xa3bf28ada8ad23bf,0x23bfa8ad28ada3bf,0xa87c28dba508a0eb,0x28a8a8bb24542271,0xa8f125c91d8ca7d3,0x28b6a46ba1e0285d,0xa630998f273aa90e,0x24252211a85728f9,0x165ba6de2906a835,0xa301286aa8f62644,0x26cca9012857a2d1,0xa89328e8a60797f2,0x2903a85d236021e0,0xa8c825751befa703,0x284aa331a1af2810,0xa4819f82277fa90a
.quad 0x1e552728a8ff2498,0xa7289e552882a882,0xa67f290ea5b4a271,0x1df0a870289ea088,0xa90f266b2056a88d,0x2876a8a3211c261c,0xa6cc9df02857a8c4,0x2893a0eba607290e,0x1cc2a83528dfa43d,0x1fe62644a90e26de,0x282ea8e824af2331,0xa6cc290fa6a69d27,0x28e5a4c5a2a128a3,0xa909261c1f1ea843,0x248122d1a89e28b1,0xa534a14d2870a8d4
.quad 0xa3bf28ada8ad23bf,0x23bfa8ad28ada3bf,0xa8cc2893a331a3ee,0x28e8a86421af24af,0xa85d21e0246ba8b6,0x27d39d8ca5c928f1,0x9f82a53428d4a89e,0x97f22716a90c2801,0x2644a8f6286aa301,0xa8352906a6de165b,0x290ea81020eb2454,0xa8c425341df0a77f,0x27039befa57528c8,0xa1e0a360285da903,0x9b2526cca8f92888,0x2607a8db28bba55f
.quad 0x28ffa498a49828ff,0xa88228829e55a728,0x23ee2508a9052716,0xa81f14c527e3a8e8,0xa5c9290da6b99f1e,0x1d8ca85d28b6a1e0,0xa90e260720eba893,0x28c4a8571df026cc,0xa4f2a30128bfa86a,0x276e165ba7f228f6,0x24dca8ee281f9c5d,0xa14d2888a8b122d1,0x290da74b925c2790,0xa8f128279d8ca66b,0x25de1f82a83c28ee,0xa67f9c5d2801a901
.quad 0xa3bf28ada8ad23bf,0x23bfa8ad28ada3bf,0xa8fd282ea025a55f,0x290aa7e31d272607,0xa6b9925c2703a90d,0x25751f1ea8092909,0x21afa84a28fda658,0xa50828cca8a82454,0x28dfa898243d217e,0xa90e276e9cc2a59f,0x277f9df0a53428c4,0xa454a0eb2810a90e,0x9f1e2790a90d2827,0x261ca8e528a3a4c5,0xa8b128e2a6300e5c,0x28fda6f11c5d2534
.quad 0x2498a8ff27281e55,0x1e552728a8ff2498,0x290ca58aa2d128d4,0xa87c2893a025a6a6,0x22a12575a9092703,0xa74b9bef2843a8c8,0xa77f2901a534a2d1,0x2454a8e8281097f2,0xa898217e259fa906,0x2906a59fa17e2898,0x14c5a7c22901a58a,0x20252607a90a275d,0x28b6a88d21e0251e,0xa85d28d7a46ba360,0x271614c5a77f290c,0xa7a117f226f1a90f
.quad 0xa3bf28ada8ad23bf,0x23bfa8ad28ada3bf,0xa90f275d97f2a6a6,0x290ca6cc94c5273a,0xa40ea2a12876a8e5,0x211c24c5a8c828a3,0x26f1a90a2810a025,0xa83c2901a67f94c5,0x28bfa4f29fe627f2,0xa7f21fe624f2a8bf,0x17f22607a8e82893,0x22d1a8572901a6cc,0xa88d28f1a66b125c,0x290fa7d32056246b,0xa7a120252454a87c,0x221122d1a83c290c
.quad 0xa7289e552882a882,0x28ffa498a49828ff,0x2534a90826f11eb9,0xe5c2801a8e22390,0x28d7a360a51e2903,0xa8fb279018c4a827,0x97f22810a8e82454,0xa2d1a5342901a77f,0xa8f627f2965ba76e,0x286aa8bf230124f2,0xa454a3ee28cca864,0x26581eb9a84a28db,0x27d3a90325c92056,0xa6b9290fa70398c4,0x28109d27a658290a,0xa84a202525b4a8fd
.quad 0xa3bf28ada8ad23bf,0x23bfa8ad28ada3bf,0xa90126301c5da7c2,0x28eea58a9f82281f,0x9befa61c28fba843,0x98c4274ba90f2790,0x28c4a8b12481214d,0xa908281fa088a4dc,0x259f1cc2a76e290e,0xa17ea43d2898a8df,0xa6cc2901a85722d1,0x2893a8e8260717f2,0xa876240e211ca809,0x25c918c4a6b928fb,0x20eba7e3290fa81f,0xa73a2905a86423ee
.quad 0xa88228829e55a728,0x2498a8ff27281e55,0xa55fa33128dba810,0x28889f82a6cc290a,0x2809a8e5240e24c5,0xa46b28f1a7d3925c,0x26cc1df0a85728c4,0xa89320eb2607a90e,0xa6de290ea6449fe6,0x243da8df28359cc2,0xa801198f2716a90e,0x289ea211a53428f9,0x2575a8fb28099bef,0xa40e28c8a876211c,0x287ca1afa50828e8,0xa8a823312454a8cc
.quad 0xa3bf28ada8ad23bf,0x23bfa8ad28ada3bf,0xa8d424dc214da857,0x28b1a425a2d12888,0x2056a8272903a66b,0xa360288da8d7251e,0x2905a6a68e5c26cc,0xa8bb24af20eba82e,0x965b26dea9062835,0x2301a86a28f6a644,0xa90e2810a0eba454,0x28c4a5349df0277f,0x9d8ca51e28b6a8d7,0xa2a12843a909274b,0x28eea89e24dc1df0,0xa8cc25b417f2a67f
.quad 0x1e552728a8ff2498,0xa7289e552882a882,0xa90a26cc1f82a888,0x2810a8db2331255f,0x925ca7d328f1a46b,0x24c5240ea8e52809,0x290ea607a0eb2893,0xa8c428579df0a6cc,0x9cc22835a8df243d,0x9fe6a644290ea6de,0xa8f925342211a89e,0x290ea716998f2801,0x211ca87628c8a40e,0x9bef2809a8fb2575,0x28cca454a33128a8,0xa8e8250821afa87c
.quad 0xa3bf28ada8ad23bf,0x23bfa8ad28ada3bf,0xa88822d12425a8b1,0x2857a14da4dc28d4,0x251ea8d7288da360,0xa66b2903a8272056,0x282ea0eba4af28bb,0xa6cc0e5c26a6a905,0xa64428f6a86a2301,0x2835a90626de965b,0xa77f1df02534a8c4,0x245420eba810290e,0x274ba9092843a2a1,0xa8d728b6a51e9d8c,0x267f97f2a5b428cc,0x9df0a4dc289ea8ee
.quad 0x28ffa498a49828ff,0xa88228829e55a728,0xa39028e2a8018e5c,0x9eb9a6f12908a534,0xa82718c42790a8fb,0x2903a51ea36028d7,0x277fa901253422d1,0xa45428e8a81017f2,0x24f22301a8bf286a,0xa76e965b27f2a8f6,0xa8db284a9eb9a658,0x2864a8cc23ee2454,0x98c4a703290fa6b9,0x205625c9a90327d3,0x28fda5b4a025284a,0xa90a26581d27a810
.quad 0xa3bf28ada8ad23bf,0x23bfa8ad28ada3bf,0xa81f1f82258aa8ee,0x27c29c5da6302901,0x2790a90f274b98c4,0xa84328fba61c9bef,0x24dc2088a81f2908,0xa14da48128b1a8c4,0xa8df2898a43da17e,0x290ea76e1cc2259f,0x97f2a60728e8a893,0xa2d12857a90126cc,0x28fba6b918c425c9,0xa809211c240ea876,0xa3ee2864a905273a,0x281fa90f27e3a0eb
.quad 0x2498a8ff27281e55,0x1e552728a8ff2498,0x26a62025a893287c,0xa8d422d1258aa90c,0xa8c828439befa74b,0x2703a909257522a1,0x17f2a81028e8a454,0x22d12534a901277f,0x2898a17ea59f2906,0xa906259f217ea898,0xa75d290aa607a025,0x258aa90127c294c5,0xa360a46b28d7a85d,0x251e21e0a88d28b6,0x290fa6f197f227a1,0xa90c277f94c5a716
.quad 0xa3bf28ada8ad23bf,0x23bfa8ad28ada3bf,0xa73a14c526cca90c,0x26a617f2a75d290f,0x28a3a8c824c5211c,0xa8e52876a2a1a40e,0x14c5267fa901283c,0x2025a810290aa6f1,0xa8bf24f21fe6a7f2,0x27f29fe6a4f228bf,0x26cca9012857a2d1,0xa89328e8a60797f2,0x246b2056a7d3290f,0x125ca66b28f1a88d,0xa90c283ca2d1a211,0x287ca454a02527a1
.quad 0xa7289e552882a882,0x28ffa498a49828ff,0x28e8a7e394c5281f,0xa7162905a508a3ee,0xa1e028b6a85d1d8c,0x9f1ea6b9290da5c9,0xa6cc9df02857a8c4,0x2893a0eba607290e,0x28f6a7f2165b276e,0xa86a28bfa301a4f2,0xa2d128b1a888214d,0x1c5da81f28eea4dc,0xa66b9d8c2827a8f1,0x2790925ca74b290d,0x2901a8011c5d267f,0xa8ee283c9f82a5de
.quad 0xa3bf28ada8ad23bf,0x23bfa8ad28ada3bf,0xa6079d2727e3a90a,0x255f2025a82e28fd,0x2909a8091f1e2575,0xa90d2703925ca6b9,0xa45428a8a8cc2508,0x2658a8fd284aa1af,0xa59f9cc2276ea90e,0x217e243da89828df,0x290ea81020eb2454,0xa8c425341df0a77f,0xa4c528a3a8e5261c,0x2827a90d27909f1e,0xa5349c5d26f1a8fd,0x8e5c2630a8e228b1
.quad 0xa88228829e55a728,0x2498a8ff27281e55,0x2088a89e28709df0,0x227125b4a90e267f,0x261c211ca8a32876,0xa88d2056266ba90f,0xa90e260720eba893,0x28c4a8571df026cc,0x26dea90e26441fe6,0xa43d28dfa8351cc2,0x1d2726a6a90f26cc,0xa331a4af28e8a82e,0xa8431f1e261ca909,0x28a3a2a1a4c528e5,0x28d4a870214d2534,0xa8b1289ea2d1a481
.quad 0xa3bf28ada8ad23bf,0x23bfa8ad28ada3bf,0xa4afa1af2864a8e8,0x23ee2331a89328cc,0x28f1a5c99d8c27d3,0xa8b6246b21e0a85d,0xa801290ca71617f2,0x289ea8d425341f82,0x165ba6de2906a835,0xa301286aa8f62644,0x277f9df0a53428c4,0xa454a0eb2810a90e,0xa903285da360a1e0,0x28c8a5759bef2703,0x255fa8bb28dba607,0xa88828f9a6cc1b25
.quad 0x1e552728a8ff2498,0xa7289e552882a882,0xa7c297f2282ea8cc,0x2901a4dca42528ee,0x290fa66ba056288d,0xa87628a3a11ca61c,0xa77f2901a534a2d1,0x2454a8e8281097f2,0x1cc2a83528dfa43d,0x1fe62644a90e26de,0x25b420eba87c28bb,0xa77f8e5c27a1a905,0xa8e524c522a1a8a3,0x2909a61c9f1e2843,0x2888a8c424252390,0xa85728e2a4dca211
.quad 0xa3bf28ada8ad23bf,0x23bfa8ad28ada3bf,0xa271a45428bba8a8,0x20eb2508a8db287c,0x285da1e0a46b28b6,0xa7d31d8c25c9a8f1,0xa8f92857a211a425,0x290ea73a198f2630,0x2644a8f6286aa301,0xa8352906a6de165b,0x17f22607a8e82893,0x22d1a8572901a6cc,0xa7031bef2575a8c8,0x21e02360a85d2903,0x290aa77f1f822481,0xa81021af2331a84a
.quad 0x28ffa498a49828ff,0xa88228829e55a728,0xa8a828649d27a73a,0x25dea90f265820eb,0x25c9a90d26b91f1e,0x9d8c285da8b621e0,0x97f22810a8e82454,0xa2d1a5342901a77f,0xa4f2a30128bfa86a,0x276e165ba7f228f6,0x2870a088a5de2908,0xa8e224812390a8c4,0xa90d274b125ca790,0x28f1a8271d8c266b,0x281fa8f9258a2088,0xa7c22908a6309df0
.quad 0xa3bf28ada8ad23bf,0x23bfa8ad28ada3bf,0x9eb9a5b428f4a84a,0x1b252658a9052810,0x26b9125ca703290d,0xa5759f1e2809a909,0xa8db255f1eb9a7e3,0x2864a271a3ee2893,0x28dfa898243d217e,0xa90e276e9cc2a59f,0xa6cc2901a85722d1,0x2893a8e8260717f2,0x1f1ea790290da827,0xa61c28e5a8a324c5,0x2390214da801290f,0x1eb9a75d2908a857
.quad 0x2498a8ff27281e55,0x1e552728a8ff2498,0x998f283ca8c42211,0xa4afa45428f4a7a1,0xa2a1a5752909a703,0x274b1befa84328c8,0x26cc1df0a85728c4,0xa89320eb2607a90e,0xa898217e259fa906,0x2906a59fa17e2898,0x290fa67f9df0283c,0xa8f428109b25a6f1,0xa8b6288da1e0a51e,0x285da8d7246b2360,0x273aa90f26cc198f,0xa6a6290ea75d0e5c
.quad 0xa3bf28ada8ad23bf,0x23bfa8ad28ada3bf,0x8e5ca6f1290ea7a1,0x998f277fa90f2716,0x240e22a1a87628e5,0xa11ca4c528c8a8a3,0xa75d1b252607a8f4,0x258a1df0a7c2290f,0x28bfa4f29fe627f2,0xa7f21fe624f2a8bf,0xa90e2810a0eba454,0x28c4a5349df0277f,0x288da8f1266b925c,0xa90f27d3a056a46b,0xa6a628f4a89324af,0x28d4a8c4258a198f
.quad 0xa7289e552882a882,0x28ffa498a49828ff,0x28579c5da75d28fd,0xa90f2630214da8b1,0xa8d72360251ea903,0x28fba79098c42827,0x290ea607a0eb2893,0xa8c428579df0a6cc,0xa8f627f2965ba76e,0x286aa8bf230124f2,0x2893a8a822712508,0xa7e328fda55fa1af,0xa7d32903a5c9a056,0x26b9a90f270318c4,0x2607a90527e39b25,0xa55f28f4a82e1eb9
.quad 0xa3bf28ada8ad23bf,0x23bfa8ad28ada3bf,0x1df0a8012908a67f,0xa088283ca8f925de,0x1bef261ca8fb2843,0x18c4a74b290fa790,0xa2d1a3902888a8e2,0x1c5d25dea8ee2870,0x259f1cc2a76e290e,0xa17ea43d2898a8df,0xa77f1df02534a8c4,0x245420eba810290e,0x2876a40ea11c2809,0xa5c998c426b9a8fb,0xa8e8265894c5a5de,0x27169d27a50828a8
.quad 0xa88228829e55a728,0x2498a8ff27281e55,0x284aa8bb21af2607,0xa48128f9a77f9b25,0xa80928e5a40ea4c5,0x246ba8f127d3125c,0x277fa901253422d1,0xa45428e8a81017f2,0xa6de290ea6449fe6,0x243da8df28359cc2,0x2630a90c273a17f2,0xa42528d4a8571f82,0xa57528fba8091bef,0x240ea8c82876a11c,0x24afa8db2864a0eb,0xa3ee28bba8932271
.quad 0xa3bf28ada8ad23bf,0x23bfa8ad28ada3bf,0x2211a87028e2a534,0xa390289ea8c42481,0xa0562827a903266b,0x2360a88d28d7a51e,0x1d27a7a1290fa77f,0xa331287ca8e825b4,0x965b26dea9062835,0x2301a86a28f6a644,0x97f2a60728e8a893,0xa2d12857a90126cc,0x1d8c251ea8b628d7,0x22a1a8432909a74b,0xa088a4252870a901,0xa271282ea90e27c2
.quad 0x2241a8d028180000,0x224125f3a90f25f3,0x2360a8df28090000,0x1f1e26dea909254a,0x243da8eb27f20000,0x165b27b2a8f62498,0x24c5a8f627d30000,0x9bef2835a8d723bf,0x254aa8ff27b20000,0xa0b92882a8ad2241,0x25c9a90627900000,0xa36028bfa87620b9,0x2644a90b276e0000,0xa4f228eba8351e55,0x26b9a90e274b0000,0xa61c2906a7d31a5a
.quad 0x2728a90f27280000,0xa728290fa7280000,0x2790a90e27030000,0xa8092906a66b9a5a,0x27f2a90b26de0000,0xa86a28eba59f9e55,0x2827a90626b90000,0xa8b628bfa4c5a0b9,0x2850a8ff26920000,0xa8eb2882a3bfa241,0x2876a8f6266b0000,0xa9092835a1e0a3bf,0x2898a8eb26440000,0xa90e27b29fe6a498,0x28b6a8df261c0000,0xa8fb26de9befa54a
.quad 0xa81800002818a8d0,0x290fa5f3a24128d0,0xa6b99fe6288da882,0x28d7a301a575290b,0xa4f2a3bf28dfa818,0x28359a5aa76e28ff,0xa1e0a59f2909a728,0x266b1fe6a87628ad,0x9a5aa728290ba5f3,0x23bf2498a8eb2818,0x1d8ca83528e5a498,0x1bef26dea90f2692,0x2301a8ad2898a241,0x9fe62850a8df2498,0x2575a8f628279e55,0xa4c528dfa85d20b9
.quad 0x2728a90f27280000,0xa728290fa7280000,0x2843a8f625c91e55,0xa87628dfa51ea0b9,0x28bfa8ad243d2241,0xa8f62850a17ea498,0x2903a835211c2498,0xa90926de925ca692,0x290ba7281a5a25f3,0xa8ad249820b9a818,0x28d7a59f9bef2728,0xa7d31fe624c5a8ad,0x286aa3bfa17e2818,0xa59f9a5a26dea8ff,0x27909fe6a46b2882,0xa1e0a3012843a90b
.quad 0xa81828d0a241a5f3,0x2241a8d028180000,0xa8e527f2125ca818,0x2703a906251e23bf,0xa906254a2301a8d0,0x28bfa8501cc22728,0xa8761fe6266ba90f,0x2909a59fa1e028ad,0xa6929e552850a8d0,0x28509e55a692290f,0xa2a1a4f228f1a818,0x2575217ea88d28ad,0x165ba7b22906a5f3,0x1cc22692a90e2728,0x240ea8bf288da241,0xa2a12898a8b623bf
.quad 0x2728a90f27280000,0xa728290fa7280000,0x28a3a8bf246b2241,0xa8c82898a360a3bf,0x290ea7b21cc225f3,0xa9062692165ba728,0x28c8a4f2a0562818,0xa843217e246ba8ad,0x27b29e55a54a28d0,0xa54a9e5527b2a90f,0x24c51fe6a7d3290f,0x9befa59f28d7a8ad,0x1cc2254aa8bf28d0,0x2301a8502906a728,0xa11c27f2a90f2818,0x274ba906285da3bf
.quad 0x224125f3a90f25f3,0xa81800002818a8d0,0xa0562898a8761e55,0xa2a1a59f290da692,0xa6de290ba59fa241,0x217ea8ad286a9e55,0xa8d728359befa728,0x27d3a8f624c523bf,0xa8eb249823bfa8d0,0x290ba7289a5a2818,0xa74b965b27d3a8ff,0x285d9fe6a61c290b,0xa17ea54a28f6a818,0x243d23bfa8bf2882,0x211ca86a28d7a498,0x9f1e2835a8f1254a
.quad 0x2728a90f27280000,0xa728290fa7280000,0x28e5a86a21e02498,0xa8fb2835a056a54a,0x28dfa54a9fe62818,0xa89823bf2301a882,0x2703965ba66b28ff,0xa51e9fe62809a90b,0x20b92498a8ad28d0,0x1a5aa728290ba818,0xa1e02835a9092728,0x266ba8f62876a3bf,0xa76e290ba8352241,0x28dfa8ad24f21e55,0xa8f12898a4c59e55,0x28c8a59f98c42692
.quad 0x290fa5f3a24128d0,0xa81828d0a241a5f3,0x27d3165ba82728d0,0xa90324f2240ea8eb,0x1fe62692a90e25f3,0xa644a0b92898a882,0xa4c528f6a7d30000,0x1befa83528d7a3bf,0xa8ad2882a0b9a5f3,0x27b2a8ff254a2241,0xa8d7243d240ea8d0,0x290da6449f1e2850,0xa59fa0b9286aa8d0,0x26de1a5aa7f228ff,0x1befa7f22903a5f3,0x925c276ea90d2692
.quad 0x2728a90f27280000,0xa728290fa7280000,0x2909a7f21d8c25f3,0xa90f276e98c4a692,0x2835a0b9a4f228d0,0xa76e1a5a2644a8ff,0x21e0243da8a328d0,0x98c4a64428fba850,0xa3bf2882a8eb25f3,0x2692a8ff2850a241,0xa87628f6a66b0000,0x2909a83521e023bf,0xa8f62692965ba5f3,0x27f2a0b9a43d2882,0xa66b165b25c9a8d0,0x1d8c24f2a8a328eb
.quad 0x2241a8d028180000,0x224125f3a90f25f3,0x28a3a86a1d8c2728,0xa5c9290ea66ba0b9,0x2898a0b9a644290f,0xa90e26921fe6a882,0x21e0259fa9092728,0xa66b9fe62876a8ad,0xa54a28ffa7b20000,0x20b9a88228ada241,0xa8fb27f298c4a728,0x28a3a89821e0254a,0xa7f21a5a26dea90f,0x286aa0b9a59f28ff,0x98c4a6de290fa728,0x1d8c2644a90927b2
.quad 0x2728a90f27280000,0xa728290fa7280000,0x290da6de925c2728,0xa90326441befa7b2,0x26441a5aa76e290f,0xa4f2a0b92835a8ff,0x9f1e27f2a90d2728,0x240ea89828d7a54a,0xa85028ffa6920000,0x28eba88223bf2241,0xa8d7259f1befa728,0x27d39fe6a4c528ad,0xa43da0b927f2a90f,0x965b2692a8f62882,0x240ea86a2903a728,0xa827290ea7d320b9
.quad 0xa81800002818a8d0,0x290fa5f3a24128d0,0x18c4a83528c8a241,0x24c5243da8f127b2,0x286aa8ad217e25f3,0xa59f290ba6de9e55,0x28769fe6a66b290f,0xa909259f21e0a8ad,0x1a5a2728a90b25f3,0xa3bfa49828eba818,0xa80928f6a51ea241,0x266ba90e27031a5a,0xa8bf23bf243da8d0,0x28f6a54aa17e2882,0xa056a59f28fba818,0x21e024f2a8e52850
.quad 0x2728a90f27280000,0xa728290fa7280000,0x28f1a59f9f1e2818,0xa8d724f2211ca850,0x230123bfa89828d0,0x9fe6a54a28dfa882,0xa61c28f6a85d2241,0x27d3a90e274b9a5a,0xa90b27289a5aa5f3,0x28ada498a0b92818,0xa4c59fe627d3a90f,0x1bef259fa8d728ad,0x24f2a8ad28dfa5f3,0xa835290ba76e1e55,0x290da83522a12241,0xa876243d2056a7b2
.quad 0xa81828d0a241a5f3,0x2241a8d028180000,0xa85d1cc2274ba8ff,0x290fa644a11c28ad,0x1cc2a85028bfa241,0x2301254aa9062728,0x28d7a8351bef2728,0xa7d328f6a4c5a3bf,0x26921e55a85028d0,0xa8501e552692a90f,0xa46b28dfa8431e55,0x2056a86a28c8a3bf,0xa90e26921cc2a818,0x2906a7b2165b2728,0xa360a43d28c8a882,0x246b2301a8a328ad
.quad 0x2728a90f27280000,0xa728290fa7280000,0x28b6a43da2a12882,0xa88d2301240ea8ad,0x165b2692a9062818,0x1cc2a7b2290ea728,0xa88d28dfa5759e55,0x28f1a86a22a123bf,0xa7b21e55254aa8d0,0x254a1e55a7b2290f,0x21e0a8352909a728,0xa66b28f6a87623bf,0x2906a85023012241,0xa8bf254a1cc2a728,0x251e1cc2a70328ff,0x125ca64428e5a8ad
.quad 0x224125f3a90f25f3,0xa81800002818a8d0,0xa84328bfa1e0a5f3,0x246ba8f627901a5a,0xa76e9a5a2835a8d0,0x28dfa3bfa4f228ff,0x24c5a8f627d30000,0x9bef2835a8d723bf,0x28eba498a3bf28d0,0xa90b27281a5aa818,0x125c276ea90925f3,0xa11ca59f2903a7b2,0xa8df28509fe6a5f3,0x2898a8ad23012498,0xa51ea17e2876a8d0,0x25c91fe6a84328eb
.quad 0x2728a90f27280000,0xa728290fa7280000,0x285da17ea4c528d0,0xa8271fe62575a8eb,0xa17e2850a8f625f3,0x243da8ad28bfa498,0xa90f276e9befa5f3,0x28e5a59f9d8c27b2,0xa0b9a49828ada8d0,0x9a5a2728a90b2818,0x2876a8f6266b0000,0xa9092835a1e0a3bf,0x26de9a5aa59f28d0,0xa17ea3bf286aa8ff,0xa57528bfa8d725f3,0x288da8f626b99a5a
.quad 0x290fa5f3a24128d0,0xa81828d0a241a5f3,0x1bef276ea8fb2498,0xa61ca17e28b6a850,0xa8f627b2165ba818,0x27f2a8eb243d2498,0xa1e0a59f2909a728,0x266b1fe6a87628ad,0x28ada88220b925f3,0xa7b228ffa54aa241,0x24c52301a8b62882,0xa6b99cc22827a8eb,0xa83528eba4f2a241,0x276ea90b26441e55,0xa66b9cc22809a8ff,0x2703165ba790290b
.quad 0x2728a90f27280000,0xa728290fa7280000,0x27d39cc2a61c28ff,0xa74b165b26b9a90b,0xa59f28eba86a2241,0x26dea90b27f29e55,0xa87623012360a882,0x27909cc2a5c928eb,0x23bfa88228eba5f3,0xa69228ffa8502241,0x28d7a59f9bef2728,0xa7d31fe624c5a8ad,0x9fe627b2a90e2818,0x2644a8eb2898a498,0xa909276e9f1ea498,0x2809a17ea3602850
.quad 0x2241a8d028180000,0x224125f3a90f25f3,0x28b6a17ea61c290f,0xa8fb276e1befa850,0xa43d28eba7f20000,0x965ba7b228f6a498,0xa8761fe6266ba90f,0x2909a59fa1e028ad,0x254aa8ff27b20000,0xa0b92882a8ad2241,0x28279cc2a6b9290f,0xa8b6230124c5a8eb,0xa644290ba76e0000,0x24f2a8eb28359e55,0xa790165b2703a90f,0x28099cc2a66b290b
.quad 0x2728a90f27280000,0xa728290fa7280000,0x26b9165ba74b290f,0xa61c9cc227d3a90b,0xa7f2290ba6de0000,0x286aa8eb259f1e55,0xa5c99cc22790a90f,0x23602301a87628eb,0x2850a8ff26920000,0xa8eb2882a3bfa241,0x24c51fe6a7d3290f,0x9befa59f28d7a8ad,0xa89828eba6440000,0x290ea7b21fe62498,0xa360a17e2809a90f,0x9f1e276ea9092850
.quad 0xa81800002818a8d0,0x290fa5f3a24128d0,0x2790a8f6246b2498,0xa1e028bfa8431a5a,0x24f223bfa8df2818,0xa8351a5a276ea8ff,0xa8d728359befa728,0x27d3a8f624c523bf,0x9a5aa728290ba5f3,0x23bf2498a8eb2818,0x2903a59fa11c2882,0xa909276e125ca7b2,0xa30128ada8982241,0x1fe6a85028dfa498,0xa8431fe625c9a8ff,0x2876a17ea51e28eb
.quad 0x2728a90f27280000,0xa728290fa7280000,0x25751fe6a82728ff,0xa4c5a17e285da8eb,0xa8bf28ada43da241,0x28f6a850217e2498,0x9d8ca59f28e5a882,0x9bef276ea90f27b2,0x290ba7281a5a25f3,0xa8ad249820b9a818,0xa1e02835a9092728,0x266ba8f62876a3bf,0xa86a23bf217ea818,0x259f1a5aa6de28ff,0x26b9a8f6288da498,0xa8d728bfa5759a5a
.quad 0xa81828d0a241a5f3,0x2241a8d028180000,0xa11ca644290fa5f3,0x274b1cc2a85d28ad,0x2906a54aa30128d0,0xa8bf28509cc2a728,0xa4c528f6a7d30000,0x1befa83528d7a3bf,0xa6929e552850a8d0,0x28509e55a692290f,0x28c8a86a205625f3,0xa84328dfa46ba3bf,0x965b27b2a90625f3,0x9cc2a692290ea728,0xa8a32301246ba8d0,0x28c8a43da36028ad
.quad 0x2728a90f27280000,0xa728290fa7280000,0x240e2301a88d28d0,0xa2a1a43d28b6a8ad,0xa90e27b29cc2a5f3,0x2906a692965b2728,0x22a1a86a28f1a5f3,0xa57528dfa88d23bf,0x27b29e55a54a28d0,0xa54a9e5527b2a90f,0xa87628f6a66b0000,0x2909a83521e023bf,0x9cc2a54a28bfa8d0,0xa3012850a9062728,0x28e5a644125c25f3,0xa7031cc2251ea8ad
.quad 0x224125f3a90f25f3,0xa81800002818a8d0,0xa8f1243d24c5a8ff,0x28c8a83518c427b2,0x26dea90b259f2241,0xa17e28ada86a1e55,0x21e0259fa9092728,0xa66b9fe62876a8ad,0xa8eb249823bfa8d0,0x290ba7289a5a2818,0x2703a90e266b1e55,0xa51e28f6a8091a5a,0x217e254aa8f62818,0xa43da3bf28bfa882,0xa8e524f221e0a882,0x28fba59fa0562850
.quad 0x2728a90f27280000,0xa728290fa7280000,0x211c24f2a8d72882,0x9f1ea59f28f1a850,0xa8df254a1fe6a818,0x2898a3bfa3012882,0x274ba90e27d39e55,0xa85d28f6a61c9a5a,0x20b92498a8ad28d0,0x1a5aa728290ba818,0xa8d7259f1befa728,0x27d39fe6a4c528ad,0x276ea90b2835a241,0xa8df28ada4f29e55,0x2056243da87628ff,0x22a1a835290da7b2
.quad 0x290fa5f3a24128d0,0xa81828d0a241a5f3,0xa66b290ea5c9a241,0x1d8ca86a28a3a0b9,0x9fe6a692290ea5f3,0x264420b9a8982882,0x28769fe6a66b290f,0xa909259f21e0a8ad,0xa8ad2882a0b9a5f3,0x27b2a8ff254a2241,0x21e0a89828a3a241,0x98c427f2a8fb254a,0x259f20b9a86a28d0,0xa6de9a5a27f2a8ff,0xa90926441d8ca818,0x290fa6de98c427b2
.quad 0x2728a90f27280000,0xa728290fa7280000,0x1bef2644a9032818,0x925ca6de290da7b2,0xa83520b924f2a8d0,0x276e9a5aa64428ff,0x28d7a898240e2241,0xa90d27f29f1ea54a,0xa3bf2882a8eb25f3,0x2692a8ff2850a241,0xa4c59fe627d3a90f,0x1bef259fa8d728ad,0x28f6a692165b25f3,0xa7f220b9243da882,0xa7d3290ea8272241,0x2903a86a240e20b9
.quad 0x2241a8d028180000,0x224125f3a90f25f3,0x240e24f2a9032728,0xa827165b27d3a8eb,0xa89820b92644a90f,0x290ea6929fe62882,0x28d7a8351bef2728,0xa7d328f6a4c5a3bf,0xa54a28ffa7b20000,0x20b9a88228ada241,0x9f1ea644290da728,0x240e243da8d72850,0x27f29a5aa6de290f,0xa86a20b9259fa8ff,0xa90d276e925ca728,0x2903a7f21bef2692
.quad 0x2728a90f27280000,0xa728290fa7280000,0x98c4276ea90f2728,0x1d8ca7f22909a692,0xa6449a5a276ea90f,0x24f220b9a83528ff,0x28fba64498c42728,0xa8a3243d21e0a850,0xa85028ffa6920000,0x28eba88223bf2241,0x21e0a8352909a728,0xa66b28f6a87623bf,0x243d20b9a7f2290f,0x165ba69228f6a882,0xa8a324f21d8ca728,0x25c9165ba66b28eb
.quad 0xa81800002818a8d0,0x290fa5f3a24128d0,0x290da59fa2a128d0,0xa8762898a056a692,0xa86a28ada17ea5f3,0x259fa90b26de1e55,0x24c5a8f627d30000,0x9bef2835a8d723bf,0x1a5a2728a90b25f3,0xa3bfa49828eba818,0xa61c9fe6285da8d0,0x27d3965ba74b290b,0x28bfa3bfa43d28d0,0xa8f6254a217ea882,0xa8f128359f1ea5f3,0x28d7a86a211c254a
.quad 0x2728a90f27280000,0xa728290fa7280000,0xa0562835a8fb25f3,0x21e0a86a28e5a54a,0xa301a3bf2898a8d0,0x1fe6254aa8df2882,0x28099fe6a51e28d0,0xa66b965b2703a90b,0xa90b27289a5aa5f3,0x28ada498a0b92818,0x2876a8f6266b0000,0xa9092835a1e0a3bf,0xa4f228ada8df25f3,0x2835a90b276e9e55,0x98c4a59f28c8a8d0,0xa4c52898a8f12692
.quad 0xa81828d0a241a5f3,0x2241a8d028180000,0x251ea90627031e55,0x125c27f2a8e523bf,0x9cc22850a8bf2241,0xa301a54a2906a728,0xa1e0a59f2909a728,0x266b1fe6a87628ad,0x26921e55a85028d0,0xa8501e552692a90f,0xa88d217e2575a8ff,0x28f1a4f2a2a128ad,0x290ea6929cc22818,0xa90627b2965ba728,0xa8b62898a2a1a498,0x288da8bf240e23bf
.quad 0x2728a90f27280000,0xa728290fa7280000,0xa3602898a8c82498,0x246ba8bf28a3a3bf,0x965ba6922906a818,0x9cc227b2a90e2728,0x246b217ea84328ff,0xa056a4f228c8a8ad,0xa7b21e55254aa8d0,0x254a1e55a7b2290f,0x28d7a59f9bef2728,0xa7d31fe624c5a8ad,0xa9062850a301a241,0x28bfa54a9cc22728,0x285da906274b9e55,0xa90f27f2a11ca3bf
.quad 0x224125f3a90f25f3,0xa81800002818a8d0,0xa575a30128d7a818,0x288d9fe6a6b9290b,0x276e1a5aa83528d0,0xa8df23bf24f2a8ff,0xa8761fe6266ba90f,0x2909a59fa1e028ad,0x28eba498a3bf28d0,0xa90b27281a5aa818,0xa90f26de1befa818,0x28e5a8351d8c2692,0x28dfa8501fe625f3,0xa89828ada301a498,0xa85d28dfa4c5a241,0x2827a8f6257520b9
.quad 0x2728a90f27280000,0xa728290fa7280000,0xa51e28dfa8762241,0x25c9a8f62843a0b9,0x217ea85028f6a5f3,0xa43d28ada8bf2498,0x925c26dea9092818,0x211ca8352903a692,0xa0b9a49828ada8d0,0x9a5a2728a90b2818,0x24c51fe6a7d3290f,0x9befa59f28d7a8ad,0xa6de1a5a259fa8d0,0x217e23bfa86a28ff,0x2843a301a1e02818,0xa46b9fe62790a90b
.quad 0x290fa5f3a24128d0,0xa81828d0a241a5f3,0xa90926de1f1ea882,0x2809a8df2360254a,0x28f6a7b2965b2818,0xa7f228eba43da498,0xa8d728359befa728,0x27d3a8f624c523bf,0x28ada88220b925f3,0xa7b228ffa54aa241,0xa87628bfa360a498,0x2790a90625c920b9,0x2835a8eb24f22241,0xa76e290ba6449e55,0xa7d32906a61c9e55,0x274ba90e26b91a5a
.quad 0x2728a90f27280000,0xa728290fa7280000,0xa66b2906a8091e55,0x2703a90e27909a5a,0x259fa8eb286aa241,0xa6de290ba7f21e55,0xa4c528bfa8b62498,0x26b9a9062827a0b9,0x23bfa88228eba5f3,0xa69228ffa8502241,0xa1e02835a9092728,0x266ba8f62876a3bf,0x1fe6a7b2290ea818,0xa64428eba8982498,0x9bef26dea8fb2882,0x261ca8df28b6a54a
.quad 0x28ffa7289e552882,0xa72828ffa498a498,0x290aa6cc9f822888,0xa81028dba331a55f,0x290fa66ba056288d,0xa87628a3a11ca61c,0x290ea607a0eb2893,0xa8c428579df0a6cc,0x2906a59fa17e2898,0xa8f627f2965ba76e,0x28f9a534a211289e,0xa90e2716198fa801,0x28e5a4c5a2a128a3,0xa909261c1f1ea843,0x28cca454a33128a8,0xa8e8250821afa87c
.quad 0x28ada3bfa3bf28ad,0xa8ad23bf23bfa8ad,0x2888a2d1a42528b1,0xa857214d24dca8d4,0x285da1e0a46b28b6,0xa7d31d8c25c9a8f1,0x282ea0eba4af28bb,0xa6cc0e5c26a6a905,0x27f29fe6a4f228bf,0xa59f9cc2276ea90e,0x277f9df0a53428c4,0xa454a0eb2810a90e,0x27039befa57528c8,0xa1e0a360285da903,0x267f97f2a5b428cc,0x9df0a4dc289ea8ee
.quad 0x1e55a88228829e55,0x24982498a8ff2728,0x2390a8e228010e5c,0x1eb926f1a9082534,0x25c9a90d26b91f1e,0x9d8c285da8b621e0,0x277fa901253422d1,0xa45428e8a81017f2,0x286aa8bf230124f2,0xa6de290ea6449fe6,0x28dba84a1eb92658,0xa86428cca3eea454,0x290da74b925c2790,0xa8f128279d8ca66b,0x28fda5b4a025284a,0xa90a26581d27a810
.quad 0x28ada3bfa3bf28ad,0xa8ad23bf23bfa8ad,0x281f9f82a58a28ee,0xa7c21c5d2630a901,0x26b9125ca703290d,0xa5759f1e2809a909,0x24dc2088a81f2908,0xa14da48128b1a8c4,0x217e243da89828df,0x165ba6de2906a835,0x17f22607a8e82893,0x22d1a8572901a6cc,0x9f1e2790a90d2827,0x261ca8e528a3a4c5,0xa3ee2864a905273a,0x281fa90f27e3a0eb
.quad 0xa8821e552728a8ff,0x28ffa7289e552882,0xa6a6a0252893a87c,0x28d4a2d1a58a290c,0xa2a1a5752909a703,0x274b1befa84328c8,0x17f2a81028e8a454,0x22d12534a901277f,0x243da8df28359cc2,0x9cc22835a8df243d,0x275da90a26072025,0xa58a2901a7c214c5,0x28b6a88d21e0251e,0xa85d28d7a46ba360,0x290fa6f197f227a1,0xa90c277f94c5a716
.quad 0x28ada3bfa3bf28ad,0xa8ad23bf23bfa8ad,0x273a94c5a6cc290c,0xa6a697f2275da90f,0x240e22a1a87628e5,0xa11ca4c528c8a8a3,0x14c5267fa901283c,0x2025a810290aa6f1,0xa301286aa8f62644,0x2644a8f6286aa301,0xa6cc2901a85722d1,0x2893a8e8260717f2,0xa88d28f1a66b125c,0x290fa7d32056246b,0xa90c283ca2d1a211,0x287ca454a02527a1
.quad 0xa72828ffa498a498,0x1e55a88228829e55,0xa8e827e314c5a81f,0x2716a905250823ee,0xa8d72360251ea903,0x28fba79098c42827,0xa6cc9df02857a8c4,0x2893a0eba607290e,0x9fe6a644290ea6de,0x24f22301a8bf286a,0x22d1a8b12888a14d,0x9c5d281fa8ee24dc,0x27d3a90325c92056,0xa6b9290fa70398c4,0x2901a8011c5d267f,0xa8ee283c9f82a5de
.quad 0x28ada3bfa3bf28ad,0xa8ad23bf23bfa8ad,0x26071d27a7e3290a,0xa55fa025282ea8fd,0x1bef261ca8fb2843,0x18c4a74b290fa790,0xa45428a8a8cc2508,0x2658a8fd284aa1af,0xa8352906a6de165b,0x28dfa898243d217e,0xa90e2810a0eba454,0x28c4a5349df0277f,0xa876240e211ca809,0x25c918c4a6b928fb,0xa5349c5d26f1a8fd,0x8e5c2630a8e228b1
.quad 0x24982498a8ff2728,0xa8821e552728a8ff,0xa088289ea8701df0,0xa271a5b4290ea67f,0xa80928e5a40ea4c5,0x246ba8f127d3125c,0xa90e260720eba893,0x28c4a8571df026cc,0xa76e965b27f2a8f6,0x2898a17ea59f2906,0x9d27a6a6290fa6cc,0x233124afa8e8282e,0x2575a8fb28099bef,0xa40e28c8a876211c,0x28d4a870214d2534,0xa8b1289ea2d1a481
.quad 0x28ada3bfa3bf28ad,0xa8ad23bf23bfa8ad,0x24af21afa86428e8,0xa3eea3312893a8cc,0xa0562827a903266b,0x2360a88d28d7a51e,0xa801290ca71617f2,0x289ea8d425341f82,0xa90e276e9cc2a59f,0x28bfa4f29fe627f2,0xa77f1df02534a8c4,0x245420eba810290e,0x9d8ca51e28b6a8d7,0xa2a12843a909274b,0x255fa8bb28dba607,0xa88828f9a6cc1b25
.quad 0x28ffa7289e552882,0xa72828ffa498a498,0x27c217f2a82e28cc,0xa90124dc2425a8ee,0x125c27d3a8f1246b,0xa4c5a40e28e5a809,0xa77f2901a534a2d1,0x2454a8e8281097f2,0xa906259f217ea898,0x28f6a7f2165b276e,0xa5b4a0eb287ca8bb,0x277f0e5ca7a12905,0x211ca87628c8a40e,0x9bef2809a8fb2575,0x2888a8c424252390,0xa85728e2a4dca211
.quad 0x28ada3bfa3bf28ad,0xa8ad23bf23bfa8ad,0x22712454a8bb28a8,0xa0eba50828dba87c,0xa51e28d7a88d2360,0x266ba9032827a056,0xa8f92857a211a425,0x290ea73a198f2630,0xa7f21fe624f2a8bf,0x259f1cc2a76e290e,0x97f2a60728e8a893,0xa2d12857a90126cc,0x274ba9092843a2a1,0xa8d728b6a51e9d8c,0x290aa77f1f822481,0xa81021af2331a84a
.quad 0x1e55a88228829e55,0x24982498a8ff2728,0x28a8a8641d27273a,0xa5de290fa658a0eb,0x282798c4a79028fb,0xa903251e2360a8d7,0x97f22810a8e82454,0xa2d1a5342901a77f,0xa86a28bfa301a4f2,0x26dea90e26441fe6,0xa870208825dea908,0x28e2a481a39028c4,0x98c4a703290fa6b9,0x205625c9a90327d3,0x281fa8f9258a2088,0xa7c22908a6309df0
.quad 0x28ada3bfa3bf28ad,0xa8ad23bf23bfa8ad,0x1eb925b4a8f4284a,0x9b25a6582905a810,0xa790290fa74b18c4,0x2843a8fb261c1bef,0xa8db255f1eb9a7e3,0x2864a271a3ee2893,0xa17ea43d2898a8df,0x965b26dea9062835,0x26cca9012857a2d1,0xa89328e8a60797f2,0x28fba6b918c425c9,0xa809211c240ea876,0x2390214da801290f,0x1eb9a75d2908a857
.quad 0xa8821e552728a8ff,0x28ffa7289e552882,0x198fa83c28c4a211,0x24af2454a8f427a1,0x28c8a8431bef274b,0xa7032909a575a2a1,0x26cc1df0a85728c4,0xa89320eb2607a90e,0xa43d28dfa8351cc2,0x1cc2a83528dfa43d,0xa90f267f1df0a83c,0x28f4a8101b2526f1,0xa360a46b28d7a85d,0x251e21e0a88d28b6,0x273aa90f26cc198f,0xa6a6290ea75d0e5c
.quad 0x28ada3bfa3bf28ad,0xa8ad23bf23bfa8ad,0xe5c26f1a90e27a1,0x198fa77f290fa716,0xa8a328c8a4c5a11c,0x28e5a87622a1240e,0xa75d1b252607a8f4,0x258a1df0a7c2290f,0x2301a86a28f6a644,0xa64428f6a86a2301,0x290ea81020eb2454,0xa8c425341df0a77f,0x246b2056a7d3290f,0x125ca66b28f1a88d,0xa6a628f4a89324af,0x28d4a8c4258a198f
.quad 0xa72828ffa498a498,0x1e55a88228829e55,0xa8571c5d275da8fd,0x290fa630a14d28b1,0x21e0a8b6285d9d8c,0x1f1e26b9a90d25c9,0x290ea607a0eb2893,0xa8c428579df0a6cc,0x1fe62644a90e26de,0xa4f2a30128bfa86a,0xa89328a8a271a508,0x27e3a8fd255f21af,0xa66b9d8c2827a8f1,0x2790925ca74b290d,0x2607a90527e39b25,0xa55f28f4a82e1eb9
.quad 0x28ada3bfa3bf28ad,0xa8ad23bf23bfa8ad,0x9df02801a908267f,0x2088a83c28f9a5de,0xa90928099f1ea575,0x290da703125c26b9,0xa2d1a3902888a8e2,0x1c5d25dea8ee2870,0x2835a90626de965b,0xa8df2898a43da17e,0x277f9df0a53428c4,0xa454a0eb2810a90e,0xa4c528a3a8e5261c,0x2827a90d27909f1e,0xa8e8265894c5a5de,0x27169d27a50828a8
.quad 0x24982498a8ff2728,0xa8821e552728a8ff,0xa84a28bba1afa607,0x2481a8f9277f1b25,0xa61ca11c28a3a876,0x288da056a66b290f,0x277fa901253422d1,0xa45428e8a81017f2,0x276e165ba7f228f6,0xa898217e259fa906,0xa630290ca73a97f2,0x2425a8d428579f82,0xa8431f1e261ca909,0x28a3a2a1a4c528e5,0x24afa8db2864a0eb,0xa3ee28bba8932271
.quad 0x28ada3bfa3bf28ad,0xa8ad23bf23bfa8ad,0xa2112870a8e22534,0x2390a89e28c4a481,0xa8f125c91d8ca7d3,0x28b6a46ba1e0285d,0x1d27a7a1290fa77f,0xa331287ca8e825b4,0x290ea76e1cc2259f,0xa8bf24f21fe6a7f2,0x17f22607a8e82893,0x22d1a8572901a6cc,0xa903285da360a1e0,0x28c8a5759bef2703,0xa088a4252870a901,0xa271282ea90e27c2
.quad 0x28ffa7289e552882,0xa72828ffa498a498,0x1b25277fa8f92481,0xa607a1af28bba84a,0xa90f266b2056a88d,0x2876a8a3211c261c,0x17f2a81028e8a454,0x22d12534a901277f,0x2906a59fa17e2898,0xa8f627f2965ba76e,0x9f822857a8d42425,0x97f2a73a290ca630,0xa8e524c522a1a8a3,0x2909a61c9f1e2843,0x2271a89328bba3ee,0xa0eb2864a8db24af
.quad 0x28ada3bfa3bf28ad,0xa8ad23bf23bfa8ad,0xa48128c4a89e2390,0x2534a8e22870a211,0xa85d21e0246ba8b6,0x27d39d8ca5c928f1,0x25b4a8e8287ca331,0xa77f290fa7a11d27,0x27f29fe6a4f228bf,0xa59f9cc2276ea90e,0xa6cc2901a85722d1,0x2893a8e8260717f2,0xa7031bef2575a8c8,0x21e02360a85d2903,0x27c2a90e282ea271,0xa9012870a425a088
.quad 0x1e55a88228829e55,0x24982498a8ff2728,0x28b1a14da630290f,0xa8fd275d1c5da857,0xa5c9290da6b99f1e,0x1d8ca85d28b6a1e0,0xa6cc9df02857a8c4,0x2893a0eba607290e,0x286aa8bf230124f2,0xa6de290ea6449fe6,0x21af255fa8fd27e3,0xa508a27128a8a893,0xa90d274b125ca790,0x28f1a8271d8c266b,0x1eb9a82e28f4a55f,0x9b2527e3a9052607
.quad 0x28ada3bfa3bf28ad,0xa8ad23bf23bfa8ad,0xa5de28f9a83c2088,0x267fa90828019df0,0xa6b9925c2703a90d,0x25751f1ea8092909,0x2870a8ee25de1c5d,0xa8e22888a390a2d1,0x217e243da89828df,0x165ba6de2906a835,0xa90e2810a0eba454,0x28c4a5349df0277f,0x1f1ea790290da827,0xa61c28e5a8a324c5,0x28a8a5089d272716,0xa5de94c52658a8e8
.quad 0xa8821e552728a8ff,0x28ffa7289e552882,0x27a1a8f4245424af,0xa21128c4a83c198f,0x22a12575a9092703,0xa74b9bef2843a8c8,0xa90e260720eba893,0x28c4a8571df026cc,0x243da8df28359cc2,0x9cc22835a8df243d,0x26f11b25a81028f4,0xa83c1df0267fa90f,0xa8b6288da1e0a51e,0x285da8d7246b2360,0xe5ca75d290ea6a6,0x198f26cca90f273a
.quad 0x28ada3bfa3bf28ad,0xa8ad23bf23bfa8ad,0xa716290fa77f198f,0x27a1a90e26f10e5c,0xa40ea2a12876a8e5,0x211c24c5a8c828a3,0x290fa7c21df0258a,0xa8f426071b25a75d,0xa301286aa8f62644,0x2644a8f6286aa301,0xa77f1df02534a8c4,0x245420eba810290e,0x288da8f1266b925c,0xa90f27d3a056a46b,0x198f258aa8c428d4,0x24afa89328f4a6a6
.quad 0xa72828ffa498a498,0x1e55a88228829e55,0xa0eba658290fa5de,0x273a1d27a86428a8,0x28d7a360a51e2903,0xa8fb279018c4a827,0xa77f2901a534a2d1,0x2454a8e8281097f2,0x9fe6a644290ea6de,0x24f22301a8bf286a,0x28c4a390a48128e2,0xa90825de2088a870,0xa7d32903a5c9a056,0x26b9a90f270318c4,0x9df0a6302908a7c2,0x2088258aa8f9281f
.quad 0x28ada3bfa3bf28ad,0xa8ad23bf23bfa8ad,0xa8102905a6589b25,0x284aa8f425b41eb9,0x9befa61c28fba843,0x98c4274ba90f2790,0x2893a3eea2712864,0xa7e31eb9255fa8db,0xa8352906a6de165b,0x28dfa898243d217e,0x97f2a60728e8a893,0xa2d12857a90126cc,0x2876a40ea11c2809,0xa5c998c426b9a8fb,0xa8572908a75d1eb9,0x290fa801214d2390
.quad 0x24982498a8ff2728,0xa8821e552728a8ff,0xa8ee242524dca901,0x28cca82e17f227c2,0x2809a8e5240e24c5,0xa46b28f1a7d3925c,0x97f22810a8e82454,0xa2d1a5342901a77f,0xa76e965b27f2a8f6,0x2898a17ea59f2906,0x2905a7a10e5c277f,0xa8bb287ca0eba5b4,0xa57528fba8091bef,0x240ea8c82876a11c,0xa211a4dc28e2a857,0x23902425a8c42888
.quad 0x28ada3bfa3bf28ad,0xa8ad23bf23bfa8ad,0xa87c28dba508a0eb,0x28a8a8bb24542271,0x2056a8272903a66b,0xa360288da8d7251e,0x2630198fa73a290e,0xa425a2112857a8f9,0xa90e276e9cc2a59f,0x28bfa4f29fe627f2,0x26cca9012857a2d1,0xa89328e8a60797f2,0x1d8c251ea8b628d7,0x22a1a8432909a74b,0xa84a233121afa810,0x24811f82a77f290a
.quad 0x28ffa7289e552882,0xa72828ffa498a498,0xa67f290ea5b4a271,0x1df0a870289ea088,0x925ca7d328f1a46b,0x24c5240ea8e52809,0x26cc1df0a85728c4,0xa89320eb2607a90e,0xa906259f217ea898,0x28f6a7f2165b276e,0x282ea8e824af2331,0xa6cc290fa6a69d27,0xa11c2876a8c8240e,0x1befa80928fba575,0xa481a2d1289ea8b1,0x2534214da87028d4
.quad 0x28ada3bfa3bf28ad,0xa8ad23bf23bfa8ad,0xa8cc2893a331a3ee,0x28e8a86421af24af,0x251ea8d7288da360,0xa66b2903a8272056,0x1f822534a8d4289e,0x17f2a716290ca801,0xa7f21fe624f2a8bf,0x259f1cc2a76e290e,0x290ea81020eb2454,0xa8c425341df0a77f,0xa74b2909a84322a1,0x28d7a8b6251e1d8c,0x1b25a6cc28f9a888,0xa60728dba8bb255f
.quad 0x1e55a88228829e55,0x24982498a8ff2728,0x23ee2508a9052716,0xa81f14c527e3a8e8,0xa82718c42790a8fb,0x2903a51ea36028d7,0x290ea607a0eb2893,0xa8c428579df0a6cc,0xa86a28bfa301a4f2,0x26dea90e26441fe6,0x24dca8ee281f9c5d,0xa14d2888a8b122d1,0x18c42703a90f26b9,0xa056a5c92903a7d3,0xa5de9f82283ca8ee,0x267f1c5da8012901
.quad 0x28ada3bfa3bf28ad,0xa8ad23bf23bfa8ad,0xa8fd282ea025a55f,0x290aa7e31d272607,0x2790a90f274b98c4,0xa84328fba61c9bef,0xa1af284aa8fd2658,0x2508a8cc28a8a454,0xa17ea43d2898a8df,0x965b26dea9062835,0x277f9df0a53428c4,0xa454a0eb2810a90e,0xa8fb26b998c4a5c9,0x2809a11ca40e2876,0x28b1a8e226308e5c,0xa8fd26f19c5da534
.quad 0xa8821e552728a8ff,0x28ffa7289e552882,0x290ca58aa2d128d4,0xa87c2893a025a6a6,0xa8c828439befa74b,0x2703a909257522a1,0x277fa901253422d1,0xa45428e8a81017f2,0xa43d28dfa8351cc2,0x1cc2a83528dfa43d,0x14c5a7c22901a58a,0x20252607a90a275d,0x2360246ba8d7285d,0xa51ea1e0288da8b6,0xa71694c5277fa90c,0x27a197f2a6f1290f
.quad 0x28ada3bfa3bf28ad,0xa8ad23bf23bfa8ad,0xa90f275d97f2a6a6,0x290ca6cc94c5273a,0x28a3a8c824c5211c,0xa8e52876a2a1a40e,0xa6f1290aa8102025,0x283ca901267f14c5,0x2301a86a28f6a644,0xa64428f6a86a2301,0x17f22607a8e82893,0x22d1a8572901a6cc,0xa46ba05627d3a90f,0x925c266ba8f1288d,0x27a1a025a454287c,0xa211a2d1283ca90c
.quad 0xa72828ffa498a498,0x1e55a88228829e55,0x2534a90826f11eb9,0xe5c2801a8e22390,0xa1e028b6a85d1d8c,0x9f1ea6b9290da5c9,0x17f2a81028e8a454,0x22d12534a901277f,0x1fe62644a90e26de,0xa4f2a30128bfa86a,0xa454a3ee28cca864,0x26581eb9a84a28db,0x266b1d8ca82728f1,0xa790125c274ba90d,0xa8101d272658a90a,0x284aa025a5b428fd
.quad 0x28ada3bfa3bf28ad,0xa8ad23bf23bfa8ad,0xa90126301c5da7c2,0x28eea58a9f82281f,0x2909a8091f1e2575,0xa90d2703925ca6b9,0xa8c428b1a481a14d,0x2908a81f208824dc,0x2835a90626de965b,0xa8df2898a43da17e,0xa6cc2901a85722d1,0x2893a8e8260717f2,0x24c5a8a328e5a61c,0xa827290da7901f1e,0xa0eb27e3a90f281f,0x273aa9052864a3ee
.quad 0x24982498a8ff2728,0xa8821e552728a8ff,0xa55fa33128dba810,0x28889f82a6cc290a,0x261c211ca8a32876,0xa88d2056266ba90f,0xa6cc9df02857a8c4,0x2893a0eba607290e,0x276e165ba7f228f6,0xa898217e259fa906,0xa801198f2716a90e,0x289ea211a53428f9,0x28439f1ea61c2909,0xa8a322a124c5a8e5,0xa87c21af2508a8e8,0x28a8a331a45428cc
.quad 0x28ada3bfa3bf28ad,0xa8ad23bf23bfa8ad,0xa8d424dc214da857,0x28b1a425a2d12888,0x28f1a5c99d8c27d3,0xa8b6246b21e0a85d,0xa90526a60e5ca6cc,0x28bba4afa0eb282e,0x290ea76e1cc2259f,0xa8bf24f21fe6a7f2,0xa90e2810a0eba454,0x28c4a5349df0277f,0x2903a85d236021e0,0xa8c825751befa703,0xa8ee289ea4dc9df0,0x28cca5b497f2267f
.quad 0x22412241a818290f,0x2241a818290fa818,0x211c2301a827290f,0x246ba86a2909a7b2,0x1fe623bfa835290f,0x259fa8ad28f6a728,0x1d8c243da843290f,0x26b9a8df28d7a692,0x1a5a2498a850290f,0x27b2a8ff28ada5f3,0x125c24f2a85d290f,0x2843a90e2876a54a,0x965b254aa86a290f,0x2898a90b2835a498,0x9bef259fa876290f,0x28d7a8f627d3a3bf
.quad 0x9e5525f3a882290f,0x28ffa8d02728a241,0xa0562644a88d290f,0x290fa898266ba0b9,0xa17e2692a898290f,0x2906a850259f9e55,0xa2a126dea8a3290f,0x28e5a7f224c59a5a,0xa3bf2728a8ad290f,0x28ada72823bf8000,0xa46b276ea8b6290f,0x285da64421e01a5a,0xa4f227b2a8bf290f,0x27f2a54a1fe61e55,0xa57527f2a8c8290f,0x2703a43d1bef20b9
.quad 0xa818290fa8182241,0x290fa81822412241,0xa8a328f6a7031e55,0x28d7a64418c4254a,0xa8f628ada59f0000,0x2835a3bf9fe62728,0xa90f2835a40e9e55,0x266b9cc2a46b2850,0xa8eb2728a0b9a241,0x23bf1e55a69228d0,0xa88d259f98c4a498,0x1bef243da827290b,0xa7f223bf1cc2a5f3,0x9fe62692a8bf28ff,0xa66b1fe621e0a728,0xa4c52835a90928ad
.quad 0xa49800002498a818,0xa72828d0a8ff2818,0xa11c9fe6261ca882,0xa876290ea8a32692,0x965ba3bf276ea8d0,0xa8f628eba7f22498,0x1f1ea59f2843a8ff,0xa909286aa61c20b9,0x23bfa72828ada90f,0xa8ad2728a3bf0000,0x25c9a83528f1a8ff,0xa7d324f29d8ca0b9,0x276ea8ad290ea8d0,0xa59f20b91cc2a498,0x285da8f62903a882,0xa1e0965b2360a692
.quad 0xa81822412241a818,0x22412241a818290f,0xa575965b261ca8d0,0x9d8c26dea8f128ad,0x9fe6a3bf2835a90f,0xa59f28ada8f62728,0x1f1ea6de28e5a8d0,0xa85d290ea82723bf,0x254aa882290ba818,0xa90b2882a54a0000,0x2809a90628a3a5f3,0xa8b626449d8ca3bf,0x28dfa8eb276ea241,0xa6de20b9217ea728,0x2909a83524c58000,0xa1e09fe6266ba8ad
.quad 0x2882a5f31e552241,0x1e55a5f32882a90f,0x26b9a17e9f1e25f3,0x25c9a86a290da8ad,0x23011a5aa4f22818,0x286aa90b28bfa728,0x925c243da79028d0,0x290da8bf274ba3bf,0xa3bf2728a8ad290f,0x28ada72823bf8000,0xa7032898a90d28d0,0x26b9a301925c23bf,0xa898290ba8df2818,0x217e1a5aa43d2728,0xa90d28dfa82725f3,0x9f1e24f2a79028ad
.quad 0x2241a818290fa818,0xa818290fa8182241,0x2790a9062876a498,0xa90f2835a360a0b9,0x28f6a8ad259f8000,0xa83523bf1fe6a728,0x28c8a6441bef2498,0xa3609fe62703a8eb,0x26929e55a3bf2818,0x20b9a72828eba8d0,0x1f1e2301a7d328ff,0x2790a8f628c8a692,0xa30127b2a8f628d0,0x2906a8ad26449e55,0xa7d328f6a8d72728,0x2876a59f1bef23bf
.quad 0xa8ff28d0a7282241,0x24988000a4982818,0xa8b626dea1e09e55,0x9d8c259fa85d290b,0xa64420b91fe6a5f3,0xa6de28ada90e2882,0x9d8ca17e266ba882,0xa8f128f6a827254a,0x23bfa72828ada90f,0xa8ad2728a3bf0000,0x2809a8df2909a882,0xa5751fe61f1ea54a,0x2906a8eb2835a5f3,0x165ba3bf26dea882,0x28a3a76e24c59e55,0x261ca83528e5a90b
.quad 0x290fa81822412241,0xa81822412241a818,0x27d3a17ea2a12818,0x9f1ea43d285da90b,0x1fe623bfa835290f,0x259fa8ad28f6a728,0xa4c5286aa90d2818,0x28f1a8bf261c9a5a,0xa8ad28ffa7b22241,0x2850a4989a5a25f3,0xa8d726dea056a241,0x211c217ea74b28eb,0xa59f1a5a243da818,0xa4f22850a90e2882,0x1befa59f2876a90f,0xa8d728f6a7d323bf
.quad 0x2728a8d028ffa818,0xa88225f39e55a241,0x2909a8bf2703a241,0xa2a19cc22575a850,0x2835a54a1cc22241,0x243da7b228dfa8ff,0x21e01cc2a51e2818,0x28b6a90e288da692,0xa3bf2728a8ad290f,0x28ada72823bf8000,0xa8762906a8e52818,0x240e965ba2a12692,0xa8f62850a6442241,0xa3012692a86a28ff,0xa66b2301925ca241,0xa88d2906a8f12850
.quad 0x22412241a818290f,0x2241a818290fa818,0xa51e2898a8fb2728,0x28c8a8df266b9a5a,0xa8f628ada59f0000,0x2835a3bf9fe62728,0xa80923012056a728,0x18c424f2a876290b,0x9a5aa4982850a90f,0xa7b228ffa8ad25f3,0x2703a8df28e5a728,0xa8f1276ea1e0a0b9,0x290ea85024f28000,0xa43d9a5a259fa882,0x266b9fe6a1e02728,0x24c5a8352909a8ad
.quad 0x9e5525f3a882290f,0x28ffa8d02728a241,0xa8432906a8c82728,0x274ba3019bef254a,0xa8df27b2a43d0000,0x9cc2254aa83528ff,0xa46b165b2360a728,0xa85d2906a8d727b2,0x23bfa72828ada90f,0xa8ad2728a3bf0000,0x28c8a90e28a3a728,0xa11c9cc224c5a7b2,0x286aa69223018000,0x2644a85028f6a8ff,0x20561cc2a46b2728,0x290fa8bf27d3a54a
.quad 0xa818290fa8182241,0x290fa81822412241,0xa8b6259f125ca5f3,0x24c51cc2a6b928eb,0x9fe6a3bf2835a90f,0xa59f28ada8f62728,0x274ba8f628b6a5f3,0xa90927f2a2a1a0b9,0x28eba72820b92241,0xa3bf9e552692a8d0,0x22a11fe6a6b928d0,0x266ba8bf28fba7b2,0xa64428ada9062818,0x28f6a7b223011e55,0xa9092835a4c50000,0x21e01fe6a66b28ad
.quad 0xa49800002498a818,0xa72828d0a8ff2818,0x251ea8352903a8d0,0xa8d7276ea3609a5a,0x290ea8ad26dea241,0x9fe6a0b92644a882,0x25c99fe6a05625f3,0x27d3a8df2903a850,0xa3bf2728a8ad290f,0x28ada72823bf8000,0xa8fb28f6a84325f3,0x1bef217ea61c2850,0xa6de23bf965ba241,0xa83528eba9062882,0x211ca59f2809a8d0,0xa87626dea40e1a5a
.quad 0xa81822412241a818,0x22412241a818290f,0x2056a76e2903a882,0xa809290ea84323bf,0x28f6a8ad259f8000,0xa83523bf1fe6a728,0x25c9965ba51e2882,0x211ca76e28fba8ad,0xa54a2882a90b2818,0x290ba882254a8000,0xa90327f2a3609e55,0x240e1cc2a61c28ad,0xa17ea0b926dea8d0,0xa76e28eba8df2728,0x27d3a8f628d7a728,0xa876259f9befa3bf
.quad 0x2882a5f31e552241,0x1e55a5f32882a90f,0x98c424f2a82728ff,0x28fba8df2790a3bf,0xa8bf290ba86a25f3,0x24f29a5aa3012728,0xa703230118c4a498,0xa6b92898a90f28ad,0x23bfa72828ada90f,0xa8ad2728a3bf0000,0x290fa8bf2790a498,0x18c4a43d274ba8ad,0x243d9a5aa17e25f3,0x28dfa90b2898a728,0xa6b9286aa8fb28ff,0x25c9a17e98c423bf
.quad 0x2241a818290fa818,0xa818290fa8182241,0x290da7f221e02241,0xa74b1fe6240ea850,0x1fe623bfa835290f,0x259fa8ad28f6a728,0xa88d2906a7d32241,0x28a3a59f125c254a,0xa6921e5523bfa818,0xa0b92728a8eb28d0,0x25c9a8982909a818,0xa90d2835a46b9a5a,0x28bfa6921fe62241,0x9cc2a3bf27f2a8ff,0x9bef259fa876290f,0x28d7a8f627d3a3bf
.quad 0xa8ff28d0a7282241,0x24988000a4982818,0xa40e965b24c5a818,0xa80928f6a8e527b2,0x27f2a8eb28f6a818,0xa76e23bf165ba498,0x2809a4f21bef2241,0x2575a83528fba8eb,0xa3bf2728a8ad290f,0x28ada72823bf8000,0xa903286aa66b2241,0xa056259fa82728eb,0x9cc2a0b9259fa818,0xa90e28ada76e2498,0x28b6a90e28d7a818,0x9d8c9fe6251ea7b2
.quad 0x290fa81822412241,0xa81822412241a818,0x1bef24f2a88d28ff,0x25c9a8bf28e5a692,0xa8f628ada59f0000,0x2835a3bf9fe62728,0xa1e0a17e2790a8ff,0xa5752898a90327b2,0x28ada8ff27b2a241,0xa85024981a5aa5f3,0x24c5165ba5752882,0x251ea86a290fa850,0xa835290ba89825f3,0x286aa54a165b2498,0xa66b1fe621e0a728,0xa4c52835a90928ad
.quad 0x2728a8d028ffa818,0xa88225f39e55a241,0x27d3a43d925c2498,0x246ba7f228f1a8eb,0xa59f2850a90628d0,0x2898a692217e1e55,0xa8762644a11c9e55,0xa40e276ea8c8290b,0x23bfa72828ada90f,0xa8ad2728a3bf0000,0x28d7a7f2251e9e55,0x2360a6de288da90b,0x9fe6254aa7f228d0,0x28bfa7b224f29e55,0xa9092898a74b2498,0xa2a12644a84328eb
.quad 0x22412241a818290f,0x2241a818290fa818,0xa8e528bfa5c90000,0x288da4f29bef2692,0x9fe6a3bf2835a90f,0xa59f28ada8f62728,0x2903a89825758000,0xa790217e21e0a7b2,0x1a5a2498a850290f,0x27b2a8ff28ada5f3,0xa90f286aa51e0000,0x2575965ba4c52850,0x165ba54a286aa90f,0xa898290ba8352498,0x2909a83524c58000,0xa1e09fe6266ba8ad
.quad 0x9e5525f3a882290f,0x28ffa8d02728a241,0xa8f127f2a46b0000,0x125c243da7d328eb,0x217ea6922898a90f,0xa9062850a59f1e55,0x28c8a76e240e8000,0x211ca6442876a90b,0xa3bf2728a8ad290f,0x28ada72823bf8000,0xa88d26dea3600000,0xa51e27f2a8d7290b,0x24f2a7b228bfa90f,0xa7f2254a9fe69e55,0x2843a64422a18000,0x274ba8982909a8eb
.quad 0xa818290fa8182241,0x290fa81822412241,0xa40e9fe6274ba8ff,0xa1e027f2a90d2850,0x28f6a8ad259f8000,0xa83523bf1fe6a728,0x925c259fa8a328ff,0x27d3a906288da54a,0xa8eb2728a0b9a241,0x23bf1e55a69228d0,0x246ba835290da882,0xa9092898a5c91a5a,0x27f2a3bf9cc225f3,0x1fe6a69228bfa8ff,0xa7d328f6a8d72728,0x2876a59f1bef23bf
.quad 0xa49800002498a818,0xa72828d0a8ff2818,0x28e5a8f62809a498,0xa4c5165b240ea7b2,0x165b23bfa76e28d0,0x28f6a8eb27f2a498,0xa8fb2835a5751e55,0x9bef24f2a80928eb,0x23bfa72828ada90f,0xa8ad2728a3bf0000,0x2827a59f20561e55,0x266ba86a2903a8eb,0xa76e28ada90e28d0,0x259fa0b99cc22498,0xa51e1fe61d8ca498,0xa8d7290ea8b627b2
.quad 0xa81822412241a818,0x22412241a818290f,0x2843a90e2809a241,0xa903276ea056a3bf,0x1fe623bfa835290f,0x259fa8ad28f6a728,0xa8fb276ea11ca241,0x251e165ba5c928ad,0x254aa882290ba818,0xa90b2882a54a0000,0x261c9cc2a40e2818,0x2360a7f22903a8ad,0xa8df28eba76e2241,0x26dea0b9a17e2728,0x1befa59f2876a90f,0xa8d728f6a7d323bf
.quad 0x2882a5f31e552241,0x1e55a5f32882a90f,0xa79028dfa8fb2818,0x2827a4f218c423bf,0xa3019a5a24f2a818,0xa86a290ba8bf2728,0x290fa89826b9a241,0x98c4a3012703a8ad,0xa3bf2728a8ad290f,0x28ada72823bf8000,0xa74b243d98c4a241,0xa79028bfa90f28ad,0x2898a90b28dfa818,0xa17e9a5a243da728,0x18c4217ea5c92818,0x28fba86a26b9a3bf
.quad 0x2241a818290fa818,0xa818290fa8182241,0x26b99cc2a4c52882,0x925ca59f28b6a8eb,0xa8f628ada59f0000,0x2835a3bf9fe62728,0x22a1a7f22909a882,0xa8b628f6a74b20b9,0x26929e55a3bf2818,0x20b9a72828eba8d0,0xa8fb28bfa66b1e55,0x26b99fe6a2a127b2,0x2301a7b228f6a8d0,0xa90628ada6441e55,0x266b9fe6a1e02728,0x24c5a8352909a8ad
.quad 0xa8ff28d0a7282241,0x24988000a4982818,0x2360a76e28d7a8ff,0xa9032835a51e1a5a,0x2644a0b99fe625f3,0x26dea8ad290ea882,0xa90328dfa7d32498,0x20561fe6a5c92850,0x23bfa72828ada90f,0xa8ad2728a3bf0000,0x261ca17e9bef2498,0x2843a8f628fba850,0xa90628eba83525f3,0x965b23bfa6de2882,0x240ea6de2876a8ff,0xa809259fa11c9a5a
.quad 0x290fa81822412241,0xa81822412241a818,0xa66b28dfa8c825f3,0x28fba898251e1a5a,0x9fe6a3bf2835a90f,0xa59f28ada8f62728,0x2876a4f298c425f3,0xa056a3012809a90b,0xa8ad28ffa7b22241,0x2850a4989a5a25f3,0x21e0a76e28f1a8d0,0xa8e528dfa70320b9,0x259f9a5aa43d2818,0x24f2a850290ea882,0xa9092835a4c50000,0x21e01fe6a66b28ad
.quad 0x2728a8d028ffa818,0xa88225f39e55a241,0x1bef2301a74b28d0,0x28c8a9062843a54a,0xa835254a9cc2a241,0xa43d27b2a8df28ff,0x28d7a906285da5f3,0xa360965b246ba7b2,0xa3bf2728a8ad290f,0x28ada72823bf8000,0xa4c51cc2211ca5f3,0xa8a3290ea8c827b2,0x28f6a8502644a241,0x2301a692286aa8ff,0xa7d328bfa90f28d0,0x246b9cc2a056254a
.quad 0x22412241a818290f,0x2241a818290fa818,0xa85d243d1f1ea728,0x22a1217ea7d3290b,0x28f6a8ad259f8000,0xa83523bf1fe6a728,0xa61c28bfa8f12728,0x290da86a24c51a5a,0x9a5aa4982850a90f,0xa7b228ffa8ad25f3,0x274ba17ea11c2728,0x2056a6de28d7a8eb,0xa90e2850a4f20000,0x243d1a5aa59f2882,0x27d3a8f628d7a728,0xa876259f9befa3bf
.quad 0x9e5525f3a882290f,0x28ffa8d02728a241,0xa5751cc222a1a728,0xa70328bfa9092850,0x28dfa7b2243d8000,0x1cc2a54a2835a8ff,0xa88d290ea8b62728,0x251e9cc2a1e02692,0x23bfa72828ada90f,0xa8ad2728a3bf0000,0x22a1165ba40e2728,0x28e5a9062876a692,0xa86a2692a3010000,0xa6442850a8f628ff,0x28f1a906288da728,0x125ca301266ba850
.quad 0xa818290fa8182241,0x290fa81822412241,0x2360a835290fa818,0xa8762906a79020b9,0x1fe623bfa835290f,0x259fa8ad28f6a728,0xa7031fe62360a818,0x9bef2644a8c828eb,0x28eba72820b92241,0xa3bf9e552692a8d0,0xa8c828f6a7902241,0x27d3a3019f1e2692,0x2644a8ad2906a818,0xa8f627b2a3019e55,0x9bef259fa876290f,0x28d7a8f627d3a3bf
.quad 0xa49800002498a818,0xa72828d0a8ff2818,0x285da59f1d8c2241,0x21e0a6de28b6a90b,0xa90e28ada6de2241,0x1fe620b9a6442882,0x2827a8f628f1a818,0xa66b217e1d8ca54a,0xa3bf2728a8ad290f,0x28ada72823bf8000,0x9f1e9fe62575a818,0xa90928dfa809254a,0x26dea3bf165b2241,0x2835a8eb2906a882,0xa8e52835a61c2241,0xa4c5276ea8a3290b
.quad 0xa81822412241a818,0x22412241a818290f,0x28f1a6de1d8c2498,0xa61c165b2575a8ad,0xa8f628ada59f0000,0x2835a3bf9fe62728,0x2827a90e285da498,0xa8e526de9f1ea3bf,0xa54a2882a90b2818,0x290ba882254a8000,0x1d8ca64428b6a8ff,0xa8a32906a80923bf,0x217e20b9a6de28d0,0x276ea8eb28dfa728,0xa66b1fe621e0a728,0xa4c52835a90928ad
.quad 0x2882a5f31e552241,0x1e55a5f32882a90f,0xa90d286aa5c91e55,0x1f1e217ea6b928ad,0x28bfa90b286aa5f3,0xa4f21a5a2301a728,0xa74b28bfa90d2882,0x2790a43d125c23bf,0x23bfa72828ada90f,0xa8ad2728a3bf0000,0x125c2301a6b92882,0x290da8982703a3bf,0xa43d1a5a217ea5f3,0xa8df290ba8982728,0x2790a4f21f1e1e55,0x2827a8df290da8ad
.quad 0x2241a818290fa818,0xa818290fa8182241,0x98c42644a8d728d0,0x2703a8f628a3a54a,0x9fe6a3bf2835a90f,0xa59f28ada8f62728,0x246b1cc2a66b28d0,0x240ea835290fa850,0xa6921e5523bfa818,0xa0b92728a8eb28d0,0x2827a43d9bef25f3,0x18c4a59f288da90b,0xa8bf26929fe6a241,0x1cc223bfa7f228ff,0x2909a83524c58000,0xa1e09fe6266ba8ad
.quad 0xa8ff28d0a7282241,0x24988000a4982818,0x28a3a90e2876a5f3,0xa61c1fe6211ca692,0xa7f228eba8f62818,0x276ea3bf965b2498,0x261ca86a2909a8d0,0xa843259f9f1ea0b9,0xa3bf2728a8ad290f,0x28ada72823bf8000,0x1d8ca4f227d3a8d0,0xa8f12835a5c920b9,0x1cc220b9a59f2818,0x290ea8ad276ea498,0xa360165b21e0a5f3,0xa90328f6a85d2692
.quad 0x290fa81822412241,0xa81822412241a818,0xa909286aa46b9e55,0x2827a301a11c27b2,0x28f6a8ad259f8000,0xa83523bf1fe6a728,0xa8d728dfa6b91e55,0x2843a43d9d8c2692,0x28ada8ff27b2a241,0xa85024981a5aa5f3,0xa876290ea8432498,0x285da4f2925c254a,0x2835a90b2898a5f3,0xa86a254a965ba498,0xa7d328f6a8d72728,0x2876a59f1bef23bf
.quad 0x2728a8d028ffa818,0xa88225f39e55a241,0xa66b2898a90f2882,0x288da644205620b9,0x259fa8502906a8d0,0xa8982692a17e9e55,0xa4c527f2a8e528ff,0x28a3a6de22a11a5a,0x23bfa72828ada90f,0xa8ad2728a3bf0000,0xa1e02644a85d28ff,0x28b6a76e246b9a5a,0x1fe6a54a27f2a8d0,0xa8bf27b2a4f21e55,0x9bef243da7032882,0x28c8a7f22575a0b9
.quad 0x290f,0x0,0xa90f,0x0,0x290f,0x0,0xa90f,0x0,0x290f,0x0,0xa90f,0x0,0x290f,0x0,0xa90f,0x0
.quad 0x290f,0x0,0xa90f,0x0,0x290f,0x0,0xa90f,0x0,0x290f,0x0,0xa90f,0x0,0x290f,0x0,0xa90f
.zero 776
.quad 0xa818290fa8182241,0x290fa81822412241,0xa84a290ea8012211,0x2901a75d202523ee,0xa8762909a7d321e0,0x28d7a66b1bef24c5,0xa89e2901a7a121af,0x2893a55f8e5c258a,0xa8bf28f6a76e217e,0x2835a43d9cc22644,0xa8db28e8a73a214d,0x277fa211a08826f1,0xa8f128d7a703211c,0x266b9f1ea2a12790,0xa90128c4a6cc20eb,0x253497f2a4542810
.quad 0xa90b28ada69220b9,0x23bf1a5aa54a2850,0xa90f2893a6582088,0x20eb2025a6302888,0xa90d2876a61c2056,0x1bef22a1a70328b6,0xa9052857a5de2025,0x97f22481a7c228db,0xa8f62835a59f1fe6,0x9fe6259fa83528f6,0xa8e22810a55f1f82,0xa2d126a6a87c2908,0xa8c827d3a51e1f1e,0xa4c52790a8b6290f,0xa8a8277fa4dc1eb9,0xa607282ea8e2290c
.quad 0xa81822412241a818,0x22412241a818290f,0xa6a61c5d24dca888,0xe5c25b4a8bb28e8,0xa4c59bef266ba8d7,0xa1e027d3a9092876,0xa14da21127c2a905,0xa5b428a8a8fd277f,0x965ba4f2286aa90e,0xa7f22906a898259f,0x1f82a6a628cca8f4,0xa8bb28fda7c222d1,0x240ea8092903a8b6,0xa90d288da5c91bef,0x2607a893290ea857,0xa8e8277fa2d19df0
.quad 0x27b2a8eb28eba7b2,0xa850254a9a5aa3bf,0x287ca90f289ea67f,0xa6a6214d1f82a607,0x28e5a8fb2827a51e,0xa40e925c246ba7d3,0x290fa8b12716a331,0x9c5da21126a6a893,0x28f6a835259f9fe6,0x1fe6a59f2835a8f6,0x289ea71623ee94c5,0x24dca7c228cca90e,0x2809a57520561d8c,0x274ba8a3290da8d7,0x267fa33114c52211,0x2888a90528f4a857
.quad 0x2241a818290fa818,0xa818290fa8182241,0x267fa8e228c4a5de,0xa8fd2893a5089b25,0x2876a90927d3a1e0,0xa8d7266b9befa4c5,0x2908a888253414c5,0xa75d20eb2271a7e3,0x28dfa6de1fe62301,0xa3019fe626dea8df,0x2801a3909df02658,0x1c5da60728a8a905,0x251e925ca4c52843,0x2575a876290fa85d,0x1df022d1a77f28e8,0x2857a90e2893a607
.quad 0xa0b92692a8ad290b,0x290ba8ad2692a0b9,0xa5de2870a90e28a8,0x28b1a6cc21af1eb9,0xa8432903a8d72790,0x26b9a1e09d8c2575,0xa8f928eea8102508,0x214d1df0a55f282e,0xa8f62835a59f1fe6,0x9fe6259fa83528f6,0xa83c25dea0eb9d27,0xa6302857a8fd28f4,0xa5c9211c1befa46b,0xa88d2909a8e52827,0xa0889c5d2454a716,0xa90f28c4a7e3255f
.quad 0x290fa81822412241,0xa81822412241a818,0x2857a4259f82273a,0xa271a1af27e3a90c,0x24c51befa66b28d7,0x21e0a7d32909a876,0x97f225dea8b128f9,0x2801a90a287ca508,0xa59f2898a90627f2,0x290ea86a24f2165b,0xa893290aa81f2425,0x283ca481998f25b4,0xa9092827a46b98c4,0x23601d8ca61c28a3,0xa810245417f2a534,0xa0eb26cca8c42901
.quad 0xa3bf9a5a254aa850,0xa7b228eba8eb27b2,0x1df0a5b42864a90c,0xa90a28bba6f12211,0x266ba88d290fa8a3,0xa85d25c99f1ea11c,0x28c4a90c287ca658,0xa4250e5c23eea75d,0x28f6a835259f9fe6,0x1fe6a59f2835a8f6,0x277fa4811b2521af,0x275da8b1290fa8bb,0x21e018c4a40e2703,0x2903a8f12843a61c,0xa0eb258aa80128cc,0x287ca6f124259b25
.quad 0x22412241a818290f,0x2241a818290fa818,0xa390283ca90f2810,0x287ca905277fa088,0xa8762909a7d321e0,0x28d7a66b1bef24c5,0xa8f4273aa088a2d1,0x24dc198fa60728bb,0xa6441cc2243da835,0xa17e276ea8f628bf,0x14c5a55f287ca90e,0xa864290fa85724dc,0x26b9a8c828fba7d3,0xa8e5274ba1e0a056,0x2901a8c426cca0eb,0xa53417f22454a810
.quad 0x2850a54a1a5a23bf,0x20b9a69228ada90b,0x22711d27a58a2857,0x284aa90828c4a716,0xa360274ba8c82909,0x28f1a80924c598c4,0xa870290aa8cc277f,0x258a9eb9a0eb2630,0xa8f62835a59f1fe6,0x9fe6259fa83528f6,0xa6582211198fa454,0xa82e28eea9012864,0x125ca36026b9a876,0xa8fb285da66b22a1,0x26a6a86428f9a901,0xa5de21af17f2a390
.quad 0xa818290fa8182241,0x290fa81822412241,0xa8ee26cc9d27a4af,0x260794c5a58a28b1,0xa4c59bef266ba8d7,0xa1e027d3a9092876,0x2331a810290ca870,0xa8c428eea7162025,0x28bfa8f6276ea17e,0xa835243d1cc2a644,0x2870a5340e5c2508,0x97f2a4af284aa90f,0x205621e0a74b28e5,0x27d3a8fb28c8a6b9,0xa6072893a90e2857,0x28e8a77f22d11df0
.quad 0xa90b28ada69220b9,0x23bf1a5aa54a2850,0xa73a22d11c5da55f,0xa534283ca90528cc,0x18c4a4c52809a8f1,0xa90928c8a74b2360,0x2801a8e828fda83c,0xa6cc22711b25a4dc,0x28f6a835259f9fe6,0x1fe6a59f2835a8f6,0x25089df0a08825b4,0x2893a90c28d4a7e3,0xa2a1266ba85d28fb,0x2876a6b92360925c,0xa8b1290ea8db281f,0x1df01f82a50827a1
.quad 0xa81822412241a818,0x22412241a818290f,0x198fa65828dba8cc,0xa71628f9a89e2534,0x2876a90927d3a1e0,0xa8d7266b9befa4c5,0x2864a4af9b252630,0x9f82a390281fa90e,0x165b24f2a86a290e,0x27f2a9062898a59f,0xa82e290ca888258a,0x289ea5de1b252454,0xa8a3261c9d8ca360,0x18c4246ba8272909,0x9df0a2d1277fa8e8,0xa857290ea8932607
.quad 0x27b2a8eb28eba7b2,0xa850254a9a5aa3bf,0x28d4a75d23311b25,0x198fa508282ea901,0x211c1f1ea5c9285d,0x28a3a90f288da66b,0xa6f128a8a90f289e,0x27e3a4af198f22d1,0xa8f62835a59f1fe6,0x9fe6259fa83528f6,0xa3318e5c2390a6f1,0xa8db290aa88826cc,0x261ca84328f1a903,0xa703240e98c4a1e0,0x290aa89e275da4af,0x2271a630283ca8e8
.quad 0x2241a818290fa818,0xa818290fa8182241,0x290aa86424541eb9,0xa81f22d1214da7c2,0x24c51befa66b28d7,0x21e0a7d32909a876,0xa65828cca8e826f1,0x290fa85724811c5d,0xa8df26de9fe6a301,0x23011fe6a6de28df,0x9d27a3ee2810a908,0xa7e32901a8b12630,0x285da90f2876a575,0xa84324c5125ca51e,0x2810a45497f22534,0x20eba6cc28c4a901
.quad 0xa0b92692a8ad290b,0x290ba8ad2692a0b9,0xa8fd28dba77f2390,0x23ee17f2a4dc281f,0xa5751d8c21e0a6b9,0xa79028d7a9032843,0x25b4a84a2901a8e2,0xa8642607a0889f82,0x28f6a835259f9fe6,0x1fe6a59f2835a8f6,0x20251eb9a5342801,0x2905a8e8281fa58a,0xa82728e5a909288d,0x246b9befa11c25c9,0xa84a2658a2d10e5c,0xa73a2893a90828ee
.quad 0x290fa81822412241,0xa81822412241a818,0x20eb2331a82e290f,0x2481a8702908a7a1,0xa8762909a7d321e0,0x28d7a66b1bef24c5,0xa6cc1eb923eea82e,0x9d27267fa8d428e2,0x259fa8982906a7f2,0xa90e286aa4f2965b,0x28c4a67f1eb92331,0xa025a27127a1a8f9,0x9bef25c9a88d290d,0x28b6a9032809a40e,0xa90128c4a6cc20eb,0x253497f2a4542810
.quad 0xa3bf9a5a254aa850,0xa7b228eba8eb27b2,0x2810a8f928e2a7a1,0xa7c2242514c5a4af,0x27d3a46b125c240e,0x251ea82728fba8e5,0xa45427a1a8d42908,0x28bba73a239014c5,0xa8f62835a59f1fe6,0x9fe6259fa83528f6,0x97f2a271267fa870,0xa90f28a8a73a2425,0x28d7a90d28a3a74b,0x9d8ca0562575a809,0x2534a0259d272481,0x28d4a90f28bba7c2
.quad 0x22412241a818290f,0x2241a818290fa818,0xa8a828f4a6f11df0,0x28d4a63017f2255f,0xa4c59bef266ba8d7,0xa1e027d3a9092876,0x283ca90f284aa454,0xa8db26a69df0a425,0x26449cc2a43d2835,0x217ea76e28f6a8bf,0xa75d28eea8d426cc,0x28e2a71620eb21af,0xa79022a11f1ea66b,0xa11c2703a8d728f1,0x2607a893290ea857,0xa8e8277fa2d19df0
.quad 0x2850a54a1a5a23bf,0x20b9a69228ada90b,0xa4812801a8f428e8,0x28eea7e324540e5c,0xa8b62703a2a19bef,0xa056261ca876290d,0x21afa67f2888a90e,0xa8f4281fa5341d27,0x28f6a835259f9fe6,0x1fe6a59f2835a8f6,0x9c5d24afa7a128c4,0x28f9a84a2607a14d,0xa90f28b6a79024c5,0x9f1e251ea7d328c8,0x998fa14d25b4a810,0xa8fd2870a6cc23ee
.quad 0xa818290fa8182241,0x290fa81822412241,0xa55f97f22630a8d4,0x9df026f1a8f428a8,0x2876a90927d3a1e0,0xa8d7266b9befa4c5,0x24251df0a6a628db,0x2454a84a290fa83c,0xa8bf28f6a76e217e,0x2835a43d9cc22644,0xa1afa0eb2716a8e2,0xa6cc28d4a8ee275d,0x28f1a8d72703a11c,0xa66b1f1e22a1a790,0x1df022d1a77f28e8,0x2857a90e2893a607
.quad 0xa90b28ada69220b9,0x23bf1a5aa54a2850,0x8e5ca45427e3a8ee,0xa8e828f4a8012481,0x290da876261ca056,0x9befa2a12703a8b6,0x9d272534a81f28f4,0x290ea888267fa1af,0xa8f62835a59f1fe6,0x9fe6259fa83528f6,0x214da607284aa8f9,0xa8c427a1a4af1c5d,0x28c8a7d3251e9f1e,0x24c5a79028b6a90f,0xa3ee26cca87028fd,0x2810a5b4214d198f
.quad 0xa81822412241a818,0x22412241a818290f,0x27a1a9082870a481,0xa90f282ea331a0eb,0x24c51befa66b28d7,0x21e0a7d32909a876,0xa8e228d4a67f1d27,0x282ea3ee9eb926cc,0x965ba4f2286aa90e,0xa7f22906a898259f,0x28f9a7a122712025,0xa3319eb9267fa8c4,0xa40e2809a90328b6,0x290da88d25c99bef,0xa810245417f2a534,0xa0eb26cca8c42901
.quad 0x27b2a8eb28eba7b2,0xa850254a9a5aa3bf,0x24af94c5a42527c2,0x27a1a8e228f9a810,0xa8e528fba827251e,0x240e125ca46b27d3,0x94c5a390273aa8bb,0xa90828d4a7a12454,0x28f6a835259f9fe6,0x1fe6a59f2835a8f6,0xa425273aa8a8290f,0x2870a67f227117f2,0xa8092575a0569d8c,0xa74b28a3a90d28d7,0x27c2a8bb290fa8d4,0xa4811d272025a534
.quad 0x2241a818290fa818,0xa818290fa8182241,0x27c2a14da2d1281f,0x9eb9a4542864a90a,0xa8762909a7d321e0,0x28d7a66b1bef24c5,0x9c5da4812857a90f,0xa6f128e8a8cc2658,0x28dfa6de1fe62301,0xa3019fe626dea8df,0xa63028b1a90127e3,0x2908a81023ee1d27,0xa51e125c24c5a843,0xa5752876a90f285d,0x2901a8c426cca0eb,0xa53417f22454a810
.quad 0xa0b92692a8ad290b,0x290ba8ad2692a0b9,0xa81f24dc97f2a3ee,0xa390277fa8db28fd,0x2843a90328d7a790,0xa6b921e01d8ca575,0x1f822088a6072864,0x28e2a901284aa5b4,0xa8f62835a59f1fe6,0x9fe6259fa83528f6,0x258aa81f28e8a905,0xa80125349eb9a025,0x25c9a11c9bef246b,0x288da90928e5a827,0xa8ee2908a893273a,0x8e5c22d1a658284a
.quad 0x290fa81822412241,0xa81822412241a818,0xa534289ea8f92716,0x28cca8db2658998f,0xa4c59bef266ba8d7,0xa1e027d3a9092876,0x290ea81f23901f82,0xa6301b2524afa864,0xa59f2898a90627f2,0x290ea86a24f2165b,0xa4549b2525dea89e,0xa58a2888a90c282e,0x2909a827246b18c4,0xa3609d8c261ca8a3,0xa6072893a90e2857,0x28e8a77f22d11df0
.quad 0xa3bf9a5a254aa850,0xa7b228eba8eb27b2,0x2901a82e2508998f,0x9b25a331275da8d4,0xa66b288da90f28a3,0x285da5c91f1e211c,0xa2d1998f24afa7e3,0xa89e290fa8a826f1,0x28f6a835259f9fe6,0x1fe6a59f2835a8f6,0xa6cc2888a90a28db,0x26f1a3900e5c2331,0xa1e098c4240ea703,0xa90328f1a843261c,0x28e8a83c2630a271,0x24afa75d289ea90a
.quad 0x22412241a818290f,0x2241a818290fa818,0xa8b1258a14c5a607,0x24af1d27a6cc28ee,0x2876a90927d3a1e0,0xa8d7266b9befa4c5,0xa0252716a8ee28c4,0x2870a90c2810a331,0xa6441cc2243da835,0xa17e276ea8f628bf,0x290fa84a24af17f2,0xa5088e5c2534a870,0xa6b928c8a8fb27d3,0x28e5a74b21e02056,0x9df0a2d1277fa8e8,0xa857290ea8932607
.quad 0x2850a54a1a5a23bf,0x20b9a69228ada90b,0xa8cc2905a83c2534,0x255f9c5da2d1273a,0x2360a74b28c8a909,0xa8f12809a4c518c4,0x24dc9b25a27126cc,0x283ca8fd28e8a801,0xa8f62835a59f1fe6,0x9fe6259fa83528f6,0x27e3a8d4290ca893,0xa5b420881df0a508,0x925c2360a6b92876,0x28fba85d266ba2a1,0xa7a125089f829df0,0xa81f28dba90e28b1
.quad 0xa818290fa8182241,0x290fa81822412241,0x2088a77f2905a87c,0xa810290fa83c2390,0x24c51befa66b28d7,0x21e0a7d32909a876,0xa8bb2607998fa4dc,0x22d12088a73a28f4,0x28bfa8f6276ea17e,0xa835243d1cc2a644,0xa4dc2857a90f2864,0x290ea87c255f94c5,0xa056a1e0274ba8e5,0xa7d328fba8c826b9,0x2810a45497f22534,0x20eba6cc28c4a901
.quad 0xa90b28ada69220b9,0x23bf1a5aa54a2850,0x2716a8c42908a84a,0xa857258a9d27a271,0x98c424c5a80928f1,0x2909a8c8274ba360,0xa63020eb1eb9a58a,0xa77f28cca90a2870,0x28f6a835259f9fe6,0x1fe6a59f2835a8f6,0xa8642901a8ee282e,0x2454998fa2112658,0x22a1a66b285da8fb,0xa87626b9a360125c,0x239097f2a1af25de,0x2901a8f92864a6a6
.quad 0xa81822412241a818,0x22412241a818290f,0x290ca7e321af2271,0xa73a1f822425a857,0xa8762909a7d321e0,0x28d7a66b1bef24c5,0x2508a87c290aa801,0xa8f928b1a5de17f2,0x165b24f2a86a290e,0x27f2a9062898a59f,0xa5b4198f2481a83c,0xa425281fa90a2893,0x28a3a61c1d8c2360,0x98c4a46b2827a909,0xa90128c4a6cc20eb,0x253497f2a4542810
.quad 0x27b2a8eb28eba7b2,0xa850254a9a5aa3bf,0xa21126f1a8bb290a,0x290ca86425b49df0,0xa11c9f1e25c9a85d,0xa8a3290fa88d266b,0x275da3ee8e5c2425,0x2658a87c290ca8c4,0xa8f62835a59f1fe6,0x9fe6259fa83528f6,0x28bba90f28b1a75d,0xa1af9b252481a77f,0xa61c2843a8f12903,0x2703a40e18c421e0,0x1b25a42526f1a87c,0xa8cc2801a58a20eb
.quad 0x2241a818290fa818,0xa818290fa8182241,0x1b252508a89328fd,0x25dea8c428e2a67f,0xa4c59bef266ba8d7,0xa1e027d3a9092876,0x27e3a271a0eb275d,0x94c5a5342888a908,0xa8df26de9fe6a301,0x23011fe6a6de28df,0x2905a8a826079c5d,0xa6581df02390a801,0xa85d290fa8762575,0x2843a4c5925c251e,0x2607a893290ea857,0xa8e8277fa2d19df0
.quad 0xa0b92692a8ad290b,0x290ba8ad2692a0b9,0x9eb9a1af26cca8b1,0xa8a8290ea87025de,0x25759d8ca1e026b9,0x2790a8d72903a843,0xa82e255f9df0a14d,0xa5082810a8ee28f9,0x28f6a835259f9fe6,0x1fe6a59f2835a8f6,0xa8f428fda8572630,0x1d2720eba5de283c,0x2827a8e52909a88d,0xa46b1bef211ca5c9,0xa55f27e3a8c4290f,0x2716a4541c5d2088
.quad 0x290fa81822412241,0xa81822412241a818,0xa8e828bba5b48e5c,0x2888a4dc9c5d26a6,0x2876a90927d3a1e0,0xa8d7266b9befa4c5,0xa77f28fda8a825b4,0x2905a7c22211214d,0x259fa8982906a7f2,0xa90e286aa4f2965b,0xa2d127c2a8fd28bb,0x28f4a8cc26a69f82,0x1befa5c9288da90d,0xa8b62903a809240e,0x1df022d1a77f28e8,0x2857a90e2893a607
.quad 0xa3bf9a5a254aa850,0xa7b228eba8eb27b2,0x26079f82a14d26a6,0x267fa89e290fa87c,0xa7d3246b925ca40e,0xa51e2827a8fb28e5,0x2893a6a622111c5d,0x2331a71628b1a90f,0xa8f62835a59f1fe6,0x9fe6259fa83528f6,0x290ea8cc27c2a4dc,0x14c5a3ee2716a89e,0xa8d7290da8a3274b,0x1d8c2056a5752809,0x2857a8f42905a888,0xa21194c52331a67f
.quad 0x22412241a818290f,0x2241a818290fa818,0xa3eea025275da901,0xa2112801a90e284a,0x24c51befa66b28d7,0x21e0a7d32909a876,0xa58a0e5c255fa893,0xa1af27a1a901289e,0x26449cc2a43d2835,0x217ea76e28f6a8bf,0xa6f120882211a77f,0xa14d273aa8e828db,0x2790a2a19f1e266b,0x211ca70328d7a8f1,0xa810245417f2a534,0xa0eb26cca8c42901
.quad 0x2850a54a1a5a23bf,0x20b9a69228ada90b,0xa8882630a025a0eb,0xa0882658a893290f,0x28b6a70322a11bef,0x2056a61c2876a90d,0xa8db27c2a48117f2,0xa02525dea8572905,0x28f6a835259f9fe6,0x1fe6a59f2835a8f6,0xa908287ca6a622d1,0x9f82255fa81028e2,0x290fa8b62790a4c5,0x1f1ea51e27d3a8c8,0xa90c28e2a82e2607,0x9eb924dca77f28a8
.quad 0x28d0a8d025f30000,0xa8d025f30000a5f3,0x28e5a8bf25c90000,0xa88d24f21befa692,0x28f6a8ad259f0000,0xa83523bf1fe6a728,0x2903a89825750000,0xa790217e21e0a7b2,0x290ba882254a0000,0xa6921e5523bfa818,0x290fa86a251e0000,0xa575165b24c5a850,0x290ea85024f20000,0xa43d9a5a259fa882,0x2909a83524c50000,0xa1e09fe6266ba8ad
.quad 0x28ffa81824980000,0x9e55a2412728a8d0,0x28f1a7f2246b0000,0x925ca43d27d3a8eb,0x28dfa7b2243d0000,0x1cc2a54a2835a8ff,0x28c8a76e240e0000,0x211ca6442876a90b,0x28ada72823bf0000,0x23bfa72828ada90f,0x288da6de23600000,0x251ea7f228d7a90b,0x286aa69223010000,0x2644a85028f6a8ff,0x2843a64422a10000,0x274ba8982909a8eb
.quad 0x25f30000a5f328d0,0xa5f328d0a8d0,0x240e1fe6a74b28ff,0x21e0a7f2290da850,0x1fe623bfa835290f,0x259fa8ad28f6a728,0x925c259fa8a328ff,0x27d3a906288da54a,0xa0b92728a8eb28d0,0x28ada8ff27b2a241,0xa46b2835a90d2882,0x2909a89825c99a5a,0xa64428ada9062818,0x28f6a7b223011e55,0xa7d328f6a8d72728,0x2876a59f1bef23bf
.quad 0xa882290fa88225f3,0x2728a2419e5525f3,0xa8e528f6a8092498,0x24c5965ba40e27b2,0xa90e28ada6de2241,0x1fe620b9a6442882,0xa8fb2835a5751e55,0x9bef24f2a80928eb,0xa8ad2728a3bf0000,0xa3bf2728a8ad290f,0xa827259fa0569e55,0xa66b286aa90328eb,0xa6de23bf965ba241,0xa83528eba9062882,0xa51e1fe61d8ca498,0xa8d7290ea8b627b2
.quad 0xa5f328d0a8d025f3,0x28d0a8d025f30000,0xa843290ea8092241,0x2903a76e205623bf,0xa8f628ada59f0000,0x2835a3bf9fe62728,0xa8fb276ea11ca241,0x251e165ba5c928ad,0xa85024981a5aa5f3,0x1a5a2498a850290f,0xa61c1cc2240ea818,0xa36027f2a90328ad,0xa17ea0b926dea8d0,0xa76e28eba8df2728,0x1befa59f2876a90f,0xa8d728f6a7d323bf
.quad 0x2498a81828ffa8d0,0xa8ff2818a4980000,0x2790a8df28fba818,0xa82724f298c4a3bf,0x28bfa90b286aa5f3,0xa4f21a5a2301a728,0x290fa89826b9a241,0x98c4a3012703a8ad,0x28ada72823bf0000,0x23bfa72828ada90f,0x274ba43d18c42241,0x2790a8bf290fa8ad,0x243d9a5aa17e25f3,0x28dfa90b2898a728,0x18c4217ea5c92818,0x28fba86a26b9a3bf
.quad 0xa8d025f30000a5f3,0x25f30000a5f328d0,0xa6b91cc224c5a882,0x125c259fa8b628eb,0x9fe6a3bf2835a90f,0xa59f28ada8f62728,0x22a1a7f22909a882,0xa8b628f6a74b20b9,0x27b2a8ff28ada5f3,0xa8eb2728a0b9a241,0x28fba8bf266b9e55,0xa6b91fe622a1a7b2,0x28bfa6921fe62241,0x9cc2a3bf27f2a8ff,0x266b9fe6a1e02728,0x24c5a8352909a8ad
.quad 0x1e552241a72828d0,0x2882a90f2882a5f3,0xa360276ea8d728ff,0x2903a835251e9a5a,0xa7f228eba8f62818,0x276ea3bf965b2498,0xa90328dfa7d32498,0x20561fe6a5c92850,0xa8ad2728a3bf0000,0xa3bf2728a8ad290f,0xa61c217e1befa498,0xa84328f6a8fb2850,0x9cc2a0b9259fa818,0xa90e28ada76e2498,0x240ea6de2876a8ff,0xa809259fa11c9a5a
.quad 0xa5f328d0a8d0,0xa5f328d0a8d025f3,0x266ba8df28c8a5f3,0xa8fb2898a51e9a5a,0x28f6a8ad259f0000,0xa83523bf1fe6a728,0x2876a4f298c425f3,0xa056a3012809a90b,0x23bf1e55a69228d0,0x254aa882290ba818,0xa1e0276ea8f128d0,0x28e5a8df2703a0b9,0xa835290ba89825f3,0x286aa54a165b2498,0xa9092835a4c50000,0x21e01fe6a66b28ad
.quad 0xa72822411e55a5f3,0xa4982818a8ff28d0,0x9befa301274ba8d0,0xa8c82906a843254a,0x259fa8502906a8d0,0xa8982692a17e9e55,0x28d7a906285da5f3,0xa360965b246ba7b2,0x28ada72823bf0000,0x23bfa72828ada90f,0x24c59cc2a11c25f3,0x28a3a90e28c8a7b2,0x9fe6254aa7f228d0,0x28bfa7b224f29e55,0xa7d328bfa90f28d0,0x246b9cc2a056254a
.quad 0x28d0a8d025f30000,0xa8d025f30000a5f3,0x285da43d9f1e2728,0xa2a1a17e27d3a90b,0x1fe623bfa835290f,0x259fa8ad28f6a728,0xa61c28bfa8f12728,0x290da86a24c51a5a,0xa90b2882a54a0000,0x26929e55a3bf2818,0xa74b217e211ca728,0xa05626dea8d728eb,0x165ba54a286aa90f,0xa898290ba8352498,0x27d3a8f628d7a728,0xa876259f9befa3bf
.quad 0x28ffa81824980000,0x9e55a2412728a8d0,0x25759cc2a2a12728,0x2703a8bf2909a850,0xa17e2692a898290f,0x2906a850259f9e55,0xa88d290ea8b62728,0x251e9cc2a1e02692,0xa8ad2728a3bf0000,0xa3bf2728a8ad290f,0xa2a1965b240ea728,0xa8e52906a8762692,0x24f2a7b228bfa90f,0xa7f2254a9fe69e55,0x28f1a906288da728,0x125ca301266ba850
.quad 0x25f30000a5f328d0,0xa5f328d0a8d0,0xa3602835a90f2818,0x2876a9062790a0b9,0xa8f628ada59f0000,0x2835a3bf9fe62728,0xa7031fe62360a818,0x9bef2644a8c828eb,0x20b9a72828eba8d0,0xa8ad28ffa7b22241,0x28c8a8f62790a241,0xa7d323011f1ea692,0x27f2a3bf9cc225f3,0x1fe6a69228bfa8ff,0x9bef259fa876290f,0x28d7a8f627d3a3bf
.quad 0xa882290fa88225f3,0x2728a2419e5525f3,0xa85d259f9d8ca241,0xa1e026dea8b6290b,0x965ba3bf276ea8d0,0xa8f628eba7f22498,0x2827a8f628f1a818,0xa66b217e1d8ca54a,0x28ada72823bf0000,0x23bfa72828ada90f,0x1f1e1fe6a5752818,0x2909a8df2809a54a,0xa76e28ada90e28d0,0x259fa0b99cc22498,0xa8e52835a61c2241,0xa4c5276ea8a3290b
.quad 0xa5f328d0a8d025f3,0x28d0a8d025f30000,0xa8f126de9d8ca498,0x261c965ba57528ad,0x9fe6a3bf2835a90f,0xa59f28ada8f62728,0x2827a90e285da498,0xa8e526de9f1ea3bf,0x2850a4989a5a25f3,0x9a5aa4982850a90f,0x9d8c2644a8b628ff,0x28a3a9062809a3bf,0xa8df28eba76e2241,0x26dea0b9a17e2728,0xa66b1fe621e0a728,0xa4c52835a90928ad
.quad 0x2498a81828ffa8d0,0xa8ff2818a4980000,0x290da86a25c99e55,0x9f1ea17e26b9a8ad,0x23011a5aa4f22818,0x286aa90b28bfa728,0xa74b28bfa90d2882,0x2790a43d125c23bf,0xa8ad2728a3bf0000,0xa3bf2728a8ad290f,0x925ca30126b9a882,0xa90d2898a70323bf,0x2898a90b28dfa818,0xa17e9a5a243da728,0x2790a4f21f1e1e55,0x2827a8df290da8ad
.quad 0xa8d025f30000a5f3,0x25f30000a5f328d0,0x18c4a64428d7a8d0,0xa70328f6a8a3254a,0x28f6a8ad259f0000,0xa83523bf1fe6a728,0x246b1cc2a66b28d0,0x240ea835290fa850,0xa7b228ffa8ad25f3,0x28eba72820b92241,0xa827243d1befa5f3,0x98c4259fa88d290b,0x2301a7b228f6a8d0,0xa90628ada6441e55,0x2909a83524c50000,0xa1e09fe6266ba8ad
.quad 0x1e552241a72828d0,0x2882a90f2882a5f3,0xa8a3290ea87625f3,0x261c9fe6a11c2692,0xa64420b91fe6a5f3,0xa6de28ada90e2882,0x261ca86a2909a8d0,0xa843259f9f1ea0b9,0x28ada72823bf0000,0x23bfa72828ada90f,0x9d8c24f2a7d328d0,0x28f1a83525c9a0b9,0xa90628eba83525f3,0x965b23bfa6de2882,0xa360165b21e0a5f3,0xa90328f6a85d2692
.quad 0xa5f328d0a8d0,0xa5f328d0a8d025f3,0x2909a86a246b1e55,0xa8272301211ca7b2,0x1fe623bfa835290f,0x259fa8ad28f6a728,0xa8d728dfa6b91e55,0x2843a43d9d8c2692,0xa3bf9e552692a8d0,0xa54a2882a90b2818,0x2876a90e2843a498,0xa85d24f2125ca54a,0x259f9a5aa43d2818,0x24f2a850290ea882,0xa7d328f6a8d72728,0x2876a59f1bef23bf
.quad 0xa72822411e55a5f3,0xa4982818a8ff28d0,0x266ba898290fa882,0xa88d2644a056a0b9,0x2835a54a1cc22241,0x243da7b228dfa8ff,0xa4c527f2a8e528ff,0x28a3a6de22a11a5a,0xa8ad2728a3bf0000,0xa3bf2728a8ad290f,0x21e0a644285da8ff,0xa8b6276ea46b1a5a,0x28f6a8502644a241,0x2301a692286aa8ff,0x9bef243da7032882,0x28c8a7f22575a0b9
.quad 0x28d0a8d025f30000,0xa8d025f30000a5f3,0x211c2301a827290f,0x246ba86a2909a7b2,0xa8f628ada59f0000,0x2835a3bf9fe62728,0x9d8ca43d2843a90f,0xa6b928dfa8d72692,0x290ba882254a0000,0xa6921e5523bfa818,0x125c24f2a85d290f,0x2843a90e2876a54a,0xa90e2850a4f20000,0x243d1a5aa59f2882,0x1befa59f2876a90f,0xa8d728f6a7d323bf
.quad 0x28ffa81824980000,0x9e55a2412728a8d0,0xa0562644a88d290f,0x290fa898266ba0b9,0xa8df27b2a43d0000,0x9cc2254aa83528ff,0x22a1a6de28a3a90f,0xa8e527f2a4c51a5a,0x28ada72823bf0000,0x23bfa72828ada90f,0xa46b276ea8b6290f,0x285da64421e01a5a,0xa86a2692a3010000,0xa6442850a8f628ff,0x2575a7f228c8a90f,0xa703243d9befa0b9
.quad 0x25f30000a5f328d0,0xa5f328d0a8d0,0xa8a328f6a7031e55,0x28d7a64418c4254a,0x9fe6a3bf2835a90f,0xa59f28ada8f62728,0x290fa835240e1e55,0xa66b1cc2246ba850,0xa0b92728a8eb28d0,0x28ada8ff27b2a241,0xa88d259f98c4a498,0x1bef243da827290b,0x2644a8ad2906a818,0xa8f627b2a3019e55,0x266b9fe6a1e02728,0x24c5a8352909a8ad
.quad 0xa882290fa88225f3,0x2728a2419e5525f3,0xa11c9fe6261ca882,0xa876290ea8a32692,0x290ea8ad26dea241,0x9fe6a0b92644a882,0x9f1e259fa84328ff,0x2909a86a261ca0b9,0xa8ad2728a3bf0000,0xa3bf2728a8ad290f,0x25c9a83528f1a8ff,0xa7d324f29d8ca0b9,0x26dea3bf165b2241,0x2835a8eb2906a882,0xa85d28f6a9032882,0x21e0165ba3602692
.quad 0xa5f328d0a8d025f3,0x28d0a8d025f30000,0xa575965b261ca8d0,0x9d8c26dea8f128ad,0x28f6a8ad259f0000,0xa83523bf1fe6a728,0x9f1e26dea8e528d0,0x285da90e2827a3bf,0xa85024981a5aa5f3,0x1a5a2498a850290f,0x2809a90628a3a5f3,0xa8b626449d8ca3bf,0x217e20b9a6de28d0,0x276ea8eb28dfa728,0xa9092835a4c50000,0x21e01fe6a66b28ad
.quad 0x2498a81828ffa8d0,0xa8ff2818a4980000,0x26b9a17e9f1e25f3,0x25c9a86a290da8ad,0xa8bf290ba86a25f3,0x24f29a5aa3012728,0x125ca43d2790a8d0,0xa90d28bfa74b23bf,0x28ada72823bf0000,0x23bfa72828ada90f,0xa7032898a90d28d0,0x26b9a301925c23bf,0xa43d1a5a217ea5f3,0xa8df290ba8982728,0x290da8df2827a5f3,0x1f1ea4f22790a8ad
.quad 0xa8d025f30000a5f3,0x25f30000a5f328d0,0x2790a9062876a498,0xa90f2835a360a0b9,0x1fe623bfa835290f,0x259fa8ad28f6a728,0xa8c826449befa498,0x23601fe6a70328eb,0x27b2a8ff28ada5f3,0xa8eb2728a0b9a241,0x1f1e2301a7d328ff,0x2790a8f628c8a692,0xa8bf26929fe6a241,0x1cc223bfa7f228ff,0x27d3a8f628d7a728,0xa876259f9befa3bf
.quad 0x1e552241a72828d0,0x2882a90f2882a5f3,0xa8b626dea1e09e55,0x9d8c259fa85d290b,0x27f2a8eb28f6a818,0xa76e23bf165ba498,0x1d8c217ea66b2882,0x28f1a8f62827a54a,0xa8ad2728a3bf0000,0xa3bf2728a8ad290f,0x2809a8df2909a882,0xa5751fe61f1ea54a,0x1cc220b9a59f2818,0x290ea8ad276ea498,0xa8a3276ea4c51e55,0xa61c2835a8e5290b
.quad 0xa5f328d0a8d0,0xa5f328d0a8d025f3,0x27d3a17ea2a12818,0x9f1ea43d285da90b,0xa8f628ada59f0000,0x2835a3bf9fe62728,0x24c5a86a290da818,0xa8f128bfa61c1a5a,0x23bf1e55a69228d0,0x254aa882290ba818,0xa8d726dea056a241,0x211c217ea74b28eb,0x2835a90b2898a5f3,0xa86a254a965ba498,0x9bef259fa876290f,0x28d7a8f627d3a3bf
.quad 0xa72822411e55a5f3,0xa4982818a8ff28d0,0x2909a8bf2703a241,0xa2a19cc22575a850,0xa59f2850a90628d0,0x2898a692217e1e55,0xa1e09cc2251ea818,0xa8b6290ea88d2692,0x28ada72823bf0000,0x23bfa72828ada90f,0xa8762906a8e52818,0x240e965ba2a12692,0x1fe6a54a27f2a8d0,0xa8bf27b2a4f21e55,0x266ba301125c2241,0x288da90628f1a850
.quad 0x28d0a8d025f30000,0xa8d025f30000a5f3,0xa51e2898a8fb2728,0x28c8a8df266b9a5a,0x9fe6a3bf2835a90f,0xa59f28ada8f62728,0x2809a301a0562728,0x98c4a4f22876a90b,0xa90b2882a54a0000,0x26929e55a3bf2818,0x2703a8df28e5a728,0xa8f1276ea1e0a0b9,0x965b254aa86a290f,0x2898a90b2835a498,0xa66b1fe621e0a728,0xa4c52835a90928ad
.quad 0x28ffa81824980000,0x9e55a2412728a8d0,0xa8432906a8c82728,0x274ba3019bef254a,0x217ea6922898a90f,0xa9062850a59f1e55,0x246b965ba3602728,0x285da90628d7a7b2,0xa8ad2728a3bf0000,0xa3bf2728a8ad290f,0x28c8a90e28a3a728,0xa11c9cc224c5a7b2,0xa4f227b2a8bf290f,0x27f2a54a1fe61e55,0xa0569cc2246ba728,0xa90f28bfa7d3254a
.quad 0x25f30000a5f328d0,0xa5f328d0a8d0,0xa8b6259f125ca5f3,0x24c51cc2a6b928eb,0x28f6a8ad259f0000,0xa83523bf1fe6a728,0xa74b28f6a8b625f3,0x2909a7f222a120b9,0x20b9a72828eba8d0,0xa8ad28ffa7b22241,0x22a11fe6a6b928d0,0x266ba8bf28fba7b2,0xa7f223bf1cc2a5f3,0x9fe62692a8bf28ff,0x2909a83524c50000,0xa1e09fe6266ba8ad
.quad 0xa882290fa88225f3,0x2728a2419e5525f3,0x251ea8352903a8d0,0xa8d7276ea3609a5a,0x165b23bfa76e28d0,0x28f6a8eb27f2a498,0xa5c91fe62056a5f3,0xa7d328dfa9032850,0x28ada72823bf0000,0x23bfa72828ada90f,0xa8fb28f6a84325f3,0x1bef217ea61c2850,0x276ea8ad290ea8d0,0xa59f20b91cc2a498,0xa11c259fa80928d0,0x2876a6de240e9a5a
.quad 0xa5f328d0a8d025f3,0x28d0a8d025f30000,0x2056a76e2903a882,0xa809290ea84323bf,0x1fe623bfa835290f,0x259fa8ad28f6a728,0xa5c9165b251ea882,0xa11c276ea8fb28ad,0x2850a4989a5a25f3,0x9a5aa4982850a90f,0xa90327f2a3609e55,0x240e1cc2a61c28ad,0x28dfa8eb276ea241,0xa6de20b9217ea728,0xa7d328f6a8d72728,0x2876a59f1bef23bf
.quad 0x2498a81828ffa8d0,0xa8ff2818a4980000,0x98c424f2a82728ff,0x28fba8df2790a3bf,0xa3019a5a24f2a818,0xa86a290ba8bf2728,0x2703a30198c42498,0x26b9a898290fa8ad,0xa8ad2728a3bf0000,0xa3bf2728a8ad290f,0x290fa8bf2790a498,0x18c4a43d274ba8ad,0xa898290ba8df2818,0x217e1a5aa43d2728,0x26b9a86a28fba8ff,0xa5c9217e18c4a3bf
.quad 0xa8d025f30000a5f3,0x25f30000a5f328d0,0x290da7f221e02241,0xa74b1fe6240ea850,0xa8f628ada59f0000,0x2835a3bf9fe62728,0x288da90627d3a241,0xa8a3259f925ca54a,0xa7b228ffa8ad25f3,0x28eba72820b92241,0x25c9a8982909a818,0xa90d2835a46b9a5a,0xa30127b2a8f628d0,0x2906a8ad26449e55,0x1befa59f2876a90f,0xa8d728f6a7d323bf
.quad 0x1e552241a72828d0,0x2882a90f2882a5f3,0xa40e965b24c5a818,0xa80928f6a8e527b2,0x2644a0b99fe625f3,0x26dea8ad290ea882,0xa80924f29befa241,0xa5752835a8fb28eb,0x28ada72823bf0000,0x23bfa72828ada90f,0xa903286aa66b2241,0xa056259fa82728eb,0x2906a8eb2835a5f3,0x165ba3bf26dea882,0xa8b6290ea8d72818,0x1d8c1fe6a51e27b2
.quad 0xa5f328d0a8d0,0xa5f328d0a8d025f3,0x1bef24f2a88d28ff,0x25c9a8bf28e5a692,0x9fe6a3bf2835a90f,0xa59f28ada8f62728,0x21e0217ea79028ff,0x2575a8982903a7b2,0xa3bf9e552692a8d0,0xa54a2882a90b2818,0x24c5165ba5752882,0x251ea86a290fa850,0xa59f1a5a243da818,0xa4f22850a90e2882,0x266b9fe6a1e02728,0x24c5a8352909a8ad
.quad 0xa72822411e55a5f3,0xa4982818a8ff28d0,0x27d3a43d925c2498,0x246ba7f228f1a8eb,0xa835254a9cc2a241,0xa43d27b2a8df28ff,0x2876a644211c1e55,0x240ea76e28c8a90b,0xa8ad2728a3bf0000,0xa3bf2728a8ad290f,0x28d7a7f2251e9e55,0x2360a6de288da90b,0xa8f62850a6442241,0xa3012692a86a28ff,0x2909a898274ba498,0x22a1a6442843a8eb
.quad 0x25f30000a5f328d0,0xa5f328d0a8d0,0x255f17f2a63028d4,0x1df0a6f128f4a8a8,0x24c51befa66b28d7,0x21e0a7d32909a876,0x24251df0a6a628db,0x2454a84a290fa83c,0x23011fe6a6de28df,0x259fa8982906a7f2,0x21af20eba71628e2,0x26cca8d428eea75d,0x205621e0a74b28e5,0x27d3a8fb28c8a6b9,0x1df022d1a77f28e8,0x2857a90e2893a607
.quad 0x1a5a23bfa7b228eb,0x28ada90b2850a54a,0xe5c2454a7e328ee,0x28e8a8f42801a481,0x98c424c5a80928f1,0x2909a8c8274ba360,0x9d272534a81f28f4,0x290ea888267fa1af,0x9fe6259fa83528f6,0x28f6a835259f9fe6,0xa14d2607a84a28f9,0x28c4a7a124af9c5d,0xa2a1266ba85d28fb,0x2876a6b92360925c,0xa3ee26cca87028fd,0x2810a5b4214d198f
.quad 0xa5f328d0a8d025f3,0x28d0a8d025f30000,0xa7a12908a8702481,0x290fa82e233120eb,0xa8762909a7d321e0,0x28d7a66b1bef24c5,0xa8e228d4a67f1d27,0x282ea3ee9eb926cc,0xa90e286aa4f2965b,0x26449cc2a43d2835,0xa8f927a1a271a025,0x23311eb9a67f28c4,0xa8a3261c9d8ca360,0x18c4246ba8272909,0xa810245417f2a534,0xa0eb26cca8c42901
.quad 0xa69220b920b9a692,0xa54a2850a90b28ad,0xa4af14c52425a7c2,0xa7a128e2a8f92810,0xa11c9f1e25c9a85d,0xa8a3290fa88d266b,0x94c5a390273aa8bb,0xa90828d4a7a12454,0x1fe6a59f2835a8f6,0xa8f62835a59f1fe6,0x2425a73a28a8a90f,0xa870267fa27197f2,0x261ca84328f1a903,0xa703240e98c4a1e0,0x27c2a8bb290fa8d4,0xa4811d272025a534
.quad 0xa8d025f30000a5f3,0x25f30000a5f328d0,0xa7c2214d22d1a81f,0x1eb92454a864290a,0xa4c59bef266ba8d7,0xa1e027d3a9092876,0x9c5da4812857a90f,0xa6f128e8a8cc2658,0x217ea76e28f6a8bf,0xa8bf28f6a76e217e,0x2630a8b12901a7e3,0xa9082810a3ee9d27,0x285da90f2876a575,0xa84324c5125ca51e,0x2901a8c426cca0eb,0xa53417f22454a810
.quad 0x28eba7b223bf1a5a,0x9a5aa3bf27b2a8eb,0x281fa4dc17f223ee,0x2390a77f28dba8fd,0x25759d8ca1e026b9,0x2790a8d72903a843,0x1f822088a6072864,0x28e2a901284aa5b4,0x9fe6259fa83528f6,0x28f6a835259f9fe6,0xa58a281fa8e82905,0x2801a5341eb92025,0xa82728e5a909288d,0x246b9befa11c25c9,0xa8ee2908a893273a,0x8e5c22d1a658284a
.quad 0xa5f328d0a8d0,0xa5f328d0a8d025f3,0x2534a89e28f9a716,0xa8cc28dba658198f,0x2876a90927d3a1e0,0xa8d7266b9befa4c5,0x290ea81f23901f82,0xa6301b2524afa864,0x2835a43d9cc22644,0x965ba4f2286aa90e,0x24541b25a5de289e,0x258aa888290ca82e,0x9bef25c9a88d290d,0x28b6a9032809a40e,0xa6072893a90e2857,0x28e8a77f22d11df0
.quad 0xa8ad290ba850254a,0x2692a0b9a0b92692,0xa901282ea508198f,0x1b252331a75d28d4,0xa7d3246b925ca40e,0xa51e2827a8fb28e5,0xa2d1998f24afa7e3,0xa89e290fa8a826f1,0x1fe6a59f2835a8f6,0xa8f62835a59f1fe6,0x26cca888290aa8db,0xa6f123908e5ca331,0x28d7a90d28a3a74b,0x9d8ca0562575a809,0x28e8a83c2630a271,0x24afa75d289ea90a
.quad 0x28d0a8d025f30000,0xa8d025f30000a5f3,0x28b1a58a94c52607,0xa4af9d2726cca8ee,0x24c51befa66b28d7,0x21e0a7d32909a876,0xa0252716a8ee28c4,0x2870a90c2810a331,0xa7f22906a898259f,0x28dfa6de1fe62301,0xa90f284aa4af97f2,0x25080e5ca5342870,0xa79022a11f1ea66b,0xa11c2703a8d728f1,0x9df0a2d1277fa8e8,0xa857290ea8932607
.quad 0x254aa850290ba8ad,0xa8eb27b2a3bf9a5a,0x28cca905283ca534,0xa55f1c5d22d1a73a,0x28b6a70322a11bef,0x2056a61c2876a90d,0x24dc9b25a27126cc,0x283ca8fd28e8a801,0x9fe6259fa83528f6,0x28f6a835259f9fe6,0xa7e328d4a90c2893,0x25b4a0889df02508,0xa90f28b6a79024c5,0x9f1e251ea7d328c8,0xa7a125089f829df0,0xa81f28dba90e28b1
.quad 0x25f30000a5f328d0,0xa5f328d0a8d0,0xa088277fa905287c,0x2810a90f283ca390,0xa8762909a7d321e0,0x28d7a66b1bef24c5,0xa8bb2607998fa4dc,0x22d12088a73a28f4,0xa3019fe626dea8df,0xa59f2898a90627f2,0x24dca857290fa864,0xa90e287ca55f14c5,0x28f1a8d72703a11c,0xa66b1f1e22a1a790,0x2810a45497f22534,0x20eba6cc28c4a901
.quad 0x1a5a23bfa7b228eb,0x28ada90b2850a54a,0xa71628c4a908284a,0x2857a58a1d272271,0xa90d2876a61c2056,0x1bef22a1a70328b6,0xa63020eb1eb9a58a,0xa77f28cca90a2870,0x1fe6a59f2835a8f6,0xa8f62835a59f1fe6,0x2864a90128eea82e,0xa454198f2211a658,0x28c8a7d3251e9f1e,0x24c5a79028b6a90f,0x239097f2a1af25de,0x2901a8f92864a6a6
.quad 0xa5f328d0a8d025f3,0x28d0a8d025f30000,0xa90c27e3a1afa271,0x273a9f82a4252857,0xa4c59bef266ba8d7,0xa1e027d3a9092876,0x2508a87c290aa801,0xa8f928b1a5de17f2,0x290ea86a24f2165b,0xa6441cc2243da835,0x25b4998fa481283c,0x2425a81f290aa893,0xa40e2809a90328b6,0x290da88d25c99bef,0xa90128c4a6cc20eb,0x253497f2a4542810
.quad 0xa69220b920b9a692,0xa54a2850a90b28ad,0x2211a6f128bba90a,0xa90c2864a5b41df0,0x28e5a8fb2827a51e,0xa40e925c246ba7d3,0x275da3ee8e5c2425,0x2658a87c290ca8c4,0x9fe6259fa83528f6,0x28f6a835259f9fe6,0xa8bb290fa8b1275d,0x21af1b25a481277f,0xa8092575a0569d8c,0xa74b28a3a90d28d7,0x1b25a42526f1a87c,0xa8cc2801a58a20eb
.quad 0xa8d025f30000a5f3,0x25f30000a5f328d0,0x9b25a5082893a8fd,0xa5de28c4a8e2267f,0x2876a90927d3a1e0,0xa8d7266b9befa4c5,0x27e3a271a0eb275d,0x94c5a5342888a908,0xa17e276ea8f628bf,0x28bfa8f6276ea17e,0xa90528a8a6071c5d,0x26589df0a3902801,0xa51e125c24c5a843,0xa5752876a90f285d,0x2607a893290ea857,0xa8e8277fa2d19df0
.quad 0x28eba7b223bf1a5a,0x9a5aa3bf27b2a8eb,0x1eb921afa6cc28b1,0x28a8a90e2870a5de,0xa8432903a8d72790,0x26b9a1e09d8c2575,0xa82e255f9df0a14d,0xa5082810a8ee28f9,0x1fe6a59f2835a8f6,0xa8f62835a59f1fe6,0x28f4a8fd2857a630,0x9d27a0eb25dea83c,0x25c9a11c9bef246b,0x288da90928e5a827,0xa55f27e3a8c4290f,0x2716a4541c5d2088
.quad 0xa5f328d0a8d0,0xa5f328d0a8d025f3,0x28e8a8bb25b40e5c,0xa88824dc1c5da6a6,0x24c51befa66b28d7,0x21e0a7d32909a876,0xa77f28fda8a825b4,0x2905a7c22211214d,0xa835243d1cc2a644,0x165b24f2a86a290e,0x22d1a7c228fda8bb,0xa8f428cca6a61f82,0x2909a827246b18c4,0xa3609d8c261ca8a3,0x1df022d1a77f28e8,0x2857a90e2893a607
.quad 0xa8ad290ba850254a,0x2692a0b9a0b92692,0xa6071f82214da6a6,0xa67f289ea90f287c,0x266ba88d290fa8a3,0xa85d25c99f1ea11c,0x2893a6a622111c5d,0x2331a71628b1a90f,0x9fe6259fa83528f6,0x28f6a835259f9fe6,0xa90e28cca7c224dc,0x94c523eea716289e,0xa1e098c4240ea703,0xa90328f1a843261c,0x2857a8f42905a888,0xa21194c52331a67f
.quad 0x28d0a8d025f30000,0xa8d025f30000a5f3,0x23ee2025a75d2901,0x2211a801290ea84a,0xa8762909a7d321e0,0x28d7a66b1bef24c5,0xa58a0e5c255fa893,0xa1af27a1a901289e,0x27f2a9062898a59f,0xa8df26de9fe6a301,0x26f1a088a211277f,0x214da73a28e8a8db,0xa6b928c8a8fb27d3,0x28e5a74b21e02056,0xa810245417f2a534,0xa0eb26cca8c42901
.quad 0x254aa850290ba8ad,0xa8eb27b2a3bf9a5a,0x2888a630202520eb,0x2088a6582893a90f,0xa360274ba8c82909,0x28f1a80924c598c4,0xa8db27c2a48117f2,0xa02525dea8572905,0x1fe6a59f2835a8f6,0xa8f62835a59f1fe6,0x2908a87c26a6a2d1,0x1f82a55f2810a8e2,0x925c2360a6b92876,0x28fba85d266ba2a1,0xa90c28e2a82e2607,0x9eb924dca77f28a8
.quad 0x25f30000a5f328d0,0xa5f328d0a8d0,0xa84a290ea8012211,0x2901a75d202523ee,0xa4c59bef266ba8d7,0xa1e027d3a9092876,0x289ea90127a1a1af,0xa893255f0e5ca58a,0x23011fe6a6de28df,0x259fa8982906a7f2,0xa8db28e8a73a214d,0x277fa211a08826f1,0xa056a1e0274ba8e5,0xa7d328fba8c826b9,0x2901a8c426cca0eb,0xa53417f22454a810
.quad 0x1a5a23bfa7b228eb,0x28ada90b2850a54a,0xa90f2893a6582088,0x20eb2025a6302888,0x18c4a4c52809a8f1,0xa90928c8a74b2360,0x2905a85725dea025,0x17f2a48127c2a8db,0x9fe6259fa83528f6,0x28f6a835259f9fe6,0xa8e22810a55f1f82,0xa2d126a6a87c2908,0x22a1a66b285da8fb,0xa87626b9a360125c,0x28a8a77f24dc9eb9,0x2607a82e28e2a90c
.quad 0xa5f328d0a8d025f3,0x28d0a8d025f30000,0xa6a61c5d24dca888,0xe5c25b4a8bb28e8,0x2876a90927d3a1e0,0xa8d7266b9befa4c5,0x214d2211a7c22905,0x25b4a8a828fda77f,0xa90e286aa4f2965b,0x26449cc2a43d2835,0x1f82a6a628cca8f4,0xa8bb28fda7c222d1,0x28a3a61c1d8c2360,0x98c4a46b2827a909,0xa6072893a90e2857,0x28e8a77f22d11df0
.quad 0xa69220b920b9a692,0xa54a2850a90b28ad,0x287ca90f289ea67f,0xa6a6214d1f82a607,0x211c1f1ea5c9285d,0x28a3a90f288da66b,0xa90f28b1a7162331,0x1c5d2211a6a62893,0x1fe6a59f2835a8f6,0xa8f62835a59f1fe6,0x289ea71623ee94c5,0x24dca7c228cca90e,0xa61c2843a8f12903,0x2703a40e18c421e0,0xa67f233194c5a211,0xa8882905a8f42857
.quad 0xa8d025f30000a5f3,0x25f30000a5f328d0,0x267fa8e228c4a5de,0xa8fd2893a5089b25,0x24c51befa66b28d7,0x21e0a7d32909a876,0xa9082888a53494c5,0x275da0eba27127e3,0x217ea76e28f6a8bf,0xa8bf28f6a76e217e,0x2801a3909df02658,0x1c5da60728a8a905,0xa85d290fa8762575,0x2843a4c5925c251e,0x9df0a2d1277fa8e8,0xa857290ea8932607
.quad 0x28eba7b223bf1a5a,0x9a5aa3bf27b2a8eb,0xa5de2870a90e28a8,0x28b1a6cc21af1eb9,0xa5751d8c21e0a6b9,0xa79028d7a9032843,0x28f9a8ee2810a508,0xa14d9df0255fa82e,0x9fe6259fa83528f6,0x28f6a835259f9fe6,0xa83c25dea0eb9d27,0xa6302857a8fd28f4,0x2827a8e52909a88d,0xa46b1bef211ca5c9,0x20881c5da4542716,0x290fa8c427e3a55f
.quad 0xa5f328d0a8d0,0xa5f328d0a8d025f3,0x2857a4259f82273a,0xa271a1af27e3a90c,0xa8762909a7d321e0,0x28d7a66b1bef24c5,0x17f2a5de28b1a8f9,0xa801290aa87c2508,0x2835a43d9cc22644,0x965ba4f2286aa90e,0xa893290aa81f2425,0x283ca481998f25b4,0x1befa5c9288da90d,0xa8b62903a809240e,0x2810a45497f22534,0x20eba6cc28c4a901
.quad 0xa8ad290ba850254a,0x2692a0b9a0b92692,0x1df0a5b42864a90c,0xa90a28bba6f12211,0x27d3a46b125c240e,0x251ea82728fba8e5,0xa8c4290ca87c2658,0x24258e5ca3ee275d,0x1fe6a59f2835a8f6,0xa8f62835a59f1fe6,0x277fa4811b2521af,0x275da8b1290fa8bb,0xa8d7290da8a3274b,0x1d8c2056a5752809,0x20eba58a2801a8cc,0xa87c26f1a4251b25
.quad 0x28d0a8d025f30000,0xa8d025f30000a5f3,0xa390283ca90f2810,0x287ca905277fa088,0xa4c59bef266ba8d7,0xa1e027d3a9092876,0x28f4a73a208822d1,0xa4dc998f2607a8bb,0xa7f22906a898259f,0x28dfa6de1fe62301,0x14c5a55f287ca90e,0xa864290fa85724dc,0x2790a2a19f1e266b,0x211ca70328d7a8f1,0xa90128c4a6cc20eb,0x253497f2a4542810
.quad 0x254aa850290ba8ad,0xa8eb27b2a3bf9a5a,0x22711d27a58a2857,0x284aa90828c4a716,0xa8b62703a2a19bef,0xa056261ca876290d,0x2870a90a28cca77f,0xa58a1eb920eba630,0x9fe6259fa83528f6,0x28f6a835259f9fe6,0xa6582211198fa454,0xa82e28eea9012864,0x290fa8b62790a4c5,0x1f1ea51e27d3a8c8,0xa6a62864a8f92901,0x25dea1af97f22390
.quad 0x25f30000a5f328d0,0xa5f328d0a8d0,0xa8ee26cc9d27a4af,0x260794c5a58a28b1,0x2876a90927d3a1e0,0xa8d7266b9befa4c5,0xa3312810a90c2870,0x28c4a8ee2716a025,0xa3019fe626dea8df,0xa59f2898a90627f2,0x2870a5340e5c2508,0x97f2a4af284aa90f,0xa8f128d7a703211c,0x266b9f1ea2a12790,0x2607a893290ea857,0xa8e8277fa2d19df0
.quad 0x1a5a23bfa7b228eb,0x28ada90b2850a54a,0xa73a22d11c5da55f,0xa534283ca90528cc,0x290da876261ca056,0x9befa2a12703a8b6,0xa80128e8a8fd283c,0x26cca2719b2524dc,0x1fe6a59f2835a8f6,0xa8f62835a59f1fe6,0x25089df0a08825b4,0x2893a90c28d4a7e3,0xa8c827d3a51e1f1e,0xa4c52790a8b6290f,0x28b1a90e28dba81f,0x9df09f822508a7a1
.quad 0xa5f328d0a8d025f3,0x28d0a8d025f30000,0x198fa65828dba8cc,0xa71628f9a89e2534,0x24c51befa66b28d7,0x21e0a7d32909a876,0xa86424af1b25a630,0x1f822390a81f290e,0x290ea86a24f2165b,0xa6441cc2243da835,0xa82e290ca888258a,0x289ea5de1b252454,0x240ea8092903a8b6,0xa90d288da5c91bef,0x1df022d1a77f28e8,0x2857a90e2893a607
.quad 0xa69220b920b9a692,0xa54a2850a90b28ad,0x28d4a75d23311b25,0x198fa508282ea901,0xa8e528fba827251e,0x240e125ca46b27d3,0x26f1a8a8290fa89e,0xa7e324af998fa2d1,0x9fe6259fa83528f6,0x28f6a835259f9fe6,0xa3318e5c2390a6f1,0xa8db290aa88826cc,0x2809a57520561d8c,0x274ba8a3290da8d7,0xa90a289ea75d24af,0xa2712630a83c28e8
.quad 0xa8d025f30000a5f3,0x25f30000a5f328d0,0x290aa86424541eb9,0xa81f22d1214da7c2,0xa8762909a7d321e0,0x28d7a66b1bef24c5,0x2658a8cc28e8a6f1,0xa90f2857a4819c5d,0xa17e276ea8f628bf,0x28bfa8f6276ea17e,0x9d27a3ee2810a908,0xa7e32901a8b12630,0x251e925ca4c52843,0x2575a876290fa85d,0xa810245417f2a534,0xa0eb26cca8c42901
.quad 0x28eba7b223bf1a5a,0x9a5aa3bf27b2a8eb,0xa8fd28dba77f2390,0x23ee17f2a4dc281f,0x2843a90328d7a790,0xa6b921e01d8ca575,0xa5b4284aa90128e2,0x2864a60720881f82,0x1fe6a59f2835a8f6,0xa8f62835a59f1fe6,0x20251eb9a5342801,0x2905a8e8281fa58a,0xa5c9211c1befa46b,0xa88d2909a8e52827,0x284aa65822d18e5c,0x273aa8932908a8ee
.quad 0xa5f328d0a8d0,0xa5f328d0a8d025f3,0x20eb2331a82e290f,0x2481a8702908a7a1,0xa4c59bef266ba8d7,0xa1e027d3a9092876,0x26cc9eb9a3ee282e,0x1d27a67f28d4a8e2,0xa835243d1cc2a644,0x165b24f2a86a290e,0x28c4a67f1eb92331,0xa025a27127a1a8f9,0xa9092827a46b98c4,0x23601d8ca61c28a3,0x2901a8c426cca0eb,0xa53417f22454a810
.quad 0xa8ad290ba850254a,0x2692a0b9a0b92692,0x2810a8f928e2a7a1,0xa7c2242514c5a4af,0xa66b288da90f28a3,0x285da5c91f1e211c,0x2454a7a128d4a908,0xa8bb273aa39094c5,0x9fe6259fa83528f6,0x28f6a835259f9fe6,0x97f2a271267fa870,0xa90f28a8a73a2425,0x21e018c4a40e2703,0x2903a8f12843a61c,0xa53420251d27a481,0xa8d4290fa8bb27c2
.quad 0x28d0a8d025f30000,0xa8d025f30000a5f3,0xa8a828f4a6f11df0,0x28d4a63017f2255f,0x2876a90927d3a1e0,0xa8d7266b9befa4c5,0xa83c290fa84a2454,0x28dba6a61df02425,0x27f2a9062898a59f,0xa8df26de9fe6a301,0xa75d28eea8d426cc,0x28e2a71620eb21af,0x26b9a8c828fba7d3,0xa8e5274ba1e0a056,0xa6072893a90e2857,0x28e8a77f22d11df0
.quad 0x254aa850290ba8ad,0xa8eb27b2a3bf9a5a,0xa4812801a8f428e8,0x28eea7e324540e5c,0x2360a74b28c8a909,0xa8f12809a4c518c4,0xa1af267fa888290e,0x28f4a81f25349d27,0x1fe6a59f2835a8f6,0xa8f62835a59f1fe6,0x9c5d24afa7a128c4,0x28f9a84a2607a14d,0x125ca36026b9a876,0xa8fb285da66b22a1,0x198f214da5b42810,0x28fda87026cca3ee
.quad 0xa5f32818a8d0290f,0x25f3a24100002241,0xa66b2835a8d7290f,0x24c59fe69bef23bf,0xa6de2850a8df290f,0x23019a5a9fe62498,0xa74b286aa8e5290f,0x2056165ba1e0254a,0xa7b22882a8eb290f,0x1a5a1e55a3bf25f3,0xa8092898a8f1290f,0x98c4217ea4c52692,0xa83528ada8f6290f,0x9fe623bfa59f2728,0xa85d28bfa8fb290f,0xa2a124f2a66b27b2
.quad 0xa88228d0a8ff290f,0xa49825f3a7282818,0xa8a328dfa903290f,0xa5c926dea7d32850,0xa8bf28eba906290f,0xa6de27b2a8352882,0xa8d728f6a909290f,0xa7d32835a87628ad,0xa8eb28ffa90b290f,0xa8502882a8ad28d0,0xa8fb2906a90d290f,0xa8a328bfa8d728eb,0xa906290ba90e290f,0xa8df28eba8f628ff,0xa90d290ea90f290f,0xa9032906a909290b
.quad 0x28d0a90f28d0a818,0x8000a24125f3a818,0x2909a8f62876a728,0x21e0a59f27d3a8ad,0x2906a8ad27f2a5f3,0x259fa7b22898a8ff,0x28c8a83526b9a498,0x27d3a89828fba90b,0x2850a728254aa241,0x28ada8ff290ba8d0,0x274ba59f23609e55,0x2909a90628c8a850,0x259fa3bf1fe68000,0x28f6a8ad2835a728,0x23609fe6125c1e55,0x2876a7f226b9a54a
.quad 0x1e5580009e552241,0x2728a5f32498a241,0x98c41fe6a2a12498,0x24c5a30120569a5a,0xa17e23bfa4f225f3,0x1fe69a5a965b1e55,0xa4c5259fa66b2728,0x9bef1fe6a1e023bf,0xa6922728a7b22818,0xa3bf2498a54a25f3,0xa8092835a85d2882,0xa66b26dea74b27b2,0xa89828ada8bf28d0,0xa8352850a86a2882,0xa8f128f6a8fb28ff,0xa8d728dfa8e528eb
.quad 0xa8d02818a5f32241,0xa5f32818a8d0290f,0xa7d3259fa1e00000,0xa87628f6a90928ad,0xa4f220b9165ba241,0xa90e28eba86a2728,0x9d8c9cc22360a5f3,0xa8a327f2a61c23bf,0x20b9a4982692a818,0xa6922498a0b90000,0x25c9a76e285da8d0,0xa11c165b1f1ea3bf,0x2835a8ad28f6a90f,0x1fe6a3bf259fa728,0x28f1a90e2903a8d0,0x261ca76e2843a8ad
.quad 0x28ffa8d02882a818,0x2882a8d028ffa90f,0x285da7f22703a5f3,0x290fa90628e5a8ad,0x2644a54a243da241,0x2898a85027f2a728,0x21e09fe61bef8000,0x266ba59f24c5a3bf,0x9a5a1e55a0b92241,0x20b99e551a5a8000,0xa46b24f2a57525f3,0xa056217ea2a123bf,0xa76e27b2a7f22818,0xa6442692a6de2728,0xa8b628bfa8c828d0,0xa88d2898a8a328ad
.quad 0x25f3a24100002241,0x28d0a90f28d0a818,0x1bef1fe6a4c52728,0x28d7a835266ba3bf,0xa43d2692a83528d0,0x2644a3bf1cc21e55,0xa82728bfa90928ff,0x18c41fe6a46b2692,0xa90b28ffa8ad2818,0xa54a2728a85028d0,0xa88d27f2a66b2498,0xa8a328f6a90f28eb,0xa59f23bf9fe60000,0xa8f628ada8352728,0x98c49cc221e0a498,0xa703259fa40e20b9
.quad 0x2498a5f32728a818,0x9e5500001e55a241,0x2843a89828d7a8ff,0x246ba59f26b9a7b2,0x290ea90b28f6a8d0,0x286aa8ad28dfa8ff,0x2876a83527d3a728,0x2909a8f628d7a8ad,0x254aa49823bfa241,0x27b2a7282692a5f3,0x125c165b9bef1e55,0x211c9fe61d8c9a5a,0xa4f2254aa59f25f3,0xa30123bfa43d2498,0xa85d286aa8762882,0xa8272835a8432850
.quad 0x8000a24125f3a818,0xa8d02818a5f32241,0x266ba83528d7a90f,0xa4c51fe61befa3bf,0x28f6a90b28bfa818,0x217ea54a276ea882,0x2876a76e2575a241,0x285da8df290fa8eb,0x23bf9e559a5a2241,0x28eba88227b2a5f3,0xa1e024f2a6b92818,0x2575a3011d8c1a5a,0xa83528ada8f6290f,0x9fe623bfa59f2728,0xa90928dfa88d2818,0xa8272898a8e5290b
.quad 0xa72825f3a4982241,0xa8ff28d0a8822818,0x9bef965b1f1ea241,0xa61c24f2a36020b9,0x259fa692276ea818,0x1cc2a0b92301a498,0x28d7a8f62909a90f,0x27d3a8352876a8ad,0x28ada8822850a818,0x290ba8ff28eba8d0,0x24c5a43d2360a241,0x26b9a64425c9a54a,0x9fe620b9a17e2241,0x965b1a5a9cc21e55,0xa7d327f2a8092818,0xa74b276ea79027b2
.quad 0xa5f32818a8d0290f,0x25f3a24100002241,0xa90928f6a8762728,0xa1e0259fa7d328ad,0xa76e254aa17e0000,0xa8bf290ba8f62882,0x125ca17e251ea728,0xa84326dea4c520b9,0x27b2a88228eba90f,0x9a5a9e5523bfa5f3,0x2903a8bf2843a728,0x2790a86a28d7a90b,0x259fa3bf1fe68000,0x28f6a8ad2835a728,0xa11c243da5c92728,0x246ba17e1bef1a5a
.quad 0xa88228d0a8ff290f,0xa49825f3a7282818,0xa8b6286aa8092728,0xa8fb290ea90928eb,0xa30120b99cc20000,0xa76e2692a59f2498,0x24c5a59f266ba728,0x1bef9fe621e0a3bf,0x28eba8ff290ba90f,0x2850a88228ada8d0,0x2827a7f22790a728,0x28b6a8982876a850,0x1cc29a5a165b8000,0x217ea0b91fe69e55,0xa6b926dea7032728,0xa61c2644a66b2692
.quad 0x28d0a90f28d0a818,0x8000a24125f3a818,0x27d3a59f21e08000,0x2876a8f62909a8ad,0x9cc223bfa6442818,0x2835a692243d9e55,0xa88d28f6a90d28d0,0x9bef2301a5c927b2,0xa8502728a54a2241,0xa8ad28ffa90b28d0,0x925c9fe6240ea5f3,0xa7d32644a46b20b9,0x2835a8ad28f6a90f,0x1fe6a3bf259fa728,0x28a3a835274ba5f3,0x28d7a906290da8eb
.quad 0x1e5580009e552241,0x2728a5f32498a241,0xa7902835a88d28d0,0xa1e0243da5752692,0xa8df28ada86a2818,0xa8f6290ba90e28ff,0xa1e01fe69bef0000,0xa66b259fa4c523bf,0x2692a72827b2a818,0x23bfa498254aa5f3,0x2903a8f628e5a8d0,0x2909a90e290fa90b,0x243da3bf2301a241,0x259fa54a24f2a498,0xa575259fa5c925f3,0xa4c524f2a51e254a
.quad 0xa8d02818a5f32241,0xa5f32818a8d0290f,0x9bef9fe624c5a728,0xa8d72835a66b23bf,0x286aa8eb290ea8d0,0x965ba0b924f2a728,0x2809a644240e9e55,0x28b6a9062903a8ad,0xa0b92498a6922818,0x2692a49820b98000,0xa8fb290ea8e52882,0xa51e26dea82728ad,0xa59f23bf9fe60000,0xa8f628ada8352728,0x2575a6de2809a882,0x9d8c965b2056a3bf
.quad 0x28ffa8d02882a818,0x2882a8d028ffa90f,0x211c9cc2925c1e55,0x274ba644251ea3bf,0xa7f22850a89828d0,0xa43d254aa6442728,0xa8762835a7d32728,0xa90928f6a8d728ad,0x1a5a9e5520b9a241,0xa0b91e559a5a0000,0x28c8a8df28f1a8ff,0x2843a86a288da8ad,0x26dea6922644a5f3,0x27f2a7b2276ea728,0xa40e243da46b2498,0xa2a12301a36023bf
.quad 0x25f3a24100002241,0x28d0a90f28d0a818,0xa66b2835a8d7290f,0x24c59fe69bef23bf,0xa89827b2a59f2241,0xa7f228ada90628ff,0x1f1ea43d266ba818,0xa790259fa2a11a5a,0x290ba8ff28ada818,0x254aa7282850a8d0,0x22a19cc29bef2241,0x28b6a8352703a54a,0xa83528ada8f6290f,0x9fe623bfa59f2728,0xa7902644a4c52241,0xa90f28f6a8b62850
.quad 0x2498a5f32728a818,0x9e5500001e55a241,0x28f1a8bf2876a818,0x28c8a8f6290da90b,0x165b1a5a9fe62241,0x24f2a3bf217e9e55,0xa8d728f6a909290f,0xa7d32835a87628ad,0xa54a2498a3bf2241,0xa7b22728a69225f3,0x2703a76e27d3a818,0x251ea59f261ca692,0x286aa8502835a818,0x28bfa8ad2898a882,0xa11c217ea1e02241,0x9f1e1fe6a05620b9
.quad 0x8000a24125f3a818,0xa8d02818a5f32241,0x2909a8f62876a728,0x21e0a59f27d3a8ad,0x1fe61a5aa30125f3,0x28dfa85026dea498,0xa8d7290ea8f12882,0xa11c24f2a7032850,0xa3bf1e551a5aa241,0xa8eb2882a7b225f3,0x2876a8df290da8ff,0x2056a43d261ca7b2,0x259fa3bf1fe68000,0x28f6a8ad2835a728,0xa7d3286aa8c828ff,0x9f1e2301a51e2692
.quad 0xa72825f3a4982241,0xa8ff28d0a8822818,0x266ba76e2827a882,0x1d8ca17e240ea54a,0x2835a7b226dea5f3,0x2906a8eb28bfa882,0xa4c5259fa66b2728,0x9bef1fe6a1e023bf,0xa8ad2882a8502818,0xa90b28ffa8eb28d0,0x21e0a301240ea498,0x18c49cc21f1ea0b9,0x28f6a8eb28dfa8d0,0x290ea90b2906a8ff,0x9bef1cc29d8c1e55,0x925c165b98c41a5a
.quad 0xa5f32818a8d0290f,0x25f3a24100002241,0xa7d3259fa1e00000,0xa87628f6a90928ad,0x26dea85028dfa90f,0xa3011a5a1fe6a498,0x2703a4f2211c8000,0x28f1a90e28d7a850,0xa7b22882a8eb290f,0x1a5a1e55a3bf25f3,0xa61c243da0560000,0xa90d28dfa87627b2,0x2835a8ad28f6a90f,0x1fe6a3bf259fa728,0x251ea3011f1e8000,0x28c8a86a27d3a692
.quad 0xa88228d0a8ff290f,0xa49825f3a7282818,0xa40e217e9d8c0000,0xa827276ea66b254a,0x28bfa8eb2906a90f,0x26dea7b22835a882,0x21e09fe61bef8000,0x266ba59f24c5a3bf,0xa8eb28ffa90b290f,0xa8502882a8ad28d0,0x9f1e1cc298c40000,0xa40e2301a1e020b9,0x2906a90b290ea90f,0x28dfa8eb28f6a8ff,0x18c4965b125c8000,0x1d8c9cc21bef9a5a
.quad 0x28d0a90f28d0a818,0x8000a24125f3a818,0x1bef1fe6a4c52728,0x28d7a835266ba3bf,0xa90628ada7f225f3,0xa59f27b2a89828ff,0x22a1a59f2790a882,0xa66b243d9f1e9a5a,0x2850a728254aa241,0x28ada8ff290ba8d0,0xa7032835a8b628ff,0x1bef1cc2a2a1254a,0xa59f23bf9fe60000,0xa8f628ada8352728,0x28b6a8f6290fa8ff,0x24c5a6442790a850
.quad 0x1e5580009e552241,0x2728a5f32498a241,0xa90d28f6a8c82882,0xa87628bfa8f1290b,0x217ea3bf24f2a5f3,0x9fe61a5a165b9e55,0x2876a83527d3a728,0x2909a8f628d7a8ad,0xa6922728a7b22818,0xa3bf2498a54a25f3,0xa61c259fa51e2498,0xa7d3276ea7032692,0x2898a8ad28bfa8d0,0x2835a850286aa882,0x20569fe61f1e9e55,0x21e0a17e211ca0b9
.quad 0xa8d02818a5f32241,0xa5f32818a8d0290f,0x266ba83528d7a90f,0xa4c51fe61befa3bf,0x24f2a0b9965b2241,0x290ea8eb286aa728,0xa9032906a8b62818,0xa40e2644a80928ad,0x20b9a4982692a818,0xa6922498a0b90000,0x2827a6de251ea241,0x28e5a90e28fba8ad,0xa83528ada8f6290f,0x9fe623bfa59f2728,0xa056165b1d8ca241,0xa80926dea57523bf
.quad 0x28ffa8d02882a818,0x2882a8d028ffa90f,0xa51e2644a74b2818,0x125c1cc2a11c23bf,0xa644254aa43d2241,0xa8982850a7f22728,0x28d7a8f62909a90f,0x27d3a8352876a8ad,0x9a5a1e55a0b92241,0x20b99e551a5a8000,0xa88d286aa8432818,0xa8f128dfa8c828ad,0x276ea7b227f2a818,0x2644a69226dea728,0x2360a30122a1a241,0x246ba43d240ea3bf
.quad 0x25f3a24100002241,0x28d0a90f28d0a818,0xa90928f6a8762728,0xa1e0259fa7d328ad,0x243da6922835a8d0,0xa64423bf9cc29e55,0x25c9a3011bef1e55,0x290da8f6288da7b2,0xa90b28ffa8ad2818,0xa54a2728a85028d0,0x246ba64427d3a882,0xa40e1fe6125ca0b9,0x259fa3bf1fe68000,0x28f6a8ad2835a728,0xa90d2906a8d72882,0xa74b2835a8a328eb
.quad 0x2498a5f32728a818,0x9e5500001e55a241,0x2575a43d21e09e55,0x288da8352790a692,0xa90e290ba8f628d0,0xa86a28ada8df28ff,0x24c5a59f266ba728,0x1bef9fe621e0a3bf,0x254aa49823bfa241,0x27b2a7282692a5f3,0xa90f290ea90928ff,0xa8e528f6a903290b,0x24f2a54a259fa5f3,0x2301a3bf243da498,0x251ea4f224c5a498,0x25c9a59f2575a54a
.quad 0x8000a24125f3a818,0xa8d02818a5f32241,0x27d3a59f21e08000,0x2876a8f62909a8ad,0xa8f6290ba8bf2818,0xa17e254aa76e2882,0x24c5a6de2843a8d0,0xa51e217e925ca0b9,0x23bf9e559a5a2241,0x28eba88227b2a5f3,0xa8d7286aa79025f3,0xa84328bfa903290b,0x2835a8ad28f6a90f,0x1fe6a3bf259fa728,0x9bef217ea46b25f3,0x25c9a43d211c9a5a
.quad 0xa72825f3a4982241,0xa8ff28d0a8822818,0x2909a90e28fba8d0,0x2809a86a28b6a8eb,0xa59f2692a76e2818,0x9cc220b9a3012498,0xa1e01fe69bef0000,0xa66b259fa4c523bf,0x28ada8822850a818,0x290ba8ff28eba8d0,0xa8762898a8b628d0,0xa79027f2a8272850,0x1fe6a0b9217ea241,0x165b9a5a1cc29e55,0x266ba644261ca5f3,0x2703a6de26b9a692
.quad 0xa5f32818a8d0290f,0x25f3a24100002241,0x9bef9fe624c5a728,0xa8d72835a66b23bf,0x276ea54a217e8000,0x28bfa90b28f6a882,0xa90f28dfa85d2728,0xa575276ea87628eb,0x27b2a88228eba90f,0x9a5a9e5523bfa5f3,0x9d8c2301a5752728,0x26b9a4f221e09a5a,0xa59f23bf9fe60000,0xa8f628ada8352728,0x28e5a8982827a728,0x288da8df2909a90b
.quad 0xa88228d0a8ff290f,0xa49825f3a7282818,0x2360a4f2261ca728,0x9f1e165b1befa0b9,0x2301a0b91cc28000,0x276ea692259fa498,0xa8762835a7d32728,0xa90928f6a8d728ad,0x28eba8ff290ba90f,0x2850a88228ada8d0,0xa5c92644a6b92728,0xa360243da4c5254a,0x9cc21a5a965b0000,0xa17e20b99fe61e55,0x2790a76e274ba728,0x2809a7f227d3a7b2
.quad 0x28d0a90f28d0a818,0x8000a24125f3a818,0xa66b2835a8d7290f,0x24c59fe69bef23bf,0x1cc2a3bf2644a818,0xa8352692a43d1e55,0x246b9fe698c42241,0x2909a8bf2827a692,0xa8502728a54a2241,0xa8ad28ffa90b28d0,0x290fa8f628a3a818,0x266ba7f2288da8eb,0xa83528ada8f6290f,0x9fe623bfa59f2728,0x240ea59f2703a818,0xa1e01cc218c4a0b9
.quad 0x1e5580009e552241,0x2728a5f32498a241,0xa6b9259fa46b2241,0xa8d72898a84327b2,0x28dfa8ad286aa818,0x28f6a90b290ea8ff,0xa8d728f6a909290f,0xa7d32835a87628ad,0x2692a72827b2a818,0x23bfa498254aa5f3,0x9d8c1fe6a11c2241,0x1bef965b925c1a5a,0xa43d23bfa3012241,0xa59f254aa4f22498,0x2843a8352827a818,0x2876a86a285da850
.quad 0xa8d02818a5f32241,0xa5f32818a8d0290f,0x2909a8f62876a728,0x21e0a59f27d3a8ad,0xa86a28eba90e28d0,0x165b20b9a4f22728,0x261ca7f228a3a8ff,0xa3601cc21d8ca3bf,0xa0b92498a6922818,0x2692a49820b98000,0x9f1e965b211ca498,0xa85d276ea5c923bf,0x259fa3bf1fe68000,0x28f6a8ad2835a728,0xa843276ea61c2498,0xa903290ea8f128ad
.quad 0x28ffa8d02882a818,0x2882a8d028ffa90f,0xa8e52906a90f28ff,0xa70327f2a85d28ad,0x27f2a8502898a8d0,0x243da54a2644a728,0xa4c5259fa66b2728,0x9bef1fe6a1e023bf,0x1a5a9e5520b9a241,0xa0b91e559a5a0000,0x22a1a17e20569e55,0x2575a4f2246ba3bf,0xa6de2692a64425f3,0xa7f227b2a76e2728,0x28a3a898288da882,0x28c8a8bf28b6a8ad
.quad 0x25f3a24100002241,0x28d0a90f28d0a818,0xa7d3259fa1e00000,0xa87628f6a90928ad,0x2898a7b2259fa241,0x27f2a8ad2906a8ff,0xa8fb2898a7d325f3,0xa6b92835a8c8290b,0x290ba8ff28ada818,0x254aa7282850a8d0,0xa8c82906a90928d0,0xa360259fa74b2850,0x2835a8ad28f6a90f,0x1fe6a3bf259fa728,0xa6b927f2a87628d0,0x925c1fe6a360254a
.quad 0x2498a5f32728a818,0x9e5500001e55a241,0xa0562301a4c525f3,0x22a19fe618c41a5a,0x965b9a5a1fe6a241,0xa4f223bfa17e1e55,0x21e09fe61bef8000,0x266ba59f24c5a3bf,0xa54a2498a3bf2241,0xa7b22728a69225f3,0x274ba6de266ba5f3,0x285da8352809a7b2,0xa86a2850a8352818,0xa8bf28ada8982882,0x28e5a8df28d7a8d0,0x28fba8f628f1a8eb
.quad 0x8000a24125f3a818,0xa8d02818a5f32241,0x1bef1fe6a4c52728,0x28d7a835266ba3bf,0x9fe69a5a2301a5f3,0xa8df2850a6de2498,0x21e0965ba0562498,0x28e5a86a274ba54a,0xa3bf1e551a5aa241,0xa8eb2882a7b225f3,0x24c5a17e18c41e55,0x28f1a8982809a692,0xa59f23bf9fe60000,0xa8f628ada8352728,0x266ba4f222a19e55,0x28fba8bf285da7b2
.quad 0xa72825f3a4982241,0xa8ff28d0a8822818,0x27d3a6de25c9a498,0x2903a8df28a3a850,0xa83527b2a6de25f3,0xa90628eba8bf2882,0x2876a83527d3a728,0x2909a8f628d7a8ad,0xa8ad2882a8502818,0xa90b28ffa8eb28d0,0x28d7a8bf28a3a882,0x290da90628fba8eb,0xa8f628eba8df28d0,0xa90e290ba90628ff,0x2909a9062903a8ff,0x290fa90e290da90b
.quad 0x290f,0x0,0xa90f,0x0,0x290f,0x0,0xa90f,0x0,0x290f,0x0,0xa90f,0x0,0x290f,0x0,0xa90f,0x0
.quad 0x290f,0x0,0xa90f,0x0,0x290f,0x0,0xa90f,0x0,0x290f,0x0,0xa90f,0x0,0x290f,0x0,0xa90f
.zero 776
.quad 0xa8822728a4981e55,0xa7282882a8ff28ff,0xa85726cca4541df0,0xa81028c4a90e28e8,0xa827266ba40e1d8c,0xa87628f1a90d28c8,0xa7e32607a3901d27,0xa8c4290aa8fd289e,0xa76e259fa3011cc2,0xa8f6290ea8df286a,0xa6f12534a2711c5d,0xa90e28fda8b1282e,0xa66b24c5a1e01bef,0xa90928d7a87627d3,0xa5de2454a14d1b25,0xa8e8289ea82e273a
.quad 0xa54a23bfa0b91a5a,0xa8ad2850a7b22692,0xa4af22d1a025198f,0xa85727e3a6f125de,0xa40e21e09f1e18c4,0xa7d32703a61c251e,0xa2d120eb9df017f2,0xa6cc2607a5342454,0xa17e1fe69cc2165b,0xa59f24f2a43d2301,0xa0251df09b2514c5,0xa4542390a271214d,0x9d8c1bef98c4125c,0xa1e0211ca0561f1e,0x998f17f294c50e5c,0x9df01d279c5d1b25
.quad 0x24989e559e552498,0x28ffa8ff2882a728,0x20eb17f2a2d12607,0x2901a893277fa534,0x125c211ca51e274b,0x288da7902575a1e0,0xa0252481a6a6282e,0x275da55f221197f2,0xa43d2644a7f22898,0x24f2a17e165b1fe6,0xa63027c2a87c28e2,0x20250e5ca0882454,0xa7d32876a8d72909,0x9bef21e0a4c5266b,0xa88828dba908290c,0xa3ee258aa6f12810
.quad 0xa8eb290ba90b28eb,0xa69227b2a85028ad,0xa90f2905a8e228a8,0xa84a289ea8db2901,0xa8f128c8a88d2843,0xa8e52903a90f2909,0xa8932857a810277f,0xa90e2901a8e828c4,0xa7f2276ea6de2644,0xa8bf2898a86a2835,0xa65825dea55f24dc,0xa80127a1a73a26cc,0xa46b240ea36022a1,0xa5c92575a51e24c5,0xa08820259f821eb9,0xa21121afa14d20eb
.quad 0x1e55a4982728a882,0xa8822728a4981e55,0x2534a77f2893a901,0xa60722d197f2a0eb,0x2809a8b62909a8fb,0x9f1e9bef2360a61c,0x28e2a90f28e8a870,0x21afa534273aa864,0x2906a8bf2835a6de,0x26dea83528bfa906,0x2870a7a12607a425,0x28bba901290ca8db,0x266ba4c521e09bef,0x2909a8d72876a7d3,0x22119d2797f22088,0x284aa77f2630a4af
.quad 0x9a5a20b9a3bf254a,0x254aa3bf20b99a5a,0xa48125b4a6cc27c2,0x1b2517f29f822271,0xa7902827a87628b6,0xa36024c5a5c926b9,0xa8c428e8a901290e,0xa77f2810a8572893,0xa90e2906a8f628df,0xa8df28f6a906290e,0xa89e287ca857282e,0xa8f928e8a8d428bb,0xa70326b9a66b261c,0xa80927d3a790274b,0xa3902331a2d12271,0xa4812454a42523ee
.quad 0xa7282882a8ff28ff,0x24989e559e552498,0xa8e8290ea8c42810,0x9df02454a6cc2857,0xa8d72843a6b9246b,0xa703285da8e5290f,0xa6cc24afa08894c5,0xa8f9290ca8cc283c,0x9fe6965b217ea4f2,0xa89827f2a644243d,0x22d1a55f2716a83c,0xa50822119b259d27,0x27d3a87628d7a909,0x1befa1e024c5a66b,0x2901a90f28f4a8b1,0x26a6a7e32870a8cc
.quad 0x28ada85027b2a692,0x28eba90b290ba8eb,0x2607a4dc2331a088,0x28b1a8642801a716,0x1bef125c9d8c211c,0x2575a46b22a1a056,0xa4542534a60726cc,0x97f21df0a0eb22d1,0xa835286aa89828bf,0xa64426dea76e27f2,0xa90e290fa90c2905,0xa8db28eea8fd2908,0xa876285da8432827,0xa8c828b6a8a3288d,0xa5342508a4dc24af,0xa5de25b4a58a255f
.quad 0x28ffa8ff2882a728,0x1e55a4982728a882,0x2857a6cc24549df0,0x2810a8c4290ea8e8,0x22a198c4a05624c5,0x2903a8a327d3a5c9,0xa33125dea7c22893,0x2630a3ee1df01c5d,0xa86a28dfa90e28f6,0x9cc22301a59f276e,0xa8f928a8a81f26cc,0xa7e32888a8e8290f,0xa66b24c5a1e01bef,0xa90928d7a87627d3,0xe5c9f822331a534,0xa67f2508a2d11eb9
.quad 0x2692a7b22850a8ad,0x1a5aa0b923bfa54a,0x28fda90f2908a8e8,0x27a1a83c2893a8d4,0x285da809274ba66b,0x290da8fb28d7a8a3,0x22d1a0eb1df097f2,0x26cca6072534a454,0xa301243da4f2259f,0x965b1cc29fe6217e,0xa8642888a8a828c4,0xa75d27c2a810283c,0xa8fb28f1a8e528d7,0xa90f290da9092903,0xa67f2658a6302607,0xa71626f1a6cc26a6
.quad 0xa8822728a4981e55,0xa7282882a8ff28ff,0xa0eb97f222d1a607,0xa9012893a77f2534,0x25c9a7d328a3a903,0xa4c5205618c4a2a1,0x2908a90128a8a801,0x2454a67f281fa8bb,0x276ea59f23019cc2,0x28f6a90e28dfa86a,0x94c520eba4812658,0x277fa5de23ee9f82,0xa7d32876a8d72909,0x9bef21e0a4c5266b,0xa8fd28c4a86427c2,0xa85728bba8f9290f
.quad 0xa54a23bfa0b91a5a,0xa8ad2850a7b22692,0x2211a454258aa6a6,0xa0eb1c5d14c59eb9,0x28a3a8d728fba90d,0x266ba74b2809a85d,0x2893a8572810a77f,0x290ea90128e8a8c4,0x217e9fe61cc2965b,0x259fa4f2243da301,0xa58a2607a67f26f1,0xa2d123eea4812508,0xa9032909a90d290f,0xa8d728e5a8f128fb,0xa7a1277fa75d273a,0xa8102801a7e327c2
.quad 0x24989e559e552498,0x28ffa8ff2882a728,0xa534277fa8932901,0x2607a2d117f220eb,0xa90f28e5a85d2703,0xa46b26b9a84328d7,0xa58a2271998f9f82,0xa90f28eea87c277f,0x243da64427f2a898,0xa4f2217e965b9fe6,0x2905a90a28d4a864,0x258aa73a284aa8c4,0x266ba4c521e09bef,0x2909a8d72876a7d3,0xa27124dca65827a1,0x2390a02514c51df0
.quad 0xa8eb290ba90b28eb,0xa69227b2a85028ad,0xa73a2630a5082390,0xa8ee28bba8702810,0x2056a2a1246ba575,0xa11c1d8c925c9bef,0x28c4a8e82901a90e,0x277fa8102857a893,0x27f2a76e26dea644,0x28bfa898286aa835,0x9c5d1eb9a08821af,0x1d27998f0e5c17f2,0xa88d28a3a8b628c8,0xa8272843a85d2876,0xa84a283ca82e281f,0xa87c2870a8642857
.quad 0x1e55a4982728a882,0xa8822728a4981e55,0x28e8a90e28c4a810,0x1df0a45426cca857,0x261ca3601bef1f1e,0x28fba90928b6a809,0xa5082716a85728db,0x24dca0eb8e5c214d,0xa90628bfa83526de,0xa6de2835a8bf2906,0xa1af198f1df0a331,0xa89e2810a6a624dc,0x27d3a87628d7a909,0x1befa1e024c5a66b,0x287ca80126cca55f,0x28eea90e2905a8d4
.quad 0x9a5a20b9a3bf254a,0x254aa3bf20b99a5a,0xa8cc28f9a90e290a,0xa67f277fa82e2888,0xa6b925c9a4c52360,0xa8b62876a8272790,0x2454a5342607a6cc,0x17f29df020eba2d1,0x290ea90628f6a8df,0x28dfa8f62906a90e,0x2331a21120eb9f82,0x25b4a53424afa425,0xa74b2790a7d32809,0xa61c266ba6b92703,0xa8a8289ea8932888,0xa8cc28c4a8bb28b1
.quad 0xa7282882a8ff28ff,0x24989e559e552498,0xa85726cca4541df0,0xa81028c4a90e28e8,0x21e0a5752790a88d,0xa74b251ea11c925c,0x290ea8d4284aa6f1,0x25b4a7a12888a8f4,0x1fe6165ba17e24f2,0x2898a7f22644a43d,0xa89328eea90f28f4,0xa14d24afa67f2801,0xa66b24c5a1e01bef,0xa90928d7a87627d3,0x2607a75d283ca8a8,0x998f9c5d21afa481
.quad 0x28ada85027b2a692,0x28eba90b290ba8eb,0x9df021afa425255f,0x23eea14d1d270e5c,0xa909290fa90328e5,0xa843288da8c828f1,0xa2d120eb9df017f2,0xa6cc2607a5342454,0x2835a86a2898a8bf,0x2644a6de276ea7f2,0x277fa71626a6a630,0x2870a84a281fa7e3,0xa4c5251ea57525c9,0xa2a12360a40e246b,0xa8e828e2a8db28d4,0xa8fd28f9a8f428ee
.quad 0x28ffa8ff2882a728,0x1e55a4982728a882,0x20eb17f2a2d12607,0x2901a893277fa534,0xa8c8290da8f12876,0x9d8c240ea66b2827,0xa4251eb91b25a2d1,0xa90528b1a8102658,0x286aa8df290ea8f6,0x1cc2a301259fa76e,0x25b4a3901eb917f2,0x2908a8cc2857a75d,0xa7d32876a8d72909,0x9bef21e0a4c5266b,0xa71625b4a42520eb,0xa90a28e2a893281f
.quad 0x2692a7b22850a8ad,0x1a5aa0b923bfa54a,0x281fa75d2658a534,0x290ca8f428c4a87c,0xa51e261ca70327d3,0x98c41f1ea1e0240e,0xa8932857a810277f,0xa90e2901a8e828c4,0x2301a43d24f2a59f,0x165b9cc21fe6a17e,0x28e2a8cc28b1a893,0x290fa90a2901a8f4,0x9f1e2056a11c21e0,0x925c18c49bef1d8c,0xa90a2908a9052901,0xa90f290fa90e290c
.quad 0xa8822728a4981e55,0xa7282882a8ff28ff,0x2534a77f2893a901,0xa60722d197f2a0eb,0x2827a66b240e9d8c,0x2876a8f1290da8c8,0xa6582810a8b12905,0x22d19b259eb92425,0xa76e259fa3011cc2,0xa8f6290ea8df286a,0x275da85728cca908,0x97f29eb92390a5b4,0x266ba4c521e09bef,0x2909a8d72876a7d3,0xa81f2893a8e2290a,0xa0eb2425a5b42716
.quad 0xa54a23bfa0b91a5a,0xa8ad2850a7b22692,0x287ca8c428f4a90c,0x2534a658275da81f,0x240ea1e01f1e98c4,0x27d3a703261ca51e,0xa8c428e8a901290e,0xa77f2810a8572893,0xa17e1fe69cc2165b,0xa59f24f2a43d2301,0x28f4a901290aa90f,0x2893a8b128cca8e2,0x1d8c9bef18c4925c,0x21e0a11c20569f1e,0xa90c290ea90f290f,0xa9012905a908290a
.quad 0x24989e559e552498,0x28ffa8ff2882a728,0xa8e8290ea8c42810,0x9df02454a6cc2857,0x925ca11c251ea74b,0xa88d2790a57521e0,0x28f4a88827a1a5b4,0x26f1a84a28d4a90e,0xa43d2644a7f22898,0x24f2a17e165b1fe6,0xa801267fa4af214d,0xa8f4290fa8ee2893,0x27d3a87628d7a909,0x1befa1e024c5a66b,0x2481a1af1c5d198f,0x28a8a83c275da607
.quad 0xa8eb290ba90b28eb,0xa69227b2a85028ad,0x8e5c9d27214da3ee,0xa55f2425a1af1df0,0x28f1a8c8288da843,0x28e5a903290fa909,0xa4542534a60726cc,0x97f21df0a0eb22d1,0xa7f2276ea6de2644,0xa8bf2898a86a2835,0x27e3a81f284aa870,0x2630a6a62716a77f,0x246ba40e2360a2a1,0x25c9a575251ea4c5,0xa8ee28f4a8f928fd,0xa8d428dba8e228e8
.quad 0x1e55a4982728a882,0xa8822728a4981e55,0x2857a6cc24549df0,0x2810a8c4290ea8e8,0xa80928b6a90928fb,0x1f1e1befa360261c,0xa14d0e5c20eba4dc,0xa8db2857a7162508,0x2906a8bf2835a6de,0x26dea83528bfa906,0xa4dc26a6a810289e,0x23319df0998f21af,0xa66b24c5a1e01bef,0xa90928d7a87627d3,0x28d4a905290ea8ee,0x255fa6cc2801a87c
.quad 0x9a5a20b9a3bf254a,0x254aa3bf20b99a5a,0xa888282ea77f267f,0xa90a290ea8f928cc,0x2790a8272876a8b6,0x2360a4c525c9a6b9,0x22d1a0eb1df097f2,0x26cca6072534a454,0xa90e2906a8f628df,0xa8df28f6a906290e,0x2425a4af2534a5b4,0x1f82a0eb2211a331,0x2703a6b9266ba61c,0x2809a7d32790a74b,0xa8b128bba8c428cc,0xa8882893a89e28a8
.quad 0xa7282882a8ff28ff,0x24989e559e552498,0xa0eb97f222d1a607,0xa9012893a77f2534,0x28d7a84326b9a46b,0x2703a85d28e5a90f,0xa77f287ca8ee290f,0x1f82198fa271258a,0x9fe6965b217ea4f2,0xa89827f2a644243d,0x28c4a84a273aa58a,0x2864a8d4290aa905,0xa7d32876a8d72909,0x9bef21e0a4c5266b,0x9df094c52025a390,0xa7a12658a4dc2271
.quad 0x28ada85027b2a692,0x28eba90b290ba8eb,0xa8102870a8bb28ee,0xa3902508a630273a,0x9bef925c1d8ca11c,0xa575246ba2a12056,0x2893a8572810a77f,0x290ea90128e8a8c4,0xa835286aa89828bf,0xa64426dea76e27f2,0x97f28e5c198f9d27,0xa1af20889eb91c5d,0x2876a85d2843a827,0x28c8a8b628a3a88d,0xa8572864a870287c,0xa81f282ea83c284a
.quad 0x28ffa8ff2882a728,0x1e55a4982728a882,0xa534277fa8932901,0x2607a2d117f220eb,0xa2a118c42056a4c5,0xa90328a3a7d325c9,0x28bba81f267fa454,0x2801a8a82901a908,0xa86a28dfa90e28f6,0x9cc22301a59f276e,0x1f82a3ee25dea77f,0xa6582481a0eb14c5,0x266ba4c521e09bef,0x2909a8d72876a7d3,0xa90f28f9a8bb2857,0xa7c22864a8c428fd
.quad 0x2692a7b22850a8ad,0x1a5aa0b923bfa54a,0x1eb994c59c5d20eb,0x26a6a58a2454a211,0xa85d2809a74b266b,0xa90d28fba8d728a3,0x28c4a8e82901a90e,0x277fa8102857a893,0xa301243da4f2259f,0x965b1cc29fe6217e,0xa5082481a3ee22d1,0xa6f1267fa607258a,0x28fba8f128e5a8d7,0x290fa90d2909a903,0xa7c227e3a8012810,0xa73a275da77f27a1
.quad 0xa8822728a4981e55,0xa7282882a8ff28ff,0x28e8a90e28c4a810,0x1df0a45426cca857,0xa5c927d3a8a32903,0x24c5a05698c422a1,0x9c5d9df023eea630,0xa89327c2a5de2331,0x276ea59f23019cc2,0x28f6a90e28dfa86a,0xa90f28e8a88827e3,0xa6cc281fa8a828f9,0x27d3a87628d7a909,0x1befa1e024c5a66b,0x9eb922d1a508267f,0x2534a3311f828e5c
.quad 0xa54a23bfa0b91a5a,0xa8ad2850a7b22692,0x28d4a893283ca7a1,0x28e8a908290fa8fd,0xa8a328d7a8fb290d,0xa66b274ba809285d,0x2454a5342607a6cc,0x17f29df020eba2d1,0x217e9fe61cc2965b,0x259fa4f2243da301,0xa83c2810a7c2275d,0xa8c428a8a8882864,0x2903a909290da90f,0x28d7a8e528f1a8fb,0xa6a626cca6f12716,0xa6072630a658267f
.quad 0x24989e559e552498,0x28ffa8ff2882a728,0xa85726cca4541df0,0xa81028c4a90e28e8,0x290fa8e5285da703,0x246ba6b92843a8d7,0xa83c28cca90c28f9,0x14c52088a4af26cc,0x243da64427f2a898,0xa4f2217e965b9fe6,0x1d271b25a2112508,0x283ca716255fa2d1,0xa66b24c5a1e01bef,0xa90928d7a87627d3,0x28cca87027e3a6a6,0x28b1a8f4290fa901
.quad 0xa8eb290ba90b28eb,0xa69227b2a85028ad,0x2716a8012864a8b1,0x2088a33124dca607,0xa05622a1a46b2575,0x211c9d8c125c1bef,0xa2d120eb9df017f2,0xa6cc2607a5342454,0x27f2a76e26dea644,0x28bfa898286aa835,0xa90828fda8ee28db,0xa905290ca90f290e,0x288da8a328b6a8c8,0x2827a843285da876,0xa55f258aa5b425de,0xa4af24dca5082534
.quad 0x1e55a4982728a882,0xa8822728a4981e55,0x20eb17f2a2d12607,0x2901a893277fa534,0xa61c23609bef9f1e,0xa8fb2909a8b62809,0x2864a73a2534a1af,0x2870a8e8290fa8e2,0xa90628bfa83526de,0xa6de2835a8bf2906,0x28dba90c2901a8bb,0x2425a60727a1a870,0xa7d32876a8d72909,0x9bef21e0a4c5266b,0x24afa630277fa84a,0xa08817f21d27a211
.quad 0x9a5a20b9a3bf254a,0x254aa3bf20b99a5a,0xa2711f8297f29b25,0xa7c226cca5b42481,0x26b9a5c924c5a360,0x28b6a8762827a790,0xa8932857a810277f,0xa90e2901a8e828c4,0x290ea90628f6a8df,0x28dfa8f62906a90e,0xa8bb28d4a8e828f9,0xa82e2857a87c289e,0x274ba79027d3a809,0x261ca66b26b9a703,0xa3ee2425a4542481,0xa27122d1a3312390
.quad 0xa7282882a8ff28ff,0x24989e559e552498,0x2534a77f2893a901,0xa60722d197f2a0eb,0xa1e02575a790288d,0x274ba51e211c125c,0x17f2a211255fa75d,0xa82e26a6a4812025,0x1fe6165ba17e24f2,0x2898a7f22644a43d,0xa45420888e5ca025,0xa8e2287ca7c22630,0x266ba4c521e09bef,0x2909a8d72876a7d3,0xa81026f1a58a23ee,0xa90c2908a8db2888
.quad 0x28ada85027b2a692,0x28eba90b290ba8eb,0xa90128dba89e284a,0xa8a828e2a905290f,0x2909a90f2903a8e5,0x2843a88d28c8a8f1,0xa8c428e8a901290e,0xa77f2810a8572893,0x2835a86a2898a8bf,0x2644a6de276ea7f2,0xa6cc273aa7a12801,0xa4dc255fa5de2658,0x24c5a51e2575a5c9,0x22a1a360240ea46b,0xa0eb214da1af2211,0x9eb91f82a0252088
.quad 0x28ffa8ff2882a728,0x1e55a4982728a882,0xa8e8290ea8c42810,0x9df02454a6cc2857,0x28c8a90d28f1a876,0x1d8ca40e266ba827,0xa89e28fda90a28c4,0x9d272390a60727e3,0x286aa8df290ea8f6,0x1cc2a301259fa76e,0xa82e28b1a8fd290e,0x9c5d2271a53426f1,0x27d3a87628d7a909,0x1befa1e024c5a66b,0xa73a282ea89e28e8,0x9b25214da45425de
.quad 0x2692a7b22850a8ad,0x1a5aa0b923bfa54a,0xa5de26f1a7e32857,0x998f2025a2d124af,0x251ea61c2703a7d3,0x18c49f1e21e0a40e,0xa4542534a60726cc,0x97f21df0a0eb22d1,0x2301a43d24f2a59f,0x165b9cc21fe6a17e,0xa14d2271a3902454,0x94c51b259df02025,0x1f1ea056211ca1e0,0x125c98c41bef9d8c,0x9b251c5d9d271df0,0x8e5c14c597f2198f
.quad 0x2818a5f322410000,0x2818a8d0290fa8d0,0x27d3a59f21e00000,0x2876a8f62909a8ad,0x276ea54a217e0000,0x28bfa90b28f6a882,0x2703a4f2211c0000,0x28f1a90e28d7a850,0x2692a49820b90000,0x290ba8ff28ada818,0x261ca43d20560000,0x290da8df2876a7b2,0x259fa3bf1fe60000,0x28f6a8ad2835a728,0x251ea3011f1e0000,0x28c8a86a27d3a692
.quad 0x2498a2411e550000,0x2882a8182728a5f3,0x240ea17e1d8c0000,0x2827a76e266ba54a,0x2301a0b91cc20000,0x276ea692259fa498,0x21e09fe61bef0000,0x266ba59f24c5a3bf,0x20b99e551a5a0000,0x254aa49823bfa241,0x1f1e9cc218c40000,0x240ea30121e0a0b9,0x1cc29a5a165b0000,0x217ea0b91fe69e55,0x18c4965b125c0000,0x1d8c9cc21bef9a5a
.quad 0xa24100002241a5f3,0xa90f28d0a81825f3,0x9bef9fe624c5a728,0xa8d72835a66b23bf,0x1cc2a3bf2644a818,0xa8352692a43d1e55,0x22a1a59f2790a882,0xa66b243d9f1e9a5a,0x254aa7282850a8d0,0xa3bf1e551a5aa241,0x2703a83528b6a8ff,0x9bef9cc222a1a54a,0x2835a8ad28f6a90f,0x1fe6a3bf259fa728,0x28b6a8f6290fa8ff,0x24c5a6442790a850
.quad 0x28ffa90f28ffa8d0,0x2728a8182882a8d0,0x290da8f628c8a882,0x2876a8bf28f1a90b,0x28dfa8ad286aa818,0x28f6a90b290ea8ff,0x2876a83527d3a728,0x2909a8f628d7a8ad,0x27b2a7282692a5f3,0x28ada8822850a818,0x261ca59f251ea498,0x27d3a76e2703a692,0x243da3bf2301a241,0x259fa54a24f2a498,0x20569fe61f1e9e55,0x21e0a17e211ca0b9
.quad 0xa24125f3a81828d0,0x2818a5f322410000,0xa66b2835a8d7290f,0x24c59fe69bef23bf,0xa86a28eba90e28d0,0x165b20b9a4f22728,0xa9032906a8b62818,0xa40e2644a80928ad,0xa8eb2882a7b225f3,0xa7b22882a8eb290f,0xa82726dea51e2241,0xa8e5290ea8fb28ad,0xa59f23bf9fe60000,0xa8f628ada8352728,0xa056165b1d8ca241,0xa80926dea57523bf
.quad 0x1e55a2412498a5f3,0xa49822419e550000,0x251ea644274ba818,0x925c9cc2211ca3bf,0x27f2a8502898a8d0,0x243da54a2644a728,0x28d7a8f62909a90f,0x27d3a8352876a8ad,0x290ba8ff28eba8d0,0x28eba8ff290ba90f,0x288da86a2843a818,0x28f1a8df28c8a8ad,0x26dea6922644a5f3,0x27f2a7b2276ea728,0x2360a30122a1a241,0x246ba43d240ea3bf
.quad 0x2818a8d0290fa8d0,0xa24100002241a5f3,0x2909a8f62876a728,0x21e0a59f27d3a8ad,0x2898a7b2259fa241,0x27f2a8ad2906a8ff,0x25c9a3011bef1e55,0x290da8f6288da7b2,0x1a5a1e55a3bf25f3,0x2850a728254aa241,0xa46b2644a7d32882,0x240e9fe6925c20b9,0xa83528ada8f6290f,0x9fe623bfa59f2728,0xa90d2906a8d72882,0xa74b2835a8a328eb
.quad 0xa8822818a72825f3,0xa8ff290fa8ff28d0,0xa575243da1e01e55,0xa88d2835a7902692,0x965b9a5a1fe6a241,0xa4f223bfa17e1e55,0x24c5a59f266ba728,0x1bef9fe621e0a3bf,0x2850a88228ada8d0,0x2692a72827b2a818,0x290fa90e2909a8ff,0x28e5a8f62903a90b,0x286aa8502835a818,0x28bfa8ad2898a882,0x251ea4f224c5a498,0x25c9a59f2575a54a
.quad 0xa90f28d0a81825f3,0xa24125f3a81828d0,0xa7d3259fa1e00000,0xa87628f6a90928ad,0x9fe69a5a2301a5f3,0xa8df2850a6de2498,0x24c5a6de2843a8d0,0xa51e217e925ca0b9,0x28ada8ff290ba8d0,0x20b9a4982692a818,0x28d7a86a2790a5f3,0x2843a8bf2903a90b,0x259fa3bf1fe60000,0x28f6a8ad2835a728,0x9bef217ea46b25f3,0x25c9a43d211c9a5a
.quad 0xa7282818a88228d0,0x9e552241a49825f3,0xa909290ea8fb28d0,0xa809286aa8b628eb,0xa83527b2a6de25f3,0xa90628eba8bf2882,0xa1e01fe69bef0000,0xa66b259fa4c523bf,0x23bfa498254aa5f3,0x1a5a9e5520b9a241,0x2876a89828b6a8d0,0x2790a7f22827a850,0x28f6a8eb28dfa8d0,0x290ea90b2906a8ff,0x266ba644261ca5f3,0x2703a6de26b9a692
.quad 0x2818a5f322410000,0x2818a8d0290fa8d0,0x1bef1fe6a4c52728,0x28d7a835266ba3bf,0xa6de2850a8df290f,0x23019a5a9fe62498,0xa90f28dfa85d2728,0xa575276ea87628eb,0xa6922498a0b90000,0xa90b28ffa8ad2818,0x1d8ca3012575a728,0xa6b924f2a1e01a5a,0x2835a8ad28f6a90f,0x1fe6a3bf259fa728,0x28e5a8982827a728,0x288da8df2909a90b
.quad 0x2498a2411e550000,0x2882a8182728a5f3,0xa36024f2a61c2728,0x1f1e965b9bef20b9,0xa8bf28eba906290f,0xa6de27b2a8352882,0xa8762835a7d32728,0xa90928f6a8d728ad,0xa0b91e559a5a0000,0xa54a2498a3bf2241,0x25c9a64426b9a728,0x2360a43d24c5a54a,0x2906a90b290ea90f,0x28dfa8eb28f6a8ff,0x2790a76e274ba728,0x2809a7f227d3a7b2
.quad 0xa24100002241a5f3,0xa90f28d0a81825f3,0x266ba83528d7a90f,0xa4c51fe61befa3bf,0x2906a8ad27f2a5f3,0x259fa7b22898a8ff,0x246b9fe698c42241,0x2909a8bf2827a692,0xa54a2728a85028d0,0x23bf9e559a5a2241,0xa90f28f6a8a32818,0xa66b27f2a88d28eb,0xa59f23bf9fe60000,0xa8f628ada8352728,0x240ea59f2703a818,0xa1e01cc218c4a0b9
.quad 0x28ffa90f28ffa8d0,0x2728a8182882a8d0,0x26b9a59f246ba241,0x28d7a8982843a7b2,0xa17e23bfa4f225f3,0x1fe69a5a965b1e55,0xa8d728f6a909290f,0xa7d32835a87628ad,0xa7b22728a69225f3,0xa8ad2882a8502818,0x1d8c9fe6211ca241,0x9bef165b125c9a5a,0x2898a8ad28bfa8d0,0x2835a850286aa882,0x2843a8352827a818,0x2876a86a285da850
.quad 0xa24125f3a81828d0,0x2818a5f322410000,0xa90928f6a8762728,0xa1e0259fa7d328ad,0xa4f220b9165ba241,0xa90e28eba86a2728,0x261ca7f228a3a8ff,0xa3601cc21d8ca3bf,0x28eba88227b2a5f3,0x27b2a88228eba90f,0x1f1e165ba11c2498,0x285da76e25c9a3bf,0xa83528ada8f6290f,0x9fe623bfa59f2728,0xa843276ea61c2498,0xa903290ea8f128ad
.quad 0x1e55a2412498a5f3,0xa49822419e550000,0x28e5a906290fa8ff,0x2703a7f2285da8ad,0x2644a54a243da241,0x2898a85027f2a728,0xa4c5259fa66b2728,0x9bef1fe6a1e023bf,0xa90b28ffa8eb28d0,0xa8eb28ffa90b290f,0xa2a1217ea0561e55,0xa57524f2a46b23bf,0x276ea7b227f2a818,0x2644a69226dea728,0x28a3a898288da882,0x28c8a8bf28b6a8ad
.quad 0x2818a8d0290fa8d0,0xa24100002241a5f3,0x27d3a59f21e00000,0x2876a8f62909a8ad,0xa43d2692a83528d0,0x2644a3bf1cc21e55,0xa8fb2898a7d325f3,0xa6b92835a8c8290b,0x9a5a9e5523bfa5f3,0xa8502728a54a2241,0x28c8a9062909a8d0,0x2360a59f274ba850,0x259fa3bf1fe60000,0x28f6a8ad2835a728,0xa6b927f2a87628d0,0x925c1fe6a360254a
.quad 0xa8822818a72825f3,0xa8ff290fa8ff28d0,0x2056a30124c5a5f3,0xa2a11fe698c49a5a,0x290ea90b28f6a8d0,0x286aa8ad28dfa8ff,0x21e09fe61bef0000,0x266ba59f24c5a3bf,0xa8502882a8ad28d0,0xa6922728a7b22818,0xa74b26dea66b25f3,0xa85d2835a80927b2,0x24f2a54a259fa5f3,0x2301a3bf243da498,0x28e5a8df28d7a8d0,0x28fba8f628f1a8eb
.quad 0xa90f28d0a81825f3,0xa24125f3a81828d0,0x9bef9fe624c5a728,0xa8d72835a66b23bf,0x28f6a90b28bfa818,0x217ea54a276ea882,0x21e0965ba0562498,0x28e5a86a274ba54a,0xa8ad28ffa90b28d0,0xa0b92498a6922818,0xa4c5217e98c49e55,0xa8f12898a8092692,0x2835a8ad28f6a90f,0x1fe6a3bf259fa728,0x266ba4f222a19e55,0x28fba8bf285da7b2
.quad 0xa7282818a88228d0,0x9e552241a49825f3,0xa7d326dea5c92498,0xa90328dfa8a32850,0x259fa692276ea818,0x1cc2a0b92301a498,0x2876a83527d3a728,0x2909a8f628d7a8ad,0xa3bf2498a54a25f3,0x9a5a1e55a0b92241,0xa8d728bfa8a32882,0xa90d2906a8fb28eb,0x1fe6a0b9217ea241,0x165b9a5a1cc29e55,0x2909a9062903a8ff,0x290fa90e290da90b
.quad 0x2818a5f322410000,0x2818a8d0290fa8d0,0xa66b2835a8d7290f,0x24c59fe69bef23bf,0xa76e254aa17e0000,0xa8bf290ba8f62882,0x274ba86a28e5a90f,0xa056965b21e0a54a,0x2692a49820b90000,0x290ba8ff28ada818,0xa8092898a8f1290f,0x98c4217ea4c52692,0xa59f23bf9fe60000,0xa8f628ada8352728,0x285da8bf28fba90f,0x22a1a4f2266ba7b2
.quad 0x2498a2411e550000,0x2882a8182728a5f3,0xa8a328dfa903290f,0xa5c926dea7d32850,0xa30120b99cc20000,0xa76e2692a59f2498,0x28d7a8f62909a90f,0x27d3a8352876a8ad,0x20b99e551a5a0000,0x254aa49823bfa241,0xa8fb2906a90d290f,0xa8a328bfa8d728eb,0x9cc21a5a965b0000,0xa17e20b99fe61e55,0x290da90e290fa90f,0x2903a9062909a90b
.quad 0xa24100002241a5f3,0xa90f28d0a81825f3,0x2909a8f62876a728,0x21e0a59f27d3a8ad,0x9cc223bfa6442818,0x2835a692243d9e55,0xa8c82835a6b92498,0xa7d32898a8fb290b,0x254aa7282850a8d0,0xa3bf1e551a5aa241,0x274ba59f23609e55,0x2909a90628c8a850,0xa83528ada8f6290f,0x9fe623bfa59f2728,0xa3601fe6925c9e55,0xa87627f2a6b9254a
.quad 0x28ffa90f28ffa8d0,0x2728a8182882a8d0,0x98c41fe6a2a12498,0x24c5a30120569a5a,0xa8df28ada86a2818,0xa8f6290ba90e28ff,0x24c5a59f266ba728,0x1bef9fe621e0a3bf,0x27b2a7282692a5f3,0x28ada8822850a818,0xa8092835a85d2882,0xa66b26dea74b27b2,0xa43d23bfa3012241,0xa59f254aa4f22498,0x28f1a8f628fba8ff,0x28d7a8df28e5a8eb
.quad 0xa24125f3a81828d0,0x2818a5f322410000,0xa7d3259fa1e00000,0xa87628f6a90928ad,0x286aa8eb290ea8d0,0x965ba0b924f2a728,0x1d8c1cc2a36025f3,0x28a3a7f2261ca3bf,0xa8eb2882a7b225f3,0xa7b22882a8eb290f,0x25c9a76e285da8d0,0xa11c165b1f1ea3bf,0x259fa3bf1fe60000,0x28f6a8ad2835a728,0xa8f1290ea90328d0,0xa61c276ea84328ad
.quad 0x1e55a2412498a5f3,0xa49822419e550000,0x285da7f22703a5f3,0x290fa90628e5a8ad,0xa7f22850a89828d0,0xa43d254aa6442728,0xa1e01fe69bef0000,0xa66b259fa4c523bf,0x290ba8ff28eba8d0,0x28eba8ff290ba90f,0xa46b24f2a57525f3,0xa056217ea2a123bf,0xa6de2692a64425f3,0xa7f227b2a76e2728,0x28b6a8bf28c8a8d0,0x288da89828a3a8ad
.quad 0x2818a8d0290fa8d0,0xa24100002241a5f3,0x1bef1fe6a4c52728,0x28d7a835266ba3bf,0xa89827b2a59f2241,0xa7f228ada90628ff,0x2827a8bf2909a8ff,0x98c49fe6246ba692,0x1a5a1e55a3bf25f3,0x2850a728254aa241,0xa88d27f2a66b2498,0xa8a328f6a90f28eb,0x2835a8ad28f6a90f,0x1fe6a3bf259fa728,0x18c41cc2a1e02498,0x2703a59f240ea0b9
.quad 0xa8822818a72825f3,0xa8ff290fa8ff28d0,0x2843a89828d7a8ff,0x246ba59f26b9a7b2,0x165b1a5a9fe62241,0x24f2a3bf217e9e55,0xa8762835a7d32728,0xa90928f6a8d728ad,0x2850a88228ada8d0,0x2692a72827b2a818,0x125c165b9bef1e55,0x211c9fe61d8c9a5a,0xa86a2850a8352818,0xa8bf28ada8982882,0x285da86a2876a882,0x2827a8352843a850
.quad 0xa90f28d0a81825f3,0xa24125f3a81828d0,0x266ba83528d7a90f,0xa4c51fe61befa3bf,0x1fe61a5aa30125f3,0x28dfa85026dea498,0xa876276ea5752241,0xa85d28dfa90f28eb,0x28ada8ff290ba8d0,0x20b9a4982692a818,0xa1e024f2a6b92818,0x2575a3011d8c1a5a,0xa59f23bf9fe60000,0xa8f628ada8352728,0x2909a8df288da818,0x2827a89828e5a90b
.quad 0xa7282818a88228d0,0x9e552241a49825f3,0x9bef965b1f1ea241,0xa61c24f2a36020b9,0x2835a7b226dea5f3,0x2906a8eb28bfa882,0xa8d728f6a909290f,0xa7d32835a87628ad,0x23bfa498254aa5f3,0x1a5a9e5520b9a241,0x24c5a43d2360a241,0x26b9a64425c9a54a,0xa8f628eba8df28d0,0xa90e290ba90628ff,0x27d3a7f22809a818,0x274ba76e2790a7b2
.quad 0x2818a5f322410000,0x2818a8d0290fa8d0,0xa90928f6a8762728,0xa1e0259fa7d328ad,0x26dea85028dfa90f,0xa3011a5a1fe6a498,0x925c217ea51e2728,0x2843a6de24c5a0b9,0xa6922498a0b90000,0xa90b28ffa8ad2818,0x2903a8bf2843a728,0x2790a86a28d7a90b,0xa83528ada8f6290f,0x9fe623bfa59f2728,0x211ca43d25c9a728,0xa46b217e9bef9a5a
.quad 0x2498a2411e550000,0x2882a8182728a5f3,0xa8b6286aa8092728,0xa8fb290ea90928eb,0x28bfa8eb2906a90f,0x26dea7b22835a882,0xa4c5259fa66b2728,0x9bef1fe6a1e023bf,0xa0b91e559a5a0000,0xa54a2498a3bf2241,0x2827a7f22790a728,0x28b6a8982876a850,0xa906290ba90e290f,0xa8df28eba8f628ff,0x26b9a6de2703a728,0x261ca644266ba692
.quad 0xa24100002241a5f3,0xa90f28d0a81825f3,0x27d3a59f21e00000,0x2876a8f62909a8ad,0xa90628ada7f225f3,0xa59f27b2a89828ff,0x288da8f6290da8d0,0x1befa30125c9a7b2,0xa54a2728a85028d0,0x23bf9e559a5a2241,0x925c9fe6240ea5f3,0xa7d32644a46b20b9,0x259fa3bf1fe60000,0x28f6a8ad2835a728,0xa8a32835a74b25f3,0xa8d72906a90d28eb
.quad 0x28ffa90f28ffa8d0,0x2728a8182882a8d0,0xa7902835a88d28d0,0xa1e0243da5752692,0x217ea3bf24f2a5f3,0x9fe61a5a165b9e55,0x21e09fe61bef0000,0x266ba59f24c5a3bf,0xa7b22728a69225f3,0xa8ad2882a8502818,0x2903a8f628e5a8d0,0x2909a90e290fa90b,0xa89828ada8bf28d0,0xa8352850a86a2882,0x2575a59f25c9a5f3,0x24c5a4f2251ea54a
.quad 0xa24125f3a81828d0,0x2818a5f322410000,0x9bef9fe624c5a728,0xa8d72835a66b23bf,0x24f2a0b9965b2241,0x290ea8eb286aa728,0xa8092644a40e1e55,0xa8b62906a90328ad,0x28eba88227b2a5f3,0x27b2a88228eba90f,0xa8fb290ea8e52882,0xa51e26dea82728ad,0x2835a8ad28f6a90f,0x1fe6a3bf259fa728,0xa57526dea8092882,0x1d8c165ba05623bf
.quad 0x1e55a2412498a5f3,0xa49822419e550000,0x211c9cc2925c1e55,0x274ba644251ea3bf,0xa644254aa43d2241,0xa8982850a7f22728,0x2876a83527d3a728,0x2909a8f628d7a8ad,0xa90b28ffa8eb28d0,0xa8eb28ffa90b290f,0x28c8a8df28f1a8ff,0x2843a86a288da8ad,0xa76e27b2a7f22818,0xa6442692a6de2728,0x240ea43d246ba498,0x22a1a3012360a3bf
.quad 0x2818a8d0290fa8d0,0xa24100002241a5f3,0xa66b2835a8d7290f,0x24c59fe69bef23bf,0x243da6922835a8d0,0xa64423bf9cc29e55,0x9f1e243da66b2818,0x2790a59f22a19a5a,0x9a5a9e5523bfa5f3,0xa8502728a54a2241,0x22a19cc29bef2241,0x28b6a8352703a54a,0xa59f23bf9fe60000,0xa8f628ada8352728,0x2790a64424c5a241,0x290fa8f628b6a850
.quad 0xa8822818a72825f3,0xa8ff290fa8ff28d0,0x28f1a8bf2876a818,0x28c8a8f6290da90b,0xa90e290ba8f628d0,0xa86a28ada8df28ff,0x28d7a8f62909a90f,0x27d3a8352876a8ad,0xa8502882a8ad28d0,0xa6922728a7b22818,0x2703a76e27d3a818,0x251ea59f261ca692,0xa4f2254aa59f25f3,0xa30123bfa43d2498,0x211ca17e21e0a241,0x1f1e9fe62056a0b9
.quad 0xa90f28d0a81825f3,0xa24125f3a81828d0,0x2909a8f62876a728,0x21e0a59f27d3a8ad,0xa8f6290ba8bf2818,0xa17e254aa76e2882,0x28d7a90e28f1a882,0x211ca4f22703a850,0xa8ad28ffa90b28d0,0xa0b92498a6922818,0x2876a8df290da8ff,0x2056a43d261ca7b2,0xa83528ada8f6290f,0x9fe623bfa59f2728,0x27d3a86a28c8a8ff,0x1f1ea301251ea692
.quad 0xa7282818a88228d0,0x9e552241a49825f3,0x266ba76e2827a882,0x1d8ca17e240ea54a,0xa59f2692a76e2818,0x9cc220b9a3012498,0x24c5a59f266ba728,0x1bef9fe621e0a3bf,0xa3bf2498a54a25f3,0x9a5a1e55a0b92241,0x21e0a301240ea498,0x18c49cc21f1ea0b9,0x9fe620b9a17e2241,0x965b1a5a9cc21e55,0x1bef9cc21d8c9e55,0x125c965b18c49a5a
.quad 0xa4982728a88228ff,0x2728a4981e551e55,0xa534277fa8932901,0x2607a2d117f220eb,0xa5c927d3a8a32903,0x24c5a05698c422a1,0xa6582810a8b12905,0x22d19b259eb92425,0xa6de2835a8bf2906,0x1fe6165ba17e24f2,0xa75d2857a8cc2908,0x17f21eb9a39025b4,0xa7d32876a8d72909,0x9bef21e0a4c5266b,0xa81f2893a8e2290a,0xa0eb2425a5b42716
.quad 0xa85028ada8eb290b,0xa3bf254aa69227b2,0xa87c28c4a8f4290c,0xa5342658a75d281f,0xa8a328d7a8fb290d,0xa66b274ba809285d,0xa8c428e8a901290e,0xa77f2810a8572893,0xa8df28f6a906290e,0xa835286aa89828bf,0xa8f42901a90a290f,0xa89328b1a8cc28e2,0xa9032909a90d290f,0xa8d728e5a8f128fb,0xa90c290ea90f290f,0xa9012905a908290a
.quad 0x2882a8ff28ffa882,0x9e559e552498a728,0x28e8a90e28c4a810,0x1df0a45426cca857,0x290fa8e5285da703,0x246ba6b92843a8d7,0x28f4a88827a1a5b4,0x26f1a84a28d4a90e,0x2898a7f22644a43d,0x286aa8df290ea8f6,0x2801a67f24afa14d,0x28f4a90f28eea893,0x266ba4c521e09bef,0x2909a8d72876a7d3,0x2481a1af1c5d198f,0x28a8a83c275da607
.quad 0x20b99a5a9a5a20b9,0x27b2a692254aa3bf,0xe5c1d27a14d23ee,0x255fa42521af9df0,0xa05622a1a46b2575,0x211c9d8c125c1bef,0xa4542534a60726cc,0x97f21df0a0eb22d1,0xa64426dea76e27f2,0xa301243da4f2259f,0xa7e3281fa84a2870,0xa63026a6a716277f,0xa88d28a3a8b628c8,0xa8272843a85d2876,0xa8ee28f4a8f928fd,0xa8d428dba8e228e8
.quad 0xa8ff2882a7282498,0xa4982728a88228ff,0xa85726cca4541df0,0xa81028c4a90e28e8,0xa61c23609bef9f1e,0xa8fb2909a8b62809,0xa14d0e5c20eba4dc,0xa8db2857a7162508,0x1cc2a301259fa76e,0xa76e259fa3011cc2,0x24dca6a62810a89e,0xa3311df0198fa1af,0x27d3a87628d7a909,0x1befa1e024c5a66b,0x28d4a905290ea8ee,0x255fa6cc2801a87c
.quad 0x290ba8eb28ada850,0x2850a8ad28eba90b,0x2888a82e277fa67f,0x290aa90e28f9a8cc,0x26b9a5c924c5a360,0x28b6a8762827a790,0x22d1a0eb1df097f2,0x26cca6072534a454,0x965b1cc29fe6217e,0x217e9fe61cc2965b,0xa42524afa53425b4,0x9f8220eba2112331,0xa74b2790a7d32809,0xa61c266ba6b92703,0xa8b128bba8c428cc,0xa8882893a89e28a8
.quad 0x2728a4981e551e55,0x2882a8ff28ffa882,0x20eb17f2a2d12607,0x2901a893277fa534,0xa1e02575a790288d,0x274ba51e211c125c,0xa77f287ca8ee290f,0x1f82198fa271258a,0xa8f6290ea8df286a,0xa43d2644a7f22898,0xa8c4284aa73a258a,0xa86428d4a90a2905,0xa66b24c5a1e01bef,0xa90928d7a87627d3,0x9df094c52025a390,0xa7a12658a4dc2271
.quad 0x23bfa54a2692a7b2,0xa0b91a5a1a5aa0b9,0x2810a87028bba8ee,0x2390a5082630a73a,0x2909a90f2903a8e5,0x2843a88d28c8a8f1,0x2893a8572810a77f,0x290ea90128e8a8c4,0x259fa4f2243da301,0x27f2a76e26dea644,0x17f20e5c998f1d27,0x21afa0881eb99c5d,0xa4c5251ea57525c9,0xa2a12360a40e246b,0xa8572864a870287c,0xa81f282ea83c284a
.quad 0x9e559e552498a728,0xa8ff2882a7282498,0x2534a77f2893a901,0xa60722d197f2a0eb,0x28c8a90d28f1a876,0x1d8ca40e266ba827,0x28bba81f267fa454,0x2801a8a82901a908,0x24f2a17e165b1fe6,0x2906a8bf2835a6de,0x9f8223eea5de277f,0x2658a48120eb94c5,0xa7d32876a8d72909,0x9bef21e0a4c5266b,0xa90f28f9a8bb2857,0xa7c22864a8c428fd
.quad 0xa7b22692a54a23bf,0xa90b28eba8ad2850,0x9eb914c51c5da0eb,0xa6a6258aa4542211,0x251ea61c2703a7d3,0x18c49f1e21e0a40e,0x28c4a8e82901a90e,0x277fa8102857a893,0x28bfa898286aa835,0x290ea90628f6a8df,0x2508a48123eea2d1,0x26f1a67f2607a58a,0x9f1e2056a11c21e0,0x925c18c49bef1d8c,0xa7c227e3a8012810,0xa73a275da77f27a1
.quad 0xa4982728a88228ff,0x2728a4981e551e55,0xa8e8290ea8c42810,0x9df02454a6cc2857,0xa827266ba40e1d8c,0xa87628f1a90d28c8,0x9c5d9df023eea630,0xa89327c2a5de2331,0x26dea83528bfa906,0x9fe6965b217ea4f2,0x290fa8e82888a7e3,0x26cca81f28a8a8f9,0x266ba4c521e09bef,0x2909a8d72876a7d3,0x9eb922d1a508267f,0x2534a3311f828e5c
.quad 0xa85028ada8eb290b,0xa3bf254aa69227b2,0xa8d42893a83c27a1,0xa8e82908a90f28fd,0xa40e21e09f1e18c4,0xa7d32703a61c251e,0x2454a5342607a6cc,0x17f29df020eba2d1,0x28dfa8f62906a90e,0x2835a86a2898a8bf,0x283ca81027c2a75d,0x28c4a8a82888a864,0x1d8c9bef18c4925c,0x21e0a11c20569f1e,0xa6a626cca6f12716,0xa6072630a658267f
.quad 0x2882a8ff28ffa882,0x9e559e552498a728,0x2857a6cc24549df0,0x2810a8c4290ea8e8,0x125c211ca51e274b,0x288da7902575a1e0,0xa83c28cca90c28f9,0x14c52088a4af26cc,0xa89827f2a644243d,0xa86a28dfa90e28f6,0x9d279b252211a508,0xa83c2716a55f22d1,0x27d3a87628d7a909,0x1befa1e024c5a66b,0x28cca87027e3a6a6,0x28b1a8f4290fa901
.quad 0x20b99a5a9a5a20b9,0x27b2a692254aa3bf,0xa7162801a86428b1,0xa0882331a4dc2607,0xa8f128c8a88d2843,0xa8e52903a90f2909,0xa2d120eb9df017f2,0xa6cc2607a5342454,0x2644a6de276ea7f2,0x2301a43d24f2a59f,0x2908a8fd28eea8db,0x2905a90c290fa90e,0x246ba40e2360a2a1,0x25c9a575251ea4c5,0xa55f258aa5b425de,0xa4af24dca5082534
.quad 0xa8ff2882a7282498,0xa4982728a88228ff,0xa0eb97f222d1a607,0xa9012893a77f2534,0x2809a8b62909a8fb,0x9f1e9bef2360a61c,0x2864a73a2534a1af,0x2870a8e8290fa8e2,0x9cc22301a59f276e,0x276ea59f23019cc2,0xa8db290ca90128bb,0xa4252607a7a12870,0xa66b24c5a1e01bef,0xa90928d7a87627d3,0x24afa630277fa84a,0xa08817f21d27a211
.quad 0x290ba8eb28ada850,0x2850a8ad28eba90b,0x22719f8217f21b25,0x27c2a6cc25b4a481,0xa7902827a87628b6,0xa36024c5a5c926b9,0xa8932857a810277f,0xa90e2901a8e828c4,0x165b9cc21fe6a17e,0xa17e1fe69cc2165b,0x28bba8d428e8a8f9,0x282ea857287ca89e,0x2703a6b9266ba61c,0x2809a7d32790a74b,0xa3ee2425a4542481,0xa27122d1a3312390
.quad 0x2728a4981e551e55,0x2882a8ff28ffa882,0xa534277fa8932901,0x2607a2d117f220eb,0xa8d72843a6b9246b,0xa703285da8e5290f,0x17f2a211255fa75d,0xa82e26a6a4812025,0x28f6a90e28dfa86a,0x243da64427f2a898,0x2454a0880e5c2025,0x28e2a87c27c2a630,0xa7d32876a8d72909,0x9bef21e0a4c5266b,0xa81026f1a58a23ee,0xa90c2908a8db2888
.quad 0x23bfa54a2692a7b2,0xa0b91a5a1a5aa0b9,0x2901a8db289ea84a,0x28a8a8e22905a90f,0x1bef125c9d8c211c,0x2575a46b22a1a056,0xa8c428e8a901290e,0xa77f2810a8572893,0xa59f24f2a43d2301,0xa7f2276ea6de2644,0x26cca73a27a1a801,0x24dca55f25dea658,0x2876a85d2843a827,0x28c8a8b628a3a88d,0xa0eb214da1af2211,0x9eb91f82a0252088
.quad 0x9e559e552498a728,0xa8ff2882a7282498,0x28e8a90e28c4a810,0x1df0a45426cca857,0x22a198c4a05624c5,0x2903a8a327d3a5c9,0xa89e28fda90a28c4,0x9d272390a60727e3,0xa4f2217e965b9fe6,0xa90628bfa83526de,0x282ea8b128fda90e,0x1c5da2712534a6f1,0x266ba4c521e09bef,0x2909a8d72876a7d3,0xa73a282ea89e28e8,0x9b25214da45425de
.quad 0xa7b22692a54a23bf,0xa90b28eba8ad2850,0x25dea6f127e3a857,0x198fa02522d1a4af,0x285da809274ba66b,0x290da8fb28d7a8a3,0xa4542534a60726cc,0x97f21df0a0eb22d1,0xa8bf2898a86a2835,0xa90e2906a8f628df,0x214da2712390a454,0x14c59b251df0a025,0x28fba8f128e5a8d7,0x290fa90d2909a903,0x9b251c5d9d271df0,0x8e5c14c597f2198f
.quad 0xa4982728a88228ff,0x2728a4981e551e55,0xa85726cca4541df0,0xa81028c4a90e28e8,0x25c9a7d328a3a903,0xa4c5205618c4a2a1,0x27e3a60723909d27,0x28c4a90a28fda89e,0xa6de2835a8bf2906,0x1fe6165ba17e24f2,0xa6f12534a2711c5d,0xa90e28fda8b1282e,0x27d3a87628d7a909,0x1befa1e024c5a66b,0x25dea454214d9b25,0x28e8a89e282ea73a
.quad 0xa85028ada8eb290b,0xa3bf254aa69227b2,0xa4af22d1a025198f,0xa85727e3a6f125de,0x28a3a8d728fba90d,0x266ba74b2809a85d,0x22d1a0eb1df097f2,0x26cca6072534a454,0xa8df28f6a906290e,0xa835286aa89828bf,0xa0251df09b2514c5,0xa4542390a271214d,0x2903a909290da90f,0x28d7a8e528f1a8fb,0x198f97f214c58e5c,0x1df09d271c5d9b25
.quad 0x2882a8ff28ffa882,0x9e559e552498a728,0x20eb17f2a2d12607,0x2901a893277fa534,0xa90f28e5a85d2703,0xa46b26b9a84328d7,0x2025a48126a6a82e,0xa75d255fa21117f2,0x2898a7f22644a43d,0x286aa8df290ea8f6,0xa63027c2a87c28e2,0x20250e5ca0882454,0xa66b24c5a1e01bef,0xa90928d7a87627d3,0x2888a8db2908a90c,0x23eea58a26f1a810
.quad 0x20b99a5a9a5a20b9,0x27b2a692254aa3bf,0xa90f2905a8e228a8,0xa84a289ea8db2901,0x2056a2a1246ba575,0xa11c1d8c925c9bef,0x2893a8572810a77f,0x290ea90128e8a8c4,0xa64426dea76e27f2,0xa301243da4f2259f,0xa65825dea55f24dc,0xa80127a1a73a26cc,0x288da8a328b6a8c8,0x2827a843285da876,0x2088a0251f829eb9,0x2211a1af214da0eb
.quad 0xa8ff2882a7282498,0xa4982728a88228ff,0x2534a77f2893a901,0xa60722d197f2a0eb,0x261ca3601bef1f1e,0x28fba90928b6a809,0xa8e2290fa8e82870,0xa1af2534a73a2864,0x1cc2a301259fa76e,0xa76e259fa3011cc2,0x2870a7a12607a425,0x28bba901290ca8db,0xa7d32876a8d72909,0x9bef21e0a4c5266b,0xa2111d2717f2a088,0xa84a277fa63024af
.quad 0x290ba8eb28ada850,0x2850a8ad28eba90b,0xa48125b4a6cc27c2,0x1b2517f29f822271,0xa6b925c9a4c52360,0xa8b62876a8272790,0x28c4a8e82901a90e,0x277fa8102857a893,0x965b1cc29fe6217e,0x217e9fe61cc2965b,0xa89e287ca857282e,0xa8f928e8a8d428bb,0x274ba79027d3a809,0x261ca66b26b9a703,0x2390a33122d1a271,0x2481a4542425a3ee
.quad 0x2728a4981e551e55,0x2882a8ff28ffa882,0xa8e8290ea8c42810,0x9df02454a6cc2857,0x21e0a5752790a88d,0xa74b251ea11c925c,0x26cca4af208814c5,0x28f9a90c28cca83c,0xa8f6290ea8df286a,0xa43d2644a7f22898,0x22d1a55f2716a83c,0xa50822119b259d27,0x266ba4c521e09bef,0x2909a8d72876a7d3,0xa901290fa8f428b1,0xa6a627e3a87028cc
.quad 0x23bfa54a2692a7b2,0xa0b91a5a1a5aa0b9,0x2607a4dc2331a088,0x28b1a8642801a716,0xa909290fa90328e5,0xa843288da8c828f1,0x2454a5342607a6cc,0x17f29df020eba2d1,0x259fa4f2243da301,0x27f2a76e26dea644,0xa90e290fa90c2905,0xa8db28eea8fd2908,0x24c5a51e2575a5c9,0x22a1a360240ea46b,0x2534a50824dca4af,0x25dea5b4258aa55f
.quad 0x9e559e552498a728,0xa8ff2882a7282498,0x2857a6cc24549df0,0x2810a8c4290ea8e8,0xa8c8290da8f12876,0x9d8c240ea66b2827,0x2331a5de27c2a893,0xa63023ee9df09c5d,0x24f2a17e165b1fe6,0x2906a8bf2835a6de,0xa8f928a8a81f26cc,0xa7e32888a8e8290f,0x27d3a87628d7a909,0x1befa1e024c5a66b,0x8e5c1f82a3312534,0x267fa50822d19eb9
.quad 0xa7b22692a54a23bf,0xa90b28eba8ad2850,0x28fda90f2908a8e8,0x27a1a83c2893a8d4,0xa51e261ca70327d3,0x98c41f1ea1e0240e,0xa2d120eb9df017f2,0xa6cc2607a5342454,0x28bfa898286aa835,0x290ea90628f6a8df,0xa8642888a8a828c4,0xa75d27c2a810283c,0x1f1ea056211ca1e0,0x125c98c41bef9d8c,0x267fa6582630a607,0x2716a6f126cca6a6
.quad 0xa4982728a88228ff,0x2728a4981e551e55,0xa0eb97f222d1a607,0xa9012893a77f2534,0x2827a66b240e9d8c,0x2876a8f1290da8c8,0xa9082901a8a82801,0xa454267fa81f28bb,0x26dea83528bfa906,0x9fe6965b217ea4f2,0x94c520eba4812658,0x277fa5de23ee9f82,0xa66b24c5a1e01bef,0xa90928d7a87627d3,0x28fda8c42864a7c2,0x2857a8bb28f9a90f
.quad 0xa85028ada8eb290b,0xa3bf254aa69227b2,0x2211a454258aa6a6,0xa0eb1c5d14c59eb9,0x240ea1e01f1e98c4,0x27d3a703261ca51e,0xa8932857a810277f,0xa90e2901a8e828c4,0x28dfa8f62906a90e,0x2835a86a2898a8bf,0xa58a2607a67f26f1,0xa2d123eea4812508,0x9d8c1bef98c4125c,0xa1e0211ca0561f1e,0x27a1a77f275da73a,0x2810a80127e3a7c2
.quad 0x2882a8ff28ffa882,0x9e559e552498a728,0xa534277fa8932901,0x2607a2d117f220eb,0x925ca11c251ea74b,0xa88d2790a57521e0,0x258aa271198f1f82,0x290fa8ee287ca77f,0xa89827f2a644243d,0xa86a28dfa90e28f6,0x2905a90a28d4a864,0x258aa73a284aa8c4,0xa7d32876a8d72909,0x9bef21e0a4c5266b,0x2271a4dc2658a7a1,0xa390202594c59df0
.quad 0x20b99a5a9a5a20b9,0x27b2a692254aa3bf,0xa73a2630a5082390,0xa8ee28bba8702810,0x28f1a8c8288da843,0x28e5a903290fa909,0xa8c428e8a901290e,0xa77f2810a8572893,0x2644a6de276ea7f2,0x2301a43d24f2a59f,0x9c5d1eb9a08821af,0x1d27998f0e5c17f2,0xa46b240ea36022a1,0xa5c92575a51e24c5,0x284aa83c282ea81f,0x287ca8702864a857
.quad 0xa8ff2882a7282498,0xa4982728a88228ff,0x28e8a90e28c4a810,0x1df0a45426cca857,0xa80928b6a90928fb,0x1f1e1befa360261c,0x2508a7162857a8db,0xa4dc20eb0e5ca14d,0x9cc22301a59f276e,0x276ea59f23019cc2,0xa1af198f1df0a331,0xa89e2810a6a624dc,0x266ba4c521e09bef,0x2909a8d72876a7d3,0xa87c2801a6cc255f,0xa8ee290ea90528d4
.quad 0x290ba8eb28ada850,0x2850a8ad28eba90b,0xa8cc28f9a90e290a,0xa67f277fa82e2888,0x2790a8272876a8b6,0x2360a4c525c9a6b9,0xa4542534a60726cc,0x97f21df0a0eb22d1,0x165b9cc21fe6a17e,0xa17e1fe69cc2165b,0x2331a21120eb9f82,0x25b4a53424afa425,0xa70326b9a66b261c,0xa80927d3a790274b,0x28a8a89e2893a888,0x28cca8c428bba8b1
.quad 0x2728a4981e551e55,0x2882a8ff28ffa882,0xa85726cca4541df0,0xa81028c4a90e28e8,0x28d7a84326b9a46b,0x2703a85d28e5a90f,0xa90e28d4a84a26f1,0xa5b427a1a88828f4,0x28f6a90e28dfa86a,0x243da64427f2a898,0xa89328eea90f28f4,0xa14d24afa67f2801,0x27d3a87628d7a909,0x1befa1e024c5a66b,0xa607275da83c28a8,0x198f1c5da1af2481
.quad 0x23bfa54a2692a7b2,0xa0b91a5a1a5aa0b9,0x9df021afa425255f,0x23eea14d1d270e5c,0x9bef925c1d8ca11c,0xa575246ba2a12056,0x22d1a0eb1df097f2,0x26cca6072534a454,0xa59f24f2a43d2301,0xa7f2276ea6de2644,0x277fa71626a6a630,0x2870a84a281fa7e3,0xa876285da8432827,0xa8c828b6a8a3288d,0x28e8a8e228dba8d4,0x28fda8f928f4a8ee
.quad 0x9e559e552498a728,0xa8ff2882a7282498,0x20eb17f2a2d12607,0x2901a893277fa534,0xa2a118c42056a4c5,0xa90328a3a7d325c9,0x24259eb99b2522d1,0x2905a8b12810a658,0xa4f2217e965b9fe6,0xa90628bfa83526de,0x25b4a3901eb917f2,0x2908a8cc2857a75d,0xa66b24c5a1e01bef,0xa90928d7a87627d3,0x2716a5b42425a0eb,0x290aa8e22893a81f
.quad 0xa7b22692a54a23bf,0xa90b28eba8ad2850,0x281fa75d2658a534,0x290ca8f428c4a87c,0xa85d2809a74b266b,0xa90d28fba8d728a3,0x2893a8572810a77f,0x290ea90128e8a8c4,0xa8bf2898a86a2835,0xa90e2906a8f628df,0x28e2a8cc28b1a893,0x290fa90a2901a8f4,0xa8fb28f1a8e528d7,0xa90f290da9092903,0x290aa9082905a901,0x290fa90f290ea90c
.quad 0xa90f290fa90f290f,0xa90f290fa90f290f
.zero 240
.quad 0xa90f290fa90f290f,0xa90f290fa90f290f
.zero 240
.quad 0xa90f290fa90f290f,0xa90f290fa90f290f
.zero 240
.quad 0xa90f290fa90f290f,0xa90f290fa90f290f
.zero 240
.quad 0xa90f290fa90f290f,0xa90f290fa90f290f
.zero 240
.quad 0xa90f290fa90f290f,0xa90f290fa90f290f
.zero 240
.quad 0xa90f290fa90f290f,0xa90f290fa90f290f
.zero 240
.quad 0xa90f290fa90f290f,0xa90f290fa90f290f
.zero 240
.quad 0xa90f290fa90f290f,0xa90f290fa90f290f
.zero 240
.quad 0xa90f290fa90f290f,0xa90f290fa90f290f
.zero 240
.quad 0xa90f290fa90f290f,0xa90f290fa90f290f
.zero 240
.quad 0xa90f290fa90f290f,0xa90f290fa90f290f
.zero 240
.quad 0xa90f290fa90f290f,0xa90f290fa90f290f
.zero 240
.quad 0xa90f290fa90f290f,0xa90f290fa90f290f
.zero 240
.quad 0xa90f290fa90f290f,0xa90f290fa90f290f
.zero 240
.quad 0xa90f290fa90f290f,0xa90f290fa90f290f
.zero 240
.quad 0xa90f290fa90f290f,0xa90f290fa90f290f
.zero 240
.quad 0xa90f290fa90f290f,0xa90f290fa90f290f
.zero 240
.quad 0xa90f290fa90f290f,0xa90f290fa90f290f
.zero 240
.quad 0xa90f290fa90f290f,0xa90f290fa90f290f
.zero 240
.quad 0x290f
.zero 1016
.quad 0x8000000080000000,0x8000000080000000
.zero 240
.quad 0x8000000080000000,0x8000000080000000
.zero 240
.quad 0x8000000080000000,0x8000000080000000
.zero 240
.quad 0x8000000080000000,0x8000000080000000
.zero 240
.quad 0x8000000080000000,0x8000000080000000
.zero 240
.quad 0x8000000080000000,0x8000000080000000
.zero 240
.quad 0x8000000080000000,0x8000000080000000
.zero 240
.quad 0x8000000080000000,0x8000000080000000
.zero 240
.quad 0x8000000080000000,0x8000000080000000
.zero 240
.quad 0x8000000080000000,0x8000000080000000
.zero 240
.quad 0x8000000080000000,0x8000000080000000
.zero 240
.quad 0x8000000080000000,0x8000000080000000
.zero 240
.quad 0x8000000080000000,0x8000000080000000
.zero 240
.quad 0x8000000080000000,0x8000000080000000
.zero 240
.quad 0x8000000080000000,0x8000000080000000
.zero 240
.quad 0x8000000080000000,0x8000000080000000
.zero 240
.quad 0x8000000080000000,0x8000000080000000
.zero 240
.quad 0x8000000080000000,0x8000000080000000
.zero 240
.quad 0x8000000080000000,0x8000000080000000
.zero 240
.quad 0x8000000080000000,0x8000000080000000
.zero 5360
.quad 0xa90f290fa90f290f,0xa90f290fa90f290f
.zero 240
.quad 0xa90f290fa90f290f,0xa90f290fa90f290f
.zero 240
.quad 0xa90f290fa90f290f,0xa90f290fa90f290f
.zero 240
.quad 0xa90f290fa90f290f,0xa90f290fa90f290f
.zero 240
.quad 0xa90f290fa90f290f,0xa90f290fa90f290f
.zero 240
.quad 0xa90f290fa90f290f,0xa90f290fa90f290f
.zero 240
.quad 0xa90f290fa90f290f,0xa90f290fa90f290f
.zero 240
.quad 0xa90f290fa90f290f,0xa90f290fa90f290f
.zero 240
.quad 0xa90f290fa90f290f,0xa90f290fa90f290f
.zero 240
.quad 0xa90f290fa90f290f,0xa90f290fa90f290f
.zero 240
.quad 0xa90f290fa90f290f,0xa90f290fa90f290f
.zero 240
.quad 0xa90f290fa90f290f,0xa90f290fa90f290f
.zero 240
.quad 0xa90f290fa90f290f,0xa90f290fa90f290f
.zero 240
.quad 0xa90f290fa90f290f,0xa90f290fa90f290f
.zero 240
.quad 0xa90f290fa90f290f,0xa90f290fa90f290f
.zero 240
.quad 0xa90f290fa90f290f,0xa90f290fa90f290f
.zero 240
.quad 0xa90f290fa90f290f,0xa90f290fa90f290f
.zero 240
.quad 0xa90f290fa90f290f,0xa90f290fa90f290f
.zero 240
.quad 0xa90f290fa90f290f,0xa90f290fa90f290f
.zero 240
.quad 0xa90f290fa90f290f,0xa90f290fa90f290f
.zero 240
.p2align 8
k3tab:
.quad 0x3c003c003c003c00,0x8000800080008000,0x38b43a793b9c3c00,0xba79b8b4b4f28000,0xb4f234f23a793c00,0xbb9cbb9cb8b48000,0xbb9cb4f238b43c00,0xb4f2bb9cba798000,0xba79ba7934f23c00,0x38b4b8b4bb9c8000,0x8000bc0000003c00,0x3c008000bc008000,0x3a79ba79b4f23c00,0x38b438b4bb9c8000,0x3b9cb4f2b8b43c00,0xb4f23b9cba798000
.quad 0x34f234f2ba793c00,0xbb9c3b9cb8b48000,0xb8b43a79bb9c3c00,0xba7938b4b4f28000,0xbc003c00bc003c00,0x8000800080008000,0xb8b43a79bb9c3c00,0x3a79b8b434f28000,0x34f234f2ba793c00,0x3b9cbb9c38b48000,0x3b9cb4f2b8b43c00,0x34f2bb9c3a798000,0x3a79ba79b4f23c00,0xb8b4b8b43b9c8000,0xbc0080003c00,0xbc0080003c008000
.quad 0x3c003c003c003c00,0x8000800080008000,0xb8b4b4f2000034f2,0xba79bb9cbc00bb9c,0xb4f2ba79bc00ba79,0x3b9c38b48000b8b4,0x3b9c3a798000ba79,0xb4f238b43c0038b4,0xba7934f23c0034f2,0xb8b4bb9c80003b9c,0x8000bc0000003c00,0x3c008000bc008000,0x3a7934f2bc0034f2,0xb8b43b9c8000bb9c,0xbb9c3a798000ba79,0xb4f2b8b43c00b8b4
.quad 0x34f2ba793c00ba79,0x3b9cb8b4800038b4,0x38b4b4f2000034f2,0xba793b9cbc003b9c,0xbc003c00bc003c00,0x8000800080008000,0x38b4b4f2800034f2,0x3a79bb9c3c00bb9c,0x34f2ba793c00ba79,0xbb9c38b48000b8b4,0xbb9c3a790000ba79,0x34f238b4bc0038b4,0x3a7934f2bc0034f2,0x38b4bb9c80003b9c,0xbc0080003c00,0xbc0080003c008000
.quad 0x3c003c003c00,0x800080008000,0xbc00bb9cba79,0x8000b4f2b8b4,0x3c003a7934f2,0x800038b43b9c,0xbc00b8b434f2,0x8000ba79bb9c,0x3c0034f2ba79,0x80003b9c38b4,0xbc0000003c00,0x8000bc008000,0x3c00b4f2ba79,0x80003b9cb8b4,0xbc0038b434f2,0x8000ba793b9c
.quad 0x3c00ba7934f2,0x800038b4bb9c,0xbc003b9cba79,0x8000b4f238b4,0x3c00bc003c00,0x800080008000,0xbc003b9cba79,0x800034f2b8b4,0x3c00ba7934f2,0x8000b8b43b9c,0xbc0038b434f2,0x80003a79bb9c,0x3c00b4f2ba79,0x8000bb9c38b4,0xbc0080003c00,0x80003c008000
.zero 264
.quad 0x3c003c003c003c00,0x3a7938b434f20000,0x38b43a793b9c3c00,0x3b9c3b9c38b40000,0xb4f234f23a793c00,0x34f23b9c3a790000,0xbb9cb4f238b43c00,0xb8b438b43b9c0000,0xba79ba7934f23c00,0xbc0000003c000000,0x8000bc0000003c00,0xb8b4b8b43b9c0000,0x3a79ba79b4f23c00,0x34f2bb9c3a790000,0x3b9cb4f2b8b43c00,0x3b9cbb9c38b40000
.quad 0x34f234f2ba793c00,0x3a79b8b434f20000,0xb8b43a79bb9c3c00,0x0,0xbc003c00bc003c00,0xba7938b4b4f20000,0xb8b43a79bb9c3c00,0xbb9c3b9cb8b40000,0x34f234f2ba793c00,0xb4f23b9cba790000,0x3b9cb4f2b8b43c00,0x38b438b4bb9c0000,0x3a79ba79b4f23c00,0x3c000000bc000000,0xbc0080003c00,0x0
.quad 0x3c003c003c003c00,0x3a793b9c3c003b9c,0xb8b4b4f2000034f2,0xbb9cb8b4000038b4,0xb4f2ba79bc00ba79,0x34f2b8b4bc00b8b4,0x3b9c3a798000ba79,0x38b43b9c0000bb9c,0xba7934f23c0034f2,0xbc0000003c000000,0x8000bc0000003c00,0x38b4bb9c00003b9c,0x3a7934f2bc0034f2,0x34f238b4bc0038b4,0xbb9c3a798000ba79,0xbb9c38b40000b8b4
.quad 0x34f2ba793c00ba79,0x3a79bb9c3c00bb9c,0x38b4b4f2000034f2,0x0,0xbc003c00bc003c00,0xba793b9cbc003b9c,0x38b4b4f2800034f2,0x3b9cb8b4000038b4,0x34f2ba793c00ba79,0xb4f2b8b43c00b8b4,0xbb9c3a790000ba79,0xb8b43b9c0000bb9c,0x3a7934f2bc0034f2,0x3c000000bc000000,0xbc0080003c00,0x0
.quad 0x3c003c003c00,0x34f238b4,0xbc00bb9cba79,0xb8b4bb9c,0x3c003a7934f2,0x3a793b9c,0xbc00b8b434f2,0xbb9cb8b4,0x3c0034f2ba79,0x3c000000,0xbc0000003c00,0xbb9c38b4,0x3c00b4f2ba79,0x3a79bb9c,0xbc0038b434f2,0xb8b43b9c
.quad 0x3c00ba7934f2,0x34f2b8b4,0xbc003b9cba79,0x0,0x3c00bc003c00,0xb4f238b4,0xbc003b9cba79,0x38b4bb9c,0x3c00ba7934f2,0xba793b9c,0xbc0038b434f2,0x3b9cb8b4,0x3c00b4f2ba79,0xbc000000,0xbc0080003c00
.zero 256
.quad 0xba79ba7934f23c00,0xb8b438b43b9c8000,0xbb9cb4f238b43c00,0x34f23b9c3a798000,0xb4f234f23a793c00,0x3b9c3b9c38b48000,0x38b43a793b9c3c00,0x3a7938b434f28000
.zero 192
.quad 0xba7934f23c0034f2,0x38b43b9c8000bb9c,0x3b9c3a790000ba79,0x34f2b8b4bc00b8b4,0xb4f2ba79bc00ba79,0xbb9cb8b4800038b4,0xb8b4b4f2800034f2,0x3a793b9c3c003b9c
.zero 192
.quad 0x3c0034f2ba79,0x8000bb9cb8b4,0xbc00b8b434f2,0x80003a793b9c,0x3c003a7934f2,0x8000b8b4bb9c,0xbc00bb9cba79,0x800034f238b4
.zero 448
.quad 0x38b4b8b4bb9c0000,0xba79ba7934f23c00,0xb4f2bb9cba790000,0xbb9cb4f238b43c00,0xbb9cbb9cb8b40000,0xb4f234f23a793c00,0xba79b8b4b4f20000,0x38b43a793b9c3c00
.zero 192
.quad 0xb8b4bb9c00003b9c,0xba7934f23c0034f2,0xb4f238b43c0038b4,0x3b9c3a790000ba79,0x3b9c38b40000b8b4,0xb4f2ba79bc00ba79,0xba79bb9cbc00bb9c,0xb8b4b4f2800034f2
.zero 192
.quad 0x3b9c38b4,0x3c0034f2ba79,0xba79bb9c,0xbc00b8b434f2,0x38b43b9c,0x3c003a7934f2,0xb4f2b8b4,0xbc00bb9cba79
.zero 448
.quad 0x8000290f8000290f,0x8000290f8000290f,0x9fe628f68000290f,0xa59f2835a3bf28ad,0xa3bf28ad8000290f,0xa8ad23bfa7282728,0xa59f28358000290f,0xa8f69fe6a8ad23bf,0xa72827288000290f,0xa728a728a90f0000,0xa835259f8000290f,0x9fe6a8f6a8ada3bf,0xa8ad23bf8000290f,0x23bfa8ada728a728,0xa8f61fe68000290f,0x2835a59fa3bfa8ad
.quad 0xa90f00008000290f,0x290f80008000a90f,0xa8f69fe68000290f,0x2835259f23bfa8ad,0xa8ada3bf8000290f,0x23bf28ad2728a728,0xa835a59f8000290f,0x9fe628f628ada3bf,0xa728a7288000290f,0xa7282728290f8000,0xa59fa8358000290f,0xa8f61fe628ad23bf,0xa3bfa8ad8000290f,0xa8ada3bf27282728,0x9fe6a8f68000290f,0xa59fa83523bf28ad
.quad 0x8000290f8000290f,0x8000290f8000290f,0xa835259fa7282728,0xa8f61fe6a8ad23bf,0xa8ada3bfa90f0000,0xa3bfa8ada728a728,0x9fe6a8f6a728a728,0x2835a59f23bfa8ad,0x2728a7288000a90f,0x27282728290f8000,0x28f61fe62728a728,0xa59f283523bf28ad,0x23bf28ad290f8000,0xa8ada3bfa7282728,0xa59f283527282728,0x1fe6a8f6a8ada3bf
.quad 0xa90f00008000290f,0x290f80008000a90f,0xa59fa835a7282728,0x1fe628f628ada3bf,0x23bfa8ada90f0000,0xa8ad23bf27282728,0x28f69fe6a728a728,0xa59fa835a3bf28ad,0x272827288000a90f,0x2728a728a90f0000,0x9fe628f62728a728,0x2835259fa3bfa8ad,0xa8ad23bf290f8000,0xa3bf28ad2728a728,0xa835a59f27282728,0xa8f69fe628ad23bf
.quad 0x8000290f8000290f,0x8000290f8000290f,0xa8f69fe6a90f0000,0xa835a59fa8ada3bf,0x23bfa8ad8000a90f,0x28ada3bf2728a728,0x2835259f290f8000,0x9fe628f623bf28ad,0xa72827288000290f,0xa728a728a90f0000,0xa59fa835a90f0000,0x28f69fe623bfa8ad,0x28ada3bf8000a90f,0xa3bf28ad27282728,0x1fe628f6290f8000,0xa59fa835a8ad23bf
.quad 0xa90f00008000290f,0x290f80008000a90f,0x1fe6a8f6a90f0000,0xa59f283528ad23bf,0x28ad23bf8000a90f,0xa3bfa8ada7282728,0xa59f2835290f8000,0x28f61fe6a3bfa8ad,0xa728a7288000290f,0xa7282728290f8000,0x2835a59fa90f0000,0x9fe6a8f6a3bf28ad,0x23bf28ad8000a90f,0x28ad23bfa728a728,0xa8f61fe6290f8000,0xa835259f28ada3bf
.quad 0x8000290f8000290f,0x8000290f8000290f,0xa59fa835a728a728,0x9fe6a8f6a3bfa8ad,0x28ad23bf290f8000,0x23bf28ad27282728,0xa8f61fe6a7282728,0xa59fa835a8ada3bf,0x2728a7288000a90f,0x27282728290f8000,0x9fe628f627282728,0xa835a59fa8ad23bf,0xa3bfa8ada90f0000,0x28ad23bf2728a728,0x2835259f2728a728,0xa8f69fe6a3bf28ad
.quad 0xa90f00008000290f,0x290f80008000a90f,0x2835a59fa728a728,0xa8f61fe623bf28ad,0xa3bf28ad290f8000,0x28ada3bfa728a728,0x9fe6a8f6a7282728,0xa835259f28ad23bf,0x272827288000a90f,0x2728a728a90f0000,0xa8f69fe627282728,0xa59f283528ada3bf,0x28ada3bfa90f0000,0x23bfa8ada7282728,0xa59f28352728a728,0x9fe628f623bfa8ad
.quad 0x8000290f8000290f,0x8000290f8000290f,0x1fe6a8f68000a90f,0x259fa83523bfa8ad,0xa3bf28ad8000290f,0xa8ad23bfa7282728,0x259fa8358000a90f,0x28f61fe628ada3bf,0xa72827288000290f,0xa728a728a90f0000,0x2835a59f8000a90f,0x1fe628f628ad23bf,0xa8ad23bf8000290f,0x23bfa8ada728a728,0x28f69fe68000a90f,0xa835259f23bf28ad
.quad 0xa90f00008000290f,0x290f80008000a90f,0x28f61fe68000a90f,0xa835a59fa3bf28ad,0xa8ada3bf8000290f,0x23bf28ad2728a728,0x2835259f8000a90f,0x1fe6a8f6a8ad23bf,0xa728a7288000290f,0xa7282728290f8000,0x259f28358000a90f,0x28f69fe6a8ada3bf,0xa3bfa8ad8000290f,0xa8ada3bf27282728,0x1fe628f68000a90f,0x259f2835a3bfa8ad
.quad 0x8000290f8000290f,0x8000290f8000290f,0x2835a59f2728a728,0x28f69fe628ada3bf,0xa8ada3bfa90f0000,0xa3bfa8ada728a728,0x1fe628f627282728,0xa835259fa3bf28ad,0x2728a7288000a90f,0x27282728290f8000,0xa8f69fe6a7282728,0x259fa835a3bfa8ad,0x23bf28ad290f8000,0xa8ada3bfa7282728,0x259fa835a728a728,0x9fe628f628ad23bf
.quad 0xa90f00008000290f,0x290f80008000a90f,0x259f28352728a728,0x9fe6a8f6a8ad23bf,0x23bfa8ada90f0000,0xa8ad23bf27282728,0xa8f61fe627282728,0x259f283523bfa8ad,0x272827288000a90f,0x2728a728a90f0000,0x1fe6a8f6a7282728,0xa835a59f23bf28ad,0xa8ad23bf290f8000,0xa3bf28ad2728a728,0x2835259fa728a728,0x28f61fe6a8ada3bf
.quad 0x8000290f8000290f,0x8000290f8000290f,0x28f61fe6290f8000,0x2835259f28ad23bf,0x23bfa8ad8000a90f,0x28ada3bf2728a728,0xa835a59fa90f0000,0x1fe6a8f6a3bfa8ad,0xa72827288000290f,0xa728a728a90f0000,0x259f2835290f8000,0xa8f61fe6a3bf28ad,0x28ada3bf8000a90f,0xa3bf28ad27282728,0x9fe6a8f6a90f0000,0x259f283528ada3bf
.quad 0xa90f00008000290f,0x290f80008000a90f,0x9fe628f6290f8000,0x259fa835a8ada3bf,0x28ad23bf8000a90f,0xa3bfa8ada7282728,0x259fa835a90f0000,0xa8f69fe623bf28ad,0xa728a7288000290f,0xa7282728290f8000,0xa835259f290f8000,0x1fe628f623bfa8ad,0x23bf28ad8000a90f,0x28ad23bfa728a728,0x28f69fe6a90f0000,0x2835a59fa8ad23bf
.quad 0x8000290f8000290f,0x8000290f8000290f,0x259f283527282728,0x1fe628f623bf28ad,0x28ad23bf290f8000,0x23bf28ad27282728,0x28f69fe62728a728,0x259f283528ad23bf,0x2728a7288000a90f,0x27282728290f8000,0x1fe6a8f6a728a728,0x2835259f28ada3bf,0xa3bfa8ada90f0000,0x28ad23bf2728a728,0xa835a59fa7282728,0x28f61fe623bfa8ad
.quad 0xa90f00008000290f,0x290f80008000a90f,0xa835259f27282728,0x28f69fe6a3bfa8ad,0xa3bf28ad290f8000,0x28ada3bfa728a728,0x1fe628f62728a728,0x2835a59fa8ada3bf,0x272827288000a90f,0x2728a728a90f0000,0x28f61fe6a728a728,0x259fa835a8ad23bf,0x28ada3bfa90f0000,0x23bfa8ada7282728,0x259fa835a7282728,0x1fe6a8f6a3bf28ad
.quad 0x8000a90f8000290f,0x8000a90f8000290f,0x1fe6a8f68000290f,0x259fa835a3bf28ad,0x23bfa8ad8000290f,0x28ada3bfa7282728,0x259fa8358000290f,0x28f61fe6a8ad23bf,0x2728a7288000290f,0x27282728a90f0000,0x2835a59f8000290f,0x1fe628f6a8ada3bf,0x28ada3bf8000290f,0xa3bf28ada728a728,0x28f69fe68000290f,0xa835259fa3bfa8ad
.quad 0x290f80008000290f,0xa90f00008000a90f,0x28f61fe68000290f,0xa835a59f23bfa8ad,0x28ad23bf8000290f,0xa3bfa8ad2728a728,0x2835259f8000290f,0x1fe6a8f628ada3bf,0x272827288000290f,0x2728a728290f8000,0x259f28358000290f,0x28f69fe628ad23bf,0x23bf28ad8000290f,0x28ad23bf27282728,0x1fe628f68000290f,0x259f283523bf28ad
.quad 0x8000a90f8000290f,0x8000a90f8000290f,0x2835a59fa7282728,0x28f69fe6a8ad23bf,0x28ad23bfa90f0000,0x23bf28ada728a728,0x1fe628f6a728a728,0xa835259f23bfa8ad,0xa72827288000a90f,0xa728a728290f8000,0xa8f69fe62728a728,0x259fa83523bf28ad,0xa3bfa8ad290f8000,0x28ad23bfa7282728,0x259fa83527282728,0x9fe628f6a8ada3bf
.quad 0x290f80008000290f,0xa90f00008000a90f,0x259f2835a7282728,0x9fe6a8f628ada3bf,0xa3bf28ada90f0000,0x28ada3bf27282728,0xa8f61fe6a728a728,0x259f2835a3bf28ad,0xa728a7288000a90f,0xa7282728a90f0000,0x1fe6a8f62728a728,0xa835a59fa3bfa8ad,0x28ada3bf290f8000,0x23bfa8ad2728a728,0x2835259f27282728,0x28f61fe628ad23bf
.quad 0x8000a90f8000290f,0x8000a90f8000290f,0x28f61fe6a90f0000,0x2835259fa8ada3bf,0xa3bf28ad8000a90f,0xa8ad23bf2728a728,0xa835a59f290f8000,0x1fe6a8f623bf28ad,0x2728a7288000290f,0x27282728a90f0000,0x259f2835a90f0000,0xa8f61fe623bfa8ad,0xa8ad23bf8000a90f,0x23bfa8ad27282728,0x9fe6a8f6290f8000,0x259f2835a8ad23bf
.quad 0x290f80008000290f,0xa90f00008000a90f,0x9fe628f6a90f0000,0x259fa83528ad23bf,0xa8ada3bf8000a90f,0x23bf28ada7282728,0x259fa835290f8000,0xa8f69fe6a3bfa8ad,0x272827288000290f,0x2728a728290f8000,0xa835259fa90f0000,0x1fe628f6a3bf28ad,0xa3bfa8ad8000a90f,0xa8ada3bfa728a728,0x28f69fe6290f8000,0x2835a59f28ada3bf
.quad 0x8000a90f8000290f,0x8000a90f8000290f,0x259f2835a728a728,0x1fe628f6a3bfa8ad,0xa8ada3bf290f8000,0xa3bfa8ad27282728,0x28f69fe6a7282728,0x259f2835a8ada3bf,0xa72827288000a90f,0xa728a728290f8000,0x1fe6a8f627282728,0x2835259fa8ad23bf,0x23bf28ada90f0000,0xa8ada3bf2728a728,0xa835a59f2728a728,0x28f61fe6a3bf28ad
.quad 0x290f80008000290f,0xa90f00008000a90f,0xa835259fa728a728,0x28f69fe623bf28ad,0x23bfa8ad290f8000,0xa8ad23bfa728a728,0x1fe628f6a7282728,0x2835a59f28ad23bf,0xa728a7288000a90f,0xa7282728a90f0000,0x28f61fe627282728,0x259fa83528ada3bf,0xa8ad23bfa90f0000,0xa3bf28ada7282728,0x259fa8352728a728,0x1fe6a8f623bfa8ad
.quad 0x8000a90f8000290f,0x8000a90f8000290f,0x9fe628f68000a90f,0xa59f283523bfa8ad,0x23bfa8ad8000290f,0x28ada3bfa7282728,0xa59f28358000a90f,0xa8f69fe628ada3bf,0x2728a7288000290f,0x27282728a90f0000,0xa835259f8000a90f,0x9fe6a8f628ad23bf,0x28ada3bf8000290f,0xa3bf28ada728a728,0xa8f61fe68000a90f,0x2835a59f23bf28ad
.quad 0x290f80008000290f,0xa90f00008000a90f,0xa8f69fe68000a90f,0x2835259fa3bf28ad,0x28ad23bf8000290f,0xa3bfa8ad2728a728,0xa835a59f8000a90f,0x9fe628f6a8ad23bf,0x272827288000290f,0x2728a728290f8000,0xa59fa8358000a90f,0xa8f61fe6a8ada3bf,0x23bf28ad8000290f,0x28ad23bf27282728,0x9fe6a8f68000a90f,0xa59fa835a3bfa8ad
.quad 0x8000a90f8000290f,0x8000a90f8000290f,0xa835259f2728a728,0xa8f61fe628ada3bf,0x28ad23bfa90f0000,0x23bf28ada728a728,0x9fe6a8f627282728,0x2835a59fa3bf28ad,0xa72827288000a90f,0xa728a728290f8000,0x28f61fe6a7282728,0xa59f2835a3bfa8ad,0xa3bfa8ad290f8000,0x28ad23bfa7282728,0xa59f2835a728a728,0x1fe6a8f628ad23bf
.quad 0x290f80008000290f,0xa90f00008000a90f,0xa59fa8352728a728,0x1fe628f6a8ad23bf,0xa3bf28ada90f0000,0x28ada3bf27282728,0x28f69fe627282728,0xa59fa83523bfa8ad,0xa728a7288000a90f,0xa7282728a90f0000,0x9fe628f6a7282728,0x2835259f23bf28ad,0x28ada3bf290f8000,0x23bfa8ad2728a728,0xa835a59fa728a728,0xa8f69fe6a8ada3bf
.quad 0x8000a90f8000290f,0x8000a90f8000290f,0xa8f69fe6290f8000,0xa835a59f28ad23bf,0xa3bf28ad8000a90f,0xa8ad23bf2728a728,0x2835259fa90f0000,0x9fe628f6a3bfa8ad,0x2728a7288000290f,0x27282728a90f0000,0xa59fa835290f8000,0x28f69fe6a3bf28ad,0xa8ad23bf8000a90f,0x23bfa8ad27282728,0x1fe628f6a90f0000,0xa59fa83528ada3bf
.quad 0x290f80008000290f,0xa90f00008000a90f,0x1fe6a8f6290f8000,0xa59f2835a8ada3bf,0xa8ada3bf8000a90f,0x23bf28ada7282728,0xa59f2835a90f0000,0x28f61fe623bf28ad,0x272827288000290f,0x2728a728290f8000,0x2835a59f290f8000,0x9fe6a8f623bfa8ad,0xa3bfa8ad8000a90f,0xa8ada3bfa728a728,0xa8f61fe6a90f0000,0xa835259fa8ad23bf
.quad 0x8000a90f8000290f,0x8000a90f8000290f,0xa59fa83527282728,0x9fe6a8f623bf28ad,0xa8ada3bf290f8000,0xa3bfa8ad27282728,0xa8f61fe62728a728,0xa59fa83528ad23bf,0xa72827288000a90f,0xa728a728290f8000,0x9fe628f6a728a728,0xa835a59f28ada3bf,0x23bf28ada90f0000,0xa8ada3bf2728a728,0x2835259fa7282728,0xa8f69fe623bfa8ad
.quad 0x290f80008000290f,0xa90f00008000a90f,0x2835a59f27282728,0xa8f61fe6a3bfa8ad,0x23bfa8ad290f8000,0xa8ad23bfa728a728,0x9fe6a8f62728a728,0xa835259fa8ada3bf,0xa728a7288000a90f,0xa7282728a90f0000,0xa8f69fe6a728a728,0xa59f2835a8ad23bf,0xa8ad23bfa90f0000,0xa3bf28ada7282728,0xa59f2835a7282728,0x9fe628f6a3bf28ad
.quad 0x3f800000,0x3f800000,0x3f800000,0x3c20d8d23f7ffcd7,0x3f800000,0x3ca0d6d63f7ff35e,0x3f800000,0x3cf13d4c3f7fe394,0x3f800000,0x3d20cee73f7fcd79,0x3f800000,0x3d48fb303f7fb10f,0x3f800000,0x3d7122833f7f8e56,0x3f800000,0x3d8ca1f23f7f654e
.quad 0x3f800000,0x3da0af2a3f7f35f9,0x3f800000,0x3db4b86a3f7f0059,0x3f800000,0x3dc8bd363f7ec46d,0x3f800000,0x3ddcbd0d3f7e8238,0x3f800000,0x3df0b7723f7e39bc,0x3f800000,0x3e0255f43f7deafa,0x3f800000,0x3e0c4cf73f7d95f4,0x3f800000,0x3e1640833f7d3aac
.quad 0x3f800000,0x3f800000,0x3d20cee73f7fcd79,0x3d48fb303f7fb10f,0x3da0af2a3f7f35f9,0x3dc8bd363f7ec46d,0x3df0b7723f7e39bc,0x3e1640833f7d3aac,0x3e20305b3f7cd925,0x3e47c5c23f7b14be,0x3e47c5c23f7b14be,0x3e78cfcc3f7853f8,0x3e6f0c4d3f78ed3c,0x3e94a0313f74fa0b,0x3e8afa3e3f766377,0x3eac7cd43f710908
.quad 0x3e9e377a3f737871,0x3ec3ef153f6c835e,0x3eb136413f702d4f,0x3edae8803f676bd8,0x3ec3ef153f6c835e,0x3ef15aea3f61c598,0x3ed65a923f687c12,0x3f039c3d3f5b941a,0x3ee871713f641901,0x3f0e39da3f54db31,0x3efa2c903f5f5be6,0x3f187fc03f4d9f02,0x3f05c2773f5a46a0,0x3f2267993f45e403,0x3f0e39da3f54db31,0x3f2beb4a3f3daef9
.quad 0x3f800000,0x3f800000,0x3da0af2a3f7f35f9,0x3db4b86a3f7f0059,0x3e20305b3f7cd925,0x3e3403f13f7c0361,0x3e6f0c4d3f78ed3c,0x3e8622103f770f11,0x3e9e377a3f737871,0x3eb136413f702d4f,0x3ec3ef153f6c835e,0x3edae8803f676bd8,0x3ee871713f641901,0x3f0172c33f5cdc29,0x3f05c2773f5a46a0,0x3f146eba3f50935b
.quad 0x3f1679183f4f1bbd,0x3f26423a3f42a9f7,0x3f26423a3f42a9f7,0x3f36c9a93f333bc6,0x3f3504f33f3504f3,0x3f45e4033f226799,0x3f42a9f73f26423a,0x3f53731f3f104f0e,0x3f4f1bbd3f167918,0x3f5f5be63efa2c90,0x3f5a46a03f05c277,0x3f6986903ed1c759,0x3f6419013ee87171,0x3f71decf3ea7bf25,0x3f6c835e3ec3ef15,0x3f7853f83e78cfcc
.quad 0x3f800000,0x3f800000,0x3df0b7723f7e39bc,0x3e0255f43f7deafa,0x3e6f0c4d3f78ed3c,0x3e8146933f77b493,0x3eb136413f702d4f,0x3ebf47d73f6d76aa,0x3ee871713f641901,0x3efa2c903f5f5be6,0x3f0e39da3f54db31,0x3f187fc03f4d9f02,0x3f26423a3f42a9f7,0x3f316e2c3f3889dc,0x3f3bfc8f3f2dc5e3,0x3f4779bc3f207440
.quad 0x3f4f1bbd3f167918,0x3f5a46a03f05c277,0x3f5f5be63efa2c90,0x3f6986903ed1c759,0x3f6c835e3ec3ef15,0x3f74fa0b3e94a031,0x3f7663773e8afa3e,0x3f7c71603e2a1c3f,0x3f7cd9253e20305b,0x3f7fcd793d20cee7,0x3f7fcd793d20cee7,0x3f7f0059bdb4b86a,0x3f7f35f9bda0af2a,0x3f7a0d54be5b73dc,0x3f7b14bebe47c5c2,0x3f710908beac7cd4
.quad 0x3f800000,0x3f800000,0x3ca0d6d63f7ff35e,0x3cf13d4c3f7fe394,0x3d20cee73f7fcd79,0x3d7122833f7f8e56,0x3d7122833f7f8e56,0x3db4b86a3f7f0059,0x3da0af2a3f7f35f9,0x3df0b7723f7e39bc,0x3dc8bd363f7ec46d,0x3e1640833f7d3aac,0x3df0b7723f7e39bc,0x3e3403f13f7c0361,0x3e0c4cf73f7d95f4,0x3e519f653f7a9421
.quad 0x3e20305b3f7cd925,0x3e6f0c4d3f78ed3c,0x3e3403f13f7c0361,0x3e8622103f770f11,0x3e47c5c23f7b14be,0x3e94a0313f74fa0b,0x3e5b73dc3f7a0d54,0x3ea2fd523f72ae9e,0x3e6f0c4d3f78ed3c,0x3eb136413f702d4f,0x3e8146933f77b493,0x3ebf47d73f6d76aa,0x3e8afa3e3f766377,0x3ecd2ef33f6a8b4b,0x3e94a0313f74fa0b,0x3edae8803f676bd8
.quad 0x3f800000,0x3f800000,0x3d7122833f7f8e56,0x3d8ca1f23f7f654e,0x3df0b7723f7e39bc,0x3e0c4cf73f7d95f4,0x3e3403f13f7c0361,0x3e519f653f7a9421,0x3e6f0c4d3f78ed3c,0x3e8afa3e3f766377,0x3e94a0313f74fa0b,0x3eac7cd43f710908,0x3eb136413f702d4f,0x3ecd2ef33f6a8b4b,0x3ecd2ef33f6a8b4b,0x3eece91a3f62f219
.quad 0x3ee871713f641901,0x3f05c2773f5a46a0,0x3f0172c33f5cdc29,0x3f146eba3f50935b,0x3f0e39da3f54db31,0x3f2267993f45e403,0x3f1a82a43f4c1d35,0x3f2f9c323f3a4582,0x3f26423a3f42a9f7,0x3f3bfc8f3f2dc5e3,0x3f316e2c3f3889dc,0x3f4779bc3f207440,0x3f3bfc8f3f2dc5e3,0x3f5205d43f1260b2,0x3f45e4033f226799,0x3f5b941a3f039c3d
.quad 0x3f800000,0x3f800000,0x3dc8bd363f7ec46d,0x3ddcbd0d3f7e8238,0x3e47c5c23f7b14be,0x3e5b73dc3f7a0d54,0x3e94a0313f74fa0b,0x3ea2fd523f72ae9e,0x3ec3ef153f6c835e,0x3ed65a923f687c12,0x3ef15aea3f61c598,0x3f039c3d3f5b941a,0x3f0e39da3f54db31,0x3f1a82a43f4c1d35,0x3f2267993f45e403,0x3f2f9c323f3a4582
.quad 0x3f3504f33f3504f3,0x3f42a9f73f26423a,0x3f45e4033f226799,0x3f53731f3f104f0e,0x3f54db313f0e39da,0x3f61c5983ef15aea,0x3f61c5983ef15aea,0x3f6d76aa3ebf47d7,0x3f6c835e3ec3ef15,0x3f7663773e8afa3e,0x3f74fa0b3e94a031,0x3f7c71603e2a1c3f,0x3f7b14be3e47c5c2,0x3f7f8e563d712283,0x3f7ec46d3dc8bd36,0x3f7fb10fbd48fb30
.quad 0x3f800000,0x3f800000,0x3e0c4cf73f7d95f4,0x3e1640833f7d3aac,0x3e8afa3e3f766377,0x3e94a0313f74fa0b,0x3ecd2ef33f6a8b4b,0x3edae8803f676bd8,0x3f05c2773f5a46a0,0x3f0e39da3f54db31,0x3f2267993f45e403,0x3f2beb4a3f3daef9,0x3f3bfc8f3f2dc5e3,0x3f45e4033f226799,0x3f5205d43f1260b2,0x3f5b941a3f039c3d
.quad 0x3f6419013ee87171,0x3f6c835e3ec3ef15,0x3f71decf3ea7bf25,0x3f7853f83e78cfcc,0x3f7b14be3e47c5c2,0x3f7ec46d3dc8bd36,0x3f7f8e563d712283,0x3f7fb10fbd48fb30,0x3f7f35f9bda0af2a,0x3f7b14bebe47c5c2,0x3f7a0d54be5b73dc,0x3f710908beac7cd4,0x3f702d4fbeb13641,0x3f61c598bef15aea,0x3f61c598bef15aea,0x3f4d9f02bf187fc0
.quad 0x3f800000,0x3e20305b3f7cd925,0x3f800000,0x3e2a1c3f3f7c7160,0x3f800000,0x3e3403f13f7c0361,0x3f800000,0x3e3de7313f7b8f2a,0x3f800000,0x3e47c5c23f7b14be,0x3f800000,0x3e519f653f7a9421,0x3f800000,0x3e5b73dc3f7a0d54,0x3f800000,0x3e6542e93f79805c
.quad 0x3f800000,0x3e6f0c4d3f78ed3c,0x3f800000,0x3e78cfcc3f7853f8,0x3f800000,0x3e8146933f77b493,0x3f800000,0x3e8622103f770f11,0x3f800000,0x3e8afa3e3f766377,0x3f800000,0x3e8fcefe3f75b1c9,0x3f800000,0x3e94a0313f74fa0b,0x3f800000,0x3e996dba3f743c41
.quad 0x3f1679183f4f1bbd,0x3f3504f33f3504f3,0x3f1e7cf13f490a88,0x3f3daef93f2beb4a,0x3f26423a3f42a9f7,0x3f45e4033f226799,0x3f2dc5e33f3bfc8f,0x3f4d9f023f187fc0,0x3f3504f33f3504f3,0x3f54db313f0e39da,0x3f3bfc8f3f2dc5e3,0x3f5b941a3f039c3d,0x3f42a9f73f26423a,0x3f61c5983ef15aea,0x3f490a883f1e7cf1,0x3f676bd83edae880
.quad 0x3f4f1bbd3f167918,0x3f6c835e3ec3ef15,0x3f54db313f0e39da,0x3f7109083eac7cd4,0x3f5a46a03f05c277,0x3f74fa0b3e94a031,0x3f5f5be63efa2c90,0x3f7853f83e78cfcc,0x3f6419013ee87171,0x3f7b14be3e47c5c2,0x3f687c123ed65a92,0x3f7d3aac3e164083,0x3f6c835e3ec3ef15,0x3f7ec46d3dc8bd36,0x3f702d4f3eb13641,0x3f7fb10f3d48fb30
.quad 0x3f7378713e9e377a,0x3f7cd9253e20305b,0x3f78ed3c3e6f0c4d,0x3f7f654e3d8ca1f2,0x3f7cd9253e20305b,0x3f7ff35ebca0d6d6,0x3f7f35f93da0af2a,0x3f7e8238bddcbd0d,0x3f80000000000000,0x3f7b14bebe47c5c2,0x3f7f35f9bda0af2a,0x3f75b1c9be8fcefe,0x3f7cd925be20305b,0x3f6e641abeba9be1,0x3f78ed3cbe6f0c4d,0x3f653a48bee3f40d
.quad 0x3f737871be9e377a,0x3f5a46a0bf05c277,0x3f6c835ebec3ef15,0x3f4d9f02bf187fc0,0x3f641901bee87171,0x3f3f5cb5bf2a0c73,0x3f5a46a0bf05c277,0x3f2f9c32bf3a4582,0x3f4f1bbdbf167918,0x3f1e7cf1bf490a88,0x3f42a9f7bf26423a,0x3f0c2124bf563e03,0x3f3504f3bf3504f3,0x3ef15aeabf61c598,0x3f26423abf42a9f7,0x3ec8917ebf6b8a3d
.quad 0x3f737871be9e377a,0x3f641901bee87171,0x3f687c12bed65a92,0x3f53731fbf104f0e,0x3f5a46a0bf05c277,0x3f3f5cb5bf2a0c73,0x3f490a88bf1e7cf1,0x3f28296abf4105b8,0x3f3504f3bf3504f3,0x3f0e39dabf54db31,0x3f1e7cf1bf490a88,0x3ee3f40dbf653a48,0x3f05c277bf5a46a0,0x3ea7bf25bf71decf,0x3ed65a92bf687c12,0x3e519f65bf7a9421
.quad 0x3e9e377abf737871,0x3da0af2abf7f35f9,0x3e47c5c2bf7b14be,0xbd48fb30bf7fb10f,0x3da0af2abf7f35f9,0xbe3403f1bf7c0361,0xbd20cee7bf7fcd79,0xbe996dbabf743c41,0xbe20305bbf7cd925,0xbed65a92bf687c12,0xbe8afa3ebf766377,0xbf07e565bf58f3c4,0xbec3ef15bf6c835e,0xbf226799bf45e403,0xbefa2c90bf5f5be6,0xbf3a4582bf2f9c32
.quad 0x3e9e377a3f737871,0x3ee871713f641901,0x3ea7bf253f71decf,0x3ef5c6c53f609384,0x3eb136413f702d4f,0x3f0172c33f5cdc29,0x3eba9be13f6e641a,0x3f07e5653f58f3c4,0x3ec3ef153f6c835e,0x3f0e39da3f54db31,0x3ecd2ef33f6a8b4b,0x3f146eba3f50935b,0x3ed65a923f687c12,0x3f1a82a43f4c1d35,0x3edf71083f6655e7,0x3f2074403f4779bc
.quad 0x3ee871713f641901,0x3f26423a3f42a9f7,0x3ef15aea3f61c598,0x3f2beb4a3f3daef9,0x3efa2c903f5f5be6,0x3f316e2c3f3889dc,0x3f0172c33f5cdc29,0x3f36c9a93f333bc6,0x3f05c2773f5a46a0,0x3f3bfc8f3f2dc5e3,0x3f0a04f83f579b8c,0x3f4105b83f28296a,0x3f0e39da3f54db31,0x3f45e4033f226799,0x3f1260b23f5205d4,0x3f4a965e3f1c81b9
.quad 0x3f4f1bbd3f167918,0x3f6419013ee87171,0x3f579b8c3f0a04f8,0x3f6b8a3d3ec8917e,0x3f5f5be63efa2c90,0x3f71decf3ea7bf25,0x3f6655e73edf7108,0x3f770f113e862210,0x3f6c835e3ec3ef15,0x3f7b14be3e47c5c2,0x3f71decf3ea7bf25,0x3f7deafa3e0255f4,0x3f7663773e8afa3e,0x3f7f8e563d712283,0x3f7a0d543e5b73dc,0x3f7ffcd7bc20d8d2
.quad 0x3f7cd9253e20305b,0x3f7f35f9bda0af2a,0x3f7ec46d3dc8bd36,0x3f7d3aacbe164083,0x3f7fcd793d20cee7,0x3f7a0d54be5b73dc,0x3f7ff35ebca0d6d6,0x3f75b1c9be8fcefe,0x3f7f35f9bda0af2a,0x3f702d4fbeb13641,0x3f7d95f4be0c4cf7,0x3f698690bed1c759,0x3f7b14bebe47c5c2,0x3f61c598bef15aea,0x3f77b493be814693,0x3f58f3c4bf07e565
.quad 0x3f80000000000000,0x3f7cd925be20305b,0x3f7ec46dbdc8bd36,0x3f770f11be862210,0x3f7b14bebe47c5c2,0x3f6e641abeba9be1,0x3f74fa0bbe94a031,0x3f62f219beece91a,0x3f6c835ebec3ef15,0x3f54db31bf0e39da,0x3f61c598bef15aea,0x3f444969bf2456f1,0x3f54db31bf0e39da,0x3f316e2cbf3889dc,0x3f45e403bf226799,0x3f1c81b9bf4a965e
.quad 0x3f3504f3bf3504f3,0x3f05c277bf5a46a0,0x3f226799bf45e403,0x3edae880bf676bd8,0x3f0e39dabf54db31,0x3ea7bf25bf71decf,0x3ef15aeabf61c598,0x3e6542e9bf79805c,0x3ec3ef15bf6c835e,0x3df0b772bf7e39bc,0x3e94a031bf74fa0b,0x3c20d8d2bf7ffcd7,0x3e47c5c2bf7b14be,0xbdc8bd36bf7ec46d,0x3dc8bd36bf7ec46d,0xbe519f65bf7a9421
.quad 0x3f4f1bbdbf167918,0x3f3504f3bf3504f3,0x3f3889dcbf316e2c,0x3f187fc0bf4d9f02,0x3f1e7cf1bf490a88,0x3ef15aeabf61c598,0x3f0172c3bf5cdc29,0x3eac7cd4bf710908,0x3ec3ef15bf6c835e,0x3e47c5c2bf7b14be,0x3e814693bf77b493,0x3d48fb30bf7fb10f,0x3df0b772bf7e39bc,0xbdc8bd36bf7ec46d,0xbca0d6d6bf7ff35e,0xbe78cfccbf7853f8
.quad 0xbe20305bbf7cd925,0xbec3ef15bf6c835e,0xbe94a031bf74fa0b,0xbf039c3dbf5b941a,0xbed65a92bf687c12,0xbf226799bf45e403,0xbf0a04f8bf579b8c,0xbf3daef9bf2beb4a,0xbf26423abf42a9f7,0xbf54db31bf0e39da,0xbf3f5cb5bf2a0c73,0xbf676bd8bedae880,0xbf54db31bf0e39da,0xbf74fa0bbe94a031,0xbf6655e7bedf7108,0xbf7d3aacbe164083
.quad 0x3f800000,0x3f800000,0x3e20305b3f7cd925,0x3e2a1c3f3f7c7160,0x3e9e377a3f737871,0x3ea7bf253f71decf,0x3ee871713f641901,0x3ef5c6c53f609384,0x3f1679183f4f1bbd,0x3f1e7cf13f490a88,0x3f3504f33f3504f3,0x3f3daef93f2beb4a,0x3f4f1bbd3f167918,0x3f579b8c3f0a04f8,0x3f6419013ee87171,0x3f6b8a3d3ec8917e
.quad 0x3f7378713e9e377a,0x3f78ed3c3e6f0c4d,0x3f7cd9253e20305b,0x3f7f654e3d8ca1f2,0x3f80000000000000,0x3f7ec46dbdc8bd36,0x3f7cd925be20305b,0x3f770f11be862210,0x3f737871be9e377a,0x3f687c12bed65a92,0x3f641901bee87171,0x3f53731fbf104f0e,0x3f4f1bbdbf167918,0x3f3889dcbf316e2c,0x3f3504f3bf3504f3,0x3f187fc0bf4d9f02
.quad 0x3f800000,0x3f800000,0x3e47c5c23f7b14be,0x3e519f653f7a9421,0x3ec3ef153f6c835e,0x3ecd2ef33f6a8b4b,0x3f0e39da3f54db31,0x3f146eba3f50935b,0x3f3504f33f3504f3,0x3f3bfc8f3f2dc5e3,0x3f54db313f0e39da,0x3f5b941a3f039c3d,0x3f6c835e3ec3ef15,0x3f71decf3ea7bf25,0x3f7b14be3e47c5c2,0x3f7deafa3e0255f4
.quad 0x3f80000000000000,0x3f7f35f9bda0af2a,0x3f7b14bebe47c5c2,0x3f75b1c9be8fcefe,0x3f6c835ebec3ef15,0x3f61c598bef15aea,0x3f54db31bf0e39da,0x3f444969bf2456f1,0x3f3504f3bf3504f3,0x3f1e7cf1bf490a88,0x3f0e39dabf54db31,0x3ee3f40dbf653a48,0x3ec3ef15bf6c835e,0x3e814693bf77b493,0x3e47c5c2bf7b14be,0x3d48fb30bf7fb10f
.quad 0x3f800000,0x3f800000,0x3e6f0c4d3f78ed3c,0x3e78cfcc3f7853f8,0x3ee871713f641901,0x3ef15aea3f61c598,0x3f26423a3f42a9f7,0x3f2beb4a3f3daef9,0x3f4f1bbd3f167918,0x3f54db313f0e39da,0x3f6c835e3ec3ef15,0x3f7109083eac7cd4,0x3f7cd9253e20305b,0x3f7ec46d3dc8bd36,0x3f7f35f9bda0af2a,0x3f7d3aacbe164083
.quad 0x3f737871be9e377a,0x3f6c835ebec3ef15,0x3f5a46a0bf05c277,0x3f4d9f02bf187fc0,0x3f3504f3bf3504f3,0x3f226799bf45e403,0x3f05c277bf5a46a0,0x3edae880bf676bd8,0x3e9e377abf737871,0x3e47c5c2bf7b14be,0x3da0af2abf7f35f9,0xbd48fb30bf7fb10f,0xbe20305bbf7cd925,0xbe94a031bf74fa0b,0xbec3ef15bf6c835e,0xbf039c3dbf5b941a
.quad 0x3f800000,0x3f800000,0x3e8afa3e3f766377,0x3e8fcefe3f75b1c9,0x3f05c2773f5a46a0,0x3f0a04f83f579b8c,0x3f3bfc8f3f2dc5e3,0x3f4105b83f28296a,0x3f6419013ee87171,0x3f687c123ed65a92,0x3f7b14be3e47c5c2,0x3f7d3aac3e164083,0x3f7f35f9bda0af2a,0x3f7d95f4be0c4cf7,0x3f702d4fbeb13641,0x3f698690bed1c759
.quad 0x3f4f1bbdbf167918,0x3f42a9f7bf26423a,0x3f1e7cf1bf490a88,0x3f0c2124bf563e03,0x3ec3ef15bf6c835e,0x3e94a031bf74fa0b,0x3df0b772bf7e39bc,0x3c20d8d2bf7ffcd7,0xbe20305bbf7cd925,0xbe8afa3ebf766377,0xbed65a92bf687c12,0xbf07e565bf58f3c4,0xbf26423abf42a9f7,0xbf3f5cb5bf2a0c73,0xbf54db31bf0e39da,0xbf676bd8bedae880
.quad 0x3f800000,0x3f800000,0x3e3403f13f7c0361,0x3e3de7313f7b8f2a,0x3eb136413f702d4f,0x3eba9be13f6e641a,0x3f0172c33f5cdc29,0x3f07e5653f58f3c4,0x3f26423a3f42a9f7,0x3f2dc5e33f3bfc8f,0x3f45e4033f226799,0x3f4d9f023f187fc0,0x3f5f5be63efa2c90,0x3f6655e73edf7108,0x3f71decf3ea7bf25,0x3f770f113e862210
.quad 0x3f7cd9253e20305b,0x3f7f35f93da0af2a,0x3f7ff35ebca0d6d6,0x3f7e8238bddcbd0d,0x3f7b14bebe47c5c2,0x3f74fa0bbe94a031,0x3f6e641abeba9be1,0x3f62f219beece91a,0x3f5a46a0bf05c277,0x3f490a88bf1e7cf1,0x3f3f5cb5bf2a0c73,0x3f28296abf4105b8,0x3f1e7cf1bf490a88,0x3f0172c3bf5cdc29,0x3ef15aeabf61c598,0x3eac7cd4bf710908
.quad 0x3f800000,0x3f800000,0x3e5b73dc3f7a0d54,0x3e6542e93f79805c,0x3ed65a923f687c12,0x3edf71083f6655e7,0x3f1a82a43f4c1d35,0x3f2074403f4779bc,0x3f42a9f73f26423a,0x3f490a883f1e7cf1,0x3f61c5983ef15aea,0x3f676bd83edae880,0x3f7663773e8afa3e,0x3f7a0d543e5b73dc,0x3f7f8e563d712283,0x3f7ffcd7bc20d8d2
.quad 0x3f7cd925be20305b,0x3f78ed3cbe6f0c4d,0x3f6e641abeba9be1,0x3f653a48bee3f40d,0x3f54db31bf0e39da,0x3f45e403bf226799,0x3f316e2cbf3889dc,0x3f1c81b9bf4a965e,0x3f05c277bf5a46a0,0x3ed65a92bf687c12,0x3ea7bf25bf71decf,0x3e519f65bf7a9421,0x3df0b772bf7e39bc,0xbca0d6d6bf7ff35e,0xbdc8bd36bf7ec46d,0xbe78cfccbf7853f8
.quad 0x3f800000,0x3f800000,0x3e8146933f77b493,0x3e8622103f770f11,0x3efa2c903f5f5be6,0x3f0172c33f5cdc29,0x3f316e2c3f3889dc,0x3f36c9a93f333bc6,0x3f5a46a03f05c277,0x3f5f5be63efa2c90,0x3f74fa0b3e94a031,0x3f7853f83e78cfcc,0x3f7fcd793d20cee7,0x3f7ff35ebca0d6d6,0x3f7a0d54be5b73dc,0x3f75b1c9be8fcefe
.quad 0x3f641901bee87171,0x3f5a46a0bf05c277,0x3f3f5cb5bf2a0c73,0x3f2f9c32bf3a4582,0x3f0e39dabf54db31,0x3ef15aeabf61c598,0x3ea7bf25bf71decf,0x3e6542e9bf79805c,0x3da0af2abf7f35f9,0xbd20cee7bf7fcd79,0xbe3403f1bf7c0361,0xbe996dbabf743c41,0xbed65a92bf687c12,0xbf0a04f8bf579b8c,0xbf226799bf45e403,0xbf3daef9bf2beb4a
.quad 0x3f800000,0x3f800000,0x3e94a0313f74fa0b,0x3e996dba3f743c41,0x3f0e39da3f54db31,0x3f1260b23f5205d4,0x3f45e4033f226799,0x3f4a965e3f1c81b9,0x3f6c835e3ec3ef15,0x3f702d4f3eb13641,0x3f7ec46d3dc8bd36,0x3f7fb10f3d48fb30,0x3f7b14bebe47c5c2,0x3f77b493be814693,0x3f61c598bef15aea,0x3f58f3c4bf07e565
.quad 0x3f3504f3bf3504f3,0x3f26423abf42a9f7,0x3ef15aeabf61c598,0x3ec8917ebf6b8a3d,0x3e47c5c2bf7b14be,0x3dc8bd36bf7ec46d,0xbdc8bd36bf7ec46d,0xbe519f65bf7a9421,0xbec3ef15bf6c835e,0xbefa2c90bf5f5be6,0xbf226799bf45e403,0xbf3a4582bf2f9c32,0xbf54db31bf0e39da,0xbf6655e7bedf7108,0xbf74fa0bbe94a031,0xbf7d3aacbe164083
.quad 0x3f167918bf4f1bbd,0x3ee87171bf641901,0x3ee87171bf641901,0x3e996dbabf743c41,0x3e9e377abf737871,0x3e0c4cf7bf7d95f4,0x3e20305bbf7cd925,0xbcf13d4cbf7fe394,0xbf800000,0xbe47c5c2bf7b14be,0xbe20305bbf7cd925,0xbeb5eb4fbf6f4ba8,0xbe9e377abf737871,0xbf0172c3bf5cdc29,0xbee87171bf641901,0xbf2456f1bf444969
.quad 0xbf167918bf4f1bbd,0xbf42a9f7bf26423a,0xbf3504f3bf3504f3,0xbf5b941abf039c3d,0xbf4f1bbdbf167918,0xbf6e641abeba9be1,0xbf641901bee87171,0xbf7a9421be519f65,0xbf737871be9e377a,0xbf7fcd79bd20cee7,0xbf7cd925be20305b,0xbf7deafa3e0255f4,0xbf80000080000000,0xbf74fa0b3e94a031,0xbf7cd9253e20305b,0xbf653a483ee3f40d
.quad 0xbf800000,0xbe20305bbf7cd925,0xbe47c5c2bf7b14be,0xbeb5eb4fbf6f4ba8,0xbec3ef15bf6c835e,0xbf0a04f8bf579b8c,0xbf0e39dabf54db31,0xbf333bc6bf36c9a9,0xbf3504f3bf3504f3,0xbf54db31bf0e39da,0xbf54db31bf0e39da,0xbf6d76aabebf47d7,0xbf6c835ebec3ef15,0xbf7c0361be3403f1,0xbf7b14bebe47c5c2,0xbf7fe3943cf13d4c
.quad 0xbf80000080000000,0xbf78ed3c3e6f0c4d,0xbf7b14be3e47c5c2,0xbf676bd83edae880,0xbf6c835e3ec3ef15,0xbf4c1d353f1a82a4,0xbf54db313f0e39da,0xbf28296a3f4105b8,0xbf3504f33f3504f3,0xbefa2c903f5f5be6,0xbf0e39da3f54db31,0xbe996dba3f743c41,0xbec3ef153f6c835e,0xbdc8bd363f7ec46d,0xbe47c5c23f7b14be,0x3ddcbd0d3f7e8238
.quad 0xbf167918bf4f1bbd,0xbf3504f3bf3504f3,0xbf42a9f7bf26423a,0xbf5b941abf039c3d,0xbf641901bee87171,0xbf74fa0bbe94a031,0xbf78ed3cbe6f0c4d,0xbf7fb10fbd48fb30,0xbf80000080000000,0xbf7b14be3e47c5c2,0xbf78ed3c3e6f0c4d,0xbf676bd83edae880,0xbf6419013ee87171,0xbf45e4033f226799,0xbf42a9f73f26423a,0xbf187fc03f4d9f02
.quad 0xbf1679183f4f1bbd,0xbec3ef153f6c835e,0xbec3ef153f6c835e,0xbe1640833f7d3aac,0xbe20305b3f7cd925,0x3dc8bd363f7ec46d,0x3da0af2a3f7f35f9,0x3eac7cd43f710908,0x3e9e377a3f737871,0x3f0e39da3f54db31,0x3f05c2773f5a46a0,0x3f3daef93f2beb4a,0x3f3504f33f3504f3,0x3f61c5983ef15aea,0x3f5a46a03f05c277,0x3f7853f83e78cfcc
.quad 0xbf737871be9e377a,0xbf7cd925be20305b,0xbf7fcd79bd20cee7,0xbf7deafa3e0255f4,0xbf78ed3c3e6f0c4d,0xbf6a8b4b3ecd2ef3,0xbf5f5be63efa2c90,0xbf4449693f2456f1,0xbf3504f33f3504f3,0xbf0e39da3f54db31,0xbefa2c903f5f5be6,0xbe996dba3f743c41,0xbe6f0c4d3f78ed3c,0xbca0d6d63f7ff35e,0x3d20cee73f7fcd79,0x3e8622103f770f11
.quad 0x3e9e377a3f737871,0x3f05c2773f5a46a0,0x3f0e39da3f54db31,0x3f3daef93f2beb4a,0x3f42a9f73f26423a,0x3f6655e73edf7108,0x3f687c123ed65a92,0x3f7c71603e2a1c3f,0x3f7cd9253e20305b,0x3f7e39bcbdf0b772,0x3f7e39bcbdf0b772,0x3f6b8a3dbec8917e,0x3f6c835ebec3ef15,0x3f45e403bf226799,0x3f490a88bf1e7cf1,0x3f104f0ebf53731f
.quad 0x3e9e377abf737871,0x3e20305bbf7cd925,0x3e0c4cf7bf7d95f4,0xbcf13d4cbf7fe394,0xbd20cee7bf7fcd79,0xbe5b73dcbf7a0d54,0xbe5b73dcbf7a0d54,0xbec8917ebf6b8a3d,0xbec3ef15bf6c835e,0xbf0e39dabf54db31,0xbf0a04f8bf579b8c,0xbf333bc6bf36c9a9,0xbf2dc5e3bf3bfc8f,0xbf5205d4bf1260b2,0xbf4c1d35bf1a82a4,0xbf698690bed1c759
.quad 0xbf641901bee87171,0xbf78ed3cbe6f0c4d,0xbf74fa0bbe94a031,0xbf7fb10fbd48fb30,0xbf7e39bcbdf0b772,0xbf7d95f43e0c4cf7,0xbf7f8e563d712283,0xbf72ae9e3ea2fd52,0xbf78ed3c3e6f0c4d,0xbf5f5be63efa2c90,0xbf6a8b4b3ecd2ef3,0xbf4449693f2456f1,0xbf54db313f0e39da,0xbf2267993f45e403,0xbf3889dc3f316e2c,0xbef5c6c53f609384
.quad 0xbe9e377abf737871,0xbee87171bf641901,0xbf0172c3bf5cdc29,0xbf2456f1bf444969,0xbf2dc5e3bf3bfc8f,0xbf4c1d35bf1a82a4,0xbf5205d4bf1260b2,0xbf698690bed1c759,0xbf6c835ebec3ef15,0xbf7b14bebe47c5c2,0xbf7c0361be3403f1,0xbf7fe3943cf13d4c,0xbf7fcd793d20cee7,0xbf77b4933e814693,0xbf77b4933e814693,0xbf62f2193eece91a
.quad 0xbf6419013ee87171,0xbf42a9f73f26423a,0xbf45e4033f226799,0xbf187fc03f4d9f02,0xbf1e7cf13f490a88,0xbecd2ef33f6a8b4b,0xbedf71083f6655e7,0xbe3de7313f7b8f2a,0xbe6f0c4d3f78ed3c,0x3d20cee73f7fcd79,0xbca0d6d63f7ff35e,0x3e8622103f770f11,0x3e47c5c23f7b14be,0x3ef15aea3f61c598,0x3ecd2ef33f6a8b4b,0x3f28296a3f4105b8
.quad 0xbf4f1bbdbf167918,0xbf641901bee87171,0xbf6e641abeba9be1,0xbf7a9421be519f65,0xbf7e39bcbdf0b772,0xbf7f8e563d712283,0xbf7d95f43e0c4cf7,0xbf72ae9e3ea2fd52,0xbf6c835e3ec3ef15,0xbf54db313f0e39da,0xbf4c1d353f1a82a4,0xbf28296a3f4105b8,0xbf1e7cf13f490a88,0xbedf71083f6655e7,0xbecd2ef33f6a8b4b,0xbe3de7313f7b8f2a
.quad 0xbe20305b3f7cd925,0x3da0af2a3f7f35f9,0x3dc8bd363f7ec46d,0x3eac7cd43f710908,0x3eb136413f702d4f,0x3f1260b23f5205d4,0x3f1260b23f5205d4,0x3f4449693f2456f1,0x3f42a9f73f26423a,0x3f687c123ed65a92,0x3f6655e73edf7108,0x3f7c71603e2a1c3f,0x3f7b14be3e47c5c2,0x3f7ec46dbdc8bd36,0x3f7f8e56bd712283,0x3f6f4ba8beb5eb4f
.quad 0xbf80000080000000,0xbf7cd9253e20305b,0xbf74fa0b3e94a031,0xbf653a483ee3f40d,0xbf54db313f0e39da,0xbf3889dc3f316e2c,0xbf2267993f45e403,0xbef5c6c53f609384,0xbec3ef153f6c835e,0xbe47c5c23f7b14be,0xbdc8bd363f7ec46d,0x3ddcbd0d3f7e8238,0x3e47c5c23f7b14be,0x3ecd2ef33f6a8b4b,0x3ef15aea3f61c598,0x3f28296a3f4105b8
.quad 0x3f3504f33f3504f3,0x3f5a46a03f05c277,0x3f61c5983ef15aea,0x3f7853f83e78cfcc,0x3f7b14be3e47c5c2,0x3f7f8e56bd712283,0x3f7ec46dbdc8bd36,0x3f6f4ba8beb5eb4f,0x3f6c835ebec3ef15,0x3f490a88bf1e7cf1,0x3f45e403bf226799,0x3f104f0ebf53731f,0x3f0e39dabf54db31,0x3e94a031bf74fa0b,0x3e94a031bf74fa0b,0xbc20d8d2bf7ffcd7
```
